```python
import torch

def _softmax(x, axis=-1):
    return torch.softmax(x, dim=axis)

def _gelu(x):
    return torch.nn.functional.gelu(x, approximate='tanh')

def _silu(x):
    return torch.nn.functional.silu(x)

def _sigmoid(x):
    return torch.sigmoid(x)

def _layernorm(x, axis=-1, eps=1e-05):
    m = x.mean(dim=axis, keepdim=True)
    v = x.var(dim=axis, keepdim=True, unbiased=False)
    return (x - m) / torch.sqrt(v + eps)

def _scatter_add(tgt, idx, src, axis=0):
    return tgt.clone().index_add_(axis, idx, src)

def _segment_sum(src, seg, n):
    out = torch.zeros((n,) + src.shape[1:], dtype=src.dtype)
    return out.index_add_(0, seg, src)

def _pad(x, pw):
    flat = tuple((v for pair in reversed(pw) for v in pair))
    return torch.nn.functional.pad(x, flat)
kernel_name = 'concat_heads__linear_kernel_hedgehog__memory_aug_recurrent_mem_tr__prompt'

def setup_inputs():

    _w = lambda a: (lambda t: t.to(torch.bfloat16) if t.is_floating_point() else t)(torch.as_tensor(a))

    def _A_setup():
        B, S, D, H = (1, 2048, 448, 16)
        Dh = D // H
        return {'x': _w((lambda *s: torch.randn(*s, dtype=torch.bfloat16) * 0.4)(B, S, D)), 'wqkv': _w((lambda *s: torch.randn(*s, dtype=torch.bfloat16) * 0.4)(D, 3 * D)), 'w_phi': _w((lambda *s: torch.randn(*s, dtype=torch.bfloat16) * 0.4)(H, Dh, Dh) * Dh ** (-0.5)), 'wo': _w((lambda *s: torch.randn(*s, dtype=torch.bfloat16) * 0.05)(D, D))}
    _A_in = _A_setup()

    def _B_setup():
        B, S, Dm = (1, 2048, 448)
        H, Dh = (16, 256)
        M, seg = (8, 32)
        seg = min(seg, S)
        S = S // seg * seg
        return {'x': _w((lambda *s: torch.randn(*s, dtype=torch.bfloat16) * 0.05)(B, S, Dm)), 'mem0': _w((lambda *s: torch.randn(*s, dtype=torch.bfloat16) * 0.8)(B, M, Dm)), 'Wq': _w((lambda *s: torch.randn(*s, dtype=torch.bfloat16) * 1.6)(Dm, H, Dh) * Dm ** (-0.5)), 'Wk': _w((lambda *s: torch.randn(*s, dtype=torch.bfloat16) * 1.6)(Dm, H, Dh) * Dm ** (-0.5)), 'Wv': _w((lambda *s: torch.randn(*s, dtype=torch.bfloat16) * 0.8)(Dm, H, Dh) * Dm ** (-0.5)), 'Wo': _w((lambda *s: torch.randn(*s, dtype=torch.bfloat16) * 0.8)(H, Dh, Dm) * (H * Dh) ** (-0.5)), 'seg_len': seg}
    _B_in = _B_setup()
    return {'A_x': _A_in['x'], 'A_wqkv': _A_in['wqkv'], 'A_w_phi': _A_in['w_phi'], 'A_wo': _A_in['wo'], 'B_x': _B_in['x'], 'B_mem0': _B_in['mem0'], 'B_Wq': _B_in['Wq'], 'B_Wk': _B_in['Wk'], 'B_Wv': _B_in['Wv'], 'B_Wo': _B_in['Wo'], 'B_seg_len': _B_in['seg_len']}

def reference(A_x, A_wqkv, A_w_phi, A_wo, B_x, B_mem0, B_Wq, B_Wk, B_Wv, B_Wo, B_seg_len):

    def _A_ref(x, wqkv, w_phi, wo):
        B, S, D = x.shape
        H = 16
        Dh = D // H
        qkv = (lambda x, *d: x.permute(*d))((x @ wqkv).reshape(B, S, 3, H, Dh), 2, 0, 3, 1, 4)
        q, k, v = (qkv[0], qkv[1], qkv[2])
        pq = torch.einsum('bhsd,hdf->bhsf', q, w_phi)
        pk = torch.einsum('bhsd,hdf->bhsf', k, w_phi)
        phi_q = torch.concatenate([_softmax(pq, axis=-1), _softmax(-pq, axis=-1)], axis=-1)
        phi_k = torch.concatenate([_softmax(pk, axis=-1), _softmax(-pk, axis=-1)], axis=-1)
        kv = torch.einsum('bhsf,bhsd->bhfd', phi_k, v)
        z = torch.einsum('bhsf->bhf', phi_k)
        num = torch.einsum('bhqf,bhfd->bhqd', phi_q, kv)
        den = torch.einsum('bhqf,bhf->bhq', phi_q, z)[..., None] + 1e-06
        o = num / den
        return (lambda x, *d: x.permute(*d))(o, 0, 2, 1, 3).reshape(B, S, D) @ wo

    def _B_ref(x, mem0, Wq, Wk, Wv, Wo, seg_len):
        B, S, Dm = x.shape
        H, Dh = (Wq.shape[1], Wq.shape[2])
        M = mem0.shape[1]
        scale = Dh ** (-0.5)
        n_seg = S // seg_len
        L = M + seg_len
        idx = torch.arange(L)
        mask = (idx[:, None] < M) | (idx[:, None] >= idx[None, :])
        mem = mem0
        outs = []
        for s in range(n_seg):
            xs = x[:, s * seg_len:(s + 1) * seg_len, :].clone()
            h = torch.concatenate([mem, xs], axis=1)
            q = torch.einsum('btd,dhe->bhte', h, Wq)
            k = torch.einsum('btd,dhe->bhte', h, Wk)
            v = torch.einsum('btd,dhe->bhte', h, Wv)
            scores = torch.einsum('bhqe,bhke->bhqk', q, k) * scale
            scores = torch.where(mask[None, None], scores, -1000000000.0)
            p = _softmax(scores, axis=-1)
            o = torch.einsum('bhqk,bhke->bhqe', p, v)
            o = torch.einsum('bhte,hed->btd', o, Wo)
            mem = o[:, :M, :].clone()
            outs.append(o[:, M:, :])
        return torch.concatenate(outs, axis=1)
    a = _A_ref(A_x, A_wqkv, A_w_phi, A_wo)
    b = _B_ref(B_x, B_mem0, B_Wq, B_Wk, B_Wv, B_Wo, B_seg_len)
    return torch.concatenate([a, b], axis=-1)
```

```asm
; @launch kernel=mega_kernel grid=(256,1,1) block=(256,1,1) lds=124992
.amdgcn_target "amdgcn-amd-amdhsa--gfx950"
.text
.globl mega_kernel
.p2align 8
.type mega_kernel,@function
mega_kernel:
    s_cmp_ge_u32 s2, 256
    s_cbranch_scc1 wk_done
    s_load_dwordx2 s[80:81], s[0:1], 104
    s_load_dwordx2 s[82:83], s[0:1], 32
    v_lshrrev_b32 v232, 6, v0
    v_and_b32 v233, 63, v0
    s_nop 0
    v_readfirstlane_b32 s3, v232
    v_and_b32 v234, 31, v233
    v_lshrrev_b32 v235, 5, v233
    v_lshlrev_b32 v233, 4, v233
    s_waitcnt lgkmcnt(0)
    s_add_u32 s68, s80, 0x5ac0000
    s_addc_u32 s69, s81, 0x0
    s_mov_b32 s70, 0x580000
    s_mov_b32 s71, 0x00020000
    s_add_u32 s72, s80, 0x5240000
    s_addc_u32 s73, s81, 0x0
    s_mov_b32 s74, 0x200000
    s_mov_b32 s75, 0x00020000
    s_mov_b32 s76, s82
    s_mov_b32 s77, s83
    s_mov_b32 s78, 0x1c0000
    s_mov_b32 s79, 0x00020000
    s_lshl_b32 s80, s2, 2
    s_add_u32 s80, s80, s3
    s_mul_i32 s81, s80, 4682
    s_lshr_b32 s81, s81, 16
    s_mul_i32 s82, s81, 14
    s_sub_u32 s82, s80, s82
    s_lshl_b32 s83, s81, 5
    v_add_u32 v234, s83, v234
    v_mul_u32_u24 v234, 896, v234
    v_lshl_add_u32 v234, v235, 4, v234
    s_lshl_b32 s83, s82, 6
    v_add_u32 v234, s83, v234
    buffer_load_dwordx4 v[240:243], v234, s[76:79], 0 offen offset:0
    buffer_load_dwordx4 v[244:247], v234, s[76:79], 0 offen offset:32
    v_and_b32 v232, 15, v0
    s_lshr_b32 s83, s80, 4
    s_lshl_b32 s83, s83, 1
    s_and_b32 s3, s80, 1
    s_add_u32 s83, s83, s3
    s_lshl_b32 s83, s83, 4
    v_add_u32 v232, s83, v232
    v_mul_u32_u24 v232, 896, v232
    v_bfe_u32 v234, v0, 5, 1
    v_lshl_add_u32 v232, v234, 3, v232
    v_bfe_u32 v234, v0, 4, 1
    v_lshl_add_u32 v232, v234, 6, v232
    s_bfe_u32 s83, s80, 0x20002
    s_mul_i32 s83, s83, 224
    s_bfe_u32 s3, s80, 0x10001
    s_lshl_b32 s3, s3, 7
    s_add_u32 s83, s83, s3
    v_add_u32 v232, s83, v232
    buffer_load_dword v224, v232, s[76:79], 0 offen offset:0
    buffer_load_dword v225, v232, s[76:79], 0 offen offset:32
    buffer_load_dword v226, v232, s[76:79], 0 offen offset:4
    buffer_load_dword v227, v232, s[76:79], 0 offen offset:36
    buffer_load_dword v228, v232, s[76:79], 0 offen offset:16
    buffer_load_dword v229, v232, s[76:79], 0 offen offset:48
    buffer_load_dword v230, v232, s[76:79], 0 offen offset:20
    buffer_load_dword v231, v232, s[76:79], 0 offen offset:52
    s_lshl_b32 s83, s80, 11
    s_add_u32 s83, s83, 3670016
    v_add_u32 v232, s83, v233
    s_mul_i32 s81, s81, 28672
    s_lshl_b32 s82, s82, 11
    s_add_u32 s81, s81, s82
    s_cmp_lt_u32 s80, 896
    s_cselect_b32 s81, s81, 0x40000000
    v_add_u32 v235, s81, v233
    s_mul_i32 s80, s80, 2048
    v_add_u32 v234, s80, v233
    v_mov_b32 v236, -1
    v_mov_b32 v237, -1
    v_mov_b32 v238, -1
    v_mov_b32 v239, -1
    s_mov_b32 s83, 1835008
    s_and_b32 s3, s2, 7
    s_cmp_eq_u32 s3, 0
    s_cbranch_scc1 ch_entry
    s_movk_i32 s101, 2000
    s_mov_b32 s93, 0
    s_load_dwordx2 s[4:5], s[0:1], 104
    s_waitcnt lgkmcnt(0)
    s_add_u32 s96, s4, 0x543c000
    s_addc_u32 s97, s5, 0x0
    s_mov_b32 s98, 0x4000
    s_mov_b32 s99, 0x00020000
    s_sub_u32 s100, s3, 1
    s_lshl_b32 s100, s100, 5
    s_lshr_b32 s3, s2, 3
    s_add_u32 s100, s100, s3
    s_mov_b32 s101, s100
    s_branch tk_mg
wk_loop:
    s_waitcnt vmcnt(0) lgkmcnt(0)
    s_barrier
    s_load_dwordx2 s[74:75], s[0:1], 96
    s_waitcnt lgkmcnt(0)
    s_mov_b32 s80, s74
    s_mov_b32 s81, s75
    s_mov_b32 s82, 0x100
    s_mov_b32 s83, 0x00020000
    v_mov_b32 v1, 1
    v_mov_b32 v2, 0
    v_mov_b32 v3, 124928
    v_cmp_eq_u32 vcc, 0, v0
    s_and_b64 exec, exec, vcc
    buffer_atomic_add v1, v2, s[80:83], 0 offen sc0 sc1
    s_waitcnt vmcnt(0)
    ds_write_b32 v3, v1
    s_mov_b64 exec, -1
    s_waitcnt lgkmcnt(0)
    s_barrier
    ds_read_b32 v1, v3
    s_waitcnt lgkmcnt(0)
    v_readfirstlane_b32 s100, v1
    s_nop 3
    s_add_u32 s101, s100, 224
    s_cmp_lt_u32 s100, 64
    s_cbranch_scc1 tk_tu
    s_sub_u32 s100, s100, 64
    s_cmp_lt_u32 s100, 336
    s_cbranch_scc1 tk_fold
    s_sub_u32 s100, s100, 336
    s_cmp_lt_u32 s100, 256
    s_cbranch_scc1 tk_a1
    s_sub_u32 s100, s100, 256
    s_cmp_lt_u32 s100, 64
    s_cbranch_scc1 tk_a2
    s_sub_u32 s100, s100, 64
    s_cmp_lt_u32 s100, 57
    s_cbranch_scc1 tk_bfin
    s_sub_u32 s100, s100, 57
    s_cmp_lt_u32 s100, 28
    s_cbranch_scc1 tk_bf4
    s_sub_u32 s100, s100, 28
wk_done:
    s_endpgm
tk_mg:
    s_load_dwordx4 s[4:7], s[0:1], 48
    s_load_dwordx4 s[8:11], s[0:1], 64
    s_load_dwordx2 s[12:13], s[0:1], 104
    s_load_dwordx2 s[44:45], s[0:1], 32
    s_load_dwordx2 s[46:47], s[0:1], 96
    s_mov_b32 s14, 0x24924925
    s_mul_hi_u32 s15, s100, s14
    s_mul_i32 s16, s15, 7
    s_sub_u32 s16, s100, s16
    s_lshr_b32 s17, s15, 4
    s_and_b32 s18, s15, 15
    v_lshrrev_b32 v1, 6, v0
    v_and_b32 v2, 63, v0
    s_nop 0
    v_readfirstlane_b32 s19, v1
    v_and_b32 v3, 31, v2
    v_lshrrev_b32 v4, 5, v2
    v_and_b32 v10, 0x13, v3
    v_and_b32 v11, 4, v3
    v_lshl_or_b32 v10, v11, 1, v10
    v_and_b32 v11, 8, v3
    v_lshrrev_b32 v11, 1, v11
    v_or_b32 v10, v11, v10
    s_and_b32 s20, s19, 1
    s_lshr_b32 s21, s19, 1
    s_waitcnt lgkmcnt(0)
    s_cmp_eq_u32 s17, 0
    s_cselect_b32 s24, s4, s10
    s_cselect_b32 s25, s5, s11
    s_mov_b32 s26, 3670016
    s_mov_b32 s27, 0x00020000
    s_cselect_b32 s28, s6, s8
    s_cselect_b32 s29, s7, s9
    s_mov_b32 s30, 3670016
    s_mov_b32 s31, 0x00020000
    s_mov_b32 s32, s12
    s_mov_b32 s33, s13
    s_mov_b32 s34, 0xc40000
    s_mov_b32 s35, 0x00020000
    s_add_u32 s48, s12, 0x5ac0000
    s_addc_u32 s49, s13, 0x0
    s_mov_b32 s50, 0x1c0000
    s_mov_b32 s51, 0x00020000
    s_add_u32 s52, s12, 0xc40000
    s_addc_u32 s53, s13, 0x0
    s_mov_b32 s54, 0x1c00000
    s_mov_b32 s55, 0x00020000
    s_add_u32 s56, s12, 0x2840000
    s_addc_u32 s57, s13, 0x0
    s_mov_b32 s58, 0x1c00000
    s_mov_b32 s59, 0x00020000
    s_mov_b32 s60, s46
    s_mov_b32 s61, s47
    s_mov_b32 s62, 0x100
    s_mov_b32 s63, 0x00020000
    s_add_u32 s64, s12, 0x5aa0000
    s_addc_u32 s65, s13, 0x0
    s_mov_b32 s66, 0x20000
    s_mov_b32 s67, 0x00020000
    s_add_u32 s44, s12, 0x6040000
    s_addc_u32 s45, s13, 0x0
    s_mov_b32 s46, 0x621000
    s_mov_b32 s47, 0x00020000
    v_mov_b32 v11, 0
    s_lshl_b32 s22, s100, 10
    v_lshlrev_b32 v12, 2, v0
    v_add_u32 v12, s22, v12
    buffer_store_dword v11, v12, s[64:67], 0 offen sc1
    v_mov_b32 v13, 0
    s_lshl_b32 s23, s100, 2
    s_add_u32 s23, s23, 6422528
    v_mov_b32 v14, s23
    v_cmp_eq_u32 vcc, 0, v0
    s_and_b64 exec, exec, vcc
    buffer_store_dword v13, v14, s[44:47], 0 offen sc1
    s_mov_b64 exec, -1
    s_lshl_b32 s22, s16, 6
    s_lshl_b32 s23, s20, 5
    s_add_u32 s22, s22, s23
    v_and_b32 v13, 0x19, v3
    v_and_b32 v14, 2, v3
    v_lshl_or_b32 v13, v14, 1, v13
    v_and_b32 v14, 4, v3
    v_lshrrev_b32 v14, 1, v14
    v_or_b32 v13, v13, v14
    s_cmp_eq_u32 s17, 0
    s_cselect_b64 vcc, -1, 0
    v_cndmask_b32 v13, v10, v13, vcc
    v_add_u32 v5, s22, v13
    s_mul_i32 s36, s21, 224
    s_lshl_b32 s37, s20, 4
    s_add_u32 s36, s36, s37
    v_add_u32 v6, s36, v4
    v_lshlrev_b32 v6, 13, v6
    s_lshl_b32 s37, s18, 9
    v_add_u32 v6, s37, v6
    v_lshl_add_u32 v6, v3, 4, v6
    s_lshl_b32 s38, s19, 4
    v_add_u32 v15, s38, v4
    v_mul_u32_u24 v15, 528, v15
    v_lshl_add_u32 v15, v3, 4, v15
    v_add_u32 v15, 57344, v15
    s_add_u32 s4, s16, 0
    s_sub_u32 s11, s4, 7
    s_cmp_ge_u32 s4, 7
    s_cselect_b32 s4, s11, s4
    s_add_u32 s5, s16, 1
    s_sub_u32 s11, s5, 7
    s_cmp_ge_u32 s5, 7
    s_cselect_b32 s5, s11, s5
    s_add_u32 s6, s16, 2
    s_sub_u32 s11, s6, 7
    s_cmp_ge_u32 s6, 7
    s_cselect_b32 s6, s11, s6
    s_add_u32 s7, s16, 3
    s_sub_u32 s11, s7, 7
    s_cmp_ge_u32 s7, 7
    s_cselect_b32 s7, s11, s7
    s_add_u32 s8, s16, 4
    s_sub_u32 s11, s8, 7
    s_cmp_ge_u32 s8, 7
    s_cselect_b32 s8, s11, s8
    s_add_u32 s9, s16, 5
    s_sub_u32 s11, s9, 7
    s_cmp_ge_u32 s9, 7
    s_cselect_b32 s9, s11, s9
    s_add_u32 s10, s16, 6
    s_sub_u32 s11, s10, 7
    s_cmp_ge_u32 s10, 7
    s_cselect_b32 s10, s11, s10
    s_cmp_eq_u32 s17, 0
    s_cbranch_scc0 mm_mat1
    s_lshl_b32 s39, s16, 6
    s_add_u32 s39, s39, s38
    v_add_u32 v7, s39, v4
    v_lshlrev_b32 v7, 13, v7
    v_add_u32 v7, s37, v7
    v_lshl_add_u32 v7, v3, 4, v7
    s_mov_b32 s43, 0
    buffer_load_dwordx4 v[16:19], v7, s[24:27], s43 offen
    s_mov_b32 s43, 16384
    buffer_load_dwordx4 v[20:23], v7, s[24:27], s43 offen
    s_mov_b32 s43, 32768
    buffer_load_dwordx4 v[24:27], v7, s[24:27], s43 offen
    s_mov_b32 s43, 49152
    buffer_load_dwordx4 v[28:31], v7, s[24:27], s43 offen
    s_mov_b32 s43, 65536
    buffer_load_dwordx4 v[32:35], v7, s[24:27], s43 offen
    s_mov_b32 s43, 81920
    buffer_load_dwordx4 v[36:39], v7, s[24:27], s43 offen
    s_mov_b32 s43, 98304
    buffer_load_dwordx4 v[40:43], v7, s[24:27], s43 offen
    s_mov_b32 s43, 114688
    buffer_load_dwordx4 v[44:47], v7, s[24:27], s43 offen
    s_lshl_b32 s42, s4, 18
    s_add_u32 s43, s42, 0
    buffer_load_dwordx4 a[0:3], v6, s[28:31], s43 offen
    s_add_u32 s43, s42, 16384
    buffer_load_dwordx4 a[4:7], v6, s[28:31], s43 offen
    s_add_u32 s43, s42, 32768
    buffer_load_dwordx4 a[8:11], v6, s[28:31], s43 offen
    s_add_u32 s43, s42, 49152
    buffer_load_dwordx4 a[12:15], v6, s[28:31], s43 offen
    s_add_u32 s43, s42, 65536
    buffer_load_dwordx4 a[16:19], v6, s[28:31], s43 offen
    s_add_u32 s43, s42, 81920
    buffer_load_dwordx4 a[20:23], v6, s[28:31], s43 offen
    s_add_u32 s43, s42, 98304
    buffer_load_dwordx4 a[24:27], v6, s[28:31], s43 offen
    s_add_u32 s43, s42, 114688
    buffer_load_dwordx4 a[28:31], v6, s[28:31], s43 offen
    s_lshl_b32 s42, s5, 18
    s_add_u32 s43, s42, 0
    buffer_load_dwordx4 a[32:35], v6, s[28:31], s43 offen
    s_add_u32 s43, s42, 16384
    buffer_load_dwordx4 a[36:39], v6, s[28:31], s43 offen
    s_add_u32 s43, s42, 32768
    buffer_load_dwordx4 a[40:43], v6, s[28:31], s43 offen
    s_add_u32 s43, s42, 49152
    buffer_load_dwordx4 a[44:47], v6, s[28:31], s43 offen
    s_add_u32 s43, s42, 65536
    buffer_load_dwordx4 a[48:51], v6, s[28:31], s43 offen
    s_add_u32 s43, s42, 81920
    buffer_load_dwordx4 a[52:55], v6, s[28:31], s43 offen
    s_add_u32 s43, s42, 98304
    buffer_load_dwordx4 a[56:59], v6, s[28:31], s43 offen
    s_add_u32 s43, s42, 114688
    buffer_load_dwordx4 a[60:63], v6, s[28:31], s43 offen
    s_lshl_b32 s42, s6, 18
    s_add_u32 s43, s42, 0
    buffer_load_dwordx4 a[64:67], v6, s[28:31], s43 offen
    s_add_u32 s43, s42, 16384
    buffer_load_dwordx4 a[68:71], v6, s[28:31], s43 offen
    s_add_u32 s43, s42, 32768
    buffer_load_dwordx4 a[72:75], v6, s[28:31], s43 offen
    s_add_u32 s43, s42, 49152
    buffer_load_dwordx4 a[76:79], v6, s[28:31], s43 offen
    s_add_u32 s43, s42, 65536
    buffer_load_dwordx4 a[80:83], v6, s[28:31], s43 offen
    s_add_u32 s43, s42, 81920
    buffer_load_dwordx4 a[84:87], v6, s[28:31], s43 offen
    s_add_u32 s43, s42, 98304
    buffer_load_dwordx4 a[88:91], v6, s[28:31], s43 offen
    s_add_u32 s43, s42, 114688
    buffer_load_dwordx4 a[92:95], v6, s[28:31], s43 offen
    s_waitcnt vmcnt(24)
    v_mov_b32 v252, 1
    v_mov_b32 v253, 16
    v_cmp_eq_u32 vcc, 0, v0
    s_and_b64 exec, exec, vcc
    buffer_atomic_add v252, v253, s[60:63], 0 offen sc1
    s_mov_b64 exec, -1
    ds_write_b128 v15, v[16:19] offset:33792
    ds_write_b128 v15, v[20:23] offset:34848
    ds_write_b128 v15, v[24:27] offset:35904
    ds_write_b128 v15, v[28:31] offset:36960
    ds_write_b128 v15, v[32:35] offset:38016
    ds_write_b128 v15, v[36:39] offset:39072
    ds_write_b128 v15, v[40:43] offset:40128
    ds_write_b128 v15, v[44:47] offset:41184
    s_waitcnt vmcnt(16)
    ds_write_b128 v15, a[0:3] offset:0
    ds_write_b128 v15, a[4:7] offset:1056
    ds_write_b128 v15, a[8:11] offset:2112
    ds_write_b128 v15, a[12:15] offset:3168
    ds_write_b128 v15, a[16:19] offset:4224
    ds_write_b128 v15, a[20:23] offset:5280
    ds_write_b128 v15, a[24:27] offset:6336
    ds_write_b128 v15, a[28:31] offset:7392
    s_waitcnt lgkmcnt(0)
    s_barrier
    s_lshl_b32 s39, s20, 5
    v_add_u32 v7, s39, v13
    v_mul_u32_u24 v7, 528, v7
    v_lshl_add_u32 v7, v4, 4, v7
    v_add_u32 v7, 91136, v7
    ds_read_b128 v[16:19], v7 offset:0
    ds_read_b128 v[20:23], v7 offset:32
    ds_read_b128 v[24:27], v7 offset:64
    ds_read_b128 v[28:31], v7 offset:96
    ds_read_b128 v[32:35], v7 offset:128
    ds_read_b128 v[36:39], v7 offset:160
    ds_read_b128 v[40:43], v7 offset:192
    ds_read_b128 v[44:47], v7 offset:224
    ds_read_b128 v[48:51], v7 offset:256
    ds_read_b128 v[52:55], v7 offset:288
    ds_read_b128 v[56:59], v7 offset:320
    ds_read_b128 v[60:63], v7 offset:352
    ds_read_b128 v[64:67], v7 offset:384
    ds_read_b128 v[68:71], v7 offset:416
    ds_read_b128 v[72:75], v7 offset:448
    ds_read_b128 v[76:79], v7 offset:480
    s_branch mm_go
mm_mat1:
    s_mul_i32 s38, s18, 229376
    s_lshl_b32 s39, s16, 7
    s_add_u32 s38, s38, s39
    s_mul_i32 s39, s19, 57344
    s_add_u32 s38, s38, s39
    v_lshrrev_b32 v8, 3, v2
    v_and_b32 v9, 7, v2
    v_mul_u32_u24 v7, 896, v8
    v_add_u32 v7, s38, v7
    v_lshl_add_u32 v7, v9, 4, v7
    s_mov_b32 s39, 0
    buffer_load_dwordx4 v[16:19], v7, s[24:27], s39 offen
    s_mov_b32 s39, 7168
    buffer_load_dwordx4 v[20:23], v7, s[24:27], s39 offen
    s_mov_b32 s39, 14336
    buffer_load_dwordx4 v[24:27], v7, s[24:27], s39 offen
    s_mov_b32 s39, 21504
    buffer_load_dwordx4 v[28:31], v7, s[24:27], s39 offen
    s_mov_b32 s39, 28672
    buffer_load_dwordx4 v[32:35], v7, s[24:27], s39 offen
    s_mov_b32 s39, 35840
    buffer_load_dwordx4 v[36:39], v7, s[24:27], s39 offen
    s_mov_b32 s39, 43008
    buffer_load_dwordx4 v[40:43], v7, s[24:27], s39 offen
    s_mov_b32 s39, 50176
    buffer_load_dwordx4 v[44:47], v7, s[24:27], s39 offen
    s_lshl_b32 s42, s4, 18
    s_add_u32 s43, s42, 0
    buffer_load_dwordx4 a[0:3], v6, s[28:31], s43 offen
    s_add_u32 s43, s42, 16384
    buffer_load_dwordx4 a[4:7], v6, s[28:31], s43 offen
    s_add_u32 s43, s42, 32768
    buffer_load_dwordx4 a[8:11], v6, s[28:31], s43 offen
    s_add_u32 s43, s42, 49152
    buffer_load_dwordx4 a[12:15], v6, s[28:31], s43 offen
    s_add_u32 s43, s42, 65536
    buffer_load_dwordx4 a[16:19], v6, s[28:31], s43 offen
    s_add_u32 s43, s42, 81920
    buffer_load_dwordx4 a[20:23], v6, s[28:31], s43 offen
    s_add_u32 s43, s42, 98304
    buffer_load_dwordx4 a[24:27], v6, s[28:31], s43 offen
    s_add_u32 s43, s42, 114688
    buffer_load_dwordx4 a[28:31], v6, s[28:31], s43 offen
    s_lshl_b32 s42, s5, 18
    s_add_u32 s43, s42, 0
    buffer_load_dwordx4 a[32:35], v6, s[28:31], s43 offen
    s_add_u32 s43, s42, 16384
    buffer_load_dwordx4 a[36:39], v6, s[28:31], s43 offen
    s_add_u32 s43, s42, 32768
    buffer_load_dwordx4 a[40:43], v6, s[28:31], s43 offen
    s_add_u32 s43, s42, 49152
    buffer_load_dwordx4 a[44:47], v6, s[28:31], s43 offen
    s_add_u32 s43, s42, 65536
    buffer_load_dwordx4 a[48:51], v6, s[28:31], s43 offen
    s_add_u32 s43, s42, 81920
    buffer_load_dwordx4 a[52:55], v6, s[28:31], s43 offen
    s_add_u32 s43, s42, 98304
    buffer_load_dwordx4 a[56:59], v6, s[28:31], s43 offen
    s_add_u32 s43, s42, 114688
    buffer_load_dwordx4 a[60:63], v6, s[28:31], s43 offen
    s_lshl_b32 s42, s6, 18
    s_add_u32 s43, s42, 0
    buffer_load_dwordx4 a[64:67], v6, s[28:31], s43 offen
    s_add_u32 s43, s42, 16384
    buffer_load_dwordx4 a[68:71], v6, s[28:31], s43 offen
    s_add_u32 s43, s42, 32768
    buffer_load_dwordx4 a[72:75], v6, s[28:31], s43 offen
    s_add_u32 s43, s42, 49152
    buffer_load_dwordx4 a[76:79], v6, s[28:31], s43 offen
    s_add_u32 s43, s42, 65536
    buffer_load_dwordx4 a[80:83], v6, s[28:31], s43 offen
    s_add_u32 s43, s42, 81920
    buffer_load_dwordx4 a[84:87], v6, s[28:31], s43 offen
    s_add_u32 s43, s42, 98304
    buffer_load_dwordx4 a[88:91], v6, s[28:31], s43 offen
    s_add_u32 s43, s42, 114688
    buffer_load_dwordx4 a[92:95], v6, s[28:31], s43 offen
    v_mul_u32_u24 v1, 144, v8
    v_lshl_add_u32 v1, v9, 4, v1
    s_mul_i32 s39, s19, 9216
    v_add_u32 v1, s39, v1
    v_mul_u32_u24 v7, 144, v10
    v_lshl_add_u32 v7, v4, 4, v7
    s_lshl_b32 s39, s20, 6
    v_add_u32 v7, s39, v7
    v_lshlrev_b32 v8, 3, v4
    v_sub_u32 v8, v10, v8
    v_mov_b32 v9, 0x3f80
    v_mov_b32 v11, 0x3f800000
    v_mov_b32 v12, 0
    v_cmp_eq_u32 vcc, 0, v8
    v_cndmask_b32 v144, v12, v9, vcc
    v_cmp_eq_u32 vcc, 1, v8
    v_cndmask_b32 v144, v144, v11, vcc
    v_cmp_eq_u32 vcc, 2, v8
    v_cndmask_b32 v145, v12, v9, vcc
    v_cmp_eq_u32 vcc, 3, v8
    v_cndmask_b32 v145, v145, v11, vcc
    v_cmp_eq_u32 vcc, 4, v8
    v_cndmask_b32 v146, v12, v9, vcc
    v_cmp_eq_u32 vcc, 5, v8
    v_cndmask_b32 v146, v146, v11, vcc
    v_cmp_eq_u32 vcc, 6, v8
    v_cndmask_b32 v147, v12, v9, vcc
    v_cmp_eq_u32 vcc, 7, v8
    v_cndmask_b32 v147, v147, v11, vcc
    v_cmp_eq_u32 vcc, 16, v8
    v_cndmask_b32 v148, v12, v9, vcc
    v_cmp_eq_u32 vcc, 17, v8
    v_cndmask_b32 v148, v148, v11, vcc
    v_cmp_eq_u32 vcc, 18, v8
    v_cndmask_b32 v149, v12, v9, vcc
    v_cmp_eq_u32 vcc, 19, v8
    v_cndmask_b32 v149, v149, v11, vcc
    v_cmp_eq_u32 vcc, 20, v8
    v_cndmask_b32 v150, v12, v9, vcc
    v_cmp_eq_u32 vcc, 21, v8
    v_cndmask_b32 v150, v150, v11, vcc
    v_cmp_eq_u32 vcc, 22, v8
    v_cndmask_b32 v151, v12, v9, vcc
    v_cmp_eq_u32 vcc, 23, v8
    v_cndmask_b32 v151, v151, v11, vcc
    s_waitcnt vmcnt(24)
    v_mov_b32 v252, 1
    v_mov_b32 v253, 16
    v_cmp_eq_u32 vcc, 0, v0
    s_and_b64 exec, exec, vcc
    buffer_atomic_add v252, v253, s[60:63], 0 offen sc1
    s_mov_b64 exec, -1
    ds_write_b128 v1, v[16:19] offset:0
    ds_write_b128 v1, v[20:23] offset:1152
    ds_write_b128 v1, v[24:27] offset:2304
    ds_write_b128 v1, v[28:31] offset:3456
    ds_write_b128 v1, v[32:35] offset:4608
    ds_write_b128 v1, v[36:39] offset:5760
    ds_write_b128 v1, v[40:43] offset:6912
    ds_write_b128 v1, v[44:47] offset:8064
    s_waitcnt lgkmcnt(0)
    s_barrier
    ds_read_b128 v[80:83], v7 offset:0
    ds_read_b128 v[84:87], v7 offset:32
    ds_read_b128 v[88:91], v7 offset:4608
    ds_read_b128 v[92:95], v7 offset:4640
    ds_read_b128 v[96:99], v7 offset:9216
    ds_read_b128 v[100:103], v7 offset:9248
    ds_read_b128 v[104:107], v7 offset:13824
    ds_read_b128 v[108:111], v7 offset:13856
    ds_read_b128 v[112:115], v7 offset:18432
    ds_read_b128 v[116:119], v7 offset:18464
    ds_read_b128 v[120:123], v7 offset:23040
    ds_read_b128 v[124:127], v7 offset:23072
    ds_read_b128 v[128:131], v7 offset:27648
    ds_read_b128 v[132:135], v7 offset:27680
    ds_read_b128 v[136:139], v7 offset:32256
    ds_read_b128 v[140:143], v7 offset:32288
    s_waitcnt lgkmcnt(14)
    v_mfma_f32_32x32x16_bf16 v[208:223], v[80:83], v[144:147], 0
    v_mfma_f32_32x32x16_bf16 v[208:223], v[84:87], v[148:151], v[208:223]
    s_nop 7
    s_waitcnt lgkmcnt(12)
    v_mfma_f32_32x32x16_bf16 v[160:175], v[88:91], v[144:147], 0
    v_mfma_f32_32x32x16_bf16 v[160:175], v[92:95], v[148:151], v[160:175]
    v_cvt_pk_bf16_f32 v16, v208, v209
    v_cvt_pk_bf16_f32 v17, v210, v211
    v_cvt_pk_bf16_f32 v18, v212, v213
    v_cvt_pk_bf16_f32 v19, v214, v215
    v_cvt_pk_bf16_f32 v20, v216, v217
    v_cvt_pk_bf16_f32 v21, v218, v219
    v_cvt_pk_bf16_f32 v22, v220, v221
    v_cvt_pk_bf16_f32 v23, v222, v223
    s_waitcnt lgkmcnt(10)
    v_mfma_f32_32x32x16_bf16 v[208:223], v[96:99], v[144:147], 0
    v_mfma_f32_32x32x16_bf16 v[208:223], v[100:103], v[148:151], v[208:223]
    v_cvt_pk_bf16_f32 v24, v160, v161
    v_cvt_pk_bf16_f32 v25, v162, v163
    v_cvt_pk_bf16_f32 v26, v164, v165
    v_cvt_pk_bf16_f32 v27, v166, v167
    v_cvt_pk_bf16_f32 v28, v168, v169
    v_cvt_pk_bf16_f32 v29, v170, v171
    v_cvt_pk_bf16_f32 v30, v172, v173
    v_cvt_pk_bf16_f32 v31, v174, v175
    s_waitcnt lgkmcnt(8)
    v_mfma_f32_32x32x16_bf16 v[160:175], v[104:107], v[144:147], 0
    v_mfma_f32_32x32x16_bf16 v[160:175], v[108:111], v[148:151], v[160:175]
    v_cvt_pk_bf16_f32 v32, v208, v209
    v_cvt_pk_bf16_f32 v33, v210, v211
    v_cvt_pk_bf16_f32 v34, v212, v213
    v_cvt_pk_bf16_f32 v35, v214, v215
    v_cvt_pk_bf16_f32 v36, v216, v217
    v_cvt_pk_bf16_f32 v37, v218, v219
    v_cvt_pk_bf16_f32 v38, v220, v221
    v_cvt_pk_bf16_f32 v39, v222, v223
    s_waitcnt lgkmcnt(6)
    v_mfma_f32_32x32x16_bf16 v[208:223], v[112:115], v[144:147], 0
    v_mfma_f32_32x32x16_bf16 v[208:223], v[116:119], v[148:151], v[208:223]
    v_cvt_pk_bf16_f32 v40, v160, v161
    v_cvt_pk_bf16_f32 v41, v162, v163
    v_cvt_pk_bf16_f32 v42, v164, v165
    v_cvt_pk_bf16_f32 v43, v166, v167
    v_cvt_pk_bf16_f32 v44, v168, v169
    v_cvt_pk_bf16_f32 v45, v170, v171
    v_cvt_pk_bf16_f32 v46, v172, v173
    v_cvt_pk_bf16_f32 v47, v174, v175
    s_waitcnt lgkmcnt(4)
    v_mfma_f32_32x32x16_bf16 v[160:175], v[120:123], v[144:147], 0
    v_mfma_f32_32x32x16_bf16 v[160:175], v[124:127], v[148:151], v[160:175]
    v_cvt_pk_bf16_f32 v48, v208, v209
    v_cvt_pk_bf16_f32 v49, v210, v211
    v_cvt_pk_bf16_f32 v50, v212, v213
    v_cvt_pk_bf16_f32 v51, v214, v215
    v_cvt_pk_bf16_f32 v52, v216, v217
    v_cvt_pk_bf16_f32 v53, v218, v219
    v_cvt_pk_bf16_f32 v54, v220, v221
    v_cvt_pk_bf16_f32 v55, v222, v223
    s_waitcnt lgkmcnt(2)
    v_mfma_f32_32x32x16_bf16 v[208:223], v[128:131], v[144:147], 0
    v_mfma_f32_32x32x16_bf16 v[208:223], v[132:135], v[148:151], v[208:223]
    v_cvt_pk_bf16_f32 v56, v160, v161
    v_cvt_pk_bf16_f32 v57, v162, v163
    v_cvt_pk_bf16_f32 v58, v164, v165
    v_cvt_pk_bf16_f32 v59, v166, v167
    v_cvt_pk_bf16_f32 v60, v168, v169
    v_cvt_pk_bf16_f32 v61, v170, v171
    v_cvt_pk_bf16_f32 v62, v172, v173
    v_cvt_pk_bf16_f32 v63, v174, v175
    s_waitcnt lgkmcnt(0)
    v_mfma_f32_32x32x16_bf16 v[160:175], v[136:139], v[144:147], 0
    v_mfma_f32_32x32x16_bf16 v[160:175], v[140:143], v[148:151], v[160:175]
    v_cvt_pk_bf16_f32 v64, v208, v209
    v_cvt_pk_bf16_f32 v65, v210, v211
    v_cvt_pk_bf16_f32 v66, v212, v213
    v_cvt_pk_bf16_f32 v67, v214, v215
    v_cvt_pk_bf16_f32 v68, v216, v217
    v_cvt_pk_bf16_f32 v69, v218, v219
    v_cvt_pk_bf16_f32 v70, v220, v221
    v_cvt_pk_bf16_f32 v71, v222, v223
    s_nop 15
    s_nop 1
    v_cvt_pk_bf16_f32 v72, v160, v161
    v_cvt_pk_bf16_f32 v73, v162, v163
    v_cvt_pk_bf16_f32 v74, v164, v165
    v_cvt_pk_bf16_f32 v75, v166, v167
    v_cvt_pk_bf16_f32 v76, v168, v169
    v_cvt_pk_bf16_f32 v77, v170, v171
    v_cvt_pk_bf16_f32 v78, v172, v173
    v_cvt_pk_bf16_f32 v79, v174, v175
    s_waitcnt vmcnt(16)
    ds_write_b128 v15, a[0:3] offset:0
    ds_write_b128 v15, a[4:7] offset:1056
    ds_write_b128 v15, a[8:11] offset:2112
    ds_write_b128 v15, a[12:15] offset:3168
    ds_write_b128 v15, a[16:19] offset:4224
    ds_write_b128 v15, a[20:23] offset:5280
    ds_write_b128 v15, a[24:27] offset:6336
    ds_write_b128 v15, a[28:31] offset:7392
    s_waitcnt lgkmcnt(0)
    s_barrier
mm_go:
    s_cmp_eq_u32 s17, 0
    s_cbranch_scc0 mm_a1
    v_cmp_le_u32 vcc, 224, v5
    v_mov_b32 v8, 0
    v_mov_b32 v13, 0
    v_mov_b32 v9, 224
    v_mov_b32 v14, 1
    v_cndmask_b32 v8, v8, v9, vcc
    v_cndmask_b32 v13, v13, v14, vcc
    v_sub_u32 v8, v5, v8
    s_lshl_b32 s40, s18, 1
    v_add_u32 v13, s40, v13
    s_branch mm_a2
mm_a1:
    s_movk_i32 s40, 4682
    v_mul_u32_u24 v13, s40, v5
    v_lshrrev_b32 v13, 16, v13
    v_mul_u32_u24 v8, 14, v13
    v_sub_u32 v8, v5, v8
    s_mul_i32 s40, s18, 14
    s_add_u32 s40, s40, 224
    v_add_u32 v8, s40, v8
mm_a2:
    s_mov_b32 s40, 401408
    v_mul_lo_u32 v9, v13, s40
    v_lshrrev_b32 v13, 4, v8
    v_mul_u32_u24 v13, 14336, v13
    v_add_u32 v9, v9, v13
    v_and_b32 v8, 15, v8
    v_lshl_add_u32 v9, v8, 4, v9
    v_lshl_add_u32 v9, v4, 8, v9
    s_mul_i32 s42, s21, 7168
    v_add_u32 v9, s42, v9
    v_add_u32 v8, 4096, v9
    v_lshlrev_b32 v12, 4, v2
    s_mul_i32 s40, s20, 28672
    s_mul_i32 s41, s21, 14336
    s_add_u32 s40, s40, s41
    v_add_u32 v11, s40, v12
    s_mul_i32 s40, s18, 401408
    s_mul_i32 s41, s21, 200704
    s_add_u32 s40, s40, s41
    s_lshl_b32 s41, s16, 11
    s_add_u32 s40, s40, s41
    s_lshl_b32 s41, s20, 10
    s_add_u32 s40, s40, s41
    v_lshrrev_b32 v1, 4, v10
    v_mul_u32_u24 v1, 14336, v1
    v_add_u32 v1, s40, v1
    v_lshl_add_u32 v1, v4, 8, v1
    v_and_b32 v13, 15, v10
    v_lshl_add_u32 v1, v13, 4, v1
    s_lshl_b32 s39, s21, 5
    v_add_u32 v7, s39, v10
    v_mul_u32_u24 v7, 528, v7
    v_lshl_add_u32 v7, v4, 4, v7
    v_add_u32 v7, 57344, v7
    s_mov_b32 s86, 0x3db8aa3b
    s_mov_b32 s87, 0x3db8aa3b
    ds_read_b128 v[80:83], v7 offset:0
    ds_read_b128 v[84:87], v7 offset:32
    ds_read_b128 v[88:91], v7 offset:64
    ds_read_b128 v[92:95], v7 offset:96
    ds_read_b128 v[96:99], v7 offset:128
    ds_read_b128 v[100:103], v7 offset:160
    ds_read_b128 v[104:107], v7 offset:192
    ds_read_b128 v[108:111], v7 offset:224
    ds_read_b128 v[112:115], v7 offset:256
    ds_read_b128 v[116:119], v7 offset:288
    ds_read_b128 v[120:123], v7 offset:320
    ds_read_b128 v[124:127], v7 offset:352
    ds_read_b128 v[128:131], v7 offset:384
    ds_read_b128 v[132:135], v7 offset:416
    ds_read_b128 v[136:139], v7 offset:448
    ds_read_b128 v[140:143], v7 offset:480
    s_lshl_b32 s42, s7, 18
    s_add_u32 s43, s42, 0
    buffer_load_dwordx4 a[96:99], v6, s[28:31], s43 offen
    s_add_u32 s43, s42, 16384
    buffer_load_dwordx4 a[100:103], v6, s[28:31], s43 offen
    s_add_u32 s43, s42, 32768
    buffer_load_dwordx4 a[104:107], v6, s[28:31], s43 offen
    s_add_u32 s43, s42, 49152
    buffer_load_dwordx4 a[108:111], v6, s[28:31], s43 offen
    s_add_u32 s43, s42, 65536
    buffer_load_dwordx4 a[112:115], v6, s[28:31], s43 offen
    s_add_u32 s43, s42, 81920
    buffer_load_dwordx4 a[116:119], v6, s[28:31], s43 offen
    s_add_u32 s43, s42, 98304
    buffer_load_dwordx4 a[120:123], v6, s[28:31], s43 offen
    s_add_u32 s43, s42, 114688
    buffer_load_dwordx4 a[124:127], v6, s[28:31], s43 offen
    s_waitcnt lgkmcnt(0)
    s_barrier
    v_mfma_f32_32x32x16_bf16 v[208:223], v[80:83], v[16:19], 0
    v_mfma_f32_32x32x16_bf16 v[208:223], v[84:87], v[20:23], v[208:223]
    v_mfma_f32_32x32x16_bf16 v[208:223], v[88:91], v[24:27], v[208:223]
    v_mfma_f32_32x32x16_bf16 v[208:223], v[92:95], v[28:31], v[208:223]
    v_mfma_f32_32x32x16_bf16 v[208:223], v[96:99], v[32:35], v[208:223]
    v_mfma_f32_32x32x16_bf16 v[208:223], v[100:103], v[36:39], v[208:223]
    v_mfma_f32_32x32x16_bf16 v[208:223], v[104:107], v[40:43], v[208:223]
    v_mfma_f32_32x32x16_bf16 v[208:223], v[108:111], v[44:47], v[208:223]
    v_mfma_f32_32x32x16_bf16 v[208:223], v[112:115], v[48:51], v[208:223]
    v_mfma_f32_32x32x16_bf16 v[208:223], v[116:119], v[52:55], v[208:223]
    v_mfma_f32_32x32x16_bf16 v[208:223], v[120:123], v[56:59], v[208:223]
    v_mfma_f32_32x32x16_bf16 v[208:223], v[124:127], v[60:63], v[208:223]
    v_mfma_f32_32x32x16_bf16 v[208:223], v[128:131], v[64:67], v[208:223]
    s_waitcnt vmcnt(16)
    ds_write_b128 v15, a[32:35] offset:33792
    ds_write_b128 v15, a[36:39] offset:34848
    ds_write_b128 v15, a[40:43] offset:35904
    ds_write_b128 v15, a[44:47] offset:36960
    ds_write_b128 v15, a[48:51] offset:38016
    ds_write_b128 v15, a[52:55] offset:39072
    ds_write_b128 v15, a[56:59] offset:40128
    ds_write_b128 v15, a[60:63] offset:41184
    buffer_store_dwordx4 v[236:239], v234, s[72:75], 0 offen offset:0 sc1
    buffer_store_dwordx4 v[236:239], v234, s[72:75], 0 offen offset:1024 sc1
    s_waitcnt vmcnt(42)
    buffer_store_dwordx4 v[224:227], v232, s[68:71], 0 offen offset:0 sc1
    buffer_store_dwordx4 v[228:231], v232, s[68:71], 0 offen offset:1024 sc1
    buffer_store_dwordx4 v[240:243], v235, s[68:71], 0 offen offset:0 sc1
    v_mov_b32 v248, v240
    v_mov_b32 v249, v242
    v_mov_b32 v250, v241
    v_mov_b32 v251, v243
    buffer_store_dwordx4 v[244:247], v235, s[68:71], 0 offen offset:1024 sc1
    v_mov_b32 v252, v244
    v_mov_b32 v253, v246
    v_mov_b32 v254, v245
    v_mov_b32 v255, v247
    s_nop 1
    v_permlane32_swap_b32 v248, v250
    v_permlane32_swap_b32 v249, v251
    v_permlane32_swap_b32 v252, v254
    v_permlane32_swap_b32 v253, v255
    s_nop 1
    buffer_store_dwordx4 v[248:251], v235, s[68:71], s83 offen offset:0 sc1
    buffer_store_dwordx4 v[252:255], v235, s[68:71], s83 offen offset:1024 sc1
    v_mfma_f32_32x32x16_bf16 v[208:223], v[132:135], v[68:71], v[208:223]
    v_mfma_f32_32x32x16_bf16 v[208:223], v[136:139], v[72:75], v[208:223]
    v_mfma_f32_32x32x16_bf16 v[208:223], v[140:143], v[76:79], v[208:223]
    s_cmp_eq_u32 s17, 0
    s_cbranch_scc0 m0_1
    v_mfma_f32_32x32x16_bf16 v[144:159], v[16:19], v[80:83], 0
    v_mfma_f32_32x32x16_bf16 v[144:159], v[20:23], v[84:87], v[144:159]
    v_mfma_f32_32x32x16_bf16 v[144:159], v[24:27], v[88:91], v[144:159]
    v_mfma_f32_32x32x16_bf16 v[144:159], v[28:31], v[92:95], v[144:159]
    v_mfma_f32_32x32x16_bf16 v[144:159], v[32:35], v[96:99], v[144:159]
    v_mfma_f32_32x32x16_bf16 v[144:159], v[36:39], v[100:103], v[144:159]
    v_mfma_f32_32x32x16_bf16 v[144:159], v[40:43], v[104:107], v[144:159]
    v_mfma_f32_32x32x16_bf16 v[144:159], v[44:47], v[108:111], v[144:159]
    v_mfma_f32_32x32x16_bf16 v[144:159], v[48:51], v[112:115], v[144:159]
    v_mfma_f32_32x32x16_bf16 v[144:159], v[52:55], v[116:119], v[144:159]
    v_mfma_f32_32x32x16_bf16 v[144:159], v[56:59], v[120:123], v[144:159]
    v_mfma_f32_32x32x16_bf16 v[144:159], v[60:63], v[124:127], v[144:159]
    v_mfma_f32_32x32x16_bf16 v[144:159], v[64:67], v[128:131], v[144:159]
    v_mfma_f32_32x32x16_bf16 v[144:159], v[68:71], v[132:135], v[144:159]
    v_mfma_f32_32x32x16_bf16 v[144:159], v[72:75], v[136:139], v[144:159]
    v_mfma_f32_32x32x16_bf16 v[144:159], v[76:79], v[140:143], v[144:159]
m0_1:
    s_waitcnt lgkmcnt(0)
    s_barrier
    ds_read_b128 v[80:83], v7 offset:33792
    ds_read_b128 v[84:87], v7 offset:33824
    ds_read_b128 v[88:91], v7 offset:33856
    ds_read_b128 v[92:95], v7 offset:33888
    ds_read_b128 v[96:99], v7 offset:33920
    ds_read_b128 v[100:103], v7 offset:33952
    ds_read_b128 v[104:107], v7 offset:33984
    ds_read_b128 v[108:111], v7 offset:34016
    ds_read_b128 v[112:115], v7 offset:34048
    ds_read_b128 v[116:119], v7 offset:34080
    ds_read_b128 v[120:123], v7 offset:34112
    ds_read_b128 v[124:127], v7 offset:34144
    ds_read_b128 v[128:131], v7 offset:34176
    ds_read_b128 v[132:135], v7 offset:34208
    ds_read_b128 v[136:139], v7 offset:34240
    ds_read_b128 v[140:143], v7 offset:34272
    s_nop 3
    v_cvt_pk_bf16_f32 v224, v208, v209
    v_cvt_pk_bf16_f32 v225, v210, v211
    v_cvt_pk_bf16_f32 v226, v212, v213
    v_cvt_pk_bf16_f32 v227, v214, v215
    v_cvt_pk_bf16_f32 v228, v216, v217
    v_cvt_pk_bf16_f32 v229, v218, v219
    v_cvt_pk_bf16_f32 v230, v220, v221
    v_cvt_pk_bf16_f32 v231, v222, v223
    v_pk_mul_f32 v[144:145], v[144:145], s[86:87]
    v_pk_mul_f32 v[146:147], v[146:147], s[86:87]
    v_pk_mul_f32 v[148:149], v[148:149], s[86:87]
    v_pk_mul_f32 v[150:151], v[150:151], s[86:87]
    v_pk_mul_f32 v[152:153], v[152:153], s[86:87]
    v_pk_mul_f32 v[154:155], v[154:155], s[86:87]
    v_pk_mul_f32 v[156:157], v[156:157], s[86:87]
    v_pk_mul_f32 v[158:159], v[158:159], s[86:87]
    v_cvt_pk_bf16_f32 v160, v144, v145
    v_cvt_pk_bf16_f32 v161, v146, v147
    v_cvt_pk_bf16_f32 v162, v148, v149
    v_cvt_pk_bf16_f32 v163, v150, v151
    v_cvt_pk_bf16_f32 v164, v152, v153
    v_cvt_pk_bf16_f32 v165, v154, v155
    v_cvt_pk_bf16_f32 v166, v156, v157
    v_cvt_pk_bf16_f32 v167, v158, v159
    s_lshl_b32 s43, s4, 10
    buffer_store_dwordx4 v[224:227], v9, s[32:35], s43 offen offset:0 sc1
    buffer_store_dwordx4 v[228:231], v9, s[32:35], s43 offen offset:512 sc1
    s_cmp_eq_u32 s17, 0
    s_cbranch_scc0 m0_2
    s_mul_i32 s43, s4, 28672
    buffer_store_dwordx4 v[160:163], v1, s[44:47], s43 offen offset:0 sc1
    buffer_store_dwordx4 v[164:167], v1, s[44:47], s43 offen offset:512 sc1
m0_2:
    s_lshl_b32 s42, s8, 18
    s_add_u32 s43, s42, 0
    buffer_load_dwordx4 a[128:131], v6, s[28:31], s43 offen
    s_add_u32 s43, s42, 16384
    buffer_load_dwordx4 a[132:135], v6, s[28:31], s43 offen
    s_add_u32 s43, s42, 32768
    buffer_load_dwordx4 a[136:139], v6, s[28:31], s43 offen
    s_add_u32 s43, s42, 49152
    buffer_load_dwordx4 a[140:143], v6, s[28:31], s43 offen
    s_add_u32 s43, s42, 65536
    buffer_load_dwordx4 a[144:147], v6, s[28:31], s43 offen
    s_add_u32 s43, s42, 81920
    buffer_load_dwordx4 a[148:151], v6, s[28:31], s43 offen
    s_add_u32 s43, s42, 98304
    buffer_load_dwordx4 a[152:155], v6, s[28:31], s43 offen
    s_add_u32 s43, s42, 114688
    buffer_load_dwordx4 a[156:159], v6, s[28:31], s43 offen
    s_waitcnt lgkmcnt(12)
    v_mfma_f32_32x32x16_bf16 v[208:223], v[80:83], v[16:19], 0
    v_mfma_f32_32x32x16_bf16 v[208:223], v[84:87], v[20:23], v[208:223]
    v_mfma_f32_32x32x16_bf16 v[208:223], v[88:91], v[24:27], v[208:223]
    v_mfma_f32_32x32x16_bf16 v[208:223], v[92:95], v[28:31], v[208:223]
    s_waitcnt lgkmcnt(8)
    v_mfma_f32_32x32x16_bf16 v[208:223], v[96:99], v[32:35], v[208:223]
    v_mfma_f32_32x32x16_bf16 v[208:223], v[100:103], v[36:39], v[208:223]
    v_mfma_f32_32x32x16_bf16 v[208:223], v[104:107], v[40:43], v[208:223]
    v_mfma_f32_32x32x16_bf16 v[208:223], v[108:111], v[44:47], v[208:223]
    s_waitcnt lgkmcnt(4)
    v_mfma_f32_32x32x16_bf16 v[208:223], v[112:115], v[48:51], v[208:223]
    v_mfma_f32_32x32x16_bf16 v[208:223], v[116:119], v[52:55], v[208:223]
    v_mfma_f32_32x32x16_bf16 v[208:223], v[120:123], v[56:59], v[208:223]
    v_mfma_f32_32x32x16_bf16 v[208:223], v[124:127], v[60:63], v[208:223]
    s_waitcnt lgkmcnt(0)
    v_mfma_f32_32x32x16_bf16 v[208:223], v[128:131], v[64:67], v[208:223]
    s_lshl_b32 s43, s4, 11
    v_add_u32 v8, s43, v11
    ds_write_b128 v8, v[224:227] offset:0
    ds_write_b128 v8, v[228:231] offset:1024
    s_waitcnt vmcnt(8)
    ds_write_b128 v15, a[64:67] offset:0
    ds_write_b128 v15, a[68:71] offset:1056
    ds_write_b128 v15, a[72:75] offset:2112
    ds_write_b128 v15, a[76:79] offset:3168
    ds_write_b128 v15, a[80:83] offset:4224
    ds_write_b128 v15, a[84:87] offset:5280
    ds_write_b128 v15, a[88:91] offset:6336
    ds_write_b128 v15, a[92:95] offset:7392
    v_mfma_f32_32x32x16_bf16 v[208:223], v[132:135], v[68:71], v[208:223]
    v_mfma_f32_32x32x16_bf16 v[208:223], v[136:139], v[72:75], v[208:223]
    v_mfma_f32_32x32x16_bf16 v[208:223], v[140:143], v[76:79], v[208:223]
    s_cmp_eq_u32 s17, 0
    s_cbranch_scc0 m0_3
    v_mfma_f32_32x32x16_bf16 v[144:159], v[16:19], v[80:83], 0
    v_mfma_f32_32x32x16_bf16 v[144:159], v[20:23], v[84:87], v[144:159]
    v_mfma_f32_32x32x16_bf16 v[144:159], v[24:27], v[88:91], v[144:159]
    v_mfma_f32_32x32x16_bf16 v[144:159], v[28:31], v[92:95], v[144:159]
    v_mfma_f32_32x32x16_bf16 v[144:159], v[32:35], v[96:99], v[144:159]
    v_mfma_f32_32x32x16_bf16 v[144:159], v[36:39], v[100:103], v[144:159]
    v_mfma_f32_32x32x16_bf16 v[144:159], v[40:43], v[104:107], v[144:159]
    v_mfma_f32_32x32x16_bf16 v[144:159], v[44:47], v[108:111], v[144:159]
    v_mfma_f32_32x32x16_bf16 v[144:159], v[48:51], v[112:115], v[144:159]
    v_mfma_f32_32x32x16_bf16 v[144:159], v[52:55], v[116:119], v[144:159]
    v_mfma_f32_32x32x16_bf16 v[144:159], v[56:59], v[120:123], v[144:159]
    v_mfma_f32_32x32x16_bf16 v[144:159], v[60:63], v[124:127], v[144:159]
    v_mfma_f32_32x32x16_bf16 v[144:159], v[64:67], v[128:131], v[144:159]
    v_mfma_f32_32x32x16_bf16 v[144:159], v[68:71], v[132:135], v[144:159]
    v_mfma_f32_32x32x16_bf16 v[144:159], v[72:75], v[136:139], v[144:159]
    v_mfma_f32_32x32x16_bf16 v[144:159], v[76:79], v[140:143], v[144:159]
m0_3:
    s_waitcnt lgkmcnt(0)
    s_barrier
    v_mov_b32 v13, 1
    v_mov_b32 v14, 8
    v_cmp_eq_u32 vcc, 0, v0
    s_and_b64 exec, exec, vcc
    buffer_atomic_add v13, v14, s[60:63], 0 offen sc1
    s_mov_b64 exec, -1
    v_mov_b32 v13, 1
    s_lshl_b32 s23, s100, 2
    s_add_u32 s23, s23, 6422528
    v_mov_b32 v14, s23
    v_cmp_eq_u32 vcc, 0, v0
    s_and_b64 exec, exec, vcc
    buffer_store_dword v13, v14, s[44:47], 0 offen sc1
    s_mov_b64 exec, -1
    ds_read_b128 v[80:83], v7 offset:0
    ds_read_b128 v[84:87], v7 offset:32
    ds_read_b128 v[88:91], v7 offset:64
    ds_read_b128 v[92:95], v7 offset:96
    ds_read_b128 v[96:99], v7 offset:128
    ds_read_b128 v[100:103], v7 offset:160
    ds_read_b128 v[104:107], v7 offset:192
    ds_read_b128 v[108:111], v7 offset:224
    ds_read_b128 v[112:115], v7 offset:256
    ds_read_b128 v[116:119], v7 offset:288
    ds_read_b128 v[120:123], v7 offset:320
    ds_read_b128 v[124:127], v7 offset:352
    ds_read_b128 v[128:131], v7 offset:384
    ds_read_b128 v[132:135], v7 offset:416
    ds_read_b128 v[136:139], v7 offset:448
    ds_read_b128 v[140:143], v7 offset:480
    s_nop 3
    v_cvt_pk_bf16_f32 v232, v208, v209
    v_cvt_pk_bf16_f32 v233, v210, v211
    v_cvt_pk_bf16_f32 v234, v212, v213
    v_cvt_pk_bf16_f32 v235, v214, v215
    v_cvt_pk_bf16_f32 v236, v216, v217
    v_cvt_pk_bf16_f32 v237, v218, v219
    v_cvt_pk_bf16_f32 v238, v220, v221
    v_cvt_pk_bf16_f32 v239, v222, v223
    v_pk_mul_f32 v[144:145], v[144:145], s[86:87]
    v_pk_mul_f32 v[146:147], v[146:147], s[86:87]
    v_pk_mul_f32 v[148:149], v[148:149], s[86:87]
    v_pk_mul_f32 v[150:151], v[150:151], s[86:87]
    v_pk_mul_f32 v[152:153], v[152:153], s[86:87]
    v_pk_mul_f32 v[154:155], v[154:155], s[86:87]
    v_pk_mul_f32 v[156:157], v[156:157], s[86:87]
    v_pk_mul_f32 v[158:159], v[158:159], s[86:87]
    v_cvt_pk_bf16_f32 v168, v144, v145
    v_cvt_pk_bf16_f32 v169, v146, v147
    v_cvt_pk_bf16_f32 v170, v148, v149
    v_cvt_pk_bf16_f32 v171, v150, v151
    v_cvt_pk_bf16_f32 v172, v152, v153
    v_cvt_pk_bf16_f32 v173, v154, v155
    v_cvt_pk_bf16_f32 v174, v156, v157
    v_cvt_pk_bf16_f32 v175, v158, v159
    s_lshl_b32 s43, s5, 10
    buffer_store_dwordx4 v[232:235], v9, s[32:35], s43 offen offset:0 sc1
    buffer_store_dwordx4 v[236:239], v9, s[32:35], s43 offen offset:512 sc1
    s_cmp_eq_u32 s17, 0
    s_cbranch_scc0 m0_4
    s_mul_i32 s43, s5, 28672
    buffer_store_dwordx4 v[168:171], v1, s[44:47], s43 offen offset:0 sc1
    buffer_store_dwordx4 v[172:175], v1, s[44:47], s43 offen offset:512 sc1
m0_4:
    s_lshl_b32 s42, s9, 18
    s_add_u32 s43, s42, 0
    buffer_load_dwordx4 a[160:163], v6, s[28:31], s43 offen
    s_add_u32 s43, s42, 16384
    buffer_load_dwordx4 a[164:167], v6, s[28:31], s43 offen
    s_add_u32 s43, s42, 32768
    buffer_load_dwordx4 a[168:171], v6, s[28:31], s43 offen
    s_add_u32 s43, s42, 49152
    buffer_load_dwordx4 a[172:175], v6, s[28:31], s43 offen
    s_add_u32 s43, s42, 65536
    buffer_load_dwordx4 a[176:179], v6, s[28:31], s43 offen
    s_add_u32 s43, s42, 81920
    buffer_load_dwordx4 a[180:183], v6, s[28:31], s43 offen
    s_add_u32 s43, s42, 98304
    buffer_load_dwordx4 a[184:187], v6, s[28:31], s43 offen
    s_add_u32 s43, s42, 114688
    buffer_load_dwordx4 a[188:191], v6, s[28:31], s43 offen
    s_waitcnt lgkmcnt(12)
    v_mfma_f32_32x32x16_bf16 v[208:223], v[80:83], v[16:19], 0
    v_mfma_f32_32x32x16_bf16 v[208:223], v[84:87], v[20:23], v[208:223]
    v_mfma_f32_32x32x16_bf16 v[208:223], v[88:91], v[24:27], v[208:223]
    v_mfma_f32_32x32x16_bf16 v[208:223], v[92:95], v[28:31], v[208:223]
    s_waitcnt lgkmcnt(8)
    v_mfma_f32_32x32x16_bf16 v[208:223], v[96:99], v[32:35], v[208:223]
    v_mfma_f32_32x32x16_bf16 v[208:223], v[100:103], v[36:39], v[208:223]
    v_mfma_f32_32x32x16_bf16 v[208:223], v[104:107], v[40:43], v[208:223]
    v_mfma_f32_32x32x16_bf16 v[208:223], v[108:111], v[44:47], v[208:223]
    s_waitcnt lgkmcnt(4)
    v_mfma_f32_32x32x16_bf16 v[208:223], v[112:115], v[48:51], v[208:223]
    v_mfma_f32_32x32x16_bf16 v[208:223], v[116:119], v[52:55], v[208:223]
    v_mfma_f32_32x32x16_bf16 v[208:223], v[120:123], v[56:59], v[208:223]
    v_mfma_f32_32x32x16_bf16 v[208:223], v[124:127], v[60:63], v[208:223]
    s_waitcnt lgkmcnt(0)
    v_mfma_f32_32x32x16_bf16 v[208:223], v[128:131], v[64:67], v[208:223]
    s_lshl_b32 s43, s5, 11
    v_add_u32 v8, s43, v11
    ds_write_b128 v8, v[232:235] offset:0
    ds_write_b128 v8, v[236:239] offset:1024
    s_waitcnt vmcnt(8)
    ds_write_b128 v15, a[96:99] offset:33792
    ds_write_b128 v15, a[100:103] offset:34848
    ds_write_b128 v15, a[104:107] offset:35904
    ds_write_b128 v15, a[108:111] offset:36960
    ds_write_b128 v15, a[112:115] offset:38016
    ds_write_b128 v15, a[116:119] offset:39072
    ds_write_b128 v15, a[120:123] offset:40128
    ds_write_b128 v15, a[124:127] offset:41184
    v_mfma_f32_32x32x16_bf16 v[208:223], v[132:135], v[68:71], v[208:223]
    v_mfma_f32_32x32x16_bf16 v[208:223], v[136:139], v[72:75], v[208:223]
    v_mfma_f32_32x32x16_bf16 v[208:223], v[140:143], v[76:79], v[208:223]
    s_cmp_eq_u32 s17, 0
    s_cbranch_scc0 m0_5
    v_mfma_f32_32x32x16_bf16 v[144:159], v[16:19], v[80:83], 0
    v_mfma_f32_32x32x16_bf16 v[144:159], v[20:23], v[84:87], v[144:159]
    v_mfma_f32_32x32x16_bf16 v[144:159], v[24:27], v[88:91], v[144:159]
    v_mfma_f32_32x32x16_bf16 v[144:159], v[28:31], v[92:95], v[144:159]
    v_mfma_f32_32x32x16_bf16 v[144:159], v[32:35], v[96:99], v[144:159]
    v_mfma_f32_32x32x16_bf16 v[144:159], v[36:39], v[100:103], v[144:159]
    v_mfma_f32_32x32x16_bf16 v[144:159], v[40:43], v[104:107], v[144:159]
    v_mfma_f32_32x32x16_bf16 v[144:159], v[44:47], v[108:111], v[144:159]
    v_mfma_f32_32x32x16_bf16 v[144:159], v[48:51], v[112:115], v[144:159]
    v_mfma_f32_32x32x16_bf16 v[144:159], v[52:55], v[116:119], v[144:159]
    v_mfma_f32_32x32x16_bf16 v[144:159], v[56:59], v[120:123], v[144:159]
    v_mfma_f32_32x32x16_bf16 v[144:159], v[60:63], v[124:127], v[144:159]
    v_mfma_f32_32x32x16_bf16 v[144:159], v[64:67], v[128:131], v[144:159]
    v_mfma_f32_32x32x16_bf16 v[144:159], v[68:71], v[132:135], v[144:159]
    v_mfma_f32_32x32x16_bf16 v[144:159], v[72:75], v[136:139], v[144:159]
    v_mfma_f32_32x32x16_bf16 v[144:159], v[76:79], v[140:143], v[144:159]
m0_5:
    s_waitcnt lgkmcnt(0)
    s_barrier
    v_mov_b32 v13, 2
    s_lshl_b32 s23, s100, 2
    s_add_u32 s23, s23, 6422528
    v_mov_b32 v14, s23
    v_cmp_eq_u32 vcc, 0, v0
    s_and_b64 exec, exec, vcc
    buffer_store_dword v13, v14, s[44:47], 0 offen sc1
    s_mov_b64 exec, -1
    ds_read_b128 v[80:83], v7 offset:33792
    ds_read_b128 v[84:87], v7 offset:33824
    ds_read_b128 v[88:91], v7 offset:33856
    ds_read_b128 v[92:95], v7 offset:33888
    ds_read_b128 v[96:99], v7 offset:33920
    ds_read_b128 v[100:103], v7 offset:33952
    ds_read_b128 v[104:107], v7 offset:33984
    ds_read_b128 v[108:111], v7 offset:34016
    ds_read_b128 v[112:115], v7 offset:34048
    ds_read_b128 v[116:119], v7 offset:34080
    ds_read_b128 v[120:123], v7 offset:34112
    ds_read_b128 v[124:127], v7 offset:34144
    ds_read_b128 v[128:131], v7 offset:34176
    ds_read_b128 v[132:135], v7 offset:34208
    ds_read_b128 v[136:139], v7 offset:34240
    ds_read_b128 v[140:143], v7 offset:34272
    s_nop 3
    v_cvt_pk_bf16_f32 v240, v208, v209
    v_cvt_pk_bf16_f32 v241, v210, v211
    v_cvt_pk_bf16_f32 v242, v212, v213
    v_cvt_pk_bf16_f32 v243, v214, v215
    v_cvt_pk_bf16_f32 v244, v216, v217
    v_cvt_pk_bf16_f32 v245, v218, v219
    v_cvt_pk_bf16_f32 v246, v220, v221
    v_cvt_pk_bf16_f32 v247, v222, v223
    v_pk_mul_f32 v[144:145], v[144:145], s[86:87]
    v_pk_mul_f32 v[146:147], v[146:147], s[86:87]
    v_pk_mul_f32 v[148:149], v[148:149], s[86:87]
    v_pk_mul_f32 v[150:151], v[150:151], s[86:87]
    v_pk_mul_f32 v[152:153], v[152:153], s[86:87]
    v_pk_mul_f32 v[154:155], v[154:155], s[86:87]
    v_pk_mul_f32 v[156:157], v[156:157], s[86:87]
    v_pk_mul_f32 v[158:159], v[158:159], s[86:87]
    v_cvt_pk_bf16_f32 v176, v144, v145
    v_cvt_pk_bf16_f32 v177, v146, v147
    v_cvt_pk_bf16_f32 v178, v148, v149
    v_cvt_pk_bf16_f32 v179, v150, v151
    v_cvt_pk_bf16_f32 v180, v152, v153
    v_cvt_pk_bf16_f32 v181, v154, v155
    v_cvt_pk_bf16_f32 v182, v156, v157
    v_cvt_pk_bf16_f32 v183, v158, v159
    s_lshl_b32 s43, s6, 10
    buffer_store_dwordx4 v[240:243], v9, s[32:35], s43 offen offset:0 sc1
    buffer_store_dwordx4 v[244:247], v9, s[32:35], s43 offen offset:512 sc1
    s_cmp_eq_u32 s17, 0
    s_cbranch_scc0 m0_6
    s_mul_i32 s43, s6, 28672
    buffer_store_dwordx4 v[176:179], v1, s[44:47], s43 offen offset:0 sc1
    buffer_store_dwordx4 v[180:183], v1, s[44:47], s43 offen offset:512 sc1
m0_6:
    s_lshl_b32 s42, s10, 18
    s_add_u32 s43, s42, 0
    buffer_load_dwordx4 a[192:195], v6, s[28:31], s43 offen
    s_add_u32 s43, s42, 16384
    buffer_load_dwordx4 a[196:199], v6, s[28:31], s43 offen
    s_add_u32 s43, s42, 32768
    buffer_load_dwordx4 a[200:203], v6, s[28:31], s43 offen
    s_add_u32 s43, s42, 49152
    buffer_load_dwordx4 a[204:207], v6, s[28:31], s43 offen
    s_add_u32 s43, s42, 65536
    buffer_load_dwordx4 a[208:211], v6, s[28:31], s43 offen
    s_add_u32 s43, s42, 81920
    buffer_load_dwordx4 a[212:215], v6, s[28:31], s43 offen
    s_add_u32 s43, s42, 98304
    buffer_load_dwordx4 a[216:219], v6, s[28:31], s43 offen
    s_add_u32 s43, s42, 114688
    buffer_load_dwordx4 a[220:223], v6, s[28:31], s43 offen
    s_waitcnt lgkmcnt(12)
    v_mfma_f32_32x32x16_bf16 v[208:223], v[80:83], v[16:19], 0
    v_mfma_f32_32x32x16_bf16 v[208:223], v[84:87], v[20:23], v[208:223]
    v_mfma_f32_32x32x16_bf16 v[208:223], v[88:91], v[24:27], v[208:223]
    v_mfma_f32_32x32x16_bf16 v[208:223], v[92:95], v[28:31], v[208:223]
    s_waitcnt lgkmcnt(8)
    v_mfma_f32_32x32x16_bf16 v[208:223], v[96:99], v[32:35], v[208:223]
    v_mfma_f32_32x32x16_bf16 v[208:223], v[100:103], v[36:39], v[208:223]
    v_mfma_f32_32x32x16_bf16 v[208:223], v[104:107], v[40:43], v[208:223]
    v_mfma_f32_32x32x16_bf16 v[208:223], v[108:111], v[44:47], v[208:223]
    s_waitcnt lgkmcnt(4)
    v_mfma_f32_32x32x16_bf16 v[208:223], v[112:115], v[48:51], v[208:223]
    v_mfma_f32_32x32x16_bf16 v[208:223], v[116:119], v[52:55], v[208:223]
    v_mfma_f32_32x32x16_bf16 v[208:223], v[120:123], v[56:59], v[208:223]
    v_mfma_f32_32x32x16_bf16 v[208:223], v[124:127], v[60:63], v[208:223]
    s_waitcnt lgkmcnt(0)
    v_mfma_f32_32x32x16_bf16 v[208:223], v[128:131], v[64:67], v[208:223]
    s_lshl_b32 s43, s6, 11
    v_add_u32 v8, s43, v11
    ds_write_b128 v8, v[240:243] offset:0
    ds_write_b128 v8, v[244:247] offset:1024
    s_waitcnt vmcnt(20)
    s_cmp_eq_u32 s17, 0
    s_cbranch_scc1 w1_7
    s_waitcnt vmcnt(18)
w1_7:
    ds_write_b128 v15, a[128:131] offset:0
    ds_write_b128 v15, a[132:135] offset:1056
    ds_write_b128 v15, a[136:139] offset:2112
    ds_write_b128 v15, a[140:143] offset:3168
    ds_write_b128 v15, a[144:147] offset:4224
    ds_write_b128 v15, a[148:151] offset:5280
    ds_write_b128 v15, a[152:155] offset:6336
    ds_write_b128 v15, a[156:159] offset:7392
    v_mfma_f32_32x32x16_bf16 v[208:223], v[132:135], v[68:71], v[208:223]
    v_mfma_f32_32x32x16_bf16 v[208:223], v[136:139], v[72:75], v[208:223]
    v_mfma_f32_32x32x16_bf16 v[208:223], v[140:143], v[76:79], v[208:223]
    s_cmp_eq_u32 s17, 0
    s_cbranch_scc0 m0_8
    v_mfma_f32_32x32x16_bf16 v[144:159], v[16:19], v[80:83], 0
    v_mfma_f32_32x32x16_bf16 v[144:159], v[20:23], v[84:87], v[144:159]
    v_mfma_f32_32x32x16_bf16 v[144:159], v[24:27], v[88:91], v[144:159]
    v_mfma_f32_32x32x16_bf16 v[144:159], v[28:31], v[92:95], v[144:159]
    v_mfma_f32_32x32x16_bf16 v[144:159], v[32:35], v[96:99], v[144:159]
    v_mfma_f32_32x32x16_bf16 v[144:159], v[36:39], v[100:103], v[144:159]
    v_mfma_f32_32x32x16_bf16 v[144:159], v[40:43], v[104:107], v[144:159]
    v_mfma_f32_32x32x16_bf16 v[144:159], v[44:47], v[108:111], v[144:159]
    v_mfma_f32_32x32x16_bf16 v[144:159], v[48:51], v[112:115], v[144:159]
    v_mfma_f32_32x32x16_bf16 v[144:159], v[52:55], v[116:119], v[144:159]
    v_mfma_f32_32x32x16_bf16 v[144:159], v[56:59], v[120:123], v[144:159]
    v_mfma_f32_32x32x16_bf16 v[144:159], v[60:63], v[124:127], v[144:159]
    v_mfma_f32_32x32x16_bf16 v[144:159], v[64:67], v[128:131], v[144:159]
    v_mfma_f32_32x32x16_bf16 v[144:159], v[68:71], v[132:135], v[144:159]
    v_mfma_f32_32x32x16_bf16 v[144:159], v[72:75], v[136:139], v[144:159]
    v_mfma_f32_32x32x16_bf16 v[144:159], v[76:79], v[140:143], v[144:159]
m0_8:
    s_waitcnt lgkmcnt(0)
    s_barrier
    ds_read_b128 v[80:83], v7 offset:0
    ds_read_b128 v[84:87], v7 offset:32
    ds_read_b128 v[88:91], v7 offset:64
    ds_read_b128 v[92:95], v7 offset:96
    ds_read_b128 v[96:99], v7 offset:128
    ds_read_b128 v[100:103], v7 offset:160
    ds_read_b128 v[104:107], v7 offset:192
    ds_read_b128 v[108:111], v7 offset:224
    ds_read_b128 v[112:115], v7 offset:256
    ds_read_b128 v[116:119], v7 offset:288
    ds_read_b128 v[120:123], v7 offset:320
    ds_read_b128 v[124:127], v7 offset:352
    ds_read_b128 v[128:131], v7 offset:384
    ds_read_b128 v[132:135], v7 offset:416
    ds_read_b128 v[136:139], v7 offset:448
    ds_read_b128 v[140:143], v7 offset:480
    s_nop 3
    v_cvt_pk_bf16_f32 v224, v208, v209
    v_cvt_pk_bf16_f32 v225, v210, v211
    v_cvt_pk_bf16_f32 v226, v212, v213
    v_cvt_pk_bf16_f32 v227, v214, v215
    v_cvt_pk_bf16_f32 v228, v216, v217
    v_cvt_pk_bf16_f32 v229, v218, v219
    v_cvt_pk_bf16_f32 v230, v220, v221
    v_cvt_pk_bf16_f32 v231, v222, v223
    v_pk_mul_f32 v[144:145], v[144:145], s[86:87]
    v_pk_mul_f32 v[146:147], v[146:147], s[86:87]
    v_pk_mul_f32 v[148:149], v[148:149], s[86:87]
    v_pk_mul_f32 v[150:151], v[150:151], s[86:87]
    v_pk_mul_f32 v[152:153], v[152:153], s[86:87]
    v_pk_mul_f32 v[154:155], v[154:155], s[86:87]
    v_pk_mul_f32 v[156:157], v[156:157], s[86:87]
    v_pk_mul_f32 v[158:159], v[158:159], s[86:87]
    v_cvt_pk_bf16_f32 v160, v144, v145
    v_cvt_pk_bf16_f32 v161, v146, v147
    v_cvt_pk_bf16_f32 v162, v148, v149
    v_cvt_pk_bf16_f32 v163, v150, v151
    v_cvt_pk_bf16_f32 v164, v152, v153
    v_cvt_pk_bf16_f32 v165, v154, v155
    v_cvt_pk_bf16_f32 v166, v156, v157
    v_cvt_pk_bf16_f32 v167, v158, v159
    s_lshl_b32 s43, s7, 10
    buffer_store_dwordx4 v[224:227], v9, s[32:35], s43 offen offset:0 sc1
    buffer_store_dwordx4 v[228:231], v9, s[32:35], s43 offen offset:512 sc1
    s_cmp_eq_u32 s17, 0
    s_cbranch_scc0 m0_9
    s_mul_i32 s43, s7, 28672
    buffer_store_dwordx4 v[160:163], v1, s[44:47], s43 offen offset:0 sc1
    buffer_store_dwordx4 v[164:167], v1, s[44:47], s43 offen offset:512 sc1
m0_9:
    s_waitcnt lgkmcnt(12)
    v_mfma_f32_32x32x16_bf16 v[208:223], v[80:83], v[16:19], 0
    v_mfma_f32_32x32x16_bf16 v[208:223], v[84:87], v[20:23], v[208:223]
    v_mfma_f32_32x32x16_bf16 v[208:223], v[88:91], v[24:27], v[208:223]
    v_mfma_f32_32x32x16_bf16 v[208:223], v[92:95], v[28:31], v[208:223]
    s_waitcnt lgkmcnt(8)
    v_mfma_f32_32x32x16_bf16 v[208:223], v[96:99], v[32:35], v[208:223]
    v_mfma_f32_32x32x16_bf16 v[208:223], v[100:103], v[36:39], v[208:223]
    v_mfma_f32_32x32x16_bf16 v[208:223], v[104:107], v[40:43], v[208:223]
    v_mfma_f32_32x32x16_bf16 v[208:223], v[108:111], v[44:47], v[208:223]
    s_waitcnt lgkmcnt(4)
    v_mfma_f32_32x32x16_bf16 v[208:223], v[112:115], v[48:51], v[208:223]
    v_mfma_f32_32x32x16_bf16 v[208:223], v[116:119], v[52:55], v[208:223]
    v_mfma_f32_32x32x16_bf16 v[208:223], v[120:123], v[56:59], v[208:223]
    v_mfma_f32_32x32x16_bf16 v[208:223], v[124:127], v[60:63], v[208:223]
    s_waitcnt lgkmcnt(0)
    v_mfma_f32_32x32x16_bf16 v[208:223], v[128:131], v[64:67], v[208:223]
    s_lshl_b32 s43, s7, 11
    v_add_u32 v8, s43, v11
    ds_write_b128 v8, v[224:227] offset:0
    ds_write_b128 v8, v[228:231] offset:1024
    s_waitcnt vmcnt(12)
    s_cmp_eq_u32 s17, 0
    s_cbranch_scc1 w1_10
    s_waitcnt vmcnt(10)
w1_10:
    ds_write_b128 v15, a[160:163] offset:33792
    ds_write_b128 v15, a[164:167] offset:34848
    ds_write_b128 v15, a[168:171] offset:35904
    ds_write_b128 v15, a[172:175] offset:36960
    ds_write_b128 v15, a[176:179] offset:38016
    ds_write_b128 v15, a[180:183] offset:39072
    ds_write_b128 v15, a[184:187] offset:40128
    ds_write_b128 v15, a[188:191] offset:41184
    v_mfma_f32_32x32x16_bf16 v[208:223], v[132:135], v[68:71], v[208:223]
    v_mfma_f32_32x32x16_bf16 v[208:223], v[136:139], v[72:75], v[208:223]
    v_mfma_f32_32x32x16_bf16 v[208:223], v[140:143], v[76:79], v[208:223]
    s_cmp_eq_u32 s17, 0
    s_cbranch_scc0 m0_11
    v_mfma_f32_32x32x16_bf16 v[144:159], v[16:19], v[80:83], 0
    v_mfma_f32_32x32x16_bf16 v[144:159], v[20:23], v[84:87], v[144:159]
    v_mfma_f32_32x32x16_bf16 v[144:159], v[24:27], v[88:91], v[144:159]
    v_mfma_f32_32x32x16_bf16 v[144:159], v[28:31], v[92:95], v[144:159]
    v_mfma_f32_32x32x16_bf16 v[144:159], v[32:35], v[96:99], v[144:159]
    v_mfma_f32_32x32x16_bf16 v[144:159], v[36:39], v[100:103], v[144:159]
    v_mfma_f32_32x32x16_bf16 v[144:159], v[40:43], v[104:107], v[144:159]
    v_mfma_f32_32x32x16_bf16 v[144:159], v[44:47], v[108:111], v[144:159]
    v_mfma_f32_32x32x16_bf16 v[144:159], v[48:51], v[112:115], v[144:159]
    v_mfma_f32_32x32x16_bf16 v[144:159], v[52:55], v[116:119], v[144:159]
    v_mfma_f32_32x32x16_bf16 v[144:159], v[56:59], v[120:123], v[144:159]
    v_mfma_f32_32x32x16_bf16 v[144:159], v[60:63], v[124:127], v[144:159]
    v_mfma_f32_32x32x16_bf16 v[144:159], v[64:67], v[128:131], v[144:159]
    v_mfma_f32_32x32x16_bf16 v[144:159], v[68:71], v[132:135], v[144:159]
    v_mfma_f32_32x32x16_bf16 v[144:159], v[72:75], v[136:139], v[144:159]
    v_mfma_f32_32x32x16_bf16 v[144:159], v[76:79], v[140:143], v[144:159]
m0_11:
    s_waitcnt lgkmcnt(0)
    s_barrier
    v_mov_b32 v13, 3
    s_lshl_b32 s23, s100, 2
    s_add_u32 s23, s23, 6422528
    v_mov_b32 v14, s23
    v_cmp_eq_u32 vcc, 0, v0
    s_and_b64 exec, exec, vcc
    buffer_store_dword v13, v14, s[44:47], 0 offen sc1
    s_mov_b64 exec, -1
    ds_read_b128 v[80:83], v7 offset:33792
    ds_read_b128 v[84:87], v7 offset:33824
    ds_read_b128 v[88:91], v7 offset:33856
    ds_read_b128 v[92:95], v7 offset:33888
    ds_read_b128 v[96:99], v7 offset:33920
    ds_read_b128 v[100:103], v7 offset:33952
    ds_read_b128 v[104:107], v7 offset:33984
    ds_read_b128 v[108:111], v7 offset:34016
    ds_read_b128 v[112:115], v7 offset:34048
    ds_read_b128 v[116:119], v7 offset:34080
    ds_read_b128 v[120:123], v7 offset:34112
    ds_read_b128 v[124:127], v7 offset:34144
    ds_read_b128 v[128:131], v7 offset:34176
    ds_read_b128 v[132:135], v7 offset:34208
    ds_read_b128 v[136:139], v7 offset:34240
    ds_read_b128 v[140:143], v7 offset:34272
    s_nop 3
    v_cvt_pk_bf16_f32 v232, v208, v209
    v_cvt_pk_bf16_f32 v233, v210, v211
    v_cvt_pk_bf16_f32 v234, v212, v213
    v_cvt_pk_bf16_f32 v235, v214, v215
    v_cvt_pk_bf16_f32 v236, v216, v217
    v_cvt_pk_bf16_f32 v237, v218, v219
    v_cvt_pk_bf16_f32 v238, v220, v221
    v_cvt_pk_bf16_f32 v239, v222, v223
    v_pk_mul_f32 v[144:145], v[144:145], s[86:87]
    v_pk_mul_f32 v[146:147], v[146:147], s[86:87]
    v_pk_mul_f32 v[148:149], v[148:149], s[86:87]
    v_pk_mul_f32 v[150:151], v[150:151], s[86:87]
    v_pk_mul_f32 v[152:153], v[152:153], s[86:87]
    v_pk_mul_f32 v[154:155], v[154:155], s[86:87]
    v_pk_mul_f32 v[156:157], v[156:157], s[86:87]
    v_pk_mul_f32 v[158:159], v[158:159], s[86:87]
    v_cvt_pk_bf16_f32 v168, v144, v145
    v_cvt_pk_bf16_f32 v169, v146, v147
    v_cvt_pk_bf16_f32 v170, v148, v149
    v_cvt_pk_bf16_f32 v171, v150, v151
    v_cvt_pk_bf16_f32 v172, v152, v153
    v_cvt_pk_bf16_f32 v173, v154, v155
    v_cvt_pk_bf16_f32 v174, v156, v157
    v_cvt_pk_bf16_f32 v175, v158, v159
    s_lshl_b32 s43, s8, 10
    buffer_store_dwordx4 v[232:235], v9, s[32:35], s43 offen offset:0 sc1
    buffer_store_dwordx4 v[236:239], v9, s[32:35], s43 offen offset:512 sc1
    s_cmp_eq_u32 s17, 0
    s_cbranch_scc0 m0_12
    s_mul_i32 s43, s8, 28672
    buffer_store_dwordx4 v[168:171], v1, s[44:47], s43 offen offset:0 sc1
    buffer_store_dwordx4 v[172:175], v1, s[44:47], s43 offen offset:512 sc1
m0_12:
    s_waitcnt lgkmcnt(12)
    v_mfma_f32_32x32x16_bf16 v[208:223], v[80:83], v[16:19], 0
    v_mfma_f32_32x32x16_bf16 v[208:223], v[84:87], v[20:23], v[208:223]
    v_mfma_f32_32x32x16_bf16 v[208:223], v[88:91], v[24:27], v[208:223]
    v_mfma_f32_32x32x16_bf16 v[208:223], v[92:95], v[28:31], v[208:223]
    s_waitcnt lgkmcnt(8)
    v_mfma_f32_32x32x16_bf16 v[208:223], v[96:99], v[32:35], v[208:223]
    v_mfma_f32_32x32x16_bf16 v[208:223], v[100:103], v[36:39], v[208:223]
    v_mfma_f32_32x32x16_bf16 v[208:223], v[104:107], v[40:43], v[208:223]
    v_mfma_f32_32x32x16_bf16 v[208:223], v[108:111], v[44:47], v[208:223]
    s_waitcnt lgkmcnt(4)
    v_mfma_f32_32x32x16_bf16 v[208:223], v[112:115], v[48:51], v[208:223]
    v_mfma_f32_32x32x16_bf16 v[208:223], v[116:119], v[52:55], v[208:223]
    v_mfma_f32_32x32x16_bf16 v[208:223], v[120:123], v[56:59], v[208:223]
    v_mfma_f32_32x32x16_bf16 v[208:223], v[124:127], v[60:63], v[208:223]
    s_waitcnt lgkmcnt(0)
    v_mfma_f32_32x32x16_bf16 v[208:223], v[128:131], v[64:67], v[208:223]
    s_lshl_b32 s43, s8, 11
    v_add_u32 v8, s43, v11
    ds_write_b128 v8, v[232:235] offset:0
    ds_write_b128 v8, v[236:239] offset:1024
    s_waitcnt vmcnt(4)
    s_cmp_eq_u32 s17, 0
    s_cbranch_scc1 w1_13
    s_waitcnt vmcnt(2)
w1_13:
    ds_write_b128 v15, a[192:195] offset:0
    ds_write_b128 v15, a[196:199] offset:1056
    ds_write_b128 v15, a[200:203] offset:2112
    ds_write_b128 v15, a[204:207] offset:3168
    ds_write_b128 v15, a[208:211] offset:4224
    ds_write_b128 v15, a[212:215] offset:5280
    ds_write_b128 v15, a[216:219] offset:6336
    ds_write_b128 v15, a[220:223] offset:7392
    v_mfma_f32_32x32x16_bf16 v[208:223], v[132:135], v[68:71], v[208:223]
    v_mfma_f32_32x32x16_bf16 v[208:223], v[136:139], v[72:75], v[208:223]
    v_mfma_f32_32x32x16_bf16 v[208:223], v[140:143], v[76:79], v[208:223]
    s_cmp_eq_u32 s17, 0
    s_cbranch_scc0 m0_14
    v_mfma_f32_32x32x16_bf16 v[144:159], v[16:19], v[80:83], 0
    v_mfma_f32_32x32x16_bf16 v[144:159], v[20:23], v[84:87], v[144:159]
    v_mfma_f32_32x32x16_bf16 v[144:159], v[24:27], v[88:91], v[144:159]
    v_mfma_f32_32x32x16_bf16 v[144:159], v[28:31], v[92:95], v[144:159]
    v_mfma_f32_32x32x16_bf16 v[144:159], v[32:35], v[96:99], v[144:159]
    v_mfma_f32_32x32x16_bf16 v[144:159], v[36:39], v[100:103], v[144:159]
    v_mfma_f32_32x32x16_bf16 v[144:159], v[40:43], v[104:107], v[144:159]
    v_mfma_f32_32x32x16_bf16 v[144:159], v[44:47], v[108:111], v[144:159]
    v_mfma_f32_32x32x16_bf16 v[144:159], v[48:51], v[112:115], v[144:159]
    v_mfma_f32_32x32x16_bf16 v[144:159], v[52:55], v[116:119], v[144:159]
    v_mfma_f32_32x32x16_bf16 v[144:159], v[56:59], v[120:123], v[144:159]
    v_mfma_f32_32x32x16_bf16 v[144:159], v[60:63], v[124:127], v[144:159]
    v_mfma_f32_32x32x16_bf16 v[144:159], v[64:67], v[128:131], v[144:159]
    v_mfma_f32_32x32x16_bf16 v[144:159], v[68:71], v[132:135], v[144:159]
    v_mfma_f32_32x32x16_bf16 v[144:159], v[72:75], v[136:139], v[144:159]
    v_mfma_f32_32x32x16_bf16 v[144:159], v[76:79], v[140:143], v[144:159]
m0_14:
    s_waitcnt lgkmcnt(0)
    s_barrier
    v_mov_b32 v13, 4
    s_lshl_b32 s23, s100, 2
    s_add_u32 s23, s23, 6422528
    v_mov_b32 v14, s23
    v_cmp_eq_u32 vcc, 0, v0
    s_and_b64 exec, exec, vcc
    buffer_store_dword v13, v14, s[44:47], 0 offen sc1
    s_mov_b64 exec, -1
    ds_read_b128 v[80:83], v7 offset:0
    ds_read_b128 v[84:87], v7 offset:32
    ds_read_b128 v[88:91], v7 offset:64
    ds_read_b128 v[92:95], v7 offset:96
    ds_read_b128 v[96:99], v7 offset:128
    ds_read_b128 v[100:103], v7 offset:160
    ds_read_b128 v[104:107], v7 offset:192
    ds_read_b128 v[108:111], v7 offset:224
    ds_read_b128 v[112:115], v7 offset:256
    ds_read_b128 v[116:119], v7 offset:288
    ds_read_b128 v[120:123], v7 offset:320
    ds_read_b128 v[124:127], v7 offset:352
    ds_read_b128 v[128:131], v7 offset:384
    ds_read_b128 v[132:135], v7 offset:416
    ds_read_b128 v[136:139], v7 offset:448
    ds_read_b128 v[140:143], v7 offset:480
    s_nop 3
    v_cvt_pk_bf16_f32 v240, v208, v209
    v_cvt_pk_bf16_f32 v241, v210, v211
    v_cvt_pk_bf16_f32 v242, v212, v213
    v_cvt_pk_bf16_f32 v243, v214, v215
    v_cvt_pk_bf16_f32 v244, v216, v217
    v_cvt_pk_bf16_f32 v245, v218, v219
    v_cvt_pk_bf16_f32 v246, v220, v221
    v_cvt_pk_bf16_f32 v247, v222, v223
    v_pk_mul_f32 v[144:145], v[144:145], s[86:87]
    v_pk_mul_f32 v[146:147], v[146:147], s[86:87]
    v_pk_mul_f32 v[148:149], v[148:149], s[86:87]
    v_pk_mul_f32 v[150:151], v[150:151], s[86:87]
    v_pk_mul_f32 v[152:153], v[152:153], s[86:87]
    v_pk_mul_f32 v[154:155], v[154:155], s[86:87]
    v_pk_mul_f32 v[156:157], v[156:157], s[86:87]
    v_pk_mul_f32 v[158:159], v[158:159], s[86:87]
    v_cvt_pk_bf16_f32 v176, v144, v145
    v_cvt_pk_bf16_f32 v177, v146, v147
    v_cvt_pk_bf16_f32 v178, v148, v149
    v_cvt_pk_bf16_f32 v179, v150, v151
    v_cvt_pk_bf16_f32 v180, v152, v153
    v_cvt_pk_bf16_f32 v181, v154, v155
    v_cvt_pk_bf16_f32 v182, v156, v157
    v_cvt_pk_bf16_f32 v183, v158, v159
    s_lshl_b32 s43, s9, 10
    buffer_store_dwordx4 v[240:243], v9, s[32:35], s43 offen offset:0 sc1
    buffer_store_dwordx4 v[244:247], v9, s[32:35], s43 offen offset:512 sc1
    s_cmp_eq_u32 s17, 0
    s_cbranch_scc0 m0_15
    s_mul_i32 s43, s9, 28672
    buffer_store_dwordx4 v[176:179], v1, s[44:47], s43 offen offset:0 sc1
    buffer_store_dwordx4 v[180:183], v1, s[44:47], s43 offen offset:512 sc1
m0_15:
    s_waitcnt lgkmcnt(12)
    v_mfma_f32_32x32x16_bf16 v[208:223], v[80:83], v[16:19], 0
    v_mfma_f32_32x32x16_bf16 v[208:223], v[84:87], v[20:23], v[208:223]
    v_mfma_f32_32x32x16_bf16 v[208:223], v[88:91], v[24:27], v[208:223]
    v_mfma_f32_32x32x16_bf16 v[208:223], v[92:95], v[28:31], v[208:223]
    s_waitcnt lgkmcnt(8)
    v_mfma_f32_32x32x16_bf16 v[208:223], v[96:99], v[32:35], v[208:223]
    v_mfma_f32_32x32x16_bf16 v[208:223], v[100:103], v[36:39], v[208:223]
    v_mfma_f32_32x32x16_bf16 v[208:223], v[104:107], v[40:43], v[208:223]
    v_mfma_f32_32x32x16_bf16 v[208:223], v[108:111], v[44:47], v[208:223]
    s_waitcnt lgkmcnt(4)
    v_mfma_f32_32x32x16_bf16 v[208:223], v[112:115], v[48:51], v[208:223]
    v_mfma_f32_32x32x16_bf16 v[208:223], v[116:119], v[52:55], v[208:223]
    v_mfma_f32_32x32x16_bf16 v[208:223], v[120:123], v[56:59], v[208:223]
    v_mfma_f32_32x32x16_bf16 v[208:223], v[124:127], v[60:63], v[208:223]
    s_waitcnt lgkmcnt(0)
    v_mfma_f32_32x32x16_bf16 v[208:223], v[128:131], v[64:67], v[208:223]
    s_lshl_b32 s43, s9, 11
    v_add_u32 v8, s43, v11
    ds_write_b128 v8, v[240:243] offset:0
    ds_write_b128 v8, v[244:247] offset:1024
    s_waitcnt vmcnt(4)
    s_cmp_eq_u32 s17, 0
    s_cbranch_scc1 w1_16
    s_waitcnt vmcnt(2)
w1_16:
    s_barrier
    v_mov_b32 v13, 5
    s_lshl_b32 s23, s100, 2
    s_add_u32 s23, s23, 6422528
    v_mov_b32 v14, s23
    v_cmp_eq_u32 vcc, 0, v0
    s_and_b64 exec, exec, vcc
    buffer_store_dword v13, v14, s[44:47], 0 offen sc1
    s_mov_b64 exec, -1
    v_mfma_f32_32x32x16_bf16 v[208:223], v[132:135], v[68:71], v[208:223]
    v_mfma_f32_32x32x16_bf16 v[208:223], v[136:139], v[72:75], v[208:223]
    v_mfma_f32_32x32x16_bf16 v[208:223], v[140:143], v[76:79], v[208:223]
    s_cmp_eq_u32 s17, 0
    s_cbranch_scc0 m0_17
    v_mfma_f32_32x32x16_bf16 v[144:159], v[16:19], v[80:83], 0
    v_mfma_f32_32x32x16_bf16 v[144:159], v[20:23], v[84:87], v[144:159]
    v_mfma_f32_32x32x16_bf16 v[144:159], v[24:27], v[88:91], v[144:159]
    v_mfma_f32_32x32x16_bf16 v[144:159], v[28:31], v[92:95], v[144:159]
    v_mfma_f32_32x32x16_bf16 v[144:159], v[32:35], v[96:99], v[144:159]
    v_mfma_f32_32x32x16_bf16 v[144:159], v[36:39], v[100:103], v[144:159]
    v_mfma_f32_32x32x16_bf16 v[144:159], v[40:43], v[104:107], v[144:159]
    v_mfma_f32_32x32x16_bf16 v[144:159], v[44:47], v[108:111], v[144:159]
    v_mfma_f32_32x32x16_bf16 v[144:159], v[48:51], v[112:115], v[144:159]
    v_mfma_f32_32x32x16_bf16 v[144:159], v[52:55], v[116:119], v[144:159]
    v_mfma_f32_32x32x16_bf16 v[144:159], v[56:59], v[120:123], v[144:159]
    v_mfma_f32_32x32x16_bf16 v[144:159], v[60:63], v[124:127], v[144:159]
    v_mfma_f32_32x32x16_bf16 v[144:159], v[64:67], v[128:131], v[144:159]
    v_mfma_f32_32x32x16_bf16 v[144:159], v[68:71], v[132:135], v[144:159]
    v_mfma_f32_32x32x16_bf16 v[144:159], v[72:75], v[136:139], v[144:159]
    v_mfma_f32_32x32x16_bf16 v[144:159], v[76:79], v[140:143], v[144:159]
m0_17:
    s_nop 15
    s_nop 1
    v_cvt_pk_bf16_f32 v224, v208, v209
    v_cvt_pk_bf16_f32 v225, v210, v211
    v_cvt_pk_bf16_f32 v226, v212, v213
    v_cvt_pk_bf16_f32 v227, v214, v215
    v_cvt_pk_bf16_f32 v228, v216, v217
    v_cvt_pk_bf16_f32 v229, v218, v219
    v_cvt_pk_bf16_f32 v230, v220, v221
    v_cvt_pk_bf16_f32 v231, v222, v223
    v_pk_mul_f32 v[144:145], v[144:145], s[86:87]
    v_pk_mul_f32 v[146:147], v[146:147], s[86:87]
    v_pk_mul_f32 v[148:149], v[148:149], s[86:87]
    v_pk_mul_f32 v[150:151], v[150:151], s[86:87]
    v_pk_mul_f32 v[152:153], v[152:153], s[86:87]
    v_pk_mul_f32 v[154:155], v[154:155], s[86:87]
    v_pk_mul_f32 v[156:157], v[156:157], s[86:87]
    v_pk_mul_f32 v[158:159], v[158:159], s[86:87]
    v_cvt_pk_bf16_f32 v160, v144, v145
    v_cvt_pk_bf16_f32 v161, v146, v147
    v_cvt_pk_bf16_f32 v162, v148, v149
    v_cvt_pk_bf16_f32 v163, v150, v151
    v_cvt_pk_bf16_f32 v164, v152, v153
    v_cvt_pk_bf16_f32 v165, v154, v155
    v_cvt_pk_bf16_f32 v166, v156, v157
    v_cvt_pk_bf16_f32 v167, v158, v159
    s_lshl_b32 s43, s10, 11
    v_add_u32 v8, s43, v11
    ds_write_b128 v8, v[224:227] offset:0
    ds_write_b128 v8, v[228:231] offset:1024
    s_lshl_b32 s43, s10, 10
    buffer_store_dwordx4 v[224:227], v9, s[32:35], s43 offen offset:0 sc1
    buffer_store_dwordx4 v[228:231], v9, s[32:35], s43 offen offset:512 sc1
    s_cmp_eq_u32 s17, 0
    s_cbranch_scc0 m0_18
    s_mul_i32 s43, s10, 28672
    buffer_store_dwordx4 v[160:163], v1, s[44:47], s43 offen offset:0 sc1
    buffer_store_dwordx4 v[164:167], v1, s[44:47], s43 offen offset:512 sc1
m0_18:
    s_waitcnt vmcnt(4)
    s_cmp_eq_u32 s17, 0
    s_cbranch_scc1 w1_19
    s_waitcnt vmcnt(2)
w1_19:
    s_barrier
    v_mov_b32 v13, 6
    s_lshl_b32 s23, s100, 2
    s_add_u32 s23, s23, 6422528
    v_mov_b32 v14, s23
    v_cmp_eq_u32 vcc, 0, v0
    s_and_b64 exec, exec, vcc
    buffer_store_dword v13, v14, s[44:47], 0 offen sc1
    s_mov_b64 exec, -1
    s_waitcnt lgkmcnt(0)
    s_cmp_eq_u32 s93, 1
    s_cbranch_scc1 is_20
    s_mov_b32 s93, 1
    v_readfirstlane_b32 s22, v0
    s_nop 3
    s_cmp_lt_u32 s22, 64
    s_cbranch_scc0 is_20
    s_load_dwordx2 s[22:23], s[0:1], 96
    s_waitcnt lgkmcnt(0)
    s_mov_b32 s84, s22
    s_mov_b32 s85, s23
    s_mov_b32 s86, 0x100
    s_mov_b32 s87, 0x00020000
    v_mov_b32 v14, 8
    s_mov_b32 s22, 0
wc_21:
    buffer_load_dword v13, v14, s[84:87], 0 offen sc1
    s_add_u32 s22, s22, 1
    s_cmp_gt_u32 s22, 3000000
    s_cbranch_scc1 wk_done
    s_waitcnt vmcnt(0)
    v_readfirstlane_b32 s23, v13
    s_nop 3
    s_cmp_ge_u32 s23, 256
    s_cbranch_scc1 wc_21_ok
    s_sleep 8
    s_branch wc_21
wc_21_ok:
is_20:
    s_waitcnt vmcnt(0)
    s_barrier
    v_mov_b32 v13, 8
    s_lshl_b32 s23, s100, 2
    s_add_u32 s23, s23, 6422528
    v_mov_b32 v14, s23
    v_cmp_eq_u32 vcc, 0, v0
    s_and_b64 exec, exec, vcc
    buffer_store_dword v13, v14, s[44:47], 0 offen sc1
    s_mov_b64 exec, -1
    s_barrier
    v_mov_b32 v13, 0
    s_lshl_b32 s22, s100, 2
    v_cmp_eq_u32 vcc, 0, v0
    s_and_b64 exec, exec, vcc
    buffer_store_dword v13, v13, s[96:99], s22 offen offset:0 sc1
    s_mov_b64 exec, -1
    ds_read_b128 a[0:3], v12 offset:0
    ds_read_b128 a[4:7], v12 offset:1024
    ds_read_b128 a[8:11], v12 offset:2048
    ds_read_b128 a[12:15], v12 offset:3072
    ds_read_b128 a[16:19], v12 offset:4096
    ds_read_b128 a[20:23], v12 offset:5120
    ds_read_b128 a[24:27], v12 offset:6144
    ds_read_b128 a[28:31], v12 offset:7168
    ds_read_b128 a[32:35], v12 offset:8192
    ds_read_b128 a[36:39], v12 offset:9216
    ds_read_b128 a[40:43], v12 offset:10240
    ds_read_b128 a[44:47], v12 offset:11264
    ds_read_b128 a[48:51], v12 offset:12288
    ds_read_b128 a[52:55], v12 offset:13312
    ds_read_b128 a[56:59], v12 offset:14336
    ds_read_b128 a[60:63], v12 offset:15360
    ds_read_b128 a[64:67], v12 offset:16384
    ds_read_b128 a[68:71], v12 offset:17408
    ds_read_b128 a[72:75], v12 offset:18432
    ds_read_b128 a[76:79], v12 offset:19456
    ds_read_b128 a[80:83], v12 offset:20480
    ds_read_b128 a[84:87], v12 offset:21504
    ds_read_b128 a[88:91], v12 offset:22528
    ds_read_b128 a[92:95], v12 offset:23552
    ds_read_b128 a[96:99], v12 offset:24576
    ds_read_b128 a[100:103], v12 offset:25600
    ds_read_b128 a[104:107], v12 offset:26624
    ds_read_b128 a[108:111], v12 offset:27648
    ds_read_b128 a[112:115], v12 offset:28672
    ds_read_b128 a[116:119], v12 offset:29696
    ds_read_b128 a[120:123], v12 offset:30720
    ds_read_b128 a[124:127], v12 offset:31744
    ds_read_b128 a[128:131], v12 offset:32768
    ds_read_b128 a[132:135], v12 offset:33792
    ds_read_b128 a[136:139], v12 offset:34816
    ds_read_b128 a[140:143], v12 offset:35840
    ds_read_b128 a[144:147], v12 offset:36864
    ds_read_b128 a[148:151], v12 offset:37888
    ds_read_b128 a[152:155], v12 offset:38912
    ds_read_b128 a[156:159], v12 offset:39936
    ds_read_b128 a[160:163], v12 offset:40960
    ds_read_b128 a[164:167], v12 offset:41984
    ds_read_b128 a[168:171], v12 offset:43008
    ds_read_b128 a[172:175], v12 offset:44032
    ds_read_b128 a[176:179], v12 offset:45056
    ds_read_b128 a[180:183], v12 offset:46080
    ds_read_b128 a[184:187], v12 offset:47104
    ds_read_b128 a[188:191], v12 offset:48128
    ds_read_b128 a[192:195], v12 offset:49152
    ds_read_b128 a[196:199], v12 offset:50176
    ds_read_b128 a[200:203], v12 offset:51200
    ds_read_b128 a[204:207], v12 offset:52224
    ds_read_b128 a[208:211], v12 offset:53248
    ds_read_b128 a[212:215], v12 offset:54272
    ds_read_b128 a[216:219], v12 offset:55296
    ds_read_b128 a[220:223], v12 offset:56320
    s_cmp_eq_u32 s17, 0
    s_cselect_b64 vcc, -1, 0
    v_cndmask_b32 v14, v10, v3, vcc
    s_mul_i32 s22, s19, 28672
    v_lshl_add_u32 v5, v4, 5, v14
    v_lshlrev_b32 v5, 4, v5
    v_add_u32 v5, s22, v5
    s_mov_b32 s36, 0
    s_mov_b32 s37, 0
    s_mov_b32 s38, 0
    s_add_u32 s39, s36, 0
    buffer_load_dwordx4 v[16:19], v5, s[48:51], s39 offen offset:0
    buffer_load_dwordx4 v[20:23], v5, s[48:51], s39 offen offset:1024
    buffer_load_dwordx4 v[24:27], v5, s[48:51], s39 offen offset:2048
    buffer_load_dwordx4 v[28:31], v5, s[48:51], s39 offen offset:3072
    s_add_u32 s39, s36, 4096
    buffer_load_dwordx4 v[32:35], v5, s[48:51], s39 offen offset:0
    buffer_load_dwordx4 v[36:39], v5, s[48:51], s39 offen offset:1024
    buffer_load_dwordx4 v[40:43], v5, s[48:51], s39 offen offset:2048
    buffer_load_dwordx4 v[44:47], v5, s[48:51], s39 offen offset:3072
    s_add_u32 s39, s36, 8192
    buffer_load_dwordx4 v[48:51], v5, s[48:51], s39 offen offset:0
    buffer_load_dwordx4 v[52:55], v5, s[48:51], s39 offen offset:1024
    buffer_load_dwordx4 v[56:59], v5, s[48:51], s39 offen offset:2048
    buffer_load_dwordx4 v[60:63], v5, s[48:51], s39 offen offset:3072
    s_add_u32 s39, s36, 12288
    buffer_load_dwordx4 v[64:67], v5, s[48:51], s39 offen offset:0
    buffer_load_dwordx4 v[68:71], v5, s[48:51], s39 offen offset:1024
    s_add_u32 s39, s36, 12288
    buffer_load_dwordx4 v[72:75], v5, s[48:51], s39 offen offset:2048
    buffer_load_dwordx4 v[76:79], v5, s[48:51], s39 offen offset:3072
    s_add_u32 s39, s36, 16384
    buffer_load_dwordx4 v[80:83], v5, s[48:51], s39 offen offset:0
    buffer_load_dwordx4 v[84:87], v5, s[48:51], s39 offen offset:1024
    buffer_load_dwordx4 v[88:91], v5, s[48:51], s39 offen offset:2048
    buffer_load_dwordx4 v[92:95], v5, s[48:51], s39 offen offset:3072
    s_add_u32 s39, s36, 20480
    buffer_load_dwordx4 v[96:99], v5, s[48:51], s39 offen offset:0
    buffer_load_dwordx4 v[100:103], v5, s[48:51], s39 offen offset:1024
    buffer_load_dwordx4 v[104:107], v5, s[48:51], s39 offen offset:2048
    buffer_load_dwordx4 v[108:111], v5, s[48:51], s39 offen offset:3072
    s_add_u32 s39, s36, 24576
    buffer_load_dwordx4 v[112:115], v5, s[48:51], s39 offen offset:0
    buffer_load_dwordx4 v[116:119], v5, s[48:51], s39 offen offset:1024
    buffer_load_dwordx4 v[120:123], v5, s[48:51], s39 offen offset:2048
    buffer_load_dwordx4 v[124:127], v5, s[48:51], s39 offen offset:3072
    s_add_u32 s36, s36, 114688
    s_waitcnt lgkmcnt(0)
    s_cmp_eq_u32 s17, 0
    s_cbranch_scc0 gx_m1
    s_lshl_b32 s22, s19, 4
    s_add_u32 s22, s22, s18
    s_mul_i32 s22, s22, 28672
    s_lshl_b32 s23, s16, 11
    s_add_u32 s22, s22, s23
    v_lshrrev_b32 v6, 4, v3
    v_mul_u32_u24 v6, 14336, v6
    v_add_u32 v6, s22, v6
    v_lshl_add_u32 v6, v4, 10, v6
    v_and_b32 v7, 15, v3
    v_lshl_add_u32 v6, v7, 4, v6
    s_add_u32 s39, s36, 0
    buffer_load_dwordx4 v[128:131], v5, s[48:51], s39 offen offset:0
    buffer_load_dwordx4 v[132:135], v5, s[48:51], s39 offen offset:1024
    buffer_load_dwordx4 v[136:139], v5, s[48:51], s39 offen offset:2048
    buffer_load_dwordx4 v[140:143], v5, s[48:51], s39 offen offset:3072
    s_add_u32 s39, s36, 4096
    buffer_load_dwordx4 v[144:147], v5, s[48:51], s39 offen offset:0
    buffer_load_dwordx4 v[148:151], v5, s[48:51], s39 offen offset:1024
    buffer_load_dwordx4 v[152:155], v5, s[48:51], s39 offen offset:2048
    buffer_load_dwordx4 v[156:159], v5, s[48:51], s39 offen offset:3072
    s_add_u32 s39, s36, 8192
    buffer_load_dwordx4 v[160:163], v5, s[48:51], s39 offen offset:0
    buffer_load_dwordx4 v[164:167], v5, s[48:51], s39 offen offset:1024
    buffer_load_dwordx4 v[168:171], v5, s[48:51], s39 offen offset:2048
    buffer_load_dwordx4 v[172:175], v5, s[48:51], s39 offen offset:3072
    s_add_u32 s39, s36, 12288
    buffer_load_dwordx4 v[176:179], v5, s[48:51], s39 offen offset:0
    buffer_load_dwordx4 v[180:183], v5, s[48:51], s39 offen offset:1024
    s_waitcnt vmcnt(28)
    v_mfma_f32_32x32x16_bf16 v[184:199], a[0:3], v[16:19], 0
    v_mfma_f32_32x32x16_bf16 v[200:215], a[112:115], v[16:19], 0
    v_mfma_f32_32x32x16_bf16 v[184:199], a[4:7], v[20:23], v[184:199]
    v_mfma_f32_32x32x16_bf16 v[200:215], a[116:119], v[20:23], v[200:215]
    v_mfma_f32_32x32x16_bf16 v[184:199], a[8:11], v[24:27], v[184:199]
    v_mfma_f32_32x32x16_bf16 v[200:215], a[120:123], v[24:27], v[200:215]
    v_mfma_f32_32x32x16_bf16 v[184:199], a[12:15], v[28:31], v[184:199]
    v_mfma_f32_32x32x16_bf16 v[200:215], a[124:127], v[28:31], v[200:215]
    v_mfma_f32_32x32x16_bf16 v[184:199], a[16:19], v[32:35], v[184:199]
    v_mfma_f32_32x32x16_bf16 v[200:215], a[128:131], v[32:35], v[200:215]
    v_mfma_f32_32x32x16_bf16 v[184:199], a[20:23], v[36:39], v[184:199]
    v_mfma_f32_32x32x16_bf16 v[200:215], a[132:135], v[36:39], v[200:215]
    v_mfma_f32_32x32x16_bf16 v[184:199], a[24:27], v[40:43], v[184:199]
    v_mfma_f32_32x32x16_bf16 v[200:215], a[136:139], v[40:43], v[200:215]
    v_mfma_f32_32x32x16_bf16 v[184:199], a[28:31], v[44:47], v[184:199]
    v_mfma_f32_32x32x16_bf16 v[200:215], a[140:143], v[44:47], v[200:215]
    v_mfma_f32_32x32x16_bf16 v[184:199], a[32:35], v[48:51], v[184:199]
    v_mfma_f32_32x32x16_bf16 v[200:215], a[144:147], v[48:51], v[200:215]
    v_mfma_f32_32x32x16_bf16 v[184:199], a[36:39], v[52:55], v[184:199]
    v_mfma_f32_32x32x16_bf16 v[200:215], a[148:151], v[52:55], v[200:215]
    v_mfma_f32_32x32x16_bf16 v[184:199], a[40:43], v[56:59], v[184:199]
    v_mfma_f32_32x32x16_bf16 v[200:215], a[152:155], v[56:59], v[200:215]
    v_mfma_f32_32x32x16_bf16 v[184:199], a[44:47], v[60:63], v[184:199]
    v_mfma_f32_32x32x16_bf16 v[200:215], a[156:159], v[60:63], v[200:215]
    v_mfma_f32_32x32x16_bf16 v[184:199], a[48:51], v[64:67], v[184:199]
    v_mfma_f32_32x32x16_bf16 v[200:215], a[160:163], v[64:67], v[200:215]
    v_mfma_f32_32x32x16_bf16 v[184:199], a[52:55], v[68:71], v[184:199]
    v_mfma_f32_32x32x16_bf16 v[200:215], a[164:167], v[68:71], v[200:215]
    s_add_u32 s39, s36, 12288
    buffer_load_dwordx4 v[16:19], v5, s[48:51], s39 offen offset:2048
    buffer_load_dwordx4 v[20:23], v5, s[48:51], s39 offen offset:3072
    s_add_u32 s39, s36, 16384
    buffer_load_dwordx4 v[24:27], v5, s[48:51], s39 offen offset:0
    buffer_load_dwordx4 v[28:31], v5, s[48:51], s39 offen offset:1024
    buffer_load_dwordx4 v[32:35], v5, s[48:51], s39 offen offset:2048
    buffer_load_dwordx4 v[36:39], v5, s[48:51], s39 offen offset:3072
    s_add_u32 s39, s36, 20480
    buffer_load_dwordx4 v[40:43], v5, s[48:51], s39 offen offset:0
    buffer_load_dwordx4 v[44:47], v5, s[48:51], s39 offen offset:1024
    buffer_load_dwordx4 v[48:51], v5, s[48:51], s39 offen offset:2048
    buffer_load_dwordx4 v[52:55], v5, s[48:51], s39 offen offset:3072
    s_add_u32 s39, s36, 24576
    buffer_load_dwordx4 v[56:59], v5, s[48:51], s39 offen offset:0
    buffer_load_dwordx4 v[60:63], v5, s[48:51], s39 offen offset:1024
    buffer_load_dwordx4 v[64:67], v5, s[48:51], s39 offen offset:2048
    buffer_load_dwordx4 v[68:71], v5, s[48:51], s39 offen offset:3072
    s_add_u32 s36, s36, 114688
    s_waitcnt vmcnt(28)
    v_mfma_f32_32x32x16_bf16 v[184:199], a[56:59], v[72:75], v[184:199]
    v_mfma_f32_32x32x16_bf16 v[200:215], a[168:171], v[72:75], v[200:215]
    v_mfma_f32_32x32x16_bf16 v[184:199], a[60:63], v[76:79], v[184:199]
    v_mfma_f32_32x32x16_bf16 v[200:215], a[172:175], v[76:79], v[200:215]
    v_mfma_f32_32x32x16_bf16 v[184:199], a[64:67], v[80:83], v[184:199]
    v_mfma_f32_32x32x16_bf16 v[200:215], a[176:179], v[80:83], v[200:215]
    v_mfma_f32_32x32x16_bf16 v[184:199], a[68:71], v[84:87], v[184:199]
    v_mfma_f32_32x32x16_bf16 v[200:215], a[180:183], v[84:87], v[200:215]
    v_mfma_f32_32x32x16_bf16 v[184:199], a[72:75], v[88:91], v[184:199]
    v_mfma_f32_32x32x16_bf16 v[200:215], a[184:187], v[88:91], v[200:215]
    v_mfma_f32_32x32x16_bf16 v[184:199], a[76:79], v[92:95], v[184:199]
    v_mfma_f32_32x32x16_bf16 v[200:215], a[188:191], v[92:95], v[200:215]
    v_mfma_f32_32x32x16_bf16 v[184:199], a[80:83], v[96:99], v[184:199]
    v_mfma_f32_32x32x16_bf16 v[200:215], a[192:195], v[96:99], v[200:215]
    v_mfma_f32_32x32x16_bf16 v[184:199], a[84:87], v[100:103], v[184:199]
    v_mfma_f32_32x32x16_bf16 v[200:215], a[196:199], v[100:103], v[200:215]
    v_mfma_f32_32x32x16_bf16 v[184:199], a[88:91], v[104:107], v[184:199]
    v_mfma_f32_32x32x16_bf16 v[200:215], a[200:203], v[104:107], v[200:215]
    v_mfma_f32_32x32x16_bf16 v[184:199], a[92:95], v[108:111], v[184:199]
    v_mfma_f32_32x32x16_bf16 v[200:215], a[204:207], v[108:111], v[200:215]
    v_mfma_f32_32x32x16_bf16 v[184:199], a[96:99], v[112:115], v[184:199]
    v_mfma_f32_32x32x16_bf16 v[200:215], a[208:211], v[112:115], v[200:215]
    v_mfma_f32_32x32x16_bf16 v[184:199], a[100:103], v[116:119], v[184:199]
    v_mfma_f32_32x32x16_bf16 v[200:215], a[212:215], v[116:119], v[200:215]
    v_mfma_f32_32x32x16_bf16 v[184:199], a[104:107], v[120:123], v[184:199]
    v_mfma_f32_32x32x16_bf16 v[200:215], a[216:219], v[120:123], v[200:215]
    v_mfma_f32_32x32x16_bf16 v[184:199], a[108:111], v[124:127], v[184:199]
    v_mfma_f32_32x32x16_bf16 v[200:215], a[220:223], v[124:127], v[200:215]
    s_nop 15
    s_nop 1
    v_cvt_pk_bf16_f32 v216, v184, v185
    v_cvt_pk_bf16_f32 v217, v186, v187
    v_cvt_pk_bf16_f32 v218, v188, v189
    v_cvt_pk_bf16_f32 v219, v190, v191
    v_cvt_pk_bf16_f32 v220, v192, v193
    v_cvt_pk_bf16_f32 v221, v194, v195
    v_cvt_pk_bf16_f32 v222, v196, v197
    v_cvt_pk_bf16_f32 v223, v198, v199
    v_cvt_pk_bf16_f32 v224, v200, v201
    v_cvt_pk_bf16_f32 v225, v202, v203
    v_cvt_pk_bf16_f32 v226, v204, v205
    v_cvt_pk_bf16_f32 v227, v206, v207
    v_cvt_pk_bf16_f32 v228, v208, v209
    v_cvt_pk_bf16_f32 v229, v210, v211
    v_cvt_pk_bf16_f32 v230, v212, v213
    v_cvt_pk_bf16_f32 v231, v214, v215
    buffer_store_dwordx4 v[216:219], v6, s[52:55], s37 offen offset:0 sc1
    buffer_store_dwordx4 v[220:223], v6, s[52:55], s37 offen offset:256 sc1
    buffer_store_dwordx4 v[224:227], v6, s[52:55], s37 offen offset:512 sc1
    buffer_store_dwordx4 v[228:231], v6, s[52:55], s37 offen offset:768 sc1
    s_add_u32 s37, s37, 1835008
    s_add_u32 s39, s36, 0
    buffer_load_dwordx4 v[72:75], v5, s[48:51], s39 offen offset:0
    buffer_load_dwordx4 v[76:79], v5, s[48:51], s39 offen offset:1024
    buffer_load_dwordx4 v[80:83], v5, s[48:51], s39 offen offset:2048
    buffer_load_dwordx4 v[84:87], v5, s[48:51], s39 offen offset:3072
    s_add_u32 s39, s36, 4096
    buffer_load_dwordx4 v[88:91], v5, s[48:51], s39 offen offset:0
    buffer_load_dwordx4 v[92:95], v5, s[48:51], s39 offen offset:1024
    buffer_load_dwordx4 v[96:99], v5, s[48:51], s39 offen offset:2048
    buffer_load_dwordx4 v[100:103], v5, s[48:51], s39 offen offset:3072
    s_add_u32 s39, s36, 8192
    buffer_load_dwordx4 v[104:107], v5, s[48:51], s39 offen offset:0
    buffer_load_dwordx4 v[108:111], v5, s[48:51], s39 offen offset:1024
    buffer_load_dwordx4 v[112:115], v5, s[48:51], s39 offen offset:2048
    buffer_load_dwordx4 v[116:119], v5, s[48:51], s39 offen offset:3072
    s_add_u32 s39, s36, 12288
    buffer_load_dwordx4 v[120:123], v5, s[48:51], s39 offen offset:0
    buffer_load_dwordx4 v[124:127], v5, s[48:51], s39 offen offset:1024
    s_waitcnt vmcnt(28)
    v_mfma_f32_32x32x16_bf16 v[184:199], a[0:3], v[128:131], 0
    v_mfma_f32_32x32x16_bf16 v[200:215], a[112:115], v[128:131], 0
    v_mfma_f32_32x32x16_bf16 v[184:199], a[4:7], v[132:135], v[184:199]
    v_mfma_f32_32x32x16_bf16 v[200:215], a[116:119], v[132:135], v[200:215]
    v_mfma_f32_32x32x16_bf16 v[184:199], a[8:11], v[136:139], v[184:199]
    v_mfma_f32_32x32x16_bf16 v[200:215], a[120:123], v[136:139], v[200:215]
    v_mfma_f32_32x32x16_bf16 v[184:199], a[12:15], v[140:143], v[184:199]
    v_mfma_f32_32x32x16_bf16 v[200:215], a[124:127], v[140:143], v[200:215]
    v_mfma_f32_32x32x16_bf16 v[184:199], a[16:19], v[144:147], v[184:199]
    v_mfma_f32_32x32x16_bf16 v[200:215], a[128:131], v[144:147], v[200:215]
    v_mfma_f32_32x32x16_bf16 v[184:199], a[20:23], v[148:151], v[184:199]
    v_mfma_f32_32x32x16_bf16 v[200:215], a[132:135], v[148:151], v[200:215]
    v_mfma_f32_32x32x16_bf16 v[184:199], a[24:27], v[152:155], v[184:199]
    v_mfma_f32_32x32x16_bf16 v[200:215], a[136:139], v[152:155], v[200:215]
    v_mfma_f32_32x32x16_bf16 v[184:199], a[28:31], v[156:159], v[184:199]
    v_mfma_f32_32x32x16_bf16 v[200:215], a[140:143], v[156:159], v[200:215]
    v_mfma_f32_32x32x16_bf16 v[184:199], a[32:35], v[160:163], v[184:199]
    v_mfma_f32_32x32x16_bf16 v[200:215], a[144:147], v[160:163], v[200:215]
    v_mfma_f32_32x32x16_bf16 v[184:199], a[36:39], v[164:167], v[184:199]
    v_mfma_f32_32x32x16_bf16 v[200:215], a[148:151], v[164:167], v[200:215]
    v_mfma_f32_32x32x16_bf16 v[184:199], a[40:43], v[168:171], v[184:199]
    v_mfma_f32_32x32x16_bf16 v[200:215], a[152:155], v[168:171], v[200:215]
    v_mfma_f32_32x32x16_bf16 v[184:199], a[44:47], v[172:175], v[184:199]
    v_mfma_f32_32x32x16_bf16 v[200:215], a[156:159], v[172:175], v[200:215]
    v_mfma_f32_32x32x16_bf16 v[184:199], a[48:51], v[176:179], v[184:199]
    v_mfma_f32_32x32x16_bf16 v[200:215], a[160:163], v[176:179], v[200:215]
    v_mfma_f32_32x32x16_bf16 v[184:199], a[52:55], v[180:183], v[184:199]
    v_mfma_f32_32x32x16_bf16 v[200:215], a[164:167], v[180:183], v[200:215]
    s_add_u32 s39, s36, 12288
    buffer_load_dwordx4 v[128:131], v5, s[48:51], s39 offen offset:2048
    buffer_load_dwordx4 v[132:135], v5, s[48:51], s39 offen offset:3072
    s_add_u32 s39, s36, 16384
    buffer_load_dwordx4 v[136:139], v5, s[48:51], s39 offen offset:0
    buffer_load_dwordx4 v[140:143], v5, s[48:51], s39 offen offset:1024
    buffer_load_dwordx4 v[144:147], v5, s[48:51], s39 offen offset:2048
    buffer_load_dwordx4 v[148:151], v5, s[48:51], s39 offen offset:3072
    s_add_u32 s39, s36, 20480
    buffer_load_dwordx4 v[152:155], v5, s[48:51], s39 offen offset:0
    buffer_load_dwordx4 v[156:159], v5, s[48:51], s39 offen offset:1024
    buffer_load_dwordx4 v[160:163], v5, s[48:51], s39 offen offset:2048
    buffer_load_dwordx4 v[164:167], v5, s[48:51], s39 offen offset:3072
    s_add_u32 s39, s36, 24576
    buffer_load_dwordx4 v[168:171], v5, s[48:51], s39 offen offset:0
    buffer_load_dwordx4 v[172:175], v5, s[48:51], s39 offen offset:1024
    buffer_load_dwordx4 v[176:179], v5, s[48:51], s39 offen offset:2048
    buffer_load_dwordx4 v[180:183], v5, s[48:51], s39 offen offset:3072
    s_add_u32 s36, s36, 114688
    s_waitcnt vmcnt(28)
    s_barrier
    v_mov_b32 v13, 0
    s_lshl_b32 s22, s100, 2
    s_add_u32 s22, s22, 12288
    v_cmp_eq_u32 vcc, 0, v0
    s_and_b64 exec, exec, vcc
    buffer_store_dword v13, v13, s[96:99], s22 offen offset:0 sc1
    s_mov_b64 exec, -1
    v_mfma_f32_32x32x16_bf16 v[184:199], a[56:59], v[16:19], v[184:199]
    v_mfma_f32_32x32x16_bf16 v[200:215], a[168:171], v[16:19], v[200:215]
    v_mfma_f32_32x32x16_bf16 v[184:199], a[60:63], v[20:23], v[184:199]
    v_mfma_f32_32x32x16_bf16 v[200:215], a[172:175], v[20:23], v[200:215]
    v_mfma_f32_32x32x16_bf16 v[184:199], a[64:67], v[24:27], v[184:199]
    v_mfma_f32_32x32x16_bf16 v[200:215], a[176:179], v[24:27], v[200:215]
    v_mfma_f32_32x32x16_bf16 v[184:199], a[68:71], v[28:31], v[184:199]
    v_mfma_f32_32x32x16_bf16 v[200:215], a[180:183], v[28:31], v[200:215]
    v_mfma_f32_32x32x16_bf16 v[184:199], a[72:75], v[32:35], v[184:199]
    v_mfma_f32_32x32x16_bf16 v[200:215], a[184:187], v[32:35], v[200:215]
    v_mfma_f32_32x32x16_bf16 v[184:199], a[76:79], v[36:39], v[184:199]
    v_mfma_f32_32x32x16_bf16 v[200:215], a[188:191], v[36:39], v[200:215]
    v_mfma_f32_32x32x16_bf16 v[184:199], a[80:83], v[40:43], v[184:199]
    v_mfma_f32_32x32x16_bf16 v[200:215], a[192:195], v[40:43], v[200:215]
    v_mfma_f32_32x32x16_bf16 v[184:199], a[84:87], v[44:47], v[184:199]
    v_mfma_f32_32x32x16_bf16 v[200:215], a[196:199], v[44:47], v[200:215]
    v_mfma_f32_32x32x16_bf16 v[184:199], a[88:91], v[48:51], v[184:199]
    v_mfma_f32_32x32x16_bf16 v[200:215], a[200:203], v[48:51], v[200:215]
    v_mfma_f32_32x32x16_bf16 v[184:199], a[92:95], v[52:55], v[184:199]
    v_mfma_f32_32x32x16_bf16 v[200:215], a[204:207], v[52:55], v[200:215]
    v_mfma_f32_32x32x16_bf16 v[184:199], a[96:99], v[56:59], v[184:199]
    v_mfma_f32_32x32x16_bf16 v[200:215], a[208:211], v[56:59], v[200:215]
    v_mfma_f32_32x32x16_bf16 v[184:199], a[100:103], v[60:63], v[184:199]
    v_mfma_f32_32x32x16_bf16 v[200:215], a[212:215], v[60:63], v[200:215]
    v_mfma_f32_32x32x16_bf16 v[184:199], a[104:107], v[64:67], v[184:199]
    v_mfma_f32_32x32x16_bf16 v[200:215], a[216:219], v[64:67], v[200:215]
    v_mfma_f32_32x32x16_bf16 v[184:199], a[108:111], v[68:71], v[184:199]
    v_mfma_f32_32x32x16_bf16 v[200:215], a[220:223], v[68:71], v[200:215]
    s_nop 15
    s_nop 1
    v_cvt_pk_bf16_f32 v216, v184, v185
    v_cvt_pk_bf16_f32 v217, v186, v187
    v_cvt_pk_bf16_f32 v218, v188, v189
    v_cvt_pk_bf16_f32 v219, v190, v191
    v_cvt_pk_bf16_f32 v220, v192, v193
    v_cvt_pk_bf16_f32 v221, v194, v195
    v_cvt_pk_bf16_f32 v222, v196, v197
    v_cvt_pk_bf16_f32 v223, v198, v199
    v_cvt_pk_bf16_f32 v224, v200, v201
    v_cvt_pk_bf16_f32 v225, v202, v203
    v_cvt_pk_bf16_f32 v226, v204, v205
    v_cvt_pk_bf16_f32 v227, v206, v207
    v_cvt_pk_bf16_f32 v228, v208, v209
    v_cvt_pk_bf16_f32 v229, v210, v211
    v_cvt_pk_bf16_f32 v230, v212, v213
    v_cvt_pk_bf16_f32 v231, v214, v215
    buffer_store_dwordx4 v[216:219], v6, s[52:55], s37 offen offset:0 sc1
    buffer_store_dwordx4 v[220:223], v6, s[52:55], s37 offen offset:256 sc1
    buffer_store_dwordx4 v[224:227], v6, s[52:55], s37 offen offset:512 sc1
    buffer_store_dwordx4 v[228:231], v6, s[52:55], s37 offen offset:768 sc1
    s_add_u32 s37, s37, 1835008
    s_add_u32 s39, s36, 0
    buffer_load_dwordx4 v[16:19], v5, s[48:51], s39 offen offset:0
    buffer_load_dwordx4 v[20:23], v5, s[48:51], s39 offen offset:1024
    buffer_load_dwordx4 v[24:27], v5, s[48:51], s39 offen offset:2048
    buffer_load_dwordx4 v[28:31], v5, s[48:51], s39 offen offset:3072
    s_add_u32 s39, s36, 4096
    buffer_load_dwordx4 v[32:35], v5, s[48:51], s39 offen offset:0
    buffer_load_dwordx4 v[36:39], v5, s[48:51], s39 offen offset:1024
    buffer_load_dwordx4 v[40:43], v5, s[48:51], s39 offen offset:2048
    buffer_load_dwordx4 v[44:47], v5, s[48:51], s39 offen offset:3072
    s_add_u32 s39, s36, 8192
    buffer_load_dwordx4 v[48:51], v5, s[48:51], s39 offen offset:0
    buffer_load_dwordx4 v[52:55], v5, s[48:51], s39 offen offset:1024
    buffer_load_dwordx4 v[56:59], v5, s[48:51], s39 offen offset:2048
    buffer_load_dwordx4 v[60:63], v5, s[48:51], s39 offen offset:3072
    s_add_u32 s39, s36, 12288
    buffer_load_dwordx4 v[64:67], v5, s[48:51], s39 offen offset:0
    buffer_load_dwordx4 v[68:71], v5, s[48:51], s39 offen offset:1024
    s_waitcnt vmcnt(28)
    v_mfma_f32_32x32x16_bf16 v[184:199], a[0:3], v[72:75], 0
    v_mfma_f32_32x32x16_bf16 v[200:215], a[112:115], v[72:75], 0
    v_mfma_f32_32x32x16_bf16 v[184:199], a[4:7], v[76:79], v[184:199]
    v_mfma_f32_32x32x16_bf16 v[200:215], a[116:119], v[76:79], v[200:215]
    v_mfma_f32_32x32x16_bf16 v[184:199], a[8:11], v[80:83], v[184:199]
    v_mfma_f32_32x32x16_bf16 v[200:215], a[120:123], v[80:83], v[200:215]
    v_mfma_f32_32x32x16_bf16 v[184:199], a[12:15], v[84:87], v[184:199]
    v_mfma_f32_32x32x16_bf16 v[200:215], a[124:127], v[84:87], v[200:215]
    v_mfma_f32_32x32x16_bf16 v[184:199], a[16:19], v[88:91], v[184:199]
    v_mfma_f32_32x32x16_bf16 v[200:215], a[128:131], v[88:91], v[200:215]
    v_mfma_f32_32x32x16_bf16 v[184:199], a[20:23], v[92:95], v[184:199]
    v_mfma_f32_32x32x16_bf16 v[200:215], a[132:135], v[92:95], v[200:215]
    v_mfma_f32_32x32x16_bf16 v[184:199], a[24:27], v[96:99], v[184:199]
    v_mfma_f32_32x32x16_bf16 v[200:215], a[136:139], v[96:99], v[200:215]
    v_mfma_f32_32x32x16_bf16 v[184:199], a[28:31], v[100:103], v[184:199]
    v_mfma_f32_32x32x16_bf16 v[200:215], a[140:143], v[100:103], v[200:215]
    v_mfma_f32_32x32x16_bf16 v[184:199], a[32:35], v[104:107], v[184:199]
    v_mfma_f32_32x32x16_bf16 v[200:215], a[144:147], v[104:107], v[200:215]
    v_mfma_f32_32x32x16_bf16 v[184:199], a[36:39], v[108:111], v[184:199]
    v_mfma_f32_32x32x16_bf16 v[200:215], a[148:151], v[108:111], v[200:215]
    v_mfma_f32_32x32x16_bf16 v[184:199], a[40:43], v[112:115], v[184:199]
    v_mfma_f32_32x32x16_bf16 v[200:215], a[152:155], v[112:115], v[200:215]
    v_mfma_f32_32x32x16_bf16 v[184:199], a[44:47], v[116:119], v[184:199]
    v_mfma_f32_32x32x16_bf16 v[200:215], a[156:159], v[116:119], v[200:215]
    v_mfma_f32_32x32x16_bf16 v[184:199], a[48:51], v[120:123], v[184:199]
    v_mfma_f32_32x32x16_bf16 v[200:215], a[160:163], v[120:123], v[200:215]
    v_mfma_f32_32x32x16_bf16 v[184:199], a[52:55], v[124:127], v[184:199]
    v_mfma_f32_32x32x16_bf16 v[200:215], a[164:167], v[124:127], v[200:215]
    s_add_u32 s39, s36, 12288
    buffer_load_dwordx4 v[72:75], v5, s[48:51], s39 offen offset:2048
    buffer_load_dwordx4 v[76:79], v5, s[48:51], s39 offen offset:3072
    s_add_u32 s39, s36, 16384
    buffer_load_dwordx4 v[80:83], v5, s[48:51], s39 offen offset:0
    buffer_load_dwordx4 v[84:87], v5, s[48:51], s39 offen offset:1024
    buffer_load_dwordx4 v[88:91], v5, s[48:51], s39 offen offset:2048
    buffer_load_dwordx4 v[92:95], v5, s[48:51], s39 offen offset:3072
    s_add_u32 s39, s36, 20480
    buffer_load_dwordx4 v[96:99], v5, s[48:51], s39 offen offset:0
    buffer_load_dwordx4 v[100:103], v5, s[48:51], s39 offen offset:1024
    buffer_load_dwordx4 v[104:107], v5, s[48:51], s39 offen offset:2048
    buffer_load_dwordx4 v[108:111], v5, s[48:51], s39 offen offset:3072
    s_add_u32 s39, s36, 24576
    buffer_load_dwordx4 v[112:115], v5, s[48:51], s39 offen offset:0
    buffer_load_dwordx4 v[116:119], v5, s[48:51], s39 offen offset:1024
    buffer_load_dwordx4 v[120:123], v5, s[48:51], s39 offen offset:2048
    buffer_load_dwordx4 v[124:127], v5, s[48:51], s39 offen offset:3072
    s_add_u32 s36, s36, 114688
    s_waitcnt vmcnt(28)
    s_barrier
    v_mov_b32 v13, 0
    s_lshl_b32 s22, s100, 2
    s_add_u32 s22, s22, 4096
    v_cmp_eq_u32 vcc, 0, v0
    s_and_b64 exec, exec, vcc
    buffer_store_dword v13, v13, s[96:99], s22 offen offset:0 sc1
    s_mov_b64 exec, -1
    v_mfma_f32_32x32x16_bf16 v[184:199], a[56:59], v[128:131], v[184:199]
    v_mfma_f32_32x32x16_bf16 v[200:215], a[168:171], v[128:131], v[200:215]
    v_mfma_f32_32x32x16_bf16 v[184:199], a[60:63], v[132:135], v[184:199]
    v_mfma_f32_32x32x16_bf16 v[200:215], a[172:175], v[132:135], v[200:215]
    v_mfma_f32_32x32x16_bf16 v[184:199], a[64:67], v[136:139], v[184:199]
    v_mfma_f32_32x32x16_bf16 v[200:215], a[176:179], v[136:139], v[200:215]
    v_mfma_f32_32x32x16_bf16 v[184:199], a[68:71], v[140:143], v[184:199]
    v_mfma_f32_32x32x16_bf16 v[200:215], a[180:183], v[140:143], v[200:215]
    v_mfma_f32_32x32x16_bf16 v[184:199], a[72:75], v[144:147], v[184:199]
    v_mfma_f32_32x32x16_bf16 v[200:215], a[184:187], v[144:147], v[200:215]
    v_mfma_f32_32x32x16_bf16 v[184:199], a[76:79], v[148:151], v[184:199]
    v_mfma_f32_32x32x16_bf16 v[200:215], a[188:191], v[148:151], v[200:215]
    v_mfma_f32_32x32x16_bf16 v[184:199], a[80:83], v[152:155], v[184:199]
    v_mfma_f32_32x32x16_bf16 v[200:215], a[192:195], v[152:155], v[200:215]
    v_mfma_f32_32x32x16_bf16 v[184:199], a[84:87], v[156:159], v[184:199]
    v_mfma_f32_32x32x16_bf16 v[200:215], a[196:199], v[156:159], v[200:215]
    v_mfma_f32_32x32x16_bf16 v[184:199], a[88:91], v[160:163], v[184:199]
    v_mfma_f32_32x32x16_bf16 v[200:215], a[200:203], v[160:163], v[200:215]
    v_mfma_f32_32x32x16_bf16 v[184:199], a[92:95], v[164:167], v[184:199]
    v_mfma_f32_32x32x16_bf16 v[200:215], a[204:207], v[164:167], v[200:215]
    v_mfma_f32_32x32x16_bf16 v[184:199], a[96:99], v[168:171], v[184:199]
    v_mfma_f32_32x32x16_bf16 v[200:215], a[208:211], v[168:171], v[200:215]
    v_mfma_f32_32x32x16_bf16 v[184:199], a[100:103], v[172:175], v[184:199]
    v_mfma_f32_32x32x16_bf16 v[200:215], a[212:215], v[172:175], v[200:215]
    v_mfma_f32_32x32x16_bf16 v[184:199], a[104:107], v[176:179], v[184:199]
    v_mfma_f32_32x32x16_bf16 v[200:215], a[216:219], v[176:179], v[200:215]
    v_mfma_f32_32x32x16_bf16 v[184:199], a[108:111], v[180:183], v[184:199]
    v_mfma_f32_32x32x16_bf16 v[200:215], a[220:223], v[180:183], v[200:215]
    s_nop 15
    s_nop 1
    v_cvt_pk_bf16_f32 v216, v184, v185
    v_cvt_pk_bf16_f32 v217, v186, v187
    v_cvt_pk_bf16_f32 v218, v188, v189
    v_cvt_pk_bf16_f32 v219, v190, v191
    v_cvt_pk_bf16_f32 v220, v192, v193
    v_cvt_pk_bf16_f32 v221, v194, v195
    v_cvt_pk_bf16_f32 v222, v196, v197
    v_cvt_pk_bf16_f32 v223, v198, v199
    v_cvt_pk_bf16_f32 v224, v200, v201
    v_cvt_pk_bf16_f32 v225, v202, v203
    v_cvt_pk_bf16_f32 v226, v204, v205
    v_cvt_pk_bf16_f32 v227, v206, v207
    v_cvt_pk_bf16_f32 v228, v208, v209
    v_cvt_pk_bf16_f32 v229, v210, v211
    v_cvt_pk_bf16_f32 v230, v212, v213
    v_cvt_pk_bf16_f32 v231, v214, v215
    buffer_store_dwordx4 v[216:219], v6, s[52:55], s37 offen offset:0 sc1
    buffer_store_dwordx4 v[220:223], v6, s[52:55], s37 offen offset:256 sc1
    buffer_store_dwordx4 v[224:227], v6, s[52:55], s37 offen offset:512 sc1
    buffer_store_dwordx4 v[228:231], v6, s[52:55], s37 offen offset:768 sc1
    s_add_u32 s37, s37, 1835008
    s_add_u32 s39, s36, 0
    buffer_load_dwordx4 v[128:131], v5, s[48:51], s39 offen offset:0
    buffer_load_dwordx4 v[132:135], v5, s[48:51], s39 offen offset:1024
    buffer_load_dwordx4 v[136:139], v5, s[48:51], s39 offen offset:2048
    buffer_load_dwordx4 v[140:143], v5, s[48:51], s39 offen offset:3072
    s_add_u32 s39, s36, 4096
    buffer_load_dwordx4 v[144:147], v5, s[48:51], s39 offen offset:0
    buffer_load_dwordx4 v[148:151], v5, s[48:51], s39 offen offset:1024
    buffer_load_dwordx4 v[152:155], v5, s[48:51], s39 offen offset:2048
    buffer_load_dwordx4 v[156:159], v5, s[48:51], s39 offen offset:3072
    s_add_u32 s39, s36, 8192
    buffer_load_dwordx4 v[160:163], v5, s[48:51], s39 offen offset:0
    buffer_load_dwordx4 v[164:167], v5, s[48:51], s39 offen offset:1024
    buffer_load_dwordx4 v[168:171], v5, s[48:51], s39 offen offset:2048
    buffer_load_dwordx4 v[172:175], v5, s[48:51], s39 offen offset:3072
    s_add_u32 s39, s36, 12288
    buffer_load_dwordx4 v[176:179], v5, s[48:51], s39 offen offset:0
    buffer_load_dwordx4 v[180:183], v5, s[48:51], s39 offen offset:1024
    s_waitcnt vmcnt(28)
    v_mfma_f32_32x32x16_bf16 v[184:199], a[0:3], v[16:19], 0
    v_mfma_f32_32x32x16_bf16 v[200:215], a[112:115], v[16:19], 0
    v_mfma_f32_32x32x16_bf16 v[184:199], a[4:7], v[20:23], v[184:199]
    v_mfma_f32_32x32x16_bf16 v[200:215], a[116:119], v[20:23], v[200:215]
    v_mfma_f32_32x32x16_bf16 v[184:199], a[8:11], v[24:27], v[184:199]
    v_mfma_f32_32x32x16_bf16 v[200:215], a[120:123], v[24:27], v[200:215]
    v_mfma_f32_32x32x16_bf16 v[184:199], a[12:15], v[28:31], v[184:199]
    v_mfma_f32_32x32x16_bf16 v[200:215], a[124:127], v[28:31], v[200:215]
    v_mfma_f32_32x32x16_bf16 v[184:199], a[16:19], v[32:35], v[184:199]
    v_mfma_f32_32x32x16_bf16 v[200:215], a[128:131], v[32:35], v[200:215]
    v_mfma_f32_32x32x16_bf16 v[184:199], a[20:23], v[36:39], v[184:199]
    v_mfma_f32_32x32x16_bf16 v[200:215], a[132:135], v[36:39], v[200:215]
    v_mfma_f32_32x32x16_bf16 v[184:199], a[24:27], v[40:43], v[184:199]
    v_mfma_f32_32x32x16_bf16 v[200:215], a[136:139], v[40:43], v[200:215]
    v_mfma_f32_32x32x16_bf16 v[184:199], a[28:31], v[44:47], v[184:199]
    v_mfma_f32_32x32x16_bf16 v[200:215], a[140:143], v[44:47], v[200:215]
    v_mfma_f32_32x32x16_bf16 v[184:199], a[32:35], v[48:51], v[184:199]
    v_mfma_f32_32x32x16_bf16 v[200:215], a[144:147], v[48:51], v[200:215]
    v_mfma_f32_32x32x16_bf16 v[184:199], a[36:39], v[52:55], v[184:199]
    v_mfma_f32_32x32x16_bf16 v[200:215], a[148:151], v[52:55], v[200:215]
    v_mfma_f32_32x32x16_bf16 v[184:199], a[40:43], v[56:59], v[184:199]
    v_mfma_f32_32x32x16_bf16 v[200:215], a[152:155], v[56:59], v[200:215]
    v_mfma_f32_32x32x16_bf16 v[184:199], a[44:47], v[60:63], v[184:199]
    v_mfma_f32_32x32x16_bf16 v[200:215], a[156:159], v[60:63], v[200:215]
    v_mfma_f32_32x32x16_bf16 v[184:199], a[48:51], v[64:67], v[184:199]
    v_mfma_f32_32x32x16_bf16 v[200:215], a[160:163], v[64:67], v[200:215]
    v_mfma_f32_32x32x16_bf16 v[184:199], a[52:55], v[68:71], v[184:199]
    v_mfma_f32_32x32x16_bf16 v[200:215], a[164:167], v[68:71], v[200:215]
    s_add_u32 s39, s36, 12288
    buffer_load_dwordx4 v[16:19], v5, s[48:51], s39 offen offset:2048
    buffer_load_dwordx4 v[20:23], v5, s[48:51], s39 offen offset:3072
    s_add_u32 s39, s36, 16384
    buffer_load_dwordx4 v[24:27], v5, s[48:51], s39 offen offset:0
    buffer_load_dwordx4 v[28:31], v5, s[48:51], s39 offen offset:1024
    buffer_load_dwordx4 v[32:35], v5, s[48:51], s39 offen offset:2048
    buffer_load_dwordx4 v[36:39], v5, s[48:51], s39 offen offset:3072
    s_add_u32 s39, s36, 20480
    buffer_load_dwordx4 v[40:43], v5, s[48:51], s39 offen offset:0
    buffer_load_dwordx4 v[44:47], v5, s[48:51], s39 offen offset:1024
    buffer_load_dwordx4 v[48:51], v5, s[48:51], s39 offen offset:2048
    buffer_load_dwordx4 v[52:55], v5, s[48:51], s39 offen offset:3072
    s_add_u32 s39, s36, 24576
    buffer_load_dwordx4 v[56:59], v5, s[48:51], s39 offen offset:0
    buffer_load_dwordx4 v[60:63], v5, s[48:51], s39 offen offset:1024
    buffer_load_dwordx4 v[64:67], v5, s[48:51], s39 offen offset:2048
    buffer_load_dwordx4 v[68:71], v5, s[48:51], s39 offen offset:3072
    s_add_u32 s36, s36, 114688
    s_waitcnt vmcnt(28)
    v_mfma_f32_32x32x16_bf16 v[184:199], a[56:59], v[72:75], v[184:199]
    v_mfma_f32_32x32x16_bf16 v[200:215], a[168:171], v[72:75], v[200:215]
    v_mfma_f32_32x32x16_bf16 v[184:199], a[60:63], v[76:79], v[184:199]
    v_mfma_f32_32x32x16_bf16 v[200:215], a[172:175], v[76:79], v[200:215]
    v_mfma_f32_32x32x16_bf16 v[184:199], a[64:67], v[80:83], v[184:199]
    v_mfma_f32_32x32x16_bf16 v[200:215], a[176:179], v[80:83], v[200:215]
    v_mfma_f32_32x32x16_bf16 v[184:199], a[68:71], v[84:87], v[184:199]
    v_mfma_f32_32x32x16_bf16 v[200:215], a[180:183], v[84:87], v[200:215]
    v_mfma_f32_32x32x16_bf16 v[184:199], a[72:75], v[88:91], v[184:199]
    v_mfma_f32_32x32x16_bf16 v[200:215], a[184:187], v[88:91], v[200:215]
    v_mfma_f32_32x32x16_bf16 v[184:199], a[76:79], v[92:95], v[184:199]
    v_mfma_f32_32x32x16_bf16 v[200:215], a[188:191], v[92:95], v[200:215]
    v_mfma_f32_32x32x16_bf16 v[184:199], a[80:83], v[96:99], v[184:199]
    v_mfma_f32_32x32x16_bf16 v[200:215], a[192:195], v[96:99], v[200:215]
    v_mfma_f32_32x32x16_bf16 v[184:199], a[84:87], v[100:103], v[184:199]
    v_mfma_f32_32x32x16_bf16 v[200:215], a[196:199], v[100:103], v[200:215]
    v_mfma_f32_32x32x16_bf16 v[184:199], a[88:91], v[104:107], v[184:199]
    v_mfma_f32_32x32x16_bf16 v[200:215], a[200:203], v[104:107], v[200:215]
    v_mfma_f32_32x32x16_bf16 v[184:199], a[92:95], v[108:111], v[184:199]
    v_mfma_f32_32x32x16_bf16 v[200:215], a[204:207], v[108:111], v[200:215]
    v_mfma_f32_32x32x16_bf16 v[184:199], a[96:99], v[112:115], v[184:199]
    v_mfma_f32_32x32x16_bf16 v[200:215], a[208:211], v[112:115], v[200:215]
    v_mfma_f32_32x32x16_bf16 v[184:199], a[100:103], v[116:119], v[184:199]
    v_mfma_f32_32x32x16_bf16 v[200:215], a[212:215], v[116:119], v[200:215]
    v_mfma_f32_32x32x16_bf16 v[184:199], a[104:107], v[120:123], v[184:199]
    v_mfma_f32_32x32x16_bf16 v[200:215], a[216:219], v[120:123], v[200:215]
    v_mfma_f32_32x32x16_bf16 v[184:199], a[108:111], v[124:127], v[184:199]
    v_mfma_f32_32x32x16_bf16 v[200:215], a[220:223], v[124:127], v[200:215]
    s_nop 15
    s_nop 1
    v_cvt_pk_bf16_f32 v216, v184, v185
    v_cvt_pk_bf16_f32 v217, v186, v187
    v_cvt_pk_bf16_f32 v218, v188, v189
    v_cvt_pk_bf16_f32 v219, v190, v191
    v_cvt_pk_bf16_f32 v220, v192, v193
    v_cvt_pk_bf16_f32 v221, v194, v195
    v_cvt_pk_bf16_f32 v222, v196, v197
    v_cvt_pk_bf16_f32 v223, v198, v199
    v_cvt_pk_bf16_f32 v224, v200, v201
    v_cvt_pk_bf16_f32 v225, v202, v203
    v_cvt_pk_bf16_f32 v226, v204, v205
    v_cvt_pk_bf16_f32 v227, v206, v207
    v_cvt_pk_bf16_f32 v228, v208, v209
    v_cvt_pk_bf16_f32 v229, v210, v211
    v_cvt_pk_bf16_f32 v230, v212, v213
    v_cvt_pk_bf16_f32 v231, v214, v215
    buffer_store_dwordx4 v[216:219], v6, s[52:55], s37 offen offset:0 sc1
    buffer_store_dwordx4 v[220:223], v6, s[52:55], s37 offen offset:256 sc1
    buffer_store_dwordx4 v[224:227], v6, s[52:55], s37 offen offset:512 sc1
    buffer_store_dwordx4 v[228:231], v6, s[52:55], s37 offen offset:768 sc1
    s_add_u32 s37, s37, 1835008
    s_add_u32 s39, s36, 0
    buffer_load_dwordx4 v[72:75], v5, s[48:51], s39 offen offset:0
    buffer_load_dwordx4 v[76:79], v5, s[48:51], s39 offen offset:1024
    buffer_load_dwordx4 v[80:83], v5, s[48:51], s39 offen offset:2048
    buffer_load_dwordx4 v[84:87], v5, s[48:51], s39 offen offset:3072
    s_add_u32 s39, s36, 4096
    buffer_load_dwordx4 v[88:91], v5, s[48:51], s39 offen offset:0
    buffer_load_dwordx4 v[92:95], v5, s[48:51], s39 offen offset:1024
    buffer_load_dwordx4 v[96:99], v5, s[48:51], s39 offen offset:2048
    buffer_load_dwordx4 v[100:103], v5, s[48:51], s39 offen offset:3072
    s_add_u32 s39, s36, 8192
    buffer_load_dwordx4 v[104:107], v5, s[48:51], s39 offen offset:0
    buffer_load_dwordx4 v[108:111], v5, s[48:51], s39 offen offset:1024
    buffer_load_dwordx4 v[112:115], v5, s[48:51], s39 offen offset:2048
    buffer_load_dwordx4 v[116:119], v5, s[48:51], s39 offen offset:3072
    s_add_u32 s39, s36, 12288
    buffer_load_dwordx4 v[120:123], v5, s[48:51], s39 offen offset:0
    buffer_load_dwordx4 v[124:127], v5, s[48:51], s39 offen offset:1024
    s_waitcnt vmcnt(28)
    v_mfma_f32_32x32x16_bf16 v[184:199], a[0:3], v[128:131], 0
    v_mfma_f32_32x32x16_bf16 v[200:215], a[112:115], v[128:131], 0
    v_mfma_f32_32x32x16_bf16 v[184:199], a[4:7], v[132:135], v[184:199]
    v_mfma_f32_32x32x16_bf16 v[200:215], a[116:119], v[132:135], v[200:215]
    v_mfma_f32_32x32x16_bf16 v[184:199], a[8:11], v[136:139], v[184:199]
    v_mfma_f32_32x32x16_bf16 v[200:215], a[120:123], v[136:139], v[200:215]
    v_mfma_f32_32x32x16_bf16 v[184:199], a[12:15], v[140:143], v[184:199]
    v_mfma_f32_32x32x16_bf16 v[200:215], a[124:127], v[140:143], v[200:215]
    v_mfma_f32_32x32x16_bf16 v[184:199], a[16:19], v[144:147], v[184:199]
    v_mfma_f32_32x32x16_bf16 v[200:215], a[128:131], v[144:147], v[200:215]
    v_mfma_f32_32x32x16_bf16 v[184:199], a[20:23], v[148:151], v[184:199]
    v_mfma_f32_32x32x16_bf16 v[200:215], a[132:135], v[148:151], v[200:215]
    v_mfma_f32_32x32x16_bf16 v[184:199], a[24:27], v[152:155], v[184:199]
    v_mfma_f32_32x32x16_bf16 v[200:215], a[136:139], v[152:155], v[200:215]
    v_mfma_f32_32x32x16_bf16 v[184:199], a[28:31], v[156:159], v[184:199]
    v_mfma_f32_32x32x16_bf16 v[200:215], a[140:143], v[156:159], v[200:215]
    v_mfma_f32_32x32x16_bf16 v[184:199], a[32:35], v[160:163], v[184:199]
    v_mfma_f32_32x32x16_bf16 v[200:215], a[144:147], v[160:163], v[200:215]
    v_mfma_f32_32x32x16_bf16 v[184:199], a[36:39], v[164:167], v[184:199]
    v_mfma_f32_32x32x16_bf16 v[200:215], a[148:151], v[164:167], v[200:215]
    v_mfma_f32_32x32x16_bf16 v[184:199], a[40:43], v[168:171], v[184:199]
    v_mfma_f32_32x32x16_bf16 v[200:215], a[152:155], v[168:171], v[200:215]
    v_mfma_f32_32x32x16_bf16 v[184:199], a[44:47], v[172:175], v[184:199]
    v_mfma_f32_32x32x16_bf16 v[200:215], a[156:159], v[172:175], v[200:215]
    v_mfma_f32_32x32x16_bf16 v[184:199], a[48:51], v[176:179], v[184:199]
    v_mfma_f32_32x32x16_bf16 v[200:215], a[160:163], v[176:179], v[200:215]
    v_mfma_f32_32x32x16_bf16 v[184:199], a[52:55], v[180:183], v[184:199]
    v_mfma_f32_32x32x16_bf16 v[200:215], a[164:167], v[180:183], v[200:215]
    s_add_u32 s39, s36, 12288
    buffer_load_dwordx4 v[128:131], v5, s[48:51], s39 offen offset:2048
    buffer_load_dwordx4 v[132:135], v5, s[48:51], s39 offen offset:3072
    s_add_u32 s39, s36, 16384
    buffer_load_dwordx4 v[136:139], v5, s[48:51], s39 offen offset:0
    buffer_load_dwordx4 v[140:143], v5, s[48:51], s39 offen offset:1024
    buffer_load_dwordx4 v[144:147], v5, s[48:51], s39 offen offset:2048
    buffer_load_dwordx4 v[148:151], v5, s[48:51], s39 offen offset:3072
    s_add_u32 s39, s36, 20480
    buffer_load_dwordx4 v[152:155], v5, s[48:51], s39 offen offset:0
    buffer_load_dwordx4 v[156:159], v5, s[48:51], s39 offen offset:1024
    buffer_load_dwordx4 v[160:163], v5, s[48:51], s39 offen offset:2048
    buffer_load_dwordx4 v[164:167], v5, s[48:51], s39 offen offset:3072
    s_add_u32 s39, s36, 24576
    buffer_load_dwordx4 v[168:171], v5, s[48:51], s39 offen offset:0
    buffer_load_dwordx4 v[172:175], v5, s[48:51], s39 offen offset:1024
    buffer_load_dwordx4 v[176:179], v5, s[48:51], s39 offen offset:2048
    buffer_load_dwordx4 v[180:183], v5, s[48:51], s39 offen offset:3072
    s_add_u32 s36, s36, 114688
    s_waitcnt vmcnt(28)
    s_barrier
    v_mov_b32 v13, 0
    s_lshl_b32 s22, s100, 2
    s_add_u32 s22, s22, 5120
    v_cmp_eq_u32 vcc, 0, v0
    s_and_b64 exec, exec, vcc
    buffer_store_dword v13, v13, s[96:99], s22 offen offset:0 sc1
    s_mov_b64 exec, -1
    v_mfma_f32_32x32x16_bf16 v[184:199], a[56:59], v[16:19], v[184:199]
    v_mfma_f32_32x32x16_bf16 v[200:215], a[168:171], v[16:19], v[200:215]
    v_mfma_f32_32x32x16_bf16 v[184:199], a[60:63], v[20:23], v[184:199]
    v_mfma_f32_32x32x16_bf16 v[200:215], a[172:175], v[20:23], v[200:215]
    v_mfma_f32_32x32x16_bf16 v[184:199], a[64:67], v[24:27], v[184:199]
    v_mfma_f32_32x32x16_bf16 v[200:215], a[176:179], v[24:27], v[200:215]
    v_mfma_f32_32x32x16_bf16 v[184:199], a[68:71], v[28:31], v[184:199]
    v_mfma_f32_32x32x16_bf16 v[200:215], a[180:183], v[28:31], v[200:215]
    v_mfma_f32_32x32x16_bf16 v[184:199], a[72:75], v[32:35], v[184:199]
    v_mfma_f32_32x32x16_bf16 v[200:215], a[184:187], v[32:35], v[200:215]
    v_mfma_f32_32x32x16_bf16 v[184:199], a[76:79], v[36:39], v[184:199]
    v_mfma_f32_32x32x16_bf16 v[200:215], a[188:191], v[36:39], v[200:215]
    v_mfma_f32_32x32x16_bf16 v[184:199], a[80:83], v[40:43], v[184:199]
    v_mfma_f32_32x32x16_bf16 v[200:215], a[192:195], v[40:43], v[200:215]
    v_mfma_f32_32x32x16_bf16 v[184:199], a[84:87], v[44:47], v[184:199]
    v_mfma_f32_32x32x16_bf16 v[200:215], a[196:199], v[44:47], v[200:215]
    v_mfma_f32_32x32x16_bf16 v[184:199], a[88:91], v[48:51], v[184:199]
    v_mfma_f32_32x32x16_bf16 v[200:215], a[200:203], v[48:51], v[200:215]
    v_mfma_f32_32x32x16_bf16 v[184:199], a[92:95], v[52:55], v[184:199]
    v_mfma_f32_32x32x16_bf16 v[200:215], a[204:207], v[52:55], v[200:215]
    v_mfma_f32_32x32x16_bf16 v[184:199], a[96:99], v[56:59], v[184:199]
    v_mfma_f32_32x32x16_bf16 v[200:215], a[208:211], v[56:59], v[200:215]
    v_mfma_f32_32x32x16_bf16 v[184:199], a[100:103], v[60:63], v[184:199]
    v_mfma_f32_32x32x16_bf16 v[200:215], a[212:215], v[60:63], v[200:215]
    v_mfma_f32_32x32x16_bf16 v[184:199], a[104:107], v[64:67], v[184:199]
    v_mfma_f32_32x32x16_bf16 v[200:215], a[216:219], v[64:67], v[200:215]
    v_mfma_f32_32x32x16_bf16 v[184:199], a[108:111], v[68:71], v[184:199]
    v_mfma_f32_32x32x16_bf16 v[200:215], a[220:223], v[68:71], v[200:215]
    s_nop 15
    s_nop 1
    v_cvt_pk_bf16_f32 v216, v184, v185
    v_cvt_pk_bf16_f32 v217, v186, v187
    v_cvt_pk_bf16_f32 v218, v188, v189
    v_cvt_pk_bf16_f32 v219, v190, v191
    v_cvt_pk_bf16_f32 v220, v192, v193
    v_cvt_pk_bf16_f32 v221, v194, v195
    v_cvt_pk_bf16_f32 v222, v196, v197
    v_cvt_pk_bf16_f32 v223, v198, v199
    v_cvt_pk_bf16_f32 v224, v200, v201
    v_cvt_pk_bf16_f32 v225, v202, v203
    v_cvt_pk_bf16_f32 v226, v204, v205
    v_cvt_pk_bf16_f32 v227, v206, v207
    v_cvt_pk_bf16_f32 v228, v208, v209
    v_cvt_pk_bf16_f32 v229, v210, v211
    v_cvt_pk_bf16_f32 v230, v212, v213
    v_cvt_pk_bf16_f32 v231, v214, v215
    buffer_store_dwordx4 v[216:219], v6, s[52:55], s37 offen offset:0 sc1
    buffer_store_dwordx4 v[220:223], v6, s[52:55], s37 offen offset:256 sc1
    buffer_store_dwordx4 v[224:227], v6, s[52:55], s37 offen offset:512 sc1
    buffer_store_dwordx4 v[228:231], v6, s[52:55], s37 offen offset:768 sc1
    s_add_u32 s37, s37, 1835008
    s_add_u32 s39, s36, 0
    buffer_load_dwordx4 v[16:19], v5, s[48:51], s39 offen offset:0
    buffer_load_dwordx4 v[20:23], v5, s[48:51], s39 offen offset:1024
    buffer_load_dwordx4 v[24:27], v5, s[48:51], s39 offen offset:2048
    buffer_load_dwordx4 v[28:31], v5, s[48:51], s39 offen offset:3072
    s_add_u32 s39, s36, 4096
    buffer_load_dwordx4 v[32:35], v5, s[48:51], s39 offen offset:0
    buffer_load_dwordx4 v[36:39], v5, s[48:51], s39 offen offset:1024
    buffer_load_dwordx4 v[40:43], v5, s[48:51], s39 offen offset:2048
    buffer_load_dwordx4 v[44:47], v5, s[48:51], s39 offen offset:3072
    s_add_u32 s39, s36, 8192
    buffer_load_dwordx4 v[48:51], v5, s[48:51], s39 offen offset:0
    buffer_load_dwordx4 v[52:55], v5, s[48:51], s39 offen offset:1024
    buffer_load_dwordx4 v[56:59], v5, s[48:51], s39 offen offset:2048
    buffer_load_dwordx4 v[60:63], v5, s[48:51], s39 offen offset:3072
    s_add_u32 s39, s36, 12288
    buffer_load_dwordx4 v[64:67], v5, s[48:51], s39 offen offset:0
    buffer_load_dwordx4 v[68:71], v5, s[48:51], s39 offen offset:1024
    s_waitcnt vmcnt(28)
    v_mfma_f32_32x32x16_bf16 v[184:199], a[0:3], v[72:75], 0
    v_mfma_f32_32x32x16_bf16 v[200:215], a[112:115], v[72:75], 0
    v_mfma_f32_32x32x16_bf16 v[184:199], a[4:7], v[76:79], v[184:199]
    v_mfma_f32_32x32x16_bf16 v[200:215], a[116:119], v[76:79], v[200:215]
    v_mfma_f32_32x32x16_bf16 v[184:199], a[8:11], v[80:83], v[184:199]
    v_mfma_f32_32x32x16_bf16 v[200:215], a[120:123], v[80:83], v[200:215]
    v_mfma_f32_32x32x16_bf16 v[184:199], a[12:15], v[84:87], v[184:199]
    v_mfma_f32_32x32x16_bf16 v[200:215], a[124:127], v[84:87], v[200:215]
    v_mfma_f32_32x32x16_bf16 v[184:199], a[16:19], v[88:91], v[184:199]
    v_mfma_f32_32x32x16_bf16 v[200:215], a[128:131], v[88:91], v[200:215]
    v_mfma_f32_32x32x16_bf16 v[184:199], a[20:23], v[92:95], v[184:199]
    v_mfma_f32_32x32x16_bf16 v[200:215], a[132:135], v[92:95], v[200:215]
    v_mfma_f32_32x32x16_bf16 v[184:199], a[24:27], v[96:99], v[184:199]
    v_mfma_f32_32x32x16_bf16 v[200:215], a[136:139], v[96:99], v[200:215]
    v_mfma_f32_32x32x16_bf16 v[184:199], a[28:31], v[100:103], v[184:199]
    v_mfma_f32_32x32x16_bf16 v[200:215], a[140:143], v[100:103], v[200:215]
    v_mfma_f32_32x32x16_bf16 v[184:199], a[32:35], v[104:107], v[184:199]
    v_mfma_f32_32x32x16_bf16 v[200:215], a[144:147], v[104:107], v[200:215]
    v_mfma_f32_32x32x16_bf16 v[184:199], a[36:39], v[108:111], v[184:199]
    v_mfma_f32_32x32x16_bf16 v[200:215], a[148:151], v[108:111], v[200:215]
    v_mfma_f32_32x32x16_bf16 v[184:199], a[40:43], v[112:115], v[184:199]
    v_mfma_f32_32x32x16_bf16 v[200:215], a[152:155], v[112:115], v[200:215]
    v_mfma_f32_32x32x16_bf16 v[184:199], a[44:47], v[116:119], v[184:199]
    v_mfma_f32_32x32x16_bf16 v[200:215], a[156:159], v[116:119], v[200:215]
    v_mfma_f32_32x32x16_bf16 v[184:199], a[48:51], v[120:123], v[184:199]
    v_mfma_f32_32x32x16_bf16 v[200:215], a[160:163], v[120:123], v[200:215]
    v_mfma_f32_32x32x16_bf16 v[184:199], a[52:55], v[124:127], v[184:199]
    v_mfma_f32_32x32x16_bf16 v[200:215], a[164:167], v[124:127], v[200:215]
    s_add_u32 s39, s36, 12288
    buffer_load_dwordx4 v[72:75], v5, s[48:51], s39 offen offset:2048
    buffer_load_dwordx4 v[76:79], v5, s[48:51], s39 offen offset:3072
    s_add_u32 s39, s36, 16384
    buffer_load_dwordx4 v[80:83], v5, s[48:51], s39 offen offset:0
    buffer_load_dwordx4 v[84:87], v5, s[48:51], s39 offen offset:1024
    buffer_load_dwordx4 v[88:91], v5, s[48:51], s39 offen offset:2048
    buffer_load_dwordx4 v[92:95], v5, s[48:51], s39 offen offset:3072
    s_add_u32 s39, s36, 20480
    buffer_load_dwordx4 v[96:99], v5, s[48:51], s39 offen offset:0
    buffer_load_dwordx4 v[100:103], v5, s[48:51], s39 offen offset:1024
    buffer_load_dwordx4 v[104:107], v5, s[48:51], s39 offen offset:2048
    buffer_load_dwordx4 v[108:111], v5, s[48:51], s39 offen offset:3072
    s_add_u32 s39, s36, 24576
    buffer_load_dwordx4 v[112:115], v5, s[48:51], s39 offen offset:0
    buffer_load_dwordx4 v[116:119], v5, s[48:51], s39 offen offset:1024
    buffer_load_dwordx4 v[120:123], v5, s[48:51], s39 offen offset:2048
    buffer_load_dwordx4 v[124:127], v5, s[48:51], s39 offen offset:3072
    s_add_u32 s36, s36, 114688
    s_waitcnt vmcnt(28)
    v_mfma_f32_32x32x16_bf16 v[184:199], a[56:59], v[128:131], v[184:199]
    v_mfma_f32_32x32x16_bf16 v[200:215], a[168:171], v[128:131], v[200:215]
    v_mfma_f32_32x32x16_bf16 v[184:199], a[60:63], v[132:135], v[184:199]
    v_mfma_f32_32x32x16_bf16 v[200:215], a[172:175], v[132:135], v[200:215]
    v_mfma_f32_32x32x16_bf16 v[184:199], a[64:67], v[136:139], v[184:199]
    v_mfma_f32_32x32x16_bf16 v[200:215], a[176:179], v[136:139], v[200:215]
    v_mfma_f32_32x32x16_bf16 v[184:199], a[68:71], v[140:143], v[184:199]
    v_mfma_f32_32x32x16_bf16 v[200:215], a[180:183], v[140:143], v[200:215]
    v_mfma_f32_32x32x16_bf16 v[184:199], a[72:75], v[144:147], v[184:199]
    v_mfma_f32_32x32x16_bf16 v[200:215], a[184:187], v[144:147], v[200:215]
    v_mfma_f32_32x32x16_bf16 v[184:199], a[76:79], v[148:151], v[184:199]
    v_mfma_f32_32x32x16_bf16 v[200:215], a[188:191], v[148:151], v[200:215]
    v_mfma_f32_32x32x16_bf16 v[184:199], a[80:83], v[152:155], v[184:199]
    v_mfma_f32_32x32x16_bf16 v[200:215], a[192:195], v[152:155], v[200:215]
    v_mfma_f32_32x32x16_bf16 v[184:199], a[84:87], v[156:159], v[184:199]
    v_mfma_f32_32x32x16_bf16 v[200:215], a[196:199], v[156:159], v[200:215]
    v_mfma_f32_32x32x16_bf16 v[184:199], a[88:91], v[160:163], v[184:199]
    v_mfma_f32_32x32x16_bf16 v[200:215], a[200:203], v[160:163], v[200:215]
    v_mfma_f32_32x32x16_bf16 v[184:199], a[92:95], v[164:167], v[184:199]
    v_mfma_f32_32x32x16_bf16 v[200:215], a[204:207], v[164:167], v[200:215]
    v_mfma_f32_32x32x16_bf16 v[184:199], a[96:99], v[168:171], v[184:199]
    v_mfma_f32_32x32x16_bf16 v[200:215], a[208:211], v[168:171], v[200:215]
    v_mfma_f32_32x32x16_bf16 v[184:199], a[100:103], v[172:175], v[184:199]
    v_mfma_f32_32x32x16_bf16 v[200:215], a[212:215], v[172:175], v[200:215]
    v_mfma_f32_32x32x16_bf16 v[184:199], a[104:107], v[176:179], v[184:199]
    v_mfma_f32_32x32x16_bf16 v[200:215], a[216:219], v[176:179], v[200:215]
    v_mfma_f32_32x32x16_bf16 v[184:199], a[108:111], v[180:183], v[184:199]
    v_mfma_f32_32x32x16_bf16 v[200:215], a[220:223], v[180:183], v[200:215]
    s_nop 15
    s_nop 1
    v_cvt_pk_bf16_f32 v216, v184, v185
    v_cvt_pk_bf16_f32 v217, v186, v187
    v_cvt_pk_bf16_f32 v218, v188, v189
    v_cvt_pk_bf16_f32 v219, v190, v191
    v_cvt_pk_bf16_f32 v220, v192, v193
    v_cvt_pk_bf16_f32 v221, v194, v195
    v_cvt_pk_bf16_f32 v222, v196, v197
    v_cvt_pk_bf16_f32 v223, v198, v199
    v_cvt_pk_bf16_f32 v224, v200, v201
    v_cvt_pk_bf16_f32 v225, v202, v203
    v_cvt_pk_bf16_f32 v226, v204, v205
    v_cvt_pk_bf16_f32 v227, v206, v207
    v_cvt_pk_bf16_f32 v228, v208, v209
    v_cvt_pk_bf16_f32 v229, v210, v211
    v_cvt_pk_bf16_f32 v230, v212, v213
    v_cvt_pk_bf16_f32 v231, v214, v215
    buffer_store_dwordx4 v[216:219], v6, s[52:55], s37 offen offset:0 sc1
    buffer_store_dwordx4 v[220:223], v6, s[52:55], s37 offen offset:256 sc1
    buffer_store_dwordx4 v[224:227], v6, s[52:55], s37 offen offset:512 sc1
    buffer_store_dwordx4 v[228:231], v6, s[52:55], s37 offen offset:768 sc1
    s_add_u32 s37, s37, 1835008
    s_add_u32 s39, s36, 0
    buffer_load_dwordx4 v[128:131], v5, s[48:51], s39 offen offset:0
    buffer_load_dwordx4 v[132:135], v5, s[48:51], s39 offen offset:1024
    buffer_load_dwordx4 v[136:139], v5, s[48:51], s39 offen offset:2048
    buffer_load_dwordx4 v[140:143], v5, s[48:51], s39 offen offset:3072
    s_add_u32 s39, s36, 4096
    buffer_load_dwordx4 v[144:147], v5, s[48:51], s39 offen offset:0
    buffer_load_dwordx4 v[148:151], v5, s[48:51], s39 offen offset:1024
    buffer_load_dwordx4 v[152:155], v5, s[48:51], s39 offen offset:2048
    buffer_load_dwordx4 v[156:159], v5, s[48:51], s39 offen offset:3072
    s_add_u32 s39, s36, 8192
    buffer_load_dwordx4 v[160:163], v5, s[48:51], s39 offen offset:0
    buffer_load_dwordx4 v[164:167], v5, s[48:51], s39 offen offset:1024
    buffer_load_dwordx4 v[168:171], v5, s[48:51], s39 offen offset:2048
    buffer_load_dwordx4 v[172:175], v5, s[48:51], s39 offen offset:3072
    s_add_u32 s39, s36, 12288
    buffer_load_dwordx4 v[176:179], v5, s[48:51], s39 offen offset:0
    buffer_load_dwordx4 v[180:183], v5, s[48:51], s39 offen offset:1024
    s_waitcnt vmcnt(28)
    v_mfma_f32_32x32x16_bf16 v[184:199], a[0:3], v[16:19], 0
    v_mfma_f32_32x32x16_bf16 v[200:215], a[112:115], v[16:19], 0
    v_mfma_f32_32x32x16_bf16 v[184:199], a[4:7], v[20:23], v[184:199]
    v_mfma_f32_32x32x16_bf16 v[200:215], a[116:119], v[20:23], v[200:215]
    v_mfma_f32_32x32x16_bf16 v[184:199], a[8:11], v[24:27], v[184:199]
    v_mfma_f32_32x32x16_bf16 v[200:215], a[120:123], v[24:27], v[200:215]
    v_mfma_f32_32x32x16_bf16 v[184:199], a[12:15], v[28:31], v[184:199]
    v_mfma_f32_32x32x16_bf16 v[200:215], a[124:127], v[28:31], v[200:215]
    v_mfma_f32_32x32x16_bf16 v[184:199], a[16:19], v[32:35], v[184:199]
    v_mfma_f32_32x32x16_bf16 v[200:215], a[128:131], v[32:35], v[200:215]
    v_mfma_f32_32x32x16_bf16 v[184:199], a[20:23], v[36:39], v[184:199]
    v_mfma_f32_32x32x16_bf16 v[200:215], a[132:135], v[36:39], v[200:215]
    v_mfma_f32_32x32x16_bf16 v[184:199], a[24:27], v[40:43], v[184:199]
    v_mfma_f32_32x32x16_bf16 v[200:215], a[136:139], v[40:43], v[200:215]
    v_mfma_f32_32x32x16_bf16 v[184:199], a[28:31], v[44:47], v[184:199]
    v_mfma_f32_32x32x16_bf16 v[200:215], a[140:143], v[44:47], v[200:215]
    v_mfma_f32_32x32x16_bf16 v[184:199], a[32:35], v[48:51], v[184:199]
    v_mfma_f32_32x32x16_bf16 v[200:215], a[144:147], v[48:51], v[200:215]
    v_mfma_f32_32x32x16_bf16 v[184:199], a[36:39], v[52:55], v[184:199]
    v_mfma_f32_32x32x16_bf16 v[200:215], a[148:151], v[52:55], v[200:215]
    v_mfma_f32_32x32x16_bf16 v[184:199], a[40:43], v[56:59], v[184:199]
    v_mfma_f32_32x32x16_bf16 v[200:215], a[152:155], v[56:59], v[200:215]
    v_mfma_f32_32x32x16_bf16 v[184:199], a[44:47], v[60:63], v[184:199]
    v_mfma_f32_32x32x16_bf16 v[200:215], a[156:159], v[60:63], v[200:215]
    v_mfma_f32_32x32x16_bf16 v[184:199], a[48:51], v[64:67], v[184:199]
    v_mfma_f32_32x32x16_bf16 v[200:215], a[160:163], v[64:67], v[200:215]
    v_mfma_f32_32x32x16_bf16 v[184:199], a[52:55], v[68:71], v[184:199]
    v_mfma_f32_32x32x16_bf16 v[200:215], a[164:167], v[68:71], v[200:215]
    s_add_u32 s39, s36, 12288
    buffer_load_dwordx4 v[16:19], v5, s[48:51], s39 offen offset:2048
    buffer_load_dwordx4 v[20:23], v5, s[48:51], s39 offen offset:3072
    s_add_u32 s39, s36, 16384
    buffer_load_dwordx4 v[24:27], v5, s[48:51], s39 offen offset:0
    buffer_load_dwordx4 v[28:31], v5, s[48:51], s39 offen offset:1024
    buffer_load_dwordx4 v[32:35], v5, s[48:51], s39 offen offset:2048
    buffer_load_dwordx4 v[36:39], v5, s[48:51], s39 offen offset:3072
    s_add_u32 s39, s36, 20480
    buffer_load_dwordx4 v[40:43], v5, s[48:51], s39 offen offset:0
    buffer_load_dwordx4 v[44:47], v5, s[48:51], s39 offen offset:1024
    buffer_load_dwordx4 v[48:51], v5, s[48:51], s39 offen offset:2048
    buffer_load_dwordx4 v[52:55], v5, s[48:51], s39 offen offset:3072
    s_add_u32 s39, s36, 24576
    buffer_load_dwordx4 v[56:59], v5, s[48:51], s39 offen offset:0
    buffer_load_dwordx4 v[60:63], v5, s[48:51], s39 offen offset:1024
    buffer_load_dwordx4 v[64:67], v5, s[48:51], s39 offen offset:2048
    buffer_load_dwordx4 v[68:71], v5, s[48:51], s39 offen offset:3072
    s_add_u32 s36, s36, 114688
    s_waitcnt vmcnt(28)
    s_barrier
    v_mov_b32 v13, 0
    s_lshl_b32 s22, s100, 2
    s_add_u32 s22, s22, 6144
    v_cmp_eq_u32 vcc, 0, v0
    s_and_b64 exec, exec, vcc
    buffer_store_dword v13, v13, s[96:99], s22 offen offset:0 sc1
    s_mov_b64 exec, -1
    v_mfma_f32_32x32x16_bf16 v[184:199], a[56:59], v[72:75], v[184:199]
    v_mfma_f32_32x32x16_bf16 v[200:215], a[168:171], v[72:75], v[200:215]
    v_mfma_f32_32x32x16_bf16 v[184:199], a[60:63], v[76:79], v[184:199]
    v_mfma_f32_32x32x16_bf16 v[200:215], a[172:175], v[76:79], v[200:215]
    v_mfma_f32_32x32x16_bf16 v[184:199], a[64:67], v[80:83], v[184:199]
    v_mfma_f32_32x32x16_bf16 v[200:215], a[176:179], v[80:83], v[200:215]
    v_mfma_f32_32x32x16_bf16 v[184:199], a[68:71], v[84:87], v[184:199]
    v_mfma_f32_32x32x16_bf16 v[200:215], a[180:183], v[84:87], v[200:215]
    v_mfma_f32_32x32x16_bf16 v[184:199], a[72:75], v[88:91], v[184:199]
    v_mfma_f32_32x32x16_bf16 v[200:215], a[184:187], v[88:91], v[200:215]
    v_mfma_f32_32x32x16_bf16 v[184:199], a[76:79], v[92:95], v[184:199]
    v_mfma_f32_32x32x16_bf16 v[200:215], a[188:191], v[92:95], v[200:215]
    v_mfma_f32_32x32x16_bf16 v[184:199], a[80:83], v[96:99], v[184:199]
    v_mfma_f32_32x32x16_bf16 v[200:215], a[192:195], v[96:99], v[200:215]
    v_mfma_f32_32x32x16_bf16 v[184:199], a[84:87], v[100:103], v[184:199]
    v_mfma_f32_32x32x16_bf16 v[200:215], a[196:199], v[100:103], v[200:215]
    v_mfma_f32_32x32x16_bf16 v[184:199], a[88:91], v[104:107], v[184:199]
    v_mfma_f32_32x32x16_bf16 v[200:215], a[200:203], v[104:107], v[200:215]
    v_mfma_f32_32x32x16_bf16 v[184:199], a[92:95], v[108:111], v[184:199]
    v_mfma_f32_32x32x16_bf16 v[200:215], a[204:207], v[108:111], v[200:215]
    v_mfma_f32_32x32x16_bf16 v[184:199], a[96:99], v[112:115], v[184:199]
    v_mfma_f32_32x32x16_bf16 v[200:215], a[208:211], v[112:115], v[200:215]
    v_mfma_f32_32x32x16_bf16 v[184:199], a[100:103], v[116:119], v[184:199]
    v_mfma_f32_32x32x16_bf16 v[200:215], a[212:215], v[116:119], v[200:215]
    v_mfma_f32_32x32x16_bf16 v[184:199], a[104:107], v[120:123], v[184:199]
    v_mfma_f32_32x32x16_bf16 v[200:215], a[216:219], v[120:123], v[200:215]
    v_mfma_f32_32x32x16_bf16 v[184:199], a[108:111], v[124:127], v[184:199]
    v_mfma_f32_32x32x16_bf16 v[200:215], a[220:223], v[124:127], v[200:215]
    s_nop 15
    s_nop 1
    v_cvt_pk_bf16_f32 v216, v184, v185
    v_cvt_pk_bf16_f32 v217, v186, v187
    v_cvt_pk_bf16_f32 v218, v188, v189
    v_cvt_pk_bf16_f32 v219, v190, v191
    v_cvt_pk_bf16_f32 v220, v192, v193
    v_cvt_pk_bf16_f32 v221, v194, v195
    v_cvt_pk_bf16_f32 v222, v196, v197
    v_cvt_pk_bf16_f32 v223, v198, v199
    v_cvt_pk_bf16_f32 v224, v200, v201
    v_cvt_pk_bf16_f32 v225, v202, v203
    v_cvt_pk_bf16_f32 v226, v204, v205
    v_cvt_pk_bf16_f32 v227, v206, v207
    v_cvt_pk_bf16_f32 v228, v208, v209
    v_cvt_pk_bf16_f32 v229, v210, v211
    v_cvt_pk_bf16_f32 v230, v212, v213
    v_cvt_pk_bf16_f32 v231, v214, v215
    buffer_store_dwordx4 v[216:219], v6, s[52:55], s37 offen offset:0 sc1
    buffer_store_dwordx4 v[220:223], v6, s[52:55], s37 offen offset:256 sc1
    buffer_store_dwordx4 v[224:227], v6, s[52:55], s37 offen offset:512 sc1
    buffer_store_dwordx4 v[228:231], v6, s[52:55], s37 offen offset:768 sc1
    s_add_u32 s37, s37, 1835008
    s_add_u32 s39, s36, 0
    buffer_load_dwordx4 v[72:75], v5, s[48:51], s39 offen offset:0
    buffer_load_dwordx4 v[76:79], v5, s[48:51], s39 offen offset:1024
    buffer_load_dwordx4 v[80:83], v5, s[48:51], s39 offen offset:2048
    buffer_load_dwordx4 v[84:87], v5, s[48:51], s39 offen offset:3072
    s_add_u32 s39, s36, 4096
    buffer_load_dwordx4 v[88:91], v5, s[48:51], s39 offen offset:0
    buffer_load_dwordx4 v[92:95], v5, s[48:51], s39 offen offset:1024
    buffer_load_dwordx4 v[96:99], v5, s[48:51], s39 offen offset:2048
    buffer_load_dwordx4 v[100:103], v5, s[48:51], s39 offen offset:3072
    s_add_u32 s39, s36, 8192
    buffer_load_dwordx4 v[104:107], v5, s[48:51], s39 offen offset:0
    buffer_load_dwordx4 v[108:111], v5, s[48:51], s39 offen offset:1024
    buffer_load_dwordx4 v[112:115], v5, s[48:51], s39 offen offset:2048
    buffer_load_dwordx4 v[116:119], v5, s[48:51], s39 offen offset:3072
    s_add_u32 s39, s36, 12288
    buffer_load_dwordx4 v[120:123], v5, s[48:51], s39 offen offset:0
    buffer_load_dwordx4 v[124:127], v5, s[48:51], s39 offen offset:1024
    s_waitcnt vmcnt(28)
    v_mfma_f32_32x32x16_bf16 v[184:199], a[0:3], v[128:131], 0
    v_mfma_f32_32x32x16_bf16 v[200:215], a[112:115], v[128:131], 0
    v_mfma_f32_32x32x16_bf16 v[184:199], a[4:7], v[132:135], v[184:199]
    v_mfma_f32_32x32x16_bf16 v[200:215], a[116:119], v[132:135], v[200:215]
    v_mfma_f32_32x32x16_bf16 v[184:199], a[8:11], v[136:139], v[184:199]
    v_mfma_f32_32x32x16_bf16 v[200:215], a[120:123], v[136:139], v[200:215]
    v_mfma_f32_32x32x16_bf16 v[184:199], a[12:15], v[140:143], v[184:199]
    v_mfma_f32_32x32x16_bf16 v[200:215], a[124:127], v[140:143], v[200:215]
    v_mfma_f32_32x32x16_bf16 v[184:199], a[16:19], v[144:147], v[184:199]
    v_mfma_f32_32x32x16_bf16 v[200:215], a[128:131], v[144:147], v[200:215]
    v_mfma_f32_32x32x16_bf16 v[184:199], a[20:23], v[148:151], v[184:199]
    v_mfma_f32_32x32x16_bf16 v[200:215], a[132:135], v[148:151], v[200:215]
    v_mfma_f32_32x32x16_bf16 v[184:199], a[24:27], v[152:155], v[184:199]
    v_mfma_f32_32x32x16_bf16 v[200:215], a[136:139], v[152:155], v[200:215]
    v_mfma_f32_32x32x16_bf16 v[184:199], a[28:31], v[156:159], v[184:199]
    v_mfma_f32_32x32x16_bf16 v[200:215], a[140:143], v[156:159], v[200:215]
    v_mfma_f32_32x32x16_bf16 v[184:199], a[32:35], v[160:163], v[184:199]
    v_mfma_f32_32x32x16_bf16 v[200:215], a[144:147], v[160:163], v[200:215]
    v_mfma_f32_32x32x16_bf16 v[184:199], a[36:39], v[164:167], v[184:199]
    v_mfma_f32_32x32x16_bf16 v[200:215], a[148:151], v[164:167], v[200:215]
    v_mfma_f32_32x32x16_bf16 v[184:199], a[40:43], v[168:171], v[184:199]
    v_mfma_f32_32x32x16_bf16 v[200:215], a[152:155], v[168:171], v[200:215]
    v_mfma_f32_32x32x16_bf16 v[184:199], a[44:47], v[172:175], v[184:199]
    v_mfma_f32_32x32x16_bf16 v[200:215], a[156:159], v[172:175], v[200:215]
    v_mfma_f32_32x32x16_bf16 v[184:199], a[48:51], v[176:179], v[184:199]
    v_mfma_f32_32x32x16_bf16 v[200:215], a[160:163], v[176:179], v[200:215]
    v_mfma_f32_32x32x16_bf16 v[184:199], a[52:55], v[180:183], v[184:199]
    v_mfma_f32_32x32x16_bf16 v[200:215], a[164:167], v[180:183], v[200:215]
    s_add_u32 s39, s36, 12288
    buffer_load_dwordx4 v[128:131], v5, s[48:51], s39 offen offset:2048
    buffer_load_dwordx4 v[132:135], v5, s[48:51], s39 offen offset:3072
    s_add_u32 s39, s36, 16384
    buffer_load_dwordx4 v[136:139], v5, s[48:51], s39 offen offset:0
    buffer_load_dwordx4 v[140:143], v5, s[48:51], s39 offen offset:1024
    buffer_load_dwordx4 v[144:147], v5, s[48:51], s39 offen offset:2048
    buffer_load_dwordx4 v[148:151], v5, s[48:51], s39 offen offset:3072
    s_add_u32 s39, s36, 20480
    buffer_load_dwordx4 v[152:155], v5, s[48:51], s39 offen offset:0
    buffer_load_dwordx4 v[156:159], v5, s[48:51], s39 offen offset:1024
    buffer_load_dwordx4 v[160:163], v5, s[48:51], s39 offen offset:2048
    buffer_load_dwordx4 v[164:167], v5, s[48:51], s39 offen offset:3072
    s_add_u32 s39, s36, 24576
    buffer_load_dwordx4 v[168:171], v5, s[48:51], s39 offen offset:0
    buffer_load_dwordx4 v[172:175], v5, s[48:51], s39 offen offset:1024
    buffer_load_dwordx4 v[176:179], v5, s[48:51], s39 offen offset:2048
    buffer_load_dwordx4 v[180:183], v5, s[48:51], s39 offen offset:3072
    s_add_u32 s36, s36, 114688
    s_waitcnt vmcnt(28)
    v_mfma_f32_32x32x16_bf16 v[184:199], a[56:59], v[16:19], v[184:199]
    v_mfma_f32_32x32x16_bf16 v[200:215], a[168:171], v[16:19], v[200:215]
    v_mfma_f32_32x32x16_bf16 v[184:199], a[60:63], v[20:23], v[184:199]
    v_mfma_f32_32x32x16_bf16 v[200:215], a[172:175], v[20:23], v[200:215]
    v_mfma_f32_32x32x16_bf16 v[184:199], a[64:67], v[24:27], v[184:199]
    v_mfma_f32_32x32x16_bf16 v[200:215], a[176:179], v[24:27], v[200:215]
    v_mfma_f32_32x32x16_bf16 v[184:199], a[68:71], v[28:31], v[184:199]
    v_mfma_f32_32x32x16_bf16 v[200:215], a[180:183], v[28:31], v[200:215]
    v_mfma_f32_32x32x16_bf16 v[184:199], a[72:75], v[32:35], v[184:199]
    v_mfma_f32_32x32x16_bf16 v[200:215], a[184:187], v[32:35], v[200:215]
    v_mfma_f32_32x32x16_bf16 v[184:199], a[76:79], v[36:39], v[184:199]
    v_mfma_f32_32x32x16_bf16 v[200:215], a[188:191], v[36:39], v[200:215]
    v_mfma_f32_32x32x16_bf16 v[184:199], a[80:83], v[40:43], v[184:199]
    v_mfma_f32_32x32x16_bf16 v[200:215], a[192:195], v[40:43], v[200:215]
    v_mfma_f32_32x32x16_bf16 v[184:199], a[84:87], v[44:47], v[184:199]
    v_mfma_f32_32x32x16_bf16 v[200:215], a[196:199], v[44:47], v[200:215]
    v_mfma_f32_32x32x16_bf16 v[184:199], a[88:91], v[48:51], v[184:199]
    v_mfma_f32_32x32x16_bf16 v[200:215], a[200:203], v[48:51], v[200:215]
    v_mfma_f32_32x32x16_bf16 v[184:199], a[92:95], v[52:55], v[184:199]
    v_mfma_f32_32x32x16_bf16 v[200:215], a[204:207], v[52:55], v[200:215]
    v_mfma_f32_32x32x16_bf16 v[184:199], a[96:99], v[56:59], v[184:199]
    v_mfma_f32_32x32x16_bf16 v[200:215], a[208:211], v[56:59], v[200:215]
    v_mfma_f32_32x32x16_bf16 v[184:199], a[100:103], v[60:63], v[184:199]
    v_mfma_f32_32x32x16_bf16 v[200:215], a[212:215], v[60:63], v[200:215]
    v_mfma_f32_32x32x16_bf16 v[184:199], a[104:107], v[64:67], v[184:199]
    v_mfma_f32_32x32x16_bf16 v[200:215], a[216:219], v[64:67], v[200:215]
    v_mfma_f32_32x32x16_bf16 v[184:199], a[108:111], v[68:71], v[184:199]
    v_mfma_f32_32x32x16_bf16 v[200:215], a[220:223], v[68:71], v[200:215]
    s_nop 15
    s_nop 1
    v_cvt_pk_bf16_f32 v216, v184, v185
    v_cvt_pk_bf16_f32 v217, v186, v187
    v_cvt_pk_bf16_f32 v218, v188, v189
    v_cvt_pk_bf16_f32 v219, v190, v191
    v_cvt_pk_bf16_f32 v220, v192, v193
    v_cvt_pk_bf16_f32 v221, v194, v195
    v_cvt_pk_bf16_f32 v222, v196, v197
    v_cvt_pk_bf16_f32 v223, v198, v199
    v_cvt_pk_bf16_f32 v224, v200, v201
    v_cvt_pk_bf16_f32 v225, v202, v203
    v_cvt_pk_bf16_f32 v226, v204, v205
    v_cvt_pk_bf16_f32 v227, v206, v207
    v_cvt_pk_bf16_f32 v228, v208, v209
    v_cvt_pk_bf16_f32 v229, v210, v211
    v_cvt_pk_bf16_f32 v230, v212, v213
    v_cvt_pk_bf16_f32 v231, v214, v215
    buffer_store_dwordx4 v[216:219], v6, s[52:55], s37 offen offset:0 sc1
    buffer_store_dwordx4 v[220:223], v6, s[52:55], s37 offen offset:256 sc1
    buffer_store_dwordx4 v[224:227], v6, s[52:55], s37 offen offset:512 sc1
    buffer_store_dwordx4 v[228:231], v6, s[52:55], s37 offen offset:768 sc1
    s_add_u32 s37, s37, 1835008
    s_add_u32 s39, s36, 0
    buffer_load_dwordx4 v[16:19], v5, s[48:51], s39 offen offset:0
    buffer_load_dwordx4 v[20:23], v5, s[48:51], s39 offen offset:1024
    buffer_load_dwordx4 v[24:27], v5, s[48:51], s39 offen offset:2048
    buffer_load_dwordx4 v[28:31], v5, s[48:51], s39 offen offset:3072
    s_add_u32 s39, s36, 4096
    buffer_load_dwordx4 v[32:35], v5, s[48:51], s39 offen offset:0
    buffer_load_dwordx4 v[36:39], v5, s[48:51], s39 offen offset:1024
    buffer_load_dwordx4 v[40:43], v5, s[48:51], s39 offen offset:2048
    buffer_load_dwordx4 v[44:47], v5, s[48:51], s39 offen offset:3072
    s_add_u32 s39, s36, 8192
    buffer_load_dwordx4 v[48:51], v5, s[48:51], s39 offen offset:0
    buffer_load_dwordx4 v[52:55], v5, s[48:51], s39 offen offset:1024
    buffer_load_dwordx4 v[56:59], v5, s[48:51], s39 offen offset:2048
    buffer_load_dwordx4 v[60:63], v5, s[48:51], s39 offen offset:3072
    s_add_u32 s39, s36, 12288
    buffer_load_dwordx4 v[64:67], v5, s[48:51], s39 offen offset:0
    buffer_load_dwordx4 v[68:71], v5, s[48:51], s39 offen offset:1024
    s_waitcnt vmcnt(28)
    v_mfma_f32_32x32x16_bf16 v[184:199], a[0:3], v[72:75], 0
    v_mfma_f32_32x32x16_bf16 v[200:215], a[112:115], v[72:75], 0
    v_mfma_f32_32x32x16_bf16 v[184:199], a[4:7], v[76:79], v[184:199]
    v_mfma_f32_32x32x16_bf16 v[200:215], a[116:119], v[76:79], v[200:215]
    v_mfma_f32_32x32x16_bf16 v[184:199], a[8:11], v[80:83], v[184:199]
    v_mfma_f32_32x32x16_bf16 v[200:215], a[120:123], v[80:83], v[200:215]
    v_mfma_f32_32x32x16_bf16 v[184:199], a[12:15], v[84:87], v[184:199]
    v_mfma_f32_32x32x16_bf16 v[200:215], a[124:127], v[84:87], v[200:215]
    v_mfma_f32_32x32x16_bf16 v[184:199], a[16:19], v[88:91], v[184:199]
    v_mfma_f32_32x32x16_bf16 v[200:215], a[128:131], v[88:91], v[200:215]
    v_mfma_f32_32x32x16_bf16 v[184:199], a[20:23], v[92:95], v[184:199]
    v_mfma_f32_32x32x16_bf16 v[200:215], a[132:135], v[92:95], v[200:215]
    v_mfma_f32_32x32x16_bf16 v[184:199], a[24:27], v[96:99], v[184:199]
    v_mfma_f32_32x32x16_bf16 v[200:215], a[136:139], v[96:99], v[200:215]
    v_mfma_f32_32x32x16_bf16 v[184:199], a[28:31], v[100:103], v[184:199]
    v_mfma_f32_32x32x16_bf16 v[200:215], a[140:143], v[100:103], v[200:215]
    v_mfma_f32_32x32x16_bf16 v[184:199], a[32:35], v[104:107], v[184:199]
    v_mfma_f32_32x32x16_bf16 v[200:215], a[144:147], v[104:107], v[200:215]
    v_mfma_f32_32x32x16_bf16 v[184:199], a[36:39], v[108:111], v[184:199]
    v_mfma_f32_32x32x16_bf16 v[200:215], a[148:151], v[108:111], v[200:215]
    v_mfma_f32_32x32x16_bf16 v[184:199], a[40:43], v[112:115], v[184:199]
    v_mfma_f32_32x32x16_bf16 v[200:215], a[152:155], v[112:115], v[200:215]
    v_mfma_f32_32x32x16_bf16 v[184:199], a[44:47], v[116:119], v[184:199]
    v_mfma_f32_32x32x16_bf16 v[200:215], a[156:159], v[116:119], v[200:215]
    v_mfma_f32_32x32x16_bf16 v[184:199], a[48:51], v[120:123], v[184:199]
    v_mfma_f32_32x32x16_bf16 v[200:215], a[160:163], v[120:123], v[200:215]
    v_mfma_f32_32x32x16_bf16 v[184:199], a[52:55], v[124:127], v[184:199]
    v_mfma_f32_32x32x16_bf16 v[200:215], a[164:167], v[124:127], v[200:215]
    s_add_u32 s39, s36, 12288
    buffer_load_dwordx4 v[72:75], v5, s[48:51], s39 offen offset:2048
    buffer_load_dwordx4 v[76:79], v5, s[48:51], s39 offen offset:3072
    s_add_u32 s39, s36, 16384
    buffer_load_dwordx4 v[80:83], v5, s[48:51], s39 offen offset:0
    buffer_load_dwordx4 v[84:87], v5, s[48:51], s39 offen offset:1024
    buffer_load_dwordx4 v[88:91], v5, s[48:51], s39 offen offset:2048
    buffer_load_dwordx4 v[92:95], v5, s[48:51], s39 offen offset:3072
    s_add_u32 s39, s36, 20480
    buffer_load_dwordx4 v[96:99], v5, s[48:51], s39 offen offset:0
    buffer_load_dwordx4 v[100:103], v5, s[48:51], s39 offen offset:1024
    buffer_load_dwordx4 v[104:107], v5, s[48:51], s39 offen offset:2048
    buffer_load_dwordx4 v[108:111], v5, s[48:51], s39 offen offset:3072
    s_add_u32 s39, s36, 24576
    buffer_load_dwordx4 v[112:115], v5, s[48:51], s39 offen offset:0
    buffer_load_dwordx4 v[116:119], v5, s[48:51], s39 offen offset:1024
    buffer_load_dwordx4 v[120:123], v5, s[48:51], s39 offen offset:2048
    buffer_load_dwordx4 v[124:127], v5, s[48:51], s39 offen offset:3072
    s_add_u32 s36, s36, 114688
    s_waitcnt vmcnt(28)
    s_barrier
    v_mov_b32 v13, 0
    s_lshl_b32 s22, s100, 2
    s_add_u32 s22, s22, 7168
    v_cmp_eq_u32 vcc, 0, v0
    s_and_b64 exec, exec, vcc
    buffer_store_dword v13, v13, s[96:99], s22 offen offset:0 sc1
    s_mov_b64 exec, -1
    v_mfma_f32_32x32x16_bf16 v[184:199], a[56:59], v[128:131], v[184:199]
    v_mfma_f32_32x32x16_bf16 v[200:215], a[168:171], v[128:131], v[200:215]
    v_mfma_f32_32x32x16_bf16 v[184:199], a[60:63], v[132:135], v[184:199]
    v_mfma_f32_32x32x16_bf16 v[200:215], a[172:175], v[132:135], v[200:215]
    v_mfma_f32_32x32x16_bf16 v[184:199], a[64:67], v[136:139], v[184:199]
    v_mfma_f32_32x32x16_bf16 v[200:215], a[176:179], v[136:139], v[200:215]
    v_mfma_f32_32x32x16_bf16 v[184:199], a[68:71], v[140:143], v[184:199]
    v_mfma_f32_32x32x16_bf16 v[200:215], a[180:183], v[140:143], v[200:215]
    v_mfma_f32_32x32x16_bf16 v[184:199], a[72:75], v[144:147], v[184:199]
    v_mfma_f32_32x32x16_bf16 v[200:215], a[184:187], v[144:147], v[200:215]
    v_mfma_f32_32x32x16_bf16 v[184:199], a[76:79], v[148:151], v[184:199]
    v_mfma_f32_32x32x16_bf16 v[200:215], a[188:191], v[148:151], v[200:215]
    v_mfma_f32_32x32x16_bf16 v[184:199], a[80:83], v[152:155], v[184:199]
    v_mfma_f32_32x32x16_bf16 v[200:215], a[192:195], v[152:155], v[200:215]
    v_mfma_f32_32x32x16_bf16 v[184:199], a[84:87], v[156:159], v[184:199]
    v_mfma_f32_32x32x16_bf16 v[200:215], a[196:199], v[156:159], v[200:215]
    v_mfma_f32_32x32x16_bf16 v[184:199], a[88:91], v[160:163], v[184:199]
    v_mfma_f32_32x32x16_bf16 v[200:215], a[200:203], v[160:163], v[200:215]
    v_mfma_f32_32x32x16_bf16 v[184:199], a[92:95], v[164:167], v[184:199]
    v_mfma_f32_32x32x16_bf16 v[200:215], a[204:207], v[164:167], v[200:215]
    v_mfma_f32_32x32x16_bf16 v[184:199], a[96:99], v[168:171], v[184:199]
    v_mfma_f32_32x32x16_bf16 v[200:215], a[208:211], v[168:171], v[200:215]
    v_mfma_f32_32x32x16_bf16 v[184:199], a[100:103], v[172:175], v[184:199]
    v_mfma_f32_32x32x16_bf16 v[200:215], a[212:215], v[172:175], v[200:215]
    v_mfma_f32_32x32x16_bf16 v[184:199], a[104:107], v[176:179], v[184:199]
    v_mfma_f32_32x32x16_bf16 v[200:215], a[216:219], v[176:179], v[200:215]
    v_mfma_f32_32x32x16_bf16 v[184:199], a[108:111], v[180:183], v[184:199]
    v_mfma_f32_32x32x16_bf16 v[200:215], a[220:223], v[180:183], v[200:215]
    s_nop 15
    s_nop 1
    v_cvt_pk_bf16_f32 v216, v184, v185
    v_cvt_pk_bf16_f32 v217, v186, v187
    v_cvt_pk_bf16_f32 v218, v188, v189
    v_cvt_pk_bf16_f32 v219, v190, v191
    v_cvt_pk_bf16_f32 v220, v192, v193
    v_cvt_pk_bf16_f32 v221, v194, v195
    v_cvt_pk_bf16_f32 v222, v196, v197
    v_cvt_pk_bf16_f32 v223, v198, v199
    v_cvt_pk_bf16_f32 v224, v200, v201
    v_cvt_pk_bf16_f32 v225, v202, v203
    v_cvt_pk_bf16_f32 v226, v204, v205
    v_cvt_pk_bf16_f32 v227, v206, v207
    v_cvt_pk_bf16_f32 v228, v208, v209
    v_cvt_pk_bf16_f32 v229, v210, v211
    v_cvt_pk_bf16_f32 v230, v212, v213
    v_cvt_pk_bf16_f32 v231, v214, v215
    buffer_store_dwordx4 v[216:219], v6, s[52:55], s37 offen offset:0 sc1
    buffer_store_dwordx4 v[220:223], v6, s[52:55], s37 offen offset:256 sc1
    buffer_store_dwordx4 v[224:227], v6, s[52:55], s37 offen offset:512 sc1
    buffer_store_dwordx4 v[228:231], v6, s[52:55], s37 offen offset:768 sc1
    s_add_u32 s37, s37, 1835008
    s_add_u32 s39, s36, 0
    buffer_load_dwordx4 v[128:131], v5, s[48:51], s39 offen offset:0
    buffer_load_dwordx4 v[132:135], v5, s[48:51], s39 offen offset:1024
    buffer_load_dwordx4 v[136:139], v5, s[48:51], s39 offen offset:2048
    buffer_load_dwordx4 v[140:143], v5, s[48:51], s39 offen offset:3072
    s_add_u32 s39, s36, 4096
    buffer_load_dwordx4 v[144:147], v5, s[48:51], s39 offen offset:0
    buffer_load_dwordx4 v[148:151], v5, s[48:51], s39 offen offset:1024
    buffer_load_dwordx4 v[152:155], v5, s[48:51], s39 offen offset:2048
    buffer_load_dwordx4 v[156:159], v5, s[48:51], s39 offen offset:3072
    s_add_u32 s39, s36, 8192
    buffer_load_dwordx4 v[160:163], v5, s[48:51], s39 offen offset:0
    buffer_load_dwordx4 v[164:167], v5, s[48:51], s39 offen offset:1024
    buffer_load_dwordx4 v[168:171], v5, s[48:51], s39 offen offset:2048
    buffer_load_dwordx4 v[172:175], v5, s[48:51], s39 offen offset:3072
    s_add_u32 s39, s36, 12288
    buffer_load_dwordx4 v[176:179], v5, s[48:51], s39 offen offset:0
    buffer_load_dwordx4 v[180:183], v5, s[48:51], s39 offen offset:1024
    s_waitcnt vmcnt(28)
    v_mfma_f32_32x32x16_bf16 v[184:199], a[0:3], v[16:19], 0
    v_mfma_f32_32x32x16_bf16 v[200:215], a[112:115], v[16:19], 0
    v_mfma_f32_32x32x16_bf16 v[184:199], a[4:7], v[20:23], v[184:199]
    v_mfma_f32_32x32x16_bf16 v[200:215], a[116:119], v[20:23], v[200:215]
    v_mfma_f32_32x32x16_bf16 v[184:199], a[8:11], v[24:27], v[184:199]
    v_mfma_f32_32x32x16_bf16 v[200:215], a[120:123], v[24:27], v[200:215]
    v_mfma_f32_32x32x16_bf16 v[184:199], a[12:15], v[28:31], v[184:199]
    v_mfma_f32_32x32x16_bf16 v[200:215], a[124:127], v[28:31], v[200:215]
    v_mfma_f32_32x32x16_bf16 v[184:199], a[16:19], v[32:35], v[184:199]
    v_mfma_f32_32x32x16_bf16 v[200:215], a[128:131], v[32:35], v[200:215]
    v_mfma_f32_32x32x16_bf16 v[184:199], a[20:23], v[36:39], v[184:199]
    v_mfma_f32_32x32x16_bf16 v[200:215], a[132:135], v[36:39], v[200:215]
    v_mfma_f32_32x32x16_bf16 v[184:199], a[24:27], v[40:43], v[184:199]
    v_mfma_f32_32x32x16_bf16 v[200:215], a[136:139], v[40:43], v[200:215]
    v_mfma_f32_32x32x16_bf16 v[184:199], a[28:31], v[44:47], v[184:199]
    v_mfma_f32_32x32x16_bf16 v[200:215], a[140:143], v[44:47], v[200:215]
    v_mfma_f32_32x32x16_bf16 v[184:199], a[32:35], v[48:51], v[184:199]
    v_mfma_f32_32x32x16_bf16 v[200:215], a[144:147], v[48:51], v[200:215]
    v_mfma_f32_32x32x16_bf16 v[184:199], a[36:39], v[52:55], v[184:199]
    v_mfma_f32_32x32x16_bf16 v[200:215], a[148:151], v[52:55], v[200:215]
    v_mfma_f32_32x32x16_bf16 v[184:199], a[40:43], v[56:59], v[184:199]
    v_mfma_f32_32x32x16_bf16 v[200:215], a[152:155], v[56:59], v[200:215]
    v_mfma_f32_32x32x16_bf16 v[184:199], a[44:47], v[60:63], v[184:199]
    v_mfma_f32_32x32x16_bf16 v[200:215], a[156:159], v[60:63], v[200:215]
    v_mfma_f32_32x32x16_bf16 v[184:199], a[48:51], v[64:67], v[184:199]
    v_mfma_f32_32x32x16_bf16 v[200:215], a[160:163], v[64:67], v[200:215]
    v_mfma_f32_32x32x16_bf16 v[184:199], a[52:55], v[68:71], v[184:199]
    v_mfma_f32_32x32x16_bf16 v[200:215], a[164:167], v[68:71], v[200:215]
    s_add_u32 s39, s36, 12288
    buffer_load_dwordx4 v[16:19], v5, s[48:51], s39 offen offset:2048
    buffer_load_dwordx4 v[20:23], v5, s[48:51], s39 offen offset:3072
    s_add_u32 s39, s36, 16384
    buffer_load_dwordx4 v[24:27], v5, s[48:51], s39 offen offset:0
    buffer_load_dwordx4 v[28:31], v5, s[48:51], s39 offen offset:1024
    buffer_load_dwordx4 v[32:35], v5, s[48:51], s39 offen offset:2048
    buffer_load_dwordx4 v[36:39], v5, s[48:51], s39 offen offset:3072
    s_add_u32 s39, s36, 20480
    buffer_load_dwordx4 v[40:43], v5, s[48:51], s39 offen offset:0
    buffer_load_dwordx4 v[44:47], v5, s[48:51], s39 offen offset:1024
    buffer_load_dwordx4 v[48:51], v5, s[48:51], s39 offen offset:2048
    buffer_load_dwordx4 v[52:55], v5, s[48:51], s39 offen offset:3072
    s_add_u32 s39, s36, 24576
    buffer_load_dwordx4 v[56:59], v5, s[48:51], s39 offen offset:0
    buffer_load_dwordx4 v[60:63], v5, s[48:51], s39 offen offset:1024
    buffer_load_dwordx4 v[64:67], v5, s[48:51], s39 offen offset:2048
    buffer_load_dwordx4 v[68:71], v5, s[48:51], s39 offen offset:3072
    s_add_u32 s36, s36, 114688
    s_waitcnt vmcnt(28)
    v_mfma_f32_32x32x16_bf16 v[184:199], a[56:59], v[72:75], v[184:199]
    v_mfma_f32_32x32x16_bf16 v[200:215], a[168:171], v[72:75], v[200:215]
    v_mfma_f32_32x32x16_bf16 v[184:199], a[60:63], v[76:79], v[184:199]
    v_mfma_f32_32x32x16_bf16 v[200:215], a[172:175], v[76:79], v[200:215]
    v_mfma_f32_32x32x16_bf16 v[184:199], a[64:67], v[80:83], v[184:199]
    v_mfma_f32_32x32x16_bf16 v[200:215], a[176:179], v[80:83], v[200:215]
    v_mfma_f32_32x32x16_bf16 v[184:199], a[68:71], v[84:87], v[184:199]
    v_mfma_f32_32x32x16_bf16 v[200:215], a[180:183], v[84:87], v[200:215]
    v_mfma_f32_32x32x16_bf16 v[184:199], a[72:75], v[88:91], v[184:199]
    v_mfma_f32_32x32x16_bf16 v[200:215], a[184:187], v[88:91], v[200:215]
    v_mfma_f32_32x32x16_bf16 v[184:199], a[76:79], v[92:95], v[184:199]
    v_mfma_f32_32x32x16_bf16 v[200:215], a[188:191], v[92:95], v[200:215]
    v_mfma_f32_32x32x16_bf16 v[184:199], a[80:83], v[96:99], v[184:199]
    v_mfma_f32_32x32x16_bf16 v[200:215], a[192:195], v[96:99], v[200:215]
    v_mfma_f32_32x32x16_bf16 v[184:199], a[84:87], v[100:103], v[184:199]
    v_mfma_f32_32x32x16_bf16 v[200:215], a[196:199], v[100:103], v[200:215]
    v_mfma_f32_32x32x16_bf16 v[184:199], a[88:91], v[104:107], v[184:199]
    v_mfma_f32_32x32x16_bf16 v[200:215], a[200:203], v[104:107], v[200:215]
    v_mfma_f32_32x32x16_bf16 v[184:199], a[92:95], v[108:111], v[184:199]
    v_mfma_f32_32x32x16_bf16 v[200:215], a[204:207], v[108:111], v[200:215]
    v_mfma_f32_32x32x16_bf16 v[184:199], a[96:99], v[112:115], v[184:199]
    v_mfma_f32_32x32x16_bf16 v[200:215], a[208:211], v[112:115], v[200:215]
    v_mfma_f32_32x32x16_bf16 v[184:199], a[100:103], v[116:119], v[184:199]
    v_mfma_f32_32x32x16_bf16 v[200:215], a[212:215], v[116:119], v[200:215]
    v_mfma_f32_32x32x16_bf16 v[184:199], a[104:107], v[120:123], v[184:199]
    v_mfma_f32_32x32x16_bf16 v[200:215], a[216:219], v[120:123], v[200:215]
    v_mfma_f32_32x32x16_bf16 v[184:199], a[108:111], v[124:127], v[184:199]
    v_mfma_f32_32x32x16_bf16 v[200:215], a[220:223], v[124:127], v[200:215]
    s_nop 15
    s_nop 1
    v_cvt_pk_bf16_f32 v216, v184, v185
    v_cvt_pk_bf16_f32 v217, v186, v187
    v_cvt_pk_bf16_f32 v218, v188, v189
    v_cvt_pk_bf16_f32 v219, v190, v191
    v_cvt_pk_bf16_f32 v220, v192, v193
    v_cvt_pk_bf16_f32 v221, v194, v195
    v_cvt_pk_bf16_f32 v222, v196, v197
    v_cvt_pk_bf16_f32 v223, v198, v199
    v_cvt_pk_bf16_f32 v224, v200, v201
    v_cvt_pk_bf16_f32 v225, v202, v203
    v_cvt_pk_bf16_f32 v226, v204, v205
    v_cvt_pk_bf16_f32 v227, v206, v207
    v_cvt_pk_bf16_f32 v228, v208, v209
    v_cvt_pk_bf16_f32 v229, v210, v211
    v_cvt_pk_bf16_f32 v230, v212, v213
    v_cvt_pk_bf16_f32 v231, v214, v215
    buffer_store_dwordx4 v[216:219], v6, s[52:55], s37 offen offset:0 sc1
    buffer_store_dwordx4 v[220:223], v6, s[52:55], s37 offen offset:256 sc1
    buffer_store_dwordx4 v[224:227], v6, s[52:55], s37 offen offset:512 sc1
    buffer_store_dwordx4 v[228:231], v6, s[52:55], s37 offen offset:768 sc1
    s_add_u32 s37, s37, 1835008
    s_add_u32 s39, s36, 0
    buffer_load_dwordx4 v[72:75], v5, s[48:51], s39 offen offset:0
    buffer_load_dwordx4 v[76:79], v5, s[48:51], s39 offen offset:1024
    buffer_load_dwordx4 v[80:83], v5, s[48:51], s39 offen offset:2048
    buffer_load_dwordx4 v[84:87], v5, s[48:51], s39 offen offset:3072
    s_add_u32 s39, s36, 4096
    buffer_load_dwordx4 v[88:91], v5, s[48:51], s39 offen offset:0
    buffer_load_dwordx4 v[92:95], v5, s[48:51], s39 offen offset:1024
    buffer_load_dwordx4 v[96:99], v5, s[48:51], s39 offen offset:2048
    buffer_load_dwordx4 v[100:103], v5, s[48:51], s39 offen offset:3072
    s_add_u32 s39, s36, 8192
    buffer_load_dwordx4 v[104:107], v5, s[48:51], s39 offen offset:0
    buffer_load_dwordx4 v[108:111], v5, s[48:51], s39 offen offset:1024
    buffer_load_dwordx4 v[112:115], v5, s[48:51], s39 offen offset:2048
    buffer_load_dwordx4 v[116:119], v5, s[48:51], s39 offen offset:3072
    s_add_u32 s39, s36, 12288
    buffer_load_dwordx4 v[120:123], v5, s[48:51], s39 offen offset:0
    buffer_load_dwordx4 v[124:127], v5, s[48:51], s39 offen offset:1024
    s_waitcnt vmcnt(28)
    v_mfma_f32_32x32x16_bf16 v[184:199], a[0:3], v[128:131], 0
    v_mfma_f32_32x32x16_bf16 v[200:215], a[112:115], v[128:131], 0
    v_mfma_f32_32x32x16_bf16 v[184:199], a[4:7], v[132:135], v[184:199]
    v_mfma_f32_32x32x16_bf16 v[200:215], a[116:119], v[132:135], v[200:215]
    v_mfma_f32_32x32x16_bf16 v[184:199], a[8:11], v[136:139], v[184:199]
    v_mfma_f32_32x32x16_bf16 v[200:215], a[120:123], v[136:139], v[200:215]
    v_mfma_f32_32x32x16_bf16 v[184:199], a[12:15], v[140:143], v[184:199]
    v_mfma_f32_32x32x16_bf16 v[200:215], a[124:127], v[140:143], v[200:215]
    v_mfma_f32_32x32x16_bf16 v[184:199], a[16:19], v[144:147], v[184:199]
    v_mfma_f32_32x32x16_bf16 v[200:215], a[128:131], v[144:147], v[200:215]
    v_mfma_f32_32x32x16_bf16 v[184:199], a[20:23], v[148:151], v[184:199]
    v_mfma_f32_32x32x16_bf16 v[200:215], a[132:135], v[148:151], v[200:215]
    v_mfma_f32_32x32x16_bf16 v[184:199], a[24:27], v[152:155], v[184:199]
    v_mfma_f32_32x32x16_bf16 v[200:215], a[136:139], v[152:155], v[200:215]
    v_mfma_f32_32x32x16_bf16 v[184:199], a[28:31], v[156:159], v[184:199]
    v_mfma_f32_32x32x16_bf16 v[200:215], a[140:143], v[156:159], v[200:215]
    v_mfma_f32_32x32x16_bf16 v[184:199], a[32:35], v[160:163], v[184:199]
    v_mfma_f32_32x32x16_bf16 v[200:215], a[144:147], v[160:163], v[200:215]
    v_mfma_f32_32x32x16_bf16 v[184:199], a[36:39], v[164:167], v[184:199]
    v_mfma_f32_32x32x16_bf16 v[200:215], a[148:151], v[164:167], v[200:215]
    v_mfma_f32_32x32x16_bf16 v[184:199], a[40:43], v[168:171], v[184:199]
    v_mfma_f32_32x32x16_bf16 v[200:215], a[152:155], v[168:171], v[200:215]
    v_mfma_f32_32x32x16_bf16 v[184:199], a[44:47], v[172:175], v[184:199]
    v_mfma_f32_32x32x16_bf16 v[200:215], a[156:159], v[172:175], v[200:215]
    v_mfma_f32_32x32x16_bf16 v[184:199], a[48:51], v[176:179], v[184:199]
    v_mfma_f32_32x32x16_bf16 v[200:215], a[160:163], v[176:179], v[200:215]
    v_mfma_f32_32x32x16_bf16 v[184:199], a[52:55], v[180:183], v[184:199]
    v_mfma_f32_32x32x16_bf16 v[200:215], a[164:167], v[180:183], v[200:215]
    s_add_u32 s39, s36, 12288
    buffer_load_dwordx4 v[128:131], v5, s[48:51], s39 offen offset:2048
    buffer_load_dwordx4 v[132:135], v5, s[48:51], s39 offen offset:3072
    s_add_u32 s39, s36, 16384
    buffer_load_dwordx4 v[136:139], v5, s[48:51], s39 offen offset:0
    buffer_load_dwordx4 v[140:143], v5, s[48:51], s39 offen offset:1024
    buffer_load_dwordx4 v[144:147], v5, s[48:51], s39 offen offset:2048
    buffer_load_dwordx4 v[148:151], v5, s[48:51], s39 offen offset:3072
    s_add_u32 s39, s36, 20480
    buffer_load_dwordx4 v[152:155], v5, s[48:51], s39 offen offset:0
    buffer_load_dwordx4 v[156:159], v5, s[48:51], s39 offen offset:1024
    buffer_load_dwordx4 v[160:163], v5, s[48:51], s39 offen offset:2048
    buffer_load_dwordx4 v[164:167], v5, s[48:51], s39 offen offset:3072
    s_add_u32 s39, s36, 24576
    buffer_load_dwordx4 v[168:171], v5, s[48:51], s39 offen offset:0
    buffer_load_dwordx4 v[172:175], v5, s[48:51], s39 offen offset:1024
    buffer_load_dwordx4 v[176:179], v5, s[48:51], s39 offen offset:2048
    buffer_load_dwordx4 v[180:183], v5, s[48:51], s39 offen offset:3072
    s_add_u32 s36, s36, 114688
    s_waitcnt vmcnt(28)
    s_barrier
    v_mov_b32 v13, 0
    s_lshl_b32 s22, s100, 2
    s_add_u32 s22, s22, 8192
    v_cmp_eq_u32 vcc, 0, v0
    s_and_b64 exec, exec, vcc
    buffer_store_dword v13, v13, s[96:99], s22 offen offset:0 sc1
    s_mov_b64 exec, -1
    v_mfma_f32_32x32x16_bf16 v[184:199], a[56:59], v[16:19], v[184:199]
    v_mfma_f32_32x32x16_bf16 v[200:215], a[168:171], v[16:19], v[200:215]
    v_mfma_f32_32x32x16_bf16 v[184:199], a[60:63], v[20:23], v[184:199]
    v_mfma_f32_32x32x16_bf16 v[200:215], a[172:175], v[20:23], v[200:215]
    v_mfma_f32_32x32x16_bf16 v[184:199], a[64:67], v[24:27], v[184:199]
    v_mfma_f32_32x32x16_bf16 v[200:215], a[176:179], v[24:27], v[200:215]
    v_mfma_f32_32x32x16_bf16 v[184:199], a[68:71], v[28:31], v[184:199]
    v_mfma_f32_32x32x16_bf16 v[200:215], a[180:183], v[28:31], v[200:215]
    v_mfma_f32_32x32x16_bf16 v[184:199], a[72:75], v[32:35], v[184:199]
    v_mfma_f32_32x32x16_bf16 v[200:215], a[184:187], v[32:35], v[200:215]
    v_mfma_f32_32x32x16_bf16 v[184:199], a[76:79], v[36:39], v[184:199]
    v_mfma_f32_32x32x16_bf16 v[200:215], a[188:191], v[36:39], v[200:215]
    v_mfma_f32_32x32x16_bf16 v[184:199], a[80:83], v[40:43], v[184:199]
    v_mfma_f32_32x32x16_bf16 v[200:215], a[192:195], v[40:43], v[200:215]
    v_mfma_f32_32x32x16_bf16 v[184:199], a[84:87], v[44:47], v[184:199]
    v_mfma_f32_32x32x16_bf16 v[200:215], a[196:199], v[44:47], v[200:215]
    v_mfma_f32_32x32x16_bf16 v[184:199], a[88:91], v[48:51], v[184:199]
    v_mfma_f32_32x32x16_bf16 v[200:215], a[200:203], v[48:51], v[200:215]
    v_mfma_f32_32x32x16_bf16 v[184:199], a[92:95], v[52:55], v[184:199]
    v_mfma_f32_32x32x16_bf16 v[200:215], a[204:207], v[52:55], v[200:215]
    v_mfma_f32_32x32x16_bf16 v[184:199], a[96:99], v[56:59], v[184:199]
    v_mfma_f32_32x32x16_bf16 v[200:215], a[208:211], v[56:59], v[200:215]
    v_mfma_f32_32x32x16_bf16 v[184:199], a[100:103], v[60:63], v[184:199]
    v_mfma_f32_32x32x16_bf16 v[200:215], a[212:215], v[60:63], v[200:215]
    v_mfma_f32_32x32x16_bf16 v[184:199], a[104:107], v[64:67], v[184:199]
    v_mfma_f32_32x32x16_bf16 v[200:215], a[216:219], v[64:67], v[200:215]
    v_mfma_f32_32x32x16_bf16 v[184:199], a[108:111], v[68:71], v[184:199]
    v_mfma_f32_32x32x16_bf16 v[200:215], a[220:223], v[68:71], v[200:215]
    s_nop 15
    s_nop 1
    v_cvt_pk_bf16_f32 v216, v184, v185
    v_cvt_pk_bf16_f32 v217, v186, v187
    v_cvt_pk_bf16_f32 v218, v188, v189
    v_cvt_pk_bf16_f32 v219, v190, v191
    v_cvt_pk_bf16_f32 v220, v192, v193
    v_cvt_pk_bf16_f32 v221, v194, v195
    v_cvt_pk_bf16_f32 v222, v196, v197
    v_cvt_pk_bf16_f32 v223, v198, v199
    v_cvt_pk_bf16_f32 v224, v200, v201
    v_cvt_pk_bf16_f32 v225, v202, v203
    v_cvt_pk_bf16_f32 v226, v204, v205
    v_cvt_pk_bf16_f32 v227, v206, v207
    v_cvt_pk_bf16_f32 v228, v208, v209
    v_cvt_pk_bf16_f32 v229, v210, v211
    v_cvt_pk_bf16_f32 v230, v212, v213
    v_cvt_pk_bf16_f32 v231, v214, v215
    buffer_store_dwordx4 v[216:219], v6, s[52:55], s37 offen offset:0 sc1
    buffer_store_dwordx4 v[220:223], v6, s[52:55], s37 offen offset:256 sc1
    buffer_store_dwordx4 v[224:227], v6, s[52:55], s37 offen offset:512 sc1
    buffer_store_dwordx4 v[228:231], v6, s[52:55], s37 offen offset:768 sc1
    s_add_u32 s37, s37, 1835008
    s_add_u32 s39, s36, 0
    buffer_load_dwordx4 v[16:19], v5, s[48:51], s39 offen offset:0
    buffer_load_dwordx4 v[20:23], v5, s[48:51], s39 offen offset:1024
    buffer_load_dwordx4 v[24:27], v5, s[48:51], s39 offen offset:2048
    buffer_load_dwordx4 v[28:31], v5, s[48:51], s39 offen offset:3072
    s_add_u32 s39, s36, 4096
    buffer_load_dwordx4 v[32:35], v5, s[48:51], s39 offen offset:0
    buffer_load_dwordx4 v[36:39], v5, s[48:51], s39 offen offset:1024
    buffer_load_dwordx4 v[40:43], v5, s[48:51], s39 offen offset:2048
    buffer_load_dwordx4 v[44:47], v5, s[48:51], s39 offen offset:3072
    s_add_u32 s39, s36, 8192
    buffer_load_dwordx4 v[48:51], v5, s[48:51], s39 offen offset:0
    buffer_load_dwordx4 v[52:55], v5, s[48:51], s39 offen offset:1024
    buffer_load_dwordx4 v[56:59], v5, s[48:51], s39 offen offset:2048
    buffer_load_dwordx4 v[60:63], v5, s[48:51], s39 offen offset:3072
    s_add_u32 s39, s36, 12288
    buffer_load_dwordx4 v[64:67], v5, s[48:51], s39 offen offset:0
    buffer_load_dwordx4 v[68:71], v5, s[48:51], s39 offen offset:1024
    s_waitcnt vmcnt(28)
    v_mfma_f32_32x32x16_bf16 v[184:199], a[0:3], v[72:75], 0
    v_mfma_f32_32x32x16_bf16 v[200:215], a[112:115], v[72:75], 0
    v_mfma_f32_32x32x16_bf16 v[184:199], a[4:7], v[76:79], v[184:199]
    v_mfma_f32_32x32x16_bf16 v[200:215], a[116:119], v[76:79], v[200:215]
    v_mfma_f32_32x32x16_bf16 v[184:199], a[8:11], v[80:83], v[184:199]
    v_mfma_f32_32x32x16_bf16 v[200:215], a[120:123], v[80:83], v[200:215]
    v_mfma_f32_32x32x16_bf16 v[184:199], a[12:15], v[84:87], v[184:199]
    v_mfma_f32_32x32x16_bf16 v[200:215], a[124:127], v[84:87], v[200:215]
    v_mfma_f32_32x32x16_bf16 v[184:199], a[16:19], v[88:91], v[184:199]
    v_mfma_f32_32x32x16_bf16 v[200:215], a[128:131], v[88:91], v[200:215]
    v_mfma_f32_32x32x16_bf16 v[184:199], a[20:23], v[92:95], v[184:199]
    v_mfma_f32_32x32x16_bf16 v[200:215], a[132:135], v[92:95], v[200:215]
    v_mfma_f32_32x32x16_bf16 v[184:199], a[24:27], v[96:99], v[184:199]
    v_mfma_f32_32x32x16_bf16 v[200:215], a[136:139], v[96:99], v[200:215]
    v_mfma_f32_32x32x16_bf16 v[184:199], a[28:31], v[100:103], v[184:199]
    v_mfma_f32_32x32x16_bf16 v[200:215], a[140:143], v[100:103], v[200:215]
    v_mfma_f32_32x32x16_bf16 v[184:199], a[32:35], v[104:107], v[184:199]
    v_mfma_f32_32x32x16_bf16 v[200:215], a[144:147], v[104:107], v[200:215]
    v_mfma_f32_32x32x16_bf16 v[184:199], a[36:39], v[108:111], v[184:199]
    v_mfma_f32_32x32x16_bf16 v[200:215], a[148:151], v[108:111], v[200:215]
    v_mfma_f32_32x32x16_bf16 v[184:199], a[40:43], v[112:115], v[184:199]
    v_mfma_f32_32x32x16_bf16 v[200:215], a[152:155], v[112:115], v[200:215]
    v_mfma_f32_32x32x16_bf16 v[184:199], a[44:47], v[116:119], v[184:199]
    v_mfma_f32_32x32x16_bf16 v[200:215], a[156:159], v[116:119], v[200:215]
    v_mfma_f32_32x32x16_bf16 v[184:199], a[48:51], v[120:123], v[184:199]
    v_mfma_f32_32x32x16_bf16 v[200:215], a[160:163], v[120:123], v[200:215]
    v_mfma_f32_32x32x16_bf16 v[184:199], a[52:55], v[124:127], v[184:199]
    v_mfma_f32_32x32x16_bf16 v[200:215], a[164:167], v[124:127], v[200:215]
    s_add_u32 s39, s36, 12288
    buffer_load_dwordx4 v[72:75], v5, s[48:51], s39 offen offset:2048
    buffer_load_dwordx4 v[76:79], v5, s[48:51], s39 offen offset:3072
    s_add_u32 s39, s36, 16384
    buffer_load_dwordx4 v[80:83], v5, s[48:51], s39 offen offset:0
    buffer_load_dwordx4 v[84:87], v5, s[48:51], s39 offen offset:1024
    buffer_load_dwordx4 v[88:91], v5, s[48:51], s39 offen offset:2048
    buffer_load_dwordx4 v[92:95], v5, s[48:51], s39 offen offset:3072
    s_add_u32 s39, s36, 20480
    buffer_load_dwordx4 v[96:99], v5, s[48:51], s39 offen offset:0
    buffer_load_dwordx4 v[100:103], v5, s[48:51], s39 offen offset:1024
    buffer_load_dwordx4 v[104:107], v5, s[48:51], s39 offen offset:2048
    buffer_load_dwordx4 v[108:111], v5, s[48:51], s39 offen offset:3072
    s_add_u32 s39, s36, 24576
    buffer_load_dwordx4 v[112:115], v5, s[48:51], s39 offen offset:0
    buffer_load_dwordx4 v[116:119], v5, s[48:51], s39 offen offset:1024
    buffer_load_dwordx4 v[120:123], v5, s[48:51], s39 offen offset:2048
    buffer_load_dwordx4 v[124:127], v5, s[48:51], s39 offen offset:3072
    s_add_u32 s36, s36, 114688
    s_waitcnt vmcnt(28)
    v_mfma_f32_32x32x16_bf16 v[184:199], a[56:59], v[128:131], v[184:199]
    v_mfma_f32_32x32x16_bf16 v[200:215], a[168:171], v[128:131], v[200:215]
    v_mfma_f32_32x32x16_bf16 v[184:199], a[60:63], v[132:135], v[184:199]
    v_mfma_f32_32x32x16_bf16 v[200:215], a[172:175], v[132:135], v[200:215]
    v_mfma_f32_32x32x16_bf16 v[184:199], a[64:67], v[136:139], v[184:199]
    v_mfma_f32_32x32x16_bf16 v[200:215], a[176:179], v[136:139], v[200:215]
    v_mfma_f32_32x32x16_bf16 v[184:199], a[68:71], v[140:143], v[184:199]
    v_mfma_f32_32x32x16_bf16 v[200:215], a[180:183], v[140:143], v[200:215]
    v_mfma_f32_32x32x16_bf16 v[184:199], a[72:75], v[144:147], v[184:199]
    v_mfma_f32_32x32x16_bf16 v[200:215], a[184:187], v[144:147], v[200:215]
    v_mfma_f32_32x32x16_bf16 v[184:199], a[76:79], v[148:151], v[184:199]
    v_mfma_f32_32x32x16_bf16 v[200:215], a[188:191], v[148:151], v[200:215]
    v_mfma_f32_32x32x16_bf16 v[184:199], a[80:83], v[152:155], v[184:199]
    v_mfma_f32_32x32x16_bf16 v[200:215], a[192:195], v[152:155], v[200:215]
    v_mfma_f32_32x32x16_bf16 v[184:199], a[84:87], v[156:159], v[184:199]
    v_mfma_f32_32x32x16_bf16 v[200:215], a[196:199], v[156:159], v[200:215]
    v_mfma_f32_32x32x16_bf16 v[184:199], a[88:91], v[160:163], v[184:199]
    v_mfma_f32_32x32x16_bf16 v[200:215], a[200:203], v[160:163], v[200:215]
    v_mfma_f32_32x32x16_bf16 v[184:199], a[92:95], v[164:167], v[184:199]
    v_mfma_f32_32x32x16_bf16 v[200:215], a[204:207], v[164:167], v[200:215]
    v_mfma_f32_32x32x16_bf16 v[184:199], a[96:99], v[168:171], v[184:199]
    v_mfma_f32_32x32x16_bf16 v[200:215], a[208:211], v[168:171], v[200:215]
    v_mfma_f32_32x32x16_bf16 v[184:199], a[100:103], v[172:175], v[184:199]
    v_mfma_f32_32x32x16_bf16 v[200:215], a[212:215], v[172:175], v[200:215]
    v_mfma_f32_32x32x16_bf16 v[184:199], a[104:107], v[176:179], v[184:199]
    v_mfma_f32_32x32x16_bf16 v[200:215], a[216:219], v[176:179], v[200:215]
    v_mfma_f32_32x32x16_bf16 v[184:199], a[108:111], v[180:183], v[184:199]
    v_mfma_f32_32x32x16_bf16 v[200:215], a[220:223], v[180:183], v[200:215]
    s_nop 15
    s_nop 1
    v_cvt_pk_bf16_f32 v216, v184, v185
    v_cvt_pk_bf16_f32 v217, v186, v187
    v_cvt_pk_bf16_f32 v218, v188, v189
    v_cvt_pk_bf16_f32 v219, v190, v191
    v_cvt_pk_bf16_f32 v220, v192, v193
    v_cvt_pk_bf16_f32 v221, v194, v195
    v_cvt_pk_bf16_f32 v222, v196, v197
    v_cvt_pk_bf16_f32 v223, v198, v199
    v_cvt_pk_bf16_f32 v224, v200, v201
    v_cvt_pk_bf16_f32 v225, v202, v203
    v_cvt_pk_bf16_f32 v226, v204, v205
    v_cvt_pk_bf16_f32 v227, v206, v207
    v_cvt_pk_bf16_f32 v228, v208, v209
    v_cvt_pk_bf16_f32 v229, v210, v211
    v_cvt_pk_bf16_f32 v230, v212, v213
    v_cvt_pk_bf16_f32 v231, v214, v215
    buffer_store_dwordx4 v[216:219], v6, s[52:55], s37 offen offset:0 sc1
    buffer_store_dwordx4 v[220:223], v6, s[52:55], s37 offen offset:256 sc1
    buffer_store_dwordx4 v[224:227], v6, s[52:55], s37 offen offset:512 sc1
    buffer_store_dwordx4 v[228:231], v6, s[52:55], s37 offen offset:768 sc1
    s_add_u32 s37, s37, 1835008
    s_add_u32 s39, s36, 0
    buffer_load_dwordx4 v[128:131], v5, s[48:51], s39 offen offset:0
    buffer_load_dwordx4 v[132:135], v5, s[48:51], s39 offen offset:1024
    buffer_load_dwordx4 v[136:139], v5, s[48:51], s39 offen offset:2048
    buffer_load_dwordx4 v[140:143], v5, s[48:51], s39 offen offset:3072
    s_add_u32 s39, s36, 4096
    buffer_load_dwordx4 v[144:147], v5, s[48:51], s39 offen offset:0
    buffer_load_dwordx4 v[148:151], v5, s[48:51], s39 offen offset:1024
    buffer_load_dwordx4 v[152:155], v5, s[48:51], s39 offen offset:2048
    buffer_load_dwordx4 v[156:159], v5, s[48:51], s39 offen offset:3072
    s_add_u32 s39, s36, 8192
    buffer_load_dwordx4 v[160:163], v5, s[48:51], s39 offen offset:0
    buffer_load_dwordx4 v[164:167], v5, s[48:51], s39 offen offset:1024
    buffer_load_dwordx4 v[168:171], v5, s[48:51], s39 offen offset:2048
    buffer_load_dwordx4 v[172:175], v5, s[48:51], s39 offen offset:3072
    s_add_u32 s39, s36, 12288
    buffer_load_dwordx4 v[176:179], v5, s[48:51], s39 offen offset:0
    buffer_load_dwordx4 v[180:183], v5, s[48:51], s39 offen offset:1024
    s_waitcnt vmcnt(28)
    v_mfma_f32_32x32x16_bf16 v[184:199], a[0:3], v[16:19], 0
    v_mfma_f32_32x32x16_bf16 v[200:215], a[112:115], v[16:19], 0
    v_mfma_f32_32x32x16_bf16 v[184:199], a[4:7], v[20:23], v[184:199]
    v_mfma_f32_32x32x16_bf16 v[200:215], a[116:119], v[20:23], v[200:215]
    v_mfma_f32_32x32x16_bf16 v[184:199], a[8:11], v[24:27], v[184:199]
    v_mfma_f32_32x32x16_bf16 v[200:215], a[120:123], v[24:27], v[200:215]
    v_mfma_f32_32x32x16_bf16 v[184:199], a[12:15], v[28:31], v[184:199]
    v_mfma_f32_32x32x16_bf16 v[200:215], a[124:127], v[28:31], v[200:215]
    v_mfma_f32_32x32x16_bf16 v[184:199], a[16:19], v[32:35], v[184:199]
    v_mfma_f32_32x32x16_bf16 v[200:215], a[128:131], v[32:35], v[200:215]
    v_mfma_f32_32x32x16_bf16 v[184:199], a[20:23], v[36:39], v[184:199]
    v_mfma_f32_32x32x16_bf16 v[200:215], a[132:135], v[36:39], v[200:215]
    v_mfma_f32_32x32x16_bf16 v[184:199], a[24:27], v[40:43], v[184:199]
    v_mfma_f32_32x32x16_bf16 v[200:215], a[136:139], v[40:43], v[200:215]
    v_mfma_f32_32x32x16_bf16 v[184:199], a[28:31], v[44:47], v[184:199]
    v_mfma_f32_32x32x16_bf16 v[200:215], a[140:143], v[44:47], v[200:215]
    v_mfma_f32_32x32x16_bf16 v[184:199], a[32:35], v[48:51], v[184:199]
    v_mfma_f32_32x32x16_bf16 v[200:215], a[144:147], v[48:51], v[200:215]
    v_mfma_f32_32x32x16_bf16 v[184:199], a[36:39], v[52:55], v[184:199]
    v_mfma_f32_32x32x16_bf16 v[200:215], a[148:151], v[52:55], v[200:215]
    v_mfma_f32_32x32x16_bf16 v[184:199], a[40:43], v[56:59], v[184:199]
    v_mfma_f32_32x32x16_bf16 v[200:215], a[152:155], v[56:59], v[200:215]
    v_mfma_f32_32x32x16_bf16 v[184:199], a[44:47], v[60:63], v[184:199]
    v_mfma_f32_32x32x16_bf16 v[200:215], a[156:159], v[60:63], v[200:215]
    v_mfma_f32_32x32x16_bf16 v[184:199], a[48:51], v[64:67], v[184:199]
    v_mfma_f32_32x32x16_bf16 v[200:215], a[160:163], v[64:67], v[200:215]
    v_mfma_f32_32x32x16_bf16 v[184:199], a[52:55], v[68:71], v[184:199]
    v_mfma_f32_32x32x16_bf16 v[200:215], a[164:167], v[68:71], v[200:215]
    s_add_u32 s39, s36, 12288
    buffer_load_dwordx4 v[16:19], v5, s[48:51], s39 offen offset:2048
    buffer_load_dwordx4 v[20:23], v5, s[48:51], s39 offen offset:3072
    s_add_u32 s39, s36, 16384
    buffer_load_dwordx4 v[24:27], v5, s[48:51], s39 offen offset:0
    buffer_load_dwordx4 v[28:31], v5, s[48:51], s39 offen offset:1024
    buffer_load_dwordx4 v[32:35], v5, s[48:51], s39 offen offset:2048
    buffer_load_dwordx4 v[36:39], v5, s[48:51], s39 offen offset:3072
    s_add_u32 s39, s36, 20480
    buffer_load_dwordx4 v[40:43], v5, s[48:51], s39 offen offset:0
    buffer_load_dwordx4 v[44:47], v5, s[48:51], s39 offen offset:1024
    buffer_load_dwordx4 v[48:51], v5, s[48:51], s39 offen offset:2048
    buffer_load_dwordx4 v[52:55], v5, s[48:51], s39 offen offset:3072
    s_add_u32 s39, s36, 24576
    buffer_load_dwordx4 v[56:59], v5, s[48:51], s39 offen offset:0
    buffer_load_dwordx4 v[60:63], v5, s[48:51], s39 offen offset:1024
    buffer_load_dwordx4 v[64:67], v5, s[48:51], s39 offen offset:2048
    buffer_load_dwordx4 v[68:71], v5, s[48:51], s39 offen offset:3072
    s_add_u32 s36, s36, 114688
    s_waitcnt vmcnt(28)
    s_barrier
    v_mov_b32 v13, 0
    s_lshl_b32 s22, s100, 2
    s_add_u32 s22, s22, 9216
    v_cmp_eq_u32 vcc, 0, v0
    s_and_b64 exec, exec, vcc
    buffer_store_dword v13, v13, s[96:99], s22 offen offset:0 sc1
    s_mov_b64 exec, -1
    v_mfma_f32_32x32x16_bf16 v[184:199], a[56:59], v[72:75], v[184:199]
    v_mfma_f32_32x32x16_bf16 v[200:215], a[168:171], v[72:75], v[200:215]
    v_mfma_f32_32x32x16_bf16 v[184:199], a[60:63], v[76:79], v[184:199]
    v_mfma_f32_32x32x16_bf16 v[200:215], a[172:175], v[76:79], v[200:215]
    v_mfma_f32_32x32x16_bf16 v[184:199], a[64:67], v[80:83], v[184:199]
    v_mfma_f32_32x32x16_bf16 v[200:215], a[176:179], v[80:83], v[200:215]
    v_mfma_f32_32x32x16_bf16 v[184:199], a[68:71], v[84:87], v[184:199]
    v_mfma_f32_32x32x16_bf16 v[200:215], a[180:183], v[84:87], v[200:215]
    v_mfma_f32_32x32x16_bf16 v[184:199], a[72:75], v[88:91], v[184:199]
    v_mfma_f32_32x32x16_bf16 v[200:215], a[184:187], v[88:91], v[200:215]
    v_mfma_f32_32x32x16_bf16 v[184:199], a[76:79], v[92:95], v[184:199]
    v_mfma_f32_32x32x16_bf16 v[200:215], a[188:191], v[92:95], v[200:215]
    v_mfma_f32_32x32x16_bf16 v[184:199], a[80:83], v[96:99], v[184:199]
    v_mfma_f32_32x32x16_bf16 v[200:215], a[192:195], v[96:99], v[200:215]
    v_mfma_f32_32x32x16_bf16 v[184:199], a[84:87], v[100:103], v[184:199]
    v_mfma_f32_32x32x16_bf16 v[200:215], a[196:199], v[100:103], v[200:215]
    v_mfma_f32_32x32x16_bf16 v[184:199], a[88:91], v[104:107], v[184:199]
    v_mfma_f32_32x32x16_bf16 v[200:215], a[200:203], v[104:107], v[200:215]
    v_mfma_f32_32x32x16_bf16 v[184:199], a[92:95], v[108:111], v[184:199]
    v_mfma_f32_32x32x16_bf16 v[200:215], a[204:207], v[108:111], v[200:215]
    v_mfma_f32_32x32x16_bf16 v[184:199], a[96:99], v[112:115], v[184:199]
    v_mfma_f32_32x32x16_bf16 v[200:215], a[208:211], v[112:115], v[200:215]
    v_mfma_f32_32x32x16_bf16 v[184:199], a[100:103], v[116:119], v[184:199]
    v_mfma_f32_32x32x16_bf16 v[200:215], a[212:215], v[116:119], v[200:215]
    v_mfma_f32_32x32x16_bf16 v[184:199], a[104:107], v[120:123], v[184:199]
    v_mfma_f32_32x32x16_bf16 v[200:215], a[216:219], v[120:123], v[200:215]
    v_mfma_f32_32x32x16_bf16 v[184:199], a[108:111], v[124:127], v[184:199]
    v_mfma_f32_32x32x16_bf16 v[200:215], a[220:223], v[124:127], v[200:215]
    s_nop 15
    s_nop 1
    v_cvt_pk_bf16_f32 v216, v184, v185
    v_cvt_pk_bf16_f32 v217, v186, v187
    v_cvt_pk_bf16_f32 v218, v188, v189
    v_cvt_pk_bf16_f32 v219, v190, v191
    v_cvt_pk_bf16_f32 v220, v192, v193
    v_cvt_pk_bf16_f32 v221, v194, v195
    v_cvt_pk_bf16_f32 v222, v196, v197
    v_cvt_pk_bf16_f32 v223, v198, v199
    v_cvt_pk_bf16_f32 v224, v200, v201
    v_cvt_pk_bf16_f32 v225, v202, v203
    v_cvt_pk_bf16_f32 v226, v204, v205
    v_cvt_pk_bf16_f32 v227, v206, v207
    v_cvt_pk_bf16_f32 v228, v208, v209
    v_cvt_pk_bf16_f32 v229, v210, v211
    v_cvt_pk_bf16_f32 v230, v212, v213
    v_cvt_pk_bf16_f32 v231, v214, v215
    buffer_store_dwordx4 v[216:219], v6, s[52:55], s37 offen offset:0 sc1
    buffer_store_dwordx4 v[220:223], v6, s[52:55], s37 offen offset:256 sc1
    buffer_store_dwordx4 v[224:227], v6, s[52:55], s37 offen offset:512 sc1
    buffer_store_dwordx4 v[228:231], v6, s[52:55], s37 offen offset:768 sc1
    s_add_u32 s37, s37, 1835008
    s_add_u32 s39, s36, 0
    buffer_load_dwordx4 v[72:75], v5, s[48:51], s39 offen offset:0
    buffer_load_dwordx4 v[76:79], v5, s[48:51], s39 offen offset:1024
    buffer_load_dwordx4 v[80:83], v5, s[48:51], s39 offen offset:2048
    buffer_load_dwordx4 v[84:87], v5, s[48:51], s39 offen offset:3072
    s_add_u32 s39, s36, 4096
    buffer_load_dwordx4 v[88:91], v5, s[48:51], s39 offen offset:0
    buffer_load_dwordx4 v[92:95], v5, s[48:51], s39 offen offset:1024
    buffer_load_dwordx4 v[96:99], v5, s[48:51], s39 offen offset:2048
    buffer_load_dwordx4 v[100:103], v5, s[48:51], s39 offen offset:3072
    s_add_u32 s39, s36, 8192
    buffer_load_dwordx4 v[104:107], v5, s[48:51], s39 offen offset:0
    buffer_load_dwordx4 v[108:111], v5, s[48:51], s39 offen offset:1024
    buffer_load_dwordx4 v[112:115], v5, s[48:51], s39 offen offset:2048
    buffer_load_dwordx4 v[116:119], v5, s[48:51], s39 offen offset:3072
    s_add_u32 s39, s36, 12288
    buffer_load_dwordx4 v[120:123], v5, s[48:51], s39 offen offset:0
    buffer_load_dwordx4 v[124:127], v5, s[48:51], s39 offen offset:1024
    s_waitcnt vmcnt(28)
    v_mfma_f32_32x32x16_bf16 v[184:199], a[0:3], v[128:131], 0
    v_mfma_f32_32x32x16_bf16 v[200:215], a[112:115], v[128:131], 0
    v_mfma_f32_32x32x16_bf16 v[184:199], a[4:7], v[132:135], v[184:199]
    v_mfma_f32_32x32x16_bf16 v[200:215], a[116:119], v[132:135], v[200:215]
    v_mfma_f32_32x32x16_bf16 v[184:199], a[8:11], v[136:139], v[184:199]
    v_mfma_f32_32x32x16_bf16 v[200:215], a[120:123], v[136:139], v[200:215]
    v_mfma_f32_32x32x16_bf16 v[184:199], a[12:15], v[140:143], v[184:199]
    v_mfma_f32_32x32x16_bf16 v[200:215], a[124:127], v[140:143], v[200:215]
    v_mfma_f32_32x32x16_bf16 v[184:199], a[16:19], v[144:147], v[184:199]
    v_mfma_f32_32x32x16_bf16 v[200:215], a[128:131], v[144:147], v[200:215]
    v_mfma_f32_32x32x16_bf16 v[184:199], a[20:23], v[148:151], v[184:199]
    v_mfma_f32_32x32x16_bf16 v[200:215], a[132:135], v[148:151], v[200:215]
    v_mfma_f32_32x32x16_bf16 v[184:199], a[24:27], v[152:155], v[184:199]
    v_mfma_f32_32x32x16_bf16 v[200:215], a[136:139], v[152:155], v[200:215]
    v_mfma_f32_32x32x16_bf16 v[184:199], a[28:31], v[156:159], v[184:199]
    v_mfma_f32_32x32x16_bf16 v[200:215], a[140:143], v[156:159], v[200:215]
    v_mfma_f32_32x32x16_bf16 v[184:199], a[32:35], v[160:163], v[184:199]
    v_mfma_f32_32x32x16_bf16 v[200:215], a[144:147], v[160:163], v[200:215]
    v_mfma_f32_32x32x16_bf16 v[184:199], a[36:39], v[164:167], v[184:199]
    v_mfma_f32_32x32x16_bf16 v[200:215], a[148:151], v[164:167], v[200:215]
    v_mfma_f32_32x32x16_bf16 v[184:199], a[40:43], v[168:171], v[184:199]
    v_mfma_f32_32x32x16_bf16 v[200:215], a[152:155], v[168:171], v[200:215]
    v_mfma_f32_32x32x16_bf16 v[184:199], a[44:47], v[172:175], v[184:199]
    v_mfma_f32_32x32x16_bf16 v[200:215], a[156:159], v[172:175], v[200:215]
    v_mfma_f32_32x32x16_bf16 v[184:199], a[48:51], v[176:179], v[184:199]
    v_mfma_f32_32x32x16_bf16 v[200:215], a[160:163], v[176:179], v[200:215]
    v_mfma_f32_32x32x16_bf16 v[184:199], a[52:55], v[180:183], v[184:199]
    v_mfma_f32_32x32x16_bf16 v[200:215], a[164:167], v[180:183], v[200:215]
    s_add_u32 s39, s36, 12288
    buffer_load_dwordx4 v[128:131], v5, s[48:51], s39 offen offset:2048
    buffer_load_dwordx4 v[132:135], v5, s[48:51], s39 offen offset:3072
    s_add_u32 s39, s36, 16384
    buffer_load_dwordx4 v[136:139], v5, s[48:51], s39 offen offset:0
    buffer_load_dwordx4 v[140:143], v5, s[48:51], s39 offen offset:1024
    buffer_load_dwordx4 v[144:147], v5, s[48:51], s39 offen offset:2048
    buffer_load_dwordx4 v[148:151], v5, s[48:51], s39 offen offset:3072
    s_add_u32 s39, s36, 20480
    buffer_load_dwordx4 v[152:155], v5, s[48:51], s39 offen offset:0
    buffer_load_dwordx4 v[156:159], v5, s[48:51], s39 offen offset:1024
    buffer_load_dwordx4 v[160:163], v5, s[48:51], s39 offen offset:2048
    buffer_load_dwordx4 v[164:167], v5, s[48:51], s39 offen offset:3072
    s_add_u32 s39, s36, 24576
    buffer_load_dwordx4 v[168:171], v5, s[48:51], s39 offen offset:0
    buffer_load_dwordx4 v[172:175], v5, s[48:51], s39 offen offset:1024
    buffer_load_dwordx4 v[176:179], v5, s[48:51], s39 offen offset:2048
    buffer_load_dwordx4 v[180:183], v5, s[48:51], s39 offen offset:3072
    s_add_u32 s36, s36, 114688
    s_waitcnt vmcnt(28)
    v_mfma_f32_32x32x16_bf16 v[184:199], a[56:59], v[16:19], v[184:199]
    v_mfma_f32_32x32x16_bf16 v[200:215], a[168:171], v[16:19], v[200:215]
    v_mfma_f32_32x32x16_bf16 v[184:199], a[60:63], v[20:23], v[184:199]
    v_mfma_f32_32x32x16_bf16 v[200:215], a[172:175], v[20:23], v[200:215]
    v_mfma_f32_32x32x16_bf16 v[184:199], a[64:67], v[24:27], v[184:199]
    v_mfma_f32_32x32x16_bf16 v[200:215], a[176:179], v[24:27], v[200:215]
    v_mfma_f32_32x32x16_bf16 v[184:199], a[68:71], v[28:31], v[184:199]
    v_mfma_f32_32x32x16_bf16 v[200:215], a[180:183], v[28:31], v[200:215]
    v_mfma_f32_32x32x16_bf16 v[184:199], a[72:75], v[32:35], v[184:199]
    v_mfma_f32_32x32x16_bf16 v[200:215], a[184:187], v[32:35], v[200:215]
    v_mfma_f32_32x32x16_bf16 v[184:199], a[76:79], v[36:39], v[184:199]
    v_mfma_f32_32x32x16_bf16 v[200:215], a[188:191], v[36:39], v[200:215]
    v_mfma_f32_32x32x16_bf16 v[184:199], a[80:83], v[40:43], v[184:199]
    v_mfma_f32_32x32x16_bf16 v[200:215], a[192:195], v[40:43], v[200:215]
    v_mfma_f32_32x32x16_bf16 v[184:199], a[84:87], v[44:47], v[184:199]
    v_mfma_f32_32x32x16_bf16 v[200:215], a[196:199], v[44:47], v[200:215]
    v_mfma_f32_32x32x16_bf16 v[184:199], a[88:91], v[48:51], v[184:199]
    v_mfma_f32_32x32x16_bf16 v[200:215], a[200:203], v[48:51], v[200:215]
    v_mfma_f32_32x32x16_bf16 v[184:199], a[92:95], v[52:55], v[184:199]
    v_mfma_f32_32x32x16_bf16 v[200:215], a[204:207], v[52:55], v[200:215]
    v_mfma_f32_32x32x16_bf16 v[184:199], a[96:99], v[56:59], v[184:199]
    v_mfma_f32_32x32x16_bf16 v[200:215], a[208:211], v[56:59], v[200:215]
    v_mfma_f32_32x32x16_bf16 v[184:199], a[100:103], v[60:63], v[184:199]
    v_mfma_f32_32x32x16_bf16 v[200:215], a[212:215], v[60:63], v[200:215]
    v_mfma_f32_32x32x16_bf16 v[184:199], a[104:107], v[64:67], v[184:199]
    v_mfma_f32_32x32x16_bf16 v[200:215], a[216:219], v[64:67], v[200:215]
    v_mfma_f32_32x32x16_bf16 v[184:199], a[108:111], v[68:71], v[184:199]
    v_mfma_f32_32x32x16_bf16 v[200:215], a[220:223], v[68:71], v[200:215]
    s_nop 15
    s_nop 1
    v_cvt_pk_bf16_f32 v216, v184, v185
    v_cvt_pk_bf16_f32 v217, v186, v187
    v_cvt_pk_bf16_f32 v218, v188, v189
    v_cvt_pk_bf16_f32 v219, v190, v191
    v_cvt_pk_bf16_f32 v220, v192, v193
    v_cvt_pk_bf16_f32 v221, v194, v195
    v_cvt_pk_bf16_f32 v222, v196, v197
    v_cvt_pk_bf16_f32 v223, v198, v199
    v_cvt_pk_bf16_f32 v224, v200, v201
    v_cvt_pk_bf16_f32 v225, v202, v203
    v_cvt_pk_bf16_f32 v226, v204, v205
    v_cvt_pk_bf16_f32 v227, v206, v207
    v_cvt_pk_bf16_f32 v228, v208, v209
    v_cvt_pk_bf16_f32 v229, v210, v211
    v_cvt_pk_bf16_f32 v230, v212, v213
    v_cvt_pk_bf16_f32 v231, v214, v215
    buffer_store_dwordx4 v[216:219], v6, s[52:55], s37 offen offset:0 sc1
    buffer_store_dwordx4 v[220:223], v6, s[52:55], s37 offen offset:256 sc1
    buffer_store_dwordx4 v[224:227], v6, s[52:55], s37 offen offset:512 sc1
    buffer_store_dwordx4 v[228:231], v6, s[52:55], s37 offen offset:768 sc1
    s_add_u32 s37, s37, 1835008
    s_add_u32 s39, s36, 0
    buffer_load_dwordx4 v[16:19], v5, s[48:51], s39 offen offset:0
    buffer_load_dwordx4 v[20:23], v5, s[48:51], s39 offen offset:1024
    buffer_load_dwordx4 v[24:27], v5, s[48:51], s39 offen offset:2048
    buffer_load_dwordx4 v[28:31], v5, s[48:51], s39 offen offset:3072
    s_add_u32 s39, s36, 4096
    buffer_load_dwordx4 v[32:35], v5, s[48:51], s39 offen offset:0
    buffer_load_dwordx4 v[36:39], v5, s[48:51], s39 offen offset:1024
    buffer_load_dwordx4 v[40:43], v5, s[48:51], s39 offen offset:2048
    buffer_load_dwordx4 v[44:47], v5, s[48:51], s39 offen offset:3072
    s_add_u32 s39, s36, 8192
    buffer_load_dwordx4 v[48:51], v5, s[48:51], s39 offen offset:0
    buffer_load_dwordx4 v[52:55], v5, s[48:51], s39 offen offset:1024
    buffer_load_dwordx4 v[56:59], v5, s[48:51], s39 offen offset:2048
    buffer_load_dwordx4 v[60:63], v5, s[48:51], s39 offen offset:3072
    s_add_u32 s39, s36, 12288
    buffer_load_dwordx4 v[64:67], v5, s[48:51], s39 offen offset:0
    buffer_load_dwordx4 v[68:71], v5, s[48:51], s39 offen offset:1024
    s_waitcnt vmcnt(28)
    v_mfma_f32_32x32x16_bf16 v[184:199], a[0:3], v[72:75], 0
    v_mfma_f32_32x32x16_bf16 v[200:215], a[112:115], v[72:75], 0
    v_mfma_f32_32x32x16_bf16 v[184:199], a[4:7], v[76:79], v[184:199]
    v_mfma_f32_32x32x16_bf16 v[200:215], a[116:119], v[76:79], v[200:215]
    v_mfma_f32_32x32x16_bf16 v[184:199], a[8:11], v[80:83], v[184:199]
    v_mfma_f32_32x32x16_bf16 v[200:215], a[120:123], v[80:83], v[200:215]
    v_mfma_f32_32x32x16_bf16 v[184:199], a[12:15], v[84:87], v[184:199]
    v_mfma_f32_32x32x16_bf16 v[200:215], a[124:127], v[84:87], v[200:215]
    v_mfma_f32_32x32x16_bf16 v[184:199], a[16:19], v[88:91], v[184:199]
    v_mfma_f32_32x32x16_bf16 v[200:215], a[128:131], v[88:91], v[200:215]
    v_mfma_f32_32x32x16_bf16 v[184:199], a[20:23], v[92:95], v[184:199]
    v_mfma_f32_32x32x16_bf16 v[200:215], a[132:135], v[92:95], v[200:215]
    v_mfma_f32_32x32x16_bf16 v[184:199], a[24:27], v[96:99], v[184:199]
    v_mfma_f32_32x32x16_bf16 v[200:215], a[136:139], v[96:99], v[200:215]
    v_mfma_f32_32x32x16_bf16 v[184:199], a[28:31], v[100:103], v[184:199]
    v_mfma_f32_32x32x16_bf16 v[200:215], a[140:143], v[100:103], v[200:215]
    v_mfma_f32_32x32x16_bf16 v[184:199], a[32:35], v[104:107], v[184:199]
    v_mfma_f32_32x32x16_bf16 v[200:215], a[144:147], v[104:107], v[200:215]
    v_mfma_f32_32x32x16_bf16 v[184:199], a[36:39], v[108:111], v[184:199]
    v_mfma_f32_32x32x16_bf16 v[200:215], a[148:151], v[108:111], v[200:215]
    v_mfma_f32_32x32x16_bf16 v[184:199], a[40:43], v[112:115], v[184:199]
    v_mfma_f32_32x32x16_bf16 v[200:215], a[152:155], v[112:115], v[200:215]
    v_mfma_f32_32x32x16_bf16 v[184:199], a[44:47], v[116:119], v[184:199]
    v_mfma_f32_32x32x16_bf16 v[200:215], a[156:159], v[116:119], v[200:215]
    v_mfma_f32_32x32x16_bf16 v[184:199], a[48:51], v[120:123], v[184:199]
    v_mfma_f32_32x32x16_bf16 v[200:215], a[160:163], v[120:123], v[200:215]
    v_mfma_f32_32x32x16_bf16 v[184:199], a[52:55], v[124:127], v[184:199]
    v_mfma_f32_32x32x16_bf16 v[200:215], a[164:167], v[124:127], v[200:215]
    s_add_u32 s39, s36, 12288
    buffer_load_dwordx4 v[72:75], v5, s[48:51], s39 offen offset:2048
    buffer_load_dwordx4 v[76:79], v5, s[48:51], s39 offen offset:3072
    s_add_u32 s39, s36, 16384
    buffer_load_dwordx4 v[80:83], v5, s[48:51], s39 offen offset:0
    buffer_load_dwordx4 v[84:87], v5, s[48:51], s39 offen offset:1024
    buffer_load_dwordx4 v[88:91], v5, s[48:51], s39 offen offset:2048
    buffer_load_dwordx4 v[92:95], v5, s[48:51], s39 offen offset:3072
    s_add_u32 s39, s36, 20480
    buffer_load_dwordx4 v[96:99], v5, s[48:51], s39 offen offset:0
    buffer_load_dwordx4 v[100:103], v5, s[48:51], s39 offen offset:1024
    buffer_load_dwordx4 v[104:107], v5, s[48:51], s39 offen offset:2048
    buffer_load_dwordx4 v[108:111], v5, s[48:51], s39 offen offset:3072
    s_add_u32 s39, s36, 24576
    buffer_load_dwordx4 v[112:115], v5, s[48:51], s39 offen offset:0
    buffer_load_dwordx4 v[116:119], v5, s[48:51], s39 offen offset:1024
    buffer_load_dwordx4 v[120:123], v5, s[48:51], s39 offen offset:2048
    buffer_load_dwordx4 v[124:127], v5, s[48:51], s39 offen offset:3072
    s_add_u32 s36, s36, 114688
    s_waitcnt vmcnt(28)
    s_barrier
    v_mov_b32 v13, 0
    s_lshl_b32 s22, s100, 2
    s_add_u32 s22, s22, 10240
    v_cmp_eq_u32 vcc, 0, v0
    s_and_b64 exec, exec, vcc
    buffer_store_dword v13, v13, s[96:99], s22 offen offset:0 sc1
    s_mov_b64 exec, -1
    v_mfma_f32_32x32x16_bf16 v[184:199], a[56:59], v[128:131], v[184:199]
    v_mfma_f32_32x32x16_bf16 v[200:215], a[168:171], v[128:131], v[200:215]
    v_mfma_f32_32x32x16_bf16 v[184:199], a[60:63], v[132:135], v[184:199]
    v_mfma_f32_32x32x16_bf16 v[200:215], a[172:175], v[132:135], v[200:215]
    v_mfma_f32_32x32x16_bf16 v[184:199], a[64:67], v[136:139], v[184:199]
    v_mfma_f32_32x32x16_bf16 v[200:215], a[176:179], v[136:139], v[200:215]
    v_mfma_f32_32x32x16_bf16 v[184:199], a[68:71], v[140:143], v[184:199]
    v_mfma_f32_32x32x16_bf16 v[200:215], a[180:183], v[140:143], v[200:215]
    v_mfma_f32_32x32x16_bf16 v[184:199], a[72:75], v[144:147], v[184:199]
    v_mfma_f32_32x32x16_bf16 v[200:215], a[184:187], v[144:147], v[200:215]
    v_mfma_f32_32x32x16_bf16 v[184:199], a[76:79], v[148:151], v[184:199]
    v_mfma_f32_32x32x16_bf16 v[200:215], a[188:191], v[148:151], v[200:215]
    v_mfma_f32_32x32x16_bf16 v[184:199], a[80:83], v[152:155], v[184:199]
    v_mfma_f32_32x32x16_bf16 v[200:215], a[192:195], v[152:155], v[200:215]
    v_mfma_f32_32x32x16_bf16 v[184:199], a[84:87], v[156:159], v[184:199]
    v_mfma_f32_32x32x16_bf16 v[200:215], a[196:199], v[156:159], v[200:215]
    v_mfma_f32_32x32x16_bf16 v[184:199], a[88:91], v[160:163], v[184:199]
    v_mfma_f32_32x32x16_bf16 v[200:215], a[200:203], v[160:163], v[200:215]
    v_mfma_f32_32x32x16_bf16 v[184:199], a[92:95], v[164:167], v[184:199]
    v_mfma_f32_32x32x16_bf16 v[200:215], a[204:207], v[164:167], v[200:215]
    v_mfma_f32_32x32x16_bf16 v[184:199], a[96:99], v[168:171], v[184:199]
    v_mfma_f32_32x32x16_bf16 v[200:215], a[208:211], v[168:171], v[200:215]
    v_mfma_f32_32x32x16_bf16 v[184:199], a[100:103], v[172:175], v[184:199]
    v_mfma_f32_32x32x16_bf16 v[200:215], a[212:215], v[172:175], v[200:215]
    v_mfma_f32_32x32x16_bf16 v[184:199], a[104:107], v[176:179], v[184:199]
    v_mfma_f32_32x32x16_bf16 v[200:215], a[216:219], v[176:179], v[200:215]
    v_mfma_f32_32x32x16_bf16 v[184:199], a[108:111], v[180:183], v[184:199]
    v_mfma_f32_32x32x16_bf16 v[200:215], a[220:223], v[180:183], v[200:215]
    s_nop 15
    s_nop 1
    v_cvt_pk_bf16_f32 v216, v184, v185
    v_cvt_pk_bf16_f32 v217, v186, v187
    v_cvt_pk_bf16_f32 v218, v188, v189
    v_cvt_pk_bf16_f32 v219, v190, v191
    v_cvt_pk_bf16_f32 v220, v192, v193
    v_cvt_pk_bf16_f32 v221, v194, v195
    v_cvt_pk_bf16_f32 v222, v196, v197
    v_cvt_pk_bf16_f32 v223, v198, v199
    v_cvt_pk_bf16_f32 v224, v200, v201
    v_cvt_pk_bf16_f32 v225, v202, v203
    v_cvt_pk_bf16_f32 v226, v204, v205
    v_cvt_pk_bf16_f32 v227, v206, v207
    v_cvt_pk_bf16_f32 v228, v208, v209
    v_cvt_pk_bf16_f32 v229, v210, v211
    v_cvt_pk_bf16_f32 v230, v212, v213
    v_cvt_pk_bf16_f32 v231, v214, v215
    buffer_store_dwordx4 v[216:219], v6, s[52:55], s37 offen offset:0 sc1
    buffer_store_dwordx4 v[220:223], v6, s[52:55], s37 offen offset:256 sc1
    buffer_store_dwordx4 v[224:227], v6, s[52:55], s37 offen offset:512 sc1
    buffer_store_dwordx4 v[228:231], v6, s[52:55], s37 offen offset:768 sc1
    s_add_u32 s37, s37, 1835008
    s_waitcnt vmcnt(14)
    v_mfma_f32_32x32x16_bf16 v[184:199], a[0:3], v[16:19], 0
    v_mfma_f32_32x32x16_bf16 v[200:215], a[112:115], v[16:19], 0
    v_mfma_f32_32x32x16_bf16 v[184:199], a[4:7], v[20:23], v[184:199]
    v_mfma_f32_32x32x16_bf16 v[200:215], a[116:119], v[20:23], v[200:215]
    v_mfma_f32_32x32x16_bf16 v[184:199], a[8:11], v[24:27], v[184:199]
    v_mfma_f32_32x32x16_bf16 v[200:215], a[120:123], v[24:27], v[200:215]
    v_mfma_f32_32x32x16_bf16 v[184:199], a[12:15], v[28:31], v[184:199]
    v_mfma_f32_32x32x16_bf16 v[200:215], a[124:127], v[28:31], v[200:215]
    v_mfma_f32_32x32x16_bf16 v[184:199], a[16:19], v[32:35], v[184:199]
    v_mfma_f32_32x32x16_bf16 v[200:215], a[128:131], v[32:35], v[200:215]
    v_mfma_f32_32x32x16_bf16 v[184:199], a[20:23], v[36:39], v[184:199]
    v_mfma_f32_32x32x16_bf16 v[200:215], a[132:135], v[36:39], v[200:215]
    v_mfma_f32_32x32x16_bf16 v[184:199], a[24:27], v[40:43], v[184:199]
    v_mfma_f32_32x32x16_bf16 v[200:215], a[136:139], v[40:43], v[200:215]
    v_mfma_f32_32x32x16_bf16 v[184:199], a[28:31], v[44:47], v[184:199]
    v_mfma_f32_32x32x16_bf16 v[200:215], a[140:143], v[44:47], v[200:215]
    v_mfma_f32_32x32x16_bf16 v[184:199], a[32:35], v[48:51], v[184:199]
    v_mfma_f32_32x32x16_bf16 v[200:215], a[144:147], v[48:51], v[200:215]
    v_mfma_f32_32x32x16_bf16 v[184:199], a[36:39], v[52:55], v[184:199]
    v_mfma_f32_32x32x16_bf16 v[200:215], a[148:151], v[52:55], v[200:215]
    v_mfma_f32_32x32x16_bf16 v[184:199], a[40:43], v[56:59], v[184:199]
    v_mfma_f32_32x32x16_bf16 v[200:215], a[152:155], v[56:59], v[200:215]
    v_mfma_f32_32x32x16_bf16 v[184:199], a[44:47], v[60:63], v[184:199]
    v_mfma_f32_32x32x16_bf16 v[200:215], a[156:159], v[60:63], v[200:215]
    v_mfma_f32_32x32x16_bf16 v[184:199], a[48:51], v[64:67], v[184:199]
    v_mfma_f32_32x32x16_bf16 v[200:215], a[160:163], v[64:67], v[200:215]
    v_mfma_f32_32x32x16_bf16 v[184:199], a[52:55], v[68:71], v[184:199]
    v_mfma_f32_32x32x16_bf16 v[200:215], a[164:167], v[68:71], v[200:215]
    s_waitcnt vmcnt(0)
    v_mfma_f32_32x32x16_bf16 v[184:199], a[56:59], v[72:75], v[184:199]
    v_mfma_f32_32x32x16_bf16 v[200:215], a[168:171], v[72:75], v[200:215]
    v_mfma_f32_32x32x16_bf16 v[184:199], a[60:63], v[76:79], v[184:199]
    v_mfma_f32_32x32x16_bf16 v[200:215], a[172:175], v[76:79], v[200:215]
    v_mfma_f32_32x32x16_bf16 v[184:199], a[64:67], v[80:83], v[184:199]
    v_mfma_f32_32x32x16_bf16 v[200:215], a[176:179], v[80:83], v[200:215]
    v_mfma_f32_32x32x16_bf16 v[184:199], a[68:71], v[84:87], v[184:199]
    v_mfma_f32_32x32x16_bf16 v[200:215], a[180:183], v[84:87], v[200:215]
    v_mfma_f32_32x32x16_bf16 v[184:199], a[72:75], v[88:91], v[184:199]
    v_mfma_f32_32x32x16_bf16 v[200:215], a[184:187], v[88:91], v[200:215]
    v_mfma_f32_32x32x16_bf16 v[184:199], a[76:79], v[92:95], v[184:199]
    v_mfma_f32_32x32x16_bf16 v[200:215], a[188:191], v[92:95], v[200:215]
    v_mfma_f32_32x32x16_bf16 v[184:199], a[80:83], v[96:99], v[184:199]
    v_mfma_f32_32x32x16_bf16 v[200:215], a[192:195], v[96:99], v[200:215]
    v_mfma_f32_32x32x16_bf16 v[184:199], a[84:87], v[100:103], v[184:199]
    v_mfma_f32_32x32x16_bf16 v[200:215], a[196:199], v[100:103], v[200:215]
    v_mfma_f32_32x32x16_bf16 v[184:199], a[88:91], v[104:107], v[184:199]
    v_mfma_f32_32x32x16_bf16 v[200:215], a[200:203], v[104:107], v[200:215]
    v_mfma_f32_32x32x16_bf16 v[184:199], a[92:95], v[108:111], v[184:199]
    v_mfma_f32_32x32x16_bf16 v[200:215], a[204:207], v[108:111], v[200:215]
    v_mfma_f32_32x32x16_bf16 v[184:199], a[96:99], v[112:115], v[184:199]
    v_mfma_f32_32x32x16_bf16 v[200:215], a[208:211], v[112:115], v[200:215]
    v_mfma_f32_32x32x16_bf16 v[184:199], a[100:103], v[116:119], v[184:199]
    v_mfma_f32_32x32x16_bf16 v[200:215], a[212:215], v[116:119], v[200:215]
    v_mfma_f32_32x32x16_bf16 v[184:199], a[104:107], v[120:123], v[184:199]
    v_mfma_f32_32x32x16_bf16 v[200:215], a[216:219], v[120:123], v[200:215]
    v_mfma_f32_32x32x16_bf16 v[184:199], a[108:111], v[124:127], v[184:199]
    v_mfma_f32_32x32x16_bf16 v[200:215], a[220:223], v[124:127], v[200:215]
    s_nop 15
    s_nop 1
    v_cvt_pk_bf16_f32 v216, v184, v185
    v_cvt_pk_bf16_f32 v217, v186, v187
    v_cvt_pk_bf16_f32 v218, v188, v189
    v_cvt_pk_bf16_f32 v219, v190, v191
    v_cvt_pk_bf16_f32 v220, v192, v193
    v_cvt_pk_bf16_f32 v221, v194, v195
    v_cvt_pk_bf16_f32 v222, v196, v197
    v_cvt_pk_bf16_f32 v223, v198, v199
    v_cvt_pk_bf16_f32 v224, v200, v201
    v_cvt_pk_bf16_f32 v225, v202, v203
    v_cvt_pk_bf16_f32 v226, v204, v205
    v_cvt_pk_bf16_f32 v227, v206, v207
    v_cvt_pk_bf16_f32 v228, v208, v209
    v_cvt_pk_bf16_f32 v229, v210, v211
    v_cvt_pk_bf16_f32 v230, v212, v213
    v_cvt_pk_bf16_f32 v231, v214, v215
    buffer_store_dwordx4 v[216:219], v6, s[52:55], s37 offen offset:0 sc1
    buffer_store_dwordx4 v[220:223], v6, s[52:55], s37 offen offset:256 sc1
    buffer_store_dwordx4 v[224:227], v6, s[52:55], s37 offen offset:512 sc1
    buffer_store_dwordx4 v[228:231], v6, s[52:55], s37 offen offset:768 sc1
    s_add_u32 s37, s37, 1835008
    s_waitcnt vmcnt(0)
    s_barrier
    v_mov_b32 v13, 0
    s_lshl_b32 s22, s100, 2
    s_add_u32 s22, s22, 11264
    v_cmp_eq_u32 vcc, 0, v0
    s_and_b64 exec, exec, vcc
    buffer_store_dword v13, v13, s[96:99], s22 offen offset:0 sc1
    s_mov_b64 exec, -1
    s_branch wk_loop
gx_m1:
    s_lshl_b32 s22, s19, 4
    s_add_u32 s22, s22, s18
    s_mul_i32 s22, s22, 28672
    s_lshl_b32 s23, s16, 10
    s_add_u32 s22, s22, s23
    v_lshlrev_b32 v6, 4, v10
    v_add_u32 v6, s22, v6
    v_mul_u32_u24 v7, 7168, v4
    v_add_u32 v6, v6, v7
    v_add_u32 v7, 14336, v6
    s_add_u32 s39, s36, 0
    buffer_load_dwordx4 v[128:131], v5, s[48:51], s39 offen offset:0
    buffer_load_dwordx4 v[132:135], v5, s[48:51], s39 offen offset:1024
    buffer_load_dwordx4 v[136:139], v5, s[48:51], s39 offen offset:2048
    buffer_load_dwordx4 v[140:143], v5, s[48:51], s39 offen offset:3072
    s_add_u32 s39, s36, 4096
    buffer_load_dwordx4 v[144:147], v5, s[48:51], s39 offen offset:0
    buffer_load_dwordx4 v[148:151], v5, s[48:51], s39 offen offset:1024
    buffer_load_dwordx4 v[152:155], v5, s[48:51], s39 offen offset:2048
    buffer_load_dwordx4 v[156:159], v5, s[48:51], s39 offen offset:3072
    s_add_u32 s39, s36, 8192
    buffer_load_dwordx4 v[160:163], v5, s[48:51], s39 offen offset:0
    buffer_load_dwordx4 v[164:167], v5, s[48:51], s39 offen offset:1024
    buffer_load_dwordx4 v[168:171], v5, s[48:51], s39 offen offset:2048
    buffer_load_dwordx4 v[172:175], v5, s[48:51], s39 offen offset:3072
    s_add_u32 s39, s36, 12288
    buffer_load_dwordx4 v[176:179], v5, s[48:51], s39 offen offset:0
    buffer_load_dwordx4 v[180:183], v5, s[48:51], s39 offen offset:1024
    s_waitcnt vmcnt(28)
    v_mfma_f32_32x32x16_bf16 v[184:199], v[16:19], a[0:3], 0
    v_mfma_f32_32x32x16_bf16 v[200:215], v[16:19], a[112:115], 0
    v_mfma_f32_32x32x16_bf16 v[184:199], v[20:23], a[4:7], v[184:199]
    v_mfma_f32_32x32x16_bf16 v[200:215], v[20:23], a[116:119], v[200:215]
    v_mfma_f32_32x32x16_bf16 v[184:199], v[24:27], a[8:11], v[184:199]
    v_mfma_f32_32x32x16_bf16 v[200:215], v[24:27], a[120:123], v[200:215]
    v_mfma_f32_32x32x16_bf16 v[184:199], v[28:31], a[12:15], v[184:199]
    v_mfma_f32_32x32x16_bf16 v[200:215], v[28:31], a[124:127], v[200:215]
    v_mfma_f32_32x32x16_bf16 v[184:199], v[32:35], a[16:19], v[184:199]
    v_mfma_f32_32x32x16_bf16 v[200:215], v[32:35], a[128:131], v[200:215]
    v_mfma_f32_32x32x16_bf16 v[184:199], v[36:39], a[20:23], v[184:199]
    v_mfma_f32_32x32x16_bf16 v[200:215], v[36:39], a[132:135], v[200:215]
    v_mfma_f32_32x32x16_bf16 v[184:199], v[40:43], a[24:27], v[184:199]
    v_mfma_f32_32x32x16_bf16 v[200:215], v[40:43], a[136:139], v[200:215]
    v_mfma_f32_32x32x16_bf16 v[184:199], v[44:47], a[28:31], v[184:199]
    v_mfma_f32_32x32x16_bf16 v[200:215], v[44:47], a[140:143], v[200:215]
    v_mfma_f32_32x32x16_bf16 v[184:199], v[48:51], a[32:35], v[184:199]
    v_mfma_f32_32x32x16_bf16 v[200:215], v[48:51], a[144:147], v[200:215]
    v_mfma_f32_32x32x16_bf16 v[184:199], v[52:55], a[36:39], v[184:199]
    v_mfma_f32_32x32x16_bf16 v[200:215], v[52:55], a[148:151], v[200:215]
    v_mfma_f32_32x32x16_bf16 v[184:199], v[56:59], a[40:43], v[184:199]
    v_mfma_f32_32x32x16_bf16 v[200:215], v[56:59], a[152:155], v[200:215]
    v_mfma_f32_32x32x16_bf16 v[184:199], v[60:63], a[44:47], v[184:199]
    v_mfma_f32_32x32x16_bf16 v[200:215], v[60:63], a[156:159], v[200:215]
    v_mfma_f32_32x32x16_bf16 v[184:199], v[64:67], a[48:51], v[184:199]
    v_mfma_f32_32x32x16_bf16 v[200:215], v[64:67], a[160:163], v[200:215]
    v_mfma_f32_32x32x16_bf16 v[184:199], v[68:71], a[52:55], v[184:199]
    v_mfma_f32_32x32x16_bf16 v[200:215], v[68:71], a[164:167], v[200:215]
    s_add_u32 s39, s36, 12288
    buffer_load_dwordx4 v[16:19], v5, s[48:51], s39 offen offset:2048
    buffer_load_dwordx4 v[20:23], v5, s[48:51], s39 offen offset:3072
    s_add_u32 s39, s36, 16384
    buffer_load_dwordx4 v[24:27], v5, s[48:51], s39 offen offset:0
    buffer_load_dwordx4 v[28:31], v5, s[48:51], s39 offen offset:1024
    buffer_load_dwordx4 v[32:35], v5, s[48:51], s39 offen offset:2048
    buffer_load_dwordx4 v[36:39], v5, s[48:51], s39 offen offset:3072
    s_add_u32 s39, s36, 20480
    buffer_load_dwordx4 v[40:43], v5, s[48:51], s39 offen offset:0
    buffer_load_dwordx4 v[44:47], v5, s[48:51], s39 offen offset:1024
    buffer_load_dwordx4 v[48:51], v5, s[48:51], s39 offen offset:2048
    buffer_load_dwordx4 v[52:55], v5, s[48:51], s39 offen offset:3072
    s_add_u32 s39, s36, 24576
    buffer_load_dwordx4 v[56:59], v5, s[48:51], s39 offen offset:0
    buffer_load_dwordx4 v[60:63], v5, s[48:51], s39 offen offset:1024
    buffer_load_dwordx4 v[64:67], v5, s[48:51], s39 offen offset:2048
    buffer_load_dwordx4 v[68:71], v5, s[48:51], s39 offen offset:3072
    s_add_u32 s36, s36, 114688
    s_waitcnt vmcnt(28)
    v_mfma_f32_32x32x16_bf16 v[184:199], v[72:75], a[56:59], v[184:199]
    v_mfma_f32_32x32x16_bf16 v[200:215], v[72:75], a[168:171], v[200:215]
    v_mfma_f32_32x32x16_bf16 v[184:199], v[76:79], a[60:63], v[184:199]
    v_mfma_f32_32x32x16_bf16 v[200:215], v[76:79], a[172:175], v[200:215]
    v_mfma_f32_32x32x16_bf16 v[184:199], v[80:83], a[64:67], v[184:199]
    v_mfma_f32_32x32x16_bf16 v[200:215], v[80:83], a[176:179], v[200:215]
    v_mfma_f32_32x32x16_bf16 v[184:199], v[84:87], a[68:71], v[184:199]
    v_mfma_f32_32x32x16_bf16 v[200:215], v[84:87], a[180:183], v[200:215]
    v_mfma_f32_32x32x16_bf16 v[184:199], v[88:91], a[72:75], v[184:199]
    v_mfma_f32_32x32x16_bf16 v[200:215], v[88:91], a[184:187], v[200:215]
    v_mfma_f32_32x32x16_bf16 v[184:199], v[92:95], a[76:79], v[184:199]
    v_mfma_f32_32x32x16_bf16 v[200:215], v[92:95], a[188:191], v[200:215]
    v_mfma_f32_32x32x16_bf16 v[184:199], v[96:99], a[80:83], v[184:199]
    v_mfma_f32_32x32x16_bf16 v[200:215], v[96:99], a[192:195], v[200:215]
    v_mfma_f32_32x32x16_bf16 v[184:199], v[100:103], a[84:87], v[184:199]
    v_mfma_f32_32x32x16_bf16 v[200:215], v[100:103], a[196:199], v[200:215]
    v_mfma_f32_32x32x16_bf16 v[184:199], v[104:107], a[88:91], v[184:199]
    v_mfma_f32_32x32x16_bf16 v[200:215], v[104:107], a[200:203], v[200:215]
    v_mfma_f32_32x32x16_bf16 v[184:199], v[108:111], a[92:95], v[184:199]
    v_mfma_f32_32x32x16_bf16 v[200:215], v[108:111], a[204:207], v[200:215]
    v_mfma_f32_32x32x16_bf16 v[184:199], v[112:115], a[96:99], v[184:199]
    v_mfma_f32_32x32x16_bf16 v[200:215], v[112:115], a[208:211], v[200:215]
    v_mfma_f32_32x32x16_bf16 v[184:199], v[116:119], a[100:103], v[184:199]
    v_mfma_f32_32x32x16_bf16 v[200:215], v[116:119], a[212:215], v[200:215]
    v_mfma_f32_32x32x16_bf16 v[184:199], v[120:123], a[104:107], v[184:199]
    v_mfma_f32_32x32x16_bf16 v[200:215], v[120:123], a[216:219], v[200:215]
    v_mfma_f32_32x32x16_bf16 v[184:199], v[124:127], a[108:111], v[184:199]
    v_mfma_f32_32x32x16_bf16 v[200:215], v[124:127], a[220:223], v[200:215]
    s_nop 15
    s_nop 1
    v_cvt_pk_bf16_f32 v216, v184, v185
    v_cvt_pk_bf16_f32 v217, v186, v187
    v_cvt_pk_bf16_f32 v218, v188, v189
    v_cvt_pk_bf16_f32 v219, v190, v191
    v_cvt_pk_bf16_f32 v220, v192, v193
    v_cvt_pk_bf16_f32 v221, v194, v195
    v_cvt_pk_bf16_f32 v222, v196, v197
    v_cvt_pk_bf16_f32 v223, v198, v199
    v_cvt_pk_bf16_f32 v224, v200, v201
    v_cvt_pk_bf16_f32 v225, v202, v203
    v_cvt_pk_bf16_f32 v226, v204, v205
    v_cvt_pk_bf16_f32 v227, v206, v207
    v_cvt_pk_bf16_f32 v228, v208, v209
    v_cvt_pk_bf16_f32 v229, v210, v211
    v_cvt_pk_bf16_f32 v230, v212, v213
    v_cvt_pk_bf16_f32 v231, v214, v215
    buffer_store_dwordx4 v[216:219], v6, s[56:59], s37 offen offset:0 sc1
    buffer_store_dwordx4 v[220:223], v7, s[56:59], s37 offen offset:0 sc1
    buffer_store_dwordx4 v[224:227], v6, s[56:59], s37 offen offset:512 sc1
    buffer_store_dwordx4 v[228:231], v7, s[56:59], s37 offen offset:512 sc1
    s_add_u32 s37, s37, 1835008
    s_add_u32 s39, s36, 0
    buffer_load_dwordx4 v[72:75], v5, s[48:51], s39 offen offset:0
    buffer_load_dwordx4 v[76:79], v5, s[48:51], s39 offen offset:1024
    buffer_load_dwordx4 v[80:83], v5, s[48:51], s39 offen offset:2048
    buffer_load_dwordx4 v[84:87], v5, s[48:51], s39 offen offset:3072
    s_add_u32 s39, s36, 4096
    buffer_load_dwordx4 v[88:91], v5, s[48:51], s39 offen offset:0
    buffer_load_dwordx4 v[92:95], v5, s[48:51], s39 offen offset:1024
    buffer_load_dwordx4 v[96:99], v5, s[48:51], s39 offen offset:2048
    buffer_load_dwordx4 v[100:103], v5, s[48:51], s39 offen offset:3072
    s_add_u32 s39, s36, 8192
    buffer_load_dwordx4 v[104:107], v5, s[48:51], s39 offen offset:0
    buffer_load_dwordx4 v[108:111], v5, s[48:51], s39 offen offset:1024
    buffer_load_dwordx4 v[112:115], v5, s[48:51], s39 offen offset:2048
    buffer_load_dwordx4 v[116:119], v5, s[48:51], s39 offen offset:3072
    s_add_u32 s39, s36, 12288
    buffer_load_dwordx4 v[120:123], v5, s[48:51], s39 offen offset:0
    buffer_load_dwordx4 v[124:127], v5, s[48:51], s39 offen offset:1024
    s_waitcnt vmcnt(28)
    v_mfma_f32_32x32x16_bf16 v[184:199], v[128:131], a[0:3], 0
    v_mfma_f32_32x32x16_bf16 v[200:215], v[128:131], a[112:115], 0
    v_mfma_f32_32x32x16_bf16 v[184:199], v[132:135], a[4:7], v[184:199]
    v_mfma_f32_32x32x16_bf16 v[200:215], v[132:135], a[116:119], v[200:215]
    v_mfma_f32_32x32x16_bf16 v[184:199], v[136:139], a[8:11], v[184:199]
    v_mfma_f32_32x32x16_bf16 v[200:215], v[136:139], a[120:123], v[200:215]
    v_mfma_f32_32x32x16_bf16 v[184:199], v[140:143], a[12:15], v[184:199]
    v_mfma_f32_32x32x16_bf16 v[200:215], v[140:143], a[124:127], v[200:215]
    v_mfma_f32_32x32x16_bf16 v[184:199], v[144:147], a[16:19], v[184:199]
    v_mfma_f32_32x32x16_bf16 v[200:215], v[144:147], a[128:131], v[200:215]
    v_mfma_f32_32x32x16_bf16 v[184:199], v[148:151], a[20:23], v[184:199]
    v_mfma_f32_32x32x16_bf16 v[200:215], v[148:151], a[132:135], v[200:215]
    v_mfma_f32_32x32x16_bf16 v[184:199], v[152:155], a[24:27], v[184:199]
    v_mfma_f32_32x32x16_bf16 v[200:215], v[152:155], a[136:139], v[200:215]
    v_mfma_f32_32x32x16_bf16 v[184:199], v[156:159], a[28:31], v[184:199]
    v_mfma_f32_32x32x16_bf16 v[200:215], v[156:159], a[140:143], v[200:215]
    v_mfma_f32_32x32x16_bf16 v[184:199], v[160:163], a[32:35], v[184:199]
    v_mfma_f32_32x32x16_bf16 v[200:215], v[160:163], a[144:147], v[200:215]
    v_mfma_f32_32x32x16_bf16 v[184:199], v[164:167], a[36:39], v[184:199]
    v_mfma_f32_32x32x16_bf16 v[200:215], v[164:167], a[148:151], v[200:215]
    v_mfma_f32_32x32x16_bf16 v[184:199], v[168:171], a[40:43], v[184:199]
    v_mfma_f32_32x32x16_bf16 v[200:215], v[168:171], a[152:155], v[200:215]
    v_mfma_f32_32x32x16_bf16 v[184:199], v[172:175], a[44:47], v[184:199]
    v_mfma_f32_32x32x16_bf16 v[200:215], v[172:175], a[156:159], v[200:215]
    v_mfma_f32_32x32x16_bf16 v[184:199], v[176:179], a[48:51], v[184:199]
    v_mfma_f32_32x32x16_bf16 v[200:215], v[176:179], a[160:163], v[200:215]
    v_mfma_f32_32x32x16_bf16 v[184:199], v[180:183], a[52:55], v[184:199]
    v_mfma_f32_32x32x16_bf16 v[200:215], v[180:183], a[164:167], v[200:215]
    s_add_u32 s39, s36, 12288
    buffer_load_dwordx4 v[128:131], v5, s[48:51], s39 offen offset:2048
    buffer_load_dwordx4 v[132:135], v5, s[48:51], s39 offen offset:3072
    s_add_u32 s39, s36, 16384
    buffer_load_dwordx4 v[136:139], v5, s[48:51], s39 offen offset:0
    buffer_load_dwordx4 v[140:143], v5, s[48:51], s39 offen offset:1024
    buffer_load_dwordx4 v[144:147], v5, s[48:51], s39 offen offset:2048
    buffer_load_dwordx4 v[148:151], v5, s[48:51], s39 offen offset:3072
    s_add_u32 s39, s36, 20480
    buffer_load_dwordx4 v[152:155], v5, s[48:51], s39 offen offset:0
    buffer_load_dwordx4 v[156:159], v5, s[48:51], s39 offen offset:1024
    buffer_load_dwordx4 v[160:163], v5, s[48:51], s39 offen offset:2048
    buffer_load_dwordx4 v[164:167], v5, s[48:51], s39 offen offset:3072
    s_add_u32 s39, s36, 24576
    buffer_load_dwordx4 v[168:171], v5, s[48:51], s39 offen offset:0
    buffer_load_dwordx4 v[172:175], v5, s[48:51], s39 offen offset:1024
    buffer_load_dwordx4 v[176:179], v5, s[48:51], s39 offen offset:2048
    buffer_load_dwordx4 v[180:183], v5, s[48:51], s39 offen offset:3072
    s_add_u32 s36, s36, 114688
    s_waitcnt vmcnt(28)
    s_barrier
    v_mov_b32 v13, 0
    s_lshl_b32 s22, s100, 2
    s_add_u32 s22, s22, 12288
    v_cmp_eq_u32 vcc, 0, v0
    s_and_b64 exec, exec, vcc
    buffer_store_dword v13, v13, s[96:99], s22 offen offset:0 sc1
    s_mov_b64 exec, -1
    v_mfma_f32_32x32x16_bf16 v[184:199], v[16:19], a[56:59], v[184:199]
    v_mfma_f32_32x32x16_bf16 v[200:215], v[16:19], a[168:171], v[200:215]
    v_mfma_f32_32x32x16_bf16 v[184:199], v[20:23], a[60:63], v[184:199]
    v_mfma_f32_32x32x16_bf16 v[200:215], v[20:23], a[172:175], v[200:215]
    v_mfma_f32_32x32x16_bf16 v[184:199], v[24:27], a[64:67], v[184:199]
    v_mfma_f32_32x32x16_bf16 v[200:215], v[24:27], a[176:179], v[200:215]
    v_mfma_f32_32x32x16_bf16 v[184:199], v[28:31], a[68:71], v[184:199]
    v_mfma_f32_32x32x16_bf16 v[200:215], v[28:31], a[180:183], v[200:215]
    v_mfma_f32_32x32x16_bf16 v[184:199], v[32:35], a[72:75], v[184:199]
    v_mfma_f32_32x32x16_bf16 v[200:215], v[32:35], a[184:187], v[200:215]
    v_mfma_f32_32x32x16_bf16 v[184:199], v[36:39], a[76:79], v[184:199]
    v_mfma_f32_32x32x16_bf16 v[200:215], v[36:39], a[188:191], v[200:215]
    v_mfma_f32_32x32x16_bf16 v[184:199], v[40:43], a[80:83], v[184:199]
    v_mfma_f32_32x32x16_bf16 v[200:215], v[40:43], a[192:195], v[200:215]
    v_mfma_f32_32x32x16_bf16 v[184:199], v[44:47], a[84:87], v[184:199]
    v_mfma_f32_32x32x16_bf16 v[200:215], v[44:47], a[196:199], v[200:215]
    v_mfma_f32_32x32x16_bf16 v[184:199], v[48:51], a[88:91], v[184:199]
    v_mfma_f32_32x32x16_bf16 v[200:215], v[48:51], a[200:203], v[200:215]
    v_mfma_f32_32x32x16_bf16 v[184:199], v[52:55], a[92:95], v[184:199]
    v_mfma_f32_32x32x16_bf16 v[200:215], v[52:55], a[204:207], v[200:215]
    v_mfma_f32_32x32x16_bf16 v[184:199], v[56:59], a[96:99], v[184:199]
    v_mfma_f32_32x32x16_bf16 v[200:215], v[56:59], a[208:211], v[200:215]
    v_mfma_f32_32x32x16_bf16 v[184:199], v[60:63], a[100:103], v[184:199]
    v_mfma_f32_32x32x16_bf16 v[200:215], v[60:63], a[212:215], v[200:215]
    v_mfma_f32_32x32x16_bf16 v[184:199], v[64:67], a[104:107], v[184:199]
    v_mfma_f32_32x32x16_bf16 v[200:215], v[64:67], a[216:219], v[200:215]
    v_mfma_f32_32x32x16_bf16 v[184:199], v[68:71], a[108:111], v[184:199]
    v_mfma_f32_32x32x16_bf16 v[200:215], v[68:71], a[220:223], v[200:215]
    s_nop 15
    s_nop 1
    v_cvt_pk_bf16_f32 v216, v184, v185
    v_cvt_pk_bf16_f32 v217, v186, v187
    v_cvt_pk_bf16_f32 v218, v188, v189
    v_cvt_pk_bf16_f32 v219, v190, v191
    v_cvt_pk_bf16_f32 v220, v192, v193
    v_cvt_pk_bf16_f32 v221, v194, v195
    v_cvt_pk_bf16_f32 v222, v196, v197
    v_cvt_pk_bf16_f32 v223, v198, v199
    v_cvt_pk_bf16_f32 v224, v200, v201
    v_cvt_pk_bf16_f32 v225, v202, v203
    v_cvt_pk_bf16_f32 v226, v204, v205
    v_cvt_pk_bf16_f32 v227, v206, v207
    v_cvt_pk_bf16_f32 v228, v208, v209
    v_cvt_pk_bf16_f32 v229, v210, v211
    v_cvt_pk_bf16_f32 v230, v212, v213
    v_cvt_pk_bf16_f32 v231, v214, v215
    buffer_store_dwordx4 v[216:219], v6, s[56:59], s37 offen offset:0 sc1
    buffer_store_dwordx4 v[220:223], v7, s[56:59], s37 offen offset:0 sc1
    buffer_store_dwordx4 v[224:227], v6, s[56:59], s37 offen offset:512 sc1
    buffer_store_dwordx4 v[228:231], v7, s[56:59], s37 offen offset:512 sc1
    s_add_u32 s37, s37, 1835008
    s_add_u32 s39, s36, 0
    buffer_load_dwordx4 v[16:19], v5, s[48:51], s39 offen offset:0
    buffer_load_dwordx4 v[20:23], v5, s[48:51], s39 offen offset:1024
    buffer_load_dwordx4 v[24:27], v5, s[48:51], s39 offen offset:2048
    buffer_load_dwordx4 v[28:31], v5, s[48:51], s39 offen offset:3072
    s_add_u32 s39, s36, 4096
    buffer_load_dwordx4 v[32:35], v5, s[48:51], s39 offen offset:0
    buffer_load_dwordx4 v[36:39], v5, s[48:51], s39 offen offset:1024
    buffer_load_dwordx4 v[40:43], v5, s[48:51], s39 offen offset:2048
    buffer_load_dwordx4 v[44:47], v5, s[48:51], s39 offen offset:3072
    s_add_u32 s39, s36, 8192
    buffer_load_dwordx4 v[48:51], v5, s[48:51], s39 offen offset:0
    buffer_load_dwordx4 v[52:55], v5, s[48:51], s39 offen offset:1024
    buffer_load_dwordx4 v[56:59], v5, s[48:51], s39 offen offset:2048
    buffer_load_dwordx4 v[60:63], v5, s[48:51], s39 offen offset:3072
    s_add_u32 s39, s36, 12288
    buffer_load_dwordx4 v[64:67], v5, s[48:51], s39 offen offset:0
    buffer_load_dwordx4 v[68:71], v5, s[48:51], s39 offen offset:1024
    s_waitcnt vmcnt(28)
    v_mfma_f32_32x32x16_bf16 v[184:199], v[72:75], a[0:3], 0
    v_mfma_f32_32x32x16_bf16 v[200:215], v[72:75], a[112:115], 0
    v_mfma_f32_32x32x16_bf16 v[184:199], v[76:79], a[4:7], v[184:199]
    v_mfma_f32_32x32x16_bf16 v[200:215], v[76:79], a[116:119], v[200:215]
    v_mfma_f32_32x32x16_bf16 v[184:199], v[80:83], a[8:11], v[184:199]
    v_mfma_f32_32x32x16_bf16 v[200:215], v[80:83], a[120:123], v[200:215]
    v_mfma_f32_32x32x16_bf16 v[184:199], v[84:87], a[12:15], v[184:199]
    v_mfma_f32_32x32x16_bf16 v[200:215], v[84:87], a[124:127], v[200:215]
    v_mfma_f32_32x32x16_bf16 v[184:199], v[88:91], a[16:19], v[184:199]
    v_mfma_f32_32x32x16_bf16 v[200:215], v[88:91], a[128:131], v[200:215]
    v_mfma_f32_32x32x16_bf16 v[184:199], v[92:95], a[20:23], v[184:199]
    v_mfma_f32_32x32x16_bf16 v[200:215], v[92:95], a[132:135], v[200:215]
    v_mfma_f32_32x32x16_bf16 v[184:199], v[96:99], a[24:27], v[184:199]
    v_mfma_f32_32x32x16_bf16 v[200:215], v[96:99], a[136:139], v[200:215]
    v_mfma_f32_32x32x16_bf16 v[184:199], v[100:103], a[28:31], v[184:199]
    v_mfma_f32_32x32x16_bf16 v[200:215], v[100:103], a[140:143], v[200:215]
    v_mfma_f32_32x32x16_bf16 v[184:199], v[104:107], a[32:35], v[184:199]
    v_mfma_f32_32x32x16_bf16 v[200:215], v[104:107], a[144:147], v[200:215]
    v_mfma_f32_32x32x16_bf16 v[184:199], v[108:111], a[36:39], v[184:199]
    v_mfma_f32_32x32x16_bf16 v[200:215], v[108:111], a[148:151], v[200:215]
    v_mfma_f32_32x32x16_bf16 v[184:199], v[112:115], a[40:43], v[184:199]
    v_mfma_f32_32x32x16_bf16 v[200:215], v[112:115], a[152:155], v[200:215]
    v_mfma_f32_32x32x16_bf16 v[184:199], v[116:119], a[44:47], v[184:199]
    v_mfma_f32_32x32x16_bf16 v[200:215], v[116:119], a[156:159], v[200:215]
    v_mfma_f32_32x32x16_bf16 v[184:199], v[120:123], a[48:51], v[184:199]
    v_mfma_f32_32x32x16_bf16 v[200:215], v[120:123], a[160:163], v[200:215]
    v_mfma_f32_32x32x16_bf16 v[184:199], v[124:127], a[52:55], v[184:199]
    v_mfma_f32_32x32x16_bf16 v[200:215], v[124:127], a[164:167], v[200:215]
    s_add_u32 s39, s36, 12288
    buffer_load_dwordx4 v[72:75], v5, s[48:51], s39 offen offset:2048
    buffer_load_dwordx4 v[76:79], v5, s[48:51], s39 offen offset:3072
    s_add_u32 s39, s36, 16384
    buffer_load_dwordx4 v[80:83], v5, s[48:51], s39 offen offset:0
    buffer_load_dwordx4 v[84:87], v5, s[48:51], s39 offen offset:1024
    buffer_load_dwordx4 v[88:91], v5, s[48:51], s39 offen offset:2048
    buffer_load_dwordx4 v[92:95], v5, s[48:51], s39 offen offset:3072
    s_add_u32 s39, s36, 20480
    buffer_load_dwordx4 v[96:99], v5, s[48:51], s39 offen offset:0
    buffer_load_dwordx4 v[100:103], v5, s[48:51], s39 offen offset:1024
    buffer_load_dwordx4 v[104:107], v5, s[48:51], s39 offen offset:2048
    buffer_load_dwordx4 v[108:111], v5, s[48:51], s39 offen offset:3072
    s_add_u32 s39, s36, 24576
    buffer_load_dwordx4 v[112:115], v5, s[48:51], s39 offen offset:0
    buffer_load_dwordx4 v[116:119], v5, s[48:51], s39 offen offset:1024
    buffer_load_dwordx4 v[120:123], v5, s[48:51], s39 offen offset:2048
    buffer_load_dwordx4 v[124:127], v5, s[48:51], s39 offen offset:3072
    s_add_u32 s36, s36, 114688
    s_waitcnt vmcnt(28)
    s_barrier
    v_mov_b32 v13, 0
    s_lshl_b32 s22, s100, 2
    s_add_u32 s22, s22, 4096
    v_cmp_eq_u32 vcc, 0, v0
    s_and_b64 exec, exec, vcc
    buffer_store_dword v13, v13, s[96:99], s22 offen offset:0 sc1
    s_mov_b64 exec, -1
    v_mfma_f32_32x32x16_bf16 v[184:199], v[128:131], a[56:59], v[184:199]
    v_mfma_f32_32x32x16_bf16 v[200:215], v[128:131], a[168:171], v[200:215]
    v_mfma_f32_32x32x16_bf16 v[184:199], v[132:135], a[60:63], v[184:199]
    v_mfma_f32_32x32x16_bf16 v[200:215], v[132:135], a[172:175], v[200:215]
    v_mfma_f32_32x32x16_bf16 v[184:199], v[136:139], a[64:67], v[184:199]
    v_mfma_f32_32x32x16_bf16 v[200:215], v[136:139], a[176:179], v[200:215]
    v_mfma_f32_32x32x16_bf16 v[184:199], v[140:143], a[68:71], v[184:199]
    v_mfma_f32_32x32x16_bf16 v[200:215], v[140:143], a[180:183], v[200:215]
    v_mfma_f32_32x32x16_bf16 v[184:199], v[144:147], a[72:75], v[184:199]
    v_mfma_f32_32x32x16_bf16 v[200:215], v[144:147], a[184:187], v[200:215]
    v_mfma_f32_32x32x16_bf16 v[184:199], v[148:151], a[76:79], v[184:199]
    v_mfma_f32_32x32x16_bf16 v[200:215], v[148:151], a[188:191], v[200:215]
    v_mfma_f32_32x32x16_bf16 v[184:199], v[152:155], a[80:83], v[184:199]
    v_mfma_f32_32x32x16_bf16 v[200:215], v[152:155], a[192:195], v[200:215]
    v_mfma_f32_32x32x16_bf16 v[184:199], v[156:159], a[84:87], v[184:199]
    v_mfma_f32_32x32x16_bf16 v[200:215], v[156:159], a[196:199], v[200:215]
    v_mfma_f32_32x32x16_bf16 v[184:199], v[160:163], a[88:91], v[184:199]
    v_mfma_f32_32x32x16_bf16 v[200:215], v[160:163], a[200:203], v[200:215]
    v_mfma_f32_32x32x16_bf16 v[184:199], v[164:167], a[92:95], v[184:199]
    v_mfma_f32_32x32x16_bf16 v[200:215], v[164:167], a[204:207], v[200:215]
    v_mfma_f32_32x32x16_bf16 v[184:199], v[168:171], a[96:99], v[184:199]
    v_mfma_f32_32x32x16_bf16 v[200:215], v[168:171], a[208:211], v[200:215]
    v_mfma_f32_32x32x16_bf16 v[184:199], v[172:175], a[100:103], v[184:199]
    v_mfma_f32_32x32x16_bf16 v[200:215], v[172:175], a[212:215], v[200:215]
    v_mfma_f32_32x32x16_bf16 v[184:199], v[176:179], a[104:107], v[184:199]
    v_mfma_f32_32x32x16_bf16 v[200:215], v[176:179], a[216:219], v[200:215]
    v_mfma_f32_32x32x16_bf16 v[184:199], v[180:183], a[108:111], v[184:199]
    v_mfma_f32_32x32x16_bf16 v[200:215], v[180:183], a[220:223], v[200:215]
    s_nop 15
    s_nop 1
    v_cvt_pk_bf16_f32 v216, v184, v185
    v_cvt_pk_bf16_f32 v217, v186, v187
    v_cvt_pk_bf16_f32 v218, v188, v189
    v_cvt_pk_bf16_f32 v219, v190, v191
    v_cvt_pk_bf16_f32 v220, v192, v193
    v_cvt_pk_bf16_f32 v221, v194, v195
    v_cvt_pk_bf16_f32 v222, v196, v197
    v_cvt_pk_bf16_f32 v223, v198, v199
    v_cvt_pk_bf16_f32 v224, v200, v201
    v_cvt_pk_bf16_f32 v225, v202, v203
    v_cvt_pk_bf16_f32 v226, v204, v205
    v_cvt_pk_bf16_f32 v227, v206, v207
    v_cvt_pk_bf16_f32 v228, v208, v209
    v_cvt_pk_bf16_f32 v229, v210, v211
    v_cvt_pk_bf16_f32 v230, v212, v213
    v_cvt_pk_bf16_f32 v231, v214, v215
    buffer_store_dwordx4 v[216:219], v6, s[56:59], s37 offen offset:0 sc1
    buffer_store_dwordx4 v[220:223], v7, s[56:59], s37 offen offset:0 sc1
    buffer_store_dwordx4 v[224:227], v6, s[56:59], s37 offen offset:512 sc1
    buffer_store_dwordx4 v[228:231], v7, s[56:59], s37 offen offset:512 sc1
    s_add_u32 s37, s37, 1835008
    s_add_u32 s39, s36, 0
    buffer_load_dwordx4 v[128:131], v5, s[48:51], s39 offen offset:0
    buffer_load_dwordx4 v[132:135], v5, s[48:51], s39 offen offset:1024
    buffer_load_dwordx4 v[136:139], v5, s[48:51], s39 offen offset:2048
    buffer_load_dwordx4 v[140:143], v5, s[48:51], s39 offen offset:3072
    s_add_u32 s39, s36, 4096
    buffer_load_dwordx4 v[144:147], v5, s[48:51], s39 offen offset:0
    buffer_load_dwordx4 v[148:151], v5, s[48:51], s39 offen offset:1024
    buffer_load_dwordx4 v[152:155], v5, s[48:51], s39 offen offset:2048
    buffer_load_dwordx4 v[156:159], v5, s[48:51], s39 offen offset:3072
    s_add_u32 s39, s36, 8192
    buffer_load_dwordx4 v[160:163], v5, s[48:51], s39 offen offset:0
    buffer_load_dwordx4 v[164:167], v5, s[48:51], s39 offen offset:1024
    buffer_load_dwordx4 v[168:171], v5, s[48:51], s39 offen offset:2048
    buffer_load_dwordx4 v[172:175], v5, s[48:51], s39 offen offset:3072
    s_add_u32 s39, s36, 12288
    buffer_load_dwordx4 v[176:179], v5, s[48:51], s39 offen offset:0
    buffer_load_dwordx4 v[180:183], v5, s[48:51], s39 offen offset:1024
    s_waitcnt vmcnt(28)
    v_mfma_f32_32x32x16_bf16 v[184:199], v[16:19], a[0:3], 0
    v_mfma_f32_32x32x16_bf16 v[200:215], v[16:19], a[112:115], 0
    v_mfma_f32_32x32x16_bf16 v[184:199], v[20:23], a[4:7], v[184:199]
    v_mfma_f32_32x32x16_bf16 v[200:215], v[20:23], a[116:119], v[200:215]
    v_mfma_f32_32x32x16_bf16 v[184:199], v[24:27], a[8:11], v[184:199]
    v_mfma_f32_32x32x16_bf16 v[200:215], v[24:27], a[120:123], v[200:215]
    v_mfma_f32_32x32x16_bf16 v[184:199], v[28:31], a[12:15], v[184:199]
    v_mfma_f32_32x32x16_bf16 v[200:215], v[28:31], a[124:127], v[200:215]
    v_mfma_f32_32x32x16_bf16 v[184:199], v[32:35], a[16:19], v[184:199]
    v_mfma_f32_32x32x16_bf16 v[200:215], v[32:35], a[128:131], v[200:215]
    v_mfma_f32_32x32x16_bf16 v[184:199], v[36:39], a[20:23], v[184:199]
    v_mfma_f32_32x32x16_bf16 v[200:215], v[36:39], a[132:135], v[200:215]
    v_mfma_f32_32x32x16_bf16 v[184:199], v[40:43], a[24:27], v[184:199]
    v_mfma_f32_32x32x16_bf16 v[200:215], v[40:43], a[136:139], v[200:215]
    v_mfma_f32_32x32x16_bf16 v[184:199], v[44:47], a[28:31], v[184:199]
    v_mfma_f32_32x32x16_bf16 v[200:215], v[44:47], a[140:143], v[200:215]
    v_mfma_f32_32x32x16_bf16 v[184:199], v[48:51], a[32:35], v[184:199]
    v_mfma_f32_32x32x16_bf16 v[200:215], v[48:51], a[144:147], v[200:215]
    v_mfma_f32_32x32x16_bf16 v[184:199], v[52:55], a[36:39], v[184:199]
    v_mfma_f32_32x32x16_bf16 v[200:215], v[52:55], a[148:151], v[200:215]
    v_mfma_f32_32x32x16_bf16 v[184:199], v[56:59], a[40:43], v[184:199]
    v_mfma_f32_32x32x16_bf16 v[200:215], v[56:59], a[152:155], v[200:215]
    v_mfma_f32_32x32x16_bf16 v[184:199], v[60:63], a[44:47], v[184:199]
    v_mfma_f32_32x32x16_bf16 v[200:215], v[60:63], a[156:159], v[200:215]
    v_mfma_f32_32x32x16_bf16 v[184:199], v[64:67], a[48:51], v[184:199]
    v_mfma_f32_32x32x16_bf16 v[200:215], v[64:67], a[160:163], v[200:215]
    v_mfma_f32_32x32x16_bf16 v[184:199], v[68:71], a[52:55], v[184:199]
    v_mfma_f32_32x32x16_bf16 v[200:215], v[68:71], a[164:167], v[200:215]
    s_add_u32 s39, s36, 12288
    buffer_load_dwordx4 v[16:19], v5, s[48:51], s39 offen offset:2048
    buffer_load_dwordx4 v[20:23], v5, s[48:51], s39 offen offset:3072
    s_add_u32 s39, s36, 16384
    buffer_load_dwordx4 v[24:27], v5, s[48:51], s39 offen offset:0
    buffer_load_dwordx4 v[28:31], v5, s[48:51], s39 offen offset:1024
    buffer_load_dwordx4 v[32:35], v5, s[48:51], s39 offen offset:2048
    buffer_load_dwordx4 v[36:39], v5, s[48:51], s39 offen offset:3072
    s_add_u32 s39, s36, 20480
    buffer_load_dwordx4 v[40:43], v5, s[48:51], s39 offen offset:0
    buffer_load_dwordx4 v[44:47], v5, s[48:51], s39 offen offset:1024
    buffer_load_dwordx4 v[48:51], v5, s[48:51], s39 offen offset:2048
    buffer_load_dwordx4 v[52:55], v5, s[48:51], s39 offen offset:3072
    s_add_u32 s39, s36, 24576
    buffer_load_dwordx4 v[56:59], v5, s[48:51], s39 offen offset:0
    buffer_load_dwordx4 v[60:63], v5, s[48:51], s39 offen offset:1024
    buffer_load_dwordx4 v[64:67], v5, s[48:51], s39 offen offset:2048
    buffer_load_dwordx4 v[68:71], v5, s[48:51], s39 offen offset:3072
    s_add_u32 s36, s36, 114688
    s_waitcnt vmcnt(28)
    v_mfma_f32_32x32x16_bf16 v[184:199], v[72:75], a[56:59], v[184:199]
    v_mfma_f32_32x32x16_bf16 v[200:215], v[72:75], a[168:171], v[200:215]
    v_mfma_f32_32x32x16_bf16 v[184:199], v[76:79], a[60:63], v[184:199]
    v_mfma_f32_32x32x16_bf16 v[200:215], v[76:79], a[172:175], v[200:215]
    v_mfma_f32_32x32x16_bf16 v[184:199], v[80:83], a[64:67], v[184:199]
    v_mfma_f32_32x32x16_bf16 v[200:215], v[80:83], a[176:179], v[200:215]
    v_mfma_f32_32x32x16_bf16 v[184:199], v[84:87], a[68:71], v[184:199]
    v_mfma_f32_32x32x16_bf16 v[200:215], v[84:87], a[180:183], v[200:215]
    v_mfma_f32_32x32x16_bf16 v[184:199], v[88:91], a[72:75], v[184:199]
    v_mfma_f32_32x32x16_bf16 v[200:215], v[88:91], a[184:187], v[200:215]
    v_mfma_f32_32x32x16_bf16 v[184:199], v[92:95], a[76:79], v[184:199]
    v_mfma_f32_32x32x16_bf16 v[200:215], v[92:95], a[188:191], v[200:215]
    v_mfma_f32_32x32x16_bf16 v[184:199], v[96:99], a[80:83], v[184:199]
    v_mfma_f32_32x32x16_bf16 v[200:215], v[96:99], a[192:195], v[200:215]
    v_mfma_f32_32x32x16_bf16 v[184:199], v[100:103], a[84:87], v[184:199]
    v_mfma_f32_32x32x16_bf16 v[200:215], v[100:103], a[196:199], v[200:215]
    v_mfma_f32_32x32x16_bf16 v[184:199], v[104:107], a[88:91], v[184:199]
    v_mfma_f32_32x32x16_bf16 v[200:215], v[104:107], a[200:203], v[200:215]
    v_mfma_f32_32x32x16_bf16 v[184:199], v[108:111], a[92:95], v[184:199]
    v_mfma_f32_32x32x16_bf16 v[200:215], v[108:111], a[204:207], v[200:215]
    v_mfma_f32_32x32x16_bf16 v[184:199], v[112:115], a[96:99], v[184:199]
    v_mfma_f32_32x32x16_bf16 v[200:215], v[112:115], a[208:211], v[200:215]
    v_mfma_f32_32x32x16_bf16 v[184:199], v[116:119], a[100:103], v[184:199]
    v_mfma_f32_32x32x16_bf16 v[200:215], v[116:119], a[212:215], v[200:215]
    v_mfma_f32_32x32x16_bf16 v[184:199], v[120:123], a[104:107], v[184:199]
    v_mfma_f32_32x32x16_bf16 v[200:215], v[120:123], a[216:219], v[200:215]
    v_mfma_f32_32x32x16_bf16 v[184:199], v[124:127], a[108:111], v[184:199]
    v_mfma_f32_32x32x16_bf16 v[200:215], v[124:127], a[220:223], v[200:215]
    s_nop 15
    s_nop 1
    v_cvt_pk_bf16_f32 v216, v184, v185
    v_cvt_pk_bf16_f32 v217, v186, v187
    v_cvt_pk_bf16_f32 v218, v188, v189
    v_cvt_pk_bf16_f32 v219, v190, v191
    v_cvt_pk_bf16_f32 v220, v192, v193
    v_cvt_pk_bf16_f32 v221, v194, v195
    v_cvt_pk_bf16_f32 v222, v196, v197
    v_cvt_pk_bf16_f32 v223, v198, v199
    v_cvt_pk_bf16_f32 v224, v200, v201
    v_cvt_pk_bf16_f32 v225, v202, v203
    v_cvt_pk_bf16_f32 v226, v204, v205
    v_cvt_pk_bf16_f32 v227, v206, v207
    v_cvt_pk_bf16_f32 v228, v208, v209
    v_cvt_pk_bf16_f32 v229, v210, v211
    v_cvt_pk_bf16_f32 v230, v212, v213
    v_cvt_pk_bf16_f32 v231, v214, v215
    buffer_store_dwordx4 v[216:219], v6, s[56:59], s37 offen offset:0 sc1
    buffer_store_dwordx4 v[220:223], v7, s[56:59], s37 offen offset:0 sc1
    buffer_store_dwordx4 v[224:227], v6, s[56:59], s37 offen offset:512 sc1
    buffer_store_dwordx4 v[228:231], v7, s[56:59], s37 offen offset:512 sc1
    s_add_u32 s37, s37, 1835008
    s_add_u32 s39, s36, 0
    buffer_load_dwordx4 v[72:75], v5, s[48:51], s39 offen offset:0
    buffer_load_dwordx4 v[76:79], v5, s[48:51], s39 offen offset:1024
    buffer_load_dwordx4 v[80:83], v5, s[48:51], s39 offen offset:2048
    buffer_load_dwordx4 v[84:87], v5, s[48:51], s39 offen offset:3072
    s_add_u32 s39, s36, 4096
    buffer_load_dwordx4 v[88:91], v5, s[48:51], s39 offen offset:0
    buffer_load_dwordx4 v[92:95], v5, s[48:51], s39 offen offset:1024
    buffer_load_dwordx4 v[96:99], v5, s[48:51], s39 offen offset:2048
    buffer_load_dwordx4 v[100:103], v5, s[48:51], s39 offen offset:3072
    s_add_u32 s39, s36, 8192
    buffer_load_dwordx4 v[104:107], v5, s[48:51], s39 offen offset:0
    buffer_load_dwordx4 v[108:111], v5, s[48:51], s39 offen offset:1024
    buffer_load_dwordx4 v[112:115], v5, s[48:51], s39 offen offset:2048
    buffer_load_dwordx4 v[116:119], v5, s[48:51], s39 offen offset:3072
    s_add_u32 s39, s36, 12288
    buffer_load_dwordx4 v[120:123], v5, s[48:51], s39 offen offset:0
    buffer_load_dwordx4 v[124:127], v5, s[48:51], s39 offen offset:1024
    s_waitcnt vmcnt(28)
    v_mfma_f32_32x32x16_bf16 v[184:199], v[128:131], a[0:3], 0
    v_mfma_f32_32x32x16_bf16 v[200:215], v[128:131], a[112:115], 0
    v_mfma_f32_32x32x16_bf16 v[184:199], v[132:135], a[4:7], v[184:199]
    v_mfma_f32_32x32x16_bf16 v[200:215], v[132:135], a[116:119], v[200:215]
    v_mfma_f32_32x32x16_bf16 v[184:199], v[136:139], a[8:11], v[184:199]
    v_mfma_f32_32x32x16_bf16 v[200:215], v[136:139], a[120:123], v[200:215]
    v_mfma_f32_32x32x16_bf16 v[184:199], v[140:143], a[12:15], v[184:199]
    v_mfma_f32_32x32x16_bf16 v[200:215], v[140:143], a[124:127], v[200:215]
    v_mfma_f32_32x32x16_bf16 v[184:199], v[144:147], a[16:19], v[184:199]
    v_mfma_f32_32x32x16_bf16 v[200:215], v[144:147], a[128:131], v[200:215]
    v_mfma_f32_32x32x16_bf16 v[184:199], v[148:151], a[20:23], v[184:199]
    v_mfma_f32_32x32x16_bf16 v[200:215], v[148:151], a[132:135], v[200:215]
    v_mfma_f32_32x32x16_bf16 v[184:199], v[152:155], a[24:27], v[184:199]
    v_mfma_f32_32x32x16_bf16 v[200:215], v[152:155], a[136:139], v[200:215]
    v_mfma_f32_32x32x16_bf16 v[184:199], v[156:159], a[28:31], v[184:199]
    v_mfma_f32_32x32x16_bf16 v[200:215], v[156:159], a[140:143], v[200:215]
    v_mfma_f32_32x32x16_bf16 v[184:199], v[160:163], a[32:35], v[184:199]
    v_mfma_f32_32x32x16_bf16 v[200:215], v[160:163], a[144:147], v[200:215]
    v_mfma_f32_32x32x16_bf16 v[184:199], v[164:167], a[36:39], v[184:199]
    v_mfma_f32_32x32x16_bf16 v[200:215], v[164:167], a[148:151], v[200:215]
    v_mfma_f32_32x32x16_bf16 v[184:199], v[168:171], a[40:43], v[184:199]
    v_mfma_f32_32x32x16_bf16 v[200:215], v[168:171], a[152:155], v[200:215]
    v_mfma_f32_32x32x16_bf16 v[184:199], v[172:175], a[44:47], v[184:199]
    v_mfma_f32_32x32x16_bf16 v[200:215], v[172:175], a[156:159], v[200:215]
    v_mfma_f32_32x32x16_bf16 v[184:199], v[176:179], a[48:51], v[184:199]
    v_mfma_f32_32x32x16_bf16 v[200:215], v[176:179], a[160:163], v[200:215]
    v_mfma_f32_32x32x16_bf16 v[184:199], v[180:183], a[52:55], v[184:199]
    v_mfma_f32_32x32x16_bf16 v[200:215], v[180:183], a[164:167], v[200:215]
    s_add_u32 s39, s36, 12288
    buffer_load_dwordx4 v[128:131], v5, s[48:51], s39 offen offset:2048
    buffer_load_dwordx4 v[132:135], v5, s[48:51], s39 offen offset:3072
    s_add_u32 s39, s36, 16384
    buffer_load_dwordx4 v[136:139], v5, s[48:51], s39 offen offset:0
    buffer_load_dwordx4 v[140:143], v5, s[48:51], s39 offen offset:1024
    buffer_load_dwordx4 v[144:147], v5, s[48:51], s39 offen offset:2048
    buffer_load_dwordx4 v[148:151], v5, s[48:51], s39 offen offset:3072
    s_add_u32 s39, s36, 20480
    buffer_load_dwordx4 v[152:155], v5, s[48:51], s39 offen offset:0
    buffer_load_dwordx4 v[156:159], v5, s[48:51], s39 offen offset:1024
    buffer_load_dwordx4 v[160:163], v5, s[48:51], s39 offen offset:2048
    buffer_load_dwordx4 v[164:167], v5, s[48:51], s39 offen offset:3072
    s_add_u32 s39, s36, 24576
    buffer_load_dwordx4 v[168:171], v5, s[48:51], s39 offen offset:0
    buffer_load_dwordx4 v[172:175], v5, s[48:51], s39 offen offset:1024
    buffer_load_dwordx4 v[176:179], v5, s[48:51], s39 offen offset:2048
    buffer_load_dwordx4 v[180:183], v5, s[48:51], s39 offen offset:3072
    s_add_u32 s36, s36, 114688
    s_waitcnt vmcnt(28)
    s_barrier
    v_mov_b32 v13, 0
    s_lshl_b32 s22, s100, 2
    s_add_u32 s22, s22, 5120
    v_cmp_eq_u32 vcc, 0, v0
    s_and_b64 exec, exec, vcc
    buffer_store_dword v13, v13, s[96:99], s22 offen offset:0 sc1
    s_mov_b64 exec, -1
    v_mfma_f32_32x32x16_bf16 v[184:199], v[16:19], a[56:59], v[184:199]
    v_mfma_f32_32x32x16_bf16 v[200:215], v[16:19], a[168:171], v[200:215]
    v_mfma_f32_32x32x16_bf16 v[184:199], v[20:23], a[60:63], v[184:199]
    v_mfma_f32_32x32x16_bf16 v[200:215], v[20:23], a[172:175], v[200:215]
    v_mfma_f32_32x32x16_bf16 v[184:199], v[24:27], a[64:67], v[184:199]
    v_mfma_f32_32x32x16_bf16 v[200:215], v[24:27], a[176:179], v[200:215]
    v_mfma_f32_32x32x16_bf16 v[184:199], v[28:31], a[68:71], v[184:199]
    v_mfma_f32_32x32x16_bf16 v[200:215], v[28:31], a[180:183], v[200:215]
    v_mfma_f32_32x32x16_bf16 v[184:199], v[32:35], a[72:75], v[184:199]
    v_mfma_f32_32x32x16_bf16 v[200:215], v[32:35], a[184:187], v[200:215]
    v_mfma_f32_32x32x16_bf16 v[184:199], v[36:39], a[76:79], v[184:199]
    v_mfma_f32_32x32x16_bf16 v[200:215], v[36:39], a[188:191], v[200:215]
    v_mfma_f32_32x32x16_bf16 v[184:199], v[40:43], a[80:83], v[184:199]
    v_mfma_f32_32x32x16_bf16 v[200:215], v[40:43], a[192:195], v[200:215]
    v_mfma_f32_32x32x16_bf16 v[184:199], v[44:47], a[84:87], v[184:199]
    v_mfma_f32_32x32x16_bf16 v[200:215], v[44:47], a[196:199], v[200:215]
    v_mfma_f32_32x32x16_bf16 v[184:199], v[48:51], a[88:91], v[184:199]
    v_mfma_f32_32x32x16_bf16 v[200:215], v[48:51], a[200:203], v[200:215]
    v_mfma_f32_32x32x16_bf16 v[184:199], v[52:55], a[92:95], v[184:199]
    v_mfma_f32_32x32x16_bf16 v[200:215], v[52:55], a[204:207], v[200:215]
    v_mfma_f32_32x32x16_bf16 v[184:199], v[56:59], a[96:99], v[184:199]
    v_mfma_f32_32x32x16_bf16 v[200:215], v[56:59], a[208:211], v[200:215]
    v_mfma_f32_32x32x16_bf16 v[184:199], v[60:63], a[100:103], v[184:199]
    v_mfma_f32_32x32x16_bf16 v[200:215], v[60:63], a[212:215], v[200:215]
    v_mfma_f32_32x32x16_bf16 v[184:199], v[64:67], a[104:107], v[184:199]
    v_mfma_f32_32x32x16_bf16 v[200:215], v[64:67], a[216:219], v[200:215]
    v_mfma_f32_32x32x16_bf16 v[184:199], v[68:71], a[108:111], v[184:199]
    v_mfma_f32_32x32x16_bf16 v[200:215], v[68:71], a[220:223], v[200:215]
    s_nop 15
    s_nop 1
    v_cvt_pk_bf16_f32 v216, v184, v185
    v_cvt_pk_bf16_f32 v217, v186, v187
    v_cvt_pk_bf16_f32 v218, v188, v189
    v_cvt_pk_bf16_f32 v219, v190, v191
    v_cvt_pk_bf16_f32 v220, v192, v193
    v_cvt_pk_bf16_f32 v221, v194, v195
    v_cvt_pk_bf16_f32 v222, v196, v197
    v_cvt_pk_bf16_f32 v223, v198, v199
    v_cvt_pk_bf16_f32 v224, v200, v201
    v_cvt_pk_bf16_f32 v225, v202, v203
    v_cvt_pk_bf16_f32 v226, v204, v205
    v_cvt_pk_bf16_f32 v227, v206, v207
    v_cvt_pk_bf16_f32 v228, v208, v209
    v_cvt_pk_bf16_f32 v229, v210, v211
    v_cvt_pk_bf16_f32 v230, v212, v213
    v_cvt_pk_bf16_f32 v231, v214, v215
    buffer_store_dwordx4 v[216:219], v6, s[56:59], s37 offen offset:0 sc1
    buffer_store_dwordx4 v[220:223], v7, s[56:59], s37 offen offset:0 sc1
    buffer_store_dwordx4 v[224:227], v6, s[56:59], s37 offen offset:512 sc1
    buffer_store_dwordx4 v[228:231], v7, s[56:59], s37 offen offset:512 sc1
    s_add_u32 s37, s37, 1835008
    s_add_u32 s39, s36, 0
    buffer_load_dwordx4 v[16:19], v5, s[48:51], s39 offen offset:0
    buffer_load_dwordx4 v[20:23], v5, s[48:51], s39 offen offset:1024
    buffer_load_dwordx4 v[24:27], v5, s[48:51], s39 offen offset:2048
    buffer_load_dwordx4 v[28:31], v5, s[48:51], s39 offen offset:3072
    s_add_u32 s39, s36, 4096
    buffer_load_dwordx4 v[32:35], v5, s[48:51], s39 offen offset:0
    buffer_load_dwordx4 v[36:39], v5, s[48:51], s39 offen offset:1024
    buffer_load_dwordx4 v[40:43], v5, s[48:51], s39 offen offset:2048
    buffer_load_dwordx4 v[44:47], v5, s[48:51], s39 offen offset:3072
    s_add_u32 s39, s36, 8192
    buffer_load_dwordx4 v[48:51], v5, s[48:51], s39 offen offset:0
    buffer_load_dwordx4 v[52:55], v5, s[48:51], s39 offen offset:1024
    buffer_load_dwordx4 v[56:59], v5, s[48:51], s39 offen offset:2048
    buffer_load_dwordx4 v[60:63], v5, s[48:51], s39 offen offset:3072
    s_add_u32 s39, s36, 12288
    buffer_load_dwordx4 v[64:67], v5, s[48:51], s39 offen offset:0
    buffer_load_dwordx4 v[68:71], v5, s[48:51], s39 offen offset:1024
    s_waitcnt vmcnt(28)
    v_mfma_f32_32x32x16_bf16 v[184:199], v[72:75], a[0:3], 0
    v_mfma_f32_32x32x16_bf16 v[200:215], v[72:75], a[112:115], 0
    v_mfma_f32_32x32x16_bf16 v[184:199], v[76:79], a[4:7], v[184:199]
    v_mfma_f32_32x32x16_bf16 v[200:215], v[76:79], a[116:119], v[200:215]
    v_mfma_f32_32x32x16_bf16 v[184:199], v[80:83], a[8:11], v[184:199]
    v_mfma_f32_32x32x16_bf16 v[200:215], v[80:83], a[120:123], v[200:215]
    v_mfma_f32_32x32x16_bf16 v[184:199], v[84:87], a[12:15], v[184:199]
    v_mfma_f32_32x32x16_bf16 v[200:215], v[84:87], a[124:127], v[200:215]
    v_mfma_f32_32x32x16_bf16 v[184:199], v[88:91], a[16:19], v[184:199]
    v_mfma_f32_32x32x16_bf16 v[200:215], v[88:91], a[128:131], v[200:215]
    v_mfma_f32_32x32x16_bf16 v[184:199], v[92:95], a[20:23], v[184:199]
    v_mfma_f32_32x32x16_bf16 v[200:215], v[92:95], a[132:135], v[200:215]
    v_mfma_f32_32x32x16_bf16 v[184:199], v[96:99], a[24:27], v[184:199]
    v_mfma_f32_32x32x16_bf16 v[200:215], v[96:99], a[136:139], v[200:215]
    v_mfma_f32_32x32x16_bf16 v[184:199], v[100:103], a[28:31], v[184:199]
    v_mfma_f32_32x32x16_bf16 v[200:215], v[100:103], a[140:143], v[200:215]
    v_mfma_f32_32x32x16_bf16 v[184:199], v[104:107], a[32:35], v[184:199]
    v_mfma_f32_32x32x16_bf16 v[200:215], v[104:107], a[144:147], v[200:215]
    v_mfma_f32_32x32x16_bf16 v[184:199], v[108:111], a[36:39], v[184:199]
    v_mfma_f32_32x32x16_bf16 v[200:215], v[108:111], a[148:151], v[200:215]
    v_mfma_f32_32x32x16_bf16 v[184:199], v[112:115], a[40:43], v[184:199]
    v_mfma_f32_32x32x16_bf16 v[200:215], v[112:115], a[152:155], v[200:215]
    v_mfma_f32_32x32x16_bf16 v[184:199], v[116:119], a[44:47], v[184:199]
    v_mfma_f32_32x32x16_bf16 v[200:215], v[116:119], a[156:159], v[200:215]
    v_mfma_f32_32x32x16_bf16 v[184:199], v[120:123], a[48:51], v[184:199]
    v_mfma_f32_32x32x16_bf16 v[200:215], v[120:123], a[160:163], v[200:215]
    v_mfma_f32_32x32x16_bf16 v[184:199], v[124:127], a[52:55], v[184:199]
    v_mfma_f32_32x32x16_bf16 v[200:215], v[124:127], a[164:167], v[200:215]
    s_add_u32 s39, s36, 12288
    buffer_load_dwordx4 v[72:75], v5, s[48:51], s39 offen offset:2048
    buffer_load_dwordx4 v[76:79], v5, s[48:51], s39 offen offset:3072
    s_add_u32 s39, s36, 16384
    buffer_load_dwordx4 v[80:83], v5, s[48:51], s39 offen offset:0
    buffer_load_dwordx4 v[84:87], v5, s[48:51], s39 offen offset:1024
    buffer_load_dwordx4 v[88:91], v5, s[48:51], s39 offen offset:2048
    buffer_load_dwordx4 v[92:95], v5, s[48:51], s39 offen offset:3072
    s_add_u32 s39, s36, 20480
    buffer_load_dwordx4 v[96:99], v5, s[48:51], s39 offen offset:0
    buffer_load_dwordx4 v[100:103], v5, s[48:51], s39 offen offset:1024
    buffer_load_dwordx4 v[104:107], v5, s[48:51], s39 offen offset:2048
    buffer_load_dwordx4 v[108:111], v5, s[48:51], s39 offen offset:3072
    s_add_u32 s39, s36, 24576
    buffer_load_dwordx4 v[112:115], v5, s[48:51], s39 offen offset:0
    buffer_load_dwordx4 v[116:119], v5, s[48:51], s39 offen offset:1024
    buffer_load_dwordx4 v[120:123], v5, s[48:51], s39 offen offset:2048
    buffer_load_dwordx4 v[124:127], v5, s[48:51], s39 offen offset:3072
    s_add_u32 s36, s36, 114688
    s_waitcnt vmcnt(28)
    v_mfma_f32_32x32x16_bf16 v[184:199], v[128:131], a[56:59], v[184:199]
    v_mfma_f32_32x32x16_bf16 v[200:215], v[128:131], a[168:171], v[200:215]
    v_mfma_f32_32x32x16_bf16 v[184:199], v[132:135], a[60:63], v[184:199]
    v_mfma_f32_32x32x16_bf16 v[200:215], v[132:135], a[172:175], v[200:215]
    v_mfma_f32_32x32x16_bf16 v[184:199], v[136:139], a[64:67], v[184:199]
    v_mfma_f32_32x32x16_bf16 v[200:215], v[136:139], a[176:179], v[200:215]
    v_mfma_f32_32x32x16_bf16 v[184:199], v[140:143], a[68:71], v[184:199]
    v_mfma_f32_32x32x16_bf16 v[200:215], v[140:143], a[180:183], v[200:215]
    v_mfma_f32_32x32x16_bf16 v[184:199], v[144:147], a[72:75], v[184:199]
    v_mfma_f32_32x32x16_bf16 v[200:215], v[144:147], a[184:187], v[200:215]
    v_mfma_f32_32x32x16_bf16 v[184:199], v[148:151], a[76:79], v[184:199]
    v_mfma_f32_32x32x16_bf16 v[200:215], v[148:151], a[188:191], v[200:215]
    v_mfma_f32_32x32x16_bf16 v[184:199], v[152:155], a[80:83], v[184:199]
    v_mfma_f32_32x32x16_bf16 v[200:215], v[152:155], a[192:195], v[200:215]
    v_mfma_f32_32x32x16_bf16 v[184:199], v[156:159], a[84:87], v[184:199]
    v_mfma_f32_32x32x16_bf16 v[200:215], v[156:159], a[196:199], v[200:215]
    v_mfma_f32_32x32x16_bf16 v[184:199], v[160:163], a[88:91], v[184:199]
    v_mfma_f32_32x32x16_bf16 v[200:215], v[160:163], a[200:203], v[200:215]
    v_mfma_f32_32x32x16_bf16 v[184:199], v[164:167], a[92:95], v[184:199]
    v_mfma_f32_32x32x16_bf16 v[200:215], v[164:167], a[204:207], v[200:215]
    v_mfma_f32_32x32x16_bf16 v[184:199], v[168:171], a[96:99], v[184:199]
    v_mfma_f32_32x32x16_bf16 v[200:215], v[168:171], a[208:211], v[200:215]
    v_mfma_f32_32x32x16_bf16 v[184:199], v[172:175], a[100:103], v[184:199]
    v_mfma_f32_32x32x16_bf16 v[200:215], v[172:175], a[212:215], v[200:215]
    v_mfma_f32_32x32x16_bf16 v[184:199], v[176:179], a[104:107], v[184:199]
    v_mfma_f32_32x32x16_bf16 v[200:215], v[176:179], a[216:219], v[200:215]
    v_mfma_f32_32x32x16_bf16 v[184:199], v[180:183], a[108:111], v[184:199]
    v_mfma_f32_32x32x16_bf16 v[200:215], v[180:183], a[220:223], v[200:215]
    s_nop 15
    s_nop 1
    v_cvt_pk_bf16_f32 v216, v184, v185
    v_cvt_pk_bf16_f32 v217, v186, v187
    v_cvt_pk_bf16_f32 v218, v188, v189
    v_cvt_pk_bf16_f32 v219, v190, v191
    v_cvt_pk_bf16_f32 v220, v192, v193
    v_cvt_pk_bf16_f32 v221, v194, v195
    v_cvt_pk_bf16_f32 v222, v196, v197
    v_cvt_pk_bf16_f32 v223, v198, v199
    v_cvt_pk_bf16_f32 v224, v200, v201
    v_cvt_pk_bf16_f32 v225, v202, v203
    v_cvt_pk_bf16_f32 v226, v204, v205
    v_cvt_pk_bf16_f32 v227, v206, v207
    v_cvt_pk_bf16_f32 v228, v208, v209
    v_cvt_pk_bf16_f32 v229, v210, v211
    v_cvt_pk_bf16_f32 v230, v212, v213
    v_cvt_pk_bf16_f32 v231, v214, v215
    buffer_store_dwordx4 v[216:219], v6, s[56:59], s37 offen offset:0 sc1
    buffer_store_dwordx4 v[220:223], v7, s[56:59], s37 offen offset:0 sc1
    buffer_store_dwordx4 v[224:227], v6, s[56:59], s37 offen offset:512 sc1
    buffer_store_dwordx4 v[228:231], v7, s[56:59], s37 offen offset:512 sc1
    s_add_u32 s37, s37, 1835008
    s_add_u32 s39, s36, 0
    buffer_load_dwordx4 v[128:131], v5, s[48:51], s39 offen offset:0
    buffer_load_dwordx4 v[132:135], v5, s[48:51], s39 offen offset:1024
    buffer_load_dwordx4 v[136:139], v5, s[48:51], s39 offen offset:2048
    buffer_load_dwordx4 v[140:143], v5, s[48:51], s39 offen offset:3072
    s_add_u32 s39, s36, 4096
    buffer_load_dwordx4 v[144:147], v5, s[48:51], s39 offen offset:0
    buffer_load_dwordx4 v[148:151], v5, s[48:51], s39 offen offset:1024
    buffer_load_dwordx4 v[152:155], v5, s[48:51], s39 offen offset:2048
    buffer_load_dwordx4 v[156:159], v5, s[48:51], s39 offen offset:3072
    s_add_u32 s39, s36, 8192
    buffer_load_dwordx4 v[160:163], v5, s[48:51], s39 offen offset:0
    buffer_load_dwordx4 v[164:167], v5, s[48:51], s39 offen offset:1024
    buffer_load_dwordx4 v[168:171], v5, s[48:51], s39 offen offset:2048
    buffer_load_dwordx4 v[172:175], v5, s[48:51], s39 offen offset:3072
    s_add_u32 s39, s36, 12288
    buffer_load_dwordx4 v[176:179], v5, s[48:51], s39 offen offset:0
    buffer_load_dwordx4 v[180:183], v5, s[48:51], s39 offen offset:1024
    s_waitcnt vmcnt(28)
    v_mfma_f32_32x32x16_bf16 v[184:199], v[16:19], a[0:3], 0
    v_mfma_f32_32x32x16_bf16 v[200:215], v[16:19], a[112:115], 0
    v_mfma_f32_32x32x16_bf16 v[184:199], v[20:23], a[4:7], v[184:199]
    v_mfma_f32_32x32x16_bf16 v[200:215], v[20:23], a[116:119], v[200:215]
    v_mfma_f32_32x32x16_bf16 v[184:199], v[24:27], a[8:11], v[184:199]
    v_mfma_f32_32x32x16_bf16 v[200:215], v[24:27], a[120:123], v[200:215]
    v_mfma_f32_32x32x16_bf16 v[184:199], v[28:31], a[12:15], v[184:199]
    v_mfma_f32_32x32x16_bf16 v[200:215], v[28:31], a[124:127], v[200:215]
    v_mfma_f32_32x32x16_bf16 v[184:199], v[32:35], a[16:19], v[184:199]
    v_mfma_f32_32x32x16_bf16 v[200:215], v[32:35], a[128:131], v[200:215]
    v_mfma_f32_32x32x16_bf16 v[184:199], v[36:39], a[20:23], v[184:199]
    v_mfma_f32_32x32x16_bf16 v[200:215], v[36:39], a[132:135], v[200:215]
    v_mfma_f32_32x32x16_bf16 v[184:199], v[40:43], a[24:27], v[184:199]
    v_mfma_f32_32x32x16_bf16 v[200:215], v[40:43], a[136:139], v[200:215]
    v_mfma_f32_32x32x16_bf16 v[184:199], v[44:47], a[28:31], v[184:199]
    v_mfma_f32_32x32x16_bf16 v[200:215], v[44:47], a[140:143], v[200:215]
    v_mfma_f32_32x32x16_bf16 v[184:199], v[48:51], a[32:35], v[184:199]
    v_mfma_f32_32x32x16_bf16 v[200:215], v[48:51], a[144:147], v[200:215]
    v_mfma_f32_32x32x16_bf16 v[184:199], v[52:55], a[36:39], v[184:199]
    v_mfma_f32_32x32x16_bf16 v[200:215], v[52:55], a[148:151], v[200:215]
    v_mfma_f32_32x32x16_bf16 v[184:199], v[56:59], a[40:43], v[184:199]
    v_mfma_f32_32x32x16_bf16 v[200:215], v[56:59], a[152:155], v[200:215]
    v_mfma_f32_32x32x16_bf16 v[184:199], v[60:63], a[44:47], v[184:199]
    v_mfma_f32_32x32x16_bf16 v[200:215], v[60:63], a[156:159], v[200:215]
    v_mfma_f32_32x32x16_bf16 v[184:199], v[64:67], a[48:51], v[184:199]
    v_mfma_f32_32x32x16_bf16 v[200:215], v[64:67], a[160:163], v[200:215]
    v_mfma_f32_32x32x16_bf16 v[184:199], v[68:71], a[52:55], v[184:199]
    v_mfma_f32_32x32x16_bf16 v[200:215], v[68:71], a[164:167], v[200:215]
    s_add_u32 s39, s36, 12288
    buffer_load_dwordx4 v[16:19], v5, s[48:51], s39 offen offset:2048
    buffer_load_dwordx4 v[20:23], v5, s[48:51], s39 offen offset:3072
    s_add_u32 s39, s36, 16384
    buffer_load_dwordx4 v[24:27], v5, s[48:51], s39 offen offset:0
    buffer_load_dwordx4 v[28:31], v5, s[48:51], s39 offen offset:1024
    buffer_load_dwordx4 v[32:35], v5, s[48:51], s39 offen offset:2048
    buffer_load_dwordx4 v[36:39], v5, s[48:51], s39 offen offset:3072
    s_add_u32 s39, s36, 20480
    buffer_load_dwordx4 v[40:43], v5, s[48:51], s39 offen offset:0
    buffer_load_dwordx4 v[44:47], v5, s[48:51], s39 offen offset:1024
    buffer_load_dwordx4 v[48:51], v5, s[48:51], s39 offen offset:2048
    buffer_load_dwordx4 v[52:55], v5, s[48:51], s39 offen offset:3072
    s_add_u32 s39, s36, 24576
    buffer_load_dwordx4 v[56:59], v5, s[48:51], s39 offen offset:0
    buffer_load_dwordx4 v[60:63], v5, s[48:51], s39 offen offset:1024
    buffer_load_dwordx4 v[64:67], v5, s[48:51], s39 offen offset:2048
    buffer_load_dwordx4 v[68:71], v5, s[48:51], s39 offen offset:3072
    s_add_u32 s36, s36, 114688
    s_waitcnt vmcnt(28)
    s_barrier
    v_mov_b32 v13, 0
    s_lshl_b32 s22, s100, 2
    s_add_u32 s22, s22, 6144
    v_cmp_eq_u32 vcc, 0, v0
    s_and_b64 exec, exec, vcc
    buffer_store_dword v13, v13, s[96:99], s22 offen offset:0 sc1
    s_mov_b64 exec, -1
    v_mfma_f32_32x32x16_bf16 v[184:199], v[72:75], a[56:59], v[184:199]
    v_mfma_f32_32x32x16_bf16 v[200:215], v[72:75], a[168:171], v[200:215]
    v_mfma_f32_32x32x16_bf16 v[184:199], v[76:79], a[60:63], v[184:199]
    v_mfma_f32_32x32x16_bf16 v[200:215], v[76:79], a[172:175], v[200:215]
    v_mfma_f32_32x32x16_bf16 v[184:199], v[80:83], a[64:67], v[184:199]
    v_mfma_f32_32x32x16_bf16 v[200:215], v[80:83], a[176:179], v[200:215]
    v_mfma_f32_32x32x16_bf16 v[184:199], v[84:87], a[68:71], v[184:199]
    v_mfma_f32_32x32x16_bf16 v[200:215], v[84:87], a[180:183], v[200:215]
    v_mfma_f32_32x32x16_bf16 v[184:199], v[88:91], a[72:75], v[184:199]
    v_mfma_f32_32x32x16_bf16 v[200:215], v[88:91], a[184:187], v[200:215]
    v_mfma_f32_32x32x16_bf16 v[184:199], v[92:95], a[76:79], v[184:199]
    v_mfma_f32_32x32x16_bf16 v[200:215], v[92:95], a[188:191], v[200:215]
    v_mfma_f32_32x32x16_bf16 v[184:199], v[96:99], a[80:83], v[184:199]
    v_mfma_f32_32x32x16_bf16 v[200:215], v[96:99], a[192:195], v[200:215]
    v_mfma_f32_32x32x16_bf16 v[184:199], v[100:103], a[84:87], v[184:199]
    v_mfma_f32_32x32x16_bf16 v[200:215], v[100:103], a[196:199], v[200:215]
    v_mfma_f32_32x32x16_bf16 v[184:199], v[104:107], a[88:91], v[184:199]
    v_mfma_f32_32x32x16_bf16 v[200:215], v[104:107], a[200:203], v[200:215]
    v_mfma_f32_32x32x16_bf16 v[184:199], v[108:111], a[92:95], v[184:199]
    v_mfma_f32_32x32x16_bf16 v[200:215], v[108:111], a[204:207], v[200:215]
    v_mfma_f32_32x32x16_bf16 v[184:199], v[112:115], a[96:99], v[184:199]
    v_mfma_f32_32x32x16_bf16 v[200:215], v[112:115], a[208:211], v[200:215]
    v_mfma_f32_32x32x16_bf16 v[184:199], v[116:119], a[100:103], v[184:199]
    v_mfma_f32_32x32x16_bf16 v[200:215], v[116:119], a[212:215], v[200:215]
    v_mfma_f32_32x32x16_bf16 v[184:199], v[120:123], a[104:107], v[184:199]
    v_mfma_f32_32x32x16_bf16 v[200:215], v[120:123], a[216:219], v[200:215]
    v_mfma_f32_32x32x16_bf16 v[184:199], v[124:127], a[108:111], v[184:199]
    v_mfma_f32_32x32x16_bf16 v[200:215], v[124:127], a[220:223], v[200:215]
    s_nop 15
    s_nop 1
    v_cvt_pk_bf16_f32 v216, v184, v185
    v_cvt_pk_bf16_f32 v217, v186, v187
    v_cvt_pk_bf16_f32 v218, v188, v189
    v_cvt_pk_bf16_f32 v219, v190, v191
    v_cvt_pk_bf16_f32 v220, v192, v193
    v_cvt_pk_bf16_f32 v221, v194, v195
    v_cvt_pk_bf16_f32 v222, v196, v197
    v_cvt_pk_bf16_f32 v223, v198, v199
    v_cvt_pk_bf16_f32 v224, v200, v201
    v_cvt_pk_bf16_f32 v225, v202, v203
    v_cvt_pk_bf16_f32 v226, v204, v205
    v_cvt_pk_bf16_f32 v227, v206, v207
    v_cvt_pk_bf16_f32 v228, v208, v209
    v_cvt_pk_bf16_f32 v229, v210, v211
    v_cvt_pk_bf16_f32 v230, v212, v213
    v_cvt_pk_bf16_f32 v231, v214, v215
    buffer_store_dwordx4 v[216:219], v6, s[56:59], s37 offen offset:0 sc1
    buffer_store_dwordx4 v[220:223], v7, s[56:59], s37 offen offset:0 sc1
    buffer_store_dwordx4 v[224:227], v6, s[56:59], s37 offen offset:512 sc1
    buffer_store_dwordx4 v[228:231], v7, s[56:59], s37 offen offset:512 sc1
    s_add_u32 s37, s37, 1835008
    s_add_u32 s39, s36, 0
    buffer_load_dwordx4 v[72:75], v5, s[48:51], s39 offen offset:0
    buffer_load_dwordx4 v[76:79], v5, s[48:51], s39 offen offset:1024
    buffer_load_dwordx4 v[80:83], v5, s[48:51], s39 offen offset:2048
    buffer_load_dwordx4 v[84:87], v5, s[48:51], s39 offen offset:3072
    s_add_u32 s39, s36, 4096
    buffer_load_dwordx4 v[88:91], v5, s[48:51], s39 offen offset:0
    buffer_load_dwordx4 v[92:95], v5, s[48:51], s39 offen offset:1024
    buffer_load_dwordx4 v[96:99], v5, s[48:51], s39 offen offset:2048
    buffer_load_dwordx4 v[100:103], v5, s[48:51], s39 offen offset:3072
    s_add_u32 s39, s36, 8192
    buffer_load_dwordx4 v[104:107], v5, s[48:51], s39 offen offset:0
    buffer_load_dwordx4 v[108:111], v5, s[48:51], s39 offen offset:1024
    buffer_load_dwordx4 v[112:115], v5, s[48:51], s39 offen offset:2048
    buffer_load_dwordx4 v[116:119], v5, s[48:51], s39 offen offset:3072
    s_add_u32 s39, s36, 12288
    buffer_load_dwordx4 v[120:123], v5, s[48:51], s39 offen offset:0
    buffer_load_dwordx4 v[124:127], v5, s[48:51], s39 offen offset:1024
    s_waitcnt vmcnt(28)
    v_mfma_f32_32x32x16_bf16 v[184:199], v[128:131], a[0:3], 0
    v_mfma_f32_32x32x16_bf16 v[200:215], v[128:131], a[112:115], 0
    v_mfma_f32_32x32x16_bf16 v[184:199], v[132:135], a[4:7], v[184:199]
    v_mfma_f32_32x32x16_bf16 v[200:215], v[132:135], a[116:119], v[200:215]
    v_mfma_f32_32x32x16_bf16 v[184:199], v[136:139], a[8:11], v[184:199]
    v_mfma_f32_32x32x16_bf16 v[200:215], v[136:139], a[120:123], v[200:215]
    v_mfma_f32_32x32x16_bf16 v[184:199], v[140:143], a[12:15], v[184:199]
    v_mfma_f32_32x32x16_bf16 v[200:215], v[140:143], a[124:127], v[200:215]
    v_mfma_f32_32x32x16_bf16 v[184:199], v[144:147], a[16:19], v[184:199]
    v_mfma_f32_32x32x16_bf16 v[200:215], v[144:147], a[128:131], v[200:215]
    v_mfma_f32_32x32x16_bf16 v[184:199], v[148:151], a[20:23], v[184:199]
    v_mfma_f32_32x32x16_bf16 v[200:215], v[148:151], a[132:135], v[200:215]
    v_mfma_f32_32x32x16_bf16 v[184:199], v[152:155], a[24:27], v[184:199]
    v_mfma_f32_32x32x16_bf16 v[200:215], v[152:155], a[136:139], v[200:215]
    v_mfma_f32_32x32x16_bf16 v[184:199], v[156:159], a[28:31], v[184:199]
    v_mfma_f32_32x32x16_bf16 v[200:215], v[156:159], a[140:143], v[200:215]
    v_mfma_f32_32x32x16_bf16 v[184:199], v[160:163], a[32:35], v[184:199]
    v_mfma_f32_32x32x16_bf16 v[200:215], v[160:163], a[144:147], v[200:215]
    v_mfma_f32_32x32x16_bf16 v[184:199], v[164:167], a[36:39], v[184:199]
    v_mfma_f32_32x32x16_bf16 v[200:215], v[164:167], a[148:151], v[200:215]
    v_mfma_f32_32x32x16_bf16 v[184:199], v[168:171], a[40:43], v[184:199]
    v_mfma_f32_32x32x16_bf16 v[200:215], v[168:171], a[152:155], v[200:215]
    v_mfma_f32_32x32x16_bf16 v[184:199], v[172:175], a[44:47], v[184:199]
    v_mfma_f32_32x32x16_bf16 v[200:215], v[172:175], a[156:159], v[200:215]
    v_mfma_f32_32x32x16_bf16 v[184:199], v[176:179], a[48:51], v[184:199]
    v_mfma_f32_32x32x16_bf16 v[200:215], v[176:179], a[160:163], v[200:215]
    v_mfma_f32_32x32x16_bf16 v[184:199], v[180:183], a[52:55], v[184:199]
    v_mfma_f32_32x32x16_bf16 v[200:215], v[180:183], a[164:167], v[200:215]
    s_add_u32 s39, s36, 12288
    buffer_load_dwordx4 v[128:131], v5, s[48:51], s39 offen offset:2048
    buffer_load_dwordx4 v[132:135], v5, s[48:51], s39 offen offset:3072
    s_add_u32 s39, s36, 16384
    buffer_load_dwordx4 v[136:139], v5, s[48:51], s39 offen offset:0
    buffer_load_dwordx4 v[140:143], v5, s[48:51], s39 offen offset:1024
    buffer_load_dwordx4 v[144:147], v5, s[48:51], s39 offen offset:2048
    buffer_load_dwordx4 v[148:151], v5, s[48:51], s39 offen offset:3072
    s_add_u32 s39, s36, 20480
    buffer_load_dwordx4 v[152:155], v5, s[48:51], s39 offen offset:0
    buffer_load_dwordx4 v[156:159], v5, s[48:51], s39 offen offset:1024
    buffer_load_dwordx4 v[160:163], v5, s[48:51], s39 offen offset:2048
    buffer_load_dwordx4 v[164:167], v5, s[48:51], s39 offen offset:3072
    s_add_u32 s39, s36, 24576
    buffer_load_dwordx4 v[168:171], v5, s[48:51], s39 offen offset:0
    buffer_load_dwordx4 v[172:175], v5, s[48:51], s39 offen offset:1024
    buffer_load_dwordx4 v[176:179], v5, s[48:51], s39 offen offset:2048
    buffer_load_dwordx4 v[180:183], v5, s[48:51], s39 offen offset:3072
    s_add_u32 s36, s36, 114688
    s_waitcnt vmcnt(28)
    v_mfma_f32_32x32x16_bf16 v[184:199], v[16:19], a[56:59], v[184:199]
    v_mfma_f32_32x32x16_bf16 v[200:215], v[16:19], a[168:171], v[200:215]
    v_mfma_f32_32x32x16_bf16 v[184:199], v[20:23], a[60:63], v[184:199]
    v_mfma_f32_32x32x16_bf16 v[200:215], v[20:23], a[172:175], v[200:215]
    v_mfma_f32_32x32x16_bf16 v[184:199], v[24:27], a[64:67], v[184:199]
    v_mfma_f32_32x32x16_bf16 v[200:215], v[24:27], a[176:179], v[200:215]
    v_mfma_f32_32x32x16_bf16 v[184:199], v[28:31], a[68:71], v[184:199]
    v_mfma_f32_32x32x16_bf16 v[200:215], v[28:31], a[180:183], v[200:215]
    v_mfma_f32_32x32x16_bf16 v[184:199], v[32:35], a[72:75], v[184:199]
    v_mfma_f32_32x32x16_bf16 v[200:215], v[32:35], a[184:187], v[200:215]
    v_mfma_f32_32x32x16_bf16 v[184:199], v[36:39], a[76:79], v[184:199]
    v_mfma_f32_32x32x16_bf16 v[200:215], v[36:39], a[188:191], v[200:215]
    v_mfma_f32_32x32x16_bf16 v[184:199], v[40:43], a[80:83], v[184:199]
    v_mfma_f32_32x32x16_bf16 v[200:215], v[40:43], a[192:195], v[200:215]
    v_mfma_f32_32x32x16_bf16 v[184:199], v[44:47], a[84:87], v[184:199]
    v_mfma_f32_32x32x16_bf16 v[200:215], v[44:47], a[196:199], v[200:215]
    v_mfma_f32_32x32x16_bf16 v[184:199], v[48:51], a[88:91], v[184:199]
    v_mfma_f32_32x32x16_bf16 v[200:215], v[48:51], a[200:203], v[200:215]
    v_mfma_f32_32x32x16_bf16 v[184:199], v[52:55], a[92:95], v[184:199]
    v_mfma_f32_32x32x16_bf16 v[200:215], v[52:55], a[204:207], v[200:215]
    v_mfma_f32_32x32x16_bf16 v[184:199], v[56:59], a[96:99], v[184:199]
    v_mfma_f32_32x32x16_bf16 v[200:215], v[56:59], a[208:211], v[200:215]
    v_mfma_f32_32x32x16_bf16 v[184:199], v[60:63], a[100:103], v[184:199]
    v_mfma_f32_32x32x16_bf16 v[200:215], v[60:63], a[212:215], v[200:215]
    v_mfma_f32_32x32x16_bf16 v[184:199], v[64:67], a[104:107], v[184:199]
    v_mfma_f32_32x32x16_bf16 v[200:215], v[64:67], a[216:219], v[200:215]
    v_mfma_f32_32x32x16_bf16 v[184:199], v[68:71], a[108:111], v[184:199]
    v_mfma_f32_32x32x16_bf16 v[200:215], v[68:71], a[220:223], v[200:215]
    s_nop 15
    s_nop 1
    v_cvt_pk_bf16_f32 v216, v184, v185
    v_cvt_pk_bf16_f32 v217, v186, v187
    v_cvt_pk_bf16_f32 v218, v188, v189
    v_cvt_pk_bf16_f32 v219, v190, v191
    v_cvt_pk_bf16_f32 v220, v192, v193
    v_cvt_pk_bf16_f32 v221, v194, v195
    v_cvt_pk_bf16_f32 v222, v196, v197
    v_cvt_pk_bf16_f32 v223, v198, v199
    v_cvt_pk_bf16_f32 v224, v200, v201
    v_cvt_pk_bf16_f32 v225, v202, v203
    v_cvt_pk_bf16_f32 v226, v204, v205
    v_cvt_pk_bf16_f32 v227, v206, v207
    v_cvt_pk_bf16_f32 v228, v208, v209
    v_cvt_pk_bf16_f32 v229, v210, v211
    v_cvt_pk_bf16_f32 v230, v212, v213
    v_cvt_pk_bf16_f32 v231, v214, v215
    buffer_store_dwordx4 v[216:219], v6, s[56:59], s37 offen offset:0 sc1
    buffer_store_dwordx4 v[220:223], v7, s[56:59], s37 offen offset:0 sc1
    buffer_store_dwordx4 v[224:227], v6, s[56:59], s37 offen offset:512 sc1
    buffer_store_dwordx4 v[228:231], v7, s[56:59], s37 offen offset:512 sc1
    s_add_u32 s37, s37, 1835008
    s_add_u32 s39, s36, 0
    buffer_load_dwordx4 v[16:19], v5, s[48:51], s39 offen offset:0
    buffer_load_dwordx4 v[20:23], v5, s[48:51], s39 offen offset:1024
    buffer_load_dwordx4 v[24:27], v5, s[48:51], s39 offen offset:2048
    buffer_load_dwordx4 v[28:31], v5, s[48:51], s39 offen offset:3072
    s_add_u32 s39, s36, 4096
    buffer_load_dwordx4 v[32:35], v5, s[48:51], s39 offen offset:0
    buffer_load_dwordx4 v[36:39], v5, s[48:51], s39 offen offset:1024
    buffer_load_dwordx4 v[40:43], v5, s[48:51], s39 offen offset:2048
    buffer_load_dwordx4 v[44:47], v5, s[48:51], s39 offen offset:3072
    s_add_u32 s39, s36, 8192
    buffer_load_dwordx4 v[48:51], v5, s[48:51], s39 offen offset:0
    buffer_load_dwordx4 v[52:55], v5, s[48:51], s39 offen offset:1024
    buffer_load_dwordx4 v[56:59], v5, s[48:51], s39 offen offset:2048
    buffer_load_dwordx4 v[60:63], v5, s[48:51], s39 offen offset:3072
    s_add_u32 s39, s36, 12288
    buffer_load_dwordx4 v[64:67], v5, s[48:51], s39 offen offset:0
    buffer_load_dwordx4 v[68:71], v5, s[48:51], s39 offen offset:1024
    s_waitcnt vmcnt(28)
    v_mfma_f32_32x32x16_bf16 v[184:199], v[72:75], a[0:3], 0
    v_mfma_f32_32x32x16_bf16 v[200:215], v[72:75], a[112:115], 0
    v_mfma_f32_32x32x16_bf16 v[184:199], v[76:79], a[4:7], v[184:199]
    v_mfma_f32_32x32x16_bf16 v[200:215], v[76:79], a[116:119], v[200:215]
    v_mfma_f32_32x32x16_bf16 v[184:199], v[80:83], a[8:11], v[184:199]
    v_mfma_f32_32x32x16_bf16 v[200:215], v[80:83], a[120:123], v[200:215]
    v_mfma_f32_32x32x16_bf16 v[184:199], v[84:87], a[12:15], v[184:199]
    v_mfma_f32_32x32x16_bf16 v[200:215], v[84:87], a[124:127], v[200:215]
    v_mfma_f32_32x32x16_bf16 v[184:199], v[88:91], a[16:19], v[184:199]
    v_mfma_f32_32x32x16_bf16 v[200:215], v[88:91], a[128:131], v[200:215]
    v_mfma_f32_32x32x16_bf16 v[184:199], v[92:95], a[20:23], v[184:199]
    v_mfma_f32_32x32x16_bf16 v[200:215], v[92:95], a[132:135], v[200:215]
    v_mfma_f32_32x32x16_bf16 v[184:199], v[96:99], a[24:27], v[184:199]
    v_mfma_f32_32x32x16_bf16 v[200:215], v[96:99], a[136:139], v[200:215]
    v_mfma_f32_32x32x16_bf16 v[184:199], v[100:103], a[28:31], v[184:199]
    v_mfma_f32_32x32x16_bf16 v[200:215], v[100:103], a[140:143], v[200:215]
    v_mfma_f32_32x32x16_bf16 v[184:199], v[104:107], a[32:35], v[184:199]
    v_mfma_f32_32x32x16_bf16 v[200:215], v[104:107], a[144:147], v[200:215]
    v_mfma_f32_32x32x16_bf16 v[184:199], v[108:111], a[36:39], v[184:199]
    v_mfma_f32_32x32x16_bf16 v[200:215], v[108:111], a[148:151], v[200:215]
    v_mfma_f32_32x32x16_bf16 v[184:199], v[112:115], a[40:43], v[184:199]
    v_mfma_f32_32x32x16_bf16 v[200:215], v[112:115], a[152:155], v[200:215]
    v_mfma_f32_32x32x16_bf16 v[184:199], v[116:119], a[44:47], v[184:199]
    v_mfma_f32_32x32x16_bf16 v[200:215], v[116:119], a[156:159], v[200:215]
    v_mfma_f32_32x32x16_bf16 v[184:199], v[120:123], a[48:51], v[184:199]
    v_mfma_f32_32x32x16_bf16 v[200:215], v[120:123], a[160:163], v[200:215]
    v_mfma_f32_32x32x16_bf16 v[184:199], v[124:127], a[52:55], v[184:199]
    v_mfma_f32_32x32x16_bf16 v[200:215], v[124:127], a[164:167], v[200:215]
    s_add_u32 s39, s36, 12288
    buffer_load_dwordx4 v[72:75], v5, s[48:51], s39 offen offset:2048
    buffer_load_dwordx4 v[76:79], v5, s[48:51], s39 offen offset:3072
    s_add_u32 s39, s36, 16384
    buffer_load_dwordx4 v[80:83], v5, s[48:51], s39 offen offset:0
    buffer_load_dwordx4 v[84:87], v5, s[48:51], s39 offen offset:1024
    buffer_load_dwordx4 v[88:91], v5, s[48:51], s39 offen offset:2048
    buffer_load_dwordx4 v[92:95], v5, s[48:51], s39 offen offset:3072
    s_add_u32 s39, s36, 20480
    buffer_load_dwordx4 v[96:99], v5, s[48:51], s39 offen offset:0
    buffer_load_dwordx4 v[100:103], v5, s[48:51], s39 offen offset:1024
    buffer_load_dwordx4 v[104:107], v5, s[48:51], s39 offen offset:2048
    buffer_load_dwordx4 v[108:111], v5, s[48:51], s39 offen offset:3072
    s_add_u32 s39, s36, 24576
    buffer_load_dwordx4 v[112:115], v5, s[48:51], s39 offen offset:0
    buffer_load_dwordx4 v[116:119], v5, s[48:51], s39 offen offset:1024
    buffer_load_dwordx4 v[120:123], v5, s[48:51], s39 offen offset:2048
    buffer_load_dwordx4 v[124:127], v5, s[48:51], s39 offen offset:3072
    s_add_u32 s36, s36, 114688
    s_waitcnt vmcnt(28)
    s_barrier
    v_mov_b32 v13, 0
    s_lshl_b32 s22, s100, 2
    s_add_u32 s22, s22, 7168
    v_cmp_eq_u32 vcc, 0, v0
    s_and_b64 exec, exec, vcc
    buffer_store_dword v13, v13, s[96:99], s22 offen offset:0 sc1
    s_mov_b64 exec, -1
    v_mfma_f32_32x32x16_bf16 v[184:199], v[128:131], a[56:59], v[184:199]
    v_mfma_f32_32x32x16_bf16 v[200:215], v[128:131], a[168:171], v[200:215]
    v_mfma_f32_32x32x16_bf16 v[184:199], v[132:135], a[60:63], v[184:199]
    v_mfma_f32_32x32x16_bf16 v[200:215], v[132:135], a[172:175], v[200:215]
    v_mfma_f32_32x32x16_bf16 v[184:199], v[136:139], a[64:67], v[184:199]
    v_mfma_f32_32x32x16_bf16 v[200:215], v[136:139], a[176:179], v[200:215]
    v_mfma_f32_32x32x16_bf16 v[184:199], v[140:143], a[68:71], v[184:199]
    v_mfma_f32_32x32x16_bf16 v[200:215], v[140:143], a[180:183], v[200:215]
    v_mfma_f32_32x32x16_bf16 v[184:199], v[144:147], a[72:75], v[184:199]
    v_mfma_f32_32x32x16_bf16 v[200:215], v[144:147], a[184:187], v[200:215]
    v_mfma_f32_32x32x16_bf16 v[184:199], v[148:151], a[76:79], v[184:199]
    v_mfma_f32_32x32x16_bf16 v[200:215], v[148:151], a[188:191], v[200:215]
    v_mfma_f32_32x32x16_bf16 v[184:199], v[152:155], a[80:83], v[184:199]
    v_mfma_f32_32x32x16_bf16 v[200:215], v[152:155], a[192:195], v[200:215]
    v_mfma_f32_32x32x16_bf16 v[184:199], v[156:159], a[84:87], v[184:199]
    v_mfma_f32_32x32x16_bf16 v[200:215], v[156:159], a[196:199], v[200:215]
    v_mfma_f32_32x32x16_bf16 v[184:199], v[160:163], a[88:91], v[184:199]
    v_mfma_f32_32x32x16_bf16 v[200:215], v[160:163], a[200:203], v[200:215]
    v_mfma_f32_32x32x16_bf16 v[184:199], v[164:167], a[92:95], v[184:199]
    v_mfma_f32_32x32x16_bf16 v[200:215], v[164:167], a[204:207], v[200:215]
    v_mfma_f32_32x32x16_bf16 v[184:199], v[168:171], a[96:99], v[184:199]
    v_mfma_f32_32x32x16_bf16 v[200:215], v[168:171], a[208:211], v[200:215]
    v_mfma_f32_32x32x16_bf16 v[184:199], v[172:175], a[100:103], v[184:199]
    v_mfma_f32_32x32x16_bf16 v[200:215], v[172:175], a[212:215], v[200:215]
    v_mfma_f32_32x32x16_bf16 v[184:199], v[176:179], a[104:107], v[184:199]
    v_mfma_f32_32x32x16_bf16 v[200:215], v[176:179], a[216:219], v[200:215]
    v_mfma_f32_32x32x16_bf16 v[184:199], v[180:183], a[108:111], v[184:199]
    v_mfma_f32_32x32x16_bf16 v[200:215], v[180:183], a[220:223], v[200:215]
    s_nop 15
    s_nop 1
    v_cvt_pk_bf16_f32 v216, v184, v185
    v_cvt_pk_bf16_f32 v217, v186, v187
    v_cvt_pk_bf16_f32 v218, v188, v189
    v_cvt_pk_bf16_f32 v219, v190, v191
    v_cvt_pk_bf16_f32 v220, v192, v193
    v_cvt_pk_bf16_f32 v221, v194, v195
    v_cvt_pk_bf16_f32 v222, v196, v197
    v_cvt_pk_bf16_f32 v223, v198, v199
    v_cvt_pk_bf16_f32 v224, v200, v201
    v_cvt_pk_bf16_f32 v225, v202, v203
    v_cvt_pk_bf16_f32 v226, v204, v205
    v_cvt_pk_bf16_f32 v227, v206, v207
    v_cvt_pk_bf16_f32 v228, v208, v209
    v_cvt_pk_bf16_f32 v229, v210, v211
    v_cvt_pk_bf16_f32 v230, v212, v213
    v_cvt_pk_bf16_f32 v231, v214, v215
    buffer_store_dwordx4 v[216:219], v6, s[56:59], s37 offen offset:0 sc1
    buffer_store_dwordx4 v[220:223], v7, s[56:59], s37 offen offset:0 sc1
    buffer_store_dwordx4 v[224:227], v6, s[56:59], s37 offen offset:512 sc1
    buffer_store_dwordx4 v[228:231], v7, s[56:59], s37 offen offset:512 sc1
    s_add_u32 s37, s37, 1835008
    s_add_u32 s39, s36, 0
    buffer_load_dwordx4 v[128:131], v5, s[48:51], s39 offen offset:0
    buffer_load_dwordx4 v[132:135], v5, s[48:51], s39 offen offset:1024
    buffer_load_dwordx4 v[136:139], v5, s[48:51], s39 offen offset:2048
    buffer_load_dwordx4 v[140:143], v5, s[48:51], s39 offen offset:3072
    s_add_u32 s39, s36, 4096
    buffer_load_dwordx4 v[144:147], v5, s[48:51], s39 offen offset:0
    buffer_load_dwordx4 v[148:151], v5, s[48:51], s39 offen offset:1024
    buffer_load_dwordx4 v[152:155], v5, s[48:51], s39 offen offset:2048
    buffer_load_dwordx4 v[156:159], v5, s[48:51], s39 offen offset:3072
    s_add_u32 s39, s36, 8192
    buffer_load_dwordx4 v[160:163], v5, s[48:51], s39 offen offset:0
    buffer_load_dwordx4 v[164:167], v5, s[48:51], s39 offen offset:1024
    buffer_load_dwordx4 v[168:171], v5, s[48:51], s39 offen offset:2048
    buffer_load_dwordx4 v[172:175], v5, s[48:51], s39 offen offset:3072
    s_add_u32 s39, s36, 12288
    buffer_load_dwordx4 v[176:179], v5, s[48:51], s39 offen offset:0
    buffer_load_dwordx4 v[180:183], v5, s[48:51], s39 offen offset:1024
    s_waitcnt vmcnt(28)
    v_mfma_f32_32x32x16_bf16 v[184:199], v[16:19], a[0:3], 0
    v_mfma_f32_32x32x16_bf16 v[200:215], v[16:19], a[112:115], 0
    v_mfma_f32_32x32x16_bf16 v[184:199], v[20:23], a[4:7], v[184:199]
    v_mfma_f32_32x32x16_bf16 v[200:215], v[20:23], a[116:119], v[200:215]
    v_mfma_f32_32x32x16_bf16 v[184:199], v[24:27], a[8:11], v[184:199]
    v_mfma_f32_32x32x16_bf16 v[200:215], v[24:27], a[120:123], v[200:215]
    v_mfma_f32_32x32x16_bf16 v[184:199], v[28:31], a[12:15], v[184:199]
    v_mfma_f32_32x32x16_bf16 v[200:215], v[28:31], a[124:127], v[200:215]
    v_mfma_f32_32x32x16_bf16 v[184:199], v[32:35], a[16:19], v[184:199]
    v_mfma_f32_32x32x16_bf16 v[200:215], v[32:35], a[128:131], v[200:215]
    v_mfma_f32_32x32x16_bf16 v[184:199], v[36:39], a[20:23], v[184:199]
    v_mfma_f32_32x32x16_bf16 v[200:215], v[36:39], a[132:135], v[200:215]
    v_mfma_f32_32x32x16_bf16 v[184:199], v[40:43], a[24:27], v[184:199]
    v_mfma_f32_32x32x16_bf16 v[200:215], v[40:43], a[136:139], v[200:215]
    v_mfma_f32_32x32x16_bf16 v[184:199], v[44:47], a[28:31], v[184:199]
    v_mfma_f32_32x32x16_bf16 v[200:215], v[44:47], a[140:143], v[200:215]
    v_mfma_f32_32x32x16_bf16 v[184:199], v[48:51], a[32:35], v[184:199]
    v_mfma_f32_32x32x16_bf16 v[200:215], v[48:51], a[144:147], v[200:215]
    v_mfma_f32_32x32x16_bf16 v[184:199], v[52:55], a[36:39], v[184:199]
    v_mfma_f32_32x32x16_bf16 v[200:215], v[52:55], a[148:151], v[200:215]
    v_mfma_f32_32x32x16_bf16 v[184:199], v[56:59], a[40:43], v[184:199]
    v_mfma_f32_32x32x16_bf16 v[200:215], v[56:59], a[152:155], v[200:215]
    v_mfma_f32_32x32x16_bf16 v[184:199], v[60:63], a[44:47], v[184:199]
    v_mfma_f32_32x32x16_bf16 v[200:215], v[60:63], a[156:159], v[200:215]
    v_mfma_f32_32x32x16_bf16 v[184:199], v[64:67], a[48:51], v[184:199]
    v_mfma_f32_32x32x16_bf16 v[200:215], v[64:67], a[160:163], v[200:215]
    v_mfma_f32_32x32x16_bf16 v[184:199], v[68:71], a[52:55], v[184:199]
    v_mfma_f32_32x32x16_bf16 v[200:215], v[68:71], a[164:167], v[200:215]
    s_add_u32 s39, s36, 12288
    buffer_load_dwordx4 v[16:19], v5, s[48:51], s39 offen offset:2048
    buffer_load_dwordx4 v[20:23], v5, s[48:51], s39 offen offset:3072
    s_add_u32 s39, s36, 16384
    buffer_load_dwordx4 v[24:27], v5, s[48:51], s39 offen offset:0
    buffer_load_dwordx4 v[28:31], v5, s[48:51], s39 offen offset:1024
    buffer_load_dwordx4 v[32:35], v5, s[48:51], s39 offen offset:2048
    buffer_load_dwordx4 v[36:39], v5, s[48:51], s39 offen offset:3072
    s_add_u32 s39, s36, 20480
    buffer_load_dwordx4 v[40:43], v5, s[48:51], s39 offen offset:0
    buffer_load_dwordx4 v[44:47], v5, s[48:51], s39 offen offset:1024
    buffer_load_dwordx4 v[48:51], v5, s[48:51], s39 offen offset:2048
    buffer_load_dwordx4 v[52:55], v5, s[48:51], s39 offen offset:3072
    s_add_u32 s39, s36, 24576
    buffer_load_dwordx4 v[56:59], v5, s[48:51], s39 offen offset:0
    buffer_load_dwordx4 v[60:63], v5, s[48:51], s39 offen offset:1024
    buffer_load_dwordx4 v[64:67], v5, s[48:51], s39 offen offset:2048
    buffer_load_dwordx4 v[68:71], v5, s[48:51], s39 offen offset:3072
    s_add_u32 s36, s36, 114688
    s_waitcnt vmcnt(28)
    v_mfma_f32_32x32x16_bf16 v[184:199], v[72:75], a[56:59], v[184:199]
    v_mfma_f32_32x32x16_bf16 v[200:215], v[72:75], a[168:171], v[200:215]
    v_mfma_f32_32x32x16_bf16 v[184:199], v[76:79], a[60:63], v[184:199]
    v_mfma_f32_32x32x16_bf16 v[200:215], v[76:79], a[172:175], v[200:215]
    v_mfma_f32_32x32x16_bf16 v[184:199], v[80:83], a[64:67], v[184:199]
    v_mfma_f32_32x32x16_bf16 v[200:215], v[80:83], a[176:179], v[200:215]
    v_mfma_f32_32x32x16_bf16 v[184:199], v[84:87], a[68:71], v[184:199]
    v_mfma_f32_32x32x16_bf16 v[200:215], v[84:87], a[180:183], v[200:215]
    v_mfma_f32_32x32x16_bf16 v[184:199], v[88:91], a[72:75], v[184:199]
    v_mfma_f32_32x32x16_bf16 v[200:215], v[88:91], a[184:187], v[200:215]
    v_mfma_f32_32x32x16_bf16 v[184:199], v[92:95], a[76:79], v[184:199]
    v_mfma_f32_32x32x16_bf16 v[200:215], v[92:95], a[188:191], v[200:215]
    v_mfma_f32_32x32x16_bf16 v[184:199], v[96:99], a[80:83], v[184:199]
    v_mfma_f32_32x32x16_bf16 v[200:215], v[96:99], a[192:195], v[200:215]
    v_mfma_f32_32x32x16_bf16 v[184:199], v[100:103], a[84:87], v[184:199]
    v_mfma_f32_32x32x16_bf16 v[200:215], v[100:103], a[196:199], v[200:215]
    v_mfma_f32_32x32x16_bf16 v[184:199], v[104:107], a[88:91], v[184:199]
    v_mfma_f32_32x32x16_bf16 v[200:215], v[104:107], a[200:203], v[200:215]
    v_mfma_f32_32x32x16_bf16 v[184:199], v[108:111], a[92:95], v[184:199]
    v_mfma_f32_32x32x16_bf16 v[200:215], v[108:111], a[204:207], v[200:215]
    v_mfma_f32_32x32x16_bf16 v[184:199], v[112:115], a[96:99], v[184:199]
    v_mfma_f32_32x32x16_bf16 v[200:215], v[112:115], a[208:211], v[200:215]
    v_mfma_f32_32x32x16_bf16 v[184:199], v[116:119], a[100:103], v[184:199]
    v_mfma_f32_32x32x16_bf16 v[200:215], v[116:119], a[212:215], v[200:215]
    v_mfma_f32_32x32x16_bf16 v[184:199], v[120:123], a[104:107], v[184:199]
    v_mfma_f32_32x32x16_bf16 v[200:215], v[120:123], a[216:219], v[200:215]
    v_mfma_f32_32x32x16_bf16 v[184:199], v[124:127], a[108:111], v[184:199]
    v_mfma_f32_32x32x16_bf16 v[200:215], v[124:127], a[220:223], v[200:215]
    s_nop 15
    s_nop 1
    v_cvt_pk_bf16_f32 v216, v184, v185
    v_cvt_pk_bf16_f32 v217, v186, v187
    v_cvt_pk_bf16_f32 v218, v188, v189
    v_cvt_pk_bf16_f32 v219, v190, v191
    v_cvt_pk_bf16_f32 v220, v192, v193
    v_cvt_pk_bf16_f32 v221, v194, v195
    v_cvt_pk_bf16_f32 v222, v196, v197
    v_cvt_pk_bf16_f32 v223, v198, v199
    v_cvt_pk_bf16_f32 v224, v200, v201
    v_cvt_pk_bf16_f32 v225, v202, v203
    v_cvt_pk_bf16_f32 v226, v204, v205
    v_cvt_pk_bf16_f32 v227, v206, v207
    v_cvt_pk_bf16_f32 v228, v208, v209
    v_cvt_pk_bf16_f32 v229, v210, v211
    v_cvt_pk_bf16_f32 v230, v212, v213
    v_cvt_pk_bf16_f32 v231, v214, v215
    buffer_store_dwordx4 v[216:219], v6, s[56:59], s37 offen offset:0 sc1
    buffer_store_dwordx4 v[220:223], v7, s[56:59], s37 offen offset:0 sc1
    buffer_store_dwordx4 v[224:227], v6, s[56:59], s37 offen offset:512 sc1
    buffer_store_dwordx4 v[228:231], v7, s[56:59], s37 offen offset:512 sc1
    s_add_u32 s37, s37, 1835008
    s_add_u32 s39, s36, 0
    buffer_load_dwordx4 v[72:75], v5, s[48:51], s39 offen offset:0
    buffer_load_dwordx4 v[76:79], v5, s[48:51], s39 offen offset:1024
    buffer_load_dwordx4 v[80:83], v5, s[48:51], s39 offen offset:2048
    buffer_load_dwordx4 v[84:87], v5, s[48:51], s39 offen offset:3072
    s_add_u32 s39, s36, 4096
    buffer_load_dwordx4 v[88:91], v5, s[48:51], s39 offen offset:0
    buffer_load_dwordx4 v[92:95], v5, s[48:51], s39 offen offset:1024
    buffer_load_dwordx4 v[96:99], v5, s[48:51], s39 offen offset:2048
    buffer_load_dwordx4 v[100:103], v5, s[48:51], s39 offen offset:3072
    s_add_u32 s39, s36, 8192
    buffer_load_dwordx4 v[104:107], v5, s[48:51], s39 offen offset:0
    buffer_load_dwordx4 v[108:111], v5, s[48:51], s39 offen offset:1024
    buffer_load_dwordx4 v[112:115], v5, s[48:51], s39 offen offset:2048
    buffer_load_dwordx4 v[116:119], v5, s[48:51], s39 offen offset:3072
    s_add_u32 s39, s36, 12288
    buffer_load_dwordx4 v[120:123], v5, s[48:51], s39 offen offset:0
    buffer_load_dwordx4 v[124:127], v5, s[48:51], s39 offen offset:1024
    s_waitcnt vmcnt(28)
    v_mfma_f32_32x32x16_bf16 v[184:199], v[128:131], a[0:3], 0
    v_mfma_f32_32x32x16_bf16 v[200:215], v[128:131], a[112:115], 0
    v_mfma_f32_32x32x16_bf16 v[184:199], v[132:135], a[4:7], v[184:199]
    v_mfma_f32_32x32x16_bf16 v[200:215], v[132:135], a[116:119], v[200:215]
    v_mfma_f32_32x32x16_bf16 v[184:199], v[136:139], a[8:11], v[184:199]
    v_mfma_f32_32x32x16_bf16 v[200:215], v[136:139], a[120:123], v[200:215]
    v_mfma_f32_32x32x16_bf16 v[184:199], v[140:143], a[12:15], v[184:199]
    v_mfma_f32_32x32x16_bf16 v[200:215], v[140:143], a[124:127], v[200:215]
    v_mfma_f32_32x32x16_bf16 v[184:199], v[144:147], a[16:19], v[184:199]
    v_mfma_f32_32x32x16_bf16 v[200:215], v[144:147], a[128:131], v[200:215]
    v_mfma_f32_32x32x16_bf16 v[184:199], v[148:151], a[20:23], v[184:199]
    v_mfma_f32_32x32x16_bf16 v[200:215], v[148:151], a[132:135], v[200:215]
    v_mfma_f32_32x32x16_bf16 v[184:199], v[152:155], a[24:27], v[184:199]
    v_mfma_f32_32x32x16_bf16 v[200:215], v[152:155], a[136:139], v[200:215]
    v_mfma_f32_32x32x16_bf16 v[184:199], v[156:159], a[28:31], v[184:199]
    v_mfma_f32_32x32x16_bf16 v[200:215], v[156:159], a[140:143], v[200:215]
    v_mfma_f32_32x32x16_bf16 v[184:199], v[160:163], a[32:35], v[184:199]
    v_mfma_f32_32x32x16_bf16 v[200:215], v[160:163], a[144:147], v[200:215]
    v_mfma_f32_32x32x16_bf16 v[184:199], v[164:167], a[36:39], v[184:199]
    v_mfma_f32_32x32x16_bf16 v[200:215], v[164:167], a[148:151], v[200:215]
    v_mfma_f32_32x32x16_bf16 v[184:199], v[168:171], a[40:43], v[184:199]
    v_mfma_f32_32x32x16_bf16 v[200:215], v[168:171], a[152:155], v[200:215]
    v_mfma_f32_32x32x16_bf16 v[184:199], v[172:175], a[44:47], v[184:199]
    v_mfma_f32_32x32x16_bf16 v[200:215], v[172:175], a[156:159], v[200:215]
    v_mfma_f32_32x32x16_bf16 v[184:199], v[176:179], a[48:51], v[184:199]
    v_mfma_f32_32x32x16_bf16 v[200:215], v[176:179], a[160:163], v[200:215]
    v_mfma_f32_32x32x16_bf16 v[184:199], v[180:183], a[52:55], v[184:199]
    v_mfma_f32_32x32x16_bf16 v[200:215], v[180:183], a[164:167], v[200:215]
    s_add_u32 s39, s36, 12288
    buffer_load_dwordx4 v[128:131], v5, s[48:51], s39 offen offset:2048
    buffer_load_dwordx4 v[132:135], v5, s[48:51], s39 offen offset:3072
    s_add_u32 s39, s36, 16384
    buffer_load_dwordx4 v[136:139], v5, s[48:51], s39 offen offset:0
    buffer_load_dwordx4 v[140:143], v5, s[48:51], s39 offen offset:1024
    buffer_load_dwordx4 v[144:147], v5, s[48:51], s39 offen offset:2048
    buffer_load_dwordx4 v[148:151], v5, s[48:51], s39 offen offset:3072
    s_add_u32 s39, s36, 20480
    buffer_load_dwordx4 v[152:155], v5, s[48:51], s39 offen offset:0
    buffer_load_dwordx4 v[156:159], v5, s[48:51], s39 offen offset:1024
    buffer_load_dwordx4 v[160:163], v5, s[48:51], s39 offen offset:2048
    buffer_load_dwordx4 v[164:167], v5, s[48:51], s39 offen offset:3072
    s_add_u32 s39, s36, 24576
    buffer_load_dwordx4 v[168:171], v5, s[48:51], s39 offen offset:0
    buffer_load_dwordx4 v[172:175], v5, s[48:51], s39 offen offset:1024
    buffer_load_dwordx4 v[176:179], v5, s[48:51], s39 offen offset:2048
    buffer_load_dwordx4 v[180:183], v5, s[48:51], s39 offen offset:3072
    s_add_u32 s36, s36, 114688
    s_waitcnt vmcnt(28)
    s_barrier
    v_mov_b32 v13, 0
    s_lshl_b32 s22, s100, 2
    s_add_u32 s22, s22, 8192
    v_cmp_eq_u32 vcc, 0, v0
    s_and_b64 exec, exec, vcc
    buffer_store_dword v13, v13, s[96:99], s22 offen offset:0 sc1
    s_mov_b64 exec, -1
    v_mfma_f32_32x32x16_bf16 v[184:199], v[16:19], a[56:59], v[184:199]
    v_mfma_f32_32x32x16_bf16 v[200:215], v[16:19], a[168:171], v[200:215]
    v_mfma_f32_32x32x16_bf16 v[184:199], v[20:23], a[60:63], v[184:199]
    v_mfma_f32_32x32x16_bf16 v[200:215], v[20:23], a[172:175], v[200:215]
    v_mfma_f32_32x32x16_bf16 v[184:199], v[24:27], a[64:67], v[184:199]
    v_mfma_f32_32x32x16_bf16 v[200:215], v[24:27], a[176:179], v[200:215]
    v_mfma_f32_32x32x16_bf16 v[184:199], v[28:31], a[68:71], v[184:199]
    v_mfma_f32_32x32x16_bf16 v[200:215], v[28:31], a[180:183], v[200:215]
    v_mfma_f32_32x32x16_bf16 v[184:199], v[32:35], a[72:75], v[184:199]
    v_mfma_f32_32x32x16_bf16 v[200:215], v[32:35], a[184:187], v[200:215]
    v_mfma_f32_32x32x16_bf16 v[184:199], v[36:39], a[76:79], v[184:199]
    v_mfma_f32_32x32x16_bf16 v[200:215], v[36:39], a[188:191], v[200:215]
    v_mfma_f32_32x32x16_bf16 v[184:199], v[40:43], a[80:83], v[184:199]
    v_mfma_f32_32x32x16_bf16 v[200:215], v[40:43], a[192:195], v[200:215]
    v_mfma_f32_32x32x16_bf16 v[184:199], v[44:47], a[84:87], v[184:199]
    v_mfma_f32_32x32x16_bf16 v[200:215], v[44:47], a[196:199], v[200:215]
    v_mfma_f32_32x32x16_bf16 v[184:199], v[48:51], a[88:91], v[184:199]
    v_mfma_f32_32x32x16_bf16 v[200:215], v[48:51], a[200:203], v[200:215]
    v_mfma_f32_32x32x16_bf16 v[184:199], v[52:55], a[92:95], v[184:199]
    v_mfma_f32_32x32x16_bf16 v[200:215], v[52:55], a[204:207], v[200:215]
    v_mfma_f32_32x32x16_bf16 v[184:199], v[56:59], a[96:99], v[184:199]
    v_mfma_f32_32x32x16_bf16 v[200:215], v[56:59], a[208:211], v[200:215]
    v_mfma_f32_32x32x16_bf16 v[184:199], v[60:63], a[100:103], v[184:199]
    v_mfma_f32_32x32x16_bf16 v[200:215], v[60:63], a[212:215], v[200:215]
    v_mfma_f32_32x32x16_bf16 v[184:199], v[64:67], a[104:107], v[184:199]
    v_mfma_f32_32x32x16_bf16 v[200:215], v[64:67], a[216:219], v[200:215]
    v_mfma_f32_32x32x16_bf16 v[184:199], v[68:71], a[108:111], v[184:199]
    v_mfma_f32_32x32x16_bf16 v[200:215], v[68:71], a[220:223], v[200:215]
    s_nop 15
    s_nop 1
    v_cvt_pk_bf16_f32 v216, v184, v185
    v_cvt_pk_bf16_f32 v217, v186, v187
    v_cvt_pk_bf16_f32 v218, v188, v189
    v_cvt_pk_bf16_f32 v219, v190, v191
    v_cvt_pk_bf16_f32 v220, v192, v193
    v_cvt_pk_bf16_f32 v221, v194, v195
    v_cvt_pk_bf16_f32 v222, v196, v197
    v_cvt_pk_bf16_f32 v223, v198, v199
    v_cvt_pk_bf16_f32 v224, v200, v201
    v_cvt_pk_bf16_f32 v225, v202, v203
    v_cvt_pk_bf16_f32 v226, v204, v205
    v_cvt_pk_bf16_f32 v227, v206, v207
    v_cvt_pk_bf16_f32 v228, v208, v209
    v_cvt_pk_bf16_f32 v229, v210, v211
    v_cvt_pk_bf16_f32 v230, v212, v213
    v_cvt_pk_bf16_f32 v231, v214, v215
    buffer_store_dwordx4 v[216:219], v6, s[56:59], s37 offen offset:0 sc1
    buffer_store_dwordx4 v[220:223], v7, s[56:59], s37 offen offset:0 sc1
    buffer_store_dwordx4 v[224:227], v6, s[56:59], s37 offen offset:512 sc1
    buffer_store_dwordx4 v[228:231], v7, s[56:59], s37 offen offset:512 sc1
    s_add_u32 s37, s37, 1835008
    s_add_u32 s39, s36, 0
    buffer_load_dwordx4 v[16:19], v5, s[48:51], s39 offen offset:0
    buffer_load_dwordx4 v[20:23], v5, s[48:51], s39 offen offset:1024
    buffer_load_dwordx4 v[24:27], v5, s[48:51], s39 offen offset:2048
    buffer_load_dwordx4 v[28:31], v5, s[48:51], s39 offen offset:3072
    s_add_u32 s39, s36, 4096
    buffer_load_dwordx4 v[32:35], v5, s[48:51], s39 offen offset:0
    buffer_load_dwordx4 v[36:39], v5, s[48:51], s39 offen offset:1024
    buffer_load_dwordx4 v[40:43], v5, s[48:51], s39 offen offset:2048
    buffer_load_dwordx4 v[44:47], v5, s[48:51], s39 offen offset:3072
    s_add_u32 s39, s36, 8192
    buffer_load_dwordx4 v[48:51], v5, s[48:51], s39 offen offset:0
    buffer_load_dwordx4 v[52:55], v5, s[48:51], s39 offen offset:1024
    buffer_load_dwordx4 v[56:59], v5, s[48:51], s39 offen offset:2048
    buffer_load_dwordx4 v[60:63], v5, s[48:51], s39 offen offset:3072
    s_add_u32 s39, s36, 12288
    buffer_load_dwordx4 v[64:67], v5, s[48:51], s39 offen offset:0
    buffer_load_dwordx4 v[68:71], v5, s[48:51], s39 offen offset:1024
    s_waitcnt vmcnt(28)
    v_mfma_f32_32x32x16_bf16 v[184:199], v[72:75], a[0:3], 0
    v_mfma_f32_32x32x16_bf16 v[200:215], v[72:75], a[112:115], 0
    v_mfma_f32_32x32x16_bf16 v[184:199], v[76:79], a[4:7], v[184:199]
    v_mfma_f32_32x32x16_bf16 v[200:215], v[76:79], a[116:119], v[200:215]
    v_mfma_f32_32x32x16_bf16 v[184:199], v[80:83], a[8:11], v[184:199]
    v_mfma_f32_32x32x16_bf16 v[200:215], v[80:83], a[120:123], v[200:215]
    v_mfma_f32_32x32x16_bf16 v[184:199], v[84:87], a[12:15], v[184:199]
    v_mfma_f32_32x32x16_bf16 v[200:215], v[84:87], a[124:127], v[200:215]
    v_mfma_f32_32x32x16_bf16 v[184:199], v[88:91], a[16:19], v[184:199]
    v_mfma_f32_32x32x16_bf16 v[200:215], v[88:91], a[128:131], v[200:215]
    v_mfma_f32_32x32x16_bf16 v[184:199], v[92:95], a[20:23], v[184:199]
    v_mfma_f32_32x32x16_bf16 v[200:215], v[92:95], a[132:135], v[200:215]
    v_mfma_f32_32x32x16_bf16 v[184:199], v[96:99], a[24:27], v[184:199]
    v_mfma_f32_32x32x16_bf16 v[200:215], v[96:99], a[136:139], v[200:215]
    v_mfma_f32_32x32x16_bf16 v[184:199], v[100:103], a[28:31], v[184:199]
    v_mfma_f32_32x32x16_bf16 v[200:215], v[100:103], a[140:143], v[200:215]
    v_mfma_f32_32x32x16_bf16 v[184:199], v[104:107], a[32:35], v[184:199]
    v_mfma_f32_32x32x16_bf16 v[200:215], v[104:107], a[144:147], v[200:215]
    v_mfma_f32_32x32x16_bf16 v[184:199], v[108:111], a[36:39], v[184:199]
    v_mfma_f32_32x32x16_bf16 v[200:215], v[108:111], a[148:151], v[200:215]
    v_mfma_f32_32x32x16_bf16 v[184:199], v[112:115], a[40:43], v[184:199]
    v_mfma_f32_32x32x16_bf16 v[200:215], v[112:115], a[152:155], v[200:215]
    v_mfma_f32_32x32x16_bf16 v[184:199], v[116:119], a[44:47], v[184:199]
    v_mfma_f32_32x32x16_bf16 v[200:215], v[116:119], a[156:159], v[200:215]
    v_mfma_f32_32x32x16_bf16 v[184:199], v[120:123], a[48:51], v[184:199]
    v_mfma_f32_32x32x16_bf16 v[200:215], v[120:123], a[160:163], v[200:215]
    v_mfma_f32_32x32x16_bf16 v[184:199], v[124:127], a[52:55], v[184:199]
    v_mfma_f32_32x32x16_bf16 v[200:215], v[124:127], a[164:167], v[200:215]
    s_add_u32 s39, s36, 12288
    buffer_load_dwordx4 v[72:75], v5, s[48:51], s39 offen offset:2048
    buffer_load_dwordx4 v[76:79], v5, s[48:51], s39 offen offset:3072
    s_add_u32 s39, s36, 16384
    buffer_load_dwordx4 v[80:83], v5, s[48:51], s39 offen offset:0
    buffer_load_dwordx4 v[84:87], v5, s[48:51], s39 offen offset:1024
    buffer_load_dwordx4 v[88:91], v5, s[48:51], s39 offen offset:2048
    buffer_load_dwordx4 v[92:95], v5, s[48:51], s39 offen offset:3072
    s_add_u32 s39, s36, 20480
    buffer_load_dwordx4 v[96:99], v5, s[48:51], s39 offen offset:0
    buffer_load_dwordx4 v[100:103], v5, s[48:51], s39 offen offset:1024
    buffer_load_dwordx4 v[104:107], v5, s[48:51], s39 offen offset:2048
    buffer_load_dwordx4 v[108:111], v5, s[48:51], s39 offen offset:3072
    s_add_u32 s39, s36, 24576
    buffer_load_dwordx4 v[112:115], v5, s[48:51], s39 offen offset:0
    buffer_load_dwordx4 v[116:119], v5, s[48:51], s39 offen offset:1024
    buffer_load_dwordx4 v[120:123], v5, s[48:51], s39 offen offset:2048
    buffer_load_dwordx4 v[124:127], v5, s[48:51], s39 offen offset:3072
    s_add_u32 s36, s36, 114688
    s_waitcnt vmcnt(28)
    v_mfma_f32_32x32x16_bf16 v[184:199], v[128:131], a[56:59], v[184:199]
    v_mfma_f32_32x32x16_bf16 v[200:215], v[128:131], a[168:171], v[200:215]
    v_mfma_f32_32x32x16_bf16 v[184:199], v[132:135], a[60:63], v[184:199]
    v_mfma_f32_32x32x16_bf16 v[200:215], v[132:135], a[172:175], v[200:215]
    v_mfma_f32_32x32x16_bf16 v[184:199], v[136:139], a[64:67], v[184:199]
    v_mfma_f32_32x32x16_bf16 v[200:215], v[136:139], a[176:179], v[200:215]
    v_mfma_f32_32x32x16_bf16 v[184:199], v[140:143], a[68:71], v[184:199]
    v_mfma_f32_32x32x16_bf16 v[200:215], v[140:143], a[180:183], v[200:215]
    v_mfma_f32_32x32x16_bf16 v[184:199], v[144:147], a[72:75], v[184:199]
    v_mfma_f32_32x32x16_bf16 v[200:215], v[144:147], a[184:187], v[200:215]
    v_mfma_f32_32x32x16_bf16 v[184:199], v[148:151], a[76:79], v[184:199]
    v_mfma_f32_32x32x16_bf16 v[200:215], v[148:151], a[188:191], v[200:215]
    v_mfma_f32_32x32x16_bf16 v[184:199], v[152:155], a[80:83], v[184:199]
    v_mfma_f32_32x32x16_bf16 v[200:215], v[152:155], a[192:195], v[200:215]
    v_mfma_f32_32x32x16_bf16 v[184:199], v[156:159], a[84:87], v[184:199]
    v_mfma_f32_32x32x16_bf16 v[200:215], v[156:159], a[196:199], v[200:215]
    v_mfma_f32_32x32x16_bf16 v[184:199], v[160:163], a[88:91], v[184:199]
    v_mfma_f32_32x32x16_bf16 v[200:215], v[160:163], a[200:203], v[200:215]
    v_mfma_f32_32x32x16_bf16 v[184:199], v[164:167], a[92:95], v[184:199]
    v_mfma_f32_32x32x16_bf16 v[200:215], v[164:167], a[204:207], v[200:215]
    v_mfma_f32_32x32x16_bf16 v[184:199], v[168:171], a[96:99], v[184:199]
    v_mfma_f32_32x32x16_bf16 v[200:215], v[168:171], a[208:211], v[200:215]
    v_mfma_f32_32x32x16_bf16 v[184:199], v[172:175], a[100:103], v[184:199]
    v_mfma_f32_32x32x16_bf16 v[200:215], v[172:175], a[212:215], v[200:215]
    v_mfma_f32_32x32x16_bf16 v[184:199], v[176:179], a[104:107], v[184:199]
    v_mfma_f32_32x32x16_bf16 v[200:215], v[176:179], a[216:219], v[200:215]
    v_mfma_f32_32x32x16_bf16 v[184:199], v[180:183], a[108:111], v[184:199]
    v_mfma_f32_32x32x16_bf16 v[200:215], v[180:183], a[220:223], v[200:215]
    s_nop 15
    s_nop 1
    v_cvt_pk_bf16_f32 v216, v184, v185
    v_cvt_pk_bf16_f32 v217, v186, v187
    v_cvt_pk_bf16_f32 v218, v188, v189
    v_cvt_pk_bf16_f32 v219, v190, v191
    v_cvt_pk_bf16_f32 v220, v192, v193
    v_cvt_pk_bf16_f32 v221, v194, v195
    v_cvt_pk_bf16_f32 v222, v196, v197
    v_cvt_pk_bf16_f32 v223, v198, v199
    v_cvt_pk_bf16_f32 v224, v200, v201
    v_cvt_pk_bf16_f32 v225, v202, v203
    v_cvt_pk_bf16_f32 v226, v204, v205
    v_cvt_pk_bf16_f32 v227, v206, v207
    v_cvt_pk_bf16_f32 v228, v208, v209
    v_cvt_pk_bf16_f32 v229, v210, v211
    v_cvt_pk_bf16_f32 v230, v212, v213
    v_cvt_pk_bf16_f32 v231, v214, v215
    buffer_store_dwordx4 v[216:219], v6, s[56:59], s37 offen offset:0 sc1
    buffer_store_dwordx4 v[220:223], v7, s[56:59], s37 offen offset:0 sc1
    buffer_store_dwordx4 v[224:227], v6, s[56:59], s37 offen offset:512 sc1
    buffer_store_dwordx4 v[228:231], v7, s[56:59], s37 offen offset:512 sc1
    s_add_u32 s37, s37, 1835008
    s_add_u32 s39, s36, 0
    buffer_load_dwordx4 v[128:131], v5, s[48:51], s39 offen offset:0
    buffer_load_dwordx4 v[132:135], v5, s[48:51], s39 offen offset:1024
    buffer_load_dwordx4 v[136:139], v5, s[48:51], s39 offen offset:2048
    buffer_load_dwordx4 v[140:143], v5, s[48:51], s39 offen offset:3072
    s_add_u32 s39, s36, 4096
    buffer_load_dwordx4 v[144:147], v5, s[48:51], s39 offen offset:0
    buffer_load_dwordx4 v[148:151], v5, s[48:51], s39 offen offset:1024
    buffer_load_dwordx4 v[152:155], v5, s[48:51], s39 offen offset:2048
    buffer_load_dwordx4 v[156:159], v5, s[48:51], s39 offen offset:3072
    s_add_u32 s39, s36, 8192
    buffer_load_dwordx4 v[160:163], v5, s[48:51], s39 offen offset:0
    buffer_load_dwordx4 v[164:167], v5, s[48:51], s39 offen offset:1024
    buffer_load_dwordx4 v[168:171], v5, s[48:51], s39 offen offset:2048
    buffer_load_dwordx4 v[172:175], v5, s[48:51], s39 offen offset:3072
    s_add_u32 s39, s36, 12288
    buffer_load_dwordx4 v[176:179], v5, s[48:51], s39 offen offset:0
    buffer_load_dwordx4 v[180:183], v5, s[48:51], s39 offen offset:1024
    s_waitcnt vmcnt(28)
    v_mfma_f32_32x32x16_bf16 v[184:199], v[16:19], a[0:3], 0
    v_mfma_f32_32x32x16_bf16 v[200:215], v[16:19], a[112:115], 0
    v_mfma_f32_32x32x16_bf16 v[184:199], v[20:23], a[4:7], v[184:199]
    v_mfma_f32_32x32x16_bf16 v[200:215], v[20:23], a[116:119], v[200:215]
    v_mfma_f32_32x32x16_bf16 v[184:199], v[24:27], a[8:11], v[184:199]
    v_mfma_f32_32x32x16_bf16 v[200:215], v[24:27], a[120:123], v[200:215]
    v_mfma_f32_32x32x16_bf16 v[184:199], v[28:31], a[12:15], v[184:199]
    v_mfma_f32_32x32x16_bf16 v[200:215], v[28:31], a[124:127], v[200:215]
    v_mfma_f32_32x32x16_bf16 v[184:199], v[32:35], a[16:19], v[184:199]
    v_mfma_f32_32x32x16_bf16 v[200:215], v[32:35], a[128:131], v[200:215]
    v_mfma_f32_32x32x16_bf16 v[184:199], v[36:39], a[20:23], v[184:199]
    v_mfma_f32_32x32x16_bf16 v[200:215], v[36:39], a[132:135], v[200:215]
    v_mfma_f32_32x32x16_bf16 v[184:199], v[40:43], a[24:27], v[184:199]
    v_mfma_f32_32x32x16_bf16 v[200:215], v[40:43], a[136:139], v[200:215]
    v_mfma_f32_32x32x16_bf16 v[184:199], v[44:47], a[28:31], v[184:199]
    v_mfma_f32_32x32x16_bf16 v[200:215], v[44:47], a[140:143], v[200:215]
    v_mfma_f32_32x32x16_bf16 v[184:199], v[48:51], a[32:35], v[184:199]
    v_mfma_f32_32x32x16_bf16 v[200:215], v[48:51], a[144:147], v[200:215]
    v_mfma_f32_32x32x16_bf16 v[184:199], v[52:55], a[36:39], v[184:199]
    v_mfma_f32_32x32x16_bf16 v[200:215], v[52:55], a[148:151], v[200:215]
    v_mfma_f32_32x32x16_bf16 v[184:199], v[56:59], a[40:43], v[184:199]
    v_mfma_f32_32x32x16_bf16 v[200:215], v[56:59], a[152:155], v[200:215]
    v_mfma_f32_32x32x16_bf16 v[184:199], v[60:63], a[44:47], v[184:199]
    v_mfma_f32_32x32x16_bf16 v[200:215], v[60:63], a[156:159], v[200:215]
    v_mfma_f32_32x32x16_bf16 v[184:199], v[64:67], a[48:51], v[184:199]
    v_mfma_f32_32x32x16_bf16 v[200:215], v[64:67], a[160:163], v[200:215]
    v_mfma_f32_32x32x16_bf16 v[184:199], v[68:71], a[52:55], v[184:199]
    v_mfma_f32_32x32x16_bf16 v[200:215], v[68:71], a[164:167], v[200:215]
    s_add_u32 s39, s36, 12288
    buffer_load_dwordx4 v[16:19], v5, s[48:51], s39 offen offset:2048
    buffer_load_dwordx4 v[20:23], v5, s[48:51], s39 offen offset:3072
    s_add_u32 s39, s36, 16384
    buffer_load_dwordx4 v[24:27], v5, s[48:51], s39 offen offset:0
    buffer_load_dwordx4 v[28:31], v5, s[48:51], s39 offen offset:1024
    buffer_load_dwordx4 v[32:35], v5, s[48:51], s39 offen offset:2048
    buffer_load_dwordx4 v[36:39], v5, s[48:51], s39 offen offset:3072
    s_add_u32 s39, s36, 20480
    buffer_load_dwordx4 v[40:43], v5, s[48:51], s39 offen offset:0
    buffer_load_dwordx4 v[44:47], v5, s[48:51], s39 offen offset:1024
    buffer_load_dwordx4 v[48:51], v5, s[48:51], s39 offen offset:2048
    buffer_load_dwordx4 v[52:55], v5, s[48:51], s39 offen offset:3072
    s_add_u32 s39, s36, 24576
    buffer_load_dwordx4 v[56:59], v5, s[48:51], s39 offen offset:0
    buffer_load_dwordx4 v[60:63], v5, s[48:51], s39 offen offset:1024
    buffer_load_dwordx4 v[64:67], v5, s[48:51], s39 offen offset:2048
    buffer_load_dwordx4 v[68:71], v5, s[48:51], s39 offen offset:3072
    s_add_u32 s36, s36, 114688
    s_waitcnt vmcnt(28)
    s_barrier
    v_mov_b32 v13, 0
    s_lshl_b32 s22, s100, 2
    s_add_u32 s22, s22, 9216
    v_cmp_eq_u32 vcc, 0, v0
    s_and_b64 exec, exec, vcc
    buffer_store_dword v13, v13, s[96:99], s22 offen offset:0 sc1
    s_mov_b64 exec, -1
    v_mfma_f32_32x32x16_bf16 v[184:199], v[72:75], a[56:59], v[184:199]
    v_mfma_f32_32x32x16_bf16 v[200:215], v[72:75], a[168:171], v[200:215]
    v_mfma_f32_32x32x16_bf16 v[184:199], v[76:79], a[60:63], v[184:199]
    v_mfma_f32_32x32x16_bf16 v[200:215], v[76:79], a[172:175], v[200:215]
    v_mfma_f32_32x32x16_bf16 v[184:199], v[80:83], a[64:67], v[184:199]
    v_mfma_f32_32x32x16_bf16 v[200:215], v[80:83], a[176:179], v[200:215]
    v_mfma_f32_32x32x16_bf16 v[184:199], v[84:87], a[68:71], v[184:199]
    v_mfma_f32_32x32x16_bf16 v[200:215], v[84:87], a[180:183], v[200:215]
    v_mfma_f32_32x32x16_bf16 v[184:199], v[88:91], a[72:75], v[184:199]
    v_mfma_f32_32x32x16_bf16 v[200:215], v[88:91], a[184:187], v[200:215]
    v_mfma_f32_32x32x16_bf16 v[184:199], v[92:95], a[76:79], v[184:199]
    v_mfma_f32_32x32x16_bf16 v[200:215], v[92:95], a[188:191], v[200:215]
    v_mfma_f32_32x32x16_bf16 v[184:199], v[96:99], a[80:83], v[184:199]
    v_mfma_f32_32x32x16_bf16 v[200:215], v[96:99], a[192:195], v[200:215]
    v_mfma_f32_32x32x16_bf16 v[184:199], v[100:103], a[84:87], v[184:199]
    v_mfma_f32_32x32x16_bf16 v[200:215], v[100:103], a[196:199], v[200:215]
    v_mfma_f32_32x32x16_bf16 v[184:199], v[104:107], a[88:91], v[184:199]
    v_mfma_f32_32x32x16_bf16 v[200:215], v[104:107], a[200:203], v[200:215]
    v_mfma_f32_32x32x16_bf16 v[184:199], v[108:111], a[92:95], v[184:199]
    v_mfma_f32_32x32x16_bf16 v[200:215], v[108:111], a[204:207], v[200:215]
    v_mfma_f32_32x32x16_bf16 v[184:199], v[112:115], a[96:99], v[184:199]
    v_mfma_f32_32x32x16_bf16 v[200:215], v[112:115], a[208:211], v[200:215]
    v_mfma_f32_32x32x16_bf16 v[184:199], v[116:119], a[100:103], v[184:199]
    v_mfma_f32_32x32x16_bf16 v[200:215], v[116:119], a[212:215], v[200:215]
    v_mfma_f32_32x32x16_bf16 v[184:199], v[120:123], a[104:107], v[184:199]
    v_mfma_f32_32x32x16_bf16 v[200:215], v[120:123], a[216:219], v[200:215]
    v_mfma_f32_32x32x16_bf16 v[184:199], v[124:127], a[108:111], v[184:199]
    v_mfma_f32_32x32x16_bf16 v[200:215], v[124:127], a[220:223], v[200:215]
    s_nop 15
    s_nop 1
    v_cvt_pk_bf16_f32 v216, v184, v185
    v_cvt_pk_bf16_f32 v217, v186, v187
    v_cvt_pk_bf16_f32 v218, v188, v189
    v_cvt_pk_bf16_f32 v219, v190, v191
    v_cvt_pk_bf16_f32 v220, v192, v193
    v_cvt_pk_bf16_f32 v221, v194, v195
    v_cvt_pk_bf16_f32 v222, v196, v197
    v_cvt_pk_bf16_f32 v223, v198, v199
    v_cvt_pk_bf16_f32 v224, v200, v201
    v_cvt_pk_bf16_f32 v225, v202, v203
    v_cvt_pk_bf16_f32 v226, v204, v205
    v_cvt_pk_bf16_f32 v227, v206, v207
    v_cvt_pk_bf16_f32 v228, v208, v209
    v_cvt_pk_bf16_f32 v229, v210, v211
    v_cvt_pk_bf16_f32 v230, v212, v213
    v_cvt_pk_bf16_f32 v231, v214, v215
    buffer_store_dwordx4 v[216:219], v6, s[56:59], s37 offen offset:0 sc1
    buffer_store_dwordx4 v[220:223], v7, s[56:59], s37 offen offset:0 sc1
    buffer_store_dwordx4 v[224:227], v6, s[56:59], s37 offen offset:512 sc1
    buffer_store_dwordx4 v[228:231], v7, s[56:59], s37 offen offset:512 sc1
    s_add_u32 s37, s37, 1835008
    s_add_u32 s39, s36, 0
    buffer_load_dwordx4 v[72:75], v5, s[48:51], s39 offen offset:0
    buffer_load_dwordx4 v[76:79], v5, s[48:51], s39 offen offset:1024
    buffer_load_dwordx4 v[80:83], v5, s[48:51], s39 offen offset:2048
    buffer_load_dwordx4 v[84:87], v5, s[48:51], s39 offen offset:3072
    s_add_u32 s39, s36, 4096
    buffer_load_dwordx4 v[88:91], v5, s[48:51], s39 offen offset:0
    buffer_load_dwordx4 v[92:95], v5, s[48:51], s39 offen offset:1024
    buffer_load_dwordx4 v[96:99], v5, s[48:51], s39 offen offset:2048
    buffer_load_dwordx4 v[100:103], v5, s[48:51], s39 offen offset:3072
    s_add_u32 s39, s36, 8192
    buffer_load_dwordx4 v[104:107], v5, s[48:51], s39 offen offset:0
    buffer_load_dwordx4 v[108:111], v5, s[48:51], s39 offen offset:1024
    buffer_load_dwordx4 v[112:115], v5, s[48:51], s39 offen offset:2048
    buffer_load_dwordx4 v[116:119], v5, s[48:51], s39 offen offset:3072
    s_add_u32 s39, s36, 12288
    buffer_load_dwordx4 v[120:123], v5, s[48:51], s39 offen offset:0
    buffer_load_dwordx4 v[124:127], v5, s[48:51], s39 offen offset:1024
    s_waitcnt vmcnt(28)
    v_mfma_f32_32x32x16_bf16 v[184:199], v[128:131], a[0:3], 0
    v_mfma_f32_32x32x16_bf16 v[200:215], v[128:131], a[112:115], 0
    v_mfma_f32_32x32x16_bf16 v[184:199], v[132:135], a[4:7], v[184:199]
    v_mfma_f32_32x32x16_bf16 v[200:215], v[132:135], a[116:119], v[200:215]
    v_mfma_f32_32x32x16_bf16 v[184:199], v[136:139], a[8:11], v[184:199]
    v_mfma_f32_32x32x16_bf16 v[200:215], v[136:139], a[120:123], v[200:215]
    v_mfma_f32_32x32x16_bf16 v[184:199], v[140:143], a[12:15], v[184:199]
    v_mfma_f32_32x32x16_bf16 v[200:215], v[140:143], a[124:127], v[200:215]
    v_mfma_f32_32x32x16_bf16 v[184:199], v[144:147], a[16:19], v[184:199]
    v_mfma_f32_32x32x16_bf16 v[200:215], v[144:147], a[128:131], v[200:215]
    v_mfma_f32_32x32x16_bf16 v[184:199], v[148:151], a[20:23], v[184:199]
    v_mfma_f32_32x32x16_bf16 v[200:215], v[148:151], a[132:135], v[200:215]
    v_mfma_f32_32x32x16_bf16 v[184:199], v[152:155], a[24:27], v[184:199]
    v_mfma_f32_32x32x16_bf16 v[200:215], v[152:155], a[136:139], v[200:215]
    v_mfma_f32_32x32x16_bf16 v[184:199], v[156:159], a[28:31], v[184:199]
    v_mfma_f32_32x32x16_bf16 v[200:215], v[156:159], a[140:143], v[200:215]
    v_mfma_f32_32x32x16_bf16 v[184:199], v[160:163], a[32:35], v[184:199]
    v_mfma_f32_32x32x16_bf16 v[200:215], v[160:163], a[144:147], v[200:215]
    v_mfma_f32_32x32x16_bf16 v[184:199], v[164:167], a[36:39], v[184:199]
    v_mfma_f32_32x32x16_bf16 v[200:215], v[164:167], a[148:151], v[200:215]
    v_mfma_f32_32x32x16_bf16 v[184:199], v[168:171], a[40:43], v[184:199]
    v_mfma_f32_32x32x16_bf16 v[200:215], v[168:171], a[152:155], v[200:215]
    v_mfma_f32_32x32x16_bf16 v[184:199], v[172:175], a[44:47], v[184:199]
    v_mfma_f32_32x32x16_bf16 v[200:215], v[172:175], a[156:159], v[200:215]
    v_mfma_f32_32x32x16_bf16 v[184:199], v[176:179], a[48:51], v[184:199]
    v_mfma_f32_32x32x16_bf16 v[200:215], v[176:179], a[160:163], v[200:215]
    v_mfma_f32_32x32x16_bf16 v[184:199], v[180:183], a[52:55], v[184:199]
    v_mfma_f32_32x32x16_bf16 v[200:215], v[180:183], a[164:167], v[200:215]
    s_add_u32 s39, s36, 12288
    buffer_load_dwordx4 v[128:131], v5, s[48:51], s39 offen offset:2048
    buffer_load_dwordx4 v[132:135], v5, s[48:51], s39 offen offset:3072
    s_add_u32 s39, s36, 16384
    buffer_load_dwordx4 v[136:139], v5, s[48:51], s39 offen offset:0
    buffer_load_dwordx4 v[140:143], v5, s[48:51], s39 offen offset:1024
    buffer_load_dwordx4 v[144:147], v5, s[48:51], s39 offen offset:2048
    buffer_load_dwordx4 v[148:151], v5, s[48:51], s39 offen offset:3072
    s_add_u32 s39, s36, 20480
    buffer_load_dwordx4 v[152:155], v5, s[48:51], s39 offen offset:0
    buffer_load_dwordx4 v[156:159], v5, s[48:51], s39 offen offset:1024
    buffer_load_dwordx4 v[160:163], v5, s[48:51], s39 offen offset:2048
    buffer_load_dwordx4 v[164:167], v5, s[48:51], s39 offen offset:3072
    s_add_u32 s39, s36, 24576
    buffer_load_dwordx4 v[168:171], v5, s[48:51], s39 offen offset:0
    buffer_load_dwordx4 v[172:175], v5, s[48:51], s39 offen offset:1024
    buffer_load_dwordx4 v[176:179], v5, s[48:51], s39 offen offset:2048
    buffer_load_dwordx4 v[180:183], v5, s[48:51], s39 offen offset:3072
    s_add_u32 s36, s36, 114688
    s_waitcnt vmcnt(28)
    v_mfma_f32_32x32x16_bf16 v[184:199], v[16:19], a[56:59], v[184:199]
    v_mfma_f32_32x32x16_bf16 v[200:215], v[16:19], a[168:171], v[200:215]
    v_mfma_f32_32x32x16_bf16 v[184:199], v[20:23], a[60:63], v[184:199]
    v_mfma_f32_32x32x16_bf16 v[200:215], v[20:23], a[172:175], v[200:215]
    v_mfma_f32_32x32x16_bf16 v[184:199], v[24:27], a[64:67], v[184:199]
    v_mfma_f32_32x32x16_bf16 v[200:215], v[24:27], a[176:179], v[200:215]
    v_mfma_f32_32x32x16_bf16 v[184:199], v[28:31], a[68:71], v[184:199]
    v_mfma_f32_32x32x16_bf16 v[200:215], v[28:31], a[180:183], v[200:215]
    v_mfma_f32_32x32x16_bf16 v[184:199], v[32:35], a[72:75], v[184:199]
    v_mfma_f32_32x32x16_bf16 v[200:215], v[32:35], a[184:187], v[200:215]
    v_mfma_f32_32x32x16_bf16 v[184:199], v[36:39], a[76:79], v[184:199]
    v_mfma_f32_32x32x16_bf16 v[200:215], v[36:39], a[188:191], v[200:215]
    v_mfma_f32_32x32x16_bf16 v[184:199], v[40:43], a[80:83], v[184:199]
    v_mfma_f32_32x32x16_bf16 v[200:215], v[40:43], a[192:195], v[200:215]
    v_mfma_f32_32x32x16_bf16 v[184:199], v[44:47], a[84:87], v[184:199]
    v_mfma_f32_32x32x16_bf16 v[200:215], v[44:47], a[196:199], v[200:215]
    v_mfma_f32_32x32x16_bf16 v[184:199], v[48:51], a[88:91], v[184:199]
    v_mfma_f32_32x32x16_bf16 v[200:215], v[48:51], a[200:203], v[200:215]
    v_mfma_f32_32x32x16_bf16 v[184:199], v[52:55], a[92:95], v[184:199]
    v_mfma_f32_32x32x16_bf16 v[200:215], v[52:55], a[204:207], v[200:215]
    v_mfma_f32_32x32x16_bf16 v[184:199], v[56:59], a[96:99], v[184:199]
    v_mfma_f32_32x32x16_bf16 v[200:215], v[56:59], a[208:211], v[200:215]
    v_mfma_f32_32x32x16_bf16 v[184:199], v[60:63], a[100:103], v[184:199]
    v_mfma_f32_32x32x16_bf16 v[200:215], v[60:63], a[212:215], v[200:215]
    v_mfma_f32_32x32x16_bf16 v[184:199], v[64:67], a[104:107], v[184:199]
    v_mfma_f32_32x32x16_bf16 v[200:215], v[64:67], a[216:219], v[200:215]
    v_mfma_f32_32x32x16_bf16 v[184:199], v[68:71], a[108:111], v[184:199]
    v_mfma_f32_32x32x16_bf16 v[200:215], v[68:71], a[220:223], v[200:215]
    s_nop 15
    s_nop 1
    v_cvt_pk_bf16_f32 v216, v184, v185
    v_cvt_pk_bf16_f32 v217, v186, v187
    v_cvt_pk_bf16_f32 v218, v188, v189
    v_cvt_pk_bf16_f32 v219, v190, v191
    v_cvt_pk_bf16_f32 v220, v192, v193
    v_cvt_pk_bf16_f32 v221, v194, v195
    v_cvt_pk_bf16_f32 v222, v196, v197
    v_cvt_pk_bf16_f32 v223, v198, v199
    v_cvt_pk_bf16_f32 v224, v200, v201
    v_cvt_pk_bf16_f32 v225, v202, v203
    v_cvt_pk_bf16_f32 v226, v204, v205
    v_cvt_pk_bf16_f32 v227, v206, v207
    v_cvt_pk_bf16_f32 v228, v208, v209
    v_cvt_pk_bf16_f32 v229, v210, v211
    v_cvt_pk_bf16_f32 v230, v212, v213
    v_cvt_pk_bf16_f32 v231, v214, v215
    buffer_store_dwordx4 v[216:219], v6, s[56:59], s37 offen offset:0 sc1
    buffer_store_dwordx4 v[220:223], v7, s[56:59], s37 offen offset:0 sc1
    buffer_store_dwordx4 v[224:227], v6, s[56:59], s37 offen offset:512 sc1
    buffer_store_dwordx4 v[228:231], v7, s[56:59], s37 offen offset:512 sc1
    s_add_u32 s37, s37, 1835008
    s_add_u32 s39, s36, 0
    buffer_load_dwordx4 v[16:19], v5, s[48:51], s39 offen offset:0
    buffer_load_dwordx4 v[20:23], v5, s[48:51], s39 offen offset:1024
    buffer_load_dwordx4 v[24:27], v5, s[48:51], s39 offen offset:2048
    buffer_load_dwordx4 v[28:31], v5, s[48:51], s39 offen offset:3072
    s_add_u32 s39, s36, 4096
    buffer_load_dwordx4 v[32:35], v5, s[48:51], s39 offen offset:0
    buffer_load_dwordx4 v[36:39], v5, s[48:51], s39 offen offset:1024
    buffer_load_dwordx4 v[40:43], v5, s[48:51], s39 offen offset:2048
    buffer_load_dwordx4 v[44:47], v5, s[48:51], s39 offen offset:3072
    s_add_u32 s39, s36, 8192
    buffer_load_dwordx4 v[48:51], v5, s[48:51], s39 offen offset:0
    buffer_load_dwordx4 v[52:55], v5, s[48:51], s39 offen offset:1024
    buffer_load_dwordx4 v[56:59], v5, s[48:51], s39 offen offset:2048
    buffer_load_dwordx4 v[60:63], v5, s[48:51], s39 offen offset:3072
    s_add_u32 s39, s36, 12288
    buffer_load_dwordx4 v[64:67], v5, s[48:51], s39 offen offset:0
    buffer_load_dwordx4 v[68:71], v5, s[48:51], s39 offen offset:1024
    s_waitcnt vmcnt(28)
    v_mfma_f32_32x32x16_bf16 v[184:199], v[72:75], a[0:3], 0
    v_mfma_f32_32x32x16_bf16 v[200:215], v[72:75], a[112:115], 0
    v_mfma_f32_32x32x16_bf16 v[184:199], v[76:79], a[4:7], v[184:199]
    v_mfma_f32_32x32x16_bf16 v[200:215], v[76:79], a[116:119], v[200:215]
    v_mfma_f32_32x32x16_bf16 v[184:199], v[80:83], a[8:11], v[184:199]
    v_mfma_f32_32x32x16_bf16 v[200:215], v[80:83], a[120:123], v[200:215]
    v_mfma_f32_32x32x16_bf16 v[184:199], v[84:87], a[12:15], v[184:199]
    v_mfma_f32_32x32x16_bf16 v[200:215], v[84:87], a[124:127], v[200:215]
    v_mfma_f32_32x32x16_bf16 v[184:199], v[88:91], a[16:19], v[184:199]
    v_mfma_f32_32x32x16_bf16 v[200:215], v[88:91], a[128:131], v[200:215]
    v_mfma_f32_32x32x16_bf16 v[184:199], v[92:95], a[20:23], v[184:199]
    v_mfma_f32_32x32x16_bf16 v[200:215], v[92:95], a[132:135], v[200:215]
    v_mfma_f32_32x32x16_bf16 v[184:199], v[96:99], a[24:27], v[184:199]
    v_mfma_f32_32x32x16_bf16 v[200:215], v[96:99], a[136:139], v[200:215]
    v_mfma_f32_32x32x16_bf16 v[184:199], v[100:103], a[28:31], v[184:199]
    v_mfma_f32_32x32x16_bf16 v[200:215], v[100:103], a[140:143], v[200:215]
    v_mfma_f32_32x32x16_bf16 v[184:199], v[104:107], a[32:35], v[184:199]
    v_mfma_f32_32x32x16_bf16 v[200:215], v[104:107], a[144:147], v[200:215]
    v_mfma_f32_32x32x16_bf16 v[184:199], v[108:111], a[36:39], v[184:199]
    v_mfma_f32_32x32x16_bf16 v[200:215], v[108:111], a[148:151], v[200:215]
    v_mfma_f32_32x32x16_bf16 v[184:199], v[112:115], a[40:43], v[184:199]
    v_mfma_f32_32x32x16_bf16 v[200:215], v[112:115], a[152:155], v[200:215]
    v_mfma_f32_32x32x16_bf16 v[184:199], v[116:119], a[44:47], v[184:199]
    v_mfma_f32_32x32x16_bf16 v[200:215], v[116:119], a[156:159], v[200:215]
    v_mfma_f32_32x32x16_bf16 v[184:199], v[120:123], a[48:51], v[184:199]
    v_mfma_f32_32x32x16_bf16 v[200:215], v[120:123], a[160:163], v[200:215]
    v_mfma_f32_32x32x16_bf16 v[184:199], v[124:127], a[52:55], v[184:199]
    v_mfma_f32_32x32x16_bf16 v[200:215], v[124:127], a[164:167], v[200:215]
    s_add_u32 s39, s36, 12288
    buffer_load_dwordx4 v[72:75], v5, s[48:51], s39 offen offset:2048
    buffer_load_dwordx4 v[76:79], v5, s[48:51], s39 offen offset:3072
    s_add_u32 s39, s36, 16384
    buffer_load_dwordx4 v[80:83], v5, s[48:51], s39 offen offset:0
    buffer_load_dwordx4 v[84:87], v5, s[48:51], s39 offen offset:1024
    buffer_load_dwordx4 v[88:91], v5, s[48:51], s39 offen offset:2048
    buffer_load_dwordx4 v[92:95], v5, s[48:51], s39 offen offset:3072
    s_add_u32 s39, s36, 20480
    buffer_load_dwordx4 v[96:99], v5, s[48:51], s39 offen offset:0
    buffer_load_dwordx4 v[100:103], v5, s[48:51], s39 offen offset:1024
    buffer_load_dwordx4 v[104:107], v5, s[48:51], s39 offen offset:2048
    buffer_load_dwordx4 v[108:111], v5, s[48:51], s39 offen offset:3072
    s_add_u32 s39, s36, 24576
    buffer_load_dwordx4 v[112:115], v5, s[48:51], s39 offen offset:0
    buffer_load_dwordx4 v[116:119], v5, s[48:51], s39 offen offset:1024
    buffer_load_dwordx4 v[120:123], v5, s[48:51], s39 offen offset:2048
    buffer_load_dwordx4 v[124:127], v5, s[48:51], s39 offen offset:3072
    s_add_u32 s36, s36, 114688
    s_waitcnt vmcnt(28)
    s_barrier
    v_mov_b32 v13, 0
    s_lshl_b32 s22, s100, 2
    s_add_u32 s22, s22, 10240
    v_cmp_eq_u32 vcc, 0, v0
    s_and_b64 exec, exec, vcc
    buffer_store_dword v13, v13, s[96:99], s22 offen offset:0 sc1
    s_mov_b64 exec, -1
    v_mfma_f32_32x32x16_bf16 v[184:199], v[128:131], a[56:59], v[184:199]
    v_mfma_f32_32x32x16_bf16 v[200:215], v[128:131], a[168:171], v[200:215]
    v_mfma_f32_32x32x16_bf16 v[184:199], v[132:135], a[60:63], v[184:199]
    v_mfma_f32_32x32x16_bf16 v[200:215], v[132:135], a[172:175], v[200:215]
    v_mfma_f32_32x32x16_bf16 v[184:199], v[136:139], a[64:67], v[184:199]
    v_mfma_f32_32x32x16_bf16 v[200:215], v[136:139], a[176:179], v[200:215]
    v_mfma_f32_32x32x16_bf16 v[184:199], v[140:143], a[68:71], v[184:199]
    v_mfma_f32_32x32x16_bf16 v[200:215], v[140:143], a[180:183], v[200:215]
    v_mfma_f32_32x32x16_bf16 v[184:199], v[144:147], a[72:75], v[184:199]
    v_mfma_f32_32x32x16_bf16 v[200:215], v[144:147], a[184:187], v[200:215]
    v_mfma_f32_32x32x16_bf16 v[184:199], v[148:151], a[76:79], v[184:199]
    v_mfma_f32_32x32x16_bf16 v[200:215], v[148:151], a[188:191], v[200:215]
    v_mfma_f32_32x32x16_bf16 v[184:199], v[152:155], a[80:83], v[184:199]
    v_mfma_f32_32x32x16_bf16 v[200:215], v[152:155], a[192:195], v[200:215]
    v_mfma_f32_32x32x16_bf16 v[184:199], v[156:159], a[84:87], v[184:199]
    v_mfma_f32_32x32x16_bf16 v[200:215], v[156:159], a[196:199], v[200:215]
    v_mfma_f32_32x32x16_bf16 v[184:199], v[160:163], a[88:91], v[184:199]
    v_mfma_f32_32x32x16_bf16 v[200:215], v[160:163], a[200:203], v[200:215]
    v_mfma_f32_32x32x16_bf16 v[184:199], v[164:167], a[92:95], v[184:199]
    v_mfma_f32_32x32x16_bf16 v[200:215], v[164:167], a[204:207], v[200:215]
    v_mfma_f32_32x32x16_bf16 v[184:199], v[168:171], a[96:99], v[184:199]
    v_mfma_f32_32x32x16_bf16 v[200:215], v[168:171], a[208:211], v[200:215]
    v_mfma_f32_32x32x16_bf16 v[184:199], v[172:175], a[100:103], v[184:199]
    v_mfma_f32_32x32x16_bf16 v[200:215], v[172:175], a[212:215], v[200:215]
    v_mfma_f32_32x32x16_bf16 v[184:199], v[176:179], a[104:107], v[184:199]
    v_mfma_f32_32x32x16_bf16 v[200:215], v[176:179], a[216:219], v[200:215]
    v_mfma_f32_32x32x16_bf16 v[184:199], v[180:183], a[108:111], v[184:199]
    v_mfma_f32_32x32x16_bf16 v[200:215], v[180:183], a[220:223], v[200:215]
    s_nop 15
    s_nop 1
    v_cvt_pk_bf16_f32 v216, v184, v185
    v_cvt_pk_bf16_f32 v217, v186, v187
    v_cvt_pk_bf16_f32 v218, v188, v189
    v_cvt_pk_bf16_f32 v219, v190, v191
    v_cvt_pk_bf16_f32 v220, v192, v193
    v_cvt_pk_bf16_f32 v221, v194, v195
    v_cvt_pk_bf16_f32 v222, v196, v197
    v_cvt_pk_bf16_f32 v223, v198, v199
    v_cvt_pk_bf16_f32 v224, v200, v201
    v_cvt_pk_bf16_f32 v225, v202, v203
    v_cvt_pk_bf16_f32 v226, v204, v205
    v_cvt_pk_bf16_f32 v227, v206, v207
    v_cvt_pk_bf16_f32 v228, v208, v209
    v_cvt_pk_bf16_f32 v229, v210, v211
    v_cvt_pk_bf16_f32 v230, v212, v213
    v_cvt_pk_bf16_f32 v231, v214, v215
    buffer_store_dwordx4 v[216:219], v6, s[56:59], s37 offen offset:0 sc1
    buffer_store_dwordx4 v[220:223], v7, s[56:59], s37 offen offset:0 sc1
    buffer_store_dwordx4 v[224:227], v6, s[56:59], s37 offen offset:512 sc1
    buffer_store_dwordx4 v[228:231], v7, s[56:59], s37 offen offset:512 sc1
    s_add_u32 s37, s37, 1835008
    s_waitcnt vmcnt(14)
    v_mfma_f32_32x32x16_bf16 v[184:199], v[16:19], a[0:3], 0
    v_mfma_f32_32x32x16_bf16 v[200:215], v[16:19], a[112:115], 0
    v_mfma_f32_32x32x16_bf16 v[184:199], v[20:23], a[4:7], v[184:199]
    v_mfma_f32_32x32x16_bf16 v[200:215], v[20:23], a[116:119], v[200:215]
    v_mfma_f32_32x32x16_bf16 v[184:199], v[24:27], a[8:11], v[184:199]
    v_mfma_f32_32x32x16_bf16 v[200:215], v[24:27], a[120:123], v[200:215]
    v_mfma_f32_32x32x16_bf16 v[184:199], v[28:31], a[12:15], v[184:199]
    v_mfma_f32_32x32x16_bf16 v[200:215], v[28:31], a[124:127], v[200:215]
    v_mfma_f32_32x32x16_bf16 v[184:199], v[32:35], a[16:19], v[184:199]
    v_mfma_f32_32x32x16_bf16 v[200:215], v[32:35], a[128:131], v[200:215]
    v_mfma_f32_32x32x16_bf16 v[184:199], v[36:39], a[20:23], v[184:199]
    v_mfma_f32_32x32x16_bf16 v[200:215], v[36:39], a[132:135], v[200:215]
    v_mfma_f32_32x32x16_bf16 v[184:199], v[40:43], a[24:27], v[184:199]
    v_mfma_f32_32x32x16_bf16 v[200:215], v[40:43], a[136:139], v[200:215]
    v_mfma_f32_32x32x16_bf16 v[184:199], v[44:47], a[28:31], v[184:199]
    v_mfma_f32_32x32x16_bf16 v[200:215], v[44:47], a[140:143], v[200:215]
    v_mfma_f32_32x32x16_bf16 v[184:199], v[48:51], a[32:35], v[184:199]
    v_mfma_f32_32x32x16_bf16 v[200:215], v[48:51], a[144:147], v[200:215]
    v_mfma_f32_32x32x16_bf16 v[184:199], v[52:55], a[36:39], v[184:199]
    v_mfma_f32_32x32x16_bf16 v[200:215], v[52:55], a[148:151], v[200:215]
    v_mfma_f32_32x32x16_bf16 v[184:199], v[56:59], a[40:43], v[184:199]
    v_mfma_f32_32x32x16_bf16 v[200:215], v[56:59], a[152:155], v[200:215]
    v_mfma_f32_32x32x16_bf16 v[184:199], v[60:63], a[44:47], v[184:199]
    v_mfma_f32_32x32x16_bf16 v[200:215], v[60:63], a[156:159], v[200:215]
    v_mfma_f32_32x32x16_bf16 v[184:199], v[64:67], a[48:51], v[184:199]
    v_mfma_f32_32x32x16_bf16 v[200:215], v[64:67], a[160:163], v[200:215]
    v_mfma_f32_32x32x16_bf16 v[184:199], v[68:71], a[52:55], v[184:199]
    v_mfma_f32_32x32x16_bf16 v[200:215], v[68:71], a[164:167], v[200:215]
    s_waitcnt vmcnt(0)
    v_mfma_f32_32x32x16_bf16 v[184:199], v[72:75], a[56:59], v[184:199]
    v_mfma_f32_32x32x16_bf16 v[200:215], v[72:75], a[168:171], v[200:215]
    v_mfma_f32_32x32x16_bf16 v[184:199], v[76:79], a[60:63], v[184:199]
    v_mfma_f32_32x32x16_bf16 v[200:215], v[76:79], a[172:175], v[200:215]
    v_mfma_f32_32x32x16_bf16 v[184:199], v[80:83], a[64:67], v[184:199]
    v_mfma_f32_32x32x16_bf16 v[200:215], v[80:83], a[176:179], v[200:215]
    v_mfma_f32_32x32x16_bf16 v[184:199], v[84:87], a[68:71], v[184:199]
    v_mfma_f32_32x32x16_bf16 v[200:215], v[84:87], a[180:183], v[200:215]
    v_mfma_f32_32x32x16_bf16 v[184:199], v[88:91], a[72:75], v[184:199]
    v_mfma_f32_32x32x16_bf16 v[200:215], v[88:91], a[184:187], v[200:215]
    v_mfma_f32_32x32x16_bf16 v[184:199], v[92:95], a[76:79], v[184:199]
    v_mfma_f32_32x32x16_bf16 v[200:215], v[92:95], a[188:191], v[200:215]
    v_mfma_f32_32x32x16_bf16 v[184:199], v[96:99], a[80:83], v[184:199]
    v_mfma_f32_32x32x16_bf16 v[200:215], v[96:99], a[192:195], v[200:215]
    v_mfma_f32_32x32x16_bf16 v[184:199], v[100:103], a[84:87], v[184:199]
    v_mfma_f32_32x32x16_bf16 v[200:215], v[100:103], a[196:199], v[200:215]
    v_mfma_f32_32x32x16_bf16 v[184:199], v[104:107], a[88:91], v[184:199]
    v_mfma_f32_32x32x16_bf16 v[200:215], v[104:107], a[200:203], v[200:215]
    v_mfma_f32_32x32x16_bf16 v[184:199], v[108:111], a[92:95], v[184:199]
    v_mfma_f32_32x32x16_bf16 v[200:215], v[108:111], a[204:207], v[200:215]
    v_mfma_f32_32x32x16_bf16 v[184:199], v[112:115], a[96:99], v[184:199]
    v_mfma_f32_32x32x16_bf16 v[200:215], v[112:115], a[208:211], v[200:215]
    v_mfma_f32_32x32x16_bf16 v[184:199], v[116:119], a[100:103], v[184:199]
    v_mfma_f32_32x32x16_bf16 v[200:215], v[116:119], a[212:215], v[200:215]
    v_mfma_f32_32x32x16_bf16 v[184:199], v[120:123], a[104:107], v[184:199]
    v_mfma_f32_32x32x16_bf16 v[200:215], v[120:123], a[216:219], v[200:215]
    v_mfma_f32_32x32x16_bf16 v[184:199], v[124:127], a[108:111], v[184:199]
    v_mfma_f32_32x32x16_bf16 v[200:215], v[124:127], a[220:223], v[200:215]
    s_nop 15
    s_nop 1
    v_cvt_pk_bf16_f32 v216, v184, v185
    v_cvt_pk_bf16_f32 v217, v186, v187
    v_cvt_pk_bf16_f32 v218, v188, v189
    v_cvt_pk_bf16_f32 v219, v190, v191
    v_cvt_pk_bf16_f32 v220, v192, v193
    v_cvt_pk_bf16_f32 v221, v194, v195
    v_cvt_pk_bf16_f32 v222, v196, v197
    v_cvt_pk_bf16_f32 v223, v198, v199
    v_cvt_pk_bf16_f32 v224, v200, v201
    v_cvt_pk_bf16_f32 v225, v202, v203
    v_cvt_pk_bf16_f32 v226, v204, v205
    v_cvt_pk_bf16_f32 v227, v206, v207
    v_cvt_pk_bf16_f32 v228, v208, v209
    v_cvt_pk_bf16_f32 v229, v210, v211
    v_cvt_pk_bf16_f32 v230, v212, v213
    v_cvt_pk_bf16_f32 v231, v214, v215
    buffer_store_dwordx4 v[216:219], v6, s[56:59], s37 offen offset:0 sc1
    buffer_store_dwordx4 v[220:223], v7, s[56:59], s37 offen offset:0 sc1
    buffer_store_dwordx4 v[224:227], v6, s[56:59], s37 offen offset:512 sc1
    buffer_store_dwordx4 v[228:231], v7, s[56:59], s37 offen offset:512 sc1
    s_add_u32 s37, s37, 1835008
    s_waitcnt vmcnt(0)
    s_barrier
    v_mov_b32 v13, 0
    s_lshl_b32 s22, s100, 2
    s_add_u32 s22, s22, 11264
    v_cmp_eq_u32 vcc, 0, v0
    s_and_b64 exec, exec, vcc
    buffer_store_dword v13, v13, s[96:99], s22 offen offset:0 sc1
    s_mov_b64 exec, -1
    s_branch wk_loop
tk_tu:
    s_cmp_eq_u32 s93, 1
    s_cbranch_scc1 is_23
    s_mov_b32 s93, 1
    v_readfirstlane_b32 s74, v0
    s_nop 3
    s_cmp_lt_u32 s74, 64
    s_cbranch_scc0 is_23
    s_load_dwordx2 s[74:75], s[0:1], 96
    s_waitcnt lgkmcnt(0)
    s_mov_b32 s84, s74
    s_mov_b32 s85, s75
    s_mov_b32 s86, 0x100
    s_mov_b32 s87, 0x00020000
    v_mov_b32 v13, 8
    s_mov_b32 s74, 0
wc_24:
    buffer_load_dword v12, v13, s[84:87], 0 offen sc1
    s_add_u32 s74, s74, 1
    s_cmp_gt_u32 s74, 3000000
    s_cbranch_scc1 wk_done
    s_waitcnt vmcnt(0)
    v_readfirstlane_b32 s75, v12
    s_nop 3
    s_cmp_ge_u32 s75, 256
    s_cbranch_scc1 wc_24_ok
    s_sleep 8
    s_branch wc_24
wc_24_ok:
is_23:
    v_readfirstlane_b32 s74, v0
    s_nop 3
    s_cmp_lt_u32 s74, 64
    s_cbranch_scc0 fx_22
    v_and_b32 v20, 63, v0
    v_lshlrev_b32 v20, 4, v20
    v_add_u32 v20, 0, v20
    s_mov_b32 s74, 0
    v_mov_b32 v12, 0
    v_mov_b32 v13, 0
    v_mov_b32 v14, 0
    v_mov_b32 v15, 0
    v_mov_b32 v16, 0
    v_mov_b32 v17, 0
    v_mov_b32 v18, 0
    v_mov_b32 v19, 0
fw_25:
    s_mov_b32 exec_lo, 0xffffffff
    s_mov_b32 exec_hi, 0xffffff
    buffer_load_dwordx4 v[12:15], v20, s[96:99], 0 offen sc1
    s_mov_b64 exec, -1
    s_add_u32 s74, s74, 1
    s_cmp_gt_u32 s74, 3000000
    s_cbranch_scc1 wk_done
    s_waitcnt vmcnt(0)
    v_max3_u32 v12, v12, v13, v14
    v_max3_u32 v16, v16, v17, v18
    v_max3_u32 v12, v12, v15, v19
    v_max_u32 v12, v12, v16
    v_cmp_eq_u32 vcc, -1, v12
    s_cbranch_vccz fw_25_ok
    s_sleep 8
    s_branch fw_25
fw_25_ok:
fx_22:
    s_barrier
    s_and_b32 s2, s100, 31
    s_lshr_b32 s52, s100, 5
    s_load_dwordx2 s[4:5], s[0:1], 104
    s_lshr_b32 s6, s2, 1
    s_and_b32 s7, s2, 1
    v_lshrrev_b32 v1, 6, v0
    v_and_b32 v22, 63, v0
    s_nop 0
    v_readfirstlane_b32 s8, v1
    v_and_b32 v23, 15, v22
    v_lshrrev_b32 v24, 4, v22
    v_and_b32 v25, 7, v22
    v_lshlrev_b32 v3, 4, v22
    s_waitcnt lgkmcnt(0)
    s_mov_b32 s16, s4
    s_mov_b32 s17, s5
    s_mov_b32 s18, 0xc40000
    s_mov_b32 s19, 0x00020000
    s_add_u32 s28, s4, 0x4440000
    s_addc_u32 s29, s5, 0x0
    s_mov_b32 s30, 0x700000
    s_mov_b32 s31, 0x00020000
    s_add_u32 s32, s4, 0x4b40000
    s_addc_u32 s33, s5, 0x0
    s_mov_b32 s34, 0x700000
    s_mov_b32 s35, 0x00020000
    s_add_u32 s36, s4, 0x53c4000
    s_addc_u32 s37, s5, 0x0
    s_mov_b32 s38, 0x70000
    s_mov_b32 s39, 0x00020000
    s_add_u32 s40, s4, 0x5434000
    s_addc_u32 s41, s5, 0x0
    s_mov_b32 s42, 0x8000
    s_mov_b32 s43, 0x00020000
    v_cmp_gt_u32 s[72:73], 14, v23
    v_cmp_gt_u32 s[44:45], 32, v22
    v_cmp_gt_u32 s[46:47], 56, v22
    s_mul_i32 s9, s2, 14
    s_and_b32 s15, s6, 3
    v_mul_u32_u24 v1, 912, v25
    v_lshl_add_u32 v1, v24, 5, v1
    v_lshrrev_b32 v26, 3, v23
    v_lshl_add_u32 v1, v26, 4, v1
    v_mov_b32 v4, 0x4444
    v_mov_b32 v26, 0xeeee
    v_cmp_gt_u32 vcc, 8, v23
    s_nop 1
    v_cndmask_b32 v4, v26, v4, vcc
    v_and_b32 v26, 1, v24
    v_lshlrev_b32 v6, 3, v26
    v_lshrrev_b32 v26, 1, v24
    v_lshl_add_u32 v6, v26, 2, v6
    v_lshl_add_u32 v6, v23, 4, v6
    v_add_u32 v6, 8192, v6
    v_and_b32 v26, 1, v24
    v_lshlrev_b32 v5, 7, v26
    v_lshrrev_b32 v26, 1, v24
    v_lshl_add_u32 v5, v26, 6, v5
    v_bfe_u32 v26, v23, 1, 1
    v_lshl_add_u32 v5, v26, 4, v5
    v_lshrrev_b32 v26, 2, v23
    v_lshl_add_u32 v5, v26, 2, v5
    v_and_b32 v26, 1, v23
    v_lshl_add_u32 v5, v26, 1, v5
    v_add_u32 v5, 12288, v5
    s_mul_i32 s12, s8, 1792
    v_add_u32 v15, s12, v3
    s_mul_i32 s12, s8, 1824
    v_add_u32 v16, s12, v3
    s_lshl_b32 s12, s8, 10
    v_add_u32 v11, s12, v3
    v_mul_u32_u24 v14, 224, v24
    v_lshl_add_u32 v14, v23, 4, v14
    s_mul_i32 s12, s8, 896
    v_add_u32 v14, s12, v14
    s_lshr_b32 s12, s6, 2
    s_mul_i32 s12, s12, 28
    s_mul_i32 s13, s7, 14
    s_add_u32 s12, s12, s13
    s_lshl_b32 s12, s12, 10
    s_lshl_b32 s13, s15, 8
    s_add_u32 s12, s12, s13
    s_lshl_b32 s13, s8, 12
    s_add_u32 s12, s12, s13
    v_lshlrev_b32 v12, 10, v24
    v_lshl_add_u32 v12, v23, 4, v12
    v_add_u32 v12, s12, v12
    v_mul_u32_u24 v13, 448, v24
    v_add_u32 v13, v13, v23
    v_add_u32 v13, s9, v13
    v_lshlrev_b32 v13, 4, v13
    s_mul_i32 s12, s8, 28672
    v_add_u32 v13, s12, v13
    s_lshl_b32 s57, s2, 4
    s_lshl_b32 s12, s8, 2
    s_add_u32 s57, s57, s12
    s_lshl_b32 s12, s52, 9
    s_add_u32 s57, s57, s12
    s_mul_i32 s53, s52, 7168
    s_mul_i32 s55, s52, 114688
    s_mul_i32 s56, s52, 114688
    s_cmp_eq_u32 s8, 1
    s_cbranch_scc1 tu_w1
    s_cmp_eq_u32 s8, 2
    s_cbranch_scc1 tu_w2
    s_cmp_eq_u32 s8, 3
    s_cbranch_scc1 tu_w3
tu_w0:
    s_mul_i32 s13, s2, 401408
    s_add_u32 s12, s13, 0
    buffer_load_dwordx4 a[0:3], v3, s[16:19], s12 offen offset:0
    buffer_load_dwordx4 a[4:7], v3, s[16:19], s12 offen offset:1024
    buffer_load_dwordx4 a[8:11], v3, s[16:19], s12 offen offset:2048
    buffer_load_dwordx4 a[12:15], v3, s[16:19], s12 offen offset:3072
    s_add_u32 s12, s13, 4096
    buffer_load_dwordx4 a[16:19], v3, s[16:19], s12 offen offset:0
    buffer_load_dwordx4 a[20:23], v3, s[16:19], s12 offen offset:1024
    buffer_load_dwordx4 a[24:27], v3, s[16:19], s12 offen offset:2048
    buffer_load_dwordx4 a[28:31], v3, s[16:19], s12 offen offset:3072
    s_add_u32 s12, s13, 8192
    buffer_load_dwordx4 a[32:35], v3, s[16:19], s12 offen offset:0
    buffer_load_dwordx4 a[36:39], v3, s[16:19], s12 offen offset:1024
    buffer_load_dwordx4 a[40:43], v3, s[16:19], s12 offen offset:2048
    buffer_load_dwordx4 a[44:47], v3, s[16:19], s12 offen offset:3072
    s_add_u32 s12, s13, 12288
    buffer_load_dwordx4 a[48:51], v3, s[16:19], s12 offen offset:0
    buffer_load_dwordx4 a[52:55], v3, s[16:19], s12 offen offset:1024
    s_add_u32 s12, s13, 14336
    buffer_load_dwordx4 a[56:59], v3, s[16:19], s12 offen offset:0
    buffer_load_dwordx4 a[60:63], v3, s[16:19], s12 offen offset:1024
    buffer_load_dwordx4 a[64:67], v3, s[16:19], s12 offen offset:2048
    buffer_load_dwordx4 a[68:71], v3, s[16:19], s12 offen offset:3072
    s_add_u32 s12, s13, 18432
    buffer_load_dwordx4 a[72:75], v3, s[16:19], s12 offen offset:0
    buffer_load_dwordx4 a[76:79], v3, s[16:19], s12 offen offset:1024
    buffer_load_dwordx4 a[80:83], v3, s[16:19], s12 offen offset:2048
    buffer_load_dwordx4 a[84:87], v3, s[16:19], s12 offen offset:3072
    s_add_u32 s12, s13, 22528
    buffer_load_dwordx4 a[88:91], v3, s[16:19], s12 offen offset:0
    buffer_load_dwordx4 a[92:95], v3, s[16:19], s12 offen offset:1024
    buffer_load_dwordx4 a[96:99], v3, s[16:19], s12 offen offset:2048
    buffer_load_dwordx4 a[100:103], v3, s[16:19], s12 offen offset:3072
    s_add_u32 s12, s13, 26624
    buffer_load_dwordx4 a[104:107], v3, s[16:19], s12 offen offset:0
    buffer_load_dwordx4 a[108:111], v3, s[16:19], s12 offen offset:1024
    s_add_u32 s12, s13, 28672
    buffer_load_dwordx4 a[112:115], v3, s[16:19], s12 offen offset:0
    buffer_load_dwordx4 a[116:119], v3, s[16:19], s12 offen offset:1024
    buffer_load_dwordx4 a[120:123], v3, s[16:19], s12 offen offset:2048
    buffer_load_dwordx4 a[124:127], v3, s[16:19], s12 offen offset:3072
    s_add_u32 s12, s13, 32768
    buffer_load_dwordx4 a[128:131], v3, s[16:19], s12 offen offset:0
    buffer_load_dwordx4 a[132:135], v3, s[16:19], s12 offen offset:1024
    buffer_load_dwordx4 a[136:139], v3, s[16:19], s12 offen offset:2048
    buffer_load_dwordx4 a[140:143], v3, s[16:19], s12 offen offset:3072
    s_add_u32 s12, s13, 36864
    buffer_load_dwordx4 a[144:147], v3, s[16:19], s12 offen offset:0
    buffer_load_dwordx4 a[148:151], v3, s[16:19], s12 offen offset:1024
    buffer_load_dwordx4 a[152:155], v3, s[16:19], s12 offen offset:2048
    buffer_load_dwordx4 a[156:159], v3, s[16:19], s12 offen offset:3072
    s_add_u32 s12, s13, 40960
    buffer_load_dwordx4 a[160:163], v3, s[16:19], s12 offen offset:0
    buffer_load_dwordx4 a[164:167], v3, s[16:19], s12 offen offset:1024
    s_add_u32 s12, s13, 43008
    buffer_load_dwordx4 a[168:171], v3, s[16:19], s12 offen offset:0
    buffer_load_dwordx4 a[172:175], v3, s[16:19], s12 offen offset:1024
    buffer_load_dwordx4 a[176:179], v3, s[16:19], s12 offen offset:2048
    buffer_load_dwordx4 a[180:183], v3, s[16:19], s12 offen offset:3072
    s_add_u32 s12, s13, 47104
    buffer_load_dwordx4 a[184:187], v3, s[16:19], s12 offen offset:0
    buffer_load_dwordx4 a[188:191], v3, s[16:19], s12 offen offset:1024
    buffer_load_dwordx4 a[192:195], v3, s[16:19], s12 offen offset:2048
    buffer_load_dwordx4 a[196:199], v3, s[16:19], s12 offen offset:3072
    s_add_u32 s12, s13, 51200
    buffer_load_dwordx4 a[200:203], v3, s[16:19], s12 offen offset:0
    buffer_load_dwordx4 a[204:207], v3, s[16:19], s12 offen offset:1024
    buffer_load_dwordx4 a[208:211], v3, s[16:19], s12 offen offset:2048
    buffer_load_dwordx4 a[212:215], v3, s[16:19], s12 offen offset:3072
    s_add_u32 s12, s13, 55296
    buffer_load_dwordx4 a[216:219], v3, s[16:19], s12 offen offset:0
    buffer_load_dwordx4 a[220:223], v3, s[16:19], s12 offen offset:1024
    s_add_u32 s12, s13, 200704
    buffer_load_dwordx4 v[88:91], v3, s[16:19], s12 offen offset:0
    buffer_load_dwordx4 v[92:95], v3, s[16:19], s12 offen offset:1024
    buffer_load_dwordx4 v[96:99], v3, s[16:19], s12 offen offset:2048
    buffer_load_dwordx4 v[100:103], v3, s[16:19], s12 offen offset:3072
    s_add_u32 s12, s13, 204800
    buffer_load_dwordx4 v[104:107], v3, s[16:19], s12 offen offset:0
    buffer_load_dwordx4 v[108:111], v3, s[16:19], s12 offen offset:1024
    buffer_load_dwordx4 v[112:115], v3, s[16:19], s12 offen offset:2048
    buffer_load_dwordx4 v[116:119], v3, s[16:19], s12 offen offset:3072
    s_add_u32 s12, s13, 208896
    buffer_load_dwordx4 v[120:123], v3, s[16:19], s12 offen offset:0
    buffer_load_dwordx4 v[124:127], v3, s[16:19], s12 offen offset:1024
    buffer_load_dwordx4 v[128:131], v3, s[16:19], s12 offen offset:2048
    buffer_load_dwordx4 v[132:135], v3, s[16:19], s12 offen offset:3072
    s_add_u32 s12, s13, 212992
    buffer_load_dwordx4 v[136:139], v3, s[16:19], s12 offen offset:0
    buffer_load_dwordx4 v[140:143], v3, s[16:19], s12 offen offset:1024
    s_add_u32 s12, s13, 215040
    buffer_load_dwordx4 v[144:147], v3, s[16:19], s12 offen offset:0
    buffer_load_dwordx4 v[148:151], v3, s[16:19], s12 offen offset:1024
    buffer_load_dwordx4 v[152:155], v3, s[16:19], s12 offen offset:2048
    buffer_load_dwordx4 v[156:159], v3, s[16:19], s12 offen offset:3072
    s_add_u32 s12, s13, 219136
    buffer_load_dwordx4 v[160:163], v3, s[16:19], s12 offen offset:0
    buffer_load_dwordx4 v[164:167], v3, s[16:19], s12 offen offset:1024
    buffer_load_dwordx4 v[168:171], v3, s[16:19], s12 offen offset:2048
    buffer_load_dwordx4 v[172:175], v3, s[16:19], s12 offen offset:3072
    s_add_u32 s12, s13, 223232
    buffer_load_dwordx4 v[176:179], v3, s[16:19], s12 offen offset:0
    buffer_load_dwordx4 v[180:183], v3, s[16:19], s12 offen offset:1024
    buffer_load_dwordx4 v[184:187], v3, s[16:19], s12 offen offset:2048
    buffer_load_dwordx4 v[188:191], v3, s[16:19], s12 offen offset:3072
    s_add_u32 s12, s13, 227328
    buffer_load_dwordx4 v[192:195], v3, s[16:19], s12 offen offset:0
    buffer_load_dwordx4 v[196:199], v3, s[16:19], s12 offen offset:1024
    s_add_u32 s12, s13, 229376
    buffer_load_dwordx4 v[200:203], v3, s[16:19], s12 offen offset:0
    buffer_load_dwordx4 v[204:207], v3, s[16:19], s12 offen offset:1024
    buffer_load_dwordx4 v[208:211], v3, s[16:19], s12 offen offset:2048
    buffer_load_dwordx4 v[212:215], v3, s[16:19], s12 offen offset:3072
    s_add_u32 s12, s13, 233472
    buffer_load_dwordx4 v[216:219], v3, s[16:19], s12 offen offset:0
    buffer_load_dwordx4 v[220:223], v3, s[16:19], s12 offen offset:1024
    buffer_load_dwordx4 v[224:227], v3, s[16:19], s12 offen offset:2048
    buffer_load_dwordx4 v[228:231], v3, s[16:19], s12 offen offset:3072
    s_add_u32 s12, s13, 237568
    buffer_load_dwordx4 v[232:235], v3, s[16:19], s12 offen offset:0
    buffer_load_dwordx4 v[236:239], v3, s[16:19], s12 offen offset:1024
    buffer_load_dwordx4 v[240:243], v3, s[16:19], s12 offen offset:2048
    buffer_load_dwordx4 v[244:247], v3, s[16:19], s12 offen offset:3072
    s_add_u32 s12, s13, 241664
    buffer_load_dwordx4 v[248:251], v3, s[16:19], s12 offen offset:0
    buffer_load_dwordx4 v[252:255], v3, s[16:19], s12 offen offset:1024
    v_mov_b32 v76, -1
    v_mov_b32 v77, -1
    v_mov_b32 v78, -1
    v_mov_b32 v79, -1
    s_add_u32 s12, s55, 7110656
    s_add_u32 s13, s56, 7110656
    buffer_store_dwordx4 v[76:79], v12, s[28:31], s12 offen sc1
    s_mov_b64 exec, s[72:73]
    buffer_store_dwordx4 v[76:79], v13, s[32:35], s13 offen sc1
    s_mov_b64 exec, -1
    s_nop 1
    v_mov_b32 v76, 0
    v_mov_b32 v77, 0
    v_mov_b32 v78, 0
    v_mov_b32 v79, 0
    v_mov_b32 v80, 0
    v_mov_b32 v81, 0
    v_mov_b32 v82, 0
    v_mov_b32 v83, 0
tu_loop0:
    s_mov_b32 s62, 0
tu_loop0_p:
    s_mov_b64 exec, s[46:47]
    buffer_load_dwordx4 v[76:79], v15, s[36:39], s53 offen offset:0 sc1
    buffer_load_dwordx4 v[80:83], v15, s[36:39], s53 offen offset:896 sc1
    s_mov_b64 exec, -1
    s_waitcnt vmcnt(0)
    s_cmp_eq_u32 s62, 0
    s_cbranch_scc0 tu_loop0_nf
    s_cmp_lt_u32 s52, 2
    s_cbranch_scc1 tu_loop0_nf
    s_mov_b64 exec, 1
    buffer_store_dword v3, v3, s[40:43], s57 offen sc1
    s_mov_b64 exec, -1
    s_add_u32 s57, s57, 1024
tu_loop0_nf:
    s_add_u32 s62, s62, 1
    s_cmp_gt_u32 s62, 3000000
    s_cbranch_scc1 wk_done
    v_max3_u32 v84, v76, v77, v78
    v_max3_u32 v85, v79, v80, v81
    v_max3_u32 v84, v84, v82, v83
    v_max_u32 v84, v84, v85
    v_cmp_eq_u32 vcc, -1, v84
    s_cbranch_vccz tu_loop0_g
    s_sleep 2
    s_branch tu_loop0_p
tu_loop0_g:
    s_mov_b64 exec, s[46:47]
    ds_write_b128 v16, v[76:79] offset:0
    ds_write_b128 v16, v[80:83] offset:912
    s_mov_b64 exec, -1
    v_mov_b32 v48, 0
    v_mov_b32 v49, 0
    v_mov_b32 v50, 0
    v_mov_b32 v51, 0
    v_mov_b32 v52, 0
    v_mov_b32 v53, 0
    v_mov_b32 v54, 0
    v_mov_b32 v55, 0
    v_mov_b32 v56, 0
    v_mov_b32 v57, 0
    v_mov_b32 v58, 0
    v_mov_b32 v59, 0
    v_mov_b32 v60, 0
    v_mov_b32 v61, 0
    v_mov_b32 v62, 0
    v_mov_b32 v63, 0
    v_mov_b32 v64, 0
    v_mov_b32 v65, 0
    v_mov_b32 v66, 0
    v_mov_b32 v67, 0
    v_mov_b32 v68, 0
    v_mov_b32 v69, 0
    v_mov_b32 v70, 0
    v_mov_b32 v71, 0
    v_mov_b32 v72, 0
    v_mov_b32 v73, 0
    v_mov_b32 v74, 0
    v_mov_b32 v75, 0
    s_waitcnt lgkmcnt(0)
    s_barrier
    ds_read_b128 v[20:23], v1 offset:0
    ds_read_b128 v[24:27], v1 offset:128
    ds_read_b128 v[28:31], v1 offset:256
    ds_read_b128 v[32:35], v1 offset:384
    ds_read_b128 v[36:39], v1 offset:512
    ds_read_b128 v[40:43], v1 offset:640
    ds_read_b128 v[44:47], v1 offset:768
    s_waitcnt lgkmcnt(6)
    v_smfmac_f32_16x16x64_bf16 v[48:51], v[20:23], a[0:7], v4
    v_smfmac_f32_16x16x64_bf16 v[52:55], v[20:23], a[56:63], v4
    v_smfmac_f32_16x16x64_bf16 v[56:59], v[20:23], a[112:119], v4
    v_smfmac_f32_16x16x64_bf16 v[60:63], v[20:23], a[168:175], v4
    v_smfmac_f32_16x16x64_bf16 v[64:67], v[20:23], v[88:95], v4
    v_smfmac_f32_16x16x64_bf16 v[68:71], v[20:23], v[144:151], v4
    v_smfmac_f32_16x16x64_bf16 v[72:75], v[20:23], v[200:207], v4
    s_waitcnt lgkmcnt(5)
    v_smfmac_f32_16x16x64_bf16 v[48:51], v[24:27], a[8:15], v4
    v_smfmac_f32_16x16x64_bf16 v[52:55], v[24:27], a[64:71], v4
    v_smfmac_f32_16x16x64_bf16 v[56:59], v[24:27], a[120:127], v4
    v_smfmac_f32_16x16x64_bf16 v[60:63], v[24:27], a[176:183], v4
    v_smfmac_f32_16x16x64_bf16 v[64:67], v[24:27], v[96:103], v4
    v_smfmac_f32_16x16x64_bf16 v[68:71], v[24:27], v[152:159], v4
    v_smfmac_f32_16x16x64_bf16 v[72:75], v[24:27], v[208:215], v4
    s_waitcnt lgkmcnt(4)
    v_smfmac_f32_16x16x64_bf16 v[48:51], v[28:31], a[16:23], v4
    v_smfmac_f32_16x16x64_bf16 v[52:55], v[28:31], a[72:79], v4
    v_smfmac_f32_16x16x64_bf16 v[56:59], v[28:31], a[128:135], v4
    v_smfmac_f32_16x16x64_bf16 v[60:63], v[28:31], a[184:191], v4
    v_smfmac_f32_16x16x64_bf16 v[64:67], v[28:31], v[104:111], v4
    v_smfmac_f32_16x16x64_bf16 v[68:71], v[28:31], v[160:167], v4
    v_smfmac_f32_16x16x64_bf16 v[72:75], v[28:31], v[216:223], v4
    s_waitcnt lgkmcnt(3)
    v_smfmac_f32_16x16x64_bf16 v[48:51], v[32:35], a[24:31], v4
    v_smfmac_f32_16x16x64_bf16 v[52:55], v[32:35], a[80:87], v4
    v_smfmac_f32_16x16x64_bf16 v[56:59], v[32:35], a[136:143], v4
    v_smfmac_f32_16x16x64_bf16 v[60:63], v[32:35], a[192:199], v4
    v_smfmac_f32_16x16x64_bf16 v[64:67], v[32:35], v[112:119], v4
    v_smfmac_f32_16x16x64_bf16 v[68:71], v[32:35], v[168:175], v4
    v_smfmac_f32_16x16x64_bf16 v[72:75], v[32:35], v[224:231], v4
    s_waitcnt lgkmcnt(2)
    v_smfmac_f32_16x16x64_bf16 v[48:51], v[36:39], a[32:39], v4
    v_smfmac_f32_16x16x64_bf16 v[52:55], v[36:39], a[88:95], v4
    v_smfmac_f32_16x16x64_bf16 v[56:59], v[36:39], a[144:151], v4
    v_smfmac_f32_16x16x64_bf16 v[60:63], v[36:39], a[200:207], v4
    v_smfmac_f32_16x16x64_bf16 v[64:67], v[36:39], v[120:127], v4
    v_smfmac_f32_16x16x64_bf16 v[68:71], v[36:39], v[176:183], v4
    v_smfmac_f32_16x16x64_bf16 v[72:75], v[36:39], v[232:239], v4
    s_waitcnt lgkmcnt(1)
    v_smfmac_f32_16x16x64_bf16 v[48:51], v[40:43], a[40:47], v4
    v_smfmac_f32_16x16x64_bf16 v[52:55], v[40:43], a[96:103], v4
    v_smfmac_f32_16x16x64_bf16 v[56:59], v[40:43], a[152:159], v4
    v_smfmac_f32_16x16x64_bf16 v[60:63], v[40:43], a[208:215], v4
    v_smfmac_f32_16x16x64_bf16 v[64:67], v[40:43], v[128:135], v4
    v_smfmac_f32_16x16x64_bf16 v[68:71], v[40:43], v[184:191], v4
    v_smfmac_f32_16x16x64_bf16 v[72:75], v[40:43], v[240:247], v4
    s_waitcnt lgkmcnt(0)
    v_smfmac_f32_16x16x64_bf16 v[48:51], v[44:47], a[48:55], v4
    v_smfmac_f32_16x16x64_bf16 v[52:55], v[44:47], a[104:111], v4
    v_smfmac_f32_16x16x64_bf16 v[56:59], v[44:47], a[160:167], v4
    v_smfmac_f32_16x16x64_bf16 v[60:63], v[44:47], a[216:223], v4
    v_smfmac_f32_16x16x64_bf16 v[64:67], v[44:47], v[136:143], v4
    v_smfmac_f32_16x16x64_bf16 v[68:71], v[44:47], v[192:199], v4
    v_smfmac_f32_16x16x64_bf16 v[72:75], v[44:47], v[248:255], v4
    s_nop 7
    v_permlane32_swap_b32 v48, v50
    v_permlane32_swap_b32 v49, v51
    s_nop 0
    v_add_f32 v48, v48, v50
    v_add_f32 v49, v49, v51
    v_cvt_pk_bf16_f32 v48, v48, v49
    v_permlane32_swap_b32 v52, v54
    v_permlane32_swap_b32 v53, v55
    s_nop 0
    v_add_f32 v52, v52, v54
    v_add_f32 v53, v53, v55
    v_cvt_pk_bf16_f32 v52, v52, v53
    v_permlane32_swap_b32 v56, v58
    v_permlane32_swap_b32 v57, v59
    s_nop 0
    v_add_f32 v56, v56, v58
    v_add_f32 v57, v57, v59
    v_cvt_pk_bf16_f32 v56, v56, v57
    v_permlane32_swap_b32 v60, v62
    v_permlane32_swap_b32 v61, v63
    s_nop 0
    v_add_f32 v60, v60, v62
    v_add_f32 v61, v61, v63
    v_cvt_pk_bf16_f32 v60, v60, v61
    v_permlane32_swap_b32 v64, v66
    v_permlane32_swap_b32 v65, v67
    s_nop 0
    v_add_f32 v64, v64, v66
    v_add_f32 v65, v65, v67
    v_cvt_pk_bf16_f32 v64, v64, v65
    v_permlane32_swap_b32 v68, v70
    v_permlane32_swap_b32 v69, v71
    s_nop 0
    v_add_f32 v68, v68, v70
    v_add_f32 v69, v69, v71
    v_cvt_pk_bf16_f32 v68, v68, v69
    v_permlane32_swap_b32 v72, v74
    v_permlane32_swap_b32 v73, v75
    s_nop 0
    v_add_f32 v72, v72, v74
    v_add_f32 v73, v73, v75
    v_cvt_pk_bf16_f32 v72, v72, v73
    ds_write_b16 v5, v48 offset:0
    ds_write_b16_d16_hi v5, v48 offset:32
    ds_write_b16 v5, v52 offset:256
    ds_write_b16_d16_hi v5, v52 offset:288
    ds_write_b16 v5, v56 offset:512
    ds_write_b16_d16_hi v5, v56 offset:544
    ds_write_b16 v5, v60 offset:768
    ds_write_b16_d16_hi v5, v60 offset:800
    ds_write_b32 v6, v64 offset:0
    ds_write_b32 v6, v68 offset:256
    ds_write_b32 v6, v72 offset:512
    s_waitcnt lgkmcnt(0)
    s_barrier
    ds_read_b128 v[20:23], v11 offset:12288
    ds_read_b128 v[24:27], v14 offset:8192
    s_waitcnt lgkmcnt(1)
    v_min_u32 v20, 0xfffffffe, v20
    v_min_u32 v21, 0xfffffffe, v21
    v_min_u32 v22, 0xfffffffe, v22
    v_min_u32 v23, 0xfffffffe, v23
    buffer_store_dwordx4 v[20:23], v12, s[28:31], s55 offen sc1
    s_mov_b64 exec, s[72:73]
    s_waitcnt lgkmcnt(0)
    v_min_u32 v24, 0xfffffffe, v24
    v_min_u32 v25, 0xfffffffe, v25
    v_min_u32 v26, 0xfffffffe, v26
    v_min_u32 v27, 0xfffffffe, v27
    buffer_store_dwordx4 v[24:27], v13, s[32:35], s56 offen sc1
    s_mov_b64 exec, -1
    s_add_u32 s52, s52, 2
    s_add_u32 s53, s53, 14336
    s_add_u32 s55, s55, 229376
    s_add_u32 s56, s56, 229376
    s_cmp_lt_u32 s52, 64
    s_cbranch_scc1 tu_loop0
    s_mov_b64 exec, 1
    buffer_store_dword v3, v3, s[40:43], s57 offen sc1
    s_mov_b64 exec, -1
    s_branch wk_loop
tu_w1:
    s_mul_i32 s13, s2, 401408
    s_add_u32 s12, s13, 57344
    buffer_load_dwordx4 a[0:3], v3, s[16:19], s12 offen offset:0
    buffer_load_dwordx4 a[4:7], v3, s[16:19], s12 offen offset:1024
    buffer_load_dwordx4 a[8:11], v3, s[16:19], s12 offen offset:2048
    buffer_load_dwordx4 a[12:15], v3, s[16:19], s12 offen offset:3072
    s_add_u32 s12, s13, 61440
    buffer_load_dwordx4 a[16:19], v3, s[16:19], s12 offen offset:0
    buffer_load_dwordx4 a[20:23], v3, s[16:19], s12 offen offset:1024
    buffer_load_dwordx4 a[24:27], v3, s[16:19], s12 offen offset:2048
    buffer_load_dwordx4 a[28:31], v3, s[16:19], s12 offen offset:3072
    s_add_u32 s12, s13, 65536
    buffer_load_dwordx4 a[32:35], v3, s[16:19], s12 offen offset:0
    buffer_load_dwordx4 a[36:39], v3, s[16:19], s12 offen offset:1024
    buffer_load_dwordx4 a[40:43], v3, s[16:19], s12 offen offset:2048
    buffer_load_dwordx4 a[44:47], v3, s[16:19], s12 offen offset:3072
    s_add_u32 s12, s13, 69632
    buffer_load_dwordx4 a[48:51], v3, s[16:19], s12 offen offset:0
    buffer_load_dwordx4 a[52:55], v3, s[16:19], s12 offen offset:1024
    s_add_u32 s12, s13, 71680
    buffer_load_dwordx4 a[56:59], v3, s[16:19], s12 offen offset:0
    buffer_load_dwordx4 a[60:63], v3, s[16:19], s12 offen offset:1024
    buffer_load_dwordx4 a[64:67], v3, s[16:19], s12 offen offset:2048
    buffer_load_dwordx4 a[68:71], v3, s[16:19], s12 offen offset:3072
    s_add_u32 s12, s13, 75776
    buffer_load_dwordx4 a[72:75], v3, s[16:19], s12 offen offset:0
    buffer_load_dwordx4 a[76:79], v3, s[16:19], s12 offen offset:1024
    buffer_load_dwordx4 a[80:83], v3, s[16:19], s12 offen offset:2048
    buffer_load_dwordx4 a[84:87], v3, s[16:19], s12 offen offset:3072
    s_add_u32 s12, s13, 79872
    buffer_load_dwordx4 a[88:91], v3, s[16:19], s12 offen offset:0
    buffer_load_dwordx4 a[92:95], v3, s[16:19], s12 offen offset:1024
    buffer_load_dwordx4 a[96:99], v3, s[16:19], s12 offen offset:2048
    buffer_load_dwordx4 a[100:103], v3, s[16:19], s12 offen offset:3072
    s_add_u32 s12, s13, 83968
    buffer_load_dwordx4 a[104:107], v3, s[16:19], s12 offen offset:0
    buffer_load_dwordx4 a[108:111], v3, s[16:19], s12 offen offset:1024
    s_add_u32 s12, s13, 86016
    buffer_load_dwordx4 a[112:115], v3, s[16:19], s12 offen offset:0
    buffer_load_dwordx4 a[116:119], v3, s[16:19], s12 offen offset:1024
    buffer_load_dwordx4 a[120:123], v3, s[16:19], s12 offen offset:2048
    buffer_load_dwordx4 a[124:127], v3, s[16:19], s12 offen offset:3072
    s_add_u32 s12, s13, 90112
    buffer_load_dwordx4 a[128:131], v3, s[16:19], s12 offen offset:0
    buffer_load_dwordx4 a[132:135], v3, s[16:19], s12 offen offset:1024
    buffer_load_dwordx4 a[136:139], v3, s[16:19], s12 offen offset:2048
    buffer_load_dwordx4 a[140:143], v3, s[16:19], s12 offen offset:3072
    s_add_u32 s12, s13, 94208
    buffer_load_dwordx4 a[144:147], v3, s[16:19], s12 offen offset:0
    buffer_load_dwordx4 a[148:151], v3, s[16:19], s12 offen offset:1024
    buffer_load_dwordx4 a[152:155], v3, s[16:19], s12 offen offset:2048
    buffer_load_dwordx4 a[156:159], v3, s[16:19], s12 offen offset:3072
    s_add_u32 s12, s13, 98304
    buffer_load_dwordx4 a[160:163], v3, s[16:19], s12 offen offset:0
    buffer_load_dwordx4 a[164:167], v3, s[16:19], s12 offen offset:1024
    s_add_u32 s12, s13, 100352
    buffer_load_dwordx4 a[168:171], v3, s[16:19], s12 offen offset:0
    buffer_load_dwordx4 a[172:175], v3, s[16:19], s12 offen offset:1024
    buffer_load_dwordx4 a[176:179], v3, s[16:19], s12 offen offset:2048
    buffer_load_dwordx4 a[180:183], v3, s[16:19], s12 offen offset:3072
    s_add_u32 s12, s13, 104448
    buffer_load_dwordx4 a[184:187], v3, s[16:19], s12 offen offset:0
    buffer_load_dwordx4 a[188:191], v3, s[16:19], s12 offen offset:1024
    buffer_load_dwordx4 a[192:195], v3, s[16:19], s12 offen offset:2048
    buffer_load_dwordx4 a[196:199], v3, s[16:19], s12 offen offset:3072
    s_add_u32 s12, s13, 108544
    buffer_load_dwordx4 a[200:203], v3, s[16:19], s12 offen offset:0
    buffer_load_dwordx4 a[204:207], v3, s[16:19], s12 offen offset:1024
    buffer_load_dwordx4 a[208:211], v3, s[16:19], s12 offen offset:2048
    buffer_load_dwordx4 a[212:215], v3, s[16:19], s12 offen offset:3072
    s_add_u32 s12, s13, 112640
    buffer_load_dwordx4 a[216:219], v3, s[16:19], s12 offen offset:0
    buffer_load_dwordx4 a[220:223], v3, s[16:19], s12 offen offset:1024
    s_add_u32 s12, s13, 243712
    buffer_load_dwordx4 v[88:91], v3, s[16:19], s12 offen offset:0
    buffer_load_dwordx4 v[92:95], v3, s[16:19], s12 offen offset:1024
    buffer_load_dwordx4 v[96:99], v3, s[16:19], s12 offen offset:2048
    buffer_load_dwordx4 v[100:103], v3, s[16:19], s12 offen offset:3072
    s_add_u32 s12, s13, 247808
    buffer_load_dwordx4 v[104:107], v3, s[16:19], s12 offen offset:0
    buffer_load_dwordx4 v[108:111], v3, s[16:19], s12 offen offset:1024
    buffer_load_dwordx4 v[112:115], v3, s[16:19], s12 offen offset:2048
    buffer_load_dwordx4 v[116:119], v3, s[16:19], s12 offen offset:3072
    s_add_u32 s12, s13, 251904
    buffer_load_dwordx4 v[120:123], v3, s[16:19], s12 offen offset:0
    buffer_load_dwordx4 v[124:127], v3, s[16:19], s12 offen offset:1024
    buffer_load_dwordx4 v[128:131], v3, s[16:19], s12 offen offset:2048
    buffer_load_dwordx4 v[132:135], v3, s[16:19], s12 offen offset:3072
    s_add_u32 s12, s13, 256000
    buffer_load_dwordx4 v[136:139], v3, s[16:19], s12 offen offset:0
    buffer_load_dwordx4 v[140:143], v3, s[16:19], s12 offen offset:1024
    s_add_u32 s12, s13, 258048
    buffer_load_dwordx4 v[144:147], v3, s[16:19], s12 offen offset:0
    buffer_load_dwordx4 v[148:151], v3, s[16:19], s12 offen offset:1024
    buffer_load_dwordx4 v[152:155], v3, s[16:19], s12 offen offset:2048
    buffer_load_dwordx4 v[156:159], v3, s[16:19], s12 offen offset:3072
    s_add_u32 s12, s13, 262144
    buffer_load_dwordx4 v[160:163], v3, s[16:19], s12 offen offset:0
    buffer_load_dwordx4 v[164:167], v3, s[16:19], s12 offen offset:1024
    buffer_load_dwordx4 v[168:171], v3, s[16:19], s12 offen offset:2048
    buffer_load_dwordx4 v[172:175], v3, s[16:19], s12 offen offset:3072
    s_add_u32 s12, s13, 266240
    buffer_load_dwordx4 v[176:179], v3, s[16:19], s12 offen offset:0
    buffer_load_dwordx4 v[180:183], v3, s[16:19], s12 offen offset:1024
    buffer_load_dwordx4 v[184:187], v3, s[16:19], s12 offen offset:2048
    buffer_load_dwordx4 v[188:191], v3, s[16:19], s12 offen offset:3072
    s_add_u32 s12, s13, 270336
    buffer_load_dwordx4 v[192:195], v3, s[16:19], s12 offen offset:0
    buffer_load_dwordx4 v[196:199], v3, s[16:19], s12 offen offset:1024
    s_add_u32 s12, s13, 272384
    buffer_load_dwordx4 v[200:203], v3, s[16:19], s12 offen offset:0
    buffer_load_dwordx4 v[204:207], v3, s[16:19], s12 offen offset:1024
    buffer_load_dwordx4 v[208:211], v3, s[16:19], s12 offen offset:2048
    buffer_load_dwordx4 v[212:215], v3, s[16:19], s12 offen offset:3072
    s_add_u32 s12, s13, 276480
    buffer_load_dwordx4 v[216:219], v3, s[16:19], s12 offen offset:0
    buffer_load_dwordx4 v[220:223], v3, s[16:19], s12 offen offset:1024
    buffer_load_dwordx4 v[224:227], v3, s[16:19], s12 offen offset:2048
    buffer_load_dwordx4 v[228:231], v3, s[16:19], s12 offen offset:3072
    s_add_u32 s12, s13, 280576
    buffer_load_dwordx4 v[232:235], v3, s[16:19], s12 offen offset:0
    buffer_load_dwordx4 v[236:239], v3, s[16:19], s12 offen offset:1024
    buffer_load_dwordx4 v[240:243], v3, s[16:19], s12 offen offset:2048
    buffer_load_dwordx4 v[244:247], v3, s[16:19], s12 offen offset:3072
    s_add_u32 s12, s13, 284672
    buffer_load_dwordx4 v[248:251], v3, s[16:19], s12 offen offset:0
    buffer_load_dwordx4 v[252:255], v3, s[16:19], s12 offen offset:1024
    v_mov_b32 v76, -1
    v_mov_b32 v77, -1
    v_mov_b32 v78, -1
    v_mov_b32 v79, -1
    s_add_u32 s12, s55, 7110656
    s_add_u32 s13, s56, 7110656
    buffer_store_dwordx4 v[76:79], v12, s[28:31], s12 offen sc1
    s_mov_b64 exec, s[72:73]
    buffer_store_dwordx4 v[76:79], v13, s[32:35], s13 offen sc1
    s_mov_b64 exec, -1
    s_nop 1
    v_mov_b32 v76, 0
    v_mov_b32 v77, 0
    v_mov_b32 v78, 0
    v_mov_b32 v79, 0
    v_mov_b32 v80, 0
    v_mov_b32 v81, 0
    v_mov_b32 v82, 0
    v_mov_b32 v83, 0
tu_loop1:
    s_mov_b32 s62, 0
tu_loop1_p:
    s_mov_b64 exec, s[46:47]
    buffer_load_dwordx4 v[76:79], v15, s[36:39], s53 offen offset:0 sc1
    buffer_load_dwordx4 v[80:83], v15, s[36:39], s53 offen offset:896 sc1
    s_mov_b64 exec, -1
    s_waitcnt vmcnt(0)
    s_cmp_eq_u32 s62, 0
    s_cbranch_scc0 tu_loop1_nf
    s_cmp_lt_u32 s52, 2
    s_cbranch_scc1 tu_loop1_nf
    s_mov_b64 exec, 1
    buffer_store_dword v3, v3, s[40:43], s57 offen sc1
    s_mov_b64 exec, -1
    s_add_u32 s57, s57, 1024
tu_loop1_nf:
    s_add_u32 s62, s62, 1
    s_cmp_gt_u32 s62, 3000000
    s_cbranch_scc1 wk_done
    v_max3_u32 v84, v76, v77, v78
    v_max3_u32 v85, v79, v80, v81
    v_max3_u32 v84, v84, v82, v83
    v_max_u32 v84, v84, v85
    v_cmp_eq_u32 vcc, -1, v84
    s_cbranch_vccz tu_loop1_g
    s_sleep 2
    s_branch tu_loop1_p
tu_loop1_g:
    s_mov_b64 exec, s[46:47]
    ds_write_b128 v16, v[76:79] offset:0
    ds_write_b128 v16, v[80:83] offset:912
    s_mov_b64 exec, -1
    v_mov_b32 v48, 0
    v_mov_b32 v49, 0
    v_mov_b32 v50, 0
    v_mov_b32 v51, 0
    v_mov_b32 v52, 0
    v_mov_b32 v53, 0
    v_mov_b32 v54, 0
    v_mov_b32 v55, 0
    v_mov_b32 v56, 0
    v_mov_b32 v57, 0
    v_mov_b32 v58, 0
    v_mov_b32 v59, 0
    v_mov_b32 v60, 0
    v_mov_b32 v61, 0
    v_mov_b32 v62, 0
    v_mov_b32 v63, 0
    v_mov_b32 v64, 0
    v_mov_b32 v65, 0
    v_mov_b32 v66, 0
    v_mov_b32 v67, 0
    v_mov_b32 v68, 0
    v_mov_b32 v69, 0
    v_mov_b32 v70, 0
    v_mov_b32 v71, 0
    v_mov_b32 v72, 0
    v_mov_b32 v73, 0
    v_mov_b32 v74, 0
    v_mov_b32 v75, 0
    s_waitcnt lgkmcnt(0)
    s_barrier
    ds_read_b128 v[20:23], v1 offset:0
    ds_read_b128 v[24:27], v1 offset:128
    ds_read_b128 v[28:31], v1 offset:256
    ds_read_b128 v[32:35], v1 offset:384
    ds_read_b128 v[36:39], v1 offset:512
    ds_read_b128 v[40:43], v1 offset:640
    ds_read_b128 v[44:47], v1 offset:768
    s_waitcnt lgkmcnt(6)
    v_smfmac_f32_16x16x64_bf16 v[48:51], v[20:23], a[0:7], v4
    v_smfmac_f32_16x16x64_bf16 v[52:55], v[20:23], a[56:63], v4
    v_smfmac_f32_16x16x64_bf16 v[56:59], v[20:23], a[112:119], v4
    v_smfmac_f32_16x16x64_bf16 v[60:63], v[20:23], a[168:175], v4
    v_smfmac_f32_16x16x64_bf16 v[64:67], v[20:23], v[88:95], v4
    v_smfmac_f32_16x16x64_bf16 v[68:71], v[20:23], v[144:151], v4
    v_smfmac_f32_16x16x64_bf16 v[72:75], v[20:23], v[200:207], v4
    s_waitcnt lgkmcnt(5)
    v_smfmac_f32_16x16x64_bf16 v[48:51], v[24:27], a[8:15], v4
    v_smfmac_f32_16x16x64_bf16 v[52:55], v[24:27], a[64:71], v4
    v_smfmac_f32_16x16x64_bf16 v[56:59], v[24:27], a[120:127], v4
    v_smfmac_f32_16x16x64_bf16 v[60:63], v[24:27], a[176:183], v4
    v_smfmac_f32_16x16x64_bf16 v[64:67], v[24:27], v[96:103], v4
    v_smfmac_f32_16x16x64_bf16 v[68:71], v[24:27], v[152:159], v4
    v_smfmac_f32_16x16x64_bf16 v[72:75], v[24:27], v[208:215], v4
    s_waitcnt lgkmcnt(4)
    v_smfmac_f32_16x16x64_bf16 v[48:51], v[28:31], a[16:23], v4
    v_smfmac_f32_16x16x64_bf16 v[52:55], v[28:31], a[72:79], v4
    v_smfmac_f32_16x16x64_bf16 v[56:59], v[28:31], a[128:135], v4
    v_smfmac_f32_16x16x64_bf16 v[60:63], v[28:31], a[184:191], v4
    v_smfmac_f32_16x16x64_bf16 v[64:67], v[28:31], v[104:111], v4
    v_smfmac_f32_16x16x64_bf16 v[68:71], v[28:31], v[160:167], v4
    v_smfmac_f32_16x16x64_bf16 v[72:75], v[28:31], v[216:223], v4
    s_waitcnt lgkmcnt(3)
    v_smfmac_f32_16x16x64_bf16 v[48:51], v[32:35], a[24:31], v4
    v_smfmac_f32_16x16x64_bf16 v[52:55], v[32:35], a[80:87], v4
    v_smfmac_f32_16x16x64_bf16 v[56:59], v[32:35], a[136:143], v4
    v_smfmac_f32_16x16x64_bf16 v[60:63], v[32:35], a[192:199], v4
    v_smfmac_f32_16x16x64_bf16 v[64:67], v[32:35], v[112:119], v4
    v_smfmac_f32_16x16x64_bf16 v[68:71], v[32:35], v[168:175], v4
    v_smfmac_f32_16x16x64_bf16 v[72:75], v[32:35], v[224:231], v4
    s_waitcnt lgkmcnt(2)
    v_smfmac_f32_16x16x64_bf16 v[48:51], v[36:39], a[32:39], v4
    v_smfmac_f32_16x16x64_bf16 v[52:55], v[36:39], a[88:95], v4
    v_smfmac_f32_16x16x64_bf16 v[56:59], v[36:39], a[144:151], v4
    v_smfmac_f32_16x16x64_bf16 v[60:63], v[36:39], a[200:207], v4
    v_smfmac_f32_16x16x64_bf16 v[64:67], v[36:39], v[120:127], v4
    v_smfmac_f32_16x16x64_bf16 v[68:71], v[36:39], v[176:183], v4
    v_smfmac_f32_16x16x64_bf16 v[72:75], v[36:39], v[232:239], v4
    s_waitcnt lgkmcnt(1)
    v_smfmac_f32_16x16x64_bf16 v[48:51], v[40:43], a[40:47], v4
    v_smfmac_f32_16x16x64_bf16 v[52:55], v[40:43], a[96:103], v4
    v_smfmac_f32_16x16x64_bf16 v[56:59], v[40:43], a[152:159], v4
    v_smfmac_f32_16x16x64_bf16 v[60:63], v[40:43], a[208:215], v4
    v_smfmac_f32_16x16x64_bf16 v[64:67], v[40:43], v[128:135], v4
    v_smfmac_f32_16x16x64_bf16 v[68:71], v[40:43], v[184:191], v4
    v_smfmac_f32_16x16x64_bf16 v[72:75], v[40:43], v[240:247], v4
    s_waitcnt lgkmcnt(0)
    v_smfmac_f32_16x16x64_bf16 v[48:51], v[44:47], a[48:55], v4
    v_smfmac_f32_16x16x64_bf16 v[52:55], v[44:47], a[104:111], v4
    v_smfmac_f32_16x16x64_bf16 v[56:59], v[44:47], a[160:167], v4
    v_smfmac_f32_16x16x64_bf16 v[60:63], v[44:47], a[216:223], v4
    v_smfmac_f32_16x16x64_bf16 v[64:67], v[44:47], v[136:143], v4
    v_smfmac_f32_16x16x64_bf16 v[68:71], v[44:47], v[192:199], v4
    v_smfmac_f32_16x16x64_bf16 v[72:75], v[44:47], v[248:255], v4
    s_nop 7
    v_permlane32_swap_b32 v48, v50
    v_permlane32_swap_b32 v49, v51
    s_nop 0
    v_add_f32 v48, v48, v50
    v_add_f32 v49, v49, v51
    v_cvt_pk_bf16_f32 v48, v48, v49
    v_permlane32_swap_b32 v52, v54
    v_permlane32_swap_b32 v53, v55
    s_nop 0
    v_add_f32 v52, v52, v54
    v_add_f32 v53, v53, v55
    v_cvt_pk_bf16_f32 v52, v52, v53
    v_permlane32_swap_b32 v56, v58
    v_permlane32_swap_b32 v57, v59
    s_nop 0
    v_add_f32 v56, v56, v58
    v_add_f32 v57, v57, v59
    v_cvt_pk_bf16_f32 v56, v56, v57
    v_permlane32_swap_b32 v60, v62
    v_permlane32_swap_b32 v61, v63
    s_nop 0
    v_add_f32 v60, v60, v62
    v_add_f32 v61, v61, v63
    v_cvt_pk_bf16_f32 v60, v60, v61
    v_permlane32_swap_b32 v64, v66
    v_permlane32_swap_b32 v65, v67
    s_nop 0
    v_add_f32 v64, v64, v66
    v_add_f32 v65, v65, v67
    v_cvt_pk_bf16_f32 v64, v64, v65
    v_permlane32_swap_b32 v68, v70
    v_permlane32_swap_b32 v69, v71
    s_nop 0
    v_add_f32 v68, v68, v70
    v_add_f32 v69, v69, v71
    v_cvt_pk_bf16_f32 v68, v68, v69
    v_permlane32_swap_b32 v72, v74
    v_permlane32_swap_b32 v73, v75
    s_nop 0
    v_add_f32 v72, v72, v74
    v_add_f32 v73, v73, v75
    v_cvt_pk_bf16_f32 v72, v72, v73
    ds_write_b16 v5, v48 offset:1024
    ds_write_b16_d16_hi v5, v48 offset:1056
    ds_write_b16 v5, v52 offset:1280
    ds_write_b16_d16_hi v5, v52 offset:1312
    ds_write_b16 v5, v56 offset:1536
    ds_write_b16_d16_hi v5, v56 offset:1568
    ds_write_b16 v5, v60 offset:1792
    ds_write_b16_d16_hi v5, v60 offset:1824
    ds_write_b32 v6, v64 offset:768
    ds_write_b32 v6, v68 offset:1024
    ds_write_b32 v6, v72 offset:1280
    s_waitcnt lgkmcnt(0)
    s_barrier
    ds_read_b128 v[20:23], v11 offset:12288
    ds_read_b128 v[24:27], v14 offset:8192
    s_waitcnt lgkmcnt(1)
    v_min_u32 v20, 0xfffffffe, v20
    v_min_u32 v21, 0xfffffffe, v21
    v_min_u32 v22, 0xfffffffe, v22
    v_min_u32 v23, 0xfffffffe, v23
    buffer_store_dwordx4 v[20:23], v12, s[28:31], s55 offen sc1
    s_mov_b64 exec, s[72:73]
    s_waitcnt lgkmcnt(0)
    v_min_u32 v24, 0xfffffffe, v24
    v_min_u32 v25, 0xfffffffe, v25
    v_min_u32 v26, 0xfffffffe, v26
    v_min_u32 v27, 0xfffffffe, v27
    buffer_store_dwordx4 v[24:27], v13, s[32:35], s56 offen sc1
    s_mov_b64 exec, -1
    s_add_u32 s52, s52, 2
    s_add_u32 s53, s53, 14336
    s_add_u32 s55, s55, 229376
    s_add_u32 s56, s56, 229376
    s_cmp_lt_u32 s52, 64
    s_cbranch_scc1 tu_loop1
    s_mov_b64 exec, 1
    buffer_store_dword v3, v3, s[40:43], s57 offen sc1
    s_mov_b64 exec, -1
    s_branch wk_loop
tu_w2:
    s_mul_i32 s13, s2, 401408
    s_add_u32 s12, s13, 114688
    buffer_load_dwordx4 a[0:3], v3, s[16:19], s12 offen offset:0
    buffer_load_dwordx4 a[4:7], v3, s[16:19], s12 offen offset:1024
    buffer_load_dwordx4 a[8:11], v3, s[16:19], s12 offen offset:2048
    buffer_load_dwordx4 a[12:15], v3, s[16:19], s12 offen offset:3072
    s_add_u32 s12, s13, 118784
    buffer_load_dwordx4 a[16:19], v3, s[16:19], s12 offen offset:0
    buffer_load_dwordx4 a[20:23], v3, s[16:19], s12 offen offset:1024
    buffer_load_dwordx4 a[24:27], v3, s[16:19], s12 offen offset:2048
    buffer_load_dwordx4 a[28:31], v3, s[16:19], s12 offen offset:3072
    s_add_u32 s12, s13, 122880
    buffer_load_dwordx4 a[32:35], v3, s[16:19], s12 offen offset:0
    buffer_load_dwordx4 a[36:39], v3, s[16:19], s12 offen offset:1024
    buffer_load_dwordx4 a[40:43], v3, s[16:19], s12 offen offset:2048
    buffer_load_dwordx4 a[44:47], v3, s[16:19], s12 offen offset:3072
    s_add_u32 s12, s13, 126976
    buffer_load_dwordx4 a[48:51], v3, s[16:19], s12 offen offset:0
    buffer_load_dwordx4 a[52:55], v3, s[16:19], s12 offen offset:1024
    s_add_u32 s12, s13, 129024
    buffer_load_dwordx4 a[56:59], v3, s[16:19], s12 offen offset:0
    buffer_load_dwordx4 a[60:63], v3, s[16:19], s12 offen offset:1024
    buffer_load_dwordx4 a[64:67], v3, s[16:19], s12 offen offset:2048
    buffer_load_dwordx4 a[68:71], v3, s[16:19], s12 offen offset:3072
    s_add_u32 s12, s13, 133120
    buffer_load_dwordx4 a[72:75], v3, s[16:19], s12 offen offset:0
    buffer_load_dwordx4 a[76:79], v3, s[16:19], s12 offen offset:1024
    buffer_load_dwordx4 a[80:83], v3, s[16:19], s12 offen offset:2048
    buffer_load_dwordx4 a[84:87], v3, s[16:19], s12 offen offset:3072
    s_add_u32 s12, s13, 137216
    buffer_load_dwordx4 a[88:91], v3, s[16:19], s12 offen offset:0
    buffer_load_dwordx4 a[92:95], v3, s[16:19], s12 offen offset:1024
    buffer_load_dwordx4 a[96:99], v3, s[16:19], s12 offen offset:2048
    buffer_load_dwordx4 a[100:103], v3, s[16:19], s12 offen offset:3072
    s_add_u32 s12, s13, 141312
    buffer_load_dwordx4 a[104:107], v3, s[16:19], s12 offen offset:0
    buffer_load_dwordx4 a[108:111], v3, s[16:19], s12 offen offset:1024
    s_add_u32 s12, s13, 143360
    buffer_load_dwordx4 a[112:115], v3, s[16:19], s12 offen offset:0
    buffer_load_dwordx4 a[116:119], v3, s[16:19], s12 offen offset:1024
    buffer_load_dwordx4 a[120:123], v3, s[16:19], s12 offen offset:2048
    buffer_load_dwordx4 a[124:127], v3, s[16:19], s12 offen offset:3072
    s_add_u32 s12, s13, 147456
    buffer_load_dwordx4 a[128:131], v3, s[16:19], s12 offen offset:0
    buffer_load_dwordx4 a[132:135], v3, s[16:19], s12 offen offset:1024
    buffer_load_dwordx4 a[136:139], v3, s[16:19], s12 offen offset:2048
    buffer_load_dwordx4 a[140:143], v3, s[16:19], s12 offen offset:3072
    s_add_u32 s12, s13, 151552
    buffer_load_dwordx4 a[144:147], v3, s[16:19], s12 offen offset:0
    buffer_load_dwordx4 a[148:151], v3, s[16:19], s12 offen offset:1024
    buffer_load_dwordx4 a[152:155], v3, s[16:19], s12 offen offset:2048
    buffer_load_dwordx4 a[156:159], v3, s[16:19], s12 offen offset:3072
    s_add_u32 s12, s13, 155648
    buffer_load_dwordx4 a[160:163], v3, s[16:19], s12 offen offset:0
    buffer_load_dwordx4 a[164:167], v3, s[16:19], s12 offen offset:1024
    s_add_u32 s12, s13, 157696
    buffer_load_dwordx4 a[168:171], v3, s[16:19], s12 offen offset:0
    buffer_load_dwordx4 a[172:175], v3, s[16:19], s12 offen offset:1024
    buffer_load_dwordx4 a[176:179], v3, s[16:19], s12 offen offset:2048
    buffer_load_dwordx4 a[180:183], v3, s[16:19], s12 offen offset:3072
    s_add_u32 s12, s13, 161792
    buffer_load_dwordx4 a[184:187], v3, s[16:19], s12 offen offset:0
    buffer_load_dwordx4 a[188:191], v3, s[16:19], s12 offen offset:1024
    buffer_load_dwordx4 a[192:195], v3, s[16:19], s12 offen offset:2048
    buffer_load_dwordx4 a[196:199], v3, s[16:19], s12 offen offset:3072
    s_add_u32 s12, s13, 165888
    buffer_load_dwordx4 a[200:203], v3, s[16:19], s12 offen offset:0
    buffer_load_dwordx4 a[204:207], v3, s[16:19], s12 offen offset:1024
    buffer_load_dwordx4 a[208:211], v3, s[16:19], s12 offen offset:2048
    buffer_load_dwordx4 a[212:215], v3, s[16:19], s12 offen offset:3072
    s_add_u32 s12, s13, 169984
    buffer_load_dwordx4 a[216:219], v3, s[16:19], s12 offen offset:0
    buffer_load_dwordx4 a[220:223], v3, s[16:19], s12 offen offset:1024
    s_add_u32 s12, s13, 286720
    buffer_load_dwordx4 v[88:91], v3, s[16:19], s12 offen offset:0
    buffer_load_dwordx4 v[92:95], v3, s[16:19], s12 offen offset:1024
    buffer_load_dwordx4 v[96:99], v3, s[16:19], s12 offen offset:2048
    buffer_load_dwordx4 v[100:103], v3, s[16:19], s12 offen offset:3072
    s_add_u32 s12, s13, 290816
    buffer_load_dwordx4 v[104:107], v3, s[16:19], s12 offen offset:0
    buffer_load_dwordx4 v[108:111], v3, s[16:19], s12 offen offset:1024
    buffer_load_dwordx4 v[112:115], v3, s[16:19], s12 offen offset:2048
    buffer_load_dwordx4 v[116:119], v3, s[16:19], s12 offen offset:3072
    s_add_u32 s12, s13, 294912
    buffer_load_dwordx4 v[120:123], v3, s[16:19], s12 offen offset:0
    buffer_load_dwordx4 v[124:127], v3, s[16:19], s12 offen offset:1024
    buffer_load_dwordx4 v[128:131], v3, s[16:19], s12 offen offset:2048
    buffer_load_dwordx4 v[132:135], v3, s[16:19], s12 offen offset:3072
    s_add_u32 s12, s13, 299008
    buffer_load_dwordx4 v[136:139], v3, s[16:19], s12 offen offset:0
    buffer_load_dwordx4 v[140:143], v3, s[16:19], s12 offen offset:1024
    s_add_u32 s12, s13, 301056
    buffer_load_dwordx4 v[144:147], v3, s[16:19], s12 offen offset:0
    buffer_load_dwordx4 v[148:151], v3, s[16:19], s12 offen offset:1024
    buffer_load_dwordx4 v[152:155], v3, s[16:19], s12 offen offset:2048
    buffer_load_dwordx4 v[156:159], v3, s[16:19], s12 offen offset:3072
    s_add_u32 s12, s13, 305152
    buffer_load_dwordx4 v[160:163], v3, s[16:19], s12 offen offset:0
    buffer_load_dwordx4 v[164:167], v3, s[16:19], s12 offen offset:1024
    buffer_load_dwordx4 v[168:171], v3, s[16:19], s12 offen offset:2048
    buffer_load_dwordx4 v[172:175], v3, s[16:19], s12 offen offset:3072
    s_add_u32 s12, s13, 309248
    buffer_load_dwordx4 v[176:179], v3, s[16:19], s12 offen offset:0
    buffer_load_dwordx4 v[180:183], v3, s[16:19], s12 offen offset:1024
    buffer_load_dwordx4 v[184:187], v3, s[16:19], s12 offen offset:2048
    buffer_load_dwordx4 v[188:191], v3, s[16:19], s12 offen offset:3072
    s_add_u32 s12, s13, 313344
    buffer_load_dwordx4 v[192:195], v3, s[16:19], s12 offen offset:0
    buffer_load_dwordx4 v[196:199], v3, s[16:19], s12 offen offset:1024
    s_add_u32 s12, s13, 315392
    buffer_load_dwordx4 v[200:203], v3, s[16:19], s12 offen offset:0
    buffer_load_dwordx4 v[204:207], v3, s[16:19], s12 offen offset:1024
    buffer_load_dwordx4 v[208:211], v3, s[16:19], s12 offen offset:2048
    buffer_load_dwordx4 v[212:215], v3, s[16:19], s12 offen offset:3072
    s_add_u32 s12, s13, 319488
    buffer_load_dwordx4 v[216:219], v3, s[16:19], s12 offen offset:0
    buffer_load_dwordx4 v[220:223], v3, s[16:19], s12 offen offset:1024
    buffer_load_dwordx4 v[224:227], v3, s[16:19], s12 offen offset:2048
    buffer_load_dwordx4 v[228:231], v3, s[16:19], s12 offen offset:3072
    s_add_u32 s12, s13, 323584
    buffer_load_dwordx4 v[232:235], v3, s[16:19], s12 offen offset:0
    buffer_load_dwordx4 v[236:239], v3, s[16:19], s12 offen offset:1024
    buffer_load_dwordx4 v[240:243], v3, s[16:19], s12 offen offset:2048
    buffer_load_dwordx4 v[244:247], v3, s[16:19], s12 offen offset:3072
    s_add_u32 s12, s13, 327680
    buffer_load_dwordx4 v[248:251], v3, s[16:19], s12 offen offset:0
    buffer_load_dwordx4 v[252:255], v3, s[16:19], s12 offen offset:1024
    v_mov_b32 v76, -1
    v_mov_b32 v77, -1
    v_mov_b32 v78, -1
    v_mov_b32 v79, -1
    s_add_u32 s12, s55, 7110656
    s_add_u32 s13, s56, 7110656
    buffer_store_dwordx4 v[76:79], v12, s[28:31], s12 offen sc1
    s_mov_b64 exec, s[72:73]
    buffer_store_dwordx4 v[76:79], v13, s[32:35], s13 offen sc1
    s_mov_b64 exec, -1
    s_nop 1
    v_mov_b32 v76, 0
    v_mov_b32 v77, 0
    v_mov_b32 v78, 0
    v_mov_b32 v79, 0
    v_mov_b32 v80, 0
    v_mov_b32 v81, 0
    v_mov_b32 v82, 0
    v_mov_b32 v83, 0
tu_loop2:
    s_mov_b32 s62, 0
tu_loop2_p:
    s_mov_b64 exec, s[46:47]
    buffer_load_dwordx4 v[76:79], v15, s[36:39], s53 offen offset:0 sc1
    buffer_load_dwordx4 v[80:83], v15, s[36:39], s53 offen offset:896 sc1
    s_mov_b64 exec, -1
    s_waitcnt vmcnt(0)
    s_cmp_eq_u32 s62, 0
    s_cbranch_scc0 tu_loop2_nf
    s_cmp_lt_u32 s52, 2
    s_cbranch_scc1 tu_loop2_nf
    s_mov_b64 exec, 1
    buffer_store_dword v3, v3, s[40:43], s57 offen sc1
    s_mov_b64 exec, -1
    s_add_u32 s57, s57, 1024
tu_loop2_nf:
    s_add_u32 s62, s62, 1
    s_cmp_gt_u32 s62, 3000000
    s_cbranch_scc1 wk_done
    v_max3_u32 v84, v76, v77, v78
    v_max3_u32 v85, v79, v80, v81
    v_max3_u32 v84, v84, v82, v83
    v_max_u32 v84, v84, v85
    v_cmp_eq_u32 vcc, -1, v84
    s_cbranch_vccz tu_loop2_g
    s_sleep 2
    s_branch tu_loop2_p
tu_loop2_g:
    s_mov_b64 exec, s[46:47]
    ds_write_b128 v16, v[76:79] offset:0
    ds_write_b128 v16, v[80:83] offset:912
    s_mov_b64 exec, -1
    v_mov_b32 v48, 0
    v_mov_b32 v49, 0
    v_mov_b32 v50, 0
    v_mov_b32 v51, 0
    v_mov_b32 v52, 0
    v_mov_b32 v53, 0
    v_mov_b32 v54, 0
    v_mov_b32 v55, 0
    v_mov_b32 v56, 0
    v_mov_b32 v57, 0
    v_mov_b32 v58, 0
    v_mov_b32 v59, 0
    v_mov_b32 v60, 0
    v_mov_b32 v61, 0
    v_mov_b32 v62, 0
    v_mov_b32 v63, 0
    v_mov_b32 v64, 0
    v_mov_b32 v65, 0
    v_mov_b32 v66, 0
    v_mov_b32 v67, 0
    v_mov_b32 v68, 0
    v_mov_b32 v69, 0
    v_mov_b32 v70, 0
    v_mov_b32 v71, 0
    v_mov_b32 v72, 0
    v_mov_b32 v73, 0
    v_mov_b32 v74, 0
    v_mov_b32 v75, 0
    s_waitcnt lgkmcnt(0)
    s_barrier
    ds_read_b128 v[20:23], v1 offset:0
    ds_read_b128 v[24:27], v1 offset:128
    ds_read_b128 v[28:31], v1 offset:256
    ds_read_b128 v[32:35], v1 offset:384
    ds_read_b128 v[36:39], v1 offset:512
    ds_read_b128 v[40:43], v1 offset:640
    ds_read_b128 v[44:47], v1 offset:768
    s_waitcnt lgkmcnt(6)
    v_smfmac_f32_16x16x64_bf16 v[48:51], v[20:23], a[0:7], v4
    v_smfmac_f32_16x16x64_bf16 v[52:55], v[20:23], a[56:63], v4
    v_smfmac_f32_16x16x64_bf16 v[56:59], v[20:23], a[112:119], v4
    v_smfmac_f32_16x16x64_bf16 v[60:63], v[20:23], a[168:175], v4
    v_smfmac_f32_16x16x64_bf16 v[64:67], v[20:23], v[88:95], v4
    v_smfmac_f32_16x16x64_bf16 v[68:71], v[20:23], v[144:151], v4
    v_smfmac_f32_16x16x64_bf16 v[72:75], v[20:23], v[200:207], v4
    s_waitcnt lgkmcnt(5)
    v_smfmac_f32_16x16x64_bf16 v[48:51], v[24:27], a[8:15], v4
    v_smfmac_f32_16x16x64_bf16 v[52:55], v[24:27], a[64:71], v4
    v_smfmac_f32_16x16x64_bf16 v[56:59], v[24:27], a[120:127], v4
    v_smfmac_f32_16x16x64_bf16 v[60:63], v[24:27], a[176:183], v4
    v_smfmac_f32_16x16x64_bf16 v[64:67], v[24:27], v[96:103], v4
    v_smfmac_f32_16x16x64_bf16 v[68:71], v[24:27], v[152:159], v4
    v_smfmac_f32_16x16x64_bf16 v[72:75], v[24:27], v[208:215], v4
    s_waitcnt lgkmcnt(4)
    v_smfmac_f32_16x16x64_bf16 v[48:51], v[28:31], a[16:23], v4
    v_smfmac_f32_16x16x64_bf16 v[52:55], v[28:31], a[72:79], v4
    v_smfmac_f32_16x16x64_bf16 v[56:59], v[28:31], a[128:135], v4
    v_smfmac_f32_16x16x64_bf16 v[60:63], v[28:31], a[184:191], v4
    v_smfmac_f32_16x16x64_bf16 v[64:67], v[28:31], v[104:111], v4
    v_smfmac_f32_16x16x64_bf16 v[68:71], v[28:31], v[160:167], v4
    v_smfmac_f32_16x16x64_bf16 v[72:75], v[28:31], v[216:223], v4
    s_waitcnt lgkmcnt(3)
    v_smfmac_f32_16x16x64_bf16 v[48:51], v[32:35], a[24:31], v4
    v_smfmac_f32_16x16x64_bf16 v[52:55], v[32:35], a[80:87], v4
    v_smfmac_f32_16x16x64_bf16 v[56:59], v[32:35], a[136:143], v4
    v_smfmac_f32_16x16x64_bf16 v[60:63], v[32:35], a[192:199], v4
    v_smfmac_f32_16x16x64_bf16 v[64:67], v[32:35], v[112:119], v4
    v_smfmac_f32_16x16x64_bf16 v[68:71], v[32:35], v[168:175], v4
    v_smfmac_f32_16x16x64_bf16 v[72:75], v[32:35], v[224:231], v4
    s_waitcnt lgkmcnt(2)
    v_smfmac_f32_16x16x64_bf16 v[48:51], v[36:39], a[32:39], v4
    v_smfmac_f32_16x16x64_bf16 v[52:55], v[36:39], a[88:95], v4
    v_smfmac_f32_16x16x64_bf16 v[56:59], v[36:39], a[144:151], v4
    v_smfmac_f32_16x16x64_bf16 v[60:63], v[36:39], a[200:207], v4
    v_smfmac_f32_16x16x64_bf16 v[64:67], v[36:39], v[120:127], v4
    v_smfmac_f32_16x16x64_bf16 v[68:71], v[36:39], v[176:183], v4
    v_smfmac_f32_16x16x64_bf16 v[72:75], v[36:39], v[232:239], v4
    s_waitcnt lgkmcnt(1)
    v_smfmac_f32_16x16x64_bf16 v[48:51], v[40:43], a[40:47], v4
    v_smfmac_f32_16x16x64_bf16 v[52:55], v[40:43], a[96:103], v4
    v_smfmac_f32_16x16x64_bf16 v[56:59], v[40:43], a[152:159], v4
    v_smfmac_f32_16x16x64_bf16 v[60:63], v[40:43], a[208:215], v4
    v_smfmac_f32_16x16x64_bf16 v[64:67], v[40:43], v[128:135], v4
    v_smfmac_f32_16x16x64_bf16 v[68:71], v[40:43], v[184:191], v4
    v_smfmac_f32_16x16x64_bf16 v[72:75], v[40:43], v[240:247], v4
    s_waitcnt lgkmcnt(0)
    v_smfmac_f32_16x16x64_bf16 v[48:51], v[44:47], a[48:55], v4
    v_smfmac_f32_16x16x64_bf16 v[52:55], v[44:47], a[104:111], v4
    v_smfmac_f32_16x16x64_bf16 v[56:59], v[44:47], a[160:167], v4
    v_smfmac_f32_16x16x64_bf16 v[60:63], v[44:47], a[216:223], v4
    v_smfmac_f32_16x16x64_bf16 v[64:67], v[44:47], v[136:143], v4
    v_smfmac_f32_16x16x64_bf16 v[68:71], v[44:47], v[192:199], v4
    v_smfmac_f32_16x16x64_bf16 v[72:75], v[44:47], v[248:255], v4
    s_nop 7
    v_permlane32_swap_b32 v48, v50
    v_permlane32_swap_b32 v49, v51
    s_nop 0
    v_add_f32 v48, v48, v50
    v_add_f32 v49, v49, v51
    v_cvt_pk_bf16_f32 v48, v48, v49
    v_permlane32_swap_b32 v52, v54
    v_permlane32_swap_b32 v53, v55
    s_nop 0
    v_add_f32 v52, v52, v54
    v_add_f32 v53, v53, v55
    v_cvt_pk_bf16_f32 v52, v52, v53
    v_permlane32_swap_b32 v56, v58
    v_permlane32_swap_b32 v57, v59
    s_nop 0
    v_add_f32 v56, v56, v58
    v_add_f32 v57, v57, v59
    v_cvt_pk_bf16_f32 v56, v56, v57
    v_permlane32_swap_b32 v60, v62
    v_permlane32_swap_b32 v61, v63
    s_nop 0
    v_add_f32 v60, v60, v62
    v_add_f32 v61, v61, v63
    v_cvt_pk_bf16_f32 v60, v60, v61
    v_permlane32_swap_b32 v64, v66
    v_permlane32_swap_b32 v65, v67
    s_nop 0
    v_add_f32 v64, v64, v66
    v_add_f32 v65, v65, v67
    v_cvt_pk_bf16_f32 v64, v64, v65
    v_permlane32_swap_b32 v68, v70
    v_permlane32_swap_b32 v69, v71
    s_nop 0
    v_add_f32 v68, v68, v70
    v_add_f32 v69, v69, v71
    v_cvt_pk_bf16_f32 v68, v68, v69
    v_permlane32_swap_b32 v72, v74
    v_permlane32_swap_b32 v73, v75
    s_nop 0
    v_add_f32 v72, v72, v74
    v_add_f32 v73, v73, v75
    v_cvt_pk_bf16_f32 v72, v72, v73
    ds_write_b16 v5, v48 offset:2048
    ds_write_b16_d16_hi v5, v48 offset:2080
    ds_write_b16 v5, v52 offset:2304
    ds_write_b16_d16_hi v5, v52 offset:2336
    ds_write_b16 v5, v56 offset:2560
    ds_write_b16_d16_hi v5, v56 offset:2592
    ds_write_b16 v5, v60 offset:2816
    ds_write_b16_d16_hi v5, v60 offset:2848
    ds_write_b32 v6, v64 offset:1536
    ds_write_b32 v6, v68 offset:1792
    ds_write_b32 v6, v72 offset:2048
    s_waitcnt lgkmcnt(0)
    s_barrier
    ds_read_b128 v[20:23], v11 offset:12288
    ds_read_b128 v[24:27], v14 offset:8192
    s_waitcnt lgkmcnt(1)
    v_min_u32 v20, 0xfffffffe, v20
    v_min_u32 v21, 0xfffffffe, v21
    v_min_u32 v22, 0xfffffffe, v22
    v_min_u32 v23, 0xfffffffe, v23
    buffer_store_dwordx4 v[20:23], v12, s[28:31], s55 offen sc1
    s_mov_b64 exec, s[72:73]
    s_waitcnt lgkmcnt(0)
    v_min_u32 v24, 0xfffffffe, v24
    v_min_u32 v25, 0xfffffffe, v25
    v_min_u32 v26, 0xfffffffe, v26
    v_min_u32 v27, 0xfffffffe, v27
    buffer_store_dwordx4 v[24:27], v13, s[32:35], s56 offen sc1
    s_mov_b64 exec, -1
    s_add_u32 s52, s52, 2
    s_add_u32 s53, s53, 14336
    s_add_u32 s55, s55, 229376
    s_add_u32 s56, s56, 229376
    s_cmp_lt_u32 s52, 64
    s_cbranch_scc1 tu_loop2
    s_mov_b64 exec, 1
    buffer_store_dword v3, v3, s[40:43], s57 offen sc1
    s_mov_b64 exec, -1
    s_branch wk_loop
tu_w3:
    s_mul_i32 s13, s2, 401408
    s_add_u32 s12, s13, 172032
    buffer_load_dwordx4 a[0:3], v3, s[16:19], s12 offen offset:0
    buffer_load_dwordx4 a[4:7], v3, s[16:19], s12 offen offset:1024
    buffer_load_dwordx4 a[8:11], v3, s[16:19], s12 offen offset:2048
    buffer_load_dwordx4 a[12:15], v3, s[16:19], s12 offen offset:3072
    s_add_u32 s12, s13, 176128
    buffer_load_dwordx4 a[16:19], v3, s[16:19], s12 offen offset:0
    buffer_load_dwordx4 a[20:23], v3, s[16:19], s12 offen offset:1024
    buffer_load_dwordx4 a[24:27], v3, s[16:19], s12 offen offset:2048
    buffer_load_dwordx4 a[28:31], v3, s[16:19], s12 offen offset:3072
    s_add_u32 s12, s13, 180224
    buffer_load_dwordx4 a[32:35], v3, s[16:19], s12 offen offset:0
    buffer_load_dwordx4 a[36:39], v3, s[16:19], s12 offen offset:1024
    buffer_load_dwordx4 a[40:43], v3, s[16:19], s12 offen offset:2048
    buffer_load_dwordx4 a[44:47], v3, s[16:19], s12 offen offset:3072
    s_add_u32 s12, s13, 184320
    buffer_load_dwordx4 a[48:51], v3, s[16:19], s12 offen offset:0
    buffer_load_dwordx4 a[52:55], v3, s[16:19], s12 offen offset:1024
    s_add_u32 s12, s13, 186368
    buffer_load_dwordx4 a[56:59], v3, s[16:19], s12 offen offset:0
    buffer_load_dwordx4 a[60:63], v3, s[16:19], s12 offen offset:1024
    buffer_load_dwordx4 a[64:67], v3, s[16:19], s12 offen offset:2048
    buffer_load_dwordx4 a[68:71], v3, s[16:19], s12 offen offset:3072
    s_add_u32 s12, s13, 190464
    buffer_load_dwordx4 a[72:75], v3, s[16:19], s12 offen offset:0
    buffer_load_dwordx4 a[76:79], v3, s[16:19], s12 offen offset:1024
    buffer_load_dwordx4 a[80:83], v3, s[16:19], s12 offen offset:2048
    buffer_load_dwordx4 a[84:87], v3, s[16:19], s12 offen offset:3072
    s_add_u32 s12, s13, 194560
    buffer_load_dwordx4 a[88:91], v3, s[16:19], s12 offen offset:0
    buffer_load_dwordx4 a[92:95], v3, s[16:19], s12 offen offset:1024
    buffer_load_dwordx4 a[96:99], v3, s[16:19], s12 offen offset:2048
    buffer_load_dwordx4 a[100:103], v3, s[16:19], s12 offen offset:3072
    s_add_u32 s12, s13, 198656
    buffer_load_dwordx4 a[104:107], v3, s[16:19], s12 offen offset:0
    buffer_load_dwordx4 a[108:111], v3, s[16:19], s12 offen offset:1024
    s_add_u32 s12, s13, 329728
    buffer_load_dwordx4 a[112:115], v3, s[16:19], s12 offen offset:0
    buffer_load_dwordx4 a[116:119], v3, s[16:19], s12 offen offset:1024
    buffer_load_dwordx4 a[120:123], v3, s[16:19], s12 offen offset:2048
    buffer_load_dwordx4 a[124:127], v3, s[16:19], s12 offen offset:3072
    s_add_u32 s12, s13, 333824
    buffer_load_dwordx4 a[128:131], v3, s[16:19], s12 offen offset:0
    buffer_load_dwordx4 a[132:135], v3, s[16:19], s12 offen offset:1024
    buffer_load_dwordx4 a[136:139], v3, s[16:19], s12 offen offset:2048
    buffer_load_dwordx4 a[140:143], v3, s[16:19], s12 offen offset:3072
    s_add_u32 s12, s13, 337920
    buffer_load_dwordx4 a[144:147], v3, s[16:19], s12 offen offset:0
    buffer_load_dwordx4 a[148:151], v3, s[16:19], s12 offen offset:1024
    buffer_load_dwordx4 a[152:155], v3, s[16:19], s12 offen offset:2048
    buffer_load_dwordx4 a[156:159], v3, s[16:19], s12 offen offset:3072
    s_add_u32 s12, s13, 342016
    buffer_load_dwordx4 a[160:163], v3, s[16:19], s12 offen offset:0
    buffer_load_dwordx4 a[164:167], v3, s[16:19], s12 offen offset:1024
    s_add_u32 s12, s13, 344064
    buffer_load_dwordx4 a[168:171], v3, s[16:19], s12 offen offset:0
    buffer_load_dwordx4 a[172:175], v3, s[16:19], s12 offen offset:1024
    buffer_load_dwordx4 a[176:179], v3, s[16:19], s12 offen offset:2048
    buffer_load_dwordx4 a[180:183], v3, s[16:19], s12 offen offset:3072
    s_add_u32 s12, s13, 348160
    buffer_load_dwordx4 a[184:187], v3, s[16:19], s12 offen offset:0
    buffer_load_dwordx4 a[188:191], v3, s[16:19], s12 offen offset:1024
    buffer_load_dwordx4 a[192:195], v3, s[16:19], s12 offen offset:2048
    buffer_load_dwordx4 a[196:199], v3, s[16:19], s12 offen offset:3072
    s_add_u32 s12, s13, 352256
    buffer_load_dwordx4 a[200:203], v3, s[16:19], s12 offen offset:0
    buffer_load_dwordx4 a[204:207], v3, s[16:19], s12 offen offset:1024
    buffer_load_dwordx4 a[208:211], v3, s[16:19], s12 offen offset:2048
    buffer_load_dwordx4 a[212:215], v3, s[16:19], s12 offen offset:3072
    s_add_u32 s12, s13, 356352
    buffer_load_dwordx4 a[216:219], v3, s[16:19], s12 offen offset:0
    buffer_load_dwordx4 a[220:223], v3, s[16:19], s12 offen offset:1024
    s_add_u32 s12, s13, 358400
    buffer_load_dwordx4 v[88:91], v3, s[16:19], s12 offen offset:0
    buffer_load_dwordx4 v[92:95], v3, s[16:19], s12 offen offset:1024
    buffer_load_dwordx4 v[96:99], v3, s[16:19], s12 offen offset:2048
    buffer_load_dwordx4 v[100:103], v3, s[16:19], s12 offen offset:3072
    s_add_u32 s12, s13, 362496
    buffer_load_dwordx4 v[104:107], v3, s[16:19], s12 offen offset:0
    buffer_load_dwordx4 v[108:111], v3, s[16:19], s12 offen offset:1024
    buffer_load_dwordx4 v[112:115], v3, s[16:19], s12 offen offset:2048
    buffer_load_dwordx4 v[116:119], v3, s[16:19], s12 offen offset:3072
    s_add_u32 s12, s13, 366592
    buffer_load_dwordx4 v[120:123], v3, s[16:19], s12 offen offset:0
    buffer_load_dwordx4 v[124:127], v3, s[16:19], s12 offen offset:1024
    buffer_load_dwordx4 v[128:131], v3, s[16:19], s12 offen offset:2048
    buffer_load_dwordx4 v[132:135], v3, s[16:19], s12 offen offset:3072
    s_add_u32 s12, s13, 370688
    buffer_load_dwordx4 v[136:139], v3, s[16:19], s12 offen offset:0
    buffer_load_dwordx4 v[140:143], v3, s[16:19], s12 offen offset:1024
    s_add_u32 s12, s13, 372736
    buffer_load_dwordx4 v[144:147], v3, s[16:19], s12 offen offset:0
    buffer_load_dwordx4 v[148:151], v3, s[16:19], s12 offen offset:1024
    buffer_load_dwordx4 v[152:155], v3, s[16:19], s12 offen offset:2048
    buffer_load_dwordx4 v[156:159], v3, s[16:19], s12 offen offset:3072
    s_add_u32 s12, s13, 376832
    buffer_load_dwordx4 v[160:163], v3, s[16:19], s12 offen offset:0
    buffer_load_dwordx4 v[164:167], v3, s[16:19], s12 offen offset:1024
    buffer_load_dwordx4 v[168:171], v3, s[16:19], s12 offen offset:2048
    buffer_load_dwordx4 v[172:175], v3, s[16:19], s12 offen offset:3072
    s_add_u32 s12, s13, 380928
    buffer_load_dwordx4 v[176:179], v3, s[16:19], s12 offen offset:0
    buffer_load_dwordx4 v[180:183], v3, s[16:19], s12 offen offset:1024
    buffer_load_dwordx4 v[184:187], v3, s[16:19], s12 offen offset:2048
    buffer_load_dwordx4 v[188:191], v3, s[16:19], s12 offen offset:3072
    s_add_u32 s12, s13, 385024
    buffer_load_dwordx4 v[192:195], v3, s[16:19], s12 offen offset:0
    buffer_load_dwordx4 v[196:199], v3, s[16:19], s12 offen offset:1024
    s_add_u32 s12, s13, 387072
    buffer_load_dwordx4 v[200:203], v3, s[16:19], s12 offen offset:0
    buffer_load_dwordx4 v[204:207], v3, s[16:19], s12 offen offset:1024
    buffer_load_dwordx4 v[208:211], v3, s[16:19], s12 offen offset:2048
    buffer_load_dwordx4 v[212:215], v3, s[16:19], s12 offen offset:3072
    s_add_u32 s12, s13, 391168
    buffer_load_dwordx4 v[216:219], v3, s[16:19], s12 offen offset:0
    buffer_load_dwordx4 v[220:223], v3, s[16:19], s12 offen offset:1024
    buffer_load_dwordx4 v[224:227], v3, s[16:19], s12 offen offset:2048
    buffer_load_dwordx4 v[228:231], v3, s[16:19], s12 offen offset:3072
    s_add_u32 s12, s13, 395264
    buffer_load_dwordx4 v[232:235], v3, s[16:19], s12 offen offset:0
    buffer_load_dwordx4 v[236:239], v3, s[16:19], s12 offen offset:1024
    buffer_load_dwordx4 v[240:243], v3, s[16:19], s12 offen offset:2048
    buffer_load_dwordx4 v[244:247], v3, s[16:19], s12 offen offset:3072
    s_add_u32 s12, s13, 399360
    buffer_load_dwordx4 v[248:251], v3, s[16:19], s12 offen offset:0
    buffer_load_dwordx4 v[252:255], v3, s[16:19], s12 offen offset:1024
    v_mov_b32 v76, -1
    v_mov_b32 v77, -1
    v_mov_b32 v78, -1
    v_mov_b32 v79, -1
    s_add_u32 s12, s55, 7110656
    s_add_u32 s13, s56, 7110656
    s_mov_b64 exec, s[44:45]
    buffer_store_dwordx4 v[76:79], v12, s[28:31], s12 offen sc1
    s_mov_b64 exec, s[72:73]
    buffer_store_dwordx4 v[76:79], v13, s[32:35], s13 offen sc1
    s_mov_b64 exec, -1
    s_nop 1
    v_mov_b32 v76, 0
    v_mov_b32 v77, 0
    v_mov_b32 v78, 0
    v_mov_b32 v79, 0
    v_mov_b32 v80, 0
    v_mov_b32 v81, 0
    v_mov_b32 v82, 0
    v_mov_b32 v83, 0
tu_loop3:
    s_mov_b32 s62, 0
tu_loop3_p:
    s_mov_b64 exec, s[46:47]
    buffer_load_dwordx4 v[76:79], v15, s[36:39], s53 offen offset:0 sc1
    buffer_load_dwordx4 v[80:83], v15, s[36:39], s53 offen offset:896 sc1
    s_mov_b64 exec, -1
    s_waitcnt vmcnt(0)
    s_cmp_eq_u32 s62, 0
    s_cbranch_scc0 tu_loop3_nf
    s_cmp_lt_u32 s52, 2
    s_cbranch_scc1 tu_loop3_nf
    s_mov_b64 exec, 1
    buffer_store_dword v3, v3, s[40:43], s57 offen sc1
    s_mov_b64 exec, -1
    s_add_u32 s57, s57, 1024
tu_loop3_nf:
    s_add_u32 s62, s62, 1
    s_cmp_gt_u32 s62, 3000000
    s_cbranch_scc1 wk_done
    v_max3_u32 v84, v76, v77, v78
    v_max3_u32 v85, v79, v80, v81
    v_max3_u32 v84, v84, v82, v83
    v_max_u32 v84, v84, v85
    v_cmp_eq_u32 vcc, -1, v84
    s_cbranch_vccz tu_loop3_g
    s_sleep 2
    s_branch tu_loop3_p
tu_loop3_g:
    s_mov_b64 exec, s[46:47]
    ds_write_b128 v16, v[76:79] offset:0
    ds_write_b128 v16, v[80:83] offset:912
    s_mov_b64 exec, -1
    v_mov_b32 v48, 0
    v_mov_b32 v49, 0
    v_mov_b32 v50, 0
    v_mov_b32 v51, 0
    v_mov_b32 v52, 0
    v_mov_b32 v53, 0
    v_mov_b32 v54, 0
    v_mov_b32 v55, 0
    v_mov_b32 v56, 0
    v_mov_b32 v57, 0
    v_mov_b32 v58, 0
    v_mov_b32 v59, 0
    v_mov_b32 v60, 0
    v_mov_b32 v61, 0
    v_mov_b32 v62, 0
    v_mov_b32 v63, 0
    v_mov_b32 v64, 0
    v_mov_b32 v65, 0
    v_mov_b32 v66, 0
    v_mov_b32 v67, 0
    v_mov_b32 v68, 0
    v_mov_b32 v69, 0
    v_mov_b32 v70, 0
    v_mov_b32 v71, 0
    v_mov_b32 v72, 0
    v_mov_b32 v73, 0
    v_mov_b32 v74, 0
    v_mov_b32 v75, 0
    s_waitcnt lgkmcnt(0)
    s_barrier
    ds_read_b128 v[20:23], v1 offset:0
    ds_read_b128 v[24:27], v1 offset:128
    ds_read_b128 v[28:31], v1 offset:256
    ds_read_b128 v[32:35], v1 offset:384
    ds_read_b128 v[36:39], v1 offset:512
    ds_read_b128 v[40:43], v1 offset:640
    ds_read_b128 v[44:47], v1 offset:768
    s_waitcnt lgkmcnt(6)
    v_smfmac_f32_16x16x64_bf16 v[48:51], v[20:23], a[0:7], v4
    v_smfmac_f32_16x16x64_bf16 v[52:55], v[20:23], a[56:63], v4
    v_smfmac_f32_16x16x64_bf16 v[56:59], v[20:23], a[112:119], v4
    v_smfmac_f32_16x16x64_bf16 v[60:63], v[20:23], a[168:175], v4
    v_smfmac_f32_16x16x64_bf16 v[64:67], v[20:23], v[88:95], v4
    v_smfmac_f32_16x16x64_bf16 v[68:71], v[20:23], v[144:151], v4
    v_smfmac_f32_16x16x64_bf16 v[72:75], v[20:23], v[200:207], v4
    s_waitcnt lgkmcnt(5)
    v_smfmac_f32_16x16x64_bf16 v[48:51], v[24:27], a[8:15], v4
    v_smfmac_f32_16x16x64_bf16 v[52:55], v[24:27], a[64:71], v4
    v_smfmac_f32_16x16x64_bf16 v[56:59], v[24:27], a[120:127], v4
    v_smfmac_f32_16x16x64_bf16 v[60:63], v[24:27], a[176:183], v4
    v_smfmac_f32_16x16x64_bf16 v[64:67], v[24:27], v[96:103], v4
    v_smfmac_f32_16x16x64_bf16 v[68:71], v[24:27], v[152:159], v4
    v_smfmac_f32_16x16x64_bf16 v[72:75], v[24:27], v[208:215], v4
    s_waitcnt lgkmcnt(4)
    v_smfmac_f32_16x16x64_bf16 v[48:51], v[28:31], a[16:23], v4
    v_smfmac_f32_16x16x64_bf16 v[52:55], v[28:31], a[72:79], v4
    v_smfmac_f32_16x16x64_bf16 v[56:59], v[28:31], a[128:135], v4
    v_smfmac_f32_16x16x64_bf16 v[60:63], v[28:31], a[184:191], v4
    v_smfmac_f32_16x16x64_bf16 v[64:67], v[28:31], v[104:111], v4
    v_smfmac_f32_16x16x64_bf16 v[68:71], v[28:31], v[160:167], v4
    v_smfmac_f32_16x16x64_bf16 v[72:75], v[28:31], v[216:223], v4
    s_waitcnt lgkmcnt(3)
    v_smfmac_f32_16x16x64_bf16 v[48:51], v[32:35], a[24:31], v4
    v_smfmac_f32_16x16x64_bf16 v[52:55], v[32:35], a[80:87], v4
    v_smfmac_f32_16x16x64_bf16 v[56:59], v[32:35], a[136:143], v4
    v_smfmac_f32_16x16x64_bf16 v[60:63], v[32:35], a[192:199], v4
    v_smfmac_f32_16x16x64_bf16 v[64:67], v[32:35], v[112:119], v4
    v_smfmac_f32_16x16x64_bf16 v[68:71], v[32:35], v[168:175], v4
    v_smfmac_f32_16x16x64_bf16 v[72:75], v[32:35], v[224:231], v4
    s_waitcnt lgkmcnt(2)
    v_smfmac_f32_16x16x64_bf16 v[48:51], v[36:39], a[32:39], v4
    v_smfmac_f32_16x16x64_bf16 v[52:55], v[36:39], a[88:95], v4
    v_smfmac_f32_16x16x64_bf16 v[56:59], v[36:39], a[144:151], v4
    v_smfmac_f32_16x16x64_bf16 v[60:63], v[36:39], a[200:207], v4
    v_smfmac_f32_16x16x64_bf16 v[64:67], v[36:39], v[120:127], v4
    v_smfmac_f32_16x16x64_bf16 v[68:71], v[36:39], v[176:183], v4
    v_smfmac_f32_16x16x64_bf16 v[72:75], v[36:39], v[232:239], v4
    s_waitcnt lgkmcnt(1)
    v_smfmac_f32_16x16x64_bf16 v[48:51], v[40:43], a[40:47], v4
    v_smfmac_f32_16x16x64_bf16 v[52:55], v[40:43], a[96:103], v4
    v_smfmac_f32_16x16x64_bf16 v[56:59], v[40:43], a[152:159], v4
    v_smfmac_f32_16x16x64_bf16 v[60:63], v[40:43], a[208:215], v4
    v_smfmac_f32_16x16x64_bf16 v[64:67], v[40:43], v[128:135], v4
    v_smfmac_f32_16x16x64_bf16 v[68:71], v[40:43], v[184:191], v4
    v_smfmac_f32_16x16x64_bf16 v[72:75], v[40:43], v[240:247], v4
    s_waitcnt lgkmcnt(0)
    v_smfmac_f32_16x16x64_bf16 v[48:51], v[44:47], a[48:55], v4
    v_smfmac_f32_16x16x64_bf16 v[52:55], v[44:47], a[104:111], v4
    v_smfmac_f32_16x16x64_bf16 v[56:59], v[44:47], a[160:167], v4
    v_smfmac_f32_16x16x64_bf16 v[60:63], v[44:47], a[216:223], v4
    v_smfmac_f32_16x16x64_bf16 v[64:67], v[44:47], v[136:143], v4
    v_smfmac_f32_16x16x64_bf16 v[68:71], v[44:47], v[192:199], v4
    v_smfmac_f32_16x16x64_bf16 v[72:75], v[44:47], v[248:255], v4
    s_nop 7
    v_permlane32_swap_b32 v48, v50
    v_permlane32_swap_b32 v49, v51
    s_nop 0
    v_add_f32 v48, v48, v50
    v_add_f32 v49, v49, v51
    v_cvt_pk_bf16_f32 v48, v48, v49
    v_permlane32_swap_b32 v52, v54
    v_permlane32_swap_b32 v53, v55
    s_nop 0
    v_add_f32 v52, v52, v54
    v_add_f32 v53, v53, v55
    v_cvt_pk_bf16_f32 v52, v52, v53
    v_permlane32_swap_b32 v56, v58
    v_permlane32_swap_b32 v57, v59
    s_nop 0
    v_add_f32 v56, v56, v58
    v_add_f32 v57, v57, v59
    v_cvt_pk_bf16_f32 v56, v56, v57
    v_permlane32_swap_b32 v60, v62
    v_permlane32_swap_b32 v61, v63
    s_nop 0
    v_add_f32 v60, v60, v62
    v_add_f32 v61, v61, v63
    v_cvt_pk_bf16_f32 v60, v60, v61
    v_permlane32_swap_b32 v64, v66
    v_permlane32_swap_b32 v65, v67
    s_nop 0
    v_add_f32 v64, v64, v66
    v_add_f32 v65, v65, v67
    v_cvt_pk_bf16_f32 v64, v64, v65
    v_permlane32_swap_b32 v68, v70
    v_permlane32_swap_b32 v69, v71
    s_nop 0
    v_add_f32 v68, v68, v70
    v_add_f32 v69, v69, v71
    v_cvt_pk_bf16_f32 v68, v68, v69
    v_permlane32_swap_b32 v72, v74
    v_permlane32_swap_b32 v73, v75
    s_nop 0
    v_add_f32 v72, v72, v74
    v_add_f32 v73, v73, v75
    v_cvt_pk_bf16_f32 v72, v72, v73
    ds_write_b16 v5, v48 offset:3072
    ds_write_b16_d16_hi v5, v48 offset:3104
    ds_write_b16 v5, v52 offset:3328
    ds_write_b16_d16_hi v5, v52 offset:3360
    ds_write_b32 v6, v56 offset:2304
    ds_write_b32 v6, v60 offset:2560
    ds_write_b32 v6, v64 offset:2816
    ds_write_b32 v6, v68 offset:3072
    ds_write_b32 v6, v72 offset:3328
    s_waitcnt lgkmcnt(0)
    s_barrier
    ds_read_b128 v[20:23], v11 offset:12288
    ds_read_b128 v[24:27], v14 offset:8192
    s_waitcnt lgkmcnt(1)
    v_min_u32 v20, 0xfffffffe, v20
    v_min_u32 v21, 0xfffffffe, v21
    v_min_u32 v22, 0xfffffffe, v22
    v_min_u32 v23, 0xfffffffe, v23
    s_mov_b64 exec, s[44:45]
    buffer_store_dwordx4 v[20:23], v12, s[28:31], s55 offen sc1
    s_mov_b64 exec, s[72:73]
    s_waitcnt lgkmcnt(0)
    v_min_u32 v24, 0xfffffffe, v24
    v_min_u32 v25, 0xfffffffe, v25
    v_min_u32 v26, 0xfffffffe, v26
    v_min_u32 v27, 0xfffffffe, v27
    buffer_store_dwordx4 v[24:27], v13, s[32:35], s56 offen sc1
    s_mov_b64 exec, -1
    s_add_u32 s52, s52, 2
    s_add_u32 s53, s53, 14336
    s_add_u32 s55, s55, 229376
    s_add_u32 s56, s56, 229376
    s_cmp_lt_u32 s52, 64
    s_cbranch_scc1 tu_loop3
    s_mov_b64 exec, 1
    buffer_store_dword v3, v3, s[40:43], s57 offen sc1
    s_mov_b64 exec, -1
    s_branch wk_loop
tk_fold:
    s_load_dwordx4 s[4:7], s[0:1], 8
    s_load_dwordx2 s[8:9], s[0:1], 24
    s_load_dwordx2 s[10:11], s[0:1], 104
    v_lshrrev_b32 v1, 6, v0
    v_and_b32 v2, 63, v0
    s_nop 0
    v_readfirstlane_b32 s3, v1
    v_and_b32 v3, 31, v2
    v_lshrrev_b32 v4, 5, v2
    s_waitcnt lgkmcnt(0)
    s_mov_b32 s12, s4
    s_mov_b32 s13, s5
    s_mov_b32 s14, 0x126000
    s_mov_b32 s15, 0x00020000
    s_mov_b32 s16, s6
    s_mov_b32 s17, s7
    s_mov_b32 s18, 0x6200
    s_mov_b32 s19, 0x00020000
    s_mov_b32 s20, s8
    s_mov_b32 s21, s9
    s_mov_b32 s22, 0x62000
    s_mov_b32 s23, 0x00020000
    s_add_u32 s24, s10, 0x54e0000
    s_addc_u32 s25, s11, 0x0
    s_mov_b32 s26, 0x150000
    s_mov_b32 s27, 0x00020000
    s_add_u32 s28, s10, 0x5630000
    s_addc_u32 s29, s11, 0x0
    s_mov_b32 s30, 0x70000
    s_mov_b32 s31, 0x00020000
    v_mov_b32 v9, 0x7ffffff0
    s_cmp_ge_u32 s100, 224
    s_cbranch_scc1 fo_wo
    s_cmp_ge_u32 s100, 112
    s_cbranch_scc1 fo_v
    s_lshl_b32 s32, s100, 2
    s_add_u32 s32, s32, s3
    s_mul_i32 s33, s32, 4682
    s_lshr_b32 s33, s33, 16
    s_mul_i32 s34, s33, 14
    s_sub_u32 s34, s32, s34
    s_lshr_b32 s35, s33, 4
    s_and_b32 s36, s33, 15
    v_and_b32 v5, 0x13, v3
    v_and_b32 v6, 4, v3
    v_lshl_or_b32 v5, v6, 1, v5
    v_and_b32 v6, 8, v3
    v_lshrrev_b32 v6, 1, v6
    v_or_b32 v5, v6, v5
    s_lshl_b32 s37, s34, 5
    v_add_u32 v6, s37, v5
    v_mul_u32_u24 v6, 2688, v6
    s_mul_i32 s37, s35, 896
    s_mul_i32 s38, s36, 56
    s_add_u32 s37, s37, s38
    v_add_u32 v6, s37, v6
    v_lshl_add_u32 v6, v4, 4, v6
    buffer_load_dwordx4 v[16:19], v6, s[12:15], 0 offen offset:0
    buffer_load_dwordx4 v[20:23], v6, s[12:15], 0 offen offset:32
    s_mul_i32 s37, s36, 1568
    v_lshlrev_b32 v7, 1, v3
    v_add_u32 v7, s37, v7
    v_mul_u32_u24 v8, 448, v4
    v_add_u32 v7, v7, v8
    v_cmp_gt_u32 vcc, 28, v3
    s_nop 1
    v_cndmask_b32 v7, v9, v7, vcc
    v_cmp_eq_u32 vcc, 0, v4
    s_nop 1
    v_cndmask_b32 v8, v9, v7, vcc
    buffer_load_ushort v32, v7, s[16:19], 0 offen offset:0
    buffer_load_ushort v33, v7, s[16:19], 0 offen offset:56
    buffer_load_ushort v34, v7, s[16:19], 0 offen offset:112
    buffer_load_ushort v35, v7, s[16:19], 0 offen offset:168
    buffer_load_ushort v36, v7, s[16:19], 0 offen offset:224
    buffer_load_ushort v37, v7, s[16:19], 0 offen offset:280
    buffer_load_ushort v38, v7, s[16:19], 0 offen offset:336
    buffer_load_ushort v39, v7, s[16:19], 0 offen offset:392
    buffer_load_ushort v40, v7, s[16:19], 0 offen offset:896
    buffer_load_ushort v41, v7, s[16:19], 0 offen offset:952
    buffer_load_ushort v42, v7, s[16:19], 0 offen offset:1008
    buffer_load_ushort v43, v7, s[16:19], 0 offen offset:1064
    buffer_load_ushort v44, v8, s[16:19], 0 offen offset:1120
    buffer_load_ushort v45, v8, s[16:19], 0 offen offset:1176
    buffer_load_ushort v46, v8, s[16:19], 0 offen offset:1232
    buffer_load_ushort v47, v8, s[16:19], 0 offen offset:1288
    s_waitcnt vmcnt(0)
    v_lshl_or_b32 v24, v33, 16, v32
    v_lshl_or_b32 v25, v35, 16, v34
    v_lshl_or_b32 v26, v37, 16, v36
    v_lshl_or_b32 v27, v39, 16, v38
    v_lshl_or_b32 v28, v41, 16, v40
    v_lshl_or_b32 v29, v43, 16, v42
    v_lshl_or_b32 v30, v45, 16, v44
    v_lshl_or_b32 v31, v47, 16, v46
    s_nop 1
    v_mfma_f32_32x32x16_bf16 v[48:63], v[16:19], v[24:27], 0
    v_mfma_f32_32x32x16_bf16 v[48:63], v[20:23], v[28:31], v[48:63]
    s_nop 15
    s_nop 1
    v_cvt_pk_bf16_f32 v64, v48, v49
    v_cvt_pk_bf16_f32 v65, v50, v51
    v_cvt_pk_bf16_f32 v66, v52, v53
    v_cvt_pk_bf16_f32 v67, v54, v55
    v_cvt_pk_bf16_f32 v68, v56, v57
    v_cvt_pk_bf16_f32 v69, v58, v59
    v_cvt_pk_bf16_f32 v70, v60, v61
    v_cvt_pk_bf16_f32 v71, v62, v63
    s_lshl_b32 s37, s33, 5
    v_add_u32 v6, s37, v3
    v_mul_u32_u24 v6, 896, v6
    s_lshl_b32 s37, s34, 6
    v_add_u32 v6, s37, v6
    v_lshl_add_u32 v6, v4, 4, v6
    buffer_store_dwordx4 v[64:67], v6, s[24:27], 0 offen offset:0 sc1
    buffer_store_dwordx4 v[68:71], v6, s[24:27], 0 offen offset:32 sc1
    s_branch fo_done
fo_v:
    s_sub_u32 s32, s100, 112
    s_lshl_b32 s32, s32, 8
    v_add_u32 v5, s32, v0
    v_and_b32 v6, 511, v5
    v_lshrrev_b32 v7, 9, v5
    v_lshrrev_b32 v8, 5, v6
    v_mul_u32_u24 v8, 28, v8
    v_add_u32 v8, v8, v3
    v_mul_u32_u24 v10, 10752, v7
    v_add_u32 v8, v8, v10
    v_add_u32 v8, 896, v8
    v_lshlrev_b32 v8, 1, v8
    v_cmp_gt_u32 vcc, 28, v3
    s_nop 1
    v_cndmask_b32 v8, v9, v8, vcc
    s_mov_b32 s33, 0
    buffer_load_ushort v32, v8, s[12:15], s33 offen
    s_add_u32 s33, s33, 2688
    buffer_load_ushort v33, v8, s[12:15], s33 offen
    s_add_u32 s33, s33, 2688
    buffer_load_ushort v34, v8, s[12:15], s33 offen
    s_add_u32 s33, s33, 2688
    buffer_load_ushort v35, v8, s[12:15], s33 offen
    s_add_u32 s33, s33, 2688
    buffer_load_ushort v36, v8, s[12:15], s33 offen
    s_add_u32 s33, s33, 2688
    buffer_load_ushort v37, v8, s[12:15], s33 offen
    s_add_u32 s33, s33, 2688
    buffer_load_ushort v38, v8, s[12:15], s33 offen
    s_add_u32 s33, s33, 2688
    buffer_load_ushort v39, v8, s[12:15], s33 offen
    s_add_u32 s33, s33, 2688
    v_add_u32 v6, 1024, v6
    v_mul_u32_u24 v6, 896, v6
    v_lshl_add_u32 v6, v7, 4, v6
    s_waitcnt vmcnt(0)
    v_lshl_or_b32 v24, v33, 16, v32
    v_lshl_or_b32 v25, v35, 16, v34
    v_lshl_or_b32 v26, v37, 16, v36
    v_lshl_or_b32 v27, v39, 16, v38
    buffer_store_dwordx4 v[24:27], v6, s[24:27], 0 offen sc1
    s_branch fo_done
fo_wo:
    s_sub_u32 s32, s100, 224
    s_lshl_b32 s32, s32, 2
    s_add_u32 s32, s32, s3
    s_mov_b32 s33, 0x24924925
    s_mul_hi_u32 s33, s32, s33
    s_mul_i32 s34, s33, 7
    s_sub_u32 s34, s32, s34
    s_lshr_b32 s35, s33, 2
    s_and_b32 s36, s33, 3
    s_lshl_b32 s37, s34, 6
    v_add_u32 v5, s37, v2
    s_mul_i32 s37, s35, 28
    s_lshl_b32 s38, s36, 3
    s_add_u32 s37, s37, s38
    s_mul_i32 s37, s37, 896
    v_lshlrev_b32 v6, 1, v5
    v_add_u32 v6, s37, v6
    s_cmp_eq_u32 s36, 3
    s_cselect_b64 vcc, -1, 0
    v_cndmask_b32 v7, v6, v9, vcc
    s_movk_i32 s39, 3584
    buffer_load_ushort v32, v6, s[20:23], 0 offen offset:0
    buffer_load_ushort v33, v6, s[20:23], 0 offen offset:896
    buffer_load_ushort v34, v6, s[20:23], 0 offen offset:1792
    buffer_load_ushort v35, v6, s[20:23], 0 offen offset:2688
    buffer_load_ushort v36, v7, s[20:23], s39 offen offset:0
    buffer_load_ushort v37, v7, s[20:23], s39 offen offset:896
    buffer_load_ushort v38, v7, s[20:23], s39 offen offset:1792
    buffer_load_ushort v39, v7, s[20:23], s39 offen offset:2688
    v_lshlrev_b32 v8, 10, v5
    s_lshl_b32 s37, s33, 4
    v_add_u32 v8, s37, v8
    s_waitcnt vmcnt(0)
    v_lshl_or_b32 v24, v33, 16, v32
    v_lshl_or_b32 v25, v35, 16, v34
    v_lshl_or_b32 v26, v37, 16, v36
    v_lshl_or_b32 v27, v39, 16, v38
    buffer_store_dwordx4 v[24:27], v8, s[28:31], 0 offen sc1
fo_done:
    s_cmp_eq_u32 s93, 1
    s_cbranch_scc1 is_26
    s_mov_b32 s93, 1
    v_readfirstlane_b32 s74, v0
    s_nop 3
    s_cmp_lt_u32 s74, 64
    s_cbranch_scc0 is_26
    s_load_dwordx2 s[74:75], s[0:1], 96
    s_waitcnt lgkmcnt(0)
    s_mov_b32 s84, s74
    s_mov_b32 s85, s75
    s_mov_b32 s86, 0x100
    s_mov_b32 s87, 0x00020000
    v_mov_b32 v13, 8
    s_mov_b32 s74, 0
wc_27:
    buffer_load_dword v12, v13, s[84:87], 0 offen sc1
    s_add_u32 s74, s74, 1
    s_cmp_gt_u32 s74, 3000000
    s_cbranch_scc1 wk_done
    s_waitcnt vmcnt(0)
    v_readfirstlane_b32 s75, v12
    s_nop 3
    s_cmp_ge_u32 s75, 256
    s_cbranch_scc1 wc_27_ok
    s_sleep 8
    s_branch wc_27
wc_27_ok:
is_26:
    s_waitcnt vmcnt(0)
    s_barrier
    v_mov_b32 v12, 0
    s_lshl_b32 s74, s100, 2
    v_cmp_eq_u32 vcc, 0, v0
    s_and_b64 exec, exec, vcc
    buffer_store_dword v12, v12, s[96:99], s74 offen offset:1024 sc1
    s_mov_b64 exec, -1
    s_branch wk_loop
tk_a1:
    s_cmp_eq_u32 s93, 1
    s_cbranch_scc1 is_29
    s_mov_b32 s93, 1
    v_readfirstlane_b32 s74, v0
    s_nop 3
    s_cmp_lt_u32 s74, 64
    s_cbranch_scc0 is_29
    s_load_dwordx2 s[74:75], s[0:1], 96
    s_waitcnt lgkmcnt(0)
    s_mov_b32 s84, s74
    s_mov_b32 s85, s75
    s_mov_b32 s86, 0x100
    s_mov_b32 s87, 0x00020000
    v_mov_b32 v13, 8
    s_mov_b32 s74, 0
wc_30:
    buffer_load_dword v12, v13, s[84:87], 0 offen sc1
    s_add_u32 s74, s74, 1
    s_cmp_gt_u32 s74, 3000000
    s_cbranch_scc1 wk_done
    s_waitcnt vmcnt(0)
    v_readfirstlane_b32 s75, v12
    s_nop 3
    s_cmp_ge_u32 s75, 256
    s_cbranch_scc1 wc_30_ok
    s_sleep 8
    s_branch wc_30
wc_30_ok:
is_29:
    v_readfirstlane_b32 s74, v0
    s_nop 3
    s_cmp_lt_u32 s74, 64
    s_cbranch_scc0 fx_28
    v_and_b32 v20, 63, v0
    v_lshlrev_b32 v20, 4, v20
    v_add_u32 v20, 1024, v20
    s_mov_b32 s74, 0
    v_mov_b32 v12, 0
    v_mov_b32 v13, 0
    v_mov_b32 v14, 0
    v_mov_b32 v15, 0
    v_mov_b32 v16, 0
    v_mov_b32 v17, 0
    v_mov_b32 v18, 0
    v_mov_b32 v19, 0
fw_31:
    s_mov_b32 exec_lo, 0xffffffff
    s_mov_b32 exec_hi, 0xffffffff
    buffer_load_dwordx4 v[12:15], v20, s[96:99], 0 offen sc1
    s_mov_b32 exec_lo, 0xfffff
    s_mov_b32 exec_hi, 0x0
    buffer_load_dwordx4 v[16:19], v20, s[96:99], 0 offen offset:1024 sc1
    s_mov_b64 exec, -1
    s_add_u32 s74, s74, 1
    s_cmp_gt_u32 s74, 3000000
    s_cbranch_scc1 wk_done
    s_waitcnt vmcnt(0)
    v_max3_u32 v12, v12, v13, v14
    v_max3_u32 v16, v16, v17, v18
    v_max3_u32 v12, v12, v15, v19
    v_max_u32 v12, v12, v16
    v_cmp_eq_u32 vcc, -1, v12
    s_cbranch_vccz fw_31_ok
    s_sleep 8
    s_branch fw_31
fw_31_ok:
fx_28:
    s_barrier
    s_cmp_eq_u32 s93, 1
    s_cbranch_scc1 is_33
    s_mov_b32 s93, 1
    v_readfirstlane_b32 s74, v0
    s_nop 3
    s_cmp_lt_u32 s74, 64
    s_cbranch_scc0 is_33
    s_load_dwordx2 s[74:75], s[0:1], 96
    s_waitcnt lgkmcnt(0)
    s_mov_b32 s84, s74
    s_mov_b32 s85, s75
    s_mov_b32 s86, 0x100
    s_mov_b32 s87, 0x00020000
    v_mov_b32 v13, 8
    s_mov_b32 s74, 0
wc_34:
    buffer_load_dword v12, v13, s[84:87], 0 offen sc1
    s_add_u32 s74, s74, 1
    s_cmp_gt_u32 s74, 3000000
    s_cbranch_scc1 wk_done
    s_waitcnt vmcnt(0)
    v_readfirstlane_b32 s75, v12
    s_nop 3
    s_cmp_ge_u32 s75, 256
    s_cbranch_scc1 wc_34_ok
    s_sleep 8
    s_branch wc_34
wc_34_ok:
is_33:
    v_readfirstlane_b32 s74, v0
    s_nop 3
    s_cmp_lt_u32 s74, 64
    s_cbranch_scc0 fx_32
    v_and_b32 v20, 63, v0
    v_lshlrev_b32 v20, 4, v20
    v_add_u32 v20, 0, v20
    s_mov_b32 s74, 0
    v_mov_b32 v12, 0
    v_mov_b32 v13, 0
    v_mov_b32 v14, 0
    v_mov_b32 v15, 0
    v_mov_b32 v16, 0
    v_mov_b32 v17, 0
    v_mov_b32 v18, 0
    v_mov_b32 v19, 0
fw_35:
    s_mov_b32 exec_lo, 0xffffffff
    s_mov_b32 exec_hi, 0xffffff
    buffer_load_dwordx4 v[12:15], v20, s[96:99], 0 offen sc1
    s_mov_b64 exec, -1
    s_add_u32 s74, s74, 1
    s_cmp_gt_u32 s74, 3000000
    s_cbranch_scc1 wk_done
    s_waitcnt vmcnt(0)
    v_max3_u32 v12, v12, v13, v14
    v_max3_u32 v16, v16, v17, v18
    v_max3_u32 v12, v12, v15, v19
    v_max_u32 v12, v12, v16
    v_cmp_eq_u32 vcc, -1, v12
    s_cbranch_vccz fw_35_ok
    s_sleep 8
    s_branch fw_35
fw_35_ok:
fx_32:
    s_barrier
    s_load_dwordx2 s[4:5], s[0:1], 104
    s_load_dwordx2 s[6:7], s[0:1], 0
    v_lshrrev_b32 v1, 6, v0
    v_and_b32 v2, 63, v0
    s_nop 0
    v_readfirstlane_b32 s10, v1
    v_and_b32 v3, 31, v2
    v_lshrrev_b32 v4, 5, v2
    s_and_b32 s8, s100, 15
    s_lshr_b32 s9, s100, 4
    s_waitcnt lgkmcnt(0)
    s_mov_b32 s12, s6
    s_mov_b32 s13, s7
    s_mov_b32 s14, 0x1c0000
    s_mov_b32 s15, 0x00020000
    s_add_u32 s16, s4, 0x54e0000
    s_addc_u32 s17, s5, 0x0
    s_mov_b32 s18, 0x150000
    s_mov_b32 s19, 0x00020000
    s_add_u32 s20, s4, 0x5aa0000
    s_addc_u32 s21, s5, 0x0
    s_mov_b32 s22, 0x20000
    s_mov_b32 s23, 0x00020000
    s_lshl_b32 s11, s9, 2
    s_add_u32 s11, s11, s10
    s_lshl_b32 s11, s11, 5
    v_add_u32 v6, s11, v3
    v_mul_u32_u24 v6, 896, v6
    v_lshl_add_u32 v6, v4, 4, v6
    s_lshl_b32 s11, s8, 5
    s_add_u32 s11, s11, 512
    v_add_u32 v7, s11, v3
    v_mul_u32_u24 v7, 896, v7
    v_lshl_add_u32 v7, v4, 4, v7
    s_mov_b32 s24, 458752
    buffer_load_dwordx4 v[16:19], v6, s[12:15], 0 offen offset:0
    buffer_load_dwordx4 a[0:3], v7, s[16:19], 0 offen offset:0 sc1
    buffer_load_dwordx4 a[112:115], v7, s[16:19], s24 offen offset:0 sc1
    buffer_load_dwordx4 v[20:23], v6, s[12:15], 0 offen offset:32
    buffer_load_dwordx4 a[4:7], v7, s[16:19], 0 offen offset:32 sc1
    buffer_load_dwordx4 a[116:119], v7, s[16:19], s24 offen offset:32 sc1
    buffer_load_dwordx4 v[24:27], v6, s[12:15], 0 offen offset:64
    buffer_load_dwordx4 a[8:11], v7, s[16:19], 0 offen offset:64 sc1
    buffer_load_dwordx4 a[120:123], v7, s[16:19], s24 offen offset:64 sc1
    buffer_load_dwordx4 v[28:31], v6, s[12:15], 0 offen offset:96
    buffer_load_dwordx4 a[12:15], v7, s[16:19], 0 offen offset:96 sc1
    buffer_load_dwordx4 a[124:127], v7, s[16:19], s24 offen offset:96 sc1
    buffer_load_dwordx4 v[32:35], v6, s[12:15], 0 offen offset:128
    buffer_load_dwordx4 a[16:19], v7, s[16:19], 0 offen offset:128 sc1
    buffer_load_dwordx4 a[128:131], v7, s[16:19], s24 offen offset:128 sc1
    buffer_load_dwordx4 v[36:39], v6, s[12:15], 0 offen offset:160
    buffer_load_dwordx4 a[20:23], v7, s[16:19], 0 offen offset:160 sc1
    buffer_load_dwordx4 a[132:135], v7, s[16:19], s24 offen offset:160 sc1
    buffer_load_dwordx4 v[40:43], v6, s[12:15], 0 offen offset:192
    buffer_load_dwordx4 a[24:27], v7, s[16:19], 0 offen offset:192 sc1
    buffer_load_dwordx4 a[136:139], v7, s[16:19], s24 offen offset:192 sc1
    buffer_load_dwordx4 v[44:47], v6, s[12:15], 0 offen offset:224
    buffer_load_dwordx4 a[28:31], v7, s[16:19], 0 offen offset:224 sc1
    buffer_load_dwordx4 a[140:143], v7, s[16:19], s24 offen offset:224 sc1
    buffer_load_dwordx4 v[48:51], v6, s[12:15], 0 offen offset:256
    buffer_load_dwordx4 a[32:35], v7, s[16:19], 0 offen offset:256 sc1
    buffer_load_dwordx4 a[144:147], v7, s[16:19], s24 offen offset:256 sc1
    buffer_load_dwordx4 v[52:55], v6, s[12:15], 0 offen offset:288
    buffer_load_dwordx4 a[36:39], v7, s[16:19], 0 offen offset:288 sc1
    buffer_load_dwordx4 a[148:151], v7, s[16:19], s24 offen offset:288 sc1
    buffer_load_dwordx4 v[56:59], v6, s[12:15], 0 offen offset:320
    buffer_load_dwordx4 a[40:43], v7, s[16:19], 0 offen offset:320 sc1
    buffer_load_dwordx4 a[152:155], v7, s[16:19], s24 offen offset:320 sc1
    buffer_load_dwordx4 v[60:63], v6, s[12:15], 0 offen offset:352
    buffer_load_dwordx4 a[44:47], v7, s[16:19], 0 offen offset:352 sc1
    buffer_load_dwordx4 a[156:159], v7, s[16:19], s24 offen offset:352 sc1
    buffer_load_dwordx4 v[64:67], v6, s[12:15], 0 offen offset:384
    buffer_load_dwordx4 a[48:51], v7, s[16:19], 0 offen offset:384 sc1
    buffer_load_dwordx4 a[160:163], v7, s[16:19], s24 offen offset:384 sc1
    buffer_load_dwordx4 v[68:71], v6, s[12:15], 0 offen offset:416
    buffer_load_dwordx4 a[52:55], v7, s[16:19], 0 offen offset:416 sc1
    buffer_load_dwordx4 a[164:167], v7, s[16:19], s24 offen offset:416 sc1
    buffer_load_dwordx4 v[72:75], v6, s[12:15], 0 offen offset:448
    buffer_load_dwordx4 a[56:59], v7, s[16:19], 0 offen offset:448 sc1
    buffer_load_dwordx4 a[168:171], v7, s[16:19], s24 offen offset:448 sc1
    buffer_load_dwordx4 v[76:79], v6, s[12:15], 0 offen offset:480
    buffer_load_dwordx4 a[60:63], v7, s[16:19], 0 offen offset:480 sc1
    buffer_load_dwordx4 a[172:175], v7, s[16:19], s24 offen offset:480 sc1
    buffer_load_dwordx4 v[80:83], v6, s[12:15], 0 offen offset:512
    buffer_load_dwordx4 a[64:67], v7, s[16:19], 0 offen offset:512 sc1
    buffer_load_dwordx4 a[176:179], v7, s[16:19], s24 offen offset:512 sc1
    buffer_load_dwordx4 v[84:87], v6, s[12:15], 0 offen offset:544
    buffer_load_dwordx4 a[68:71], v7, s[16:19], 0 offen offset:544 sc1
    buffer_load_dwordx4 a[180:183], v7, s[16:19], s24 offen offset:544 sc1
    buffer_load_dwordx4 v[88:91], v6, s[12:15], 0 offen offset:576
    buffer_load_dwordx4 a[72:75], v7, s[16:19], 0 offen offset:576 sc1
    buffer_load_dwordx4 a[184:187], v7, s[16:19], s24 offen offset:576 sc1
    buffer_load_dwordx4 v[92:95], v6, s[12:15], 0 offen offset:608
    buffer_load_dwordx4 a[76:79], v7, s[16:19], 0 offen offset:608 sc1
    buffer_load_dwordx4 a[188:191], v7, s[16:19], s24 offen offset:608 sc1
    buffer_load_dwordx4 v[96:99], v6, s[12:15], 0 offen offset:640
    buffer_load_dwordx4 a[80:83], v7, s[16:19], 0 offen offset:640 sc1
    buffer_load_dwordx4 a[192:195], v7, s[16:19], s24 offen offset:640 sc1
    buffer_load_dwordx4 v[100:103], v6, s[12:15], 0 offen offset:672
    buffer_load_dwordx4 a[84:87], v7, s[16:19], 0 offen offset:672 sc1
    buffer_load_dwordx4 a[196:199], v7, s[16:19], s24 offen offset:672 sc1
    buffer_load_dwordx4 v[104:107], v6, s[12:15], 0 offen offset:704
    buffer_load_dwordx4 a[88:91], v7, s[16:19], 0 offen offset:704 sc1
    buffer_load_dwordx4 a[200:203], v7, s[16:19], s24 offen offset:704 sc1
    buffer_load_dwordx4 v[108:111], v6, s[12:15], 0 offen offset:736
    buffer_load_dwordx4 a[92:95], v7, s[16:19], 0 offen offset:736 sc1
    buffer_load_dwordx4 a[204:207], v7, s[16:19], s24 offen offset:736 sc1
    buffer_load_dwordx4 v[112:115], v6, s[12:15], 0 offen offset:768
    buffer_load_dwordx4 a[96:99], v7, s[16:19], 0 offen offset:768 sc1
    buffer_load_dwordx4 a[208:211], v7, s[16:19], s24 offen offset:768 sc1
    buffer_load_dwordx4 v[116:119], v6, s[12:15], 0 offen offset:800
    buffer_load_dwordx4 a[100:103], v7, s[16:19], 0 offen offset:800 sc1
    buffer_load_dwordx4 a[212:215], v7, s[16:19], s24 offen offset:800 sc1
    buffer_load_dwordx4 v[120:123], v6, s[12:15], 0 offen offset:832
    buffer_load_dwordx4 a[104:107], v7, s[16:19], 0 offen offset:832 sc1
    buffer_load_dwordx4 a[216:219], v7, s[16:19], s24 offen offset:832 sc1
    buffer_load_dwordx4 v[124:127], v6, s[12:15], 0 offen offset:864
    buffer_load_dwordx4 a[108:111], v7, s[16:19], 0 offen offset:864 sc1
    buffer_load_dwordx4 a[220:223], v7, s[16:19], s24 offen offset:864 sc1
    v_cmp_gt_u32 s[26:27], 28, v3
    v_cmp_eq_u32 s[28:29], 28, v3
    v_mov_b32 v8, 0xf149f2ca
    v_mov_b32 v9, 0x7149f2ca
    s_mov_b32 s30, 0x3fb8aa3b
    v_mov_b32 v10, 1.0
    v_mov_b32 v11, 0
    s_waitcnt vmcnt(63)
    v_mfma_f32_32x32x16_bf16 v[128:143], v[16:19], a[0:3], 0
    v_mfma_f32_32x32x16_bf16 v[144:159], v[16:19], a[112:115], 0
    v_mfma_f32_32x32x16_bf16 v[128:143], v[20:23], a[4:7], v[128:143]
    v_mfma_f32_32x32x16_bf16 v[144:159], v[20:23], a[116:119], v[144:159]
    v_mfma_f32_32x32x16_bf16 v[128:143], v[24:27], a[8:11], v[128:143]
    v_mfma_f32_32x32x16_bf16 v[144:159], v[24:27], a[120:123], v[144:159]
    v_mfma_f32_32x32x16_bf16 v[128:143], v[28:31], a[12:15], v[128:143]
    v_mfma_f32_32x32x16_bf16 v[144:159], v[28:31], a[124:127], v[144:159]
    s_waitcnt vmcnt(60)
    v_mfma_f32_32x32x16_bf16 v[128:143], v[32:35], a[16:19], v[128:143]
    v_mfma_f32_32x32x16_bf16 v[144:159], v[32:35], a[128:131], v[144:159]
    v_mfma_f32_32x32x16_bf16 v[128:143], v[36:39], a[20:23], v[128:143]
    v_mfma_f32_32x32x16_bf16 v[144:159], v[36:39], a[132:135], v[144:159]
    v_mfma_f32_32x32x16_bf16 v[128:143], v[40:43], a[24:27], v[128:143]
    v_mfma_f32_32x32x16_bf16 v[144:159], v[40:43], a[136:139], v[144:159]
    v_mfma_f32_32x32x16_bf16 v[128:143], v[44:47], a[28:31], v[128:143]
    v_mfma_f32_32x32x16_bf16 v[144:159], v[44:47], a[140:143], v[144:159]
    s_waitcnt vmcnt(48)
    v_mfma_f32_32x32x16_bf16 v[128:143], v[48:51], a[32:35], v[128:143]
    v_mfma_f32_32x32x16_bf16 v[144:159], v[48:51], a[144:147], v[144:159]
    v_mfma_f32_32x32x16_bf16 v[128:143], v[52:55], a[36:39], v[128:143]
    v_mfma_f32_32x32x16_bf16 v[144:159], v[52:55], a[148:151], v[144:159]
    v_mfma_f32_32x32x16_bf16 v[128:143], v[56:59], a[40:43], v[128:143]
    v_mfma_f32_32x32x16_bf16 v[144:159], v[56:59], a[152:155], v[144:159]
    v_mfma_f32_32x32x16_bf16 v[128:143], v[60:63], a[44:47], v[128:143]
    v_mfma_f32_32x32x16_bf16 v[144:159], v[60:63], a[156:159], v[144:159]
    s_waitcnt vmcnt(36)
    v_mfma_f32_32x32x16_bf16 v[128:143], v[64:67], a[48:51], v[128:143]
    v_mfma_f32_32x32x16_bf16 v[144:159], v[64:67], a[160:163], v[144:159]
    v_mfma_f32_32x32x16_bf16 v[128:143], v[68:71], a[52:55], v[128:143]
    v_mfma_f32_32x32x16_bf16 v[144:159], v[68:71], a[164:167], v[144:159]
    v_mfma_f32_32x32x16_bf16 v[128:143], v[72:75], a[56:59], v[128:143]
    v_mfma_f32_32x32x16_bf16 v[144:159], v[72:75], a[168:171], v[144:159]
    v_mfma_f32_32x32x16_bf16 v[128:143], v[76:79], a[60:63], v[128:143]
    v_mfma_f32_32x32x16_bf16 v[144:159], v[76:79], a[172:175], v[144:159]
    s_waitcnt vmcnt(24)
    v_mfma_f32_32x32x16_bf16 v[128:143], v[80:83], a[64:67], v[128:143]
    v_mfma_f32_32x32x16_bf16 v[144:159], v[80:83], a[176:179], v[144:159]
    v_mfma_f32_32x32x16_bf16 v[128:143], v[84:87], a[68:71], v[128:143]
    v_mfma_f32_32x32x16_bf16 v[144:159], v[84:87], a[180:183], v[144:159]
    v_mfma_f32_32x32x16_bf16 v[128:143], v[88:91], a[72:75], v[128:143]
    v_mfma_f32_32x32x16_bf16 v[144:159], v[88:91], a[184:187], v[144:159]
    v_mfma_f32_32x32x16_bf16 v[128:143], v[92:95], a[76:79], v[128:143]
    v_mfma_f32_32x32x16_bf16 v[144:159], v[92:95], a[188:191], v[144:159]
    s_waitcnt vmcnt(12)
    v_mfma_f32_32x32x16_bf16 v[128:143], v[96:99], a[80:83], v[128:143]
    v_mfma_f32_32x32x16_bf16 v[144:159], v[96:99], a[192:195], v[144:159]
    v_mfma_f32_32x32x16_bf16 v[128:143], v[100:103], a[84:87], v[128:143]
    v_mfma_f32_32x32x16_bf16 v[144:159], v[100:103], a[196:199], v[144:159]
    v_mfma_f32_32x32x16_bf16 v[128:143], v[104:107], a[88:91], v[128:143]
    v_mfma_f32_32x32x16_bf16 v[144:159], v[104:107], a[200:203], v[144:159]
    v_mfma_f32_32x32x16_bf16 v[128:143], v[108:111], a[92:95], v[128:143]
    v_mfma_f32_32x32x16_bf16 v[144:159], v[108:111], a[204:207], v[144:159]
    s_waitcnt vmcnt(0)
    v_mfma_f32_32x32x16_bf16 v[128:143], v[112:115], a[96:99], v[128:143]
    v_mfma_f32_32x32x16_bf16 v[144:159], v[112:115], a[208:211], v[144:159]
    v_mfma_f32_32x32x16_bf16 v[128:143], v[116:119], a[100:103], v[128:143]
    v_mfma_f32_32x32x16_bf16 v[144:159], v[116:119], a[212:215], v[144:159]
    v_mfma_f32_32x32x16_bf16 v[128:143], v[120:123], a[104:107], v[128:143]
    v_mfma_f32_32x32x16_bf16 v[144:159], v[120:123], a[216:219], v[144:159]
    v_mfma_f32_32x32x16_bf16 v[128:143], v[124:127], a[108:111], v[128:143]
    v_mfma_f32_32x32x16_bf16 v[144:159], v[124:127], a[220:223], v[144:159]
    s_nop 15
    s_nop 1
    v_cndmask_b32_e64 v160, v8, v128, s[26:27]
    v_cndmask_b32_e64 v176, v9, v128, s[26:27]
    v_cndmask_b32_e64 v161, v8, v129, s[26:27]
    v_cndmask_b32_e64 v177, v9, v129, s[26:27]
    v_cndmask_b32_e64 v162, v8, v130, s[26:27]
    v_cndmask_b32_e64 v178, v9, v130, s[26:27]
    v_cndmask_b32_e64 v163, v8, v131, s[26:27]
    v_cndmask_b32_e64 v179, v9, v131, s[26:27]
    v_cndmask_b32_e64 v164, v8, v132, s[26:27]
    v_cndmask_b32_e64 v180, v9, v132, s[26:27]
    v_cndmask_b32_e64 v165, v8, v133, s[26:27]
    v_cndmask_b32_e64 v181, v9, v133, s[26:27]
    v_cndmask_b32_e64 v166, v8, v134, s[26:27]
    v_cndmask_b32_e64 v182, v9, v134, s[26:27]
    v_cndmask_b32_e64 v167, v8, v135, s[26:27]
    v_cndmask_b32_e64 v183, v9, v135, s[26:27]
    v_cndmask_b32_e64 v168, v8, v136, s[26:27]
    v_cndmask_b32_e64 v184, v9, v136, s[26:27]
    v_cndmask_b32_e64 v169, v8, v137, s[26:27]
    v_cndmask_b32_e64 v185, v9, v137, s[26:27]
    v_cndmask_b32_e64 v170, v8, v138, s[26:27]
    v_cndmask_b32_e64 v186, v9, v138, s[26:27]
    v_cndmask_b32_e64 v171, v8, v139, s[26:27]
    v_cndmask_b32_e64 v187, v9, v139, s[26:27]
    v_cndmask_b32_e64 v172, v8, v140, s[26:27]
    v_cndmask_b32_e64 v188, v9, v140, s[26:27]
    v_cndmask_b32_e64 v173, v8, v141, s[26:27]
    v_cndmask_b32_e64 v189, v9, v141, s[26:27]
    v_cndmask_b32_e64 v174, v8, v142, s[26:27]
    v_cndmask_b32_e64 v190, v9, v142, s[26:27]
    v_cndmask_b32_e64 v175, v8, v143, s[26:27]
    v_cndmask_b32_e64 v191, v9, v143, s[26:27]
    v_max_f32_dpp v160, v160, v160 row_ror:8 row_mask:0xf bank_mask:0xf
    v_max_f32_dpp v161, v161, v161 row_ror:8 row_mask:0xf bank_mask:0xf
    v_max_f32_dpp v162, v162, v162 row_ror:8 row_mask:0xf bank_mask:0xf
    v_max_f32_dpp v163, v163, v163 row_ror:8 row_mask:0xf bank_mask:0xf
    v_max_f32_dpp v164, v164, v164 row_ror:8 row_mask:0xf bank_mask:0xf
    v_max_f32_dpp v165, v165, v165 row_ror:8 row_mask:0xf bank_mask:0xf
    v_max_f32_dpp v166, v166, v166 row_ror:8 row_mask:0xf bank_mask:0xf
    v_max_f32_dpp v167, v167, v167 row_ror:8 row_mask:0xf bank_mask:0xf
    v_max_f32_dpp v168, v168, v168 row_ror:8 row_mask:0xf bank_mask:0xf
    v_max_f32_dpp v169, v169, v169 row_ror:8 row_mask:0xf bank_mask:0xf
    v_max_f32_dpp v170, v170, v170 row_ror:8 row_mask:0xf bank_mask:0xf
    v_max_f32_dpp v171, v171, v171 row_ror:8 row_mask:0xf bank_mask:0xf
    v_max_f32_dpp v172, v172, v172 row_ror:8 row_mask:0xf bank_mask:0xf
    v_max_f32_dpp v173, v173, v173 row_ror:8 row_mask:0xf bank_mask:0xf
    v_max_f32_dpp v174, v174, v174 row_ror:8 row_mask:0xf bank_mask:0xf
    v_max_f32_dpp v175, v175, v175 row_ror:8 row_mask:0xf bank_mask:0xf
    v_max_f32_dpp v160, v160, v160 row_ror:4 row_mask:0xf bank_mask:0xf
    v_max_f32_dpp v161, v161, v161 row_ror:4 row_mask:0xf bank_mask:0xf
    v_max_f32_dpp v162, v162, v162 row_ror:4 row_mask:0xf bank_mask:0xf
    v_max_f32_dpp v163, v163, v163 row_ror:4 row_mask:0xf bank_mask:0xf
    v_max_f32_dpp v164, v164, v164 row_ror:4 row_mask:0xf bank_mask:0xf
    v_max_f32_dpp v165, v165, v165 row_ror:4 row_mask:0xf bank_mask:0xf
    v_max_f32_dpp v166, v166, v166 row_ror:4 row_mask:0xf bank_mask:0xf
    v_max_f32_dpp v167, v167, v167 row_ror:4 row_mask:0xf bank_mask:0xf
    v_max_f32_dpp v168, v168, v168 row_ror:4 row_mask:0xf bank_mask:0xf
    v_max_f32_dpp v169, v169, v169 row_ror:4 row_mask:0xf bank_mask:0xf
    v_max_f32_dpp v170, v170, v170 row_ror:4 row_mask:0xf bank_mask:0xf
    v_max_f32_dpp v171, v171, v171 row_ror:4 row_mask:0xf bank_mask:0xf
    v_max_f32_dpp v172, v172, v172 row_ror:4 row_mask:0xf bank_mask:0xf
    v_max_f32_dpp v173, v173, v173 row_ror:4 row_mask:0xf bank_mask:0xf
    v_max_f32_dpp v174, v174, v174 row_ror:4 row_mask:0xf bank_mask:0xf
    v_max_f32_dpp v175, v175, v175 row_ror:4 row_mask:0xf bank_mask:0xf
    v_max_f32_dpp v160, v160, v160 row_ror:2 row_mask:0xf bank_mask:0xf
    v_max_f32_dpp v161, v161, v161 row_ror:2 row_mask:0xf bank_mask:0xf
    v_max_f32_dpp v162, v162, v162 row_ror:2 row_mask:0xf bank_mask:0xf
    v_max_f32_dpp v163, v163, v163 row_ror:2 row_mask:0xf bank_mask:0xf
    v_max_f32_dpp v164, v164, v164 row_ror:2 row_mask:0xf bank_mask:0xf
    v_max_f32_dpp v165, v165, v165 row_ror:2 row_mask:0xf bank_mask:0xf
    v_max_f32_dpp v166, v166, v166 row_ror:2 row_mask:0xf bank_mask:0xf
    v_max_f32_dpp v167, v167, v167 row_ror:2 row_mask:0xf bank_mask:0xf
    v_max_f32_dpp v168, v168, v168 row_ror:2 row_mask:0xf bank_mask:0xf
    v_max_f32_dpp v169, v169, v169 row_ror:2 row_mask:0xf bank_mask:0xf
    v_max_f32_dpp v170, v170, v170 row_ror:2 row_mask:0xf bank_mask:0xf
    v_max_f32_dpp v171, v171, v171 row_ror:2 row_mask:0xf bank_mask:0xf
    v_max_f32_dpp v172, v172, v172 row_ror:2 row_mask:0xf bank_mask:0xf
    v_max_f32_dpp v173, v173, v173 row_ror:2 row_mask:0xf bank_mask:0xf
    v_max_f32_dpp v174, v174, v174 row_ror:2 row_mask:0xf bank_mask:0xf
    v_max_f32_dpp v175, v175, v175 row_ror:2 row_mask:0xf bank_mask:0xf
    v_max_f32_dpp v160, v160, v160 row_ror:1 row_mask:0xf bank_mask:0xf
    v_max_f32_dpp v161, v161, v161 row_ror:1 row_mask:0xf bank_mask:0xf
    v_max_f32_dpp v162, v162, v162 row_ror:1 row_mask:0xf bank_mask:0xf
    v_max_f32_dpp v163, v163, v163 row_ror:1 row_mask:0xf bank_mask:0xf
    v_max_f32_dpp v164, v164, v164 row_ror:1 row_mask:0xf bank_mask:0xf
    v_max_f32_dpp v165, v165, v165 row_ror:1 row_mask:0xf bank_mask:0xf
    v_max_f32_dpp v166, v166, v166 row_ror:1 row_mask:0xf bank_mask:0xf
    v_max_f32_dpp v167, v167, v167 row_ror:1 row_mask:0xf bank_mask:0xf
    v_max_f32_dpp v168, v168, v168 row_ror:1 row_mask:0xf bank_mask:0xf
    v_max_f32_dpp v169, v169, v169 row_ror:1 row_mask:0xf bank_mask:0xf
    v_max_f32_dpp v170, v170, v170 row_ror:1 row_mask:0xf bank_mask:0xf
    v_max_f32_dpp v171, v171, v171 row_ror:1 row_mask:0xf bank_mask:0xf
    v_max_f32_dpp v172, v172, v172 row_ror:1 row_mask:0xf bank_mask:0xf
    v_max_f32_dpp v173, v173, v173 row_ror:1 row_mask:0xf bank_mask:0xf
    v_max_f32_dpp v174, v174, v174 row_ror:1 row_mask:0xf bank_mask:0xf
    v_max_f32_dpp v175, v175, v175 row_ror:1 row_mask:0xf bank_mask:0xf
    v_mov_b32 v192, v160
    v_mov_b32 v193, v161
    v_mov_b32 v194, v162
    v_mov_b32 v195, v163
    v_mov_b32 v196, v164
    v_mov_b32 v197, v165
    v_mov_b32 v198, v166
    v_mov_b32 v199, v167
    v_mov_b32 v200, v168
    v_mov_b32 v201, v169
    v_mov_b32 v202, v170
    v_mov_b32 v203, v171
    v_mov_b32 v204, v172
    v_mov_b32 v205, v173
    v_mov_b32 v206, v174
    v_mov_b32 v207, v175
    v_permlane16_swap_b32 v160, v192
    v_permlane16_swap_b32 v161, v193
    v_permlane16_swap_b32 v162, v194
    v_permlane16_swap_b32 v163, v195
    v_permlane16_swap_b32 v164, v196
    v_permlane16_swap_b32 v165, v197
    v_permlane16_swap_b32 v166, v198
    v_permlane16_swap_b32 v167, v199
    v_permlane16_swap_b32 v168, v200
    v_permlane16_swap_b32 v169, v201
    v_permlane16_swap_b32 v170, v202
    v_permlane16_swap_b32 v171, v203
    v_permlane16_swap_b32 v172, v204
    v_permlane16_swap_b32 v173, v205
    v_permlane16_swap_b32 v174, v206
    v_permlane16_swap_b32 v175, v207
    v_max_f32 v160, v160, v192
    v_max_f32 v161, v161, v193
    v_max_f32 v162, v162, v194
    v_max_f32 v163, v163, v195
    v_max_f32 v164, v164, v196
    v_max_f32 v165, v165, v197
    v_max_f32 v166, v166, v198
    v_max_f32 v167, v167, v199
    v_max_f32 v168, v168, v200
    v_max_f32 v169, v169, v201
    v_max_f32 v170, v170, v202
    v_max_f32 v171, v171, v203
    v_max_f32 v172, v172, v204
    v_max_f32 v173, v173, v205
    v_max_f32 v174, v174, v206
    v_max_f32 v175, v175, v207
    v_min_f32_dpp v176, v176, v176 row_ror:8 row_mask:0xf bank_mask:0xf
    v_min_f32_dpp v177, v177, v177 row_ror:8 row_mask:0xf bank_mask:0xf
    v_min_f32_dpp v178, v178, v178 row_ror:8 row_mask:0xf bank_mask:0xf
    v_min_f32_dpp v179, v179, v179 row_ror:8 row_mask:0xf bank_mask:0xf
    v_min_f32_dpp v180, v180, v180 row_ror:8 row_mask:0xf bank_mask:0xf
    v_min_f32_dpp v181, v181, v181 row_ror:8 row_mask:0xf bank_mask:0xf
    v_min_f32_dpp v182, v182, v182 row_ror:8 row_mask:0xf bank_mask:0xf
    v_min_f32_dpp v183, v183, v183 row_ror:8 row_mask:0xf bank_mask:0xf
    v_min_f32_dpp v184, v184, v184 row_ror:8 row_mask:0xf bank_mask:0xf
    v_min_f32_dpp v185, v185, v185 row_ror:8 row_mask:0xf bank_mask:0xf
    v_min_f32_dpp v186, v186, v186 row_ror:8 row_mask:0xf bank_mask:0xf
    v_min_f32_dpp v187, v187, v187 row_ror:8 row_mask:0xf bank_mask:0xf
    v_min_f32_dpp v188, v188, v188 row_ror:8 row_mask:0xf bank_mask:0xf
    v_min_f32_dpp v189, v189, v189 row_ror:8 row_mask:0xf bank_mask:0xf
    v_min_f32_dpp v190, v190, v190 row_ror:8 row_mask:0xf bank_mask:0xf
    v_min_f32_dpp v191, v191, v191 row_ror:8 row_mask:0xf bank_mask:0xf
    v_min_f32_dpp v176, v176, v176 row_ror:4 row_mask:0xf bank_mask:0xf
    v_min_f32_dpp v177, v177, v177 row_ror:4 row_mask:0xf bank_mask:0xf
    v_min_f32_dpp v178, v178, v178 row_ror:4 row_mask:0xf bank_mask:0xf
    v_min_f32_dpp v179, v179, v179 row_ror:4 row_mask:0xf bank_mask:0xf
    v_min_f32_dpp v180, v180, v180 row_ror:4 row_mask:0xf bank_mask:0xf
    v_min_f32_dpp v181, v181, v181 row_ror:4 row_mask:0xf bank_mask:0xf
    v_min_f32_dpp v182, v182, v182 row_ror:4 row_mask:0xf bank_mask:0xf
    v_min_f32_dpp v183, v183, v183 row_ror:4 row_mask:0xf bank_mask:0xf
    v_min_f32_dpp v184, v184, v184 row_ror:4 row_mask:0xf bank_mask:0xf
    v_min_f32_dpp v185, v185, v185 row_ror:4 row_mask:0xf bank_mask:0xf
    v_min_f32_dpp v186, v186, v186 row_ror:4 row_mask:0xf bank_mask:0xf
    v_min_f32_dpp v187, v187, v187 row_ror:4 row_mask:0xf bank_mask:0xf
    v_min_f32_dpp v188, v188, v188 row_ror:4 row_mask:0xf bank_mask:0xf
    v_min_f32_dpp v189, v189, v189 row_ror:4 row_mask:0xf bank_mask:0xf
    v_min_f32_dpp v190, v190, v190 row_ror:4 row_mask:0xf bank_mask:0xf
    v_min_f32_dpp v191, v191, v191 row_ror:4 row_mask:0xf bank_mask:0xf
    v_min_f32_dpp v176, v176, v176 row_ror:2 row_mask:0xf bank_mask:0xf
    v_min_f32_dpp v177, v177, v177 row_ror:2 row_mask:0xf bank_mask:0xf
    v_min_f32_dpp v178, v178, v178 row_ror:2 row_mask:0xf bank_mask:0xf
    v_min_f32_dpp v179, v179, v179 row_ror:2 row_mask:0xf bank_mask:0xf
    v_min_f32_dpp v180, v180, v180 row_ror:2 row_mask:0xf bank_mask:0xf
    v_min_f32_dpp v181, v181, v181 row_ror:2 row_mask:0xf bank_mask:0xf
    v_min_f32_dpp v182, v182, v182 row_ror:2 row_mask:0xf bank_mask:0xf
    v_min_f32_dpp v183, v183, v183 row_ror:2 row_mask:0xf bank_mask:0xf
    v_min_f32_dpp v184, v184, v184 row_ror:2 row_mask:0xf bank_mask:0xf
    v_min_f32_dpp v185, v185, v185 row_ror:2 row_mask:0xf bank_mask:0xf
    v_min_f32_dpp v186, v186, v186 row_ror:2 row_mask:0xf bank_mask:0xf
    v_min_f32_dpp v187, v187, v187 row_ror:2 row_mask:0xf bank_mask:0xf
    v_min_f32_dpp v188, v188, v188 row_ror:2 row_mask:0xf bank_mask:0xf
    v_min_f32_dpp v189, v189, v189 row_ror:2 row_mask:0xf bank_mask:0xf
    v_min_f32_dpp v190, v190, v190 row_ror:2 row_mask:0xf bank_mask:0xf
    v_min_f32_dpp v191, v191, v191 row_ror:2 row_mask:0xf bank_mask:0xf
    v_min_f32_dpp v176, v176, v176 row_ror:1 row_mask:0xf bank_mask:0xf
    v_min_f32_dpp v177, v177, v177 row_ror:1 row_mask:0xf bank_mask:0xf
    v_min_f32_dpp v178, v178, v178 row_ror:1 row_mask:0xf bank_mask:0xf
    v_min_f32_dpp v179, v179, v179 row_ror:1 row_mask:0xf bank_mask:0xf
    v_min_f32_dpp v180, v180, v180 row_ror:1 row_mask:0xf bank_mask:0xf
    v_min_f32_dpp v181, v181, v181 row_ror:1 row_mask:0xf bank_mask:0xf
    v_min_f32_dpp v182, v182, v182 row_ror:1 row_mask:0xf bank_mask:0xf
    v_min_f32_dpp v183, v183, v183 row_ror:1 row_mask:0xf bank_mask:0xf
    v_min_f32_dpp v184, v184, v184 row_ror:1 row_mask:0xf bank_mask:0xf
    v_min_f32_dpp v185, v185, v185 row_ror:1 row_mask:0xf bank_mask:0xf
    v_min_f32_dpp v186, v186, v186 row_ror:1 row_mask:0xf bank_mask:0xf
    v_min_f32_dpp v187, v187, v187 row_ror:1 row_mask:0xf bank_mask:0xf
    v_min_f32_dpp v188, v188, v188 row_ror:1 row_mask:0xf bank_mask:0xf
    v_min_f32_dpp v189, v189, v189 row_ror:1 row_mask:0xf bank_mask:0xf
    v_min_f32_dpp v190, v190, v190 row_ror:1 row_mask:0xf bank_mask:0xf
    v_min_f32_dpp v191, v191, v191 row_ror:1 row_mask:0xf bank_mask:0xf
    v_mov_b32 v192, v176
    v_mov_b32 v193, v177
    v_mov_b32 v194, v178
    v_mov_b32 v195, v179
    v_mov_b32 v196, v180
    v_mov_b32 v197, v181
    v_mov_b32 v198, v182
    v_mov_b32 v199, v183
    v_mov_b32 v200, v184
    v_mov_b32 v201, v185
    v_mov_b32 v202, v186
    v_mov_b32 v203, v187
    v_mov_b32 v204, v188
    v_mov_b32 v205, v189
    v_mov_b32 v206, v190
    v_mov_b32 v207, v191
    v_permlane16_swap_b32 v176, v192
    v_permlane16_swap_b32 v177, v193
    v_permlane16_swap_b32 v178, v194
    v_permlane16_swap_b32 v179, v195
    v_permlane16_swap_b32 v180, v196
    v_permlane16_swap_b32 v181, v197
    v_permlane16_swap_b32 v182, v198
    v_permlane16_swap_b32 v183, v199
    v_permlane16_swap_b32 v184, v200
    v_permlane16_swap_b32 v185, v201
    v_permlane16_swap_b32 v186, v202
    v_permlane16_swap_b32 v187, v203
    v_permlane16_swap_b32 v188, v204
    v_permlane16_swap_b32 v189, v205
    v_permlane16_swap_b32 v190, v206
    v_permlane16_swap_b32 v191, v207
    v_min_f32 v176, v176, v192
    v_min_f32 v177, v177, v193
    v_min_f32 v178, v178, v194
    v_min_f32 v179, v179, v195
    v_min_f32 v180, v180, v196
    v_min_f32 v181, v181, v197
    v_min_f32 v182, v182, v198
    v_min_f32 v183, v183, v199
    v_min_f32 v184, v184, v200
    v_min_f32 v185, v185, v201
    v_min_f32 v186, v186, v202
    v_min_f32 v187, v187, v203
    v_min_f32 v188, v188, v204
    v_min_f32 v189, v189, v205
    v_min_f32 v190, v190, v206
    v_min_f32 v191, v191, v207
    v_sub_f32 v208, v128, v160
    v_sub_f32 v224, v176, v128
    v_sub_f32 v209, v129, v161
    v_sub_f32 v225, v177, v129
    v_sub_f32 v210, v130, v162
    v_sub_f32 v226, v178, v130
    v_sub_f32 v211, v131, v163
    v_sub_f32 v227, v179, v131
    v_sub_f32 v212, v132, v164
    v_sub_f32 v228, v180, v132
    v_sub_f32 v213, v133, v165
    v_sub_f32 v229, v181, v133
    v_sub_f32 v214, v134, v166
    v_sub_f32 v230, v182, v134
    v_sub_f32 v215, v135, v167
    v_sub_f32 v231, v183, v135
    v_sub_f32 v216, v136, v168
    v_sub_f32 v232, v184, v136
    v_sub_f32 v217, v137, v169
    v_sub_f32 v233, v185, v137
    v_sub_f32 v218, v138, v170
    v_sub_f32 v234, v186, v138
    v_sub_f32 v219, v139, v171
    v_sub_f32 v235, v187, v139
    v_sub_f32 v220, v140, v172
    v_sub_f32 v236, v188, v140
    v_sub_f32 v221, v141, v173
    v_sub_f32 v237, v189, v141
    v_sub_f32 v222, v142, v174
    v_sub_f32 v238, v190, v142
    v_sub_f32 v223, v143, v175
    v_sub_f32 v239, v191, v143
    v_mul_f32 v208, s30, v208
    v_mul_f32 v224, s30, v224
    v_mul_f32 v209, s30, v209
    v_mul_f32 v225, s30, v225
    v_mul_f32 v210, s30, v210
    v_mul_f32 v226, s30, v226
    v_mul_f32 v211, s30, v211
    v_mul_f32 v227, s30, v227
    v_mul_f32 v212, s30, v212
    v_mul_f32 v228, s30, v228
    v_mul_f32 v213, s30, v213
    v_mul_f32 v229, s30, v229
    v_mul_f32 v214, s30, v214
    v_mul_f32 v230, s30, v230
    v_mul_f32 v215, s30, v215
    v_mul_f32 v231, s30, v231
    v_mul_f32 v216, s30, v216
    v_mul_f32 v232, s30, v232
    v_mul_f32 v217, s30, v217
    v_mul_f32 v233, s30, v233
    v_mul_f32 v218, s30, v218
    v_mul_f32 v234, s30, v234
    v_mul_f32 v219, s30, v219
    v_mul_f32 v235, s30, v235
    v_mul_f32 v220, s30, v220
    v_mul_f32 v236, s30, v236
    v_mul_f32 v221, s30, v221
    v_mul_f32 v237, s30, v237
    v_mul_f32 v222, s30, v222
    v_mul_f32 v238, s30, v238
    v_mul_f32 v223, s30, v223
    v_mul_f32 v239, s30, v239
    v_exp_f32 v208, v208
    v_exp_f32 v224, v224
    v_exp_f32 v209, v209
    v_exp_f32 v225, v225
    v_exp_f32 v210, v210
    v_exp_f32 v226, v226
    v_exp_f32 v211, v211
    v_exp_f32 v227, v227
    v_exp_f32 v212, v212
    v_exp_f32 v228, v228
    v_exp_f32 v213, v213
    v_exp_f32 v229, v229
    v_exp_f32 v214, v214
    v_exp_f32 v230, v230
    v_exp_f32 v215, v215
    v_exp_f32 v231, v231
    v_exp_f32 v216, v216
    v_exp_f32 v232, v232
    v_exp_f32 v217, v217
    v_exp_f32 v233, v233
    v_exp_f32 v218, v218
    v_exp_f32 v234, v234
    v_exp_f32 v219, v219
    v_exp_f32 v235, v235
    v_exp_f32 v220, v220
    v_exp_f32 v236, v236
    v_exp_f32 v221, v221
    v_exp_f32 v237, v237
    v_exp_f32 v222, v222
    v_exp_f32 v238, v238
    v_exp_f32 v223, v223
    v_exp_f32 v239, v239
    v_cndmask_b32_e64 v208, v11, v208, s[26:27]
    v_cndmask_b32_e64 v224, v11, v224, s[26:27]
    v_cndmask_b32_e64 v209, v11, v209, s[26:27]
    v_cndmask_b32_e64 v225, v11, v225, s[26:27]
    v_cndmask_b32_e64 v210, v11, v210, s[26:27]
    v_cndmask_b32_e64 v226, v11, v226, s[26:27]
    v_cndmask_b32_e64 v211, v11, v211, s[26:27]
    v_cndmask_b32_e64 v227, v11, v227, s[26:27]
    v_cndmask_b32_e64 v212, v11, v212, s[26:27]
    v_cndmask_b32_e64 v228, v11, v228, s[26:27]
    v_cndmask_b32_e64 v213, v11, v213, s[26:27]
    v_cndmask_b32_e64 v229, v11, v229, s[26:27]
    v_cndmask_b32_e64 v214, v11, v214, s[26:27]
    v_cndmask_b32_e64 v230, v11, v230, s[26:27]
    v_cndmask_b32_e64 v215, v11, v215, s[26:27]
    v_cndmask_b32_e64 v231, v11, v231, s[26:27]
    v_cndmask_b32_e64 v216, v11, v216, s[26:27]
    v_cndmask_b32_e64 v232, v11, v232, s[26:27]
    v_cndmask_b32_e64 v217, v11, v217, s[26:27]
    v_cndmask_b32_e64 v233, v11, v233, s[26:27]
    v_cndmask_b32_e64 v218, v11, v218, s[26:27]
    v_cndmask_b32_e64 v234, v11, v234, s[26:27]
    v_cndmask_b32_e64 v219, v11, v219, s[26:27]
    v_cndmask_b32_e64 v235, v11, v235, s[26:27]
    v_cndmask_b32_e64 v220, v11, v220, s[26:27]
    v_cndmask_b32_e64 v236, v11, v236, s[26:27]
    v_cndmask_b32_e64 v221, v11, v221, s[26:27]
    v_cndmask_b32_e64 v237, v11, v237, s[26:27]
    v_cndmask_b32_e64 v222, v11, v222, s[26:27]
    v_cndmask_b32_e64 v238, v11, v238, s[26:27]
    v_cndmask_b32_e64 v223, v11, v223, s[26:27]
    v_cndmask_b32_e64 v239, v11, v239, s[26:27]
    v_mov_b32 v160, v208
    v_mov_b32 v176, v224
    v_mov_b32 v161, v209
    v_mov_b32 v177, v225
    v_mov_b32 v162, v210
    v_mov_b32 v178, v226
    v_mov_b32 v163, v211
    v_mov_b32 v179, v227
    v_mov_b32 v164, v212
    v_mov_b32 v180, v228
    v_mov_b32 v165, v213
    v_mov_b32 v181, v229
    v_mov_b32 v166, v214
    v_mov_b32 v182, v230
    v_mov_b32 v167, v215
    v_mov_b32 v183, v231
    v_mov_b32 v168, v216
    v_mov_b32 v184, v232
    v_mov_b32 v169, v217
    v_mov_b32 v185, v233
    v_mov_b32 v170, v218
    v_mov_b32 v186, v234
    v_mov_b32 v171, v219
    v_mov_b32 v187, v235
    v_mov_b32 v172, v220
    v_mov_b32 v188, v236
    v_mov_b32 v173, v221
    v_mov_b32 v189, v237
    v_mov_b32 v174, v222
    v_mov_b32 v190, v238
    v_mov_b32 v175, v223
    v_mov_b32 v191, v239
    v_add_f32_dpp v160, v160, v160 row_ror:8 row_mask:0xf bank_mask:0xf
    v_add_f32_dpp v161, v161, v161 row_ror:8 row_mask:0xf bank_mask:0xf
    v_add_f32_dpp v162, v162, v162 row_ror:8 row_mask:0xf bank_mask:0xf
    v_add_f32_dpp v163, v163, v163 row_ror:8 row_mask:0xf bank_mask:0xf
    v_add_f32_dpp v164, v164, v164 row_ror:8 row_mask:0xf bank_mask:0xf
    v_add_f32_dpp v165, v165, v165 row_ror:8 row_mask:0xf bank_mask:0xf
    v_add_f32_dpp v166, v166, v166 row_ror:8 row_mask:0xf bank_mask:0xf
    v_add_f32_dpp v167, v167, v167 row_ror:8 row_mask:0xf bank_mask:0xf
    v_add_f32_dpp v168, v168, v168 row_ror:8 row_mask:0xf bank_mask:0xf
    v_add_f32_dpp v169, v169, v169 row_ror:8 row_mask:0xf bank_mask:0xf
    v_add_f32_dpp v170, v170, v170 row_ror:8 row_mask:0xf bank_mask:0xf
    v_add_f32_dpp v171, v171, v171 row_ror:8 row_mask:0xf bank_mask:0xf
    v_add_f32_dpp v172, v172, v172 row_ror:8 row_mask:0xf bank_mask:0xf
    v_add_f32_dpp v173, v173, v173 row_ror:8 row_mask:0xf bank_mask:0xf
    v_add_f32_dpp v174, v174, v174 row_ror:8 row_mask:0xf bank_mask:0xf
    v_add_f32_dpp v175, v175, v175 row_ror:8 row_mask:0xf bank_mask:0xf
    v_add_f32_dpp v160, v160, v160 row_ror:4 row_mask:0xf bank_mask:0xf
    v_add_f32_dpp v161, v161, v161 row_ror:4 row_mask:0xf bank_mask:0xf
    v_add_f32_dpp v162, v162, v162 row_ror:4 row_mask:0xf bank_mask:0xf
    v_add_f32_dpp v163, v163, v163 row_ror:4 row_mask:0xf bank_mask:0xf
    v_add_f32_dpp v164, v164, v164 row_ror:4 row_mask:0xf bank_mask:0xf
    v_add_f32_dpp v165, v165, v165 row_ror:4 row_mask:0xf bank_mask:0xf
    v_add_f32_dpp v166, v166, v166 row_ror:4 row_mask:0xf bank_mask:0xf
    v_add_f32_dpp v167, v167, v167 row_ror:4 row_mask:0xf bank_mask:0xf
    v_add_f32_dpp v168, v168, v168 row_ror:4 row_mask:0xf bank_mask:0xf
    v_add_f32_dpp v169, v169, v169 row_ror:4 row_mask:0xf bank_mask:0xf
    v_add_f32_dpp v170, v170, v170 row_ror:4 row_mask:0xf bank_mask:0xf
    v_add_f32_dpp v171, v171, v171 row_ror:4 row_mask:0xf bank_mask:0xf
    v_add_f32_dpp v172, v172, v172 row_ror:4 row_mask:0xf bank_mask:0xf
    v_add_f32_dpp v173, v173, v173 row_ror:4 row_mask:0xf bank_mask:0xf
    v_add_f32_dpp v174, v174, v174 row_ror:4 row_mask:0xf bank_mask:0xf
    v_add_f32_dpp v175, v175, v175 row_ror:4 row_mask:0xf bank_mask:0xf
    v_add_f32_dpp v160, v160, v160 row_ror:2 row_mask:0xf bank_mask:0xf
    v_add_f32_dpp v161, v161, v161 row_ror:2 row_mask:0xf bank_mask:0xf
    v_add_f32_dpp v162, v162, v162 row_ror:2 row_mask:0xf bank_mask:0xf
    v_add_f32_dpp v163, v163, v163 row_ror:2 row_mask:0xf bank_mask:0xf
    v_add_f32_dpp v164, v164, v164 row_ror:2 row_mask:0xf bank_mask:0xf
    v_add_f32_dpp v165, v165, v165 row_ror:2 row_mask:0xf bank_mask:0xf
    v_add_f32_dpp v166, v166, v166 row_ror:2 row_mask:0xf bank_mask:0xf
    v_add_f32_dpp v167, v167, v167 row_ror:2 row_mask:0xf bank_mask:0xf
    v_add_f32_dpp v168, v168, v168 row_ror:2 row_mask:0xf bank_mask:0xf
    v_add_f32_dpp v169, v169, v169 row_ror:2 row_mask:0xf bank_mask:0xf
    v_add_f32_dpp v170, v170, v170 row_ror:2 row_mask:0xf bank_mask:0xf
    v_add_f32_dpp v171, v171, v171 row_ror:2 row_mask:0xf bank_mask:0xf
    v_add_f32_dpp v172, v172, v172 row_ror:2 row_mask:0xf bank_mask:0xf
    v_add_f32_dpp v173, v173, v173 row_ror:2 row_mask:0xf bank_mask:0xf
    v_add_f32_dpp v174, v174, v174 row_ror:2 row_mask:0xf bank_mask:0xf
    v_add_f32_dpp v175, v175, v175 row_ror:2 row_mask:0xf bank_mask:0xf
    v_add_f32_dpp v160, v160, v160 row_ror:1 row_mask:0xf bank_mask:0xf
    v_add_f32_dpp v161, v161, v161 row_ror:1 row_mask:0xf bank_mask:0xf
    v_add_f32_dpp v162, v162, v162 row_ror:1 row_mask:0xf bank_mask:0xf
    v_add_f32_dpp v163, v163, v163 row_ror:1 row_mask:0xf bank_mask:0xf
    v_add_f32_dpp v164, v164, v164 row_ror:1 row_mask:0xf bank_mask:0xf
    v_add_f32_dpp v165, v165, v165 row_ror:1 row_mask:0xf bank_mask:0xf
    v_add_f32_dpp v166, v166, v166 row_ror:1 row_mask:0xf bank_mask:0xf
    v_add_f32_dpp v167, v167, v167 row_ror:1 row_mask:0xf bank_mask:0xf
    v_add_f32_dpp v168, v168, v168 row_ror:1 row_mask:0xf bank_mask:0xf
    v_add_f32_dpp v169, v169, v169 row_ror:1 row_mask:0xf bank_mask:0xf
    v_add_f32_dpp v170, v170, v170 row_ror:1 row_mask:0xf bank_mask:0xf
    v_add_f32_dpp v171, v171, v171 row_ror:1 row_mask:0xf bank_mask:0xf
    v_add_f32_dpp v172, v172, v172 row_ror:1 row_mask:0xf bank_mask:0xf
    v_add_f32_dpp v173, v173, v173 row_ror:1 row_mask:0xf bank_mask:0xf
    v_add_f32_dpp v174, v174, v174 row_ror:1 row_mask:0xf bank_mask:0xf
    v_add_f32_dpp v175, v175, v175 row_ror:1 row_mask:0xf bank_mask:0xf
    v_mov_b32 v192, v160
    v_mov_b32 v193, v161
    v_mov_b32 v194, v162
    v_mov_b32 v195, v163
    v_mov_b32 v196, v164
    v_mov_b32 v197, v165
    v_mov_b32 v198, v166
    v_mov_b32 v199, v167
    v_mov_b32 v200, v168
    v_mov_b32 v201, v169
    v_mov_b32 v202, v170
    v_mov_b32 v203, v171
    v_mov_b32 v204, v172
    v_mov_b32 v205, v173
    v_mov_b32 v206, v174
    v_mov_b32 v207, v175
    v_permlane16_swap_b32 v160, v192
    v_permlane16_swap_b32 v161, v193
    v_permlane16_swap_b32 v162, v194
    v_permlane16_swap_b32 v163, v195
    v_permlane16_swap_b32 v164, v196
    v_permlane16_swap_b32 v165, v197
    v_permlane16_swap_b32 v166, v198
    v_permlane16_swap_b32 v167, v199
    v_permlane16_swap_b32 v168, v200
    v_permlane16_swap_b32 v169, v201
    v_permlane16_swap_b32 v170, v202
    v_permlane16_swap_b32 v171, v203
    v_permlane16_swap_b32 v172, v204
    v_permlane16_swap_b32 v173, v205
    v_permlane16_swap_b32 v174, v206
    v_permlane16_swap_b32 v175, v207
    v_add_f32 v160, v160, v192
    v_add_f32 v161, v161, v193
    v_add_f32 v162, v162, v194
    v_add_f32 v163, v163, v195
    v_add_f32 v164, v164, v196
    v_add_f32 v165, v165, v197
    v_add_f32 v166, v166, v198
    v_add_f32 v167, v167, v199
    v_add_f32 v168, v168, v200
    v_add_f32 v169, v169, v201
    v_add_f32 v170, v170, v202
    v_add_f32 v171, v171, v203
    v_add_f32 v172, v172, v204
    v_add_f32 v173, v173, v205
    v_add_f32 v174, v174, v206
    v_add_f32 v175, v175, v207
    v_add_f32_dpp v176, v176, v176 row_ror:8 row_mask:0xf bank_mask:0xf
    v_add_f32_dpp v177, v177, v177 row_ror:8 row_mask:0xf bank_mask:0xf
    v_add_f32_dpp v178, v178, v178 row_ror:8 row_mask:0xf bank_mask:0xf
    v_add_f32_dpp v179, v179, v179 row_ror:8 row_mask:0xf bank_mask:0xf
    v_add_f32_dpp v180, v180, v180 row_ror:8 row_mask:0xf bank_mask:0xf
    v_add_f32_dpp v181, v181, v181 row_ror:8 row_mask:0xf bank_mask:0xf
    v_add_f32_dpp v182, v182, v182 row_ror:8 row_mask:0xf bank_mask:0xf
    v_add_f32_dpp v183, v183, v183 row_ror:8 row_mask:0xf bank_mask:0xf
    v_add_f32_dpp v184, v184, v184 row_ror:8 row_mask:0xf bank_mask:0xf
    v_add_f32_dpp v185, v185, v185 row_ror:8 row_mask:0xf bank_mask:0xf
    v_add_f32_dpp v186, v186, v186 row_ror:8 row_mask:0xf bank_mask:0xf
    v_add_f32_dpp v187, v187, v187 row_ror:8 row_mask:0xf bank_mask:0xf
    v_add_f32_dpp v188, v188, v188 row_ror:8 row_mask:0xf bank_mask:0xf
    v_add_f32_dpp v189, v189, v189 row_ror:8 row_mask:0xf bank_mask:0xf
    v_add_f32_dpp v190, v190, v190 row_ror:8 row_mask:0xf bank_mask:0xf
    v_add_f32_dpp v191, v191, v191 row_ror:8 row_mask:0xf bank_mask:0xf
    v_add_f32_dpp v176, v176, v176 row_ror:4 row_mask:0xf bank_mask:0xf
    v_add_f32_dpp v177, v177, v177 row_ror:4 row_mask:0xf bank_mask:0xf
    v_add_f32_dpp v178, v178, v178 row_ror:4 row_mask:0xf bank_mask:0xf
    v_add_f32_dpp v179, v179, v179 row_ror:4 row_mask:0xf bank_mask:0xf
    v_add_f32_dpp v180, v180, v180 row_ror:4 row_mask:0xf bank_mask:0xf
    v_add_f32_dpp v181, v181, v181 row_ror:4 row_mask:0xf bank_mask:0xf
    v_add_f32_dpp v182, v182, v182 row_ror:4 row_mask:0xf bank_mask:0xf
    v_add_f32_dpp v183, v183, v183 row_ror:4 row_mask:0xf bank_mask:0xf
    v_add_f32_dpp v184, v184, v184 row_ror:4 row_mask:0xf bank_mask:0xf
    v_add_f32_dpp v185, v185, v185 row_ror:4 row_mask:0xf bank_mask:0xf
    v_add_f32_dpp v186, v186, v186 row_ror:4 row_mask:0xf bank_mask:0xf
    v_add_f32_dpp v187, v187, v187 row_ror:4 row_mask:0xf bank_mask:0xf
    v_add_f32_dpp v188, v188, v188 row_ror:4 row_mask:0xf bank_mask:0xf
    v_add_f32_dpp v189, v189, v189 row_ror:4 row_mask:0xf bank_mask:0xf
    v_add_f32_dpp v190, v190, v190 row_ror:4 row_mask:0xf bank_mask:0xf
    v_add_f32_dpp v191, v191, v191 row_ror:4 row_mask:0xf bank_mask:0xf
    v_add_f32_dpp v176, v176, v176 row_ror:2 row_mask:0xf bank_mask:0xf
    v_add_f32_dpp v177, v177, v177 row_ror:2 row_mask:0xf bank_mask:0xf
    v_add_f32_dpp v178, v178, v178 row_ror:2 row_mask:0xf bank_mask:0xf
    v_add_f32_dpp v179, v179, v179 row_ror:2 row_mask:0xf bank_mask:0xf
    v_add_f32_dpp v180, v180, v180 row_ror:2 row_mask:0xf bank_mask:0xf
    v_add_f32_dpp v181, v181, v181 row_ror:2 row_mask:0xf bank_mask:0xf
    v_add_f32_dpp v182, v182, v182 row_ror:2 row_mask:0xf bank_mask:0xf
    v_add_f32_dpp v183, v183, v183 row_ror:2 row_mask:0xf bank_mask:0xf
    v_add_f32_dpp v184, v184, v184 row_ror:2 row_mask:0xf bank_mask:0xf
    v_add_f32_dpp v185, v185, v185 row_ror:2 row_mask:0xf bank_mask:0xf
    v_add_f32_dpp v186, v186, v186 row_ror:2 row_mask:0xf bank_mask:0xf
    v_add_f32_dpp v187, v187, v187 row_ror:2 row_mask:0xf bank_mask:0xf
    v_add_f32_dpp v188, v188, v188 row_ror:2 row_mask:0xf bank_mask:0xf
    v_add_f32_dpp v189, v189, v189 row_ror:2 row_mask:0xf bank_mask:0xf
    v_add_f32_dpp v190, v190, v190 row_ror:2 row_mask:0xf bank_mask:0xf
    v_add_f32_dpp v191, v191, v191 row_ror:2 row_mask:0xf bank_mask:0xf
    v_add_f32_dpp v176, v176, v176 row_ror:1 row_mask:0xf bank_mask:0xf
    v_add_f32_dpp v177, v177, v177 row_ror:1 row_mask:0xf bank_mask:0xf
    v_add_f32_dpp v178, v178, v178 row_ror:1 row_mask:0xf bank_mask:0xf
    v_add_f32_dpp v179, v179, v179 row_ror:1 row_mask:0xf bank_mask:0xf
    v_add_f32_dpp v180, v180, v180 row_ror:1 row_mask:0xf bank_mask:0xf
    v_add_f32_dpp v181, v181, v181 row_ror:1 row_mask:0xf bank_mask:0xf
    v_add_f32_dpp v182, v182, v182 row_ror:1 row_mask:0xf bank_mask:0xf
    v_add_f32_dpp v183, v183, v183 row_ror:1 row_mask:0xf bank_mask:0xf
    v_add_f32_dpp v184, v184, v184 row_ror:1 row_mask:0xf bank_mask:0xf
    v_add_f32_dpp v185, v185, v185 row_ror:1 row_mask:0xf bank_mask:0xf
    v_add_f32_dpp v186, v186, v186 row_ror:1 row_mask:0xf bank_mask:0xf
    v_add_f32_dpp v187, v187, v187 row_ror:1 row_mask:0xf bank_mask:0xf
    v_add_f32_dpp v188, v188, v188 row_ror:1 row_mask:0xf bank_mask:0xf
    v_add_f32_dpp v189, v189, v189 row_ror:1 row_mask:0xf bank_mask:0xf
    v_add_f32_dpp v190, v190, v190 row_ror:1 row_mask:0xf bank_mask:0xf
    v_add_f32_dpp v191, v191, v191 row_ror:1 row_mask:0xf bank_mask:0xf
    v_mov_b32 v192, v176
    v_mov_b32 v193, v177
    v_mov_b32 v194, v178
    v_mov_b32 v195, v179
    v_mov_b32 v196, v180
    v_mov_b32 v197, v181
    v_mov_b32 v198, v182
    v_mov_b32 v199, v183
    v_mov_b32 v200, v184
    v_mov_b32 v201, v185
    v_mov_b32 v202, v186
    v_mov_b32 v203, v187
    v_mov_b32 v204, v188
    v_mov_b32 v205, v189
    v_mov_b32 v206, v190
    v_mov_b32 v207, v191
    v_permlane16_swap_b32 v176, v192
    v_permlane16_swap_b32 v177, v193
    v_permlane16_swap_b32 v178, v194
    v_permlane16_swap_b32 v179, v195
    v_permlane16_swap_b32 v180, v196
    v_permlane16_swap_b32 v181, v197
    v_permlane16_swap_b32 v182, v198
    v_permlane16_swap_b32 v183, v199
    v_permlane16_swap_b32 v184, v200
    v_permlane16_swap_b32 v185, v201
    v_permlane16_swap_b32 v186, v202
    v_permlane16_swap_b32 v187, v203
    v_permlane16_swap_b32 v188, v204
    v_permlane16_swap_b32 v189, v205
    v_permlane16_swap_b32 v190, v206
    v_permlane16_swap_b32 v191, v207
    v_add_f32 v176, v176, v192
    v_add_f32 v177, v177, v193
    v_add_f32 v178, v178, v194
    v_add_f32 v179, v179, v195
    v_add_f32 v180, v180, v196
    v_add_f32 v181, v181, v197
    v_add_f32 v182, v182, v198
    v_add_f32 v183, v183, v199
    v_add_f32 v184, v184, v200
    v_add_f32 v185, v185, v201
    v_add_f32 v186, v186, v202
    v_add_f32 v187, v187, v203
    v_add_f32 v188, v188, v204
    v_add_f32 v189, v189, v205
    v_add_f32 v190, v190, v206
    v_add_f32 v191, v191, v207
    v_rcp_f32 v160, v160
    v_rcp_f32 v176, v176
    v_rcp_f32 v161, v161
    v_rcp_f32 v177, v177
    v_rcp_f32 v162, v162
    v_rcp_f32 v178, v178
    v_rcp_f32 v163, v163
    v_rcp_f32 v179, v179
    v_rcp_f32 v164, v164
    v_rcp_f32 v180, v180
    v_rcp_f32 v165, v165
    v_rcp_f32 v181, v181
    v_rcp_f32 v166, v166
    v_rcp_f32 v182, v182
    v_rcp_f32 v167, v167
    v_rcp_f32 v183, v183
    v_rcp_f32 v168, v168
    v_rcp_f32 v184, v184
    v_rcp_f32 v169, v169
    v_rcp_f32 v185, v185
    v_rcp_f32 v170, v170
    v_rcp_f32 v186, v186
    v_rcp_f32 v171, v171
    v_rcp_f32 v187, v187
    v_rcp_f32 v172, v172
    v_rcp_f32 v188, v188
    v_rcp_f32 v173, v173
    v_rcp_f32 v189, v189
    v_rcp_f32 v174, v174
    v_rcp_f32 v190, v190
    v_rcp_f32 v175, v175
    v_rcp_f32 v191, v191
    v_mul_f32 v208, v208, v160
    v_mul_f32 v224, v224, v176
    v_cndmask_b32_e64 v144, v144, v10, s[28:29]
    v_mul_f32 v209, v209, v161
    v_mul_f32 v225, v225, v177
    v_cndmask_b32_e64 v145, v145, v10, s[28:29]
    v_mul_f32 v210, v210, v162
    v_mul_f32 v226, v226, v178
    v_cndmask_b32_e64 v146, v146, v10, s[28:29]
    v_mul_f32 v211, v211, v163
    v_mul_f32 v227, v227, v179
    v_cndmask_b32_e64 v147, v147, v10, s[28:29]
    v_mul_f32 v212, v212, v164
    v_mul_f32 v228, v228, v180
    v_cndmask_b32_e64 v148, v148, v10, s[28:29]
    v_mul_f32 v213, v213, v165
    v_mul_f32 v229, v229, v181
    v_cndmask_b32_e64 v149, v149, v10, s[28:29]
    v_mul_f32 v214, v214, v166
    v_mul_f32 v230, v230, v182
    v_cndmask_b32_e64 v150, v150, v10, s[28:29]
    v_mul_f32 v215, v215, v167
    v_mul_f32 v231, v231, v183
    v_cndmask_b32_e64 v151, v151, v10, s[28:29]
    v_mul_f32 v216, v216, v168
    v_mul_f32 v232, v232, v184
    v_cndmask_b32_e64 v152, v152, v10, s[28:29]
    v_mul_f32 v217, v217, v169
    v_mul_f32 v233, v233, v185
    v_cndmask_b32_e64 v153, v153, v10, s[28:29]
    v_mul_f32 v218, v218, v170
    v_mul_f32 v234, v234, v186
    v_cndmask_b32_e64 v154, v154, v10, s[28:29]
    v_mul_f32 v219, v219, v171
    v_mul_f32 v235, v235, v187
    v_cndmask_b32_e64 v155, v155, v10, s[28:29]
    v_mul_f32 v220, v220, v172
    v_mul_f32 v236, v236, v188
    v_cndmask_b32_e64 v156, v156, v10, s[28:29]
    v_mul_f32 v221, v221, v173
    v_mul_f32 v237, v237, v189
    v_cndmask_b32_e64 v157, v157, v10, s[28:29]
    v_mul_f32 v222, v222, v174
    v_mul_f32 v238, v238, v190
    v_cndmask_b32_e64 v158, v158, v10, s[28:29]
    v_mul_f32 v223, v223, v175
    v_mul_f32 v239, v239, v191
    v_cndmask_b32_e64 v159, v159, v10, s[28:29]
    v_cvt_pk_bf16_f32 v16, v208, v209
    v_cvt_pk_bf16_f32 v24, v224, v225
    v_cvt_pk_bf16_f32 v32, v144, v145
    v_cvt_pk_bf16_f32 v17, v210, v211
    v_cvt_pk_bf16_f32 v25, v226, v227
    v_cvt_pk_bf16_f32 v33, v146, v147
    v_cvt_pk_bf16_f32 v18, v212, v213
    v_cvt_pk_bf16_f32 v26, v228, v229
    v_cvt_pk_bf16_f32 v34, v148, v149
    v_cvt_pk_bf16_f32 v19, v214, v215
    v_cvt_pk_bf16_f32 v27, v230, v231
    v_cvt_pk_bf16_f32 v35, v150, v151
    v_cvt_pk_bf16_f32 v20, v216, v217
    v_cvt_pk_bf16_f32 v28, v232, v233
    v_cvt_pk_bf16_f32 v36, v152, v153
    v_cvt_pk_bf16_f32 v21, v218, v219
    v_cvt_pk_bf16_f32 v29, v234, v235
    v_cvt_pk_bf16_f32 v37, v154, v155
    v_cvt_pk_bf16_f32 v22, v220, v221
    v_cvt_pk_bf16_f32 v30, v236, v237
    v_cvt_pk_bf16_f32 v38, v156, v157
    v_cvt_pk_bf16_f32 v23, v222, v223
    v_cvt_pk_bf16_f32 v31, v238, v239
    v_cvt_pk_bf16_f32 v39, v158, v159
    s_nop 1
    v_mfma_f32_32x32x16_bf16 v[48:63], v[32:35], v[16:19], 0
    v_mfma_f32_32x32x16_bf16 v[48:63], v[36:39], v[20:23], v[48:63]
    v_mfma_f32_32x32x16_bf16 v[64:79], v[32:35], v[24:27], 0
    v_mfma_f32_32x32x16_bf16 v[64:79], v[36:39], v[28:31], v[64:79]
    s_nop 15
    s_nop 1
    v_lshlrev_b32 v12, 4, v2
    s_lshl_b32 s11, s10, 10
    v_add_u32 v13, s11, v12
    ds_write_b128 v13, v[48:51] offset:0
    ds_write_b128 v13, v[52:55] offset:4096
    ds_write_b128 v13, v[56:59] offset:8192
    ds_write_b128 v13, v[60:63] offset:12288
    ds_write_b128 v13, v[64:67] offset:16384
    ds_write_b128 v13, v[68:71] offset:20480
    ds_write_b128 v13, v[72:75] offset:24576
    ds_write_b128 v13, v[76:79] offset:28672
    s_waitcnt lgkmcnt(0)
    s_barrier
    s_lshl_b32 s11, s10, 13
    v_add_u32 v13, s11, v12
    ds_read_b128 v[80:83], v13 offset:0
    ds_read_b128 v[84:87], v13 offset:1024
    ds_read_b128 v[88:91], v13 offset:2048
    ds_read_b128 v[92:95], v13 offset:3072
    ds_read_b128 v[96:99], v13 offset:4096
    ds_read_b128 v[100:103], v13 offset:5120
    ds_read_b128 v[104:107], v13 offset:6144
    ds_read_b128 v[108:111], v13 offset:7168
    s_lshl_b32 s11, s8, 5
    s_and_b32 s24, s10, 1
    s_lshl_b32 s24, s24, 4
    s_add_u32 s11, s11, s24
    s_lshl_b32 s11, s11, 8
    s_lshr_b32 s24, s10, 1
    s_lshl_b32 s24, s24, 7
    s_add_u32 s11, s11, s24
    v_lshlrev_b32 v14, 10, v4
    v_lshl_add_u32 v14, v3, 2, v14
    v_add_u32 v14, s11, v14
    s_waitcnt lgkmcnt(0)
    v_add_f32 v80, v80, v84
    v_add_f32 v88, v88, v92
    v_add_f32 v80, v80, v88
    v_add_f32 v81, v81, v85
    v_add_f32 v89, v89, v93
    v_add_f32 v81, v81, v89
    v_add_f32 v82, v82, v86
    v_add_f32 v90, v90, v94
    v_add_f32 v82, v82, v90
    v_add_f32 v83, v83, v87
    v_add_f32 v91, v91, v95
    v_add_f32 v83, v83, v91
    v_add_f32 v96, v96, v100
    v_add_f32 v104, v104, v108
    v_add_f32 v96, v96, v104
    v_add_f32 v97, v97, v101
    v_add_f32 v105, v105, v109
    v_add_f32 v97, v97, v105
    v_add_f32 v98, v98, v102
    v_add_f32 v106, v106, v110
    v_add_f32 v98, v98, v106
    v_add_f32 v99, v99, v103
    v_add_f32 v107, v107, v111
    v_add_f32 v99, v99, v107
    buffer_atomic_add_f32 v80, v14, s[20:23], 0 offen offset:0 sc1
    buffer_atomic_add_f32 v81, v14, s[20:23], 0 offen offset:256 sc1
    buffer_atomic_add_f32 v82, v14, s[20:23], 0 offen offset:512 sc1
    buffer_atomic_add_f32 v83, v14, s[20:23], 0 offen offset:768 sc1
    buffer_atomic_add_f32 v96, v14, s[20:23], 0 offen offset:2048 sc1
    buffer_atomic_add_f32 v97, v14, s[20:23], 0 offen offset:2304 sc1
    buffer_atomic_add_f32 v98, v14, s[20:23], 0 offen offset:2560 sc1
    buffer_atomic_add_f32 v99, v14, s[20:23], 0 offen offset:2816 sc1
    s_cmp_eq_u32 s93, 1
    s_cbranch_scc1 is_36
    s_mov_b32 s93, 1
    v_readfirstlane_b32 s74, v0
    s_nop 3
    s_cmp_lt_u32 s74, 64
    s_cbranch_scc0 is_36
    s_load_dwordx2 s[74:75], s[0:1], 96
    s_waitcnt lgkmcnt(0)
    s_mov_b32 s84, s74
    s_mov_b32 s85, s75
    s_mov_b32 s86, 0x100
    s_mov_b32 s87, 0x00020000
    v_mov_b32 v13, 8
    s_mov_b32 s74, 0
wc_37:
    buffer_load_dword v12, v13, s[84:87], 0 offen sc1
    s_add_u32 s74, s74, 1
    s_cmp_gt_u32 s74, 3000000
    s_cbranch_scc1 wk_done
    s_waitcnt vmcnt(0)
    v_readfirstlane_b32 s75, v12
    s_nop 3
    s_cmp_ge_u32 s75, 256
    s_cbranch_scc1 wc_37_ok
    s_sleep 8
    s_branch wc_37
wc_37_ok:
is_36:
    s_waitcnt vmcnt(0)
    s_barrier
    v_mov_b32 v12, 0
    s_lshl_b32 s74, s100, 2
    v_cmp_eq_u32 vcc, 0, v0
    s_and_b64 exec, exec, vcc
    buffer_store_dword v12, v12, s[96:99], s74 offen offset:3072 sc1
    s_mov_b64 exec, -1
    s_branch wk_loop
tk_a2:
    s_cmp_eq_u32 s93, 1
    s_cbranch_scc1 is_39
    s_mov_b32 s93, 1
    v_readfirstlane_b32 s74, v0
    s_nop 3
    s_cmp_lt_u32 s74, 64
    s_cbranch_scc0 is_39
    s_load_dwordx2 s[74:75], s[0:1], 96
    s_waitcnt lgkmcnt(0)
    s_mov_b32 s84, s74
    s_mov_b32 s85, s75
    s_mov_b32 s86, 0x100
    s_mov_b32 s87, 0x00020000
    v_mov_b32 v13, 8
    s_mov_b32 s74, 0
wc_40:
    buffer_load_dword v12, v13, s[84:87], 0 offen sc1
    s_add_u32 s74, s74, 1
    s_cmp_gt_u32 s74, 3000000
    s_cbranch_scc1 wk_done
    s_waitcnt vmcnt(0)
    v_readfirstlane_b32 s75, v12
    s_nop 3
    s_cmp_ge_u32 s75, 256
    s_cbranch_scc1 wc_40_ok
    s_sleep 8
    s_branch wc_40
wc_40_ok:
is_39:
    v_readfirstlane_b32 s74, v0
    s_nop 3
    s_cmp_lt_u32 s74, 64
    s_cbranch_scc0 fx_38
    v_and_b32 v20, 63, v0
    v_lshlrev_b32 v20, 4, v20
    v_add_u32 v20, 1024, v20
    s_mov_b32 s74, 0
    v_mov_b32 v12, 0
    v_mov_b32 v13, 0
    v_mov_b32 v14, 0
    v_mov_b32 v15, 0
    v_mov_b32 v16, 0
    v_mov_b32 v17, 0
    v_mov_b32 v18, 0
    v_mov_b32 v19, 0
fw_41:
    s_mov_b32 exec_lo, 0xffffffff
    s_mov_b32 exec_hi, 0xffffffff
    buffer_load_dwordx4 v[12:15], v20, s[96:99], 0 offen sc1
    s_mov_b32 exec_lo, 0xfffff
    s_mov_b32 exec_hi, 0x0
    buffer_load_dwordx4 v[16:19], v20, s[96:99], 0 offen offset:1024 sc1
    s_mov_b64 exec, -1
    s_add_u32 s74, s74, 1
    s_cmp_gt_u32 s74, 3000000
    s_cbranch_scc1 wk_done
    s_waitcnt vmcnt(0)
    v_max3_u32 v12, v12, v13, v14
    v_max3_u32 v16, v16, v17, v18
    v_max3_u32 v12, v12, v15, v19
    v_max_u32 v12, v12, v16
    v_cmp_eq_u32 vcc, -1, v12
    s_cbranch_vccz fw_41_ok
    s_sleep 8
    s_branch fw_41
fw_41_ok:
fx_38:
    s_barrier
    s_load_dwordx2 s[4:5], s[0:1], 104
    s_load_dwordx2 s[6:7], s[0:1], 0
    s_load_dwordx2 s[8:9], s[0:1], 88
    v_lshrrev_b32 v1, 6, v0
    v_and_b32 v2, 63, v0
    s_nop 0
    v_readfirstlane_b32 s10, v1
    v_and_b32 v3, 31, v2
    v_lshrrev_b32 v4, 5, v2
    v_and_b32 v5, 0x13, v3
    v_and_b32 v6, 4, v3
    v_lshl_or_b32 v5, v6, 1, v5
    v_and_b32 v6, 8, v3
    v_lshrrev_b32 v6, 1, v6
    v_or_b32 v5, v6, v5
    s_waitcnt lgkmcnt(0)
    s_mov_b32 s12, s6
    s_mov_b32 s13, s7
    s_mov_b32 s14, 0x1c0000
    s_mov_b32 s15, 0x00020000
    s_add_u32 s16, s4, 0x54e0000
    s_addc_u32 s17, s5, 0x0
    s_mov_b32 s18, 0x150000
    s_mov_b32 s19, 0x00020000
    s_add_u32 s20, s4, 0x5aa0000
    s_addc_u32 s21, s5, 0x0
    s_mov_b32 s22, 0x20000
    s_mov_b32 s23, 0x00020000
    s_add_u32 s24, s4, 0x5630000
    s_addc_u32 s25, s5, 0x0
    s_mov_b32 s26, 0x70000
    s_mov_b32 s27, 0x00020000
    s_mov_b32 s32, s8
    s_mov_b32 s33, s9
    s_mov_b32 s34, 0x380000
    s_mov_b32 s35, 0x00020000
    s_lshl_b32 s11, s100, 5
    v_add_u32 v6, s11, v3
    v_mul_u32_u24 v6, 896, v6
    v_lshl_add_u32 v6, v4, 4, v6
    buffer_load_dwordx4 a[0:3], v6, s[12:15], 0 offen offset:0
    buffer_load_dwordx4 a[4:7], v6, s[12:15], 0 offen offset:32
    buffer_load_dwordx4 a[8:11], v6, s[12:15], 0 offen offset:64
    buffer_load_dwordx4 a[12:15], v6, s[12:15], 0 offen offset:96
    buffer_load_dwordx4 a[16:19], v6, s[12:15], 0 offen offset:128
    buffer_load_dwordx4 a[20:23], v6, s[12:15], 0 offen offset:160
    buffer_load_dwordx4 a[24:27], v6, s[12:15], 0 offen offset:192
    buffer_load_dwordx4 a[28:31], v6, s[12:15], 0 offen offset:224
    buffer_load_dwordx4 a[32:35], v6, s[12:15], 0 offen offset:256
    buffer_load_dwordx4 a[36:39], v6, s[12:15], 0 offen offset:288
    buffer_load_dwordx4 a[40:43], v6, s[12:15], 0 offen offset:320
    buffer_load_dwordx4 a[44:47], v6, s[12:15], 0 offen offset:352
    buffer_load_dwordx4 a[48:51], v6, s[12:15], 0 offen offset:384
    buffer_load_dwordx4 a[52:55], v6, s[12:15], 0 offen offset:416
    buffer_load_dwordx4 a[56:59], v6, s[12:15], 0 offen offset:448
    buffer_load_dwordx4 a[60:63], v6, s[12:15], 0 offen offset:480
    buffer_load_dwordx4 a[64:67], v6, s[12:15], 0 offen offset:512
    buffer_load_dwordx4 a[68:71], v6, s[12:15], 0 offen offset:544
    buffer_load_dwordx4 a[72:75], v6, s[12:15], 0 offen offset:576
    buffer_load_dwordx4 a[76:79], v6, s[12:15], 0 offen offset:608
    buffer_load_dwordx4 a[80:83], v6, s[12:15], 0 offen offset:640
    buffer_load_dwordx4 a[84:87], v6, s[12:15], 0 offen offset:672
    buffer_load_dwordx4 a[88:91], v6, s[12:15], 0 offen offset:704
    buffer_load_dwordx4 a[92:95], v6, s[12:15], 0 offen offset:736
    buffer_load_dwordx4 a[96:99], v6, s[12:15], 0 offen offset:768
    buffer_load_dwordx4 a[100:103], v6, s[12:15], 0 offen offset:800
    buffer_load_dwordx4 a[104:107], v6, s[12:15], 0 offen offset:832
    buffer_load_dwordx4 a[108:111], v6, s[12:15], 0 offen offset:864
    s_lshl_b32 s11, s10, 7
    v_add_u32 v8, s11, v5
    v_mul_u32_u24 v7, 896, v8
    v_lshl_add_u32 v7, v4, 4, v7
    v_lshlrev_b32 v8, 8, v8
    v_lshl_add_u32 v8, v4, 5, v8
    v_cmp_eq_u32 s[40:41], 0, v4
    v_mov_b32 v9, 0xf149f2ca
    v_mov_b32 v10, 0x7149f2ca
    s_mov_b32 s30, 0x3fb8aa3b
    v_mov_b32 v11, 0
    s_mov_b32 s39, 0
    buffer_load_dwordx4 v[16:19], v7, s[16:19], s39 offen offset:0 sc1
    buffer_load_dwordx4 v[20:23], v7, s[16:19], s39 offen offset:32 sc1
    buffer_load_dwordx4 v[24:27], v7, s[16:19], s39 offen offset:64 sc1
    buffer_load_dwordx4 v[28:31], v7, s[16:19], s39 offen offset:96 sc1
    buffer_load_dwordx4 v[32:35], v7, s[16:19], s39 offen offset:128 sc1
    buffer_load_dwordx4 v[36:39], v7, s[16:19], s39 offen offset:160 sc1
    buffer_load_dwordx4 v[40:43], v7, s[16:19], s39 offen offset:192 sc1
    buffer_load_dwordx4 v[44:47], v7, s[16:19], s39 offen offset:224 sc1
    buffer_load_dwordx4 v[48:51], v7, s[16:19], s39 offen offset:256 sc1
    buffer_load_dwordx4 v[52:55], v7, s[16:19], s39 offen offset:288 sc1
    buffer_load_dwordx4 v[56:59], v7, s[16:19], s39 offen offset:320 sc1
    buffer_load_dwordx4 v[60:63], v7, s[16:19], s39 offen offset:352 sc1
    buffer_load_dwordx4 v[64:67], v7, s[16:19], s39 offen offset:384 sc1
    buffer_load_dwordx4 v[68:71], v7, s[16:19], s39 offen offset:416 sc1
    buffer_load_dwordx4 v[72:75], v7, s[16:19], s39 offen offset:448 sc1
    buffer_load_dwordx4 v[76:79], v7, s[16:19], s39 offen offset:480 sc1
    buffer_load_dwordx4 v[80:83], v7, s[16:19], s39 offen offset:512 sc1
    buffer_load_dwordx4 v[84:87], v7, s[16:19], s39 offen offset:544 sc1
    buffer_load_dwordx4 v[88:91], v7, s[16:19], s39 offen offset:576 sc1
    buffer_load_dwordx4 v[92:95], v7, s[16:19], s39 offen offset:608 sc1
    buffer_load_dwordx4 v[96:99], v7, s[16:19], s39 offen offset:640 sc1
    buffer_load_dwordx4 v[100:103], v7, s[16:19], s39 offen offset:672 sc1
    buffer_load_dwordx4 v[104:107], v7, s[16:19], s39 offen offset:704 sc1
    buffer_load_dwordx4 v[108:111], v7, s[16:19], s39 offen offset:736 sc1
    buffer_load_dwordx4 v[112:115], v7, s[16:19], s39 offen offset:768 sc1
    buffer_load_dwordx4 v[116:119], v7, s[16:19], s39 offen offset:800 sc1
    buffer_load_dwordx4 v[120:123], v7, s[16:19], s39 offen offset:832 sc1
    buffer_load_dwordx4 v[124:127], v7, s[16:19], s39 offen offset:864 sc1
    s_mov_b32 s39, 28672
    buffer_load_dwordx4 a[112:115], v7, s[16:19], s39 offen offset:0 sc1
    buffer_load_dwordx4 a[116:119], v7, s[16:19], s39 offen offset:32 sc1
    buffer_load_dwordx4 a[120:123], v7, s[16:19], s39 offen offset:64 sc1
    buffer_load_dwordx4 a[124:127], v7, s[16:19], s39 offen offset:96 sc1
    buffer_load_dwordx4 a[128:131], v7, s[16:19], s39 offen offset:128 sc1
    buffer_load_dwordx4 a[132:135], v7, s[16:19], s39 offen offset:160 sc1
    buffer_load_dwordx4 a[136:139], v7, s[16:19], s39 offen offset:192 sc1
    buffer_load_dwordx4 a[140:143], v7, s[16:19], s39 offen offset:224 sc1
    buffer_load_dwordx4 a[144:147], v7, s[16:19], s39 offen offset:256 sc1
    buffer_load_dwordx4 a[148:151], v7, s[16:19], s39 offen offset:288 sc1
    buffer_load_dwordx4 a[152:155], v7, s[16:19], s39 offen offset:320 sc1
    buffer_load_dwordx4 a[156:159], v7, s[16:19], s39 offen offset:352 sc1
    buffer_load_dwordx4 a[160:163], v7, s[16:19], s39 offen offset:384 sc1
    buffer_load_dwordx4 a[164:167], v7, s[16:19], s39 offen offset:416 sc1
    buffer_load_dwordx4 a[168:171], v7, s[16:19], s39 offen offset:448 sc1
    buffer_load_dwordx4 a[172:175], v7, s[16:19], s39 offen offset:480 sc1
    buffer_load_dwordx4 a[176:179], v7, s[16:19], s39 offen offset:512 sc1
    buffer_load_dwordx4 a[180:183], v7, s[16:19], s39 offen offset:544 sc1
    buffer_load_dwordx4 a[184:187], v7, s[16:19], s39 offen offset:576 sc1
    buffer_load_dwordx4 a[188:191], v7, s[16:19], s39 offen offset:608 sc1
    buffer_load_dwordx4 a[192:195], v7, s[16:19], s39 offen offset:640 sc1
    buffer_load_dwordx4 a[196:199], v7, s[16:19], s39 offen offset:672 sc1
    buffer_load_dwordx4 a[200:203], v7, s[16:19], s39 offen offset:704 sc1
    buffer_load_dwordx4 a[204:207], v7, s[16:19], s39 offen offset:736 sc1
    buffer_load_dwordx4 a[208:211], v7, s[16:19], s39 offen offset:768 sc1
    buffer_load_dwordx4 a[212:215], v7, s[16:19], s39 offen offset:800 sc1
    buffer_load_dwordx4 a[216:219], v7, s[16:19], s39 offen offset:832 sc1
    buffer_load_dwordx4 a[220:223], v7, s[16:19], s39 offen offset:864 sc1
    s_waitcnt vmcnt(28)
    v_mfma_f32_32x32x16_bf16 v[128:143], v[16:19], a[0:3], 0
    v_mfma_f32_32x32x16_bf16 v[128:143], v[20:23], a[4:7], v[128:143]
    v_mfma_f32_32x32x16_bf16 v[128:143], v[24:27], a[8:11], v[128:143]
    v_mfma_f32_32x32x16_bf16 v[128:143], v[28:31], a[12:15], v[128:143]
    v_mfma_f32_32x32x16_bf16 v[128:143], v[32:35], a[16:19], v[128:143]
    v_mfma_f32_32x32x16_bf16 v[128:143], v[36:39], a[20:23], v[128:143]
    v_mfma_f32_32x32x16_bf16 v[128:143], v[40:43], a[24:27], v[128:143]
    v_mfma_f32_32x32x16_bf16 v[128:143], v[44:47], a[28:31], v[128:143]
    v_mfma_f32_32x32x16_bf16 v[128:143], v[48:51], a[32:35], v[128:143]
    v_mfma_f32_32x32x16_bf16 v[128:143], v[52:55], a[36:39], v[128:143]
    v_mfma_f32_32x32x16_bf16 v[128:143], v[56:59], a[40:43], v[128:143]
    v_mfma_f32_32x32x16_bf16 v[128:143], v[60:63], a[44:47], v[128:143]
    v_mfma_f32_32x32x16_bf16 v[128:143], v[64:67], a[48:51], v[128:143]
    v_mfma_f32_32x32x16_bf16 v[128:143], v[68:71], a[52:55], v[128:143]
    v_mfma_f32_32x32x16_bf16 v[128:143], v[72:75], a[56:59], v[128:143]
    v_mfma_f32_32x32x16_bf16 v[128:143], v[76:79], a[60:63], v[128:143]
    v_mfma_f32_32x32x16_bf16 v[128:143], v[80:83], a[64:67], v[128:143]
    v_mfma_f32_32x32x16_bf16 v[128:143], v[84:87], a[68:71], v[128:143]
    v_mfma_f32_32x32x16_bf16 v[128:143], v[88:91], a[72:75], v[128:143]
    v_mfma_f32_32x32x16_bf16 v[128:143], v[92:95], a[76:79], v[128:143]
    v_mfma_f32_32x32x16_bf16 v[128:143], v[96:99], a[80:83], v[128:143]
    v_mfma_f32_32x32x16_bf16 v[128:143], v[100:103], a[84:87], v[128:143]
    v_mfma_f32_32x32x16_bf16 v[128:143], v[104:107], a[88:91], v[128:143]
    v_mfma_f32_32x32x16_bf16 v[128:143], v[108:111], a[92:95], v[128:143]
    v_mfma_f32_32x32x16_bf16 v[128:143], v[112:115], a[96:99], v[128:143]
    v_mfma_f32_32x32x16_bf16 v[128:143], v[116:119], a[100:103], v[128:143]
    v_mfma_f32_32x32x16_bf16 v[128:143], v[120:123], a[104:107], v[128:143]
    v_mfma_f32_32x32x16_bf16 v[128:143], v[124:127], a[108:111], v[128:143]
    s_nop 0
    s_mov_b32 s39, 57344
    buffer_load_dwordx4 v[16:19], v7, s[16:19], s39 offen offset:0 sc1
    buffer_load_dwordx4 v[20:23], v7, s[16:19], s39 offen offset:32 sc1
    buffer_load_dwordx4 v[24:27], v7, s[16:19], s39 offen offset:64 sc1
    buffer_load_dwordx4 v[28:31], v7, s[16:19], s39 offen offset:96 sc1
    buffer_load_dwordx4 v[32:35], v7, s[16:19], s39 offen offset:128 sc1
    buffer_load_dwordx4 v[36:39], v7, s[16:19], s39 offen offset:160 sc1
    buffer_load_dwordx4 v[40:43], v7, s[16:19], s39 offen offset:192 sc1
    buffer_load_dwordx4 v[44:47], v7, s[16:19], s39 offen offset:224 sc1
    buffer_load_dwordx4 v[48:51], v7, s[16:19], s39 offen offset:256 sc1
    buffer_load_dwordx4 v[52:55], v7, s[16:19], s39 offen offset:288 sc1
    buffer_load_dwordx4 v[56:59], v7, s[16:19], s39 offen offset:320 sc1
    buffer_load_dwordx4 v[60:63], v7, s[16:19], s39 offen offset:352 sc1
    buffer_load_dwordx4 v[64:67], v7, s[16:19], s39 offen offset:384 sc1
    buffer_load_dwordx4 v[68:71], v7, s[16:19], s39 offen offset:416 sc1
    buffer_load_dwordx4 v[72:75], v7, s[16:19], s39 offen offset:448 sc1
    buffer_load_dwordx4 v[76:79], v7, s[16:19], s39 offen offset:480 sc1
    buffer_load_dwordx4 v[80:83], v7, s[16:19], s39 offen offset:512 sc1
    buffer_load_dwordx4 v[84:87], v7, s[16:19], s39 offen offset:544 sc1
    buffer_load_dwordx4 v[88:91], v7, s[16:19], s39 offen offset:576 sc1
    buffer_load_dwordx4 v[92:95], v7, s[16:19], s39 offen offset:608 sc1
    buffer_load_dwordx4 v[96:99], v7, s[16:19], s39 offen offset:640 sc1
    buffer_load_dwordx4 v[100:103], v7, s[16:19], s39 offen offset:672 sc1
    buffer_load_dwordx4 v[104:107], v7, s[16:19], s39 offen offset:704 sc1
    buffer_load_dwordx4 v[108:111], v7, s[16:19], s39 offen offset:736 sc1
    buffer_load_dwordx4 v[112:115], v7, s[16:19], s39 offen offset:768 sc1
    buffer_load_dwordx4 v[116:119], v7, s[16:19], s39 offen offset:800 sc1
    buffer_load_dwordx4 v[120:123], v7, s[16:19], s39 offen offset:832 sc1
    buffer_load_dwordx4 v[124:127], v7, s[16:19], s39 offen offset:864 sc1
    s_waitcnt vmcnt(28)
    v_mfma_f32_32x32x16_bf16 v[144:159], a[112:115], a[0:3], 0
    v_mfma_f32_32x32x16_bf16 v[144:159], a[116:119], a[4:7], v[144:159]
    v_mfma_f32_32x32x16_bf16 v[144:159], a[120:123], a[8:11], v[144:159]
    v_mfma_f32_32x32x16_bf16 v[144:159], a[124:127], a[12:15], v[144:159]
    v_mfma_f32_32x32x16_bf16 v[144:159], a[128:131], a[16:19], v[144:159]
    v_mfma_f32_32x32x16_bf16 v[144:159], a[132:135], a[20:23], v[144:159]
    v_mfma_f32_32x32x16_bf16 v[144:159], a[136:139], a[24:27], v[144:159]
    v_mfma_f32_32x32x16_bf16 v[144:159], a[140:143], a[28:31], v[144:159]
    v_mfma_f32_32x32x16_bf16 v[144:159], a[144:147], a[32:35], v[144:159]
    v_mfma_f32_32x32x16_bf16 v[144:159], a[148:151], a[36:39], v[144:159]
    v_mfma_f32_32x32x16_bf16 v[144:159], a[152:155], a[40:43], v[144:159]
    v_mfma_f32_32x32x16_bf16 v[144:159], a[156:159], a[44:47], v[144:159]
    v_mfma_f32_32x32x16_bf16 v[144:159], a[160:163], a[48:51], v[144:159]
    v_mfma_f32_32x32x16_bf16 v[144:159], a[164:167], a[52:55], v[144:159]
    v_mfma_f32_32x32x16_bf16 v[144:159], a[168:171], a[56:59], v[144:159]
    v_mfma_f32_32x32x16_bf16 v[144:159], a[172:175], a[60:63], v[144:159]
    v_mfma_f32_32x32x16_bf16 v[144:159], a[176:179], a[64:67], v[144:159]
    v_mfma_f32_32x32x16_bf16 v[144:159], a[180:183], a[68:71], v[144:159]
    v_mfma_f32_32x32x16_bf16 v[144:159], a[184:187], a[72:75], v[144:159]
    v_mfma_f32_32x32x16_bf16 v[144:159], a[188:191], a[76:79], v[144:159]
    v_mfma_f32_32x32x16_bf16 v[144:159], a[192:195], a[80:83], v[144:159]
    v_mfma_f32_32x32x16_bf16 v[144:159], a[196:199], a[84:87], v[144:159]
    v_mfma_f32_32x32x16_bf16 v[144:159], a[200:203], a[88:91], v[144:159]
    v_mfma_f32_32x32x16_bf16 v[144:159], a[204:207], a[92:95], v[144:159]
    v_mfma_f32_32x32x16_bf16 v[144:159], a[208:211], a[96:99], v[144:159]
    v_mfma_f32_32x32x16_bf16 v[144:159], a[212:215], a[100:103], v[144:159]
    v_mfma_f32_32x32x16_bf16 v[144:159], a[216:219], a[104:107], v[144:159]
    v_mfma_f32_32x32x16_bf16 v[144:159], a[220:223], a[108:111], v[144:159]
    s_nop 0
    s_mov_b32 s39, 86016
    buffer_load_dwordx4 a[112:115], v7, s[16:19], s39 offen offset:0 sc1
    buffer_load_dwordx4 a[116:119], v7, s[16:19], s39 offen offset:32 sc1
    buffer_load_dwordx4 a[120:123], v7, s[16:19], s39 offen offset:64 sc1
    buffer_load_dwordx4 a[124:127], v7, s[16:19], s39 offen offset:96 sc1
    buffer_load_dwordx4 a[128:131], v7, s[16:19], s39 offen offset:128 sc1
    buffer_load_dwordx4 a[132:135], v7, s[16:19], s39 offen offset:160 sc1
    buffer_load_dwordx4 a[136:139], v7, s[16:19], s39 offen offset:192 sc1
    buffer_load_dwordx4 a[140:143], v7, s[16:19], s39 offen offset:224 sc1
    buffer_load_dwordx4 a[144:147], v7, s[16:19], s39 offen offset:256 sc1
    buffer_load_dwordx4 a[148:151], v7, s[16:19], s39 offen offset:288 sc1
    buffer_load_dwordx4 a[152:155], v7, s[16:19], s39 offen offset:320 sc1
    buffer_load_dwordx4 a[156:159], v7, s[16:19], s39 offen offset:352 sc1
    buffer_load_dwordx4 a[160:163], v7, s[16:19], s39 offen offset:384 sc1
    buffer_load_dwordx4 a[164:167], v7, s[16:19], s39 offen offset:416 sc1
    buffer_load_dwordx4 a[168:171], v7, s[16:19], s39 offen offset:448 sc1
    buffer_load_dwordx4 a[172:175], v7, s[16:19], s39 offen offset:480 sc1
    buffer_load_dwordx4 a[176:179], v7, s[16:19], s39 offen offset:512 sc1
    buffer_load_dwordx4 a[180:183], v7, s[16:19], s39 offen offset:544 sc1
    buffer_load_dwordx4 a[184:187], v7, s[16:19], s39 offen offset:576 sc1
    buffer_load_dwordx4 a[188:191], v7, s[16:19], s39 offen offset:608 sc1
    buffer_load_dwordx4 a[192:195], v7, s[16:19], s39 offen offset:640 sc1
    buffer_load_dwordx4 a[196:199], v7, s[16:19], s39 offen offset:672 sc1
    buffer_load_dwordx4 a[200:203], v7, s[16:19], s39 offen offset:704 sc1
    buffer_load_dwordx4 a[204:207], v7, s[16:19], s39 offen offset:736 sc1
    buffer_load_dwordx4 a[208:211], v7, s[16:19], s39 offen offset:768 sc1
    buffer_load_dwordx4 a[212:215], v7, s[16:19], s39 offen offset:800 sc1
    buffer_load_dwordx4 a[216:219], v7, s[16:19], s39 offen offset:832 sc1
    buffer_load_dwordx4 a[220:223], v7, s[16:19], s39 offen offset:864 sc1
    s_waitcnt vmcnt(28)
    v_mfma_f32_32x32x16_bf16 v[160:175], v[16:19], a[0:3], 0
    v_mfma_f32_32x32x16_bf16 v[160:175], v[20:23], a[4:7], v[160:175]
    v_mfma_f32_32x32x16_bf16 v[160:175], v[24:27], a[8:11], v[160:175]
    v_mfma_f32_32x32x16_bf16 v[160:175], v[28:31], a[12:15], v[160:175]
    v_mfma_f32_32x32x16_bf16 v[160:175], v[32:35], a[16:19], v[160:175]
    v_mfma_f32_32x32x16_bf16 v[160:175], v[36:39], a[20:23], v[160:175]
    v_mfma_f32_32x32x16_bf16 v[160:175], v[40:43], a[24:27], v[160:175]
    v_mfma_f32_32x32x16_bf16 v[160:175], v[44:47], a[28:31], v[160:175]
    v_mfma_f32_32x32x16_bf16 v[160:175], v[48:51], a[32:35], v[160:175]
    v_mfma_f32_32x32x16_bf16 v[160:175], v[52:55], a[36:39], v[160:175]
    v_mfma_f32_32x32x16_bf16 v[160:175], v[56:59], a[40:43], v[160:175]
    v_mfma_f32_32x32x16_bf16 v[160:175], v[60:63], a[44:47], v[160:175]
    v_mfma_f32_32x32x16_bf16 v[160:175], v[64:67], a[48:51], v[160:175]
    v_mfma_f32_32x32x16_bf16 v[160:175], v[68:71], a[52:55], v[160:175]
    v_mfma_f32_32x32x16_bf16 v[160:175], v[72:75], a[56:59], v[160:175]
    v_mfma_f32_32x32x16_bf16 v[160:175], v[76:79], a[60:63], v[160:175]
    v_mfma_f32_32x32x16_bf16 v[160:175], v[80:83], a[64:67], v[160:175]
    v_mfma_f32_32x32x16_bf16 v[160:175], v[84:87], a[68:71], v[160:175]
    v_mfma_f32_32x32x16_bf16 v[160:175], v[88:91], a[72:75], v[160:175]
    v_mfma_f32_32x32x16_bf16 v[160:175], v[92:95], a[76:79], v[160:175]
    v_mfma_f32_32x32x16_bf16 v[160:175], v[96:99], a[80:83], v[160:175]
    v_mfma_f32_32x32x16_bf16 v[160:175], v[100:103], a[84:87], v[160:175]
    v_mfma_f32_32x32x16_bf16 v[160:175], v[104:107], a[88:91], v[160:175]
    v_mfma_f32_32x32x16_bf16 v[160:175], v[108:111], a[92:95], v[160:175]
    v_mfma_f32_32x32x16_bf16 v[160:175], v[112:115], a[96:99], v[160:175]
    v_mfma_f32_32x32x16_bf16 v[160:175], v[116:119], a[100:103], v[160:175]
    v_mfma_f32_32x32x16_bf16 v[160:175], v[120:123], a[104:107], v[160:175]
    v_mfma_f32_32x32x16_bf16 v[160:175], v[124:127], a[108:111], v[160:175]
    s_waitcnt vmcnt(0)
    v_mfma_f32_32x32x16_bf16 v[176:191], a[112:115], a[0:3], 0
    v_mfma_f32_32x32x16_bf16 v[176:191], a[116:119], a[4:7], v[176:191]
    v_mfma_f32_32x32x16_bf16 v[176:191], a[120:123], a[8:11], v[176:191]
    v_mfma_f32_32x32x16_bf16 v[176:191], a[124:127], a[12:15], v[176:191]
    v_mfma_f32_32x32x16_bf16 v[176:191], a[128:131], a[16:19], v[176:191]
    v_mfma_f32_32x32x16_bf16 v[176:191], a[132:135], a[20:23], v[176:191]
    v_mfma_f32_32x32x16_bf16 v[176:191], a[136:139], a[24:27], v[176:191]
    v_mfma_f32_32x32x16_bf16 v[176:191], a[140:143], a[28:31], v[176:191]
    v_mfma_f32_32x32x16_bf16 v[176:191], a[144:147], a[32:35], v[176:191]
    v_mfma_f32_32x32x16_bf16 v[176:191], a[148:151], a[36:39], v[176:191]
    v_mfma_f32_32x32x16_bf16 v[176:191], a[152:155], a[40:43], v[176:191]
    v_mfma_f32_32x32x16_bf16 v[176:191], a[156:159], a[44:47], v[176:191]
    v_mfma_f32_32x32x16_bf16 v[176:191], a[160:163], a[48:51], v[176:191]
    v_mfma_f32_32x32x16_bf16 v[176:191], a[164:167], a[52:55], v[176:191]
    v_mfma_f32_32x32x16_bf16 v[176:191], a[168:171], a[56:59], v[176:191]
    v_mfma_f32_32x32x16_bf16 v[176:191], a[172:175], a[60:63], v[176:191]
    v_mfma_f32_32x32x16_bf16 v[176:191], a[176:179], a[64:67], v[176:191]
    v_mfma_f32_32x32x16_bf16 v[176:191], a[180:183], a[68:71], v[176:191]
    v_mfma_f32_32x32x16_bf16 v[176:191], a[184:187], a[72:75], v[176:191]
    v_mfma_f32_32x32x16_bf16 v[176:191], a[188:191], a[76:79], v[176:191]
    v_mfma_f32_32x32x16_bf16 v[176:191], a[192:195], a[80:83], v[176:191]
    v_mfma_f32_32x32x16_bf16 v[176:191], a[196:199], a[84:87], v[176:191]
    v_mfma_f32_32x32x16_bf16 v[176:191], a[200:203], a[88:91], v[176:191]
    v_mfma_f32_32x32x16_bf16 v[176:191], a[204:207], a[92:95], v[176:191]
    v_mfma_f32_32x32x16_bf16 v[176:191], a[208:211], a[96:99], v[176:191]
    v_mfma_f32_32x32x16_bf16 v[176:191], a[212:215], a[100:103], v[176:191]
    v_mfma_f32_32x32x16_bf16 v[176:191], a[216:219], a[104:107], v[176:191]
    v_mfma_f32_32x32x16_bf16 v[176:191], a[220:223], a[108:111], v[176:191]
    s_nop 15
    s_cmp_eq_u32 s93, 1
    s_cbranch_scc1 is_43
    s_mov_b32 s93, 1
    v_readfirstlane_b32 s74, v0
    s_nop 3
    s_cmp_lt_u32 s74, 64
    s_cbranch_scc0 is_43
    s_load_dwordx2 s[74:75], s[0:1], 96
    s_waitcnt lgkmcnt(0)
    s_mov_b32 s84, s74
    s_mov_b32 s85, s75
    s_mov_b32 s86, 0x100
    s_mov_b32 s87, 0x00020000
    v_mov_b32 v225, 8
    s_mov_b32 s74, 0
wc_44:
    buffer_load_dword v224, v225, s[84:87], 0 offen sc1
    s_add_u32 s74, s74, 1
    s_cmp_gt_u32 s74, 3000000
    s_cbranch_scc1 wk_done
    s_waitcnt vmcnt(0)
    v_readfirstlane_b32 s75, v224
    s_nop 3
    s_cmp_ge_u32 s75, 256
    s_cbranch_scc1 wc_44_ok
    s_sleep 8
    s_branch wc_44
wc_44_ok:
is_43:
    v_readfirstlane_b32 s74, v0
    s_nop 3
    s_cmp_lt_u32 s74, 64
    s_cbranch_scc0 fx_42
    v_and_b32 v232, 63, v0
    v_lshlrev_b32 v232, 4, v232
    v_add_u32 v232, 3072, v232
    s_mov_b32 s74, 0
    v_mov_b32 v224, 0
    v_mov_b32 v225, 0
    v_mov_b32 v226, 0
    v_mov_b32 v227, 0
    v_mov_b32 v228, 0
    v_mov_b32 v229, 0
    v_mov_b32 v230, 0
    v_mov_b32 v231, 0
fw_45:
    s_mov_b32 exec_lo, 0xffffffff
    s_mov_b32 exec_hi, 0xffffffff
    buffer_load_dwordx4 v[224:227], v232, s[96:99], 0 offen sc1
    s_mov_b64 exec, -1
    s_add_u32 s74, s74, 1
    s_cmp_gt_u32 s74, 3000000
    s_cbranch_scc1 wk_done
    s_waitcnt vmcnt(0)
    v_max3_u32 v224, v224, v225, v226
    v_max3_u32 v228, v228, v229, v230
    v_max3_u32 v224, v224, v227, v231
    v_max_u32 v224, v224, v228
    v_cmp_eq_u32 vcc, -1, v224
    s_cbranch_vccz fw_45_ok
    s_sleep 8
    s_branch fw_45
fw_45_ok:
fx_42:
    s_barrier
    v_lshlrev_b32 v12, 4, v2
    s_lshl_b32 s11, s10, 13
    v_add_u32 v13, s11, v12
    s_mov_b32 s39, 0
    buffer_load_dwordx4 v[192:195], v8, s[20:23], s39 offen offset:0 sc1
    buffer_load_dwordx4 v[196:199], v8, s[20:23], s39 offen offset:16 sc1
    buffer_load_dwordx4 v[200:203], v8, s[20:23], s39 offen offset:64 sc1
    buffer_load_dwordx4 v[204:207], v8, s[20:23], s39 offen offset:80 sc1
    buffer_load_dwordx4 v[208:211], v8, s[20:23], s39 offen offset:128 sc1
    buffer_load_dwordx4 v[212:215], v8, s[20:23], s39 offen offset:144 sc1
    buffer_load_dwordx4 v[216:219], v8, s[20:23], s39 offen offset:192 sc1
    buffer_load_dwordx4 v[220:223], v8, s[20:23], s39 offen offset:208 sc1
    v_cndmask_b32_e64 v48, v9, v140, s[40:41]
    v_cndmask_b32_e64 v52, v10, v140, s[40:41]
    v_cndmask_b32_e64 v49, v9, v141, s[40:41]
    v_cndmask_b32_e64 v53, v10, v141, s[40:41]
    v_cndmask_b32_e64 v50, v9, v142, s[40:41]
    v_cndmask_b32_e64 v54, v10, v142, s[40:41]
    v_cndmask_b32_e64 v51, v9, v143, s[40:41]
    v_cndmask_b32_e64 v55, v10, v143, s[40:41]
    v_max3_f32 v48, v48, v49, v50
    v_min3_f32 v52, v52, v53, v54
    v_max_f32 v48, v48, v51
    v_min_f32 v52, v52, v55
    v_max3_f32 v48, v48, v128, v129
    v_min3_f32 v52, v52, v128, v129
    v_max3_f32 v48, v48, v130, v131
    v_min3_f32 v52, v52, v130, v131
    v_max3_f32 v48, v48, v132, v133
    v_min3_f32 v52, v52, v132, v133
    v_max3_f32 v48, v48, v134, v135
    v_min3_f32 v52, v52, v134, v135
    v_max3_f32 v48, v48, v136, v137
    v_min3_f32 v52, v52, v136, v137
    v_max3_f32 v48, v48, v138, v139
    v_min3_f32 v52, v52, v138, v139
    v_mov_b32 v49, v48
    v_mov_b32 v53, v52
    s_nop 1
    v_permlane32_swap_b32 v48, v49
    v_permlane32_swap_b32 v52, v53
    s_nop 1
    v_max_f32 v48, v48, v49
    v_min_f32 v52, v52, v53
    v_sub_f32 v16, v128, v48
    v_sub_f32 v32, v52, v128
    v_sub_f32 v17, v129, v48
    v_sub_f32 v33, v52, v129
    v_sub_f32 v18, v130, v48
    v_sub_f32 v34, v52, v130
    v_sub_f32 v19, v131, v48
    v_sub_f32 v35, v52, v131
    v_sub_f32 v20, v132, v48
    v_sub_f32 v36, v52, v132
    v_sub_f32 v21, v133, v48
    v_sub_f32 v37, v52, v133
    v_sub_f32 v22, v134, v48
    v_sub_f32 v38, v52, v134
    v_sub_f32 v23, v135, v48
    v_sub_f32 v39, v52, v135
    v_sub_f32 v24, v136, v48
    v_sub_f32 v40, v52, v136
    v_sub_f32 v25, v137, v48
    v_sub_f32 v41, v52, v137
    v_sub_f32 v26, v138, v48
    v_sub_f32 v42, v52, v138
    v_sub_f32 v27, v139, v48
    v_sub_f32 v43, v52, v139
    v_sub_f32 v28, v140, v48
    v_sub_f32 v44, v52, v140
    v_sub_f32 v29, v141, v48
    v_sub_f32 v45, v52, v141
    v_sub_f32 v30, v142, v48
    v_sub_f32 v46, v52, v142
    v_sub_f32 v31, v143, v48
    v_sub_f32 v47, v52, v143
    v_mul_f32 v16, s30, v16
    v_mul_f32 v32, s30, v32
    v_mul_f32 v17, s30, v17
    v_mul_f32 v33, s30, v33
    v_mul_f32 v18, s30, v18
    v_mul_f32 v34, s30, v34
    v_mul_f32 v19, s30, v19
    v_mul_f32 v35, s30, v35
    v_mul_f32 v20, s30, v20
    v_mul_f32 v36, s30, v36
    v_mul_f32 v21, s30, v21
    v_mul_f32 v37, s30, v37
    v_mul_f32 v22, s30, v22
    v_mul_f32 v38, s30, v38
    v_mul_f32 v23, s30, v23
    v_mul_f32 v39, s30, v39
    v_mul_f32 v24, s30, v24
    v_mul_f32 v40, s30, v40
    v_mul_f32 v25, s30, v25
    v_mul_f32 v41, s30, v41
    v_mul_f32 v26, s30, v26
    v_mul_f32 v42, s30, v42
    v_mul_f32 v27, s30, v27
    v_mul_f32 v43, s30, v43
    v_mul_f32 v28, s30, v28
    v_mul_f32 v44, s30, v44
    v_mul_f32 v29, s30, v29
    v_mul_f32 v45, s30, v45
    v_mul_f32 v30, s30, v30
    v_mul_f32 v46, s30, v46
    v_mul_f32 v31, s30, v31
    v_mul_f32 v47, s30, v47
    v_exp_f32 v16, v16
    v_exp_f32 v32, v32
    v_exp_f32 v17, v17
    v_exp_f32 v33, v33
    v_exp_f32 v18, v18
    v_exp_f32 v34, v34
    v_exp_f32 v19, v19
    v_exp_f32 v35, v35
    v_exp_f32 v20, v20
    v_exp_f32 v36, v36
    v_exp_f32 v21, v21
    v_exp_f32 v37, v37
    v_exp_f32 v22, v22
    v_exp_f32 v38, v38
    v_exp_f32 v23, v23
    v_exp_f32 v39, v39
    v_exp_f32 v24, v24
    v_exp_f32 v40, v40
    v_exp_f32 v25, v25
    v_exp_f32 v41, v41
    v_exp_f32 v26, v26
    v_exp_f32 v42, v42
    v_exp_f32 v27, v27
    v_exp_f32 v43, v43
    v_exp_f32 v28, v28
    v_exp_f32 v44, v44
    v_exp_f32 v29, v29
    v_exp_f32 v45, v45
    v_exp_f32 v30, v30
    v_exp_f32 v46, v46
    v_exp_f32 v31, v31
    v_exp_f32 v47, v47
    s_nop 0
    v_cndmask_b32_e64 v28, v11, v28, s[40:41]
    v_cndmask_b32_e64 v44, v11, v44, s[40:41]
    v_cndmask_b32_e64 v29, v11, v29, s[40:41]
    v_cndmask_b32_e64 v45, v11, v45, s[40:41]
    v_cndmask_b32_e64 v30, v11, v30, s[40:41]
    v_cndmask_b32_e64 v46, v11, v46, s[40:41]
    v_cndmask_b32_e64 v31, v11, v31, s[40:41]
    v_cndmask_b32_e64 v47, v11, v47, s[40:41]
    v_add_f32 v48, v16, v17
    v_add_f32 v52, v32, v33
    v_add_f32 v48, v48, v18
    v_add_f32 v52, v52, v34
    v_add_f32 v48, v48, v19
    v_add_f32 v52, v52, v35
    v_add_f32 v48, v48, v20
    v_add_f32 v52, v52, v36
    v_add_f32 v48, v48, v21
    v_add_f32 v52, v52, v37
    v_add_f32 v48, v48, v22
    v_add_f32 v52, v52, v38
    v_add_f32 v48, v48, v23
    v_add_f32 v52, v52, v39
    v_add_f32 v48, v48, v24
    v_add_f32 v52, v52, v40
    v_add_f32 v48, v48, v25
    v_add_f32 v52, v52, v41
    v_add_f32 v48, v48, v26
    v_add_f32 v52, v52, v42
    v_add_f32 v48, v48, v27
    v_add_f32 v52, v52, v43
    v_add_f32 v48, v48, v28
    v_add_f32 v52, v52, v44
    v_add_f32 v48, v48, v29
    v_add_f32 v52, v52, v45
    v_add_f32 v48, v48, v30
    v_add_f32 v52, v52, v46
    v_add_f32 v48, v48, v31
    v_add_f32 v52, v52, v47
    v_mov_b32 v49, v48
    v_mov_b32 v53, v52
    s_nop 1
    v_permlane32_swap_b32 v48, v49
    v_permlane32_swap_b32 v52, v53
    s_nop 1
    v_add_f32 v48, v48, v49
    v_add_f32 v52, v52, v53
    v_rcp_f32 v48, v48
    v_rcp_f32 v52, v52
    s_nop 0
    v_mul_f32 v16, v16, v48
    v_mul_f32 v32, v32, v52
    v_mul_f32 v17, v17, v48
    v_mul_f32 v33, v33, v52
    v_mul_f32 v18, v18, v48
    v_mul_f32 v34, v34, v52
    v_mul_f32 v19, v19, v48
    v_mul_f32 v35, v35, v52
    v_mul_f32 v20, v20, v48
    v_mul_f32 v36, v36, v52
    v_mul_f32 v21, v21, v48
    v_mul_f32 v37, v37, v52
    v_mul_f32 v22, v22, v48
    v_mul_f32 v38, v38, v52
    v_mul_f32 v23, v23, v48
    v_mul_f32 v39, v39, v52
    v_mul_f32 v24, v24, v48
    v_mul_f32 v40, v40, v52
    v_mul_f32 v25, v25, v48
    v_mul_f32 v41, v41, v52
    v_mul_f32 v26, v26, v48
    v_mul_f32 v42, v42, v52
    v_mul_f32 v27, v27, v48
    v_mul_f32 v43, v43, v52
    v_mul_f32 v28, v28, v48
    v_mul_f32 v44, v44, v52
    v_mul_f32 v29, v29, v48
    v_mul_f32 v45, v45, v52
    v_mul_f32 v30, v30, v48
    v_mul_f32 v46, v46, v52
    v_mul_f32 v31, v31, v48
    v_mul_f32 v47, v47, v52
    v_cvt_pk_bf16_f32 v56, v16, v17
    v_cvt_pk_bf16_f32 v57, v18, v19
    v_cvt_pk_bf16_f32 v58, v20, v21
    v_cvt_pk_bf16_f32 v59, v22, v23
    v_cvt_pk_bf16_f32 v60, v24, v25
    v_cvt_pk_bf16_f32 v61, v26, v27
    v_cvt_pk_bf16_f32 v62, v28, v29
    v_cvt_pk_bf16_f32 v63, v30, v31
    v_cvt_pk_bf16_f32 v64, v32, v33
    v_cvt_pk_bf16_f32 v65, v34, v35
    v_cvt_pk_bf16_f32 v66, v36, v37
    v_cvt_pk_bf16_f32 v67, v38, v39
    v_cvt_pk_bf16_f32 v68, v40, v41
    v_cvt_pk_bf16_f32 v69, v42, v43
    v_cvt_pk_bf16_f32 v70, v44, v45
    v_cvt_pk_bf16_f32 v71, v46, v47
    s_waitcnt vmcnt(0)
    v_cvt_pk_bf16_f32 v72, v192, v193
    v_cvt_pk_bf16_f32 v73, v194, v195
    v_cvt_pk_bf16_f32 v74, v196, v197
    v_cvt_pk_bf16_f32 v75, v198, v199
    v_cvt_pk_bf16_f32 v76, v200, v201
    v_cvt_pk_bf16_f32 v77, v202, v203
    v_cvt_pk_bf16_f32 v78, v204, v205
    v_cvt_pk_bf16_f32 v79, v206, v207
    v_cvt_pk_bf16_f32 v80, v208, v209
    v_cvt_pk_bf16_f32 v81, v210, v211
    v_cvt_pk_bf16_f32 v82, v212, v213
    v_cvt_pk_bf16_f32 v83, v214, v215
    v_cvt_pk_bf16_f32 v84, v216, v217
    v_cvt_pk_bf16_f32 v85, v218, v219
    v_cvt_pk_bf16_f32 v86, v220, v221
    v_cvt_pk_bf16_f32 v87, v222, v223
    s_nop 1
    v_mfma_f32_32x32x16_bf16 v[88:103], v[72:75], v[56:59], 0
    v_mfma_f32_32x32x16_bf16 v[88:103], v[76:79], v[60:63], v[88:103]
    v_mfma_f32_32x32x16_bf16 v[88:103], v[80:83], v[64:67], v[88:103]
    v_mfma_f32_32x32x16_bf16 v[88:103], v[84:87], v[68:71], v[88:103]
    s_nop 15
    s_nop 1
    v_mov_b32 v48, v100
    v_mov_b32 v49, v100
    s_nop 1
    v_permlane32_swap_b32 v48, v49
    s_nop 1
    v_add_f32 v49, 0x358637bd, v49
    v_rcp_f32 v49, v49
    s_nop 0
    v_mul_f32 v88, v88, v49
    v_mul_f32 v89, v89, v49
    v_mul_f32 v90, v90, v49
    v_mul_f32 v91, v91, v49
    v_mul_f32 v92, v92, v49
    v_mul_f32 v93, v93, v49
    v_mul_f32 v94, v94, v49
    v_mul_f32 v95, v95, v49
    v_mul_f32 v96, v96, v49
    v_mul_f32 v97, v97, v49
    v_mul_f32 v98, v98, v49
    v_mul_f32 v99, v99, v49
    v_mul_f32 v100, v100, v49
    v_mul_f32 v101, v101, v49
    v_mul_f32 v102, v102, v49
    v_mul_f32 v103, v103, v49
    v_cvt_pk_bf16_f32 v104, v88, v89
    v_cvt_pk_bf16_f32 v105, v90, v91
    v_cvt_pk_bf16_f32 v106, v92, v93
    v_cvt_pk_bf16_f32 v107, v94, v95
    v_cvt_pk_bf16_f32 v108, v96, v97
    v_cvt_pk_bf16_f32 v109, v98, v99
    v_cvt_pk_bf16_f32 v110, v100, v101
    v_cvt_pk_bf16_f32 v111, v102, v103
    ds_write_b128 v13, v[104:107] offset:0
    ds_write_b128 v13, v[108:111] offset:1024
    s_nop 1
    s_mov_b32 s39, 8192
    buffer_load_dwordx4 v[192:195], v8, s[20:23], s39 offen offset:0 sc1
    buffer_load_dwordx4 v[196:199], v8, s[20:23], s39 offen offset:16 sc1
    buffer_load_dwordx4 v[200:203], v8, s[20:23], s39 offen offset:64 sc1
    buffer_load_dwordx4 v[204:207], v8, s[20:23], s39 offen offset:80 sc1
    buffer_load_dwordx4 v[208:211], v8, s[20:23], s39 offen offset:128 sc1
    buffer_load_dwordx4 v[212:215], v8, s[20:23], s39 offen offset:144 sc1
    buffer_load_dwordx4 v[216:219], v8, s[20:23], s39 offen offset:192 sc1
    buffer_load_dwordx4 v[220:223], v8, s[20:23], s39 offen offset:208 sc1
    v_cndmask_b32_e64 v48, v9, v156, s[40:41]
    v_cndmask_b32_e64 v52, v10, v156, s[40:41]
    v_cndmask_b32_e64 v49, v9, v157, s[40:41]
    v_cndmask_b32_e64 v53, v10, v157, s[40:41]
    v_cndmask_b32_e64 v50, v9, v158, s[40:41]
    v_cndmask_b32_e64 v54, v10, v158, s[40:41]
    v_cndmask_b32_e64 v51, v9, v159, s[40:41]
    v_cndmask_b32_e64 v55, v10, v159, s[40:41]
    v_max3_f32 v48, v48, v49, v50
    v_min3_f32 v52, v52, v53, v54
    v_max_f32 v48, v48, v51
    v_min_f32 v52, v52, v55
    v_max3_f32 v48, v48, v144, v145
    v_min3_f32 v52, v52, v144, v145
    v_max3_f32 v48, v48, v146, v147
    v_min3_f32 v52, v52, v146, v147
    v_max3_f32 v48, v48, v148, v149
    v_min3_f32 v52, v52, v148, v149
    v_max3_f32 v48, v48, v150, v151
    v_min3_f32 v52, v52, v150, v151
    v_max3_f32 v48, v48, v152, v153
    v_min3_f32 v52, v52, v152, v153
    v_max3_f32 v48, v48, v154, v155
    v_min3_f32 v52, v52, v154, v155
    v_mov_b32 v49, v48
    v_mov_b32 v53, v52
    s_nop 1
    v_permlane32_swap_b32 v48, v49
    v_permlane32_swap_b32 v52, v53
    s_nop 1
    v_max_f32 v48, v48, v49
    v_min_f32 v52, v52, v53
    v_sub_f32 v16, v144, v48
    v_sub_f32 v32, v52, v144
    v_sub_f32 v17, v145, v48
    v_sub_f32 v33, v52, v145
    v_sub_f32 v18, v146, v48
    v_sub_f32 v34, v52, v146
    v_sub_f32 v19, v147, v48
    v_sub_f32 v35, v52, v147
    v_sub_f32 v20, v148, v48
    v_sub_f32 v36, v52, v148
    v_sub_f32 v21, v149, v48
    v_sub_f32 v37, v52, v149
    v_sub_f32 v22, v150, v48
    v_sub_f32 v38, v52, v150
    v_sub_f32 v23, v151, v48
    v_sub_f32 v39, v52, v151
    v_sub_f32 v24, v152, v48
    v_sub_f32 v40, v52, v152
    v_sub_f32 v25, v153, v48
    v_sub_f32 v41, v52, v153
    v_sub_f32 v26, v154, v48
    v_sub_f32 v42, v52, v154
    v_sub_f32 v27, v155, v48
    v_sub_f32 v43, v52, v155
    v_sub_f32 v28, v156, v48
    v_sub_f32 v44, v52, v156
    v_sub_f32 v29, v157, v48
    v_sub_f32 v45, v52, v157
    v_sub_f32 v30, v158, v48
    v_sub_f32 v46, v52, v158
    v_sub_f32 v31, v159, v48
    v_sub_f32 v47, v52, v159
    v_mul_f32 v16, s30, v16
    v_mul_f32 v32, s30, v32
    v_mul_f32 v17, s30, v17
    v_mul_f32 v33, s30, v33
    v_mul_f32 v18, s30, v18
    v_mul_f32 v34, s30, v34
    v_mul_f32 v19, s30, v19
    v_mul_f32 v35, s30, v35
    v_mul_f32 v20, s30, v20
    v_mul_f32 v36, s30, v36
    v_mul_f32 v21, s30, v21
    v_mul_f32 v37, s30, v37
    v_mul_f32 v22, s30, v22
    v_mul_f32 v38, s30, v38
    v_mul_f32 v23, s30, v23
    v_mul_f32 v39, s30, v39
    v_mul_f32 v24, s30, v24
    v_mul_f32 v40, s30, v40
    v_mul_f32 v25, s30, v25
    v_mul_f32 v41, s30, v41
    v_mul_f32 v26, s30, v26
    v_mul_f32 v42, s30, v42
    v_mul_f32 v27, s30, v27
    v_mul_f32 v43, s30, v43
    v_mul_f32 v28, s30, v28
    v_mul_f32 v44, s30, v44
    v_mul_f32 v29, s30, v29
    v_mul_f32 v45, s30, v45
    v_mul_f32 v30, s30, v30
    v_mul_f32 v46, s30, v46
    v_mul_f32 v31, s30, v31
    v_mul_f32 v47, s30, v47
    v_exp_f32 v16, v16
    v_exp_f32 v32, v32
    v_exp_f32 v17, v17
    v_exp_f32 v33, v33
    v_exp_f32 v18, v18
    v_exp_f32 v34, v34
    v_exp_f32 v19, v19
    v_exp_f32 v35, v35
    v_exp_f32 v20, v20
    v_exp_f32 v36, v36
    v_exp_f32 v21, v21
    v_exp_f32 v37, v37
    v_exp_f32 v22, v22
    v_exp_f32 v38, v38
    v_exp_f32 v23, v23
    v_exp_f32 v39, v39
    v_exp_f32 v24, v24
    v_exp_f32 v40, v40
    v_exp_f32 v25, v25
    v_exp_f32 v41, v41
    v_exp_f32 v26, v26
    v_exp_f32 v42, v42
    v_exp_f32 v27, v27
    v_exp_f32 v43, v43
    v_exp_f32 v28, v28
    v_exp_f32 v44, v44
    v_exp_f32 v29, v29
    v_exp_f32 v45, v45
    v_exp_f32 v30, v30
    v_exp_f32 v46, v46
    v_exp_f32 v31, v31
    v_exp_f32 v47, v47
    s_nop 0
    v_cndmask_b32_e64 v28, v11, v28, s[40:41]
    v_cndmask_b32_e64 v44, v11, v44, s[40:41]
    v_cndmask_b32_e64 v29, v11, v29, s[40:41]
    v_cndmask_b32_e64 v45, v11, v45, s[40:41]
    v_cndmask_b32_e64 v30, v11, v30, s[40:41]
    v_cndmask_b32_e64 v46, v11, v46, s[40:41]
    v_cndmask_b32_e64 v31, v11, v31, s[40:41]
    v_cndmask_b32_e64 v47, v11, v47, s[40:41]
    v_add_f32 v48, v16, v17
    v_add_f32 v52, v32, v33
    v_add_f32 v48, v48, v18
    v_add_f32 v52, v52, v34
    v_add_f32 v48, v48, v19
    v_add_f32 v52, v52, v35
    v_add_f32 v48, v48, v20
    v_add_f32 v52, v52, v36
    v_add_f32 v48, v48, v21
    v_add_f32 v52, v52, v37
    v_add_f32 v48, v48, v22
    v_add_f32 v52, v52, v38
    v_add_f32 v48, v48, v23
    v_add_f32 v52, v52, v39
    v_add_f32 v48, v48, v24
    v_add_f32 v52, v52, v40
    v_add_f32 v48, v48, v25
    v_add_f32 v52, v52, v41
    v_add_f32 v48, v48, v26
    v_add_f32 v52, v52, v42
    v_add_f32 v48, v48, v27
    v_add_f32 v52, v52, v43
    v_add_f32 v48, v48, v28
    v_add_f32 v52, v52, v44
    v_add_f32 v48, v48, v29
    v_add_f32 v52, v52, v45
    v_add_f32 v48, v48, v30
    v_add_f32 v52, v52, v46
    v_add_f32 v48, v48, v31
    v_add_f32 v52, v52, v47
    v_mov_b32 v49, v48
    v_mov_b32 v53, v52
    s_nop 1
    v_permlane32_swap_b32 v48, v49
    v_permlane32_swap_b32 v52, v53
    s_nop 1
    v_add_f32 v48, v48, v49
    v_add_f32 v52, v52, v53
    v_rcp_f32 v48, v48
    v_rcp_f32 v52, v52
    s_nop 0
    v_mul_f32 v16, v16, v48
    v_mul_f32 v32, v32, v52
    v_mul_f32 v17, v17, v48
    v_mul_f32 v33, v33, v52
    v_mul_f32 v18, v18, v48
    v_mul_f32 v34, v34, v52
    v_mul_f32 v19, v19, v48
    v_mul_f32 v35, v35, v52
    v_mul_f32 v20, v20, v48
    v_mul_f32 v36, v36, v52
    v_mul_f32 v21, v21, v48
    v_mul_f32 v37, v37, v52
    v_mul_f32 v22, v22, v48
    v_mul_f32 v38, v38, v52
    v_mul_f32 v23, v23, v48
    v_mul_f32 v39, v39, v52
    v_mul_f32 v24, v24, v48
    v_mul_f32 v40, v40, v52
    v_mul_f32 v25, v25, v48
    v_mul_f32 v41, v41, v52
    v_mul_f32 v26, v26, v48
    v_mul_f32 v42, v42, v52
    v_mul_f32 v27, v27, v48
    v_mul_f32 v43, v43, v52
    v_mul_f32 v28, v28, v48
    v_mul_f32 v44, v44, v52
    v_mul_f32 v29, v29, v48
    v_mul_f32 v45, v45, v52
    v_mul_f32 v30, v30, v48
    v_mul_f32 v46, v46, v52
    v_mul_f32 v31, v31, v48
    v_mul_f32 v47, v47, v52
    v_cvt_pk_bf16_f32 v56, v16, v17
    v_cvt_pk_bf16_f32 v57, v18, v19
    v_cvt_pk_bf16_f32 v58, v20, v21
    v_cvt_pk_bf16_f32 v59, v22, v23
    v_cvt_pk_bf16_f32 v60, v24, v25
    v_cvt_pk_bf16_f32 v61, v26, v27
    v_cvt_pk_bf16_f32 v62, v28, v29
    v_cvt_pk_bf16_f32 v63, v30, v31
    v_cvt_pk_bf16_f32 v64, v32, v33
    v_cvt_pk_bf16_f32 v65, v34, v35
    v_cvt_pk_bf16_f32 v66, v36, v37
    v_cvt_pk_bf16_f32 v67, v38, v39
    v_cvt_pk_bf16_f32 v68, v40, v41
    v_cvt_pk_bf16_f32 v69, v42, v43
    v_cvt_pk_bf16_f32 v70, v44, v45
    v_cvt_pk_bf16_f32 v71, v46, v47
    s_waitcnt vmcnt(0)
    v_cvt_pk_bf16_f32 v72, v192, v193
    v_cvt_pk_bf16_f32 v73, v194, v195
    v_cvt_pk_bf16_f32 v74, v196, v197
    v_cvt_pk_bf16_f32 v75, v198, v199
    v_cvt_pk_bf16_f32 v76, v200, v201
    v_cvt_pk_bf16_f32 v77, v202, v203
    v_cvt_pk_bf16_f32 v78, v204, v205
    v_cvt_pk_bf16_f32 v79, v206, v207
    v_cvt_pk_bf16_f32 v80, v208, v209
    v_cvt_pk_bf16_f32 v81, v210, v211
    v_cvt_pk_bf16_f32 v82, v212, v213
    v_cvt_pk_bf16_f32 v83, v214, v215
    v_cvt_pk_bf16_f32 v84, v216, v217
    v_cvt_pk_bf16_f32 v85, v218, v219
    v_cvt_pk_bf16_f32 v86, v220, v221
    v_cvt_pk_bf16_f32 v87, v222, v223
    s_nop 1
    v_mfma_f32_32x32x16_bf16 v[88:103], v[72:75], v[56:59], 0
    v_mfma_f32_32x32x16_bf16 v[88:103], v[76:79], v[60:63], v[88:103]
    v_mfma_f32_32x32x16_bf16 v[88:103], v[80:83], v[64:67], v[88:103]
    v_mfma_f32_32x32x16_bf16 v[88:103], v[84:87], v[68:71], v[88:103]
    s_nop 15
    s_nop 1
    v_mov_b32 v48, v100
    v_mov_b32 v49, v100
    s_nop 1
    v_permlane32_swap_b32 v48, v49
    s_nop 1
    v_add_f32 v49, 0x358637bd, v49
    v_rcp_f32 v49, v49
    s_nop 0
    v_mul_f32 v88, v88, v49
    v_mul_f32 v89, v89, v49
    v_mul_f32 v90, v90, v49
    v_mul_f32 v91, v91, v49
    v_mul_f32 v92, v92, v49
    v_mul_f32 v93, v93, v49
    v_mul_f32 v94, v94, v49
    v_mul_f32 v95, v95, v49
    v_mul_f32 v96, v96, v49
    v_mul_f32 v97, v97, v49
    v_mul_f32 v98, v98, v49
    v_mul_f32 v99, v99, v49
    v_mul_f32 v100, v100, v49
    v_mul_f32 v101, v101, v49
    v_mul_f32 v102, v102, v49
    v_mul_f32 v103, v103, v49
    v_cvt_pk_bf16_f32 v104, v88, v89
    v_cvt_pk_bf16_f32 v105, v90, v91
    v_cvt_pk_bf16_f32 v106, v92, v93
    v_cvt_pk_bf16_f32 v107, v94, v95
    v_cvt_pk_bf16_f32 v108, v96, v97
    v_cvt_pk_bf16_f32 v109, v98, v99
    v_cvt_pk_bf16_f32 v110, v100, v101
    v_cvt_pk_bf16_f32 v111, v102, v103
    ds_write_b128 v13, v[104:107] offset:2048
    ds_write_b128 v13, v[108:111] offset:3072
    s_nop 1
    s_mov_b32 s39, 16384
    buffer_load_dwordx4 v[192:195], v8, s[20:23], s39 offen offset:0 sc1
    buffer_load_dwordx4 v[196:199], v8, s[20:23], s39 offen offset:16 sc1
    buffer_load_dwordx4 v[200:203], v8, s[20:23], s39 offen offset:64 sc1
    buffer_load_dwordx4 v[204:207], v8, s[20:23], s39 offen offset:80 sc1
    buffer_load_dwordx4 v[208:211], v8, s[20:23], s39 offen offset:128 sc1
    buffer_load_dwordx4 v[212:215], v8, s[20:23], s39 offen offset:144 sc1
    buffer_load_dwordx4 v[216:219], v8, s[20:23], s39 offen offset:192 sc1
    buffer_load_dwordx4 v[220:223], v8, s[20:23], s39 offen offset:208 sc1
    v_cndmask_b32_e64 v48, v9, v172, s[40:41]
    v_cndmask_b32_e64 v52, v10, v172, s[40:41]
    v_cndmask_b32_e64 v49, v9, v173, s[40:41]
    v_cndmask_b32_e64 v53, v10, v173, s[40:41]
    v_cndmask_b32_e64 v50, v9, v174, s[40:41]
    v_cndmask_b32_e64 v54, v10, v174, s[40:41]
    v_cndmask_b32_e64 v51, v9, v175, s[40:41]
    v_cndmask_b32_e64 v55, v10, v175, s[40:41]
    v_max3_f32 v48, v48, v49, v50
    v_min3_f32 v52, v52, v53, v54
    v_max_f32 v48, v48, v51
    v_min_f32 v52, v52, v55
    v_max3_f32 v48, v48, v160, v161
    v_min3_f32 v52, v52, v160, v161
    v_max3_f32 v48, v48, v162, v163
    v_min3_f32 v52, v52, v162, v163
    v_max3_f32 v48, v48, v164, v165
    v_min3_f32 v52, v52, v164, v165
    v_max3_f32 v48, v48, v166, v167
    v_min3_f32 v52, v52, v166, v167
    v_max3_f32 v48, v48, v168, v169
    v_min3_f32 v52, v52, v168, v169
    v_max3_f32 v48, v48, v170, v171
    v_min3_f32 v52, v52, v170, v171
    v_mov_b32 v49, v48
    v_mov_b32 v53, v52
    s_nop 1
    v_permlane32_swap_b32 v48, v49
    v_permlane32_swap_b32 v52, v53
    s_nop 1
    v_max_f32 v48, v48, v49
    v_min_f32 v52, v52, v53
    v_sub_f32 v16, v160, v48
    v_sub_f32 v32, v52, v160
    v_sub_f32 v17, v161, v48
    v_sub_f32 v33, v52, v161
    v_sub_f32 v18, v162, v48
    v_sub_f32 v34, v52, v162
    v_sub_f32 v19, v163, v48
    v_sub_f32 v35, v52, v163
    v_sub_f32 v20, v164, v48
    v_sub_f32 v36, v52, v164
    v_sub_f32 v21, v165, v48
    v_sub_f32 v37, v52, v165
    v_sub_f32 v22, v166, v48
    v_sub_f32 v38, v52, v166
    v_sub_f32 v23, v167, v48
    v_sub_f32 v39, v52, v167
    v_sub_f32 v24, v168, v48
    v_sub_f32 v40, v52, v168
    v_sub_f32 v25, v169, v48
    v_sub_f32 v41, v52, v169
    v_sub_f32 v26, v170, v48
    v_sub_f32 v42, v52, v170
    v_sub_f32 v27, v171, v48
    v_sub_f32 v43, v52, v171
    v_sub_f32 v28, v172, v48
    v_sub_f32 v44, v52, v172
    v_sub_f32 v29, v173, v48
    v_sub_f32 v45, v52, v173
    v_sub_f32 v30, v174, v48
    v_sub_f32 v46, v52, v174
    v_sub_f32 v31, v175, v48
    v_sub_f32 v47, v52, v175
    v_mul_f32 v16, s30, v16
    v_mul_f32 v32, s30, v32
    v_mul_f32 v17, s30, v17
    v_mul_f32 v33, s30, v33
    v_mul_f32 v18, s30, v18
    v_mul_f32 v34, s30, v34
    v_mul_f32 v19, s30, v19
    v_mul_f32 v35, s30, v35
    v_mul_f32 v20, s30, v20
    v_mul_f32 v36, s30, v36
    v_mul_f32 v21, s30, v21
    v_mul_f32 v37, s30, v37
    v_mul_f32 v22, s30, v22
    v_mul_f32 v38, s30, v38
    v_mul_f32 v23, s30, v23
    v_mul_f32 v39, s30, v39
    v_mul_f32 v24, s30, v24
    v_mul_f32 v40, s30, v40
    v_mul_f32 v25, s30, v25
    v_mul_f32 v41, s30, v41
    v_mul_f32 v26, s30, v26
    v_mul_f32 v42, s30, v42
    v_mul_f32 v27, s30, v27
    v_mul_f32 v43, s30, v43
    v_mul_f32 v28, s30, v28
    v_mul_f32 v44, s30, v44
    v_mul_f32 v29, s30, v29
    v_mul_f32 v45, s30, v45
    v_mul_f32 v30, s30, v30
    v_mul_f32 v46, s30, v46
    v_mul_f32 v31, s30, v31
    v_mul_f32 v47, s30, v47
    v_exp_f32 v16, v16
    v_exp_f32 v32, v32
    v_exp_f32 v17, v17
    v_exp_f32 v33, v33
    v_exp_f32 v18, v18
    v_exp_f32 v34, v34
    v_exp_f32 v19, v19
    v_exp_f32 v35, v35
    v_exp_f32 v20, v20
    v_exp_f32 v36, v36
    v_exp_f32 v21, v21
    v_exp_f32 v37, v37
    v_exp_f32 v22, v22
    v_exp_f32 v38, v38
    v_exp_f32 v23, v23
    v_exp_f32 v39, v39
    v_exp_f32 v24, v24
    v_exp_f32 v40, v40
    v_exp_f32 v25, v25
    v_exp_f32 v41, v41
    v_exp_f32 v26, v26
    v_exp_f32 v42, v42
    v_exp_f32 v27, v27
    v_exp_f32 v43, v43
    v_exp_f32 v28, v28
    v_exp_f32 v44, v44
    v_exp_f32 v29, v29
    v_exp_f32 v45, v45
    v_exp_f32 v30, v30
    v_exp_f32 v46, v46
    v_exp_f32 v31, v31
    v_exp_f32 v47, v47
    s_nop 0
    v_cndmask_b32_e64 v28, v11, v28, s[40:41]
    v_cndmask_b32_e64 v44, v11, v44, s[40:41]
    v_cndmask_b32_e64 v29, v11, v29, s[40:41]
    v_cndmask_b32_e64 v45, v11, v45, s[40:41]
    v_cndmask_b32_e64 v30, v11, v30, s[40:41]
    v_cndmask_b32_e64 v46, v11, v46, s[40:41]
    v_cndmask_b32_e64 v31, v11, v31, s[40:41]
    v_cndmask_b32_e64 v47, v11, v47, s[40:41]
    v_add_f32 v48, v16, v17
    v_add_f32 v52, v32, v33
    v_add_f32 v48, v48, v18
    v_add_f32 v52, v52, v34
    v_add_f32 v48, v48, v19
    v_add_f32 v52, v52, v35
    v_add_f32 v48, v48, v20
    v_add_f32 v52, v52, v36
    v_add_f32 v48, v48, v21
    v_add_f32 v52, v52, v37
    v_add_f32 v48, v48, v22
    v_add_f32 v52, v52, v38
    v_add_f32 v48, v48, v23
    v_add_f32 v52, v52, v39
    v_add_f32 v48, v48, v24
    v_add_f32 v52, v52, v40
    v_add_f32 v48, v48, v25
    v_add_f32 v52, v52, v41
    v_add_f32 v48, v48, v26
    v_add_f32 v52, v52, v42
    v_add_f32 v48, v48, v27
    v_add_f32 v52, v52, v43
    v_add_f32 v48, v48, v28
    v_add_f32 v52, v52, v44
    v_add_f32 v48, v48, v29
    v_add_f32 v52, v52, v45
    v_add_f32 v48, v48, v30
    v_add_f32 v52, v52, v46
    v_add_f32 v48, v48, v31
    v_add_f32 v52, v52, v47
    v_mov_b32 v49, v48
    v_mov_b32 v53, v52
    s_nop 1
    v_permlane32_swap_b32 v48, v49
    v_permlane32_swap_b32 v52, v53
    s_nop 1
    v_add_f32 v48, v48, v49
    v_add_f32 v52, v52, v53
    v_rcp_f32 v48, v48
    v_rcp_f32 v52, v52
    s_nop 0
    v_mul_f32 v16, v16, v48
    v_mul_f32 v32, v32, v52
    v_mul_f32 v17, v17, v48
    v_mul_f32 v33, v33, v52
    v_mul_f32 v18, v18, v48
    v_mul_f32 v34, v34, v52
    v_mul_f32 v19, v19, v48
    v_mul_f32 v35, v35, v52
    v_mul_f32 v20, v20, v48
    v_mul_f32 v36, v36, v52
    v_mul_f32 v21, v21, v48
    v_mul_f32 v37, v37, v52
    v_mul_f32 v22, v22, v48
    v_mul_f32 v38, v38, v52
    v_mul_f32 v23, v23, v48
    v_mul_f32 v39, v39, v52
    v_mul_f32 v24, v24, v48
    v_mul_f32 v40, v40, v52
    v_mul_f32 v25, v25, v48
    v_mul_f32 v41, v41, v52
    v_mul_f32 v26, v26, v48
    v_mul_f32 v42, v42, v52
    v_mul_f32 v27, v27, v48
    v_mul_f32 v43, v43, v52
    v_mul_f32 v28, v28, v48
    v_mul_f32 v44, v44, v52
    v_mul_f32 v29, v29, v48
    v_mul_f32 v45, v45, v52
    v_mul_f32 v30, v30, v48
    v_mul_f32 v46, v46, v52
    v_mul_f32 v31, v31, v48
    v_mul_f32 v47, v47, v52
    v_cvt_pk_bf16_f32 v56, v16, v17
    v_cvt_pk_bf16_f32 v57, v18, v19
    v_cvt_pk_bf16_f32 v58, v20, v21
    v_cvt_pk_bf16_f32 v59, v22, v23
    v_cvt_pk_bf16_f32 v60, v24, v25
    v_cvt_pk_bf16_f32 v61, v26, v27
    v_cvt_pk_bf16_f32 v62, v28, v29
    v_cvt_pk_bf16_f32 v63, v30, v31
    v_cvt_pk_bf16_f32 v64, v32, v33
    v_cvt_pk_bf16_f32 v65, v34, v35
    v_cvt_pk_bf16_f32 v66, v36, v37
    v_cvt_pk_bf16_f32 v67, v38, v39
    v_cvt_pk_bf16_f32 v68, v40, v41
    v_cvt_pk_bf16_f32 v69, v42, v43
    v_cvt_pk_bf16_f32 v70, v44, v45
    v_cvt_pk_bf16_f32 v71, v46, v47
    s_waitcnt vmcnt(0)
    v_cvt_pk_bf16_f32 v72, v192, v193
    v_cvt_pk_bf16_f32 v73, v194, v195
    v_cvt_pk_bf16_f32 v74, v196, v197
    v_cvt_pk_bf16_f32 v75, v198, v199
    v_cvt_pk_bf16_f32 v76, v200, v201
    v_cvt_pk_bf16_f32 v77, v202, v203
    v_cvt_pk_bf16_f32 v78, v204, v205
    v_cvt_pk_bf16_f32 v79, v206, v207
    v_cvt_pk_bf16_f32 v80, v208, v209
    v_cvt_pk_bf16_f32 v81, v210, v211
    v_cvt_pk_bf16_f32 v82, v212, v213
    v_cvt_pk_bf16_f32 v83, v214, v215
    v_cvt_pk_bf16_f32 v84, v216, v217
    v_cvt_pk_bf16_f32 v85, v218, v219
    v_cvt_pk_bf16_f32 v86, v220, v221
    v_cvt_pk_bf16_f32 v87, v222, v223
    s_nop 1
    v_mfma_f32_32x32x16_bf16 v[88:103], v[72:75], v[56:59], 0
    v_mfma_f32_32x32x16_bf16 v[88:103], v[76:79], v[60:63], v[88:103]
    v_mfma_f32_32x32x16_bf16 v[88:103], v[80:83], v[64:67], v[88:103]
    v_mfma_f32_32x32x16_bf16 v[88:103], v[84:87], v[68:71], v[88:103]
    s_nop 15
    s_nop 1
    v_mov_b32 v48, v100
    v_mov_b32 v49, v100
    s_nop 1
    v_permlane32_swap_b32 v48, v49
    s_nop 1
    v_add_f32 v49, 0x358637bd, v49
    v_rcp_f32 v49, v49
    s_nop 0
    v_mul_f32 v88, v88, v49
    v_mul_f32 v89, v89, v49
    v_mul_f32 v90, v90, v49
    v_mul_f32 v91, v91, v49
    v_mul_f32 v92, v92, v49
    v_mul_f32 v93, v93, v49
    v_mul_f32 v94, v94, v49
    v_mul_f32 v95, v95, v49
    v_mul_f32 v96, v96, v49
    v_mul_f32 v97, v97, v49
    v_mul_f32 v98, v98, v49
    v_mul_f32 v99, v99, v49
    v_mul_f32 v100, v100, v49
    v_mul_f32 v101, v101, v49
    v_mul_f32 v102, v102, v49
    v_mul_f32 v103, v103, v49
    v_cvt_pk_bf16_f32 v104, v88, v89
    v_cvt_pk_bf16_f32 v105, v90, v91
    v_cvt_pk_bf16_f32 v106, v92, v93
    v_cvt_pk_bf16_f32 v107, v94, v95
    v_cvt_pk_bf16_f32 v108, v96, v97
    v_cvt_pk_bf16_f32 v109, v98, v99
    v_cvt_pk_bf16_f32 v110, v100, v101
    v_cvt_pk_bf16_f32 v111, v102, v103
    ds_write_b128 v13, v[104:107] offset:4096
    ds_write_b128 v13, v[108:111] offset:5120
    s_nop 1
    s_mov_b32 s39, 24576
    buffer_load_dwordx4 v[192:195], v8, s[20:23], s39 offen offset:0 sc1
    buffer_load_dwordx4 v[196:199], v8, s[20:23], s39 offen offset:16 sc1
    buffer_load_dwordx4 v[200:203], v8, s[20:23], s39 offen offset:64 sc1
    buffer_load_dwordx4 v[204:207], v8, s[20:23], s39 offen offset:80 sc1
    buffer_load_dwordx4 v[208:211], v8, s[20:23], s39 offen offset:128 sc1
    buffer_load_dwordx4 v[212:215], v8, s[20:23], s39 offen offset:144 sc1
    buffer_load_dwordx4 v[216:219], v8, s[20:23], s39 offen offset:192 sc1
    buffer_load_dwordx4 v[220:223], v8, s[20:23], s39 offen offset:208 sc1
    v_cndmask_b32_e64 v48, v9, v188, s[40:41]
    v_cndmask_b32_e64 v52, v10, v188, s[40:41]
    v_cndmask_b32_e64 v49, v9, v189, s[40:41]
    v_cndmask_b32_e64 v53, v10, v189, s[40:41]
    v_cndmask_b32_e64 v50, v9, v190, s[40:41]
    v_cndmask_b32_e64 v54, v10, v190, s[40:41]
    v_cndmask_b32_e64 v51, v9, v191, s[40:41]
    v_cndmask_b32_e64 v55, v10, v191, s[40:41]
    v_max3_f32 v48, v48, v49, v50
    v_min3_f32 v52, v52, v53, v54
    v_max_f32 v48, v48, v51
    v_min_f32 v52, v52, v55
    v_max3_f32 v48, v48, v176, v177
    v_min3_f32 v52, v52, v176, v177
    v_max3_f32 v48, v48, v178, v179
    v_min3_f32 v52, v52, v178, v179
    v_max3_f32 v48, v48, v180, v181
    v_min3_f32 v52, v52, v180, v181
    v_max3_f32 v48, v48, v182, v183
    v_min3_f32 v52, v52, v182, v183
    v_max3_f32 v48, v48, v184, v185
    v_min3_f32 v52, v52, v184, v185
    v_max3_f32 v48, v48, v186, v187
    v_min3_f32 v52, v52, v186, v187
    v_mov_b32 v49, v48
    v_mov_b32 v53, v52
    s_nop 1
    v_permlane32_swap_b32 v48, v49
    v_permlane32_swap_b32 v52, v53
    s_nop 1
    v_max_f32 v48, v48, v49
    v_min_f32 v52, v52, v53
    v_sub_f32 v16, v176, v48
    v_sub_f32 v32, v52, v176
    v_sub_f32 v17, v177, v48
    v_sub_f32 v33, v52, v177
    v_sub_f32 v18, v178, v48
    v_sub_f32 v34, v52, v178
    v_sub_f32 v19, v179, v48
    v_sub_f32 v35, v52, v179
    v_sub_f32 v20, v180, v48
    v_sub_f32 v36, v52, v180
    v_sub_f32 v21, v181, v48
    v_sub_f32 v37, v52, v181
    v_sub_f32 v22, v182, v48
    v_sub_f32 v38, v52, v182
    v_sub_f32 v23, v183, v48
    v_sub_f32 v39, v52, v183
    v_sub_f32 v24, v184, v48
    v_sub_f32 v40, v52, v184
    v_sub_f32 v25, v185, v48
    v_sub_f32 v41, v52, v185
    v_sub_f32 v26, v186, v48
    v_sub_f32 v42, v52, v186
    v_sub_f32 v27, v187, v48
    v_sub_f32 v43, v52, v187
    v_sub_f32 v28, v188, v48
    v_sub_f32 v44, v52, v188
    v_sub_f32 v29, v189, v48
    v_sub_f32 v45, v52, v189
    v_sub_f32 v30, v190, v48
    v_sub_f32 v46, v52, v190
    v_sub_f32 v31, v191, v48
    v_sub_f32 v47, v52, v191
    v_mul_f32 v16, s30, v16
    v_mul_f32 v32, s30, v32
    v_mul_f32 v17, s30, v17
    v_mul_f32 v33, s30, v33
    v_mul_f32 v18, s30, v18
    v_mul_f32 v34, s30, v34
    v_mul_f32 v19, s30, v19
    v_mul_f32 v35, s30, v35
    v_mul_f32 v20, s30, v20
    v_mul_f32 v36, s30, v36
    v_mul_f32 v21, s30, v21
    v_mul_f32 v37, s30, v37
    v_mul_f32 v22, s30, v22
    v_mul_f32 v38, s30, v38
    v_mul_f32 v23, s30, v23
    v_mul_f32 v39, s30, v39
    v_mul_f32 v24, s30, v24
    v_mul_f32 v40, s30, v40
    v_mul_f32 v25, s30, v25
    v_mul_f32 v41, s30, v41
    v_mul_f32 v26, s30, v26
    v_mul_f32 v42, s30, v42
    v_mul_f32 v27, s30, v27
    v_mul_f32 v43, s30, v43
    v_mul_f32 v28, s30, v28
    v_mul_f32 v44, s30, v44
    v_mul_f32 v29, s30, v29
    v_mul_f32 v45, s30, v45
    v_mul_f32 v30, s30, v30
    v_mul_f32 v46, s30, v46
    v_mul_f32 v31, s30, v31
    v_mul_f32 v47, s30, v47
    v_exp_f32 v16, v16
    v_exp_f32 v32, v32
    v_exp_f32 v17, v17
    v_exp_f32 v33, v33
    v_exp_f32 v18, v18
    v_exp_f32 v34, v34
    v_exp_f32 v19, v19
    v_exp_f32 v35, v35
    v_exp_f32 v20, v20
    v_exp_f32 v36, v36
    v_exp_f32 v21, v21
    v_exp_f32 v37, v37
    v_exp_f32 v22, v22
    v_exp_f32 v38, v38
    v_exp_f32 v23, v23
    v_exp_f32 v39, v39
    v_exp_f32 v24, v24
    v_exp_f32 v40, v40
    v_exp_f32 v25, v25
    v_exp_f32 v41, v41
    v_exp_f32 v26, v26
    v_exp_f32 v42, v42
    v_exp_f32 v27, v27
    v_exp_f32 v43, v43
    v_exp_f32 v28, v28
    v_exp_f32 v44, v44
    v_exp_f32 v29, v29
    v_exp_f32 v45, v45
    v_exp_f32 v30, v30
    v_exp_f32 v46, v46
    v_exp_f32 v31, v31
    v_exp_f32 v47, v47
    s_nop 0
    v_cndmask_b32_e64 v28, v11, v28, s[40:41]
    v_cndmask_b32_e64 v44, v11, v44, s[40:41]
    v_cndmask_b32_e64 v29, v11, v29, s[40:41]
    v_cndmask_b32_e64 v45, v11, v45, s[40:41]
    v_cndmask_b32_e64 v30, v11, v30, s[40:41]
    v_cndmask_b32_e64 v46, v11, v46, s[40:41]
    v_cndmask_b32_e64 v31, v11, v31, s[40:41]
    v_cndmask_b32_e64 v47, v11, v47, s[40:41]
    v_add_f32 v48, v16, v17
    v_add_f32 v52, v32, v33
    v_add_f32 v48, v48, v18
    v_add_f32 v52, v52, v34
    v_add_f32 v48, v48, v19
    v_add_f32 v52, v52, v35
    v_add_f32 v48, v48, v20
    v_add_f32 v52, v52, v36
    v_add_f32 v48, v48, v21
    v_add_f32 v52, v52, v37
    v_add_f32 v48, v48, v22
    v_add_f32 v52, v52, v38
    v_add_f32 v48, v48, v23
    v_add_f32 v52, v52, v39
    v_add_f32 v48, v48, v24
    v_add_f32 v52, v52, v40
    v_add_f32 v48, v48, v25
    v_add_f32 v52, v52, v41
    v_add_f32 v48, v48, v26
    v_add_f32 v52, v52, v42
    v_add_f32 v48, v48, v27
    v_add_f32 v52, v52, v43
    v_add_f32 v48, v48, v28
    v_add_f32 v52, v52, v44
    v_add_f32 v48, v48, v29
    v_add_f32 v52, v52, v45
    v_add_f32 v48, v48, v30
    v_add_f32 v52, v52, v46
    v_add_f32 v48, v48, v31
    v_add_f32 v52, v52, v47
    v_mov_b32 v49, v48
    v_mov_b32 v53, v52
    s_nop 1
    v_permlane32_swap_b32 v48, v49
    v_permlane32_swap_b32 v52, v53
    s_nop 1
    v_add_f32 v48, v48, v49
    v_add_f32 v52, v52, v53
    v_rcp_f32 v48, v48
    v_rcp_f32 v52, v52
    s_nop 0
    v_mul_f32 v16, v16, v48
    v_mul_f32 v32, v32, v52
    v_mul_f32 v17, v17, v48
    v_mul_f32 v33, v33, v52
    v_mul_f32 v18, v18, v48
    v_mul_f32 v34, v34, v52
    v_mul_f32 v19, v19, v48
    v_mul_f32 v35, v35, v52
    v_mul_f32 v20, v20, v48
    v_mul_f32 v36, v36, v52
    v_mul_f32 v21, v21, v48
    v_mul_f32 v37, v37, v52
    v_mul_f32 v22, v22, v48
    v_mul_f32 v38, v38, v52
    v_mul_f32 v23, v23, v48
    v_mul_f32 v39, v39, v52
    v_mul_f32 v24, v24, v48
    v_mul_f32 v40, v40, v52
    v_mul_f32 v25, v25, v48
    v_mul_f32 v41, v41, v52
    v_mul_f32 v26, v26, v48
    v_mul_f32 v42, v42, v52
    v_mul_f32 v27, v27, v48
    v_mul_f32 v43, v43, v52
    v_mul_f32 v28, v28, v48
    v_mul_f32 v44, v44, v52
    v_mul_f32 v29, v29, v48
    v_mul_f32 v45, v45, v52
    v_mul_f32 v30, v30, v48
    v_mul_f32 v46, v46, v52
    v_mul_f32 v31, v31, v48
    v_mul_f32 v47, v47, v52
    v_cvt_pk_bf16_f32 v56, v16, v17
    v_cvt_pk_bf16_f32 v57, v18, v19
    v_cvt_pk_bf16_f32 v58, v20, v21
    v_cvt_pk_bf16_f32 v59, v22, v23
    v_cvt_pk_bf16_f32 v60, v24, v25
    v_cvt_pk_bf16_f32 v61, v26, v27
    v_cvt_pk_bf16_f32 v62, v28, v29
    v_cvt_pk_bf16_f32 v63, v30, v31
    v_cvt_pk_bf16_f32 v64, v32, v33
    v_cvt_pk_bf16_f32 v65, v34, v35
    v_cvt_pk_bf16_f32 v66, v36, v37
    v_cvt_pk_bf16_f32 v67, v38, v39
    v_cvt_pk_bf16_f32 v68, v40, v41
    v_cvt_pk_bf16_f32 v69, v42, v43
    v_cvt_pk_bf16_f32 v70, v44, v45
    v_cvt_pk_bf16_f32 v71, v46, v47
    s_waitcnt vmcnt(0)
    v_cvt_pk_bf16_f32 v72, v192, v193
    v_cvt_pk_bf16_f32 v73, v194, v195
    v_cvt_pk_bf16_f32 v74, v196, v197
    v_cvt_pk_bf16_f32 v75, v198, v199
    v_cvt_pk_bf16_f32 v76, v200, v201
    v_cvt_pk_bf16_f32 v77, v202, v203
    v_cvt_pk_bf16_f32 v78, v204, v205
    v_cvt_pk_bf16_f32 v79, v206, v207
    v_cvt_pk_bf16_f32 v80, v208, v209
    v_cvt_pk_bf16_f32 v81, v210, v211
    v_cvt_pk_bf16_f32 v82, v212, v213
    v_cvt_pk_bf16_f32 v83, v214, v215
    v_cvt_pk_bf16_f32 v84, v216, v217
    v_cvt_pk_bf16_f32 v85, v218, v219
    v_cvt_pk_bf16_f32 v86, v220, v221
    v_cvt_pk_bf16_f32 v87, v222, v223
    s_nop 1
    v_mfma_f32_32x32x16_bf16 v[88:103], v[72:75], v[56:59], 0
    v_mfma_f32_32x32x16_bf16 v[88:103], v[76:79], v[60:63], v[88:103]
    v_mfma_f32_32x32x16_bf16 v[88:103], v[80:83], v[64:67], v[88:103]
    v_mfma_f32_32x32x16_bf16 v[88:103], v[84:87], v[68:71], v[88:103]
    s_nop 15
    s_nop 1
    v_mov_b32 v48, v100
    v_mov_b32 v49, v100
    s_nop 1
    v_permlane32_swap_b32 v48, v49
    s_nop 1
    v_add_f32 v49, 0x358637bd, v49
    v_rcp_f32 v49, v49
    s_nop 0
    v_mul_f32 v88, v88, v49
    v_mul_f32 v89, v89, v49
    v_mul_f32 v90, v90, v49
    v_mul_f32 v91, v91, v49
    v_mul_f32 v92, v92, v49
    v_mul_f32 v93, v93, v49
    v_mul_f32 v94, v94, v49
    v_mul_f32 v95, v95, v49
    v_mul_f32 v96, v96, v49
    v_mul_f32 v97, v97, v49
    v_mul_f32 v98, v98, v49
    v_mul_f32 v99, v99, v49
    v_mul_f32 v100, v100, v49
    v_mul_f32 v101, v101, v49
    v_mul_f32 v102, v102, v49
    v_mul_f32 v103, v103, v49
    v_cvt_pk_bf16_f32 v104, v88, v89
    v_cvt_pk_bf16_f32 v105, v90, v91
    v_cvt_pk_bf16_f32 v106, v92, v93
    v_cvt_pk_bf16_f32 v107, v94, v95
    v_cvt_pk_bf16_f32 v108, v96, v97
    v_cvt_pk_bf16_f32 v109, v98, v99
    v_cvt_pk_bf16_f32 v110, v100, v101
    v_cvt_pk_bf16_f32 v111, v102, v103
    ds_write_b128 v13, v[104:107] offset:6144
    ds_write_b128 v13, v[108:111] offset:7168
    s_nop 1
    s_waitcnt lgkmcnt(0)
    s_barrier
    ds_read_b128 a[0:3], v12 offset:0
    ds_read_b128 a[4:7], v12 offset:1024
    ds_read_b128 a[8:11], v12 offset:2048
    ds_read_b128 a[12:15], v12 offset:3072
    ds_read_b128 a[16:19], v12 offset:4096
    ds_read_b128 a[20:23], v12 offset:5120
    ds_read_b128 a[24:27], v12 offset:6144
    ds_read_b128 a[28:31], v12 offset:7168
    ds_read_b128 a[32:35], v12 offset:8192
    ds_read_b128 a[36:39], v12 offset:9216
    ds_read_b128 a[40:43], v12 offset:10240
    ds_read_b128 a[44:47], v12 offset:11264
    ds_read_b128 a[48:51], v12 offset:12288
    ds_read_b128 a[52:55], v12 offset:13312
    ds_read_b128 a[56:59], v12 offset:14336
    ds_read_b128 a[60:63], v12 offset:15360
    ds_read_b128 a[64:67], v12 offset:16384
    ds_read_b128 a[68:71], v12 offset:17408
    ds_read_b128 a[72:75], v12 offset:18432
    ds_read_b128 a[76:79], v12 offset:19456
    ds_read_b128 a[80:83], v12 offset:20480
    ds_read_b128 a[84:87], v12 offset:21504
    ds_read_b128 a[88:91], v12 offset:22528
    ds_read_b128 a[92:95], v12 offset:23552
    ds_read_b128 a[96:99], v12 offset:24576
    ds_read_b128 a[100:103], v12 offset:25600
    ds_read_b128 a[104:107], v12 offset:26624
    ds_read_b128 a[108:111], v12 offset:27648
    ds_read_b128 a[112:115], v12 offset:28672
    ds_read_b128 a[116:119], v12 offset:29696
    ds_read_b128 a[120:123], v12 offset:30720
    ds_read_b128 a[124:127], v12 offset:31744
    s_lshl_b32 s11, s10, 5
    v_add_u32 v6, s11, v5
    v_lshlrev_b32 v6, 10, v6
    v_lshl_add_u32 v6, v4, 4, v6
    s_lshl_b32 s11, s100, 5
    v_add_u32 v9, s11, v3
    v_mul_u32_u24 v9, 1792, v9
    v_lshl_add_u32 v9, v4, 4, v9
    s_lshl_b32 s36, s10, 6
    v_add_u32 v9, s36, v9
    s_mov_b32 s39, 0
    buffer_load_dwordx4 v[16:19], v6, s[24:27], s39 offen offset:0 sc1
    buffer_load_dwordx4 v[20:23], v6, s[24:27], s39 offen offset:32 sc1
    buffer_load_dwordx4 v[24:27], v6, s[24:27], s39 offen offset:64 sc1
    buffer_load_dwordx4 v[28:31], v6, s[24:27], s39 offen offset:96 sc1
    buffer_load_dwordx4 v[32:35], v6, s[24:27], s39 offen offset:128 sc1
    buffer_load_dwordx4 v[36:39], v6, s[24:27], s39 offen offset:160 sc1
    buffer_load_dwordx4 v[40:43], v6, s[24:27], s39 offen offset:192 sc1
    buffer_load_dwordx4 v[44:47], v6, s[24:27], s39 offen offset:224 sc1
    buffer_load_dwordx4 v[48:51], v6, s[24:27], s39 offen offset:256 sc1
    buffer_load_dwordx4 v[52:55], v6, s[24:27], s39 offen offset:288 sc1
    buffer_load_dwordx4 v[56:59], v6, s[24:27], s39 offen offset:320 sc1
    buffer_load_dwordx4 v[60:63], v6, s[24:27], s39 offen offset:352 sc1
    buffer_load_dwordx4 v[64:67], v6, s[24:27], s39 offen offset:384 sc1
    buffer_load_dwordx4 v[68:71], v6, s[24:27], s39 offen offset:416 sc1
    buffer_load_dwordx4 v[72:75], v6, s[24:27], s39 offen offset:448 sc1
    buffer_load_dwordx4 v[76:79], v6, s[24:27], s39 offen offset:480 sc1
    s_waitcnt lgkmcnt(0)
    s_mov_b32 s39, 0
    buffer_load_dwordx4 v[80:83], v6, s[24:27], s39 offen offset:512 sc1
    buffer_load_dwordx4 v[84:87], v6, s[24:27], s39 offen offset:544 sc1
    buffer_load_dwordx4 v[88:91], v6, s[24:27], s39 offen offset:576 sc1
    buffer_load_dwordx4 v[92:95], v6, s[24:27], s39 offen offset:608 sc1
    buffer_load_dwordx4 v[96:99], v6, s[24:27], s39 offen offset:640 sc1
    buffer_load_dwordx4 v[100:103], v6, s[24:27], s39 offen offset:672 sc1
    buffer_load_dwordx4 v[104:107], v6, s[24:27], s39 offen offset:704 sc1
    buffer_load_dwordx4 v[108:111], v6, s[24:27], s39 offen offset:736 sc1
    buffer_load_dwordx4 v[112:115], v6, s[24:27], s39 offen offset:768 sc1
    buffer_load_dwordx4 v[116:119], v6, s[24:27], s39 offen offset:800 sc1
    buffer_load_dwordx4 v[120:123], v6, s[24:27], s39 offen offset:832 sc1
    buffer_load_dwordx4 v[124:127], v6, s[24:27], s39 offen offset:864 sc1
    buffer_load_dwordx4 v[128:131], v6, s[24:27], s39 offen offset:896 sc1
    buffer_load_dwordx4 v[132:135], v6, s[24:27], s39 offen offset:928 sc1
    buffer_load_dwordx4 v[136:139], v6, s[24:27], s39 offen offset:960 sc1
    buffer_load_dwordx4 v[140:143], v6, s[24:27], s39 offen offset:992 sc1
    s_waitcnt vmcnt(16)
    v_mfma_f32_32x32x16_bf16 v[144:159], v[16:19], a[0:3], 0
    v_mfma_f32_32x32x16_bf16 v[144:159], v[20:23], a[4:7], v[144:159]
    v_mfma_f32_32x32x16_bf16 v[144:159], v[24:27], a[8:11], v[144:159]
    v_mfma_f32_32x32x16_bf16 v[144:159], v[28:31], a[12:15], v[144:159]
    v_mfma_f32_32x32x16_bf16 v[144:159], v[32:35], a[16:19], v[144:159]
    v_mfma_f32_32x32x16_bf16 v[144:159], v[36:39], a[20:23], v[144:159]
    v_mfma_f32_32x32x16_bf16 v[144:159], v[40:43], a[24:27], v[144:159]
    v_mfma_f32_32x32x16_bf16 v[144:159], v[44:47], a[28:31], v[144:159]
    v_mfma_f32_32x32x16_bf16 v[144:159], v[48:51], a[32:35], v[144:159]
    v_mfma_f32_32x32x16_bf16 v[144:159], v[52:55], a[36:39], v[144:159]
    v_mfma_f32_32x32x16_bf16 v[144:159], v[56:59], a[40:43], v[144:159]
    v_mfma_f32_32x32x16_bf16 v[144:159], v[60:63], a[44:47], v[144:159]
    v_mfma_f32_32x32x16_bf16 v[144:159], v[64:67], a[48:51], v[144:159]
    v_mfma_f32_32x32x16_bf16 v[144:159], v[68:71], a[52:55], v[144:159]
    v_mfma_f32_32x32x16_bf16 v[144:159], v[72:75], a[56:59], v[144:159]
    v_mfma_f32_32x32x16_bf16 v[144:159], v[76:79], a[60:63], v[144:159]
    s_mov_b32 s39, 131072
    buffer_load_dwordx4 v[16:19], v6, s[24:27], s39 offen offset:0 sc1
    buffer_load_dwordx4 v[20:23], v6, s[24:27], s39 offen offset:32 sc1
    buffer_load_dwordx4 v[24:27], v6, s[24:27], s39 offen offset:64 sc1
    buffer_load_dwordx4 v[28:31], v6, s[24:27], s39 offen offset:96 sc1
    buffer_load_dwordx4 v[32:35], v6, s[24:27], s39 offen offset:128 sc1
    buffer_load_dwordx4 v[36:39], v6, s[24:27], s39 offen offset:160 sc1
    buffer_load_dwordx4 v[40:43], v6, s[24:27], s39 offen offset:192 sc1
    buffer_load_dwordx4 v[44:47], v6, s[24:27], s39 offen offset:224 sc1
    buffer_load_dwordx4 v[48:51], v6, s[24:27], s39 offen offset:256 sc1
    buffer_load_dwordx4 v[52:55], v6, s[24:27], s39 offen offset:288 sc1
    buffer_load_dwordx4 v[56:59], v6, s[24:27], s39 offen offset:320 sc1
    buffer_load_dwordx4 v[60:63], v6, s[24:27], s39 offen offset:352 sc1
    buffer_load_dwordx4 v[64:67], v6, s[24:27], s39 offen offset:384 sc1
    buffer_load_dwordx4 v[68:71], v6, s[24:27], s39 offen offset:416 sc1
    buffer_load_dwordx4 v[72:75], v6, s[24:27], s39 offen offset:448 sc1
    buffer_load_dwordx4 v[76:79], v6, s[24:27], s39 offen offset:480 sc1
    s_waitcnt vmcnt(16)
    v_mfma_f32_32x32x16_bf16 v[144:159], v[80:83], a[64:67], v[144:159]
    v_mfma_f32_32x32x16_bf16 v[144:159], v[84:87], a[68:71], v[144:159]
    v_mfma_f32_32x32x16_bf16 v[144:159], v[88:91], a[72:75], v[144:159]
    v_mfma_f32_32x32x16_bf16 v[144:159], v[92:95], a[76:79], v[144:159]
    v_mfma_f32_32x32x16_bf16 v[144:159], v[96:99], a[80:83], v[144:159]
    v_mfma_f32_32x32x16_bf16 v[144:159], v[100:103], a[84:87], v[144:159]
    v_mfma_f32_32x32x16_bf16 v[144:159], v[104:107], a[88:91], v[144:159]
    v_mfma_f32_32x32x16_bf16 v[144:159], v[108:111], a[92:95], v[144:159]
    v_mfma_f32_32x32x16_bf16 v[144:159], v[112:115], a[96:99], v[144:159]
    v_mfma_f32_32x32x16_bf16 v[144:159], v[116:119], a[100:103], v[144:159]
    v_mfma_f32_32x32x16_bf16 v[144:159], v[120:123], a[104:107], v[144:159]
    v_mfma_f32_32x32x16_bf16 v[144:159], v[124:127], a[108:111], v[144:159]
    v_mfma_f32_32x32x16_bf16 v[144:159], v[128:131], a[112:115], v[144:159]
    v_mfma_f32_32x32x16_bf16 v[144:159], v[132:135], a[116:119], v[144:159]
    v_mfma_f32_32x32x16_bf16 v[144:159], v[136:139], a[120:123], v[144:159]
    v_mfma_f32_32x32x16_bf16 v[144:159], v[140:143], a[124:127], v[144:159]
    s_nop 15
    v_cvt_pk_bf16_f32 v160, v144, v145
    v_cvt_pk_bf16_f32 v161, v146, v147
    v_cvt_pk_bf16_f32 v162, v148, v149
    v_cvt_pk_bf16_f32 v163, v150, v151
    v_cvt_pk_bf16_f32 v164, v152, v153
    v_cvt_pk_bf16_f32 v165, v154, v155
    v_cvt_pk_bf16_f32 v166, v156, v157
    v_cvt_pk_bf16_f32 v167, v158, v159
    buffer_store_dwordx4 v[160:163], v9, s[32:35], 0 offen offset:0
    buffer_store_dwordx4 v[164:167], v9, s[32:35], 0 offen offset:32
    s_nop 1
    s_mov_b32 s39, 131072
    buffer_load_dwordx4 v[80:83], v6, s[24:27], s39 offen offset:512 sc1
    buffer_load_dwordx4 v[84:87], v6, s[24:27], s39 offen offset:544 sc1
    buffer_load_dwordx4 v[88:91], v6, s[24:27], s39 offen offset:576 sc1
    buffer_load_dwordx4 v[92:95], v6, s[24:27], s39 offen offset:608 sc1
    buffer_load_dwordx4 v[96:99], v6, s[24:27], s39 offen offset:640 sc1
    buffer_load_dwordx4 v[100:103], v6, s[24:27], s39 offen offset:672 sc1
    buffer_load_dwordx4 v[104:107], v6, s[24:27], s39 offen offset:704 sc1
    buffer_load_dwordx4 v[108:111], v6, s[24:27], s39 offen offset:736 sc1
    buffer_load_dwordx4 v[112:115], v6, s[24:27], s39 offen offset:768 sc1
    buffer_load_dwordx4 v[116:119], v6, s[24:27], s39 offen offset:800 sc1
    buffer_load_dwordx4 v[120:123], v6, s[24:27], s39 offen offset:832 sc1
    buffer_load_dwordx4 v[124:127], v6, s[24:27], s39 offen offset:864 sc1
    buffer_load_dwordx4 v[128:131], v6, s[24:27], s39 offen offset:896 sc1
    buffer_load_dwordx4 v[132:135], v6, s[24:27], s39 offen offset:928 sc1
    buffer_load_dwordx4 v[136:139], v6, s[24:27], s39 offen offset:960 sc1
    buffer_load_dwordx4 v[140:143], v6, s[24:27], s39 offen offset:992 sc1
    s_waitcnt vmcnt(16)
    v_mfma_f32_32x32x16_bf16 v[144:159], v[16:19], a[0:3], 0
    v_mfma_f32_32x32x16_bf16 v[144:159], v[20:23], a[4:7], v[144:159]
    v_mfma_f32_32x32x16_bf16 v[144:159], v[24:27], a[8:11], v[144:159]
    v_mfma_f32_32x32x16_bf16 v[144:159], v[28:31], a[12:15], v[144:159]
    v_mfma_f32_32x32x16_bf16 v[144:159], v[32:35], a[16:19], v[144:159]
    v_mfma_f32_32x32x16_bf16 v[144:159], v[36:39], a[20:23], v[144:159]
    v_mfma_f32_32x32x16_bf16 v[144:159], v[40:43], a[24:27], v[144:159]
    v_mfma_f32_32x32x16_bf16 v[144:159], v[44:47], a[28:31], v[144:159]
    v_mfma_f32_32x32x16_bf16 v[144:159], v[48:51], a[32:35], v[144:159]
    v_mfma_f32_32x32x16_bf16 v[144:159], v[52:55], a[36:39], v[144:159]
    v_mfma_f32_32x32x16_bf16 v[144:159], v[56:59], a[40:43], v[144:159]
    v_mfma_f32_32x32x16_bf16 v[144:159], v[60:63], a[44:47], v[144:159]
    v_mfma_f32_32x32x16_bf16 v[144:159], v[64:67], a[48:51], v[144:159]
    v_mfma_f32_32x32x16_bf16 v[144:159], v[68:71], a[52:55], v[144:159]
    v_mfma_f32_32x32x16_bf16 v[144:159], v[72:75], a[56:59], v[144:159]
    v_mfma_f32_32x32x16_bf16 v[144:159], v[76:79], a[60:63], v[144:159]
    s_mov_b32 s39, 262144
    buffer_load_dwordx4 v[16:19], v6, s[24:27], s39 offen offset:0 sc1
    buffer_load_dwordx4 v[20:23], v6, s[24:27], s39 offen offset:32 sc1
    buffer_load_dwordx4 v[24:27], v6, s[24:27], s39 offen offset:64 sc1
    buffer_load_dwordx4 v[28:31], v6, s[24:27], s39 offen offset:96 sc1
    buffer_load_dwordx4 v[32:35], v6, s[24:27], s39 offen offset:128 sc1
    buffer_load_dwordx4 v[36:39], v6, s[24:27], s39 offen offset:160 sc1
    buffer_load_dwordx4 v[40:43], v6, s[24:27], s39 offen offset:192 sc1
    buffer_load_dwordx4 v[44:47], v6, s[24:27], s39 offen offset:224 sc1
    buffer_load_dwordx4 v[48:51], v6, s[24:27], s39 offen offset:256 sc1
    buffer_load_dwordx4 v[52:55], v6, s[24:27], s39 offen offset:288 sc1
    buffer_load_dwordx4 v[56:59], v6, s[24:27], s39 offen offset:320 sc1
    buffer_load_dwordx4 v[60:63], v6, s[24:27], s39 offen offset:352 sc1
    buffer_load_dwordx4 v[64:67], v6, s[24:27], s39 offen offset:384 sc1
    buffer_load_dwordx4 v[68:71], v6, s[24:27], s39 offen offset:416 sc1
    buffer_load_dwordx4 v[72:75], v6, s[24:27], s39 offen offset:448 sc1
    buffer_load_dwordx4 v[76:79], v6, s[24:27], s39 offen offset:480 sc1
    s_waitcnt vmcnt(16)
    v_mfma_f32_32x32x16_bf16 v[144:159], v[80:83], a[64:67], v[144:159]
    v_mfma_f32_32x32x16_bf16 v[144:159], v[84:87], a[68:71], v[144:159]
    v_mfma_f32_32x32x16_bf16 v[144:159], v[88:91], a[72:75], v[144:159]
    v_mfma_f32_32x32x16_bf16 v[144:159], v[92:95], a[76:79], v[144:159]
    v_mfma_f32_32x32x16_bf16 v[144:159], v[96:99], a[80:83], v[144:159]
    v_mfma_f32_32x32x16_bf16 v[144:159], v[100:103], a[84:87], v[144:159]
    v_mfma_f32_32x32x16_bf16 v[144:159], v[104:107], a[88:91], v[144:159]
    v_mfma_f32_32x32x16_bf16 v[144:159], v[108:111], a[92:95], v[144:159]
    v_mfma_f32_32x32x16_bf16 v[144:159], v[112:115], a[96:99], v[144:159]
    v_mfma_f32_32x32x16_bf16 v[144:159], v[116:119], a[100:103], v[144:159]
    v_mfma_f32_32x32x16_bf16 v[144:159], v[120:123], a[104:107], v[144:159]
    v_mfma_f32_32x32x16_bf16 v[144:159], v[124:127], a[108:111], v[144:159]
    v_mfma_f32_32x32x16_bf16 v[144:159], v[128:131], a[112:115], v[144:159]
    v_mfma_f32_32x32x16_bf16 v[144:159], v[132:135], a[116:119], v[144:159]
    v_mfma_f32_32x32x16_bf16 v[144:159], v[136:139], a[120:123], v[144:159]
    v_mfma_f32_32x32x16_bf16 v[144:159], v[140:143], a[124:127], v[144:159]
    s_nop 15
    v_cvt_pk_bf16_f32 v160, v144, v145
    v_cvt_pk_bf16_f32 v161, v146, v147
    v_cvt_pk_bf16_f32 v162, v148, v149
    v_cvt_pk_bf16_f32 v163, v150, v151
    v_cvt_pk_bf16_f32 v164, v152, v153
    v_cvt_pk_bf16_f32 v165, v154, v155
    v_cvt_pk_bf16_f32 v166, v156, v157
    v_cvt_pk_bf16_f32 v167, v158, v159
    buffer_store_dwordx4 v[160:163], v9, s[32:35], 0 offen offset:256
    buffer_store_dwordx4 v[164:167], v9, s[32:35], 0 offen offset:288
    s_nop 1
    s_mov_b32 s39, 262144
    buffer_load_dwordx4 v[80:83], v6, s[24:27], s39 offen offset:512 sc1
    buffer_load_dwordx4 v[84:87], v6, s[24:27], s39 offen offset:544 sc1
    buffer_load_dwordx4 v[88:91], v6, s[24:27], s39 offen offset:576 sc1
    buffer_load_dwordx4 v[92:95], v6, s[24:27], s39 offen offset:608 sc1
    buffer_load_dwordx4 v[96:99], v6, s[24:27], s39 offen offset:640 sc1
    buffer_load_dwordx4 v[100:103], v6, s[24:27], s39 offen offset:672 sc1
    buffer_load_dwordx4 v[104:107], v6, s[24:27], s39 offen offset:704 sc1
    buffer_load_dwordx4 v[108:111], v6, s[24:27], s39 offen offset:736 sc1
    buffer_load_dwordx4 v[112:115], v6, s[24:27], s39 offen offset:768 sc1
    buffer_load_dwordx4 v[116:119], v6, s[24:27], s39 offen offset:800 sc1
    buffer_load_dwordx4 v[120:123], v6, s[24:27], s39 offen offset:832 sc1
    buffer_load_dwordx4 v[124:127], v6, s[24:27], s39 offen offset:864 sc1
    buffer_load_dwordx4 v[128:131], v6, s[24:27], s39 offen offset:896 sc1
    buffer_load_dwordx4 v[132:135], v6, s[24:27], s39 offen offset:928 sc1
    buffer_load_dwordx4 v[136:139], v6, s[24:27], s39 offen offset:960 sc1
    buffer_load_dwordx4 v[140:143], v6, s[24:27], s39 offen offset:992 sc1
    s_waitcnt vmcnt(16)
    v_mfma_f32_32x32x16_bf16 v[144:159], v[16:19], a[0:3], 0
    v_mfma_f32_32x32x16_bf16 v[144:159], v[20:23], a[4:7], v[144:159]
    v_mfma_f32_32x32x16_bf16 v[144:159], v[24:27], a[8:11], v[144:159]
    v_mfma_f32_32x32x16_bf16 v[144:159], v[28:31], a[12:15], v[144:159]
    v_mfma_f32_32x32x16_bf16 v[144:159], v[32:35], a[16:19], v[144:159]
    v_mfma_f32_32x32x16_bf16 v[144:159], v[36:39], a[20:23], v[144:159]
    v_mfma_f32_32x32x16_bf16 v[144:159], v[40:43], a[24:27], v[144:159]
    v_mfma_f32_32x32x16_bf16 v[144:159], v[44:47], a[28:31], v[144:159]
    v_mfma_f32_32x32x16_bf16 v[144:159], v[48:51], a[32:35], v[144:159]
    v_mfma_f32_32x32x16_bf16 v[144:159], v[52:55], a[36:39], v[144:159]
    v_mfma_f32_32x32x16_bf16 v[144:159], v[56:59], a[40:43], v[144:159]
    v_mfma_f32_32x32x16_bf16 v[144:159], v[60:63], a[44:47], v[144:159]
    v_mfma_f32_32x32x16_bf16 v[144:159], v[64:67], a[48:51], v[144:159]
    v_mfma_f32_32x32x16_bf16 v[144:159], v[68:71], a[52:55], v[144:159]
    v_mfma_f32_32x32x16_bf16 v[144:159], v[72:75], a[56:59], v[144:159]
    v_mfma_f32_32x32x16_bf16 v[144:159], v[76:79], a[60:63], v[144:159]
    s_mov_b32 s39, 393216
    buffer_load_dwordx4 v[16:19], v6, s[24:27], s39 offen offset:0 sc1
    buffer_load_dwordx4 v[20:23], v6, s[24:27], s39 offen offset:32 sc1
    buffer_load_dwordx4 v[24:27], v6, s[24:27], s39 offen offset:64 sc1
    buffer_load_dwordx4 v[28:31], v6, s[24:27], s39 offen offset:96 sc1
    buffer_load_dwordx4 v[32:35], v6, s[24:27], s39 offen offset:128 sc1
    buffer_load_dwordx4 v[36:39], v6, s[24:27], s39 offen offset:160 sc1
    buffer_load_dwordx4 v[40:43], v6, s[24:27], s39 offen offset:192 sc1
    buffer_load_dwordx4 v[44:47], v6, s[24:27], s39 offen offset:224 sc1
    buffer_load_dwordx4 v[48:51], v6, s[24:27], s39 offen offset:256 sc1
    buffer_load_dwordx4 v[52:55], v6, s[24:27], s39 offen offset:288 sc1
    buffer_load_dwordx4 v[56:59], v6, s[24:27], s39 offen offset:320 sc1
    buffer_load_dwordx4 v[60:63], v6, s[24:27], s39 offen offset:352 sc1
    buffer_load_dwordx4 v[64:67], v6, s[24:27], s39 offen offset:384 sc1
    buffer_load_dwordx4 v[68:71], v6, s[24:27], s39 offen offset:416 sc1
    buffer_load_dwordx4 v[72:75], v6, s[24:27], s39 offen offset:448 sc1
    buffer_load_dwordx4 v[76:79], v6, s[24:27], s39 offen offset:480 sc1
    s_waitcnt vmcnt(16)
    v_mfma_f32_32x32x16_bf16 v[144:159], v[80:83], a[64:67], v[144:159]
    v_mfma_f32_32x32x16_bf16 v[144:159], v[84:87], a[68:71], v[144:159]
    v_mfma_f32_32x32x16_bf16 v[144:159], v[88:91], a[72:75], v[144:159]
    v_mfma_f32_32x32x16_bf16 v[144:159], v[92:95], a[76:79], v[144:159]
    v_mfma_f32_32x32x16_bf16 v[144:159], v[96:99], a[80:83], v[144:159]
    v_mfma_f32_32x32x16_bf16 v[144:159], v[100:103], a[84:87], v[144:159]
    v_mfma_f32_32x32x16_bf16 v[144:159], v[104:107], a[88:91], v[144:159]
    v_mfma_f32_32x32x16_bf16 v[144:159], v[108:111], a[92:95], v[144:159]
    v_mfma_f32_32x32x16_bf16 v[144:159], v[112:115], a[96:99], v[144:159]
    v_mfma_f32_32x32x16_bf16 v[144:159], v[116:119], a[100:103], v[144:159]
    v_mfma_f32_32x32x16_bf16 v[144:159], v[120:123], a[104:107], v[144:159]
    v_mfma_f32_32x32x16_bf16 v[144:159], v[124:127], a[108:111], v[144:159]
    v_mfma_f32_32x32x16_bf16 v[144:159], v[128:131], a[112:115], v[144:159]
    v_mfma_f32_32x32x16_bf16 v[144:159], v[132:135], a[116:119], v[144:159]
    v_mfma_f32_32x32x16_bf16 v[144:159], v[136:139], a[120:123], v[144:159]
    v_mfma_f32_32x32x16_bf16 v[144:159], v[140:143], a[124:127], v[144:159]
    s_nop 15
    v_cvt_pk_bf16_f32 v160, v144, v145
    v_cvt_pk_bf16_f32 v161, v146, v147
    v_cvt_pk_bf16_f32 v162, v148, v149
    v_cvt_pk_bf16_f32 v163, v150, v151
    v_cvt_pk_bf16_f32 v164, v152, v153
    v_cvt_pk_bf16_f32 v165, v154, v155
    v_cvt_pk_bf16_f32 v166, v156, v157
    v_cvt_pk_bf16_f32 v167, v158, v159
    buffer_store_dwordx4 v[160:163], v9, s[32:35], 0 offen offset:512
    buffer_store_dwordx4 v[164:167], v9, s[32:35], 0 offen offset:544
    s_nop 1
    s_cmp_ge_u32 s10, 2
    s_cbranch_scc1 wk_loop
    s_mov_b32 s39, 393216
    buffer_load_dwordx4 v[80:83], v6, s[24:27], s39 offen offset:512 sc1
    buffer_load_dwordx4 v[84:87], v6, s[24:27], s39 offen offset:544 sc1
    buffer_load_dwordx4 v[88:91], v6, s[24:27], s39 offen offset:576 sc1
    buffer_load_dwordx4 v[92:95], v6, s[24:27], s39 offen offset:608 sc1
    buffer_load_dwordx4 v[96:99], v6, s[24:27], s39 offen offset:640 sc1
    buffer_load_dwordx4 v[100:103], v6, s[24:27], s39 offen offset:672 sc1
    buffer_load_dwordx4 v[104:107], v6, s[24:27], s39 offen offset:704 sc1
    buffer_load_dwordx4 v[108:111], v6, s[24:27], s39 offen offset:736 sc1
    buffer_load_dwordx4 v[112:115], v6, s[24:27], s39 offen offset:768 sc1
    buffer_load_dwordx4 v[116:119], v6, s[24:27], s39 offen offset:800 sc1
    buffer_load_dwordx4 v[120:123], v6, s[24:27], s39 offen offset:832 sc1
    buffer_load_dwordx4 v[124:127], v6, s[24:27], s39 offen offset:864 sc1
    buffer_load_dwordx4 v[128:131], v6, s[24:27], s39 offen offset:896 sc1
    buffer_load_dwordx4 v[132:135], v6, s[24:27], s39 offen offset:928 sc1
    buffer_load_dwordx4 v[136:139], v6, s[24:27], s39 offen offset:960 sc1
    buffer_load_dwordx4 v[140:143], v6, s[24:27], s39 offen offset:992 sc1
    s_waitcnt vmcnt(16)
    v_mfma_f32_32x32x16_bf16 v[144:159], v[16:19], a[0:3], 0
    v_mfma_f32_32x32x16_bf16 v[144:159], v[20:23], a[4:7], v[144:159]
    v_mfma_f32_32x32x16_bf16 v[144:159], v[24:27], a[8:11], v[144:159]
    v_mfma_f32_32x32x16_bf16 v[144:159], v[28:31], a[12:15], v[144:159]
    v_mfma_f32_32x32x16_bf16 v[144:159], v[32:35], a[16:19], v[144:159]
    v_mfma_f32_32x32x16_bf16 v[144:159], v[36:39], a[20:23], v[144:159]
    v_mfma_f32_32x32x16_bf16 v[144:159], v[40:43], a[24:27], v[144:159]
    v_mfma_f32_32x32x16_bf16 v[144:159], v[44:47], a[28:31], v[144:159]
    v_mfma_f32_32x32x16_bf16 v[144:159], v[48:51], a[32:35], v[144:159]
    v_mfma_f32_32x32x16_bf16 v[144:159], v[52:55], a[36:39], v[144:159]
    v_mfma_f32_32x32x16_bf16 v[144:159], v[56:59], a[40:43], v[144:159]
    v_mfma_f32_32x32x16_bf16 v[144:159], v[60:63], a[44:47], v[144:159]
    v_mfma_f32_32x32x16_bf16 v[144:159], v[64:67], a[48:51], v[144:159]
    v_mfma_f32_32x32x16_bf16 v[144:159], v[68:71], a[52:55], v[144:159]
    v_mfma_f32_32x32x16_bf16 v[144:159], v[72:75], a[56:59], v[144:159]
    v_mfma_f32_32x32x16_bf16 v[144:159], v[76:79], a[60:63], v[144:159]
    s_waitcnt vmcnt(0)
    v_mfma_f32_32x32x16_bf16 v[144:159], v[80:83], a[64:67], v[144:159]
    v_mfma_f32_32x32x16_bf16 v[144:159], v[84:87], a[68:71], v[144:159]
    v_mfma_f32_32x32x16_bf16 v[144:159], v[88:91], a[72:75], v[144:159]
    v_mfma_f32_32x32x16_bf16 v[144:159], v[92:95], a[76:79], v[144:159]
    v_mfma_f32_32x32x16_bf16 v[144:159], v[96:99], a[80:83], v[144:159]
    v_mfma_f32_32x32x16_bf16 v[144:159], v[100:103], a[84:87], v[144:159]
    v_mfma_f32_32x32x16_bf16 v[144:159], v[104:107], a[88:91], v[144:159]
    v_mfma_f32_32x32x16_bf16 v[144:159], v[108:111], a[92:95], v[144:159]
    v_mfma_f32_32x32x16_bf16 v[144:159], v[112:115], a[96:99], v[144:159]
    v_mfma_f32_32x32x16_bf16 v[144:159], v[116:119], a[100:103], v[144:159]
    v_mfma_f32_32x32x16_bf16 v[144:159], v[120:123], a[104:107], v[144:159]
    v_mfma_f32_32x32x16_bf16 v[144:159], v[124:127], a[108:111], v[144:159]
    v_mfma_f32_32x32x16_bf16 v[144:159], v[128:131], a[112:115], v[144:159]
    v_mfma_f32_32x32x16_bf16 v[144:159], v[132:135], a[116:119], v[144:159]
    v_mfma_f32_32x32x16_bf16 v[144:159], v[136:139], a[120:123], v[144:159]
    v_mfma_f32_32x32x16_bf16 v[144:159], v[140:143], a[124:127], v[144:159]
    s_nop 15
    v_cvt_pk_bf16_f32 v160, v144, v145
    v_cvt_pk_bf16_f32 v161, v146, v147
    v_cvt_pk_bf16_f32 v162, v148, v149
    v_cvt_pk_bf16_f32 v163, v150, v151
    v_cvt_pk_bf16_f32 v164, v152, v153
    v_cvt_pk_bf16_f32 v165, v154, v155
    v_cvt_pk_bf16_f32 v166, v156, v157
    v_cvt_pk_bf16_f32 v167, v158, v159
    buffer_store_dwordx4 v[160:163], v9, s[32:35], 0 offen offset:768
    buffer_store_dwordx4 v[164:167], v9, s[32:35], 0 offen offset:800
    s_nop 1
    s_branch wk_loop
tk_bfin:
    s_load_dwordx2 s[4:5], s[0:1], 104
    s_load_dwordx2 s[6:7], s[0:1], 32
    s_load_dwordx2 s[8:9], s[0:1], 88
    v_lshrrev_b32 v1, 6, v0
    v_and_b32 v2, 63, v0
    s_nop 0
    v_readfirstlane_b32 s10, v1
    v_and_b32 v3, 31, v2
    v_lshrrev_b32 v4, 5, v2
    v_and_b32 v5, 0x13, v3
    v_and_b32 v6, 4, v3
    v_lshl_or_b32 v5, v6, 1, v5
    v_and_b32 v6, 8, v3
    v_lshrrev_b32 v6, 1, v6
    v_or_b32 v5, v6, v5
    s_waitcnt lgkmcnt(0)
    s_add_u32 s12, s4, 0x5c80000
    s_addc_u32 s13, s5, 0x0
    s_mov_b32 s14, 0x1c0000
    s_mov_b32 s15, 0x00020000
    s_add_u32 s16, s4, 0xc40000
    s_addc_u32 s17, s5, 0x0
    s_mov_b32 s18, 0x1c00000
    s_mov_b32 s19, 0x00020000
    s_add_u32 s20, s4, 0x2840000
    s_addc_u32 s21, s5, 0x0
    s_mov_b32 s22, 0x1c00000
    s_mov_b32 s23, 0x00020000
    s_add_u32 s24, s4, 0x4440000
    s_addc_u32 s25, s5, 0x0
    s_mov_b32 s26, 0x700000
    s_mov_b32 s27, 0x00020000
    s_add_u32 s28, s4, 0x4b40000
    s_addc_u32 s29, s5, 0x0
    s_mov_b32 s30, 0x700000
    s_mov_b32 s31, 0x00020000
    s_mov_b32 s32, s8
    s_mov_b32 s33, s9
    s_mov_b32 s34, 0x380000
    s_mov_b32 s35, 0x00020000
    s_add_u32 s76, s4, 0x5434000
    s_addc_u32 s77, s5, 0x0
    s_mov_b32 s78, 0x8000
    s_mov_b32 s79, 0x00020000
    s_cmp_eq_u32 s93, 1
    s_cbranch_scc1 is_46
    s_mov_b32 s93, 1
    v_readfirstlane_b32 s74, v0
    s_nop 3
    s_cmp_lt_u32 s74, 64
    s_cbranch_scc0 is_46
    s_load_dwordx2 s[74:75], s[0:1], 96
    s_waitcnt lgkmcnt(0)
    s_mov_b32 s84, s74
    s_mov_b32 s85, s75
    s_mov_b32 s86, 0x100
    s_mov_b32 s87, 0x00020000
    v_mov_b32 v13, 8
    s_mov_b32 s74, 0
wc_47:
    buffer_load_dword v12, v13, s[84:87], 0 offen sc1
    s_add_u32 s74, s74, 1
    s_cmp_gt_u32 s74, 3000000
    s_cbranch_scc1 wk_done
    s_waitcnt vmcnt(0)
    v_readfirstlane_b32 s75, v12
    s_nop 3
    s_cmp_ge_u32 s75, 256
    s_cbranch_scc1 wc_47_ok
    s_sleep 8
    s_branch wc_47
wc_47_ok:
is_46:
    s_mul_i32 s11, s100, 28672
    v_lshlrev_b32 v6, 4, v2
    s_add_u32 s39, s11, 0
    buffer_load_dwordx4 a[0:3], v6, s[12:15], s39 offen offset:0
    buffer_load_dwordx4 a[4:7], v6, s[12:15], s39 offen offset:1024
    buffer_load_dwordx4 a[8:11], v6, s[12:15], s39 offen offset:2048
    buffer_load_dwordx4 a[12:15], v6, s[12:15], s39 offen offset:3072
    s_add_u32 s39, s11, 4096
    buffer_load_dwordx4 a[16:19], v6, s[12:15], s39 offen offset:0
    buffer_load_dwordx4 a[20:23], v6, s[12:15], s39 offen offset:1024
    buffer_load_dwordx4 a[24:27], v6, s[12:15], s39 offen offset:2048
    buffer_load_dwordx4 a[28:31], v6, s[12:15], s39 offen offset:3072
    s_add_u32 s39, s11, 8192
    buffer_load_dwordx4 a[32:35], v6, s[12:15], s39 offen offset:0
    buffer_load_dwordx4 a[36:39], v6, s[12:15], s39 offen offset:1024
    buffer_load_dwordx4 a[40:43], v6, s[12:15], s39 offen offset:2048
    buffer_load_dwordx4 a[44:47], v6, s[12:15], s39 offen offset:3072
    s_add_u32 s39, s11, 12288
    buffer_load_dwordx4 a[48:51], v6, s[12:15], s39 offen offset:0
    buffer_load_dwordx4 a[52:55], v6, s[12:15], s39 offen offset:1024
    buffer_load_dwordx4 a[56:59], v6, s[12:15], s39 offen offset:2048
    buffer_load_dwordx4 a[60:63], v6, s[12:15], s39 offen offset:3072
    s_add_u32 s39, s11, 16384
    buffer_load_dwordx4 a[64:67], v6, s[12:15], s39 offen offset:0
    buffer_load_dwordx4 a[68:71], v6, s[12:15], s39 offen offset:1024
    buffer_load_dwordx4 a[72:75], v6, s[12:15], s39 offen offset:2048
    buffer_load_dwordx4 a[76:79], v6, s[12:15], s39 offen offset:3072
    s_add_u32 s39, s11, 20480
    buffer_load_dwordx4 a[80:83], v6, s[12:15], s39 offen offset:0
    buffer_load_dwordx4 a[84:87], v6, s[12:15], s39 offen offset:1024
    buffer_load_dwordx4 a[88:91], v6, s[12:15], s39 offen offset:2048
    buffer_load_dwordx4 a[92:95], v6, s[12:15], s39 offen offset:3072
    s_add_u32 s39, s11, 24576
    buffer_load_dwordx4 a[96:99], v6, s[12:15], s39 offen offset:0
    buffer_load_dwordx4 a[100:103], v6, s[12:15], s39 offen offset:1024
    buffer_load_dwordx4 a[104:107], v6, s[12:15], s39 offen offset:2048
    buffer_load_dwordx4 a[108:111], v6, s[12:15], s39 offen offset:3072
    v_lshrrev_b32 v7, 4, v5
    v_mul_u32_u24 v7, 14336, v7
    v_lshl_add_u32 v7, v4, 10, v7
    v_and_b32 v8, 15, v5
    v_lshl_add_u32 v7, v8, 4, v7
    v_lshlrev_b32 v8, 5, v3
    v_lshl_add_u32 v8, v4, 4, v8
    s_lshl_b32 s36, s100, 2
    s_add_u32 s36, s36, s10
    s_mul_i32 s37, s36, 28672
    s_mul_i32 s38, s36, 114688
    v_lshlrev_b32 v9, 3, v4
    v_sub_u32 v9, v3, v9
    v_cmp_le_i32 s[40:41], 0, v9
    v_cmp_le_i32 s[42:43], 1, v9
    v_cmp_le_i32 s[44:45], 2, v9
    v_cmp_le_i32 s[46:47], 3, v9
    v_cmp_le_i32 s[48:49], 4, v9
    v_cmp_le_i32 s[50:51], 5, v9
    v_cmp_le_i32 s[52:53], 6, v9
    v_cmp_le_i32 s[54:55], 7, v9
    v_cmp_le_i32 s[56:57], 16, v9
    v_cmp_le_i32 s[58:59], 17, v9
    v_cmp_le_i32 s[60:61], 18, v9
    v_cmp_le_i32 s[62:63], 19, v9
    v_cmp_le_i32 s[64:65], 20, v9
    v_cmp_le_i32 s[66:67], 21, v9
    v_cmp_le_i32 s[68:69], 22, v9
    v_cmp_le_i32 s[70:71], 23, v9
    s_mov_b32 s72, 0x3db8aa3b
    v_mov_b32 v10, 0xf149f2ca
    s_lshr_b32 s11, s100, 3
    s_lshl_b32 s11, s11, 10
    s_add_u32 s11, s11, 4096
    s_cmp_eq_u32 s93, 1
    s_cbranch_scc1 is_49
    s_mov_b32 s93, 1
    v_readfirstlane_b32 s74, v0
    s_nop 3
    s_cmp_lt_u32 s74, 64
    s_cbranch_scc0 is_49
    s_load_dwordx2 s[74:75], s[0:1], 96
    s_waitcnt lgkmcnt(0)
    s_mov_b32 s84, s74
    s_mov_b32 s85, s75
    s_mov_b32 s86, 0x100
    s_mov_b32 s87, 0x00020000
    v_mov_b32 v209, 8
    s_mov_b32 s74, 0
wc_50:
    buffer_load_dword v208, v209, s[84:87], 0 offen sc1
    s_add_u32 s74, s74, 1
    s_cmp_gt_u32 s74, 3000000
    s_cbranch_scc1 wk_done
    s_waitcnt vmcnt(0)
    v_readfirstlane_b32 s75, v208
    s_nop 3
    s_cmp_ge_u32 s75, 256
    s_cbranch_scc1 wc_50_ok
    s_sleep 8
    s_branch wc_50
wc_50_ok:
is_49:
    v_readfirstlane_b32 s74, v0
    s_nop 3
    s_cmp_lt_u32 s74, 64
    s_cbranch_scc0 fx_48
    v_and_b32 v216, 63, v0
    v_lshlrev_b32 v216, 4, v216
    v_add_u32 v216, s11, v216
    s_mov_b32 s74, 0
    v_mov_b32 v208, 0
    v_mov_b32 v209, 0
    v_mov_b32 v210, 0
    v_mov_b32 v211, 0
    v_mov_b32 v212, 0
    v_mov_b32 v213, 0
    v_mov_b32 v214, 0
    v_mov_b32 v215, 0
fw_51:
    s_mov_b32 exec_lo, 0xffffffff
    s_mov_b32 exec_hi, 0xffffff
    buffer_load_dwordx4 v[208:211], v216, s[96:99], 0 offen sc1
    s_mov_b64 exec, -1
    s_add_u32 s74, s74, 1
    s_cmp_gt_u32 s74, 3000000
    s_cbranch_scc1 wk_done
    s_waitcnt vmcnt(0)
    v_max3_u32 v208, v208, v209, v210
    v_max3_u32 v212, v212, v213, v214
    v_max3_u32 v208, v208, v211, v215
    v_max_u32 v208, v208, v212
    v_cmp_eq_u32 vcc, -1, v208
    s_cbranch_vccz fw_51_ok
    s_sleep 8
    s_branch fw_51
fw_51_ok:
fx_48:
    s_barrier
    s_add_u32 s39, s38, 0
    buffer_load_dwordx4 v[16:19], v7, s[16:19], s39 offen offset:0 sc1
    buffer_load_dwordx4 v[20:23], v7, s[16:19], s39 offen offset:256 sc1
    buffer_load_dwordx4 v[24:27], v7, s[16:19], s39 offen offset:512 sc1
    buffer_load_dwordx4 v[28:31], v7, s[16:19], s39 offen offset:768 sc1
    s_add_u32 s39, s38, 2048
    buffer_load_dwordx4 v[32:35], v7, s[16:19], s39 offen offset:0 sc1
    buffer_load_dwordx4 v[36:39], v7, s[16:19], s39 offen offset:256 sc1
    buffer_load_dwordx4 v[40:43], v7, s[16:19], s39 offen offset:512 sc1
    buffer_load_dwordx4 v[44:47], v7, s[16:19], s39 offen offset:768 sc1
    s_add_u32 s39, s38, 4096
    buffer_load_dwordx4 v[48:51], v7, s[16:19], s39 offen offset:0 sc1
    buffer_load_dwordx4 v[52:55], v7, s[16:19], s39 offen offset:256 sc1
    buffer_load_dwordx4 v[56:59], v7, s[16:19], s39 offen offset:512 sc1
    buffer_load_dwordx4 v[60:63], v7, s[16:19], s39 offen offset:768 sc1
    s_add_u32 s39, s38, 6144
    buffer_load_dwordx4 v[64:67], v7, s[16:19], s39 offen offset:0 sc1
    buffer_load_dwordx4 v[68:71], v7, s[16:19], s39 offen offset:256 sc1
    buffer_load_dwordx4 v[72:75], v7, s[16:19], s39 offen offset:512 sc1
    buffer_load_dwordx4 v[76:79], v7, s[16:19], s39 offen offset:768 sc1
    s_add_u32 s39, s38, 8192
    buffer_load_dwordx4 v[80:83], v7, s[16:19], s39 offen offset:0 sc1
    buffer_load_dwordx4 v[84:87], v7, s[16:19], s39 offen offset:256 sc1
    buffer_load_dwordx4 v[88:91], v7, s[16:19], s39 offen offset:512 sc1
    buffer_load_dwordx4 v[92:95], v7, s[16:19], s39 offen offset:768 sc1
    s_add_u32 s39, s38, 10240
    buffer_load_dwordx4 v[96:99], v7, s[16:19], s39 offen offset:0 sc1
    buffer_load_dwordx4 v[100:103], v7, s[16:19], s39 offen offset:256 sc1
    buffer_load_dwordx4 v[104:107], v7, s[16:19], s39 offen offset:512 sc1
    buffer_load_dwordx4 v[108:111], v7, s[16:19], s39 offen offset:768 sc1
    s_add_u32 s39, s38, 12288
    buffer_load_dwordx4 v[112:115], v7, s[16:19], s39 offen offset:0 sc1
    buffer_load_dwordx4 v[116:119], v7, s[16:19], s39 offen offset:256 sc1
    buffer_load_dwordx4 v[120:123], v7, s[16:19], s39 offen offset:512 sc1
    buffer_load_dwordx4 v[124:127], v7, s[16:19], s39 offen offset:768 sc1
    s_add_u32 s39, s38, 28672
    buffer_load_dwordx4 a[112:115], v7, s[16:19], s39 offen offset:0 sc1
    buffer_load_dwordx4 a[116:119], v7, s[16:19], s39 offen offset:256 sc1
    buffer_load_dwordx4 a[120:123], v7, s[16:19], s39 offen offset:512 sc1
    buffer_load_dwordx4 a[124:127], v7, s[16:19], s39 offen offset:768 sc1
    s_add_u32 s39, s38, 30720
    buffer_load_dwordx4 a[128:131], v7, s[16:19], s39 offen offset:0 sc1
    buffer_load_dwordx4 a[132:135], v7, s[16:19], s39 offen offset:256 sc1
    buffer_load_dwordx4 a[136:139], v7, s[16:19], s39 offen offset:512 sc1
    buffer_load_dwordx4 a[140:143], v7, s[16:19], s39 offen offset:768 sc1
    s_add_u32 s39, s38, 32768
    buffer_load_dwordx4 a[144:147], v7, s[16:19], s39 offen offset:0 sc1
    buffer_load_dwordx4 a[148:151], v7, s[16:19], s39 offen offset:256 sc1
    buffer_load_dwordx4 a[152:155], v7, s[16:19], s39 offen offset:512 sc1
    buffer_load_dwordx4 a[156:159], v7, s[16:19], s39 offen offset:768 sc1
    s_add_u32 s39, s38, 34816
    buffer_load_dwordx4 a[160:163], v7, s[16:19], s39 offen offset:0 sc1
    buffer_load_dwordx4 a[164:167], v7, s[16:19], s39 offen offset:256 sc1
    buffer_load_dwordx4 a[168:171], v7, s[16:19], s39 offen offset:512 sc1
    buffer_load_dwordx4 a[172:175], v7, s[16:19], s39 offen offset:768 sc1
    s_add_u32 s39, s38, 36864
    buffer_load_dwordx4 a[176:179], v7, s[16:19], s39 offen offset:0 sc1
    buffer_load_dwordx4 a[180:183], v7, s[16:19], s39 offen offset:256 sc1
    buffer_load_dwordx4 a[184:187], v7, s[16:19], s39 offen offset:512 sc1
    buffer_load_dwordx4 a[188:191], v7, s[16:19], s39 offen offset:768 sc1
    s_add_u32 s39, s38, 38912
    buffer_load_dwordx4 a[192:195], v7, s[16:19], s39 offen offset:0 sc1
    buffer_load_dwordx4 a[196:199], v7, s[16:19], s39 offen offset:256 sc1
    buffer_load_dwordx4 a[200:203], v7, s[16:19], s39 offen offset:512 sc1
    buffer_load_dwordx4 a[204:207], v7, s[16:19], s39 offen offset:768 sc1
    s_add_u32 s39, s38, 40960
    buffer_load_dwordx4 a[208:211], v7, s[16:19], s39 offen offset:0 sc1
    buffer_load_dwordx4 a[212:215], v7, s[16:19], s39 offen offset:256 sc1
    buffer_load_dwordx4 a[216:219], v7, s[16:19], s39 offen offset:512 sc1
    buffer_load_dwordx4 a[220:223], v7, s[16:19], s39 offen offset:768 sc1
    s_waitcnt vmcnt(28)
    v_mfma_f32_32x32x16_bf16 v[144:159], v[16:19], a[0:3], 0
    v_mfma_f32_32x32x16_bf16 v[144:159], v[20:23], a[4:7], v[144:159]
    v_mfma_f32_32x32x16_bf16 v[144:159], v[24:27], a[8:11], v[144:159]
    v_mfma_f32_32x32x16_bf16 v[144:159], v[28:31], a[12:15], v[144:159]
    v_mfma_f32_32x32x16_bf16 v[144:159], v[32:35], a[16:19], v[144:159]
    v_mfma_f32_32x32x16_bf16 v[144:159], v[36:39], a[20:23], v[144:159]
    v_mfma_f32_32x32x16_bf16 v[144:159], v[40:43], a[24:27], v[144:159]
    v_mfma_f32_32x32x16_bf16 v[144:159], v[44:47], a[28:31], v[144:159]
    v_mfma_f32_32x32x16_bf16 v[144:159], v[48:51], a[32:35], v[144:159]
    v_mfma_f32_32x32x16_bf16 v[144:159], v[52:55], a[36:39], v[144:159]
    v_mfma_f32_32x32x16_bf16 v[144:159], v[56:59], a[40:43], v[144:159]
    v_mfma_f32_32x32x16_bf16 v[144:159], v[60:63], a[44:47], v[144:159]
    v_mfma_f32_32x32x16_bf16 v[144:159], v[64:67], a[48:51], v[144:159]
    v_mfma_f32_32x32x16_bf16 v[144:159], v[68:71], a[52:55], v[144:159]
    v_mfma_f32_32x32x16_bf16 v[144:159], v[72:75], a[56:59], v[144:159]
    v_mfma_f32_32x32x16_bf16 v[144:159], v[76:79], a[60:63], v[144:159]
    v_mfma_f32_32x32x16_bf16 v[144:159], v[80:83], a[64:67], v[144:159]
    v_mfma_f32_32x32x16_bf16 v[144:159], v[84:87], a[68:71], v[144:159]
    v_mfma_f32_32x32x16_bf16 v[144:159], v[88:91], a[72:75], v[144:159]
    v_mfma_f32_32x32x16_bf16 v[144:159], v[92:95], a[76:79], v[144:159]
    v_mfma_f32_32x32x16_bf16 v[144:159], v[96:99], a[80:83], v[144:159]
    v_mfma_f32_32x32x16_bf16 v[144:159], v[100:103], a[84:87], v[144:159]
    v_mfma_f32_32x32x16_bf16 v[144:159], v[104:107], a[88:91], v[144:159]
    v_mfma_f32_32x32x16_bf16 v[144:159], v[108:111], a[92:95], v[144:159]
    v_mfma_f32_32x32x16_bf16 v[144:159], v[112:115], a[96:99], v[144:159]
    v_mfma_f32_32x32x16_bf16 v[144:159], v[116:119], a[100:103], v[144:159]
    v_mfma_f32_32x32x16_bf16 v[144:159], v[120:123], a[104:107], v[144:159]
    v_mfma_f32_32x32x16_bf16 v[144:159], v[124:127], a[108:111], v[144:159]
    s_nop 0
    s_add_u32 s39, s38, 57344
    buffer_load_dwordx4 v[16:19], v7, s[16:19], s39 offen offset:0 sc1
    buffer_load_dwordx4 v[20:23], v7, s[16:19], s39 offen offset:256 sc1
    buffer_load_dwordx4 v[24:27], v7, s[16:19], s39 offen offset:512 sc1
    buffer_load_dwordx4 v[28:31], v7, s[16:19], s39 offen offset:768 sc1
    s_add_u32 s39, s38, 59392
    buffer_load_dwordx4 v[32:35], v7, s[16:19], s39 offen offset:0 sc1
    buffer_load_dwordx4 v[36:39], v7, s[16:19], s39 offen offset:256 sc1
    buffer_load_dwordx4 v[40:43], v7, s[16:19], s39 offen offset:512 sc1
    buffer_load_dwordx4 v[44:47], v7, s[16:19], s39 offen offset:768 sc1
    s_add_u32 s39, s38, 61440
    buffer_load_dwordx4 v[48:51], v7, s[16:19], s39 offen offset:0 sc1
    buffer_load_dwordx4 v[52:55], v7, s[16:19], s39 offen offset:256 sc1
    buffer_load_dwordx4 v[56:59], v7, s[16:19], s39 offen offset:512 sc1
    buffer_load_dwordx4 v[60:63], v7, s[16:19], s39 offen offset:768 sc1
    s_add_u32 s39, s38, 63488
    buffer_load_dwordx4 v[64:67], v7, s[16:19], s39 offen offset:0 sc1
    buffer_load_dwordx4 v[68:71], v7, s[16:19], s39 offen offset:256 sc1
    buffer_load_dwordx4 v[72:75], v7, s[16:19], s39 offen offset:512 sc1
    buffer_load_dwordx4 v[76:79], v7, s[16:19], s39 offen offset:768 sc1
    s_add_u32 s39, s38, 65536
    buffer_load_dwordx4 v[80:83], v7, s[16:19], s39 offen offset:0 sc1
    buffer_load_dwordx4 v[84:87], v7, s[16:19], s39 offen offset:256 sc1
    buffer_load_dwordx4 v[88:91], v7, s[16:19], s39 offen offset:512 sc1
    buffer_load_dwordx4 v[92:95], v7, s[16:19], s39 offen offset:768 sc1
    s_add_u32 s39, s38, 67584
    buffer_load_dwordx4 v[96:99], v7, s[16:19], s39 offen offset:0 sc1
    buffer_load_dwordx4 v[100:103], v7, s[16:19], s39 offen offset:256 sc1
    buffer_load_dwordx4 v[104:107], v7, s[16:19], s39 offen offset:512 sc1
    buffer_load_dwordx4 v[108:111], v7, s[16:19], s39 offen offset:768 sc1
    s_add_u32 s39, s38, 69632
    buffer_load_dwordx4 v[112:115], v7, s[16:19], s39 offen offset:0 sc1
    buffer_load_dwordx4 v[116:119], v7, s[16:19], s39 offen offset:256 sc1
    buffer_load_dwordx4 v[120:123], v7, s[16:19], s39 offen offset:512 sc1
    buffer_load_dwordx4 v[124:127], v7, s[16:19], s39 offen offset:768 sc1
    s_waitcnt vmcnt(28)
    v_mfma_f32_32x32x16_bf16 v[160:175], a[112:115], a[0:3], 0
    v_mfma_f32_32x32x16_bf16 v[160:175], a[116:119], a[4:7], v[160:175]
    v_mfma_f32_32x32x16_bf16 v[160:175], a[120:123], a[8:11], v[160:175]
    v_mfma_f32_32x32x16_bf16 v[160:175], a[124:127], a[12:15], v[160:175]
    v_mfma_f32_32x32x16_bf16 v[160:175], a[128:131], a[16:19], v[160:175]
    v_mfma_f32_32x32x16_bf16 v[160:175], a[132:135], a[20:23], v[160:175]
    v_mfma_f32_32x32x16_bf16 v[160:175], a[136:139], a[24:27], v[160:175]
    v_mfma_f32_32x32x16_bf16 v[160:175], a[140:143], a[28:31], v[160:175]
    v_mfma_f32_32x32x16_bf16 v[160:175], a[144:147], a[32:35], v[160:175]
    v_mfma_f32_32x32x16_bf16 v[160:175], a[148:151], a[36:39], v[160:175]
    v_mfma_f32_32x32x16_bf16 v[160:175], a[152:155], a[40:43], v[160:175]
    v_mfma_f32_32x32x16_bf16 v[160:175], a[156:159], a[44:47], v[160:175]
    v_mfma_f32_32x32x16_bf16 v[160:175], a[160:163], a[48:51], v[160:175]
    v_mfma_f32_32x32x16_bf16 v[160:175], a[164:167], a[52:55], v[160:175]
    v_mfma_f32_32x32x16_bf16 v[160:175], a[168:171], a[56:59], v[160:175]
    v_mfma_f32_32x32x16_bf16 v[160:175], a[172:175], a[60:63], v[160:175]
    v_mfma_f32_32x32x16_bf16 v[160:175], a[176:179], a[64:67], v[160:175]
    v_mfma_f32_32x32x16_bf16 v[160:175], a[180:183], a[68:71], v[160:175]
    v_mfma_f32_32x32x16_bf16 v[160:175], a[184:187], a[72:75], v[160:175]
    v_mfma_f32_32x32x16_bf16 v[160:175], a[188:191], a[76:79], v[160:175]
    v_mfma_f32_32x32x16_bf16 v[160:175], a[192:195], a[80:83], v[160:175]
    v_mfma_f32_32x32x16_bf16 v[160:175], a[196:199], a[84:87], v[160:175]
    v_mfma_f32_32x32x16_bf16 v[160:175], a[200:203], a[88:91], v[160:175]
    v_mfma_f32_32x32x16_bf16 v[160:175], a[204:207], a[92:95], v[160:175]
    v_mfma_f32_32x32x16_bf16 v[160:175], a[208:211], a[96:99], v[160:175]
    v_mfma_f32_32x32x16_bf16 v[160:175], a[212:215], a[100:103], v[160:175]
    v_mfma_f32_32x32x16_bf16 v[160:175], a[216:219], a[104:107], v[160:175]
    v_mfma_f32_32x32x16_bf16 v[160:175], a[220:223], a[108:111], v[160:175]
    s_nop 0
    s_add_u32 s39, s38, 86016
    buffer_load_dwordx4 a[112:115], v7, s[16:19], s39 offen offset:0 sc1
    buffer_load_dwordx4 a[116:119], v7, s[16:19], s39 offen offset:256 sc1
    buffer_load_dwordx4 a[120:123], v7, s[16:19], s39 offen offset:512 sc1
    buffer_load_dwordx4 a[124:127], v7, s[16:19], s39 offen offset:768 sc1
    s_add_u32 s39, s38, 88064
    buffer_load_dwordx4 a[128:131], v7, s[16:19], s39 offen offset:0 sc1
    buffer_load_dwordx4 a[132:135], v7, s[16:19], s39 offen offset:256 sc1
    buffer_load_dwordx4 a[136:139], v7, s[16:19], s39 offen offset:512 sc1
    buffer_load_dwordx4 a[140:143], v7, s[16:19], s39 offen offset:768 sc1
    s_add_u32 s39, s38, 90112
    buffer_load_dwordx4 a[144:147], v7, s[16:19], s39 offen offset:0 sc1
    buffer_load_dwordx4 a[148:151], v7, s[16:19], s39 offen offset:256 sc1
    buffer_load_dwordx4 a[152:155], v7, s[16:19], s39 offen offset:512 sc1
    buffer_load_dwordx4 a[156:159], v7, s[16:19], s39 offen offset:768 sc1
    s_add_u32 s39, s38, 92160
    buffer_load_dwordx4 a[160:163], v7, s[16:19], s39 offen offset:0 sc1
    buffer_load_dwordx4 a[164:167], v7, s[16:19], s39 offen offset:256 sc1
    buffer_load_dwordx4 a[168:171], v7, s[16:19], s39 offen offset:512 sc1
    buffer_load_dwordx4 a[172:175], v7, s[16:19], s39 offen offset:768 sc1
    s_add_u32 s39, s38, 94208
    buffer_load_dwordx4 a[176:179], v7, s[16:19], s39 offen offset:0 sc1
    buffer_load_dwordx4 a[180:183], v7, s[16:19], s39 offen offset:256 sc1
    buffer_load_dwordx4 a[184:187], v7, s[16:19], s39 offen offset:512 sc1
    buffer_load_dwordx4 a[188:191], v7, s[16:19], s39 offen offset:768 sc1
    s_add_u32 s39, s38, 96256
    buffer_load_dwordx4 a[192:195], v7, s[16:19], s39 offen offset:0 sc1
    buffer_load_dwordx4 a[196:199], v7, s[16:19], s39 offen offset:256 sc1
    buffer_load_dwordx4 a[200:203], v7, s[16:19], s39 offen offset:512 sc1
    buffer_load_dwordx4 a[204:207], v7, s[16:19], s39 offen offset:768 sc1
    s_add_u32 s39, s38, 98304
    buffer_load_dwordx4 a[208:211], v7, s[16:19], s39 offen offset:0 sc1
    buffer_load_dwordx4 a[212:215], v7, s[16:19], s39 offen offset:256 sc1
    buffer_load_dwordx4 a[216:219], v7, s[16:19], s39 offen offset:512 sc1
    buffer_load_dwordx4 a[220:223], v7, s[16:19], s39 offen offset:768 sc1
    s_waitcnt vmcnt(28)
    v_mfma_f32_32x32x16_bf16 v[176:191], v[16:19], a[0:3], 0
    v_mfma_f32_32x32x16_bf16 v[176:191], v[20:23], a[4:7], v[176:191]
    v_mfma_f32_32x32x16_bf16 v[176:191], v[24:27], a[8:11], v[176:191]
    v_mfma_f32_32x32x16_bf16 v[176:191], v[28:31], a[12:15], v[176:191]
    v_mfma_f32_32x32x16_bf16 v[176:191], v[32:35], a[16:19], v[176:191]
    v_mfma_f32_32x32x16_bf16 v[176:191], v[36:39], a[20:23], v[176:191]
    v_mfma_f32_32x32x16_bf16 v[176:191], v[40:43], a[24:27], v[176:191]
    v_mfma_f32_32x32x16_bf16 v[176:191], v[44:47], a[28:31], v[176:191]
    v_mfma_f32_32x32x16_bf16 v[176:191], v[48:51], a[32:35], v[176:191]
    v_mfma_f32_32x32x16_bf16 v[176:191], v[52:55], a[36:39], v[176:191]
    v_mfma_f32_32x32x16_bf16 v[176:191], v[56:59], a[40:43], v[176:191]
    v_mfma_f32_32x32x16_bf16 v[176:191], v[60:63], a[44:47], v[176:191]
    v_mfma_f32_32x32x16_bf16 v[176:191], v[64:67], a[48:51], v[176:191]
    v_mfma_f32_32x32x16_bf16 v[176:191], v[68:71], a[52:55], v[176:191]
    v_mfma_f32_32x32x16_bf16 v[176:191], v[72:75], a[56:59], v[176:191]
    v_mfma_f32_32x32x16_bf16 v[176:191], v[76:79], a[60:63], v[176:191]
    v_mfma_f32_32x32x16_bf16 v[176:191], v[80:83], a[64:67], v[176:191]
    v_mfma_f32_32x32x16_bf16 v[176:191], v[84:87], a[68:71], v[176:191]
    v_mfma_f32_32x32x16_bf16 v[176:191], v[88:91], a[72:75], v[176:191]
    v_mfma_f32_32x32x16_bf16 v[176:191], v[92:95], a[76:79], v[176:191]
    v_mfma_f32_32x32x16_bf16 v[176:191], v[96:99], a[80:83], v[176:191]
    v_mfma_f32_32x32x16_bf16 v[176:191], v[100:103], a[84:87], v[176:191]
    v_mfma_f32_32x32x16_bf16 v[176:191], v[104:107], a[88:91], v[176:191]
    v_mfma_f32_32x32x16_bf16 v[176:191], v[108:111], a[92:95], v[176:191]
    v_mfma_f32_32x32x16_bf16 v[176:191], v[112:115], a[96:99], v[176:191]
    v_mfma_f32_32x32x16_bf16 v[176:191], v[116:119], a[100:103], v[176:191]
    v_mfma_f32_32x32x16_bf16 v[176:191], v[120:123], a[104:107], v[176:191]
    v_mfma_f32_32x32x16_bf16 v[176:191], v[124:127], a[108:111], v[176:191]
    s_waitcnt vmcnt(0)
    v_mfma_f32_32x32x16_bf16 v[192:207], a[112:115], a[0:3], 0
    v_mfma_f32_32x32x16_bf16 v[192:207], a[116:119], a[4:7], v[192:207]
    v_mfma_f32_32x32x16_bf16 v[192:207], a[120:123], a[8:11], v[192:207]
    v_mfma_f32_32x32x16_bf16 v[192:207], a[124:127], a[12:15], v[192:207]
    v_mfma_f32_32x32x16_bf16 v[192:207], a[128:131], a[16:19], v[192:207]
    v_mfma_f32_32x32x16_bf16 v[192:207], a[132:135], a[20:23], v[192:207]
    v_mfma_f32_32x32x16_bf16 v[192:207], a[136:139], a[24:27], v[192:207]
    v_mfma_f32_32x32x16_bf16 v[192:207], a[140:143], a[28:31], v[192:207]
    v_mfma_f32_32x32x16_bf16 v[192:207], a[144:147], a[32:35], v[192:207]
    v_mfma_f32_32x32x16_bf16 v[192:207], a[148:151], a[36:39], v[192:207]
    v_mfma_f32_32x32x16_bf16 v[192:207], a[152:155], a[40:43], v[192:207]
    v_mfma_f32_32x32x16_bf16 v[192:207], a[156:159], a[44:47], v[192:207]
    v_mfma_f32_32x32x16_bf16 v[192:207], a[160:163], a[48:51], v[192:207]
    v_mfma_f32_32x32x16_bf16 v[192:207], a[164:167], a[52:55], v[192:207]
    v_mfma_f32_32x32x16_bf16 v[192:207], a[168:171], a[56:59], v[192:207]
    v_mfma_f32_32x32x16_bf16 v[192:207], a[172:175], a[60:63], v[192:207]
    v_mfma_f32_32x32x16_bf16 v[192:207], a[176:179], a[64:67], v[192:207]
    v_mfma_f32_32x32x16_bf16 v[192:207], a[180:183], a[68:71], v[192:207]
    v_mfma_f32_32x32x16_bf16 v[192:207], a[184:187], a[72:75], v[192:207]
    v_mfma_f32_32x32x16_bf16 v[192:207], a[188:191], a[76:79], v[192:207]
    v_mfma_f32_32x32x16_bf16 v[192:207], a[192:195], a[80:83], v[192:207]
    v_mfma_f32_32x32x16_bf16 v[192:207], a[196:199], a[84:87], v[192:207]
    v_mfma_f32_32x32x16_bf16 v[192:207], a[200:203], a[88:91], v[192:207]
    v_mfma_f32_32x32x16_bf16 v[192:207], a[204:207], a[92:95], v[192:207]
    v_mfma_f32_32x32x16_bf16 v[192:207], a[208:211], a[96:99], v[192:207]
    v_mfma_f32_32x32x16_bf16 v[192:207], a[212:215], a[100:103], v[192:207]
    v_mfma_f32_32x32x16_bf16 v[192:207], a[216:219], a[104:107], v[192:207]
    v_mfma_f32_32x32x16_bf16 v[192:207], a[220:223], a[108:111], v[192:207]
    s_nop 15
    v_cndmask_b32_e64 v144, v10, v144, s[40:41]
    v_cndmask_b32_e64 v145, v10, v145, s[42:43]
    v_cndmask_b32_e64 v146, v10, v146, s[44:45]
    v_cndmask_b32_e64 v147, v10, v147, s[46:47]
    v_cndmask_b32_e64 v148, v10, v148, s[48:49]
    v_cndmask_b32_e64 v149, v10, v149, s[50:51]
    v_cndmask_b32_e64 v150, v10, v150, s[52:53]
    v_cndmask_b32_e64 v151, v10, v151, s[54:55]
    v_cndmask_b32_e64 v152, v10, v152, s[56:57]
    v_cndmask_b32_e64 v153, v10, v153, s[58:59]
    v_cndmask_b32_e64 v154, v10, v154, s[60:61]
    v_cndmask_b32_e64 v155, v10, v155, s[62:63]
    v_cndmask_b32_e64 v156, v10, v156, s[64:65]
    v_cndmask_b32_e64 v157, v10, v157, s[66:67]
    v_cndmask_b32_e64 v158, v10, v158, s[68:69]
    v_cndmask_b32_e64 v159, v10, v159, s[70:71]
    v_max3_f32 v16, v144, v145, v146
    v_max3_f32 v16, v16, v147, v148
    v_max3_f32 v16, v16, v149, v150
    v_max3_f32 v16, v16, v151, v152
    v_max3_f32 v16, v16, v153, v154
    v_max3_f32 v16, v16, v155, v156
    v_max3_f32 v16, v16, v157, v158
    v_max_f32 v16, v16, v159
    v_mov_b32 v17, v16
    s_nop 1
    v_permlane32_swap_b32 v16, v17
    s_nop 1
    v_max_f32 v16, v16, v17
    v_mul_f32 v244, s72, v16
    v_fma_f32 v144, v144, s72, -v244
    v_fma_f32 v145, v145, s72, -v244
    v_fma_f32 v146, v146, s72, -v244
    v_fma_f32 v147, v147, s72, -v244
    v_fma_f32 v148, v148, s72, -v244
    v_fma_f32 v149, v149, s72, -v244
    v_fma_f32 v150, v150, s72, -v244
    v_fma_f32 v151, v151, s72, -v244
    v_fma_f32 v152, v152, s72, -v244
    v_fma_f32 v153, v153, s72, -v244
    v_fma_f32 v154, v154, s72, -v244
    v_fma_f32 v155, v155, s72, -v244
    v_fma_f32 v156, v156, s72, -v244
    v_fma_f32 v157, v157, s72, -v244
    v_fma_f32 v158, v158, s72, -v244
    v_fma_f32 v159, v159, s72, -v244
    v_exp_f32 v144, v144
    v_exp_f32 v145, v145
    v_exp_f32 v146, v146
    v_exp_f32 v147, v147
    v_exp_f32 v148, v148
    v_exp_f32 v149, v149
    v_exp_f32 v150, v150
    v_exp_f32 v151, v151
    v_exp_f32 v152, v152
    v_exp_f32 v153, v153
    v_exp_f32 v154, v154
    v_exp_f32 v155, v155
    v_exp_f32 v156, v156
    v_exp_f32 v157, v157
    v_exp_f32 v158, v158
    v_exp_f32 v159, v159
    s_nop 0
    v_add_f32 v245, v144, v145
    v_add_f32 v245, v245, v146
    v_add_f32 v245, v245, v147
    v_add_f32 v245, v245, v148
    v_add_f32 v245, v245, v149
    v_add_f32 v245, v245, v150
    v_add_f32 v245, v245, v151
    v_add_f32 v245, v245, v152
    v_add_f32 v245, v245, v153
    v_add_f32 v245, v245, v154
    v_add_f32 v245, v245, v155
    v_add_f32 v245, v245, v156
    v_add_f32 v245, v245, v157
    v_add_f32 v245, v245, v158
    v_add_f32 v245, v245, v159
    v_cndmask_b32_e64 v160, v10, v160, s[40:41]
    v_cndmask_b32_e64 v161, v10, v161, s[42:43]
    v_cndmask_b32_e64 v162, v10, v162, s[44:45]
    v_cndmask_b32_e64 v163, v10, v163, s[46:47]
    v_cndmask_b32_e64 v164, v10, v164, s[48:49]
    v_cndmask_b32_e64 v165, v10, v165, s[50:51]
    v_cndmask_b32_e64 v166, v10, v166, s[52:53]
    v_cndmask_b32_e64 v167, v10, v167, s[54:55]
    v_cndmask_b32_e64 v168, v10, v168, s[56:57]
    v_cndmask_b32_e64 v169, v10, v169, s[58:59]
    v_cndmask_b32_e64 v170, v10, v170, s[60:61]
    v_cndmask_b32_e64 v171, v10, v171, s[62:63]
    v_cndmask_b32_e64 v172, v10, v172, s[64:65]
    v_cndmask_b32_e64 v173, v10, v173, s[66:67]
    v_cndmask_b32_e64 v174, v10, v174, s[68:69]
    v_cndmask_b32_e64 v175, v10, v175, s[70:71]
    v_max3_f32 v16, v160, v161, v162
    v_max3_f32 v16, v16, v163, v164
    v_max3_f32 v16, v16, v165, v166
    v_max3_f32 v16, v16, v167, v168
    v_max3_f32 v16, v16, v169, v170
    v_max3_f32 v16, v16, v171, v172
    v_max3_f32 v16, v16, v173, v174
    v_max_f32 v16, v16, v175
    v_mov_b32 v17, v16
    s_nop 1
    v_permlane32_swap_b32 v16, v17
    s_nop 1
    v_max_f32 v16, v16, v17
    v_mul_f32 v246, s72, v16
    v_fma_f32 v160, v160, s72, -v246
    v_fma_f32 v161, v161, s72, -v246
    v_fma_f32 v162, v162, s72, -v246
    v_fma_f32 v163, v163, s72, -v246
    v_fma_f32 v164, v164, s72, -v246
    v_fma_f32 v165, v165, s72, -v246
    v_fma_f32 v166, v166, s72, -v246
    v_fma_f32 v167, v167, s72, -v246
    v_fma_f32 v168, v168, s72, -v246
    v_fma_f32 v169, v169, s72, -v246
    v_fma_f32 v170, v170, s72, -v246
    v_fma_f32 v171, v171, s72, -v246
    v_fma_f32 v172, v172, s72, -v246
    v_fma_f32 v173, v173, s72, -v246
    v_fma_f32 v174, v174, s72, -v246
    v_fma_f32 v175, v175, s72, -v246
    v_exp_f32 v160, v160
    v_exp_f32 v161, v161
    v_exp_f32 v162, v162
    v_exp_f32 v163, v163
    v_exp_f32 v164, v164
    v_exp_f32 v165, v165
    v_exp_f32 v166, v166
    v_exp_f32 v167, v167
    v_exp_f32 v168, v168
    v_exp_f32 v169, v169
    v_exp_f32 v170, v170
    v_exp_f32 v171, v171
    v_exp_f32 v172, v172
    v_exp_f32 v173, v173
    v_exp_f32 v174, v174
    v_exp_f32 v175, v175
    s_nop 0
    v_add_f32 v247, v160, v161
    v_add_f32 v247, v247, v162
    v_add_f32 v247, v247, v163
    v_add_f32 v247, v247, v164
    v_add_f32 v247, v247, v165
    v_add_f32 v247, v247, v166
    v_add_f32 v247, v247, v167
    v_add_f32 v247, v247, v168
    v_add_f32 v247, v247, v169
    v_add_f32 v247, v247, v170
    v_add_f32 v247, v247, v171
    v_add_f32 v247, v247, v172
    v_add_f32 v247, v247, v173
    v_add_f32 v247, v247, v174
    v_add_f32 v247, v247, v175
    v_cndmask_b32_e64 v176, v10, v176, s[40:41]
    v_cndmask_b32_e64 v177, v10, v177, s[42:43]
    v_cndmask_b32_e64 v178, v10, v178, s[44:45]
    v_cndmask_b32_e64 v179, v10, v179, s[46:47]
    v_cndmask_b32_e64 v180, v10, v180, s[48:49]
    v_cndmask_b32_e64 v181, v10, v181, s[50:51]
    v_cndmask_b32_e64 v182, v10, v182, s[52:53]
    v_cndmask_b32_e64 v183, v10, v183, s[54:55]
    v_cndmask_b32_e64 v184, v10, v184, s[56:57]
    v_cndmask_b32_e64 v185, v10, v185, s[58:59]
    v_cndmask_b32_e64 v186, v10, v186, s[60:61]
    v_cndmask_b32_e64 v187, v10, v187, s[62:63]
    v_cndmask_b32_e64 v188, v10, v188, s[64:65]
    v_cndmask_b32_e64 v189, v10, v189, s[66:67]
    v_cndmask_b32_e64 v190, v10, v190, s[68:69]
    v_cndmask_b32_e64 v191, v10, v191, s[70:71]
    v_max3_f32 v16, v176, v177, v178
    v_max3_f32 v16, v16, v179, v180
    v_max3_f32 v16, v16, v181, v182
    v_max3_f32 v16, v16, v183, v184
    v_max3_f32 v16, v16, v185, v186
    v_max3_f32 v16, v16, v187, v188
    v_max3_f32 v16, v16, v189, v190
    v_max_f32 v16, v16, v191
    v_mov_b32 v17, v16
    s_nop 1
    v_permlane32_swap_b32 v16, v17
    s_nop 1
    v_max_f32 v16, v16, v17
    v_mul_f32 v248, s72, v16
    v_fma_f32 v176, v176, s72, -v248
    v_fma_f32 v177, v177, s72, -v248
    v_fma_f32 v178, v178, s72, -v248
    v_fma_f32 v179, v179, s72, -v248
    v_fma_f32 v180, v180, s72, -v248
    v_fma_f32 v181, v181, s72, -v248
    v_fma_f32 v182, v182, s72, -v248
    v_fma_f32 v183, v183, s72, -v248
    v_fma_f32 v184, v184, s72, -v248
    v_fma_f32 v185, v185, s72, -v248
    v_fma_f32 v186, v186, s72, -v248
    v_fma_f32 v187, v187, s72, -v248
    v_fma_f32 v188, v188, s72, -v248
    v_fma_f32 v189, v189, s72, -v248
    v_fma_f32 v190, v190, s72, -v248
    v_fma_f32 v191, v191, s72, -v248
    v_exp_f32 v176, v176
    v_exp_f32 v177, v177
    v_exp_f32 v178, v178
    v_exp_f32 v179, v179
    v_exp_f32 v180, v180
    v_exp_f32 v181, v181
    v_exp_f32 v182, v182
    v_exp_f32 v183, v183
    v_exp_f32 v184, v184
    v_exp_f32 v185, v185
    v_exp_f32 v186, v186
    v_exp_f32 v187, v187
    v_exp_f32 v188, v188
    v_exp_f32 v189, v189
    v_exp_f32 v190, v190
    v_exp_f32 v191, v191
    s_nop 0
    v_add_f32 v249, v176, v177
    v_add_f32 v249, v249, v178
    v_add_f32 v249, v249, v179
    v_add_f32 v249, v249, v180
    v_add_f32 v249, v249, v181
    v_add_f32 v249, v249, v182
    v_add_f32 v249, v249, v183
    v_add_f32 v249, v249, v184
    v_add_f32 v249, v249, v185
    v_add_f32 v249, v249, v186
    v_add_f32 v249, v249, v187
    v_add_f32 v249, v249, v188
    v_add_f32 v249, v249, v189
    v_add_f32 v249, v249, v190
    v_add_f32 v249, v249, v191
    v_cndmask_b32_e64 v192, v10, v192, s[40:41]
    v_cndmask_b32_e64 v193, v10, v193, s[42:43]
    v_cndmask_b32_e64 v194, v10, v194, s[44:45]
    v_cndmask_b32_e64 v195, v10, v195, s[46:47]
    v_cndmask_b32_e64 v196, v10, v196, s[48:49]
    v_cndmask_b32_e64 v197, v10, v197, s[50:51]
    v_cndmask_b32_e64 v198, v10, v198, s[52:53]
    v_cndmask_b32_e64 v199, v10, v199, s[54:55]
    v_cndmask_b32_e64 v200, v10, v200, s[56:57]
    v_cndmask_b32_e64 v201, v10, v201, s[58:59]
    v_cndmask_b32_e64 v202, v10, v202, s[60:61]
    v_cndmask_b32_e64 v203, v10, v203, s[62:63]
    v_cndmask_b32_e64 v204, v10, v204, s[64:65]
    v_cndmask_b32_e64 v205, v10, v205, s[66:67]
    v_cndmask_b32_e64 v206, v10, v206, s[68:69]
    v_cndmask_b32_e64 v207, v10, v207, s[70:71]
    v_max3_f32 v16, v192, v193, v194
    v_max3_f32 v16, v16, v195, v196
    v_max3_f32 v16, v16, v197, v198
    v_max3_f32 v16, v16, v199, v200
    v_max3_f32 v16, v16, v201, v202
    v_max3_f32 v16, v16, v203, v204
    v_max3_f32 v16, v16, v205, v206
    v_max_f32 v16, v16, v207
    v_mov_b32 v17, v16
    s_nop 1
    v_permlane32_swap_b32 v16, v17
    s_nop 1
    v_max_f32 v16, v16, v17
    v_mul_f32 v250, s72, v16
    v_fma_f32 v192, v192, s72, -v250
    v_fma_f32 v193, v193, s72, -v250
    v_fma_f32 v194, v194, s72, -v250
    v_fma_f32 v195, v195, s72, -v250
    v_fma_f32 v196, v196, s72, -v250
    v_fma_f32 v197, v197, s72, -v250
    v_fma_f32 v198, v198, s72, -v250
    v_fma_f32 v199, v199, s72, -v250
    v_fma_f32 v200, v200, s72, -v250
    v_fma_f32 v201, v201, s72, -v250
    v_fma_f32 v202, v202, s72, -v250
    v_fma_f32 v203, v203, s72, -v250
    v_fma_f32 v204, v204, s72, -v250
    v_fma_f32 v205, v205, s72, -v250
    v_fma_f32 v206, v206, s72, -v250
    v_fma_f32 v207, v207, s72, -v250
    v_exp_f32 v192, v192
    v_exp_f32 v193, v193
    v_exp_f32 v194, v194
    v_exp_f32 v195, v195
    v_exp_f32 v196, v196
    v_exp_f32 v197, v197
    v_exp_f32 v198, v198
    v_exp_f32 v199, v199
    v_exp_f32 v200, v200
    v_exp_f32 v201, v201
    v_exp_f32 v202, v202
    v_exp_f32 v203, v203
    v_exp_f32 v204, v204
    v_exp_f32 v205, v205
    v_exp_f32 v206, v206
    v_exp_f32 v207, v207
    s_nop 0
    v_add_f32 v251, v192, v193
    v_add_f32 v251, v251, v194
    v_add_f32 v251, v251, v195
    v_add_f32 v251, v251, v196
    v_add_f32 v251, v251, v197
    v_add_f32 v251, v251, v198
    v_add_f32 v251, v251, v199
    v_add_f32 v251, v251, v200
    v_add_f32 v251, v251, v201
    v_add_f32 v251, v251, v202
    v_add_f32 v251, v251, v203
    v_add_f32 v251, v251, v204
    v_add_f32 v251, v251, v205
    v_add_f32 v251, v251, v206
    v_add_f32 v251, v251, v207
    s_lshl_b32 s11, s100, 9
    v_lshlrev_b32 v14, 3, v2
    s_mov_b32 s74, 0
bf_wm:
    buffer_load_dwordx2 v[12:13], v14, s[76:79], s11 offen sc1
    s_add_u32 s74, s74, 1
    s_cmp_gt_u32 s74, 3000000
    s_cbranch_scc1 wk_done
    s_waitcnt vmcnt(0)
    v_max_u32 v12, v12, v13
    v_cmp_eq_u32 vcc, -1, v12
    s_cbranch_vccz bf_m
    s_sleep 8
    s_branch bf_wm
bf_m:
    s_add_u32 s39, s37, 0
    buffer_load_dwordx4 v[16:19], v8, s[24:27], s39 offen offset:0 sc1
    buffer_load_dwordx4 v[20:23], v8, s[24:27], s39 offen offset:1024 sc1
    buffer_load_dwordx4 v[24:27], v8, s[24:27], s39 offen offset:2048 sc1
    buffer_load_dwordx4 v[28:31], v8, s[24:27], s39 offen offset:3072 sc1
    s_add_u32 s39, s37, 4096
    buffer_load_dwordx4 v[32:35], v8, s[24:27], s39 offen offset:0 sc1
    buffer_load_dwordx4 v[36:39], v8, s[24:27], s39 offen offset:1024 sc1
    buffer_load_dwordx4 v[40:43], v8, s[24:27], s39 offen offset:2048 sc1
    buffer_load_dwordx4 v[44:47], v8, s[24:27], s39 offen offset:3072 sc1
    s_add_u32 s39, s37, 8192
    buffer_load_dwordx4 v[48:51], v8, s[24:27], s39 offen offset:0 sc1
    buffer_load_dwordx4 v[52:55], v8, s[24:27], s39 offen offset:1024 sc1
    buffer_load_dwordx4 v[56:59], v8, s[24:27], s39 offen offset:2048 sc1
    buffer_load_dwordx4 v[60:63], v8, s[24:27], s39 offen offset:3072 sc1
    s_add_u32 s39, s37, 12288
    buffer_load_dwordx4 v[64:67], v8, s[24:27], s39 offen offset:0 sc1
    buffer_load_dwordx4 v[68:71], v8, s[24:27], s39 offen offset:1024 sc1
    buffer_load_dwordx4 v[72:75], v8, s[24:27], s39 offen offset:2048 sc1
    buffer_load_dwordx4 v[76:79], v8, s[24:27], s39 offen offset:3072 sc1
    s_add_u32 s39, s37, 16384
    buffer_load_dwordx4 v[80:83], v8, s[24:27], s39 offen offset:0 sc1
    buffer_load_dwordx4 v[84:87], v8, s[24:27], s39 offen offset:1024 sc1
    buffer_load_dwordx4 v[88:91], v8, s[24:27], s39 offen offset:2048 sc1
    buffer_load_dwordx4 v[92:95], v8, s[24:27], s39 offen offset:3072 sc1
    s_add_u32 s39, s37, 20480
    buffer_load_dwordx4 v[96:99], v8, s[24:27], s39 offen offset:0 sc1
    buffer_load_dwordx4 v[100:103], v8, s[24:27], s39 offen offset:1024 sc1
    buffer_load_dwordx4 v[104:107], v8, s[24:27], s39 offen offset:2048 sc1
    buffer_load_dwordx4 v[108:111], v8, s[24:27], s39 offen offset:3072 sc1
    s_add_u32 s39, s37, 24576
    buffer_load_dwordx4 v[112:115], v8, s[24:27], s39 offen offset:0 sc1
    buffer_load_dwordx4 v[116:119], v8, s[24:27], s39 offen offset:1024 sc1
    buffer_load_dwordx4 v[120:123], v8, s[24:27], s39 offen offset:2048 sc1
    buffer_load_dwordx4 v[124:127], v8, s[24:27], s39 offen offset:3072 sc1
    s_waitcnt vmcnt(26)
    v_mfma_f32_32x32x16_bf16 v[128:143], v[16:19], a[0:3], 0
    v_mfma_f32_32x32x16_bf16 v[128:143], v[20:23], a[4:7], v[128:143]
    s_waitcnt vmcnt(24)
    v_mfma_f32_32x32x16_bf16 v[128:143], v[24:27], a[8:11], v[128:143]
    v_mfma_f32_32x32x16_bf16 v[128:143], v[28:31], a[12:15], v[128:143]
    s_waitcnt vmcnt(22)
    v_mfma_f32_32x32x16_bf16 v[128:143], v[32:35], a[16:19], v[128:143]
    v_mfma_f32_32x32x16_bf16 v[128:143], v[36:39], a[20:23], v[128:143]
    s_waitcnt vmcnt(20)
    v_mfma_f32_32x32x16_bf16 v[128:143], v[40:43], a[24:27], v[128:143]
    v_mfma_f32_32x32x16_bf16 v[128:143], v[44:47], a[28:31], v[128:143]
    s_waitcnt vmcnt(18)
    v_mfma_f32_32x32x16_bf16 v[128:143], v[48:51], a[32:35], v[128:143]
    v_mfma_f32_32x32x16_bf16 v[128:143], v[52:55], a[36:39], v[128:143]
    s_waitcnt vmcnt(16)
    v_mfma_f32_32x32x16_bf16 v[128:143], v[56:59], a[40:43], v[128:143]
    v_mfma_f32_32x32x16_bf16 v[128:143], v[60:63], a[44:47], v[128:143]
    s_waitcnt vmcnt(14)
    v_mfma_f32_32x32x16_bf16 v[128:143], v[64:67], a[48:51], v[128:143]
    v_mfma_f32_32x32x16_bf16 v[128:143], v[68:71], a[52:55], v[128:143]
    s_waitcnt vmcnt(12)
    v_mfma_f32_32x32x16_bf16 v[128:143], v[72:75], a[56:59], v[128:143]
    v_mfma_f32_32x32x16_bf16 v[128:143], v[76:79], a[60:63], v[128:143]
    s_waitcnt vmcnt(10)
    v_mfma_f32_32x32x16_bf16 v[128:143], v[80:83], a[64:67], v[128:143]
    v_mfma_f32_32x32x16_bf16 v[128:143], v[84:87], a[68:71], v[128:143]
    s_waitcnt vmcnt(8)
    v_mfma_f32_32x32x16_bf16 v[128:143], v[88:91], a[72:75], v[128:143]
    v_mfma_f32_32x32x16_bf16 v[128:143], v[92:95], a[76:79], v[128:143]
    s_waitcnt vmcnt(6)
    v_mfma_f32_32x32x16_bf16 v[128:143], v[96:99], a[80:83], v[128:143]
    v_mfma_f32_32x32x16_bf16 v[128:143], v[100:103], a[84:87], v[128:143]
    s_waitcnt vmcnt(4)
    v_mfma_f32_32x32x16_bf16 v[128:143], v[104:107], a[88:91], v[128:143]
    v_mfma_f32_32x32x16_bf16 v[128:143], v[108:111], a[92:95], v[128:143]
    s_waitcnt vmcnt(2)
    v_mfma_f32_32x32x16_bf16 v[128:143], v[112:115], a[96:99], v[128:143]
    v_mfma_f32_32x32x16_bf16 v[128:143], v[116:119], a[100:103], v[128:143]
    s_waitcnt vmcnt(0)
    v_mfma_f32_32x32x16_bf16 v[128:143], v[120:123], a[104:107], v[128:143]
    v_mfma_f32_32x32x16_bf16 v[128:143], v[124:127], a[108:111], v[128:143]
    s_nop 15
    v_lshlrev_b32 v11, 4, v2
    s_lshl_b32 s11, s10, 13
    v_add_u32 v12, s11, v11
    s_lshl_b32 s11, s10, 11
    v_add_u32 v13, s11, v11
    v_max3_f32 v48, v128, v129, v130
    v_max3_f32 v52, v132, v133, v134
    v_max3_f32 v56, v136, v137, v138
    v_max3_f32 v60, v140, v141, v142
    v_max_f32 v48, v48, v131
    v_max_f32 v52, v52, v135
    v_max_f32 v56, v56, v139
    v_max_f32 v60, v60, v143
    v_mov_b32 v49, v48
    v_mov_b32 v53, v52
    v_mov_b32 v57, v56
    v_mov_b32 v61, v60
    v_permlane32_swap_b32 v48, v49
    v_permlane32_swap_b32 v52, v53
    v_permlane32_swap_b32 v56, v57
    v_permlane32_swap_b32 v60, v61
    v_max_f32 v48, v48, v49
    v_max_f32 v52, v52, v53
    v_max_f32 v56, v56, v57
    v_max_f32 v60, v60, v61
    v_mul_f32 v48, s72, v48
    v_mul_f32 v52, s72, v52
    v_mul_f32 v56, s72, v56
    v_mul_f32 v60, s72, v60
    v_max_f32 v48, v48, v244
    v_max_f32 v52, v52, v246
    v_max_f32 v56, v56, v248
    v_max_f32 v60, v60, v250
    v_sub_f32 v50, v244, v48
    v_sub_f32 v54, v246, v52
    v_sub_f32 v58, v248, v56
    v_sub_f32 v62, v250, v60
    v_fma_f32 v128, v128, s72, -v48
    v_fma_f32 v129, v129, s72, -v48
    v_fma_f32 v130, v130, s72, -v48
    v_fma_f32 v131, v131, s72, -v48
    v_fma_f32 v132, v132, s72, -v52
    v_fma_f32 v133, v133, s72, -v52
    v_fma_f32 v134, v134, s72, -v52
    v_fma_f32 v135, v135, s72, -v52
    v_fma_f32 v136, v136, s72, -v56
    v_fma_f32 v137, v137, s72, -v56
    v_fma_f32 v138, v138, s72, -v56
    v_fma_f32 v139, v139, s72, -v56
    v_fma_f32 v140, v140, s72, -v60
    v_fma_f32 v141, v141, s72, -v60
    v_fma_f32 v142, v142, s72, -v60
    v_fma_f32 v143, v143, s72, -v60
    v_exp_f32 v50, v50
    v_exp_f32 v54, v54
    v_exp_f32 v58, v58
    v_exp_f32 v62, v62
    v_exp_f32 v128, v128
    v_exp_f32 v129, v129
    v_exp_f32 v130, v130
    v_exp_f32 v131, v131
    v_exp_f32 v132, v132
    v_exp_f32 v133, v133
    v_exp_f32 v134, v134
    v_exp_f32 v135, v135
    v_exp_f32 v136, v136
    v_exp_f32 v137, v137
    v_exp_f32 v138, v138
    v_exp_f32 v139, v139
    v_exp_f32 v140, v140
    v_exp_f32 v141, v141
    v_exp_f32 v142, v142
    v_exp_f32 v143, v143
    v_fma_f32 v48, v50, v245, v128
    v_fma_f32 v52, v54, v247, v132
    v_fma_f32 v56, v58, v249, v136
    v_fma_f32 v60, v62, v251, v140
    v_add_f32 v48, v48, v129
    v_add_f32 v52, v52, v133
    v_add_f32 v56, v56, v137
    v_add_f32 v60, v60, v141
    v_add_f32 v48, v48, v130
    v_add_f32 v52, v52, v134
    v_add_f32 v56, v56, v138
    v_add_f32 v60, v60, v142
    v_add_f32 v48, v48, v131
    v_add_f32 v52, v52, v135
    v_add_f32 v56, v56, v139
    v_add_f32 v60, v60, v143
    v_mov_b32 v49, v48
    v_mov_b32 v53, v52
    v_mov_b32 v57, v56
    v_mov_b32 v61, v60
    v_permlane32_swap_b32 v48, v49
    v_permlane32_swap_b32 v52, v53
    v_permlane32_swap_b32 v56, v57
    v_permlane32_swap_b32 v60, v61
    v_add_f32 v48, v48, v49
    v_add_f32 v52, v52, v53
    v_add_f32 v56, v56, v57
    v_add_f32 v60, v60, v61
    v_rcp_f32 v48, v48
    v_rcp_f32 v52, v52
    v_rcp_f32 v56, v56
    v_rcp_f32 v60, v60
    v_mul_f32 v50, v50, v48
    v_mul_f32 v54, v54, v52
    v_mul_f32 v58, v58, v56
    v_mul_f32 v62, v62, v60
    v_pk_mul_f32 v[144:145], v[144:145], v[50:51] op_sel_hi:[1,0]
    v_pk_mul_f32 v[146:147], v[146:147], v[50:51] op_sel_hi:[1,0]
    v_pk_mul_f32 v[148:149], v[148:149], v[50:51] op_sel_hi:[1,0]
    v_pk_mul_f32 v[150:151], v[150:151], v[50:51] op_sel_hi:[1,0]
    v_pk_mul_f32 v[152:153], v[152:153], v[50:51] op_sel_hi:[1,0]
    v_pk_mul_f32 v[154:155], v[154:155], v[50:51] op_sel_hi:[1,0]
    v_pk_mul_f32 v[156:157], v[156:157], v[50:51] op_sel_hi:[1,0]
    v_pk_mul_f32 v[158:159], v[158:159], v[50:51] op_sel_hi:[1,0]
    v_pk_mul_f32 v[128:129], v[128:129], v[48:49] op_sel_hi:[1,0]
    v_pk_mul_f32 v[130:131], v[130:131], v[48:49] op_sel_hi:[1,0]
    v_cvt_pk_bf16_f32 v64, v144, v145
    v_cvt_pk_bf16_f32 v65, v146, v147
    v_cvt_pk_bf16_f32 v66, v148, v149
    v_cvt_pk_bf16_f32 v67, v150, v151
    v_cvt_pk_bf16_f32 v68, v152, v153
    v_cvt_pk_bf16_f32 v69, v154, v155
    v_cvt_pk_bf16_f32 v70, v156, v157
    v_cvt_pk_bf16_f32 v71, v158, v159
    v_cvt_pk_bf16_f32 v40, v128, v129
    v_cvt_pk_bf16_f32 v41, v130, v131
    ds_write_b128 v12, v[64:67] offset:0
    ds_write_b128 v12, v[68:71] offset:1024
    v_pk_mul_f32 v[160:161], v[160:161], v[54:55] op_sel_hi:[1,0]
    v_pk_mul_f32 v[162:163], v[162:163], v[54:55] op_sel_hi:[1,0]
    v_pk_mul_f32 v[164:165], v[164:165], v[54:55] op_sel_hi:[1,0]
    v_pk_mul_f32 v[166:167], v[166:167], v[54:55] op_sel_hi:[1,0]
    v_pk_mul_f32 v[168:169], v[168:169], v[54:55] op_sel_hi:[1,0]
    v_pk_mul_f32 v[170:171], v[170:171], v[54:55] op_sel_hi:[1,0]
    v_pk_mul_f32 v[172:173], v[172:173], v[54:55] op_sel_hi:[1,0]
    v_pk_mul_f32 v[174:175], v[174:175], v[54:55] op_sel_hi:[1,0]
    v_pk_mul_f32 v[132:133], v[132:133], v[52:53] op_sel_hi:[1,0]
    v_pk_mul_f32 v[134:135], v[134:135], v[52:53] op_sel_hi:[1,0]
    v_cvt_pk_bf16_f32 v72, v160, v161
    v_cvt_pk_bf16_f32 v73, v162, v163
    v_cvt_pk_bf16_f32 v74, v164, v165
    v_cvt_pk_bf16_f32 v75, v166, v167
    v_cvt_pk_bf16_f32 v76, v168, v169
    v_cvt_pk_bf16_f32 v77, v170, v171
    v_cvt_pk_bf16_f32 v78, v172, v173
    v_cvt_pk_bf16_f32 v79, v174, v175
    v_cvt_pk_bf16_f32 v42, v132, v133
    v_cvt_pk_bf16_f32 v43, v134, v135
    ds_write_b128 v12, v[72:75] offset:2048
    ds_write_b128 v12, v[76:79] offset:3072
    v_pk_mul_f32 v[176:177], v[176:177], v[58:59] op_sel_hi:[1,0]
    v_pk_mul_f32 v[178:179], v[178:179], v[58:59] op_sel_hi:[1,0]
    v_pk_mul_f32 v[180:181], v[180:181], v[58:59] op_sel_hi:[1,0]
    v_pk_mul_f32 v[182:183], v[182:183], v[58:59] op_sel_hi:[1,0]
    v_pk_mul_f32 v[184:185], v[184:185], v[58:59] op_sel_hi:[1,0]
    v_pk_mul_f32 v[186:187], v[186:187], v[58:59] op_sel_hi:[1,0]
    v_pk_mul_f32 v[188:189], v[188:189], v[58:59] op_sel_hi:[1,0]
    v_pk_mul_f32 v[190:191], v[190:191], v[58:59] op_sel_hi:[1,0]
    v_pk_mul_f32 v[136:137], v[136:137], v[56:57] op_sel_hi:[1,0]
    v_pk_mul_f32 v[138:139], v[138:139], v[56:57] op_sel_hi:[1,0]
    v_cvt_pk_bf16_f32 v80, v176, v177
    v_cvt_pk_bf16_f32 v81, v178, v179
    v_cvt_pk_bf16_f32 v82, v180, v181
    v_cvt_pk_bf16_f32 v83, v182, v183
    v_cvt_pk_bf16_f32 v84, v184, v185
    v_cvt_pk_bf16_f32 v85, v186, v187
    v_cvt_pk_bf16_f32 v86, v188, v189
    v_cvt_pk_bf16_f32 v87, v190, v191
    v_cvt_pk_bf16_f32 v44, v136, v137
    v_cvt_pk_bf16_f32 v45, v138, v139
    ds_write_b128 v12, v[80:83] offset:4096
    ds_write_b128 v12, v[84:87] offset:5120
    v_pk_mul_f32 v[192:193], v[192:193], v[62:63] op_sel_hi:[1,0]
    v_pk_mul_f32 v[194:195], v[194:195], v[62:63] op_sel_hi:[1,0]
    v_pk_mul_f32 v[196:197], v[196:197], v[62:63] op_sel_hi:[1,0]
    v_pk_mul_f32 v[198:199], v[198:199], v[62:63] op_sel_hi:[1,0]
    v_pk_mul_f32 v[200:201], v[200:201], v[62:63] op_sel_hi:[1,0]
    v_pk_mul_f32 v[202:203], v[202:203], v[62:63] op_sel_hi:[1,0]
    v_pk_mul_f32 v[204:205], v[204:205], v[62:63] op_sel_hi:[1,0]
    v_pk_mul_f32 v[206:207], v[206:207], v[62:63] op_sel_hi:[1,0]
    v_pk_mul_f32 v[140:141], v[140:141], v[60:61] op_sel_hi:[1,0]
    v_pk_mul_f32 v[142:143], v[142:143], v[60:61] op_sel_hi:[1,0]
    v_cvt_pk_bf16_f32 v88, v192, v193
    v_cvt_pk_bf16_f32 v89, v194, v195
    v_cvt_pk_bf16_f32 v90, v196, v197
    v_cvt_pk_bf16_f32 v91, v198, v199
    v_cvt_pk_bf16_f32 v92, v200, v201
    v_cvt_pk_bf16_f32 v93, v202, v203
    v_cvt_pk_bf16_f32 v94, v204, v205
    v_cvt_pk_bf16_f32 v95, v206, v207
    v_cvt_pk_bf16_f32 v46, v140, v141
    v_cvt_pk_bf16_f32 v47, v142, v143
    ds_write_b128 v12, v[88:91] offset:6144
    ds_write_b128 v12, v[92:95] offset:7168
    s_nop 1
    ds_write_b128 v13, v[40:43] offset:32768
    ds_write_b128 v13, v[44:47] offset:33792
    s_waitcnt lgkmcnt(0)
    s_barrier
    ds_read_b128 a[0:3], v11 offset:0
    ds_read_b128 a[4:7], v11 offset:1024
    ds_read_b128 a[8:11], v11 offset:2048
    ds_read_b128 a[12:15], v11 offset:3072
    ds_read_b128 a[16:19], v11 offset:4096
    ds_read_b128 a[20:23], v11 offset:5120
    ds_read_b128 a[24:27], v11 offset:6144
    ds_read_b128 a[28:31], v11 offset:7168
    ds_read_b128 a[32:35], v11 offset:8192
    ds_read_b128 a[36:39], v11 offset:9216
    ds_read_b128 a[40:43], v11 offset:10240
    ds_read_b128 a[44:47], v11 offset:11264
    ds_read_b128 a[48:51], v11 offset:12288
    ds_read_b128 a[52:55], v11 offset:13312
    ds_read_b128 a[56:59], v11 offset:14336
    ds_read_b128 a[60:63], v11 offset:15360
    ds_read_b128 a[64:67], v11 offset:16384
    ds_read_b128 a[68:71], v11 offset:17408
    ds_read_b128 a[72:75], v11 offset:18432
    ds_read_b128 a[76:79], v11 offset:19456
    ds_read_b128 a[80:83], v11 offset:20480
    ds_read_b128 a[84:87], v11 offset:21504
    ds_read_b128 a[88:91], v11 offset:22528
    ds_read_b128 a[92:95], v11 offset:23552
    ds_read_b128 a[96:99], v11 offset:24576
    ds_read_b128 a[100:103], v11 offset:25600
    ds_read_b128 a[104:107], v11 offset:26624
    ds_read_b128 a[108:111], v11 offset:27648
    ds_read_b128 a[112:115], v11 offset:28672
    ds_read_b128 a[116:119], v11 offset:29696
    ds_read_b128 a[120:123], v11 offset:30720
    ds_read_b128 a[124:127], v11 offset:31744
    ds_read_b128 a[128:131], v11 offset:32768
    ds_read_b128 a[132:135], v11 offset:33792
    ds_read_b128 a[136:139], v11 offset:34816
    ds_read_b128 a[140:143], v11 offset:35840
    ds_read_b128 a[144:147], v11 offset:36864
    ds_read_b128 a[148:151], v11 offset:37888
    ds_read_b128 a[152:155], v11 offset:38912
    ds_read_b128 a[156:159], v11 offset:39936
    s_mul_i32 s11, s100, 7168
    s_lshl_b32 s75, s10, 5
    s_add_u32 s11, s11, s75
    v_add_u32 v8, s11, v5
    s_mul_i32 s39, s100, 458752
    v_add_u32 v6, s75, v5
    v_lshlrev_b32 v6, 4, v6
    v_add_u32 v6, s39, v6
    v_mul_u32_u24 v7, 7168, v4
    v_add_u32 v6, v6, v7
    v_lshlrev_b32 v7, 4, v8
    v_lshl_add_u32 v7, v4, 3, v7
    s_lshl_b32 s11, s100, 5
    v_add_u32 v9, s11, v3
    v_mul_u32_u24 v9, 1792, v9
    v_lshl_add_u32 v9, v4, 4, v9
    s_lshl_b32 s75, s75, 1
    s_add_u32 s75, s75, 896
    v_add_u32 v9, s75, v9
    s_mov_b32 s39, 0
    buffer_load_dwordx4 v[16:19], v6, s[20:23], s39 offen sc1
    s_mov_b32 s39, 14336
    buffer_load_dwordx4 v[20:23], v6, s[20:23], s39 offen sc1
    s_mov_b32 s39, 0
    buffer_load_dwordx2 v[80:81], v7, s[28:31], s39 offen sc1
    s_mov_b32 s39, 28672
    buffer_load_dwordx4 v[24:27], v6, s[20:23], s39 offen sc1
    s_mov_b32 s39, 43008
    buffer_load_dwordx4 v[28:31], v6, s[20:23], s39 offen sc1
    s_mov_b32 s39, 7168
    buffer_load_dwordx2 v[82:83], v7, s[28:31], s39 offen sc1
    s_mov_b32 s39, 57344
    buffer_load_dwordx4 v[32:35], v6, s[20:23], s39 offen sc1
    s_mov_b32 s39, 71680
    buffer_load_dwordx4 v[36:39], v6, s[20:23], s39 offen sc1
    s_mov_b32 s39, 14336
    buffer_load_dwordx2 v[84:85], v7, s[28:31], s39 offen sc1
    s_mov_b32 s39, 86016
    buffer_load_dwordx4 v[40:43], v6, s[20:23], s39 offen sc1
    s_mov_b32 s39, 100352
    buffer_load_dwordx4 v[44:47], v6, s[20:23], s39 offen sc1
    s_mov_b32 s39, 21504
    buffer_load_dwordx2 v[86:87], v7, s[28:31], s39 offen sc1
    s_mov_b32 s39, 114688
    buffer_load_dwordx4 v[48:51], v6, s[20:23], s39 offen sc1
    s_mov_b32 s39, 129024
    buffer_load_dwordx4 v[52:55], v6, s[20:23], s39 offen sc1
    s_mov_b32 s39, 28672
    buffer_load_dwordx2 v[88:89], v7, s[28:31], s39 offen sc1
    s_mov_b32 s39, 143360
    buffer_load_dwordx4 v[56:59], v6, s[20:23], s39 offen sc1
    s_mov_b32 s39, 157696
    buffer_load_dwordx4 v[60:63], v6, s[20:23], s39 offen sc1
    s_mov_b32 s39, 35840
    buffer_load_dwordx2 v[90:91], v7, s[28:31], s39 offen sc1
    s_mov_b32 s39, 172032
    buffer_load_dwordx4 v[64:67], v6, s[20:23], s39 offen sc1
    s_mov_b32 s39, 186368
    buffer_load_dwordx4 v[68:71], v6, s[20:23], s39 offen sc1
    s_mov_b32 s39, 43008
    buffer_load_dwordx2 v[92:93], v7, s[28:31], s39 offen sc1
    s_mov_b32 s39, 200704
    buffer_load_dwordx4 v[72:75], v6, s[20:23], s39 offen sc1
    s_mov_b32 s39, 215040
    buffer_load_dwordx4 v[76:79], v6, s[20:23], s39 offen sc1
    s_mov_b32 s39, 50176
    buffer_load_dwordx2 v[94:95], v7, s[28:31], s39 offen sc1
    s_waitcnt lgkmcnt(0)
    s_mov_b32 s39, 229376
    buffer_load_dwordx4 v[96:99], v6, s[20:23], s39 offen sc1
    s_mov_b32 s39, 243712
    buffer_load_dwordx4 v[100:103], v6, s[20:23], s39 offen sc1
    s_mov_b32 s39, 57344
    buffer_load_dwordx2 v[160:161], v7, s[28:31], s39 offen sc1
    s_mov_b32 s39, 258048
    buffer_load_dwordx4 v[104:107], v6, s[20:23], s39 offen sc1
    s_mov_b32 s39, 272384
    buffer_load_dwordx4 v[108:111], v6, s[20:23], s39 offen sc1
    s_mov_b32 s39, 64512
    buffer_load_dwordx2 v[162:163], v7, s[28:31], s39 offen sc1
    s_mov_b32 s39, 286720
    buffer_load_dwordx4 v[112:115], v6, s[20:23], s39 offen sc1
    s_mov_b32 s39, 301056
    buffer_load_dwordx4 v[116:119], v6, s[20:23], s39 offen sc1
    s_mov_b32 s39, 71680
    buffer_load_dwordx2 v[164:165], v7, s[28:31], s39 offen sc1
    s_mov_b32 s39, 315392
    buffer_load_dwordx4 v[120:123], v6, s[20:23], s39 offen sc1
    s_mov_b32 s39, 329728
    buffer_load_dwordx4 v[124:127], v6, s[20:23], s39 offen sc1
    s_mov_b32 s39, 78848
    buffer_load_dwordx2 v[166:167], v7, s[28:31], s39 offen sc1
    s_mov_b32 s39, 344064
    buffer_load_dwordx4 v[128:131], v6, s[20:23], s39 offen sc1
    s_mov_b32 s39, 358400
    buffer_load_dwordx4 v[132:135], v6, s[20:23], s39 offen sc1
    s_mov_b32 s39, 86016
    buffer_load_dwordx2 v[168:169], v7, s[28:31], s39 offen sc1
    s_mov_b32 s39, 372736
    buffer_load_dwordx4 v[136:139], v6, s[20:23], s39 offen sc1
    s_mov_b32 s39, 387072
    buffer_load_dwordx4 v[140:143], v6, s[20:23], s39 offen sc1
    s_mov_b32 s39, 93184
    buffer_load_dwordx2 v[170:171], v7, s[28:31], s39 offen sc1
    s_mov_b32 s39, 401408
    buffer_load_dwordx4 v[144:147], v6, s[20:23], s39 offen sc1
    s_mov_b32 s39, 415744
    buffer_load_dwordx4 v[148:151], v6, s[20:23], s39 offen sc1
    s_mov_b32 s39, 100352
    buffer_load_dwordx2 v[172:173], v7, s[28:31], s39 offen sc1
    s_mov_b32 s39, 430080
    buffer_load_dwordx4 v[152:155], v6, s[20:23], s39 offen sc1
    s_mov_b32 s39, 444416
    buffer_load_dwordx4 v[156:159], v6, s[20:23], s39 offen sc1
    s_mov_b32 s39, 107520
    buffer_load_dwordx2 v[174:175], v7, s[28:31], s39 offen sc1
    s_waitcnt vmcnt(24)
    v_mfma_f32_32x32x16_bf16 v[176:191], v[16:19], a[0:3], 0
    v_mfma_f32_32x32x16_bf16 v[176:191], v[20:23], a[4:7], v[176:191]
    v_mfma_f32_32x32x16_bf16 v[176:191], v[24:27], a[8:11], v[176:191]
    v_mfma_f32_32x32x16_bf16 v[176:191], v[28:31], a[12:15], v[176:191]
    v_mfma_f32_32x32x16_bf16 v[176:191], v[32:35], a[16:19], v[176:191]
    v_mfma_f32_32x32x16_bf16 v[176:191], v[36:39], a[20:23], v[176:191]
    v_mfma_f32_32x32x16_bf16 v[176:191], v[40:43], a[24:27], v[176:191]
    v_mfma_f32_32x32x16_bf16 v[176:191], v[44:47], a[28:31], v[176:191]
    v_mfma_f32_32x32x16_bf16 v[176:191], v[48:51], a[32:35], v[176:191]
    v_mfma_f32_32x32x16_bf16 v[176:191], v[52:55], a[36:39], v[176:191]
    v_mfma_f32_32x32x16_bf16 v[176:191], v[56:59], a[40:43], v[176:191]
    v_mfma_f32_32x32x16_bf16 v[176:191], v[60:63], a[44:47], v[176:191]
    v_mfma_f32_32x32x16_bf16 v[176:191], v[64:67], a[48:51], v[176:191]
    v_mfma_f32_32x32x16_bf16 v[176:191], v[68:71], a[52:55], v[176:191]
    v_mfma_f32_32x32x16_bf16 v[176:191], v[72:75], a[56:59], v[176:191]
    v_mfma_f32_32x32x16_bf16 v[176:191], v[76:79], a[60:63], v[176:191]
    v_mfma_f32_32x32x16_bf16 v[176:191], v[80:83], a[128:131], v[176:191]
    v_mfma_f32_32x32x16_bf16 v[176:191], v[84:87], a[132:135], v[176:191]
    v_mfma_f32_32x32x16_bf16 v[176:191], v[88:91], a[136:139], v[176:191]
    v_mfma_f32_32x32x16_bf16 v[176:191], v[92:95], a[140:143], v[176:191]
    s_mov_b32 s39, 2048
    buffer_load_dwordx4 v[16:19], v6, s[20:23], s39 offen sc1
    s_mov_b32 s39, 16384
    buffer_load_dwordx4 v[20:23], v6, s[20:23], s39 offen sc1
    s_mov_b32 s39, 2048
    buffer_load_dwordx2 v[80:81], v7, s[28:31], s39 offen sc1
    s_mov_b32 s39, 30720
    buffer_load_dwordx4 v[24:27], v6, s[20:23], s39 offen sc1
    s_mov_b32 s39, 45056
    buffer_load_dwordx4 v[28:31], v6, s[20:23], s39 offen sc1
    s_mov_b32 s39, 9216
    buffer_load_dwordx2 v[82:83], v7, s[28:31], s39 offen sc1
    s_mov_b32 s39, 59392
    buffer_load_dwordx4 v[32:35], v6, s[20:23], s39 offen sc1
    s_mov_b32 s39, 73728
    buffer_load_dwordx4 v[36:39], v6, s[20:23], s39 offen sc1
    s_mov_b32 s39, 16384
    buffer_load_dwordx2 v[84:85], v7, s[28:31], s39 offen sc1
    s_mov_b32 s39, 88064
    buffer_load_dwordx4 v[40:43], v6, s[20:23], s39 offen sc1
    s_mov_b32 s39, 102400
    buffer_load_dwordx4 v[44:47], v6, s[20:23], s39 offen sc1
    s_mov_b32 s39, 23552
    buffer_load_dwordx2 v[86:87], v7, s[28:31], s39 offen sc1
    s_mov_b32 s39, 116736
    buffer_load_dwordx4 v[48:51], v6, s[20:23], s39 offen sc1
    s_mov_b32 s39, 131072
    buffer_load_dwordx4 v[52:55], v6, s[20:23], s39 offen sc1
    s_mov_b32 s39, 30720
    buffer_load_dwordx2 v[88:89], v7, s[28:31], s39 offen sc1
    s_mov_b32 s39, 145408
    buffer_load_dwordx4 v[56:59], v6, s[20:23], s39 offen sc1
    s_mov_b32 s39, 159744
    buffer_load_dwordx4 v[60:63], v6, s[20:23], s39 offen sc1
    s_mov_b32 s39, 37888
    buffer_load_dwordx2 v[90:91], v7, s[28:31], s39 offen sc1
    s_mov_b32 s39, 174080
    buffer_load_dwordx4 v[64:67], v6, s[20:23], s39 offen sc1
    s_mov_b32 s39, 188416
    buffer_load_dwordx4 v[68:71], v6, s[20:23], s39 offen sc1
    s_mov_b32 s39, 45056
    buffer_load_dwordx2 v[92:93], v7, s[28:31], s39 offen sc1
    s_mov_b32 s39, 202752
    buffer_load_dwordx4 v[72:75], v6, s[20:23], s39 offen sc1
    s_mov_b32 s39, 217088
    buffer_load_dwordx4 v[76:79], v6, s[20:23], s39 offen sc1
    s_mov_b32 s39, 52224
    buffer_load_dwordx2 v[94:95], v7, s[28:31], s39 offen sc1
    s_waitcnt vmcnt(24)
    v_mfma_f32_32x32x16_bf16 v[176:191], v[96:99], a[64:67], v[176:191]
    v_mfma_f32_32x32x16_bf16 v[176:191], v[100:103], a[68:71], v[176:191]
    v_mfma_f32_32x32x16_bf16 v[176:191], v[104:107], a[72:75], v[176:191]
    v_mfma_f32_32x32x16_bf16 v[176:191], v[108:111], a[76:79], v[176:191]
    v_mfma_f32_32x32x16_bf16 v[176:191], v[112:115], a[80:83], v[176:191]
    v_mfma_f32_32x32x16_bf16 v[176:191], v[116:119], a[84:87], v[176:191]
    v_mfma_f32_32x32x16_bf16 v[176:191], v[120:123], a[88:91], v[176:191]
    v_mfma_f32_32x32x16_bf16 v[176:191], v[124:127], a[92:95], v[176:191]
    v_mfma_f32_32x32x16_bf16 v[176:191], v[128:131], a[96:99], v[176:191]
    v_mfma_f32_32x32x16_bf16 v[176:191], v[132:135], a[100:103], v[176:191]
    v_mfma_f32_32x32x16_bf16 v[176:191], v[136:139], a[104:107], v[176:191]
    v_mfma_f32_32x32x16_bf16 v[176:191], v[140:143], a[108:111], v[176:191]
    v_mfma_f32_32x32x16_bf16 v[176:191], v[144:147], a[112:115], v[176:191]
    v_mfma_f32_32x32x16_bf16 v[176:191], v[148:151], a[116:119], v[176:191]
    v_mfma_f32_32x32x16_bf16 v[176:191], v[152:155], a[120:123], v[176:191]
    v_mfma_f32_32x32x16_bf16 v[176:191], v[156:159], a[124:127], v[176:191]
    v_mfma_f32_32x32x16_bf16 v[176:191], v[160:163], a[144:147], v[176:191]
    v_mfma_f32_32x32x16_bf16 v[176:191], v[164:167], a[148:151], v[176:191]
    v_mfma_f32_32x32x16_bf16 v[176:191], v[168:171], a[152:155], v[176:191]
    v_mfma_f32_32x32x16_bf16 v[176:191], v[172:175], a[156:159], v[176:191]
    s_nop 15
    v_cvt_pk_bf16_f32 v192, v176, v177
    v_cvt_pk_bf16_f32 v193, v178, v179
    v_cvt_pk_bf16_f32 v194, v180, v181
    v_cvt_pk_bf16_f32 v195, v182, v183
    v_cvt_pk_bf16_f32 v196, v184, v185
    v_cvt_pk_bf16_f32 v197, v186, v187
    v_cvt_pk_bf16_f32 v198, v188, v189
    v_cvt_pk_bf16_f32 v199, v190, v191
    buffer_store_dwordx4 v[192:195], v9, s[32:35], 0 offen offset:0
    buffer_store_dwordx4 v[196:199], v9, s[32:35], 0 offen offset:32
    s_nop 1
    s_mov_b32 s39, 231424
    buffer_load_dwordx4 v[96:99], v6, s[20:23], s39 offen sc1
    s_mov_b32 s39, 245760
    buffer_load_dwordx4 v[100:103], v6, s[20:23], s39 offen sc1
    s_mov_b32 s39, 59392
    buffer_load_dwordx2 v[160:161], v7, s[28:31], s39 offen sc1
    s_mov_b32 s39, 260096
    buffer_load_dwordx4 v[104:107], v6, s[20:23], s39 offen sc1
    s_mov_b32 s39, 274432
    buffer_load_dwordx4 v[108:111], v6, s[20:23], s39 offen sc1
    s_mov_b32 s39, 66560
    buffer_load_dwordx2 v[162:163], v7, s[28:31], s39 offen sc1
    s_mov_b32 s39, 288768
    buffer_load_dwordx4 v[112:115], v6, s[20:23], s39 offen sc1
    s_mov_b32 s39, 303104
    buffer_load_dwordx4 v[116:119], v6, s[20:23], s39 offen sc1
    s_mov_b32 s39, 73728
    buffer_load_dwordx2 v[164:165], v7, s[28:31], s39 offen sc1
    s_mov_b32 s39, 317440
    buffer_load_dwordx4 v[120:123], v6, s[20:23], s39 offen sc1
    s_mov_b32 s39, 331776
    buffer_load_dwordx4 v[124:127], v6, s[20:23], s39 offen sc1
    s_mov_b32 s39, 80896
    buffer_load_dwordx2 v[166:167], v7, s[28:31], s39 offen sc1
    s_mov_b32 s39, 346112
    buffer_load_dwordx4 v[128:131], v6, s[20:23], s39 offen sc1
    s_mov_b32 s39, 360448
    buffer_load_dwordx4 v[132:135], v6, s[20:23], s39 offen sc1
    s_mov_b32 s39, 88064
    buffer_load_dwordx2 v[168:169], v7, s[28:31], s39 offen sc1
    s_mov_b32 s39, 374784
    buffer_load_dwordx4 v[136:139], v6, s[20:23], s39 offen sc1
    s_mov_b32 s39, 389120
    buffer_load_dwordx4 v[140:143], v6, s[20:23], s39 offen sc1
    s_mov_b32 s39, 95232
    buffer_load_dwordx2 v[170:171], v7, s[28:31], s39 offen sc1
    s_mov_b32 s39, 403456
    buffer_load_dwordx4 v[144:147], v6, s[20:23], s39 offen sc1
    s_mov_b32 s39, 417792
    buffer_load_dwordx4 v[148:151], v6, s[20:23], s39 offen sc1
    s_mov_b32 s39, 102400
    buffer_load_dwordx2 v[172:173], v7, s[28:31], s39 offen sc1
    s_mov_b32 s39, 432128
    buffer_load_dwordx4 v[152:155], v6, s[20:23], s39 offen sc1
    s_mov_b32 s39, 446464
    buffer_load_dwordx4 v[156:159], v6, s[20:23], s39 offen sc1
    s_mov_b32 s39, 109568
    buffer_load_dwordx2 v[174:175], v7, s[28:31], s39 offen sc1
    s_waitcnt vmcnt(24)
    v_mfma_f32_32x32x16_bf16 v[176:191], v[16:19], a[0:3], 0
    v_mfma_f32_32x32x16_bf16 v[176:191], v[20:23], a[4:7], v[176:191]
    v_mfma_f32_32x32x16_bf16 v[176:191], v[24:27], a[8:11], v[176:191]
    v_mfma_f32_32x32x16_bf16 v[176:191], v[28:31], a[12:15], v[176:191]
    v_mfma_f32_32x32x16_bf16 v[176:191], v[32:35], a[16:19], v[176:191]
    v_mfma_f32_32x32x16_bf16 v[176:191], v[36:39], a[20:23], v[176:191]
    v_mfma_f32_32x32x16_bf16 v[176:191], v[40:43], a[24:27], v[176:191]
    v_mfma_f32_32x32x16_bf16 v[176:191], v[44:47], a[28:31], v[176:191]
    v_mfma_f32_32x32x16_bf16 v[176:191], v[48:51], a[32:35], v[176:191]
    v_mfma_f32_32x32x16_bf16 v[176:191], v[52:55], a[36:39], v[176:191]
    v_mfma_f32_32x32x16_bf16 v[176:191], v[56:59], a[40:43], v[176:191]
    v_mfma_f32_32x32x16_bf16 v[176:191], v[60:63], a[44:47], v[176:191]
    v_mfma_f32_32x32x16_bf16 v[176:191], v[64:67], a[48:51], v[176:191]
    v_mfma_f32_32x32x16_bf16 v[176:191], v[68:71], a[52:55], v[176:191]
    v_mfma_f32_32x32x16_bf16 v[176:191], v[72:75], a[56:59], v[176:191]
    v_mfma_f32_32x32x16_bf16 v[176:191], v[76:79], a[60:63], v[176:191]
    v_mfma_f32_32x32x16_bf16 v[176:191], v[80:83], a[128:131], v[176:191]
    v_mfma_f32_32x32x16_bf16 v[176:191], v[84:87], a[132:135], v[176:191]
    v_mfma_f32_32x32x16_bf16 v[176:191], v[88:91], a[136:139], v[176:191]
    v_mfma_f32_32x32x16_bf16 v[176:191], v[92:95], a[140:143], v[176:191]
    s_mov_b32 s39, 4096
    buffer_load_dwordx4 v[16:19], v6, s[20:23], s39 offen sc1
    s_mov_b32 s39, 18432
    buffer_load_dwordx4 v[20:23], v6, s[20:23], s39 offen sc1
    s_mov_b32 s39, 4096
    buffer_load_dwordx2 v[80:81], v7, s[28:31], s39 offen sc1
    s_mov_b32 s39, 32768
    buffer_load_dwordx4 v[24:27], v6, s[20:23], s39 offen sc1
    s_mov_b32 s39, 47104
    buffer_load_dwordx4 v[28:31], v6, s[20:23], s39 offen sc1
    s_mov_b32 s39, 11264
    buffer_load_dwordx2 v[82:83], v7, s[28:31], s39 offen sc1
    s_mov_b32 s39, 61440
    buffer_load_dwordx4 v[32:35], v6, s[20:23], s39 offen sc1
    s_mov_b32 s39, 75776
    buffer_load_dwordx4 v[36:39], v6, s[20:23], s39 offen sc1
    s_mov_b32 s39, 18432
    buffer_load_dwordx2 v[84:85], v7, s[28:31], s39 offen sc1
    s_mov_b32 s39, 90112
    buffer_load_dwordx4 v[40:43], v6, s[20:23], s39 offen sc1
    s_mov_b32 s39, 104448
    buffer_load_dwordx4 v[44:47], v6, s[20:23], s39 offen sc1
    s_mov_b32 s39, 25600
    buffer_load_dwordx2 v[86:87], v7, s[28:31], s39 offen sc1
    s_mov_b32 s39, 118784
    buffer_load_dwordx4 v[48:51], v6, s[20:23], s39 offen sc1
    s_mov_b32 s39, 133120
    buffer_load_dwordx4 v[52:55], v6, s[20:23], s39 offen sc1
    s_mov_b32 s39, 32768
    buffer_load_dwordx2 v[88:89], v7, s[28:31], s39 offen sc1
    s_mov_b32 s39, 147456
    buffer_load_dwordx4 v[56:59], v6, s[20:23], s39 offen sc1
    s_mov_b32 s39, 161792
    buffer_load_dwordx4 v[60:63], v6, s[20:23], s39 offen sc1
    s_mov_b32 s39, 39936
    buffer_load_dwordx2 v[90:91], v7, s[28:31], s39 offen sc1
    s_mov_b32 s39, 176128
    buffer_load_dwordx4 v[64:67], v6, s[20:23], s39 offen sc1
    s_mov_b32 s39, 190464
    buffer_load_dwordx4 v[68:71], v6, s[20:23], s39 offen sc1
    s_mov_b32 s39, 47104
    buffer_load_dwordx2 v[92:93], v7, s[28:31], s39 offen sc1
    s_mov_b32 s39, 204800
    buffer_load_dwordx4 v[72:75], v6, s[20:23], s39 offen sc1
    s_mov_b32 s39, 219136
    buffer_load_dwordx4 v[76:79], v6, s[20:23], s39 offen sc1
    s_mov_b32 s39, 54272
    buffer_load_dwordx2 v[94:95], v7, s[28:31], s39 offen sc1
    s_waitcnt vmcnt(24)
    v_mfma_f32_32x32x16_bf16 v[176:191], v[96:99], a[64:67], v[176:191]
    v_mfma_f32_32x32x16_bf16 v[176:191], v[100:103], a[68:71], v[176:191]
    v_mfma_f32_32x32x16_bf16 v[176:191], v[104:107], a[72:75], v[176:191]
    v_mfma_f32_32x32x16_bf16 v[176:191], v[108:111], a[76:79], v[176:191]
    v_mfma_f32_32x32x16_bf16 v[176:191], v[112:115], a[80:83], v[176:191]
    v_mfma_f32_32x32x16_bf16 v[176:191], v[116:119], a[84:87], v[176:191]
    v_mfma_f32_32x32x16_bf16 v[176:191], v[120:123], a[88:91], v[176:191]
    v_mfma_f32_32x32x16_bf16 v[176:191], v[124:127], a[92:95], v[176:191]
    v_mfma_f32_32x32x16_bf16 v[176:191], v[128:131], a[96:99], v[176:191]
    v_mfma_f32_32x32x16_bf16 v[176:191], v[132:135], a[100:103], v[176:191]
    v_mfma_f32_32x32x16_bf16 v[176:191], v[136:139], a[104:107], v[176:191]
    v_mfma_f32_32x32x16_bf16 v[176:191], v[140:143], a[108:111], v[176:191]
    v_mfma_f32_32x32x16_bf16 v[176:191], v[144:147], a[112:115], v[176:191]
    v_mfma_f32_32x32x16_bf16 v[176:191], v[148:151], a[116:119], v[176:191]
    v_mfma_f32_32x32x16_bf16 v[176:191], v[152:155], a[120:123], v[176:191]
    v_mfma_f32_32x32x16_bf16 v[176:191], v[156:159], a[124:127], v[176:191]
    v_mfma_f32_32x32x16_bf16 v[176:191], v[160:163], a[144:147], v[176:191]
    v_mfma_f32_32x32x16_bf16 v[176:191], v[164:167], a[148:151], v[176:191]
    v_mfma_f32_32x32x16_bf16 v[176:191], v[168:171], a[152:155], v[176:191]
    v_mfma_f32_32x32x16_bf16 v[176:191], v[172:175], a[156:159], v[176:191]
    s_nop 15
    v_cvt_pk_bf16_f32 v192, v176, v177
    v_cvt_pk_bf16_f32 v193, v178, v179
    v_cvt_pk_bf16_f32 v194, v180, v181
    v_cvt_pk_bf16_f32 v195, v182, v183
    v_cvt_pk_bf16_f32 v196, v184, v185
    v_cvt_pk_bf16_f32 v197, v186, v187
    v_cvt_pk_bf16_f32 v198, v188, v189
    v_cvt_pk_bf16_f32 v199, v190, v191
    buffer_store_dwordx4 v[192:195], v9, s[32:35], 0 offen offset:256
    buffer_store_dwordx4 v[196:199], v9, s[32:35], 0 offen offset:288
    s_nop 1
    s_mov_b32 s39, 233472
    buffer_load_dwordx4 v[96:99], v6, s[20:23], s39 offen sc1
    s_mov_b32 s39, 247808
    buffer_load_dwordx4 v[100:103], v6, s[20:23], s39 offen sc1
    s_mov_b32 s39, 61440
    buffer_load_dwordx2 v[160:161], v7, s[28:31], s39 offen sc1
    s_mov_b32 s39, 262144
    buffer_load_dwordx4 v[104:107], v6, s[20:23], s39 offen sc1
    s_mov_b32 s39, 276480
    buffer_load_dwordx4 v[108:111], v6, s[20:23], s39 offen sc1
    s_mov_b32 s39, 68608
    buffer_load_dwordx2 v[162:163], v7, s[28:31], s39 offen sc1
    s_mov_b32 s39, 290816
    buffer_load_dwordx4 v[112:115], v6, s[20:23], s39 offen sc1
    s_mov_b32 s39, 305152
    buffer_load_dwordx4 v[116:119], v6, s[20:23], s39 offen sc1
    s_mov_b32 s39, 75776
    buffer_load_dwordx2 v[164:165], v7, s[28:31], s39 offen sc1
    s_mov_b32 s39, 319488
    buffer_load_dwordx4 v[120:123], v6, s[20:23], s39 offen sc1
    s_mov_b32 s39, 333824
    buffer_load_dwordx4 v[124:127], v6, s[20:23], s39 offen sc1
    s_mov_b32 s39, 82944
    buffer_load_dwordx2 v[166:167], v7, s[28:31], s39 offen sc1
    s_mov_b32 s39, 348160
    buffer_load_dwordx4 v[128:131], v6, s[20:23], s39 offen sc1
    s_mov_b32 s39, 362496
    buffer_load_dwordx4 v[132:135], v6, s[20:23], s39 offen sc1
    s_mov_b32 s39, 90112
    buffer_load_dwordx2 v[168:169], v7, s[28:31], s39 offen sc1
    s_mov_b32 s39, 376832
    buffer_load_dwordx4 v[136:139], v6, s[20:23], s39 offen sc1
    s_mov_b32 s39, 391168
    buffer_load_dwordx4 v[140:143], v6, s[20:23], s39 offen sc1
    s_mov_b32 s39, 97280
    buffer_load_dwordx2 v[170:171], v7, s[28:31], s39 offen sc1
    s_mov_b32 s39, 405504
    buffer_load_dwordx4 v[144:147], v6, s[20:23], s39 offen sc1
    s_mov_b32 s39, 419840
    buffer_load_dwordx4 v[148:151], v6, s[20:23], s39 offen sc1
    s_mov_b32 s39, 104448
    buffer_load_dwordx2 v[172:173], v7, s[28:31], s39 offen sc1
    s_mov_b32 s39, 434176
    buffer_load_dwordx4 v[152:155], v6, s[20:23], s39 offen sc1
    s_mov_b32 s39, 448512
    buffer_load_dwordx4 v[156:159], v6, s[20:23], s39 offen sc1
    s_mov_b32 s39, 111616
    buffer_load_dwordx2 v[174:175], v7, s[28:31], s39 offen sc1
    s_waitcnt vmcnt(24)
    v_mfma_f32_32x32x16_bf16 v[176:191], v[16:19], a[0:3], 0
    v_mfma_f32_32x32x16_bf16 v[176:191], v[20:23], a[4:7], v[176:191]
    v_mfma_f32_32x32x16_bf16 v[176:191], v[24:27], a[8:11], v[176:191]
    v_mfma_f32_32x32x16_bf16 v[176:191], v[28:31], a[12:15], v[176:191]
    v_mfma_f32_32x32x16_bf16 v[176:191], v[32:35], a[16:19], v[176:191]
    v_mfma_f32_32x32x16_bf16 v[176:191], v[36:39], a[20:23], v[176:191]
    v_mfma_f32_32x32x16_bf16 v[176:191], v[40:43], a[24:27], v[176:191]
    v_mfma_f32_32x32x16_bf16 v[176:191], v[44:47], a[28:31], v[176:191]
    v_mfma_f32_32x32x16_bf16 v[176:191], v[48:51], a[32:35], v[176:191]
    v_mfma_f32_32x32x16_bf16 v[176:191], v[52:55], a[36:39], v[176:191]
    v_mfma_f32_32x32x16_bf16 v[176:191], v[56:59], a[40:43], v[176:191]
    v_mfma_f32_32x32x16_bf16 v[176:191], v[60:63], a[44:47], v[176:191]
    v_mfma_f32_32x32x16_bf16 v[176:191], v[64:67], a[48:51], v[176:191]
    v_mfma_f32_32x32x16_bf16 v[176:191], v[68:71], a[52:55], v[176:191]
    v_mfma_f32_32x32x16_bf16 v[176:191], v[72:75], a[56:59], v[176:191]
    v_mfma_f32_32x32x16_bf16 v[176:191], v[76:79], a[60:63], v[176:191]
    v_mfma_f32_32x32x16_bf16 v[176:191], v[80:83], a[128:131], v[176:191]
    v_mfma_f32_32x32x16_bf16 v[176:191], v[84:87], a[132:135], v[176:191]
    v_mfma_f32_32x32x16_bf16 v[176:191], v[88:91], a[136:139], v[176:191]
    v_mfma_f32_32x32x16_bf16 v[176:191], v[92:95], a[140:143], v[176:191]
    s_mov_b32 s39, 6144
    buffer_load_dwordx4 v[16:19], v6, s[20:23], s39 offen sc1
    s_mov_b32 s39, 20480
    buffer_load_dwordx4 v[20:23], v6, s[20:23], s39 offen sc1
    s_mov_b32 s39, 6144
    buffer_load_dwordx2 v[80:81], v7, s[28:31], s39 offen sc1
    s_mov_b32 s39, 34816
    buffer_load_dwordx4 v[24:27], v6, s[20:23], s39 offen sc1
    s_mov_b32 s39, 49152
    buffer_load_dwordx4 v[28:31], v6, s[20:23], s39 offen sc1
    s_mov_b32 s39, 13312
    buffer_load_dwordx2 v[82:83], v7, s[28:31], s39 offen sc1
    s_mov_b32 s39, 63488
    buffer_load_dwordx4 v[32:35], v6, s[20:23], s39 offen sc1
    s_mov_b32 s39, 77824
    buffer_load_dwordx4 v[36:39], v6, s[20:23], s39 offen sc1
    s_mov_b32 s39, 20480
    buffer_load_dwordx2 v[84:85], v7, s[28:31], s39 offen sc1
    s_mov_b32 s39, 92160
    buffer_load_dwordx4 v[40:43], v6, s[20:23], s39 offen sc1
    s_mov_b32 s39, 106496
    buffer_load_dwordx4 v[44:47], v6, s[20:23], s39 offen sc1
    s_mov_b32 s39, 27648
    buffer_load_dwordx2 v[86:87], v7, s[28:31], s39 offen sc1
    s_mov_b32 s39, 120832
    buffer_load_dwordx4 v[48:51], v6, s[20:23], s39 offen sc1
    s_mov_b32 s39, 135168
    buffer_load_dwordx4 v[52:55], v6, s[20:23], s39 offen sc1
    s_mov_b32 s39, 34816
    buffer_load_dwordx2 v[88:89], v7, s[28:31], s39 offen sc1
    s_mov_b32 s39, 149504
    buffer_load_dwordx4 v[56:59], v6, s[20:23], s39 offen sc1
    s_mov_b32 s39, 163840
    buffer_load_dwordx4 v[60:63], v6, s[20:23], s39 offen sc1
    s_mov_b32 s39, 41984
    buffer_load_dwordx2 v[90:91], v7, s[28:31], s39 offen sc1
    s_mov_b32 s39, 178176
    buffer_load_dwordx4 v[64:67], v6, s[20:23], s39 offen sc1
    s_mov_b32 s39, 192512
    buffer_load_dwordx4 v[68:71], v6, s[20:23], s39 offen sc1
    s_mov_b32 s39, 49152
    buffer_load_dwordx2 v[92:93], v7, s[28:31], s39 offen sc1
    s_mov_b32 s39, 206848
    buffer_load_dwordx4 v[72:75], v6, s[20:23], s39 offen sc1
    s_mov_b32 s39, 221184
    buffer_load_dwordx4 v[76:79], v6, s[20:23], s39 offen sc1
    s_mov_b32 s39, 56320
    buffer_load_dwordx2 v[94:95], v7, s[28:31], s39 offen sc1
    s_waitcnt vmcnt(24)
    v_mfma_f32_32x32x16_bf16 v[176:191], v[96:99], a[64:67], v[176:191]
    v_mfma_f32_32x32x16_bf16 v[176:191], v[100:103], a[68:71], v[176:191]
    v_mfma_f32_32x32x16_bf16 v[176:191], v[104:107], a[72:75], v[176:191]
    v_mfma_f32_32x32x16_bf16 v[176:191], v[108:111], a[76:79], v[176:191]
    v_mfma_f32_32x32x16_bf16 v[176:191], v[112:115], a[80:83], v[176:191]
    v_mfma_f32_32x32x16_bf16 v[176:191], v[116:119], a[84:87], v[176:191]
    v_mfma_f32_32x32x16_bf16 v[176:191], v[120:123], a[88:91], v[176:191]
    v_mfma_f32_32x32x16_bf16 v[176:191], v[124:127], a[92:95], v[176:191]
    v_mfma_f32_32x32x16_bf16 v[176:191], v[128:131], a[96:99], v[176:191]
    v_mfma_f32_32x32x16_bf16 v[176:191], v[132:135], a[100:103], v[176:191]
    v_mfma_f32_32x32x16_bf16 v[176:191], v[136:139], a[104:107], v[176:191]
    v_mfma_f32_32x32x16_bf16 v[176:191], v[140:143], a[108:111], v[176:191]
    v_mfma_f32_32x32x16_bf16 v[176:191], v[144:147], a[112:115], v[176:191]
    v_mfma_f32_32x32x16_bf16 v[176:191], v[148:151], a[116:119], v[176:191]
    v_mfma_f32_32x32x16_bf16 v[176:191], v[152:155], a[120:123], v[176:191]
    v_mfma_f32_32x32x16_bf16 v[176:191], v[156:159], a[124:127], v[176:191]
    v_mfma_f32_32x32x16_bf16 v[176:191], v[160:163], a[144:147], v[176:191]
    v_mfma_f32_32x32x16_bf16 v[176:191], v[164:167], a[148:151], v[176:191]
    v_mfma_f32_32x32x16_bf16 v[176:191], v[168:171], a[152:155], v[176:191]
    v_mfma_f32_32x32x16_bf16 v[176:191], v[172:175], a[156:159], v[176:191]
    s_nop 15
    v_cvt_pk_bf16_f32 v192, v176, v177
    v_cvt_pk_bf16_f32 v193, v178, v179
    v_cvt_pk_bf16_f32 v194, v180, v181
    v_cvt_pk_bf16_f32 v195, v182, v183
    v_cvt_pk_bf16_f32 v196, v184, v185
    v_cvt_pk_bf16_f32 v197, v186, v187
    v_cvt_pk_bf16_f32 v198, v188, v189
    v_cvt_pk_bf16_f32 v199, v190, v191
    buffer_store_dwordx4 v[192:195], v9, s[32:35], 0 offen offset:512
    buffer_store_dwordx4 v[196:199], v9, s[32:35], 0 offen offset:544
    s_nop 1
    s_cmp_ge_u32 s10, 2
    s_cbranch_scc1 wk_loop
    s_mov_b32 s39, 235520
    buffer_load_dwordx4 v[96:99], v6, s[20:23], s39 offen sc1
    s_mov_b32 s39, 249856
    buffer_load_dwordx4 v[100:103], v6, s[20:23], s39 offen sc1
    s_mov_b32 s39, 63488
    buffer_load_dwordx2 v[160:161], v7, s[28:31], s39 offen sc1
    s_mov_b32 s39, 264192
    buffer_load_dwordx4 v[104:107], v6, s[20:23], s39 offen sc1
    s_mov_b32 s39, 278528
    buffer_load_dwordx4 v[108:111], v6, s[20:23], s39 offen sc1
    s_mov_b32 s39, 70656
    buffer_load_dwordx2 v[162:163], v7, s[28:31], s39 offen sc1
    s_mov_b32 s39, 292864
    buffer_load_dwordx4 v[112:115], v6, s[20:23], s39 offen sc1
    s_mov_b32 s39, 307200
    buffer_load_dwordx4 v[116:119], v6, s[20:23], s39 offen sc1
    s_mov_b32 s39, 77824
    buffer_load_dwordx2 v[164:165], v7, s[28:31], s39 offen sc1
    s_mov_b32 s39, 321536
    buffer_load_dwordx4 v[120:123], v6, s[20:23], s39 offen sc1
    s_mov_b32 s39, 335872
    buffer_load_dwordx4 v[124:127], v6, s[20:23], s39 offen sc1
    s_mov_b32 s39, 84992
    buffer_load_dwordx2 v[166:167], v7, s[28:31], s39 offen sc1
    s_mov_b32 s39, 350208
    buffer_load_dwordx4 v[128:131], v6, s[20:23], s39 offen sc1
    s_mov_b32 s39, 364544
    buffer_load_dwordx4 v[132:135], v6, s[20:23], s39 offen sc1
    s_mov_b32 s39, 92160
    buffer_load_dwordx2 v[168:169], v7, s[28:31], s39 offen sc1
    s_mov_b32 s39, 378880
    buffer_load_dwordx4 v[136:139], v6, s[20:23], s39 offen sc1
    s_mov_b32 s39, 393216
    buffer_load_dwordx4 v[140:143], v6, s[20:23], s39 offen sc1
    s_mov_b32 s39, 99328
    buffer_load_dwordx2 v[170:171], v7, s[28:31], s39 offen sc1
    s_mov_b32 s39, 407552
    buffer_load_dwordx4 v[144:147], v6, s[20:23], s39 offen sc1
    s_mov_b32 s39, 421888
    buffer_load_dwordx4 v[148:151], v6, s[20:23], s39 offen sc1
    s_mov_b32 s39, 106496
    buffer_load_dwordx2 v[172:173], v7, s[28:31], s39 offen sc1
    s_mov_b32 s39, 436224
    buffer_load_dwordx4 v[152:155], v6, s[20:23], s39 offen sc1
    s_mov_b32 s39, 450560
    buffer_load_dwordx4 v[156:159], v6, s[20:23], s39 offen sc1
    s_mov_b32 s39, 113664
    buffer_load_dwordx2 v[174:175], v7, s[28:31], s39 offen sc1
    s_waitcnt vmcnt(24)
    v_mfma_f32_32x32x16_bf16 v[176:191], v[16:19], a[0:3], 0
    v_mfma_f32_32x32x16_bf16 v[176:191], v[20:23], a[4:7], v[176:191]
    v_mfma_f32_32x32x16_bf16 v[176:191], v[24:27], a[8:11], v[176:191]
    v_mfma_f32_32x32x16_bf16 v[176:191], v[28:31], a[12:15], v[176:191]
    v_mfma_f32_32x32x16_bf16 v[176:191], v[32:35], a[16:19], v[176:191]
    v_mfma_f32_32x32x16_bf16 v[176:191], v[36:39], a[20:23], v[176:191]
    v_mfma_f32_32x32x16_bf16 v[176:191], v[40:43], a[24:27], v[176:191]
    v_mfma_f32_32x32x16_bf16 v[176:191], v[44:47], a[28:31], v[176:191]
    v_mfma_f32_32x32x16_bf16 v[176:191], v[48:51], a[32:35], v[176:191]
    v_mfma_f32_32x32x16_bf16 v[176:191], v[52:55], a[36:39], v[176:191]
    v_mfma_f32_32x32x16_bf16 v[176:191], v[56:59], a[40:43], v[176:191]
    v_mfma_f32_32x32x16_bf16 v[176:191], v[60:63], a[44:47], v[176:191]
    v_mfma_f32_32x32x16_bf16 v[176:191], v[64:67], a[48:51], v[176:191]
    v_mfma_f32_32x32x16_bf16 v[176:191], v[68:71], a[52:55], v[176:191]
    v_mfma_f32_32x32x16_bf16 v[176:191], v[72:75], a[56:59], v[176:191]
    v_mfma_f32_32x32x16_bf16 v[176:191], v[76:79], a[60:63], v[176:191]
    v_mfma_f32_32x32x16_bf16 v[176:191], v[80:83], a[128:131], v[176:191]
    v_mfma_f32_32x32x16_bf16 v[176:191], v[84:87], a[132:135], v[176:191]
    v_mfma_f32_32x32x16_bf16 v[176:191], v[88:91], a[136:139], v[176:191]
    v_mfma_f32_32x32x16_bf16 v[176:191], v[92:95], a[140:143], v[176:191]
    s_waitcnt vmcnt(0)
    v_mfma_f32_32x32x16_bf16 v[176:191], v[96:99], a[64:67], v[176:191]
    v_mfma_f32_32x32x16_bf16 v[176:191], v[100:103], a[68:71], v[176:191]
    v_mfma_f32_32x32x16_bf16 v[176:191], v[104:107], a[72:75], v[176:191]
    v_mfma_f32_32x32x16_bf16 v[176:191], v[108:111], a[76:79], v[176:191]
    v_mfma_f32_32x32x16_bf16 v[176:191], v[112:115], a[80:83], v[176:191]
    v_mfma_f32_32x32x16_bf16 v[176:191], v[116:119], a[84:87], v[176:191]
    v_mfma_f32_32x32x16_bf16 v[176:191], v[120:123], a[88:91], v[176:191]
    v_mfma_f32_32x32x16_bf16 v[176:191], v[124:127], a[92:95], v[176:191]
    v_mfma_f32_32x32x16_bf16 v[176:191], v[128:131], a[96:99], v[176:191]
    v_mfma_f32_32x32x16_bf16 v[176:191], v[132:135], a[100:103], v[176:191]
    v_mfma_f32_32x32x16_bf16 v[176:191], v[136:139], a[104:107], v[176:191]
    v_mfma_f32_32x32x16_bf16 v[176:191], v[140:143], a[108:111], v[176:191]
    v_mfma_f32_32x32x16_bf16 v[176:191], v[144:147], a[112:115], v[176:191]
    v_mfma_f32_32x32x16_bf16 v[176:191], v[148:151], a[116:119], v[176:191]
    v_mfma_f32_32x32x16_bf16 v[176:191], v[152:155], a[120:123], v[176:191]
    v_mfma_f32_32x32x16_bf16 v[176:191], v[156:159], a[124:127], v[176:191]
    v_mfma_f32_32x32x16_bf16 v[176:191], v[160:163], a[144:147], v[176:191]
    v_mfma_f32_32x32x16_bf16 v[176:191], v[164:167], a[148:151], v[176:191]
    v_mfma_f32_32x32x16_bf16 v[176:191], v[168:171], a[152:155], v[176:191]
    v_mfma_f32_32x32x16_bf16 v[176:191], v[172:175], a[156:159], v[176:191]
    s_nop 15
    v_cvt_pk_bf16_f32 v192, v176, v177
    v_cvt_pk_bf16_f32 v193, v178, v179
    v_cvt_pk_bf16_f32 v194, v180, v181
    v_cvt_pk_bf16_f32 v195, v182, v183
    v_cvt_pk_bf16_f32 v196, v184, v185
    v_cvt_pk_bf16_f32 v197, v186, v187
    v_cvt_pk_bf16_f32 v198, v188, v189
    v_cvt_pk_bf16_f32 v199, v190, v191
    buffer_store_dwordx4 v[192:195], v9, s[32:35], 0 offen offset:768
    buffer_store_dwordx4 v[196:199], v9, s[32:35], 0 offen offset:800
    s_nop 1
    s_branch wk_loop
tk_bf4:
    s_and_b32 s73, s100, 3
    s_lshr_b32 s100, s100, 2
    s_add_u32 s100, s100, 57
    s_load_dwordx2 s[4:5], s[0:1], 104
    s_load_dwordx2 s[6:7], s[0:1], 32
    s_load_dwordx2 s[8:9], s[0:1], 88
    v_lshrrev_b32 v1, 6, v0
    v_and_b32 v2, 63, v0
    s_nop 0
    v_readfirstlane_b32 s10, v1
    v_and_b32 v3, 31, v2
    v_lshrrev_b32 v4, 5, v2
    v_and_b32 v5, 0x13, v3
    v_and_b32 v6, 4, v3
    v_lshl_or_b32 v5, v6, 1, v5
    v_and_b32 v6, 8, v3
    v_lshrrev_b32 v6, 1, v6
    v_or_b32 v5, v6, v5
    s_waitcnt lgkmcnt(0)
    s_add_u32 s12, s4, 0x5c80000
    s_addc_u32 s13, s5, 0x0
    s_mov_b32 s14, 0x1c0000
    s_mov_b32 s15, 0x00020000
    s_add_u32 s16, s4, 0xc40000
    s_addc_u32 s17, s5, 0x0
    s_mov_b32 s18, 0x1c00000
    s_mov_b32 s19, 0x00020000
    s_add_u32 s20, s4, 0x2840000
    s_addc_u32 s21, s5, 0x0
    s_mov_b32 s22, 0x1c00000
    s_mov_b32 s23, 0x00020000
    s_add_u32 s24, s4, 0x4440000
    s_addc_u32 s25, s5, 0x0
    s_mov_b32 s26, 0x700000
    s_mov_b32 s27, 0x00020000
    s_add_u32 s28, s4, 0x4b40000
    s_addc_u32 s29, s5, 0x0
    s_mov_b32 s30, 0x700000
    s_mov_b32 s31, 0x00020000
    s_mov_b32 s32, s8
    s_mov_b32 s33, s9
    s_mov_b32 s34, 0x380000
    s_mov_b32 s35, 0x00020000
    s_add_u32 s76, s4, 0x5434000
    s_addc_u32 s77, s5, 0x0
    s_mov_b32 s78, 0x8000
    s_mov_b32 s79, 0x00020000
    s_cmp_eq_u32 s93, 1
    s_cbranch_scc1 is_52
    s_mov_b32 s93, 1
    v_readfirstlane_b32 s74, v0
    s_nop 3
    s_cmp_lt_u32 s74, 64
    s_cbranch_scc0 is_52
    s_load_dwordx2 s[74:75], s[0:1], 96
    s_waitcnt lgkmcnt(0)
    s_mov_b32 s84, s74
    s_mov_b32 s85, s75
    s_mov_b32 s86, 0x100
    s_mov_b32 s87, 0x00020000
    v_mov_b32 v13, 8
    s_mov_b32 s74, 0
wc_53:
    buffer_load_dword v12, v13, s[84:87], 0 offen sc1
    s_add_u32 s74, s74, 1
    s_cmp_gt_u32 s74, 3000000
    s_cbranch_scc1 wk_done
    s_waitcnt vmcnt(0)
    v_readfirstlane_b32 s75, v12
    s_nop 3
    s_cmp_ge_u32 s75, 256
    s_cbranch_scc1 wc_53_ok
    s_sleep 8
    s_branch wc_53
wc_53_ok:
is_52:
    s_mul_i32 s11, s100, 28672
    v_lshlrev_b32 v6, 4, v2
    s_add_u32 s39, s11, 0
    buffer_load_dwordx4 a[0:3], v6, s[12:15], s39 offen offset:0
    buffer_load_dwordx4 a[4:7], v6, s[12:15], s39 offen offset:1024
    buffer_load_dwordx4 a[8:11], v6, s[12:15], s39 offen offset:2048
    buffer_load_dwordx4 a[12:15], v6, s[12:15], s39 offen offset:3072
    s_add_u32 s39, s11, 4096
    buffer_load_dwordx4 a[16:19], v6, s[12:15], s39 offen offset:0
    buffer_load_dwordx4 a[20:23], v6, s[12:15], s39 offen offset:1024
    buffer_load_dwordx4 a[24:27], v6, s[12:15], s39 offen offset:2048
    buffer_load_dwordx4 a[28:31], v6, s[12:15], s39 offen offset:3072
    s_add_u32 s39, s11, 8192
    buffer_load_dwordx4 a[32:35], v6, s[12:15], s39 offen offset:0
    buffer_load_dwordx4 a[36:39], v6, s[12:15], s39 offen offset:1024
    buffer_load_dwordx4 a[40:43], v6, s[12:15], s39 offen offset:2048
    buffer_load_dwordx4 a[44:47], v6, s[12:15], s39 offen offset:3072
    s_add_u32 s39, s11, 12288
    buffer_load_dwordx4 a[48:51], v6, s[12:15], s39 offen offset:0
    buffer_load_dwordx4 a[52:55], v6, s[12:15], s39 offen offset:1024
    buffer_load_dwordx4 a[56:59], v6, s[12:15], s39 offen offset:2048
    buffer_load_dwordx4 a[60:63], v6, s[12:15], s39 offen offset:3072
    s_add_u32 s39, s11, 16384
    buffer_load_dwordx4 a[64:67], v6, s[12:15], s39 offen offset:0
    buffer_load_dwordx4 a[68:71], v6, s[12:15], s39 offen offset:1024
    buffer_load_dwordx4 a[72:75], v6, s[12:15], s39 offen offset:2048
    buffer_load_dwordx4 a[76:79], v6, s[12:15], s39 offen offset:3072
    s_add_u32 s39, s11, 20480
    buffer_load_dwordx4 a[80:83], v6, s[12:15], s39 offen offset:0
    buffer_load_dwordx4 a[84:87], v6, s[12:15], s39 offen offset:1024
    buffer_load_dwordx4 a[88:91], v6, s[12:15], s39 offen offset:2048
    buffer_load_dwordx4 a[92:95], v6, s[12:15], s39 offen offset:3072
    s_add_u32 s39, s11, 24576
    buffer_load_dwordx4 a[96:99], v6, s[12:15], s39 offen offset:0
    buffer_load_dwordx4 a[100:103], v6, s[12:15], s39 offen offset:1024
    buffer_load_dwordx4 a[104:107], v6, s[12:15], s39 offen offset:2048
    buffer_load_dwordx4 a[108:111], v6, s[12:15], s39 offen offset:3072
    v_lshrrev_b32 v7, 4, v5
    v_mul_u32_u24 v7, 14336, v7
    v_lshl_add_u32 v7, v4, 10, v7
    v_and_b32 v8, 15, v5
    v_lshl_add_u32 v7, v8, 4, v7
    v_lshlrev_b32 v8, 5, v3
    v_lshl_add_u32 v8, v4, 4, v8
    s_lshl_b32 s36, s100, 2
    s_add_u32 s36, s36, s10
    s_mul_i32 s37, s36, 28672
    s_mul_i32 s38, s36, 114688
    v_lshlrev_b32 v9, 3, v4
    v_sub_u32 v9, v3, v9
    v_cmp_le_i32 s[40:41], 0, v9
    v_cmp_le_i32 s[42:43], 1, v9
    v_cmp_le_i32 s[44:45], 2, v9
    v_cmp_le_i32 s[46:47], 3, v9
    v_cmp_le_i32 s[48:49], 4, v9
    v_cmp_le_i32 s[50:51], 5, v9
    v_cmp_le_i32 s[52:53], 6, v9
    v_cmp_le_i32 s[54:55], 7, v9
    v_cmp_le_i32 s[56:57], 16, v9
    v_cmp_le_i32 s[58:59], 17, v9
    v_cmp_le_i32 s[60:61], 18, v9
    v_cmp_le_i32 s[62:63], 19, v9
    v_cmp_le_i32 s[64:65], 20, v9
    v_cmp_le_i32 s[66:67], 21, v9
    v_cmp_le_i32 s[68:69], 22, v9
    v_cmp_le_i32 s[70:71], 23, v9
    s_mov_b32 s72, 0x3db8aa3b
    v_mov_b32 v10, 0xf149f2ca
    s_lshr_b32 s11, s100, 3
    s_lshl_b32 s11, s11, 10
    s_add_u32 s11, s11, 4096
    s_cmp_eq_u32 s93, 1
    s_cbranch_scc1 is_55
    s_mov_b32 s93, 1
    v_readfirstlane_b32 s74, v0
    s_nop 3
    s_cmp_lt_u32 s74, 64
    s_cbranch_scc0 is_55
    s_load_dwordx2 s[74:75], s[0:1], 96
    s_waitcnt lgkmcnt(0)
    s_mov_b32 s84, s74
    s_mov_b32 s85, s75
    s_mov_b32 s86, 0x100
    s_mov_b32 s87, 0x00020000
    v_mov_b32 v209, 8
    s_mov_b32 s74, 0
wc_56:
    buffer_load_dword v208, v209, s[84:87], 0 offen sc1
    s_add_u32 s74, s74, 1
    s_cmp_gt_u32 s74, 3000000
    s_cbranch_scc1 wk_done
    s_waitcnt vmcnt(0)
    v_readfirstlane_b32 s75, v208
    s_nop 3
    s_cmp_ge_u32 s75, 256
    s_cbranch_scc1 wc_56_ok
    s_sleep 8
    s_branch wc_56
wc_56_ok:
is_55:
    v_readfirstlane_b32 s74, v0
    s_nop 3
    s_cmp_lt_u32 s74, 64
    s_cbranch_scc0 fx_54
    v_and_b32 v216, 63, v0
    v_lshlrev_b32 v216, 4, v216
    v_add_u32 v216, s11, v216
    s_mov_b32 s74, 0
    v_mov_b32 v208, 0
    v_mov_b32 v209, 0
    v_mov_b32 v210, 0
    v_mov_b32 v211, 0
    v_mov_b32 v212, 0
    v_mov_b32 v213, 0
    v_mov_b32 v214, 0
    v_mov_b32 v215, 0
fw_57:
    s_mov_b32 exec_lo, 0xffffffff
    s_mov_b32 exec_hi, 0xffffff
    buffer_load_dwordx4 v[208:211], v216, s[96:99], 0 offen sc1
    s_mov_b64 exec, -1
    s_add_u32 s74, s74, 1
    s_cmp_gt_u32 s74, 3000000
    s_cbranch_scc1 wk_done
    s_waitcnt vmcnt(0)
    v_max3_u32 v208, v208, v209, v210
    v_max3_u32 v212, v212, v213, v214
    v_max3_u32 v208, v208, v211, v215
    v_max_u32 v208, v208, v212
    v_cmp_eq_u32 vcc, -1, v208
    s_cbranch_vccz fw_57_ok
    s_sleep 8
    s_branch fw_57
fw_57_ok:
fx_54:
    s_barrier
    s_add_u32 s39, s38, 0
    buffer_load_dwordx4 v[16:19], v7, s[16:19], s39 offen offset:0 sc1
    buffer_load_dwordx4 v[20:23], v7, s[16:19], s39 offen offset:256 sc1
    buffer_load_dwordx4 v[24:27], v7, s[16:19], s39 offen offset:512 sc1
    buffer_load_dwordx4 v[28:31], v7, s[16:19], s39 offen offset:768 sc1
    s_add_u32 s39, s38, 2048
    buffer_load_dwordx4 v[32:35], v7, s[16:19], s39 offen offset:0 sc1
    buffer_load_dwordx4 v[36:39], v7, s[16:19], s39 offen offset:256 sc1
    buffer_load_dwordx4 v[40:43], v7, s[16:19], s39 offen offset:512 sc1
    buffer_load_dwordx4 v[44:47], v7, s[16:19], s39 offen offset:768 sc1
    s_add_u32 s39, s38, 4096
    buffer_load_dwordx4 v[48:51], v7, s[16:19], s39 offen offset:0 sc1
    buffer_load_dwordx4 v[52:55], v7, s[16:19], s39 offen offset:256 sc1
    buffer_load_dwordx4 v[56:59], v7, s[16:19], s39 offen offset:512 sc1
    buffer_load_dwordx4 v[60:63], v7, s[16:19], s39 offen offset:768 sc1
    s_add_u32 s39, s38, 6144
    buffer_load_dwordx4 v[64:67], v7, s[16:19], s39 offen offset:0 sc1
    buffer_load_dwordx4 v[68:71], v7, s[16:19], s39 offen offset:256 sc1
    buffer_load_dwordx4 v[72:75], v7, s[16:19], s39 offen offset:512 sc1
    buffer_load_dwordx4 v[76:79], v7, s[16:19], s39 offen offset:768 sc1
    s_add_u32 s39, s38, 8192
    buffer_load_dwordx4 v[80:83], v7, s[16:19], s39 offen offset:0 sc1
    buffer_load_dwordx4 v[84:87], v7, s[16:19], s39 offen offset:256 sc1
    buffer_load_dwordx4 v[88:91], v7, s[16:19], s39 offen offset:512 sc1
    buffer_load_dwordx4 v[92:95], v7, s[16:19], s39 offen offset:768 sc1
    s_add_u32 s39, s38, 10240
    buffer_load_dwordx4 v[96:99], v7, s[16:19], s39 offen offset:0 sc1
    buffer_load_dwordx4 v[100:103], v7, s[16:19], s39 offen offset:256 sc1
    buffer_load_dwordx4 v[104:107], v7, s[16:19], s39 offen offset:512 sc1
    buffer_load_dwordx4 v[108:111], v7, s[16:19], s39 offen offset:768 sc1
    s_add_u32 s39, s38, 12288
    buffer_load_dwordx4 v[112:115], v7, s[16:19], s39 offen offset:0 sc1
    buffer_load_dwordx4 v[116:119], v7, s[16:19], s39 offen offset:256 sc1
    buffer_load_dwordx4 v[120:123], v7, s[16:19], s39 offen offset:512 sc1
    buffer_load_dwordx4 v[124:127], v7, s[16:19], s39 offen offset:768 sc1
    s_add_u32 s39, s38, 28672
    buffer_load_dwordx4 a[112:115], v7, s[16:19], s39 offen offset:0 sc1
    buffer_load_dwordx4 a[116:119], v7, s[16:19], s39 offen offset:256 sc1
    buffer_load_dwordx4 a[120:123], v7, s[16:19], s39 offen offset:512 sc1
    buffer_load_dwordx4 a[124:127], v7, s[16:19], s39 offen offset:768 sc1
    s_add_u32 s39, s38, 30720
    buffer_load_dwordx4 a[128:131], v7, s[16:19], s39 offen offset:0 sc1
    buffer_load_dwordx4 a[132:135], v7, s[16:19], s39 offen offset:256 sc1
    buffer_load_dwordx4 a[136:139], v7, s[16:19], s39 offen offset:512 sc1
    buffer_load_dwordx4 a[140:143], v7, s[16:19], s39 offen offset:768 sc1
    s_add_u32 s39, s38, 32768
    buffer_load_dwordx4 a[144:147], v7, s[16:19], s39 offen offset:0 sc1
    buffer_load_dwordx4 a[148:151], v7, s[16:19], s39 offen offset:256 sc1
    buffer_load_dwordx4 a[152:155], v7, s[16:19], s39 offen offset:512 sc1
    buffer_load_dwordx4 a[156:159], v7, s[16:19], s39 offen offset:768 sc1
    s_add_u32 s39, s38, 34816
    buffer_load_dwordx4 a[160:163], v7, s[16:19], s39 offen offset:0 sc1
    buffer_load_dwordx4 a[164:167], v7, s[16:19], s39 offen offset:256 sc1
    buffer_load_dwordx4 a[168:171], v7, s[16:19], s39 offen offset:512 sc1
    buffer_load_dwordx4 a[172:175], v7, s[16:19], s39 offen offset:768 sc1
    s_add_u32 s39, s38, 36864
    buffer_load_dwordx4 a[176:179], v7, s[16:19], s39 offen offset:0 sc1
    buffer_load_dwordx4 a[180:183], v7, s[16:19], s39 offen offset:256 sc1
    buffer_load_dwordx4 a[184:187], v7, s[16:19], s39 offen offset:512 sc1
    buffer_load_dwordx4 a[188:191], v7, s[16:19], s39 offen offset:768 sc1
    s_add_u32 s39, s38, 38912
    buffer_load_dwordx4 a[192:195], v7, s[16:19], s39 offen offset:0 sc1
    buffer_load_dwordx4 a[196:199], v7, s[16:19], s39 offen offset:256 sc1
    buffer_load_dwordx4 a[200:203], v7, s[16:19], s39 offen offset:512 sc1
    buffer_load_dwordx4 a[204:207], v7, s[16:19], s39 offen offset:768 sc1
    s_add_u32 s39, s38, 40960
    buffer_load_dwordx4 a[208:211], v7, s[16:19], s39 offen offset:0 sc1
    buffer_load_dwordx4 a[212:215], v7, s[16:19], s39 offen offset:256 sc1
    buffer_load_dwordx4 a[216:219], v7, s[16:19], s39 offen offset:512 sc1
    buffer_load_dwordx4 a[220:223], v7, s[16:19], s39 offen offset:768 sc1
    s_waitcnt vmcnt(28)
    v_mfma_f32_32x32x16_bf16 v[144:159], v[16:19], a[0:3], 0
    v_mfma_f32_32x32x16_bf16 v[144:159], v[20:23], a[4:7], v[144:159]
    v_mfma_f32_32x32x16_bf16 v[144:159], v[24:27], a[8:11], v[144:159]
    v_mfma_f32_32x32x16_bf16 v[144:159], v[28:31], a[12:15], v[144:159]
    v_mfma_f32_32x32x16_bf16 v[144:159], v[32:35], a[16:19], v[144:159]
    v_mfma_f32_32x32x16_bf16 v[144:159], v[36:39], a[20:23], v[144:159]
    v_mfma_f32_32x32x16_bf16 v[144:159], v[40:43], a[24:27], v[144:159]
    v_mfma_f32_32x32x16_bf16 v[144:159], v[44:47], a[28:31], v[144:159]
    v_mfma_f32_32x32x16_bf16 v[144:159], v[48:51], a[32:35], v[144:159]
    v_mfma_f32_32x32x16_bf16 v[144:159], v[52:55], a[36:39], v[144:159]
    v_mfma_f32_32x32x16_bf16 v[144:159], v[56:59], a[40:43], v[144:159]
    v_mfma_f32_32x32x16_bf16 v[144:159], v[60:63], a[44:47], v[144:159]
    v_mfma_f32_32x32x16_bf16 v[144:159], v[64:67], a[48:51], v[144:159]
    v_mfma_f32_32x32x16_bf16 v[144:159], v[68:71], a[52:55], v[144:159]
    v_mfma_f32_32x32x16_bf16 v[144:159], v[72:75], a[56:59], v[144:159]
    v_mfma_f32_32x32x16_bf16 v[144:159], v[76:79], a[60:63], v[144:159]
    v_mfma_f32_32x32x16_bf16 v[144:159], v[80:83], a[64:67], v[144:159]
    v_mfma_f32_32x32x16_bf16 v[144:159], v[84:87], a[68:71], v[144:159]
    v_mfma_f32_32x32x16_bf16 v[144:159], v[88:91], a[72:75], v[144:159]
    v_mfma_f32_32x32x16_bf16 v[144:159], v[92:95], a[76:79], v[144:159]
    v_mfma_f32_32x32x16_bf16 v[144:159], v[96:99], a[80:83], v[144:159]
    v_mfma_f32_32x32x16_bf16 v[144:159], v[100:103], a[84:87], v[144:159]
    v_mfma_f32_32x32x16_bf16 v[144:159], v[104:107], a[88:91], v[144:159]
    v_mfma_f32_32x32x16_bf16 v[144:159], v[108:111], a[92:95], v[144:159]
    v_mfma_f32_32x32x16_bf16 v[144:159], v[112:115], a[96:99], v[144:159]
    v_mfma_f32_32x32x16_bf16 v[144:159], v[116:119], a[100:103], v[144:159]
    v_mfma_f32_32x32x16_bf16 v[144:159], v[120:123], a[104:107], v[144:159]
    v_mfma_f32_32x32x16_bf16 v[144:159], v[124:127], a[108:111], v[144:159]
    s_nop 0
    s_add_u32 s39, s38, 57344
    buffer_load_dwordx4 v[16:19], v7, s[16:19], s39 offen offset:0 sc1
    buffer_load_dwordx4 v[20:23], v7, s[16:19], s39 offen offset:256 sc1
    buffer_load_dwordx4 v[24:27], v7, s[16:19], s39 offen offset:512 sc1
    buffer_load_dwordx4 v[28:31], v7, s[16:19], s39 offen offset:768 sc1
    s_add_u32 s39, s38, 59392
    buffer_load_dwordx4 v[32:35], v7, s[16:19], s39 offen offset:0 sc1
    buffer_load_dwordx4 v[36:39], v7, s[16:19], s39 offen offset:256 sc1
    buffer_load_dwordx4 v[40:43], v7, s[16:19], s39 offen offset:512 sc1
    buffer_load_dwordx4 v[44:47], v7, s[16:19], s39 offen offset:768 sc1
    s_add_u32 s39, s38, 61440
    buffer_load_dwordx4 v[48:51], v7, s[16:19], s39 offen offset:0 sc1
    buffer_load_dwordx4 v[52:55], v7, s[16:19], s39 offen offset:256 sc1
    buffer_load_dwordx4 v[56:59], v7, s[16:19], s39 offen offset:512 sc1
    buffer_load_dwordx4 v[60:63], v7, s[16:19], s39 offen offset:768 sc1
    s_add_u32 s39, s38, 63488
    buffer_load_dwordx4 v[64:67], v7, s[16:19], s39 offen offset:0 sc1
    buffer_load_dwordx4 v[68:71], v7, s[16:19], s39 offen offset:256 sc1
    buffer_load_dwordx4 v[72:75], v7, s[16:19], s39 offen offset:512 sc1
    buffer_load_dwordx4 v[76:79], v7, s[16:19], s39 offen offset:768 sc1
    s_add_u32 s39, s38, 65536
    buffer_load_dwordx4 v[80:83], v7, s[16:19], s39 offen offset:0 sc1
    buffer_load_dwordx4 v[84:87], v7, s[16:19], s39 offen offset:256 sc1
    buffer_load_dwordx4 v[88:91], v7, s[16:19], s39 offen offset:512 sc1
    buffer_load_dwordx4 v[92:95], v7, s[16:19], s39 offen offset:768 sc1
    s_add_u32 s39, s38, 67584
    buffer_load_dwordx4 v[96:99], v7, s[16:19], s39 offen offset:0 sc1
    buffer_load_dwordx4 v[100:103], v7, s[16:19], s39 offen offset:256 sc1
    buffer_load_dwordx4 v[104:107], v7, s[16:19], s39 offen offset:512 sc1
    buffer_load_dwordx4 v[108:111], v7, s[16:19], s39 offen offset:768 sc1
    s_add_u32 s39, s38, 69632
    buffer_load_dwordx4 v[112:115], v7, s[16:19], s39 offen offset:0 sc1
    buffer_load_dwordx4 v[116:119], v7, s[16:19], s39 offen offset:256 sc1
    buffer_load_dwordx4 v[120:123], v7, s[16:19], s39 offen offset:512 sc1
    buffer_load_dwordx4 v[124:127], v7, s[16:19], s39 offen offset:768 sc1
    s_waitcnt vmcnt(28)
    v_mfma_f32_32x32x16_bf16 v[160:175], a[112:115], a[0:3], 0
    v_mfma_f32_32x32x16_bf16 v[160:175], a[116:119], a[4:7], v[160:175]
    v_mfma_f32_32x32x16_bf16 v[160:175], a[120:123], a[8:11], v[160:175]
    v_mfma_f32_32x32x16_bf16 v[160:175], a[124:127], a[12:15], v[160:175]
    v_mfma_f32_32x32x16_bf16 v[160:175], a[128:131], a[16:19], v[160:175]
    v_mfma_f32_32x32x16_bf16 v[160:175], a[132:135], a[20:23], v[160:175]
    v_mfma_f32_32x32x16_bf16 v[160:175], a[136:139], a[24:27], v[160:175]
    v_mfma_f32_32x32x16_bf16 v[160:175], a[140:143], a[28:31], v[160:175]
    v_mfma_f32_32x32x16_bf16 v[160:175], a[144:147], a[32:35], v[160:175]
    v_mfma_f32_32x32x16_bf16 v[160:175], a[148:151], a[36:39], v[160:175]
    v_mfma_f32_32x32x16_bf16 v[160:175], a[152:155], a[40:43], v[160:175]
    v_mfma_f32_32x32x16_bf16 v[160:175], a[156:159], a[44:47], v[160:175]
    v_mfma_f32_32x32x16_bf16 v[160:175], a[160:163], a[48:51], v[160:175]
    v_mfma_f32_32x32x16_bf16 v[160:175], a[164:167], a[52:55], v[160:175]
    v_mfma_f32_32x32x16_bf16 v[160:175], a[168:171], a[56:59], v[160:175]
    v_mfma_f32_32x32x16_bf16 v[160:175], a[172:175], a[60:63], v[160:175]
    v_mfma_f32_32x32x16_bf16 v[160:175], a[176:179], a[64:67], v[160:175]
    v_mfma_f32_32x32x16_bf16 v[160:175], a[180:183], a[68:71], v[160:175]
    v_mfma_f32_32x32x16_bf16 v[160:175], a[184:187], a[72:75], v[160:175]
    v_mfma_f32_32x32x16_bf16 v[160:175], a[188:191], a[76:79], v[160:175]
    v_mfma_f32_32x32x16_bf16 v[160:175], a[192:195], a[80:83], v[160:175]
    v_mfma_f32_32x32x16_bf16 v[160:175], a[196:199], a[84:87], v[160:175]
    v_mfma_f32_32x32x16_bf16 v[160:175], a[200:203], a[88:91], v[160:175]
    v_mfma_f32_32x32x16_bf16 v[160:175], a[204:207], a[92:95], v[160:175]
    v_mfma_f32_32x32x16_bf16 v[160:175], a[208:211], a[96:99], v[160:175]
    v_mfma_f32_32x32x16_bf16 v[160:175], a[212:215], a[100:103], v[160:175]
    v_mfma_f32_32x32x16_bf16 v[160:175], a[216:219], a[104:107], v[160:175]
    v_mfma_f32_32x32x16_bf16 v[160:175], a[220:223], a[108:111], v[160:175]
    s_nop 0
    s_add_u32 s39, s38, 86016
    buffer_load_dwordx4 a[112:115], v7, s[16:19], s39 offen offset:0 sc1
    buffer_load_dwordx4 a[116:119], v7, s[16:19], s39 offen offset:256 sc1
    buffer_load_dwordx4 a[120:123], v7, s[16:19], s39 offen offset:512 sc1
    buffer_load_dwordx4 a[124:127], v7, s[16:19], s39 offen offset:768 sc1
    s_add_u32 s39, s38, 88064
    buffer_load_dwordx4 a[128:131], v7, s[16:19], s39 offen offset:0 sc1
    buffer_load_dwordx4 a[132:135], v7, s[16:19], s39 offen offset:256 sc1
    buffer_load_dwordx4 a[136:139], v7, s[16:19], s39 offen offset:512 sc1
    buffer_load_dwordx4 a[140:143], v7, s[16:19], s39 offen offset:768 sc1
    s_add_u32 s39, s38, 90112
    buffer_load_dwordx4 a[144:147], v7, s[16:19], s39 offen offset:0 sc1
    buffer_load_dwordx4 a[148:151], v7, s[16:19], s39 offen offset:256 sc1
    buffer_load_dwordx4 a[152:155], v7, s[16:19], s39 offen offset:512 sc1
    buffer_load_dwordx4 a[156:159], v7, s[16:19], s39 offen offset:768 sc1
    s_add_u32 s39, s38, 92160
    buffer_load_dwordx4 a[160:163], v7, s[16:19], s39 offen offset:0 sc1
    buffer_load_dwordx4 a[164:167], v7, s[16:19], s39 offen offset:256 sc1
    buffer_load_dwordx4 a[168:171], v7, s[16:19], s39 offen offset:512 sc1
    buffer_load_dwordx4 a[172:175], v7, s[16:19], s39 offen offset:768 sc1
    s_add_u32 s39, s38, 94208
    buffer_load_dwordx4 a[176:179], v7, s[16:19], s39 offen offset:0 sc1
    buffer_load_dwordx4 a[180:183], v7, s[16:19], s39 offen offset:256 sc1
    buffer_load_dwordx4 a[184:187], v7, s[16:19], s39 offen offset:512 sc1
    buffer_load_dwordx4 a[188:191], v7, s[16:19], s39 offen offset:768 sc1
    s_add_u32 s39, s38, 96256
    buffer_load_dwordx4 a[192:195], v7, s[16:19], s39 offen offset:0 sc1
    buffer_load_dwordx4 a[196:199], v7, s[16:19], s39 offen offset:256 sc1
    buffer_load_dwordx4 a[200:203], v7, s[16:19], s39 offen offset:512 sc1
    buffer_load_dwordx4 a[204:207], v7, s[16:19], s39 offen offset:768 sc1
    s_add_u32 s39, s38, 98304
    buffer_load_dwordx4 a[208:211], v7, s[16:19], s39 offen offset:0 sc1
    buffer_load_dwordx4 a[212:215], v7, s[16:19], s39 offen offset:256 sc1
    buffer_load_dwordx4 a[216:219], v7, s[16:19], s39 offen offset:512 sc1
    buffer_load_dwordx4 a[220:223], v7, s[16:19], s39 offen offset:768 sc1
    s_waitcnt vmcnt(28)
    v_mfma_f32_32x32x16_bf16 v[176:191], v[16:19], a[0:3], 0
    v_mfma_f32_32x32x16_bf16 v[176:191], v[20:23], a[4:7], v[176:191]
    v_mfma_f32_32x32x16_bf16 v[176:191], v[24:27], a[8:11], v[176:191]
    v_mfma_f32_32x32x16_bf16 v[176:191], v[28:31], a[12:15], v[176:191]
    v_mfma_f32_32x32x16_bf16 v[176:191], v[32:35], a[16:19], v[176:191]
    v_mfma_f32_32x32x16_bf16 v[176:191], v[36:39], a[20:23], v[176:191]
    v_mfma_f32_32x32x16_bf16 v[176:191], v[40:43], a[24:27], v[176:191]
    v_mfma_f32_32x32x16_bf16 v[176:191], v[44:47], a[28:31], v[176:191]
    v_mfma_f32_32x32x16_bf16 v[176:191], v[48:51], a[32:35], v[176:191]
    v_mfma_f32_32x32x16_bf16 v[176:191], v[52:55], a[36:39], v[176:191]
    v_mfma_f32_32x32x16_bf16 v[176:191], v[56:59], a[40:43], v[176:191]
    v_mfma_f32_32x32x16_bf16 v[176:191], v[60:63], a[44:47], v[176:191]
    v_mfma_f32_32x32x16_bf16 v[176:191], v[64:67], a[48:51], v[176:191]
    v_mfma_f32_32x32x16_bf16 v[176:191], v[68:71], a[52:55], v[176:191]
    v_mfma_f32_32x32x16_bf16 v[176:191], v[72:75], a[56:59], v[176:191]
    v_mfma_f32_32x32x16_bf16 v[176:191], v[76:79], a[60:63], v[176:191]
    v_mfma_f32_32x32x16_bf16 v[176:191], v[80:83], a[64:67], v[176:191]
    v_mfma_f32_32x32x16_bf16 v[176:191], v[84:87], a[68:71], v[176:191]
    v_mfma_f32_32x32x16_bf16 v[176:191], v[88:91], a[72:75], v[176:191]
    v_mfma_f32_32x32x16_bf16 v[176:191], v[92:95], a[76:79], v[176:191]
    v_mfma_f32_32x32x16_bf16 v[176:191], v[96:99], a[80:83], v[176:191]
    v_mfma_f32_32x32x16_bf16 v[176:191], v[100:103], a[84:87], v[176:191]
    v_mfma_f32_32x32x16_bf16 v[176:191], v[104:107], a[88:91], v[176:191]
    v_mfma_f32_32x32x16_bf16 v[176:191], v[108:111], a[92:95], v[176:191]
    v_mfma_f32_32x32x16_bf16 v[176:191], v[112:115], a[96:99], v[176:191]
    v_mfma_f32_32x32x16_bf16 v[176:191], v[116:119], a[100:103], v[176:191]
    v_mfma_f32_32x32x16_bf16 v[176:191], v[120:123], a[104:107], v[176:191]
    v_mfma_f32_32x32x16_bf16 v[176:191], v[124:127], a[108:111], v[176:191]
    s_waitcnt vmcnt(0)
    v_mfma_f32_32x32x16_bf16 v[192:207], a[112:115], a[0:3], 0
    v_mfma_f32_32x32x16_bf16 v[192:207], a[116:119], a[4:7], v[192:207]
    v_mfma_f32_32x32x16_bf16 v[192:207], a[120:123], a[8:11], v[192:207]
    v_mfma_f32_32x32x16_bf16 v[192:207], a[124:127], a[12:15], v[192:207]
    v_mfma_f32_32x32x16_bf16 v[192:207], a[128:131], a[16:19], v[192:207]
    v_mfma_f32_32x32x16_bf16 v[192:207], a[132:135], a[20:23], v[192:207]
    v_mfma_f32_32x32x16_bf16 v[192:207], a[136:139], a[24:27], v[192:207]
    v_mfma_f32_32x32x16_bf16 v[192:207], a[140:143], a[28:31], v[192:207]
    v_mfma_f32_32x32x16_bf16 v[192:207], a[144:147], a[32:35], v[192:207]
    v_mfma_f32_32x32x16_bf16 v[192:207], a[148:151], a[36:39], v[192:207]
    v_mfma_f32_32x32x16_bf16 v[192:207], a[152:155], a[40:43], v[192:207]
    v_mfma_f32_32x32x16_bf16 v[192:207], a[156:159], a[44:47], v[192:207]
    v_mfma_f32_32x32x16_bf16 v[192:207], a[160:163], a[48:51], v[192:207]
    v_mfma_f32_32x32x16_bf16 v[192:207], a[164:167], a[52:55], v[192:207]
    v_mfma_f32_32x32x16_bf16 v[192:207], a[168:171], a[56:59], v[192:207]
    v_mfma_f32_32x32x16_bf16 v[192:207], a[172:175], a[60:63], v[192:207]
    v_mfma_f32_32x32x16_bf16 v[192:207], a[176:179], a[64:67], v[192:207]
    v_mfma_f32_32x32x16_bf16 v[192:207], a[180:183], a[68:71], v[192:207]
    v_mfma_f32_32x32x16_bf16 v[192:207], a[184:187], a[72:75], v[192:207]
    v_mfma_f32_32x32x16_bf16 v[192:207], a[188:191], a[76:79], v[192:207]
    v_mfma_f32_32x32x16_bf16 v[192:207], a[192:195], a[80:83], v[192:207]
    v_mfma_f32_32x32x16_bf16 v[192:207], a[196:199], a[84:87], v[192:207]
    v_mfma_f32_32x32x16_bf16 v[192:207], a[200:203], a[88:91], v[192:207]
    v_mfma_f32_32x32x16_bf16 v[192:207], a[204:207], a[92:95], v[192:207]
    v_mfma_f32_32x32x16_bf16 v[192:207], a[208:211], a[96:99], v[192:207]
    v_mfma_f32_32x32x16_bf16 v[192:207], a[212:215], a[100:103], v[192:207]
    v_mfma_f32_32x32x16_bf16 v[192:207], a[216:219], a[104:107], v[192:207]
    v_mfma_f32_32x32x16_bf16 v[192:207], a[220:223], a[108:111], v[192:207]
    s_mul_i32 s11, s100, 7168
    s_lshl_b32 s75, s10, 5
    s_lshl_b32 s39, s73, 7
    s_add_u32 s75, s75, s39
    s_add_u32 s11, s11, s75
    v_add_u32 v211, s11, v5
    s_mul_i32 s39, s100, 458752
    v_add_u32 v208, s75, v5
    v_lshlrev_b32 v208, 4, v208
    v_add_u32 v208, s39, v208
    v_mul_u32_u24 v209, 7168, v4
    v_add_u32 v208, v208, v209
    v_lshlrev_b32 v209, 4, v211
    v_lshl_add_u32 v209, v4, 3, v209
    s_lshl_b32 s11, s100, 5
    v_add_u32 v210, s11, v3
    v_mul_u32_u24 v210, 1792, v210
    v_lshl_add_u32 v210, v4, 4, v210
    s_lshl_b32 s75, s75, 1
    s_add_u32 s75, s75, 896
    v_add_u32 v210, s75, v210
    s_nop 4
    s_mov_b32 s39, 0
    buffer_load_dwordx4 a[112:115], v208, s[20:23], s39 offen sc1
    s_mov_b32 s39, 14336
    buffer_load_dwordx4 a[116:119], v208, s[20:23], s39 offen sc1
    s_mov_b32 s39, 28672
    buffer_load_dwordx4 a[120:123], v208, s[20:23], s39 offen sc1
    s_mov_b32 s39, 43008
    buffer_load_dwordx4 a[124:127], v208, s[20:23], s39 offen sc1
    s_mov_b32 s39, 57344
    buffer_load_dwordx4 a[128:131], v208, s[20:23], s39 offen sc1
    s_mov_b32 s39, 71680
    buffer_load_dwordx4 a[132:135], v208, s[20:23], s39 offen sc1
    s_mov_b32 s39, 86016
    buffer_load_dwordx4 a[136:139], v208, s[20:23], s39 offen sc1
    s_mov_b32 s39, 100352
    buffer_load_dwordx4 a[140:143], v208, s[20:23], s39 offen sc1
    s_mov_b32 s39, 114688
    buffer_load_dwordx4 a[144:147], v208, s[20:23], s39 offen sc1
    s_mov_b32 s39, 129024
    buffer_load_dwordx4 a[148:151], v208, s[20:23], s39 offen sc1
    s_mov_b32 s39, 143360
    buffer_load_dwordx4 a[152:155], v208, s[20:23], s39 offen sc1
    s_mov_b32 s39, 157696
    buffer_load_dwordx4 a[156:159], v208, s[20:23], s39 offen sc1
    s_mov_b32 s39, 172032
    buffer_load_dwordx4 a[160:163], v208, s[20:23], s39 offen sc1
    s_mov_b32 s39, 186368
    buffer_load_dwordx4 a[164:167], v208, s[20:23], s39 offen sc1
    s_mov_b32 s39, 200704
    buffer_load_dwordx4 a[168:171], v208, s[20:23], s39 offen sc1
    s_mov_b32 s39, 215040
    buffer_load_dwordx4 a[172:175], v208, s[20:23], s39 offen sc1
    s_mov_b32 s39, 229376
    buffer_load_dwordx4 a[176:179], v208, s[20:23], s39 offen sc1
    s_mov_b32 s39, 243712
    buffer_load_dwordx4 a[180:183], v208, s[20:23], s39 offen sc1
    s_mov_b32 s39, 258048
    buffer_load_dwordx4 a[184:187], v208, s[20:23], s39 offen sc1
    s_mov_b32 s39, 272384
    buffer_load_dwordx4 a[188:191], v208, s[20:23], s39 offen sc1
    s_mov_b32 s39, 286720
    buffer_load_dwordx4 a[192:195], v208, s[20:23], s39 offen sc1
    s_mov_b32 s39, 301056
    buffer_load_dwordx4 a[196:199], v208, s[20:23], s39 offen sc1
    s_mov_b32 s39, 315392
    buffer_load_dwordx4 a[200:203], v208, s[20:23], s39 offen sc1
    s_mov_b32 s39, 329728
    buffer_load_dwordx4 a[204:207], v208, s[20:23], s39 offen sc1
    s_mov_b32 s39, 344064
    buffer_load_dwordx4 a[208:211], v208, s[20:23], s39 offen sc1
    s_mov_b32 s39, 358400
    buffer_load_dwordx4 a[212:215], v208, s[20:23], s39 offen sc1
    s_mov_b32 s39, 372736
    buffer_load_dwordx4 a[216:219], v208, s[20:23], s39 offen sc1
    s_mov_b32 s39, 387072
    buffer_load_dwordx4 a[220:223], v208, s[20:23], s39 offen sc1
    s_mov_b32 s39, 401408
    buffer_load_dwordx4 a[224:227], v208, s[20:23], s39 offen sc1
    s_mov_b32 s39, 415744
    buffer_load_dwordx4 a[228:231], v208, s[20:23], s39 offen sc1
    s_mov_b32 s39, 430080
    buffer_load_dwordx4 a[232:235], v208, s[20:23], s39 offen sc1
    s_mov_b32 s39, 444416
    buffer_load_dwordx4 a[236:239], v208, s[20:23], s39 offen sc1
    s_nop 15
    v_cndmask_b32_e64 v144, v10, v144, s[40:41]
    v_cndmask_b32_e64 v145, v10, v145, s[42:43]
    v_cndmask_b32_e64 v146, v10, v146, s[44:45]
    v_cndmask_b32_e64 v147, v10, v147, s[46:47]
    v_cndmask_b32_e64 v148, v10, v148, s[48:49]
    v_cndmask_b32_e64 v149, v10, v149, s[50:51]
    v_cndmask_b32_e64 v150, v10, v150, s[52:53]
    v_cndmask_b32_e64 v151, v10, v151, s[54:55]
    v_cndmask_b32_e64 v152, v10, v152, s[56:57]
    v_cndmask_b32_e64 v153, v10, v153, s[58:59]
    v_cndmask_b32_e64 v154, v10, v154, s[60:61]
    v_cndmask_b32_e64 v155, v10, v155, s[62:63]
    v_cndmask_b32_e64 v156, v10, v156, s[64:65]
    v_cndmask_b32_e64 v157, v10, v157, s[66:67]
    v_cndmask_b32_e64 v158, v10, v158, s[68:69]
    v_cndmask_b32_e64 v159, v10, v159, s[70:71]
    v_max3_f32 v16, v144, v145, v146
    v_max3_f32 v16, v16, v147, v148
    v_max3_f32 v16, v16, v149, v150
    v_max3_f32 v16, v16, v151, v152
    v_max3_f32 v16, v16, v153, v154
    v_max3_f32 v16, v16, v155, v156
    v_max3_f32 v16, v16, v157, v158
    v_max_f32 v16, v16, v159
    v_mov_b32 v17, v16
    s_nop 1
    v_permlane32_swap_b32 v16, v17
    s_nop 1
    v_max_f32 v16, v16, v17
    v_mul_f32 v244, s72, v16
    v_fma_f32 v144, v144, s72, -v244
    v_fma_f32 v145, v145, s72, -v244
    v_fma_f32 v146, v146, s72, -v244
    v_fma_f32 v147, v147, s72, -v244
    v_fma_f32 v148, v148, s72, -v244
    v_fma_f32 v149, v149, s72, -v244
    v_fma_f32 v150, v150, s72, -v244
    v_fma_f32 v151, v151, s72, -v244
    v_fma_f32 v152, v152, s72, -v244
    v_fma_f32 v153, v153, s72, -v244
    v_fma_f32 v154, v154, s72, -v244
    v_fma_f32 v155, v155, s72, -v244
    v_fma_f32 v156, v156, s72, -v244
    v_fma_f32 v157, v157, s72, -v244
    v_fma_f32 v158, v158, s72, -v244
    v_fma_f32 v159, v159, s72, -v244
    v_exp_f32 v144, v144
    v_exp_f32 v145, v145
    v_exp_f32 v146, v146
    v_exp_f32 v147, v147
    v_exp_f32 v148, v148
    v_exp_f32 v149, v149
    v_exp_f32 v150, v150
    v_exp_f32 v151, v151
    v_exp_f32 v152, v152
    v_exp_f32 v153, v153
    v_exp_f32 v154, v154
    v_exp_f32 v155, v155
    v_exp_f32 v156, v156
    v_exp_f32 v157, v157
    v_exp_f32 v158, v158
    v_exp_f32 v159, v159
    s_nop 0
    v_add_f32 v245, v144, v145
    v_add_f32 v245, v245, v146
    v_add_f32 v245, v245, v147
    v_add_f32 v245, v245, v148
    v_add_f32 v245, v245, v149
    v_add_f32 v245, v245, v150
    v_add_f32 v245, v245, v151
    v_add_f32 v245, v245, v152
    v_add_f32 v245, v245, v153
    v_add_f32 v245, v245, v154
    v_add_f32 v245, v245, v155
    v_add_f32 v245, v245, v156
    v_add_f32 v245, v245, v157
    v_add_f32 v245, v245, v158
    v_add_f32 v245, v245, v159
    v_cndmask_b32_e64 v160, v10, v160, s[40:41]
    v_cndmask_b32_e64 v161, v10, v161, s[42:43]
    v_cndmask_b32_e64 v162, v10, v162, s[44:45]
    v_cndmask_b32_e64 v163, v10, v163, s[46:47]
    v_cndmask_b32_e64 v164, v10, v164, s[48:49]
    v_cndmask_b32_e64 v165, v10, v165, s[50:51]
    v_cndmask_b32_e64 v166, v10, v166, s[52:53]
    v_cndmask_b32_e64 v167, v10, v167, s[54:55]
    v_cndmask_b32_e64 v168, v10, v168, s[56:57]
    v_cndmask_b32_e64 v169, v10, v169, s[58:59]
    v_cndmask_b32_e64 v170, v10, v170, s[60:61]
    v_cndmask_b32_e64 v171, v10, v171, s[62:63]
    v_cndmask_b32_e64 v172, v10, v172, s[64:65]
    v_cndmask_b32_e64 v173, v10, v173, s[66:67]
    v_cndmask_b32_e64 v174, v10, v174, s[68:69]
    v_cndmask_b32_e64 v175, v10, v175, s[70:71]
    v_max3_f32 v16, v160, v161, v162
    v_max3_f32 v16, v16, v163, v164
    v_max3_f32 v16, v16, v165, v166
    v_max3_f32 v16, v16, v167, v168
    v_max3_f32 v16, v16, v169, v170
    v_max3_f32 v16, v16, v171, v172
    v_max3_f32 v16, v16, v173, v174
    v_max_f32 v16, v16, v175
    v_mov_b32 v17, v16
    s_nop 1
    v_permlane32_swap_b32 v16, v17
    s_nop 1
    v_max_f32 v16, v16, v17
    v_mul_f32 v246, s72, v16
    v_fma_f32 v160, v160, s72, -v246
    v_fma_f32 v161, v161, s72, -v246
    v_fma_f32 v162, v162, s72, -v246
    v_fma_f32 v163, v163, s72, -v246
    v_fma_f32 v164, v164, s72, -v246
    v_fma_f32 v165, v165, s72, -v246
    v_fma_f32 v166, v166, s72, -v246
    v_fma_f32 v167, v167, s72, -v246
    v_fma_f32 v168, v168, s72, -v246
    v_fma_f32 v169, v169, s72, -v246
    v_fma_f32 v170, v170, s72, -v246
    v_fma_f32 v171, v171, s72, -v246
    v_fma_f32 v172, v172, s72, -v246
    v_fma_f32 v173, v173, s72, -v246
    v_fma_f32 v174, v174, s72, -v246
    v_fma_f32 v175, v175, s72, -v246
    v_exp_f32 v160, v160
    v_exp_f32 v161, v161
    v_exp_f32 v162, v162
    v_exp_f32 v163, v163
    v_exp_f32 v164, v164
    v_exp_f32 v165, v165
    v_exp_f32 v166, v166
    v_exp_f32 v167, v167
    v_exp_f32 v168, v168
    v_exp_f32 v169, v169
    v_exp_f32 v170, v170
    v_exp_f32 v171, v171
    v_exp_f32 v172, v172
    v_exp_f32 v173, v173
    v_exp_f32 v174, v174
    v_exp_f32 v175, v175
    s_nop 0
    v_add_f32 v247, v160, v161
    v_add_f32 v247, v247, v162
    v_add_f32 v247, v247, v163
    v_add_f32 v247, v247, v164
    v_add_f32 v247, v247, v165
    v_add_f32 v247, v247, v166
    v_add_f32 v247, v247, v167
    v_add_f32 v247, v247, v168
    v_add_f32 v247, v247, v169
    v_add_f32 v247, v247, v170
    v_add_f32 v247, v247, v171
    v_add_f32 v247, v247, v172
    v_add_f32 v247, v247, v173
    v_add_f32 v247, v247, v174
    v_add_f32 v247, v247, v175
    v_cndmask_b32_e64 v176, v10, v176, s[40:41]
    v_cndmask_b32_e64 v177, v10, v177, s[42:43]
    v_cndmask_b32_e64 v178, v10, v178, s[44:45]
    v_cndmask_b32_e64 v179, v10, v179, s[46:47]
    v_cndmask_b32_e64 v180, v10, v180, s[48:49]
    v_cndmask_b32_e64 v181, v10, v181, s[50:51]
    v_cndmask_b32_e64 v182, v10, v182, s[52:53]
    v_cndmask_b32_e64 v183, v10, v183, s[54:55]
    v_cndmask_b32_e64 v184, v10, v184, s[56:57]
    v_cndmask_b32_e64 v185, v10, v185, s[58:59]
    v_cndmask_b32_e64 v186, v10, v186, s[60:61]
    v_cndmask_b32_e64 v187, v10, v187, s[62:63]
    v_cndmask_b32_e64 v188, v10, v188, s[64:65]
    v_cndmask_b32_e64 v189, v10, v189, s[66:67]
    v_cndmask_b32_e64 v190, v10, v190, s[68:69]
    v_cndmask_b32_e64 v191, v10, v191, s[70:71]
    v_max3_f32 v16, v176, v177, v178
    v_max3_f32 v16, v16, v179, v180
    v_max3_f32 v16, v16, v181, v182
    v_max3_f32 v16, v16, v183, v184
    v_max3_f32 v16, v16, v185, v186
    v_max3_f32 v16, v16, v187, v188
    v_max3_f32 v16, v16, v189, v190
    v_max_f32 v16, v16, v191
    v_mov_b32 v17, v16
    s_nop 1
    v_permlane32_swap_b32 v16, v17
    s_nop 1
    v_max_f32 v16, v16, v17
    v_mul_f32 v248, s72, v16
    v_fma_f32 v176, v176, s72, -v248
    v_fma_f32 v177, v177, s72, -v248
    v_fma_f32 v178, v178, s72, -v248
    v_fma_f32 v179, v179, s72, -v248
    v_fma_f32 v180, v180, s72, -v248
    v_fma_f32 v181, v181, s72, -v248
    v_fma_f32 v182, v182, s72, -v248
    v_fma_f32 v183, v183, s72, -v248
    v_fma_f32 v184, v184, s72, -v248
    v_fma_f32 v185, v185, s72, -v248
    v_fma_f32 v186, v186, s72, -v248
    v_fma_f32 v187, v187, s72, -v248
    v_fma_f32 v188, v188, s72, -v248
    v_fma_f32 v189, v189, s72, -v248
    v_fma_f32 v190, v190, s72, -v248
    v_fma_f32 v191, v191, s72, -v248
    v_exp_f32 v176, v176
    v_exp_f32 v177, v177
    v_exp_f32 v178, v178
    v_exp_f32 v179, v179
    v_exp_f32 v180, v180
    v_exp_f32 v181, v181
    v_exp_f32 v182, v182
    v_exp_f32 v183, v183
    v_exp_f32 v184, v184
    v_exp_f32 v185, v185
    v_exp_f32 v186, v186
    v_exp_f32 v187, v187
    v_exp_f32 v188, v188
    v_exp_f32 v189, v189
    v_exp_f32 v190, v190
    v_exp_f32 v191, v191
    s_nop 0
    v_add_f32 v249, v176, v177
    v_add_f32 v249, v249, v178
    v_add_f32 v249, v249, v179
    v_add_f32 v249, v249, v180
    v_add_f32 v249, v249, v181
    v_add_f32 v249, v249, v182
    v_add_f32 v249, v249, v183
    v_add_f32 v249, v249, v184
    v_add_f32 v249, v249, v185
    v_add_f32 v249, v249, v186
    v_add_f32 v249, v249, v187
    v_add_f32 v249, v249, v188
    v_add_f32 v249, v249, v189
    v_add_f32 v249, v249, v190
    v_add_f32 v249, v249, v191
    v_cndmask_b32_e64 v192, v10, v192, s[40:41]
    v_cndmask_b32_e64 v193, v10, v193, s[42:43]
    v_cndmask_b32_e64 v194, v10, v194, s[44:45]
    v_cndmask_b32_e64 v195, v10, v195, s[46:47]
    v_cndmask_b32_e64 v196, v10, v196, s[48:49]
    v_cndmask_b32_e64 v197, v10, v197, s[50:51]
    v_cndmask_b32_e64 v198, v10, v198, s[52:53]
    v_cndmask_b32_e64 v199, v10, v199, s[54:55]
    v_cndmask_b32_e64 v200, v10, v200, s[56:57]
    v_cndmask_b32_e64 v201, v10, v201, s[58:59]
    v_cndmask_b32_e64 v202, v10, v202, s[60:61]
    v_cndmask_b32_e64 v203, v10, v203, s[62:63]
    v_cndmask_b32_e64 v204, v10, v204, s[64:65]
    v_cndmask_b32_e64 v205, v10, v205, s[66:67]
    v_cndmask_b32_e64 v206, v10, v206, s[68:69]
    v_cndmask_b32_e64 v207, v10, v207, s[70:71]
    v_max3_f32 v16, v192, v193, v194
    v_max3_f32 v16, v16, v195, v196
    v_max3_f32 v16, v16, v197, v198
    v_max3_f32 v16, v16, v199, v200
    v_max3_f32 v16, v16, v201, v202
    v_max3_f32 v16, v16, v203, v204
    v_max3_f32 v16, v16, v205, v206
    v_max_f32 v16, v16, v207
    v_mov_b32 v17, v16
    s_nop 1
    v_permlane32_swap_b32 v16, v17
    s_nop 1
    v_max_f32 v16, v16, v17
    v_mul_f32 v250, s72, v16
    v_fma_f32 v192, v192, s72, -v250
    v_fma_f32 v193, v193, s72, -v250
    v_fma_f32 v194, v194, s72, -v250
    v_fma_f32 v195, v195, s72, -v250
    v_fma_f32 v196, v196, s72, -v250
    v_fma_f32 v197, v197, s72, -v250
    v_fma_f32 v198, v198, s72, -v250
    v_fma_f32 v199, v199, s72, -v250
    v_fma_f32 v200, v200, s72, -v250
    v_fma_f32 v201, v201, s72, -v250
    v_fma_f32 v202, v202, s72, -v250
    v_fma_f32 v203, v203, s72, -v250
    v_fma_f32 v204, v204, s72, -v250
    v_fma_f32 v205, v205, s72, -v250
    v_fma_f32 v206, v206, s72, -v250
    v_fma_f32 v207, v207, s72, -v250
    v_exp_f32 v192, v192
    v_exp_f32 v193, v193
    v_exp_f32 v194, v194
    v_exp_f32 v195, v195
    v_exp_f32 v196, v196
    v_exp_f32 v197, v197
    v_exp_f32 v198, v198
    v_exp_f32 v199, v199
    v_exp_f32 v200, v200
    v_exp_f32 v201, v201
    v_exp_f32 v202, v202
    v_exp_f32 v203, v203
    v_exp_f32 v204, v204
    v_exp_f32 v205, v205
    v_exp_f32 v206, v206
    v_exp_f32 v207, v207
    s_nop 0
    v_add_f32 v251, v192, v193
    v_add_f32 v251, v251, v194
    v_add_f32 v251, v251, v195
    v_add_f32 v251, v251, v196
    v_add_f32 v251, v251, v197
    v_add_f32 v251, v251, v198
    v_add_f32 v251, v251, v199
    v_add_f32 v251, v251, v200
    v_add_f32 v251, v251, v201
    v_add_f32 v251, v251, v202
    v_add_f32 v251, v251, v203
    v_add_f32 v251, v251, v204
    v_add_f32 v251, v251, v205
    v_add_f32 v251, v251, v206
    v_add_f32 v251, v251, v207
    s_lshl_b32 s11, s100, 9
    v_lshlrev_b32 v14, 3, v2
    s_mov_b32 s74, 0
bf_wm4:
    buffer_load_dwordx2 v[12:13], v14, s[76:79], s11 offen sc1
    s_add_u32 s74, s74, 1
    s_cmp_gt_u32 s74, 3000000
    s_cbranch_scc1 wk_done
    s_waitcnt vmcnt(0)
    v_max_u32 v12, v12, v13
    v_cmp_eq_u32 vcc, -1, v12
    s_cbranch_vccz bf_m4
    s_sleep 2
    s_branch bf_wm4
bf_m4:
    s_add_u32 s39, s37, 0
    buffer_load_dwordx4 v[16:19], v8, s[24:27], s39 offen offset:0 sc1
    buffer_load_dwordx4 v[20:23], v8, s[24:27], s39 offen offset:1024 sc1
    buffer_load_dwordx4 v[24:27], v8, s[24:27], s39 offen offset:2048 sc1
    buffer_load_dwordx4 v[28:31], v8, s[24:27], s39 offen offset:3072 sc1
    s_add_u32 s39, s37, 4096
    buffer_load_dwordx4 v[32:35], v8, s[24:27], s39 offen offset:0 sc1
    buffer_load_dwordx4 v[36:39], v8, s[24:27], s39 offen offset:1024 sc1
    buffer_load_dwordx4 v[40:43], v8, s[24:27], s39 offen offset:2048 sc1
    buffer_load_dwordx4 v[44:47], v8, s[24:27], s39 offen offset:3072 sc1
    s_add_u32 s39, s37, 8192
    buffer_load_dwordx4 v[48:51], v8, s[24:27], s39 offen offset:0 sc1
    buffer_load_dwordx4 v[52:55], v8, s[24:27], s39 offen offset:1024 sc1
    buffer_load_dwordx4 v[56:59], v8, s[24:27], s39 offen offset:2048 sc1
    buffer_load_dwordx4 v[60:63], v8, s[24:27], s39 offen offset:3072 sc1
    s_add_u32 s39, s37, 12288
    buffer_load_dwordx4 v[64:67], v8, s[24:27], s39 offen offset:0 sc1
    buffer_load_dwordx4 v[68:71], v8, s[24:27], s39 offen offset:1024 sc1
    buffer_load_dwordx4 v[72:75], v8, s[24:27], s39 offen offset:2048 sc1
    buffer_load_dwordx4 v[76:79], v8, s[24:27], s39 offen offset:3072 sc1
    s_add_u32 s39, s37, 16384
    buffer_load_dwordx4 v[80:83], v8, s[24:27], s39 offen offset:0 sc1
    buffer_load_dwordx4 v[84:87], v8, s[24:27], s39 offen offset:1024 sc1
    buffer_load_dwordx4 v[88:91], v8, s[24:27], s39 offen offset:2048 sc1
    buffer_load_dwordx4 v[92:95], v8, s[24:27], s39 offen offset:3072 sc1
    s_add_u32 s39, s37, 20480
    buffer_load_dwordx4 v[96:99], v8, s[24:27], s39 offen offset:0 sc1
    buffer_load_dwordx4 v[100:103], v8, s[24:27], s39 offen offset:1024 sc1
    buffer_load_dwordx4 v[104:107], v8, s[24:27], s39 offen offset:2048 sc1
    buffer_load_dwordx4 v[108:111], v8, s[24:27], s39 offen offset:3072 sc1
    s_add_u32 s39, s37, 24576
    buffer_load_dwordx4 v[112:115], v8, s[24:27], s39 offen offset:0 sc1
    buffer_load_dwordx4 v[116:119], v8, s[24:27], s39 offen offset:1024 sc1
    buffer_load_dwordx4 v[120:123], v8, s[24:27], s39 offen offset:2048 sc1
    buffer_load_dwordx4 v[124:127], v8, s[24:27], s39 offen offset:3072 sc1
    s_mov_b32 s39, 0
    buffer_load_dwordx2 v[212:213], v209, s[28:31], s39 offen sc1
    s_mov_b32 s39, 7168
    buffer_load_dwordx2 v[214:215], v209, s[28:31], s39 offen sc1
    s_mov_b32 s39, 14336
    buffer_load_dwordx2 v[216:217], v209, s[28:31], s39 offen sc1
    s_mov_b32 s39, 21504
    buffer_load_dwordx2 v[218:219], v209, s[28:31], s39 offen sc1
    s_mov_b32 s39, 28672
    buffer_load_dwordx2 v[220:221], v209, s[28:31], s39 offen sc1
    s_mov_b32 s39, 35840
    buffer_load_dwordx2 v[222:223], v209, s[28:31], s39 offen sc1
    s_mov_b32 s39, 43008
    buffer_load_dwordx2 v[224:225], v209, s[28:31], s39 offen sc1
    s_mov_b32 s39, 50176
    buffer_load_dwordx2 v[226:227], v209, s[28:31], s39 offen sc1
    s_mov_b32 s39, 57344
    buffer_load_dwordx2 v[228:229], v209, s[28:31], s39 offen sc1
    s_mov_b32 s39, 64512
    buffer_load_dwordx2 v[230:231], v209, s[28:31], s39 offen sc1
    s_mov_b32 s39, 71680
    buffer_load_dwordx2 v[232:233], v209, s[28:31], s39 offen sc1
    s_mov_b32 s39, 78848
    buffer_load_dwordx2 v[234:235], v209, s[28:31], s39 offen sc1
    s_mov_b32 s39, 86016
    buffer_load_dwordx2 v[236:237], v209, s[28:31], s39 offen sc1
    s_mov_b32 s39, 93184
    buffer_load_dwordx2 v[238:239], v209, s[28:31], s39 offen sc1
    s_mov_b32 s39, 100352
    buffer_load_dwordx2 v[240:241], v209, s[28:31], s39 offen sc1
    s_mov_b32 s39, 107520
    buffer_load_dwordx2 v[242:243], v209, s[28:31], s39 offen sc1
    s_waitcnt vmcnt(42)
    v_mfma_f32_32x32x16_bf16 v[128:143], v[16:19], a[0:3], 0
    v_max_u32 v12, v16, v17
    v_max3_u32 v12, v12, v18, v19
    v_mfma_f32_32x32x16_bf16 v[128:143], v[20:23], a[4:7], v[128:143]
    v_max3_u32 v12, v12, v20, v21
    v_max3_u32 v12, v12, v22, v23
    s_waitcnt vmcnt(40)
    v_mfma_f32_32x32x16_bf16 v[128:143], v[24:27], a[8:11], v[128:143]
    v_max3_u32 v12, v12, v24, v25
    v_max3_u32 v12, v12, v26, v27
    v_mfma_f32_32x32x16_bf16 v[128:143], v[28:31], a[12:15], v[128:143]
    v_max3_u32 v12, v12, v28, v29
    v_max3_u32 v12, v12, v30, v31
    s_waitcnt vmcnt(38)
    v_mfma_f32_32x32x16_bf16 v[128:143], v[32:35], a[16:19], v[128:143]
    v_max3_u32 v12, v12, v32, v33
    v_max3_u32 v12, v12, v34, v35
    v_mfma_f32_32x32x16_bf16 v[128:143], v[36:39], a[20:23], v[128:143]
    v_max3_u32 v12, v12, v36, v37
    v_max3_u32 v12, v12, v38, v39
    s_waitcnt vmcnt(36)
    v_mfma_f32_32x32x16_bf16 v[128:143], v[40:43], a[24:27], v[128:143]
    v_max3_u32 v12, v12, v40, v41
    v_max3_u32 v12, v12, v42, v43
    v_mfma_f32_32x32x16_bf16 v[128:143], v[44:47], a[28:31], v[128:143]
    v_max3_u32 v12, v12, v44, v45
    v_max3_u32 v12, v12, v46, v47
    s_waitcnt vmcnt(34)
    v_mfma_f32_32x32x16_bf16 v[128:143], v[48:51], a[32:35], v[128:143]
    v_max3_u32 v12, v12, v48, v49
    v_max3_u32 v12, v12, v50, v51
    v_mfma_f32_32x32x16_bf16 v[128:143], v[52:55], a[36:39], v[128:143]
    v_max3_u32 v12, v12, v52, v53
    v_max3_u32 v12, v12, v54, v55
    s_waitcnt vmcnt(32)
    v_mfma_f32_32x32x16_bf16 v[128:143], v[56:59], a[40:43], v[128:143]
    v_max3_u32 v12, v12, v56, v57
    v_max3_u32 v12, v12, v58, v59
    v_mfma_f32_32x32x16_bf16 v[128:143], v[60:63], a[44:47], v[128:143]
    v_max3_u32 v12, v12, v60, v61
    v_max3_u32 v12, v12, v62, v63
    s_waitcnt vmcnt(30)
    v_mfma_f32_32x32x16_bf16 v[128:143], v[64:67], a[48:51], v[128:143]
    v_max3_u32 v12, v12, v64, v65
    v_max3_u32 v12, v12, v66, v67
    v_mfma_f32_32x32x16_bf16 v[128:143], v[68:71], a[52:55], v[128:143]
    v_max3_u32 v12, v12, v68, v69
    v_max3_u32 v12, v12, v70, v71
    s_waitcnt vmcnt(28)
    v_mfma_f32_32x32x16_bf16 v[128:143], v[72:75], a[56:59], v[128:143]
    v_max3_u32 v12, v12, v72, v73
    v_max3_u32 v12, v12, v74, v75
    v_mfma_f32_32x32x16_bf16 v[128:143], v[76:79], a[60:63], v[128:143]
    v_max3_u32 v12, v12, v76, v77
    v_max3_u32 v12, v12, v78, v79
    s_waitcnt vmcnt(26)
    v_mfma_f32_32x32x16_bf16 v[128:143], v[80:83], a[64:67], v[128:143]
    v_max3_u32 v12, v12, v80, v81
    v_max3_u32 v12, v12, v82, v83
    v_mfma_f32_32x32x16_bf16 v[128:143], v[84:87], a[68:71], v[128:143]
    v_max3_u32 v12, v12, v84, v85
    v_max3_u32 v12, v12, v86, v87
    s_waitcnt vmcnt(24)
    v_mfma_f32_32x32x16_bf16 v[128:143], v[88:91], a[72:75], v[128:143]
    v_max3_u32 v12, v12, v88, v89
    v_max3_u32 v12, v12, v90, v91
    v_mfma_f32_32x32x16_bf16 v[128:143], v[92:95], a[76:79], v[128:143]
    v_max3_u32 v12, v12, v92, v93
    v_max3_u32 v12, v12, v94, v95
    s_waitcnt vmcnt(22)
    v_mfma_f32_32x32x16_bf16 v[128:143], v[96:99], a[80:83], v[128:143]
    v_max3_u32 v12, v12, v96, v97
    v_max3_u32 v12, v12, v98, v99
    v_mfma_f32_32x32x16_bf16 v[128:143], v[100:103], a[84:87], v[128:143]
    v_max3_u32 v12, v12, v100, v101
    v_max3_u32 v12, v12, v102, v103
    s_waitcnt vmcnt(20)
    v_mfma_f32_32x32x16_bf16 v[128:143], v[104:107], a[88:91], v[128:143]
    v_max3_u32 v12, v12, v104, v105
    v_max3_u32 v12, v12, v106, v107
    v_mfma_f32_32x32x16_bf16 v[128:143], v[108:111], a[92:95], v[128:143]
    v_max3_u32 v12, v12, v108, v109
    v_max3_u32 v12, v12, v110, v111
    s_waitcnt vmcnt(18)
    v_mfma_f32_32x32x16_bf16 v[128:143], v[112:115], a[96:99], v[128:143]
    v_max3_u32 v12, v12, v112, v113
    v_max3_u32 v12, v12, v114, v115
    v_mfma_f32_32x32x16_bf16 v[128:143], v[116:119], a[100:103], v[128:143]
    v_max3_u32 v12, v12, v116, v117
    v_max3_u32 v12, v12, v118, v119
    s_waitcnt vmcnt(16)
    v_mfma_f32_32x32x16_bf16 v[128:143], v[120:123], a[104:107], v[128:143]
    v_max3_u32 v12, v12, v120, v121
    v_max3_u32 v12, v12, v122, v123
    v_mfma_f32_32x32x16_bf16 v[128:143], v[124:127], a[108:111], v[128:143]
    v_max3_u32 v12, v12, v124, v125
    v_max3_u32 v12, v12, v126, v127
    v_cmp_eq_u32 vcc, -1, v12
    s_cbranch_vccz bf4_tok
    s_add_u32 s74, s74, 1
    s_cmp_gt_u32 s74, 3000000
    s_cbranch_scc1 wk_done
    s_waitcnt vmcnt(0)
    s_nop 15
    s_branch bf_m4
bf4_tok:
    s_nop 15
    v_lshlrev_b32 v11, 4, v2
    s_lshl_b32 s11, s10, 13
    v_add_u32 v12, s11, v11
    s_lshl_b32 s11, s10, 11
    v_add_u32 v13, s11, v11
    v_max3_f32 v48, v128, v129, v130
    v_max3_f32 v52, v132, v133, v134
    v_max3_f32 v56, v136, v137, v138
    v_max3_f32 v60, v140, v141, v142
    v_max_f32 v48, v48, v131
    v_max_f32 v52, v52, v135
    v_max_f32 v56, v56, v139
    v_max_f32 v60, v60, v143
    v_mov_b32 v49, v48
    v_mov_b32 v53, v52
    v_mov_b32 v57, v56
    v_mov_b32 v61, v60
    v_permlane32_swap_b32 v48, v49
    v_permlane32_swap_b32 v52, v53
    v_permlane32_swap_b32 v56, v57
    v_permlane32_swap_b32 v60, v61
    v_max_f32 v48, v48, v49
    v_max_f32 v52, v52, v53
    v_max_f32 v56, v56, v57
    v_max_f32 v60, v60, v61
    v_mul_f32 v48, s72, v48
    v_mul_f32 v52, s72, v52
    v_mul_f32 v56, s72, v56
    v_mul_f32 v60, s72, v60
    v_max_f32 v48, v48, v244
    v_max_f32 v52, v52, v246
    v_max_f32 v56, v56, v248
    v_max_f32 v60, v60, v250
    v_sub_f32 v50, v244, v48
    v_sub_f32 v54, v246, v52
    v_sub_f32 v58, v248, v56
    v_sub_f32 v62, v250, v60
    v_fma_f32 v128, v128, s72, -v48
    v_fma_f32 v129, v129, s72, -v48
    v_fma_f32 v130, v130, s72, -v48
    v_fma_f32 v131, v131, s72, -v48
    v_fma_f32 v132, v132, s72, -v52
    v_fma_f32 v133, v133, s72, -v52
    v_fma_f32 v134, v134, s72, -v52
    v_fma_f32 v135, v135, s72, -v52
    v_fma_f32 v136, v136, s72, -v56
    v_fma_f32 v137, v137, s72, -v56
    v_fma_f32 v138, v138, s72, -v56
    v_fma_f32 v139, v139, s72, -v56
    v_fma_f32 v140, v140, s72, -v60
    v_fma_f32 v141, v141, s72, -v60
    v_fma_f32 v142, v142, s72, -v60
    v_fma_f32 v143, v143, s72, -v60
    v_exp_f32 v50, v50
    v_exp_f32 v54, v54
    v_exp_f32 v58, v58
    v_exp_f32 v62, v62
    v_exp_f32 v128, v128
    v_exp_f32 v129, v129
    v_exp_f32 v130, v130
    v_exp_f32 v131, v131
    v_exp_f32 v132, v132
    v_exp_f32 v133, v133
    v_exp_f32 v134, v134
    v_exp_f32 v135, v135
    v_exp_f32 v136, v136
    v_exp_f32 v137, v137
    v_exp_f32 v138, v138
    v_exp_f32 v139, v139
    v_exp_f32 v140, v140
    v_exp_f32 v141, v141
    v_exp_f32 v142, v142
    v_exp_f32 v143, v143
    v_fma_f32 v48, v50, v245, v128
    v_fma_f32 v52, v54, v247, v132
    v_fma_f32 v56, v58, v249, v136
    v_fma_f32 v60, v62, v251, v140
    v_add_f32 v48, v48, v129
    v_add_f32 v52, v52, v133
    v_add_f32 v56, v56, v137
    v_add_f32 v60, v60, v141
    v_add_f32 v48, v48, v130
    v_add_f32 v52, v52, v134
    v_add_f32 v56, v56, v138
    v_add_f32 v60, v60, v142
    v_add_f32 v48, v48, v131
    v_add_f32 v52, v52, v135
    v_add_f32 v56, v56, v139
    v_add_f32 v60, v60, v143
    v_mov_b32 v49, v48
    v_mov_b32 v53, v52
    v_mov_b32 v57, v56
    v_mov_b32 v61, v60
    v_permlane32_swap_b32 v48, v49
    v_permlane32_swap_b32 v52, v53
    v_permlane32_swap_b32 v56, v57
    v_permlane32_swap_b32 v60, v61
    v_add_f32 v48, v48, v49
    v_add_f32 v52, v52, v53
    v_add_f32 v56, v56, v57
    v_add_f32 v60, v60, v61
    v_rcp_f32 v48, v48
    v_rcp_f32 v52, v52
    v_rcp_f32 v56, v56
    v_rcp_f32 v60, v60
    v_mul_f32 v50, v50, v48
    v_mul_f32 v54, v54, v52
    v_mul_f32 v58, v58, v56
    v_mul_f32 v62, v62, v60
    v_pk_mul_f32 v[144:145], v[144:145], v[50:51] op_sel_hi:[1,0]
    v_pk_mul_f32 v[146:147], v[146:147], v[50:51] op_sel_hi:[1,0]
    v_pk_mul_f32 v[148:149], v[148:149], v[50:51] op_sel_hi:[1,0]
    v_pk_mul_f32 v[150:151], v[150:151], v[50:51] op_sel_hi:[1,0]
    v_pk_mul_f32 v[152:153], v[152:153], v[50:51] op_sel_hi:[1,0]
    v_pk_mul_f32 v[154:155], v[154:155], v[50:51] op_sel_hi:[1,0]
    v_pk_mul_f32 v[156:157], v[156:157], v[50:51] op_sel_hi:[1,0]
    v_pk_mul_f32 v[158:159], v[158:159], v[50:51] op_sel_hi:[1,0]
    v_pk_mul_f32 v[128:129], v[128:129], v[48:49] op_sel_hi:[1,0]
    v_pk_mul_f32 v[130:131], v[130:131], v[48:49] op_sel_hi:[1,0]
    v_cvt_pk_bf16_f32 v64, v144, v145
    v_cvt_pk_bf16_f32 v65, v146, v147
    v_cvt_pk_bf16_f32 v66, v148, v149
    v_cvt_pk_bf16_f32 v67, v150, v151
    v_cvt_pk_bf16_f32 v68, v152, v153
    v_cvt_pk_bf16_f32 v69, v154, v155
    v_cvt_pk_bf16_f32 v70, v156, v157
    v_cvt_pk_bf16_f32 v71, v158, v159
    v_cvt_pk_bf16_f32 v40, v128, v129
    v_cvt_pk_bf16_f32 v41, v130, v131
    ds_write_b128 v12, v[64:67] offset:0
    ds_write_b128 v12, v[68:71] offset:1024
    v_pk_mul_f32 v[160:161], v[160:161], v[54:55] op_sel_hi:[1,0]
    v_pk_mul_f32 v[162:163], v[162:163], v[54:55] op_sel_hi:[1,0]
    v_pk_mul_f32 v[164:165], v[164:165], v[54:55] op_sel_hi:[1,0]
    v_pk_mul_f32 v[166:167], v[166:167], v[54:55] op_sel_hi:[1,0]
    v_pk_mul_f32 v[168:169], v[168:169], v[54:55] op_sel_hi:[1,0]
    v_pk_mul_f32 v[170:171], v[170:171], v[54:55] op_sel_hi:[1,0]
    v_pk_mul_f32 v[172:173], v[172:173], v[54:55] op_sel_hi:[1,0]
    v_pk_mul_f32 v[174:175], v[174:175], v[54:55] op_sel_hi:[1,0]
    v_pk_mul_f32 v[132:133], v[132:133], v[52:53] op_sel_hi:[1,0]
    v_pk_mul_f32 v[134:135], v[134:135], v[52:53] op_sel_hi:[1,0]
    v_cvt_pk_bf16_f32 v72, v160, v161
    v_cvt_pk_bf16_f32 v73, v162, v163
    v_cvt_pk_bf16_f32 v74, v164, v165
    v_cvt_pk_bf16_f32 v75, v166, v167
    v_cvt_pk_bf16_f32 v76, v168, v169
    v_cvt_pk_bf16_f32 v77, v170, v171
    v_cvt_pk_bf16_f32 v78, v172, v173
    v_cvt_pk_bf16_f32 v79, v174, v175
    v_cvt_pk_bf16_f32 v42, v132, v133
    v_cvt_pk_bf16_f32 v43, v134, v135
    ds_write_b128 v12, v[72:75] offset:2048
    ds_write_b128 v12, v[76:79] offset:3072
    v_pk_mul_f32 v[176:177], v[176:177], v[58:59] op_sel_hi:[1,0]
    v_pk_mul_f32 v[178:179], v[178:179], v[58:59] op_sel_hi:[1,0]
    v_pk_mul_f32 v[180:181], v[180:181], v[58:59] op_sel_hi:[1,0]
    v_pk_mul_f32 v[182:183], v[182:183], v[58:59] op_sel_hi:[1,0]
    v_pk_mul_f32 v[184:185], v[184:185], v[58:59] op_sel_hi:[1,0]
    v_pk_mul_f32 v[186:187], v[186:187], v[58:59] op_sel_hi:[1,0]
    v_pk_mul_f32 v[188:189], v[188:189], v[58:59] op_sel_hi:[1,0]
    v_pk_mul_f32 v[190:191], v[190:191], v[58:59] op_sel_hi:[1,0]
    v_pk_mul_f32 v[136:137], v[136:137], v[56:57] op_sel_hi:[1,0]
    v_pk_mul_f32 v[138:139], v[138:139], v[56:57] op_sel_hi:[1,0]
    v_cvt_pk_bf16_f32 v80, v176, v177
    v_cvt_pk_bf16_f32 v81, v178, v179
    v_cvt_pk_bf16_f32 v82, v180, v181
    v_cvt_pk_bf16_f32 v83, v182, v183
    v_cvt_pk_bf16_f32 v84, v184, v185
    v_cvt_pk_bf16_f32 v85, v186, v187
    v_cvt_pk_bf16_f32 v86, v188, v189
    v_cvt_pk_bf16_f32 v87, v190, v191
    v_cvt_pk_bf16_f32 v44, v136, v137
    v_cvt_pk_bf16_f32 v45, v138, v139
    ds_write_b128 v12, v[80:83] offset:4096
    ds_write_b128 v12, v[84:87] offset:5120
    v_pk_mul_f32 v[192:193], v[192:193], v[62:63] op_sel_hi:[1,0]
    v_pk_mul_f32 v[194:195], v[194:195], v[62:63] op_sel_hi:[1,0]
    v_pk_mul_f32 v[196:197], v[196:197], v[62:63] op_sel_hi:[1,0]
    v_pk_mul_f32 v[198:199], v[198:199], v[62:63] op_sel_hi:[1,0]
    v_pk_mul_f32 v[200:201], v[200:201], v[62:63] op_sel_hi:[1,0]
    v_pk_mul_f32 v[202:203], v[202:203], v[62:63] op_sel_hi:[1,0]
    v_pk_mul_f32 v[204:205], v[204:205], v[62:63] op_sel_hi:[1,0]
    v_pk_mul_f32 v[206:207], v[206:207], v[62:63] op_sel_hi:[1,0]
    v_pk_mul_f32 v[140:141], v[140:141], v[60:61] op_sel_hi:[1,0]
    v_pk_mul_f32 v[142:143], v[142:143], v[60:61] op_sel_hi:[1,0]
    v_cvt_pk_bf16_f32 v88, v192, v193
    v_cvt_pk_bf16_f32 v89, v194, v195
    v_cvt_pk_bf16_f32 v90, v196, v197
    v_cvt_pk_bf16_f32 v91, v198, v199
    v_cvt_pk_bf16_f32 v92, v200, v201
    v_cvt_pk_bf16_f32 v93, v202, v203
    v_cvt_pk_bf16_f32 v94, v204, v205
    v_cvt_pk_bf16_f32 v95, v206, v207
    v_cvt_pk_bf16_f32 v46, v140, v141
    v_cvt_pk_bf16_f32 v47, v142, v143
    ds_write_b128 v12, v[88:91] offset:6144
    ds_write_b128 v12, v[92:95] offset:7168
    s_nop 1
    ds_write_b128 v13, v[40:43] offset:32768
    ds_write_b128 v13, v[44:47] offset:33792
    s_waitcnt lgkmcnt(0)
    s_barrier
    s_cmp_lt_u32 s73, 3
    s_cbranch_scc1 bf4_go
    s_cmp_ge_u32 s10, 2
    s_cbranch_scc1 wk_loop
bf4_go:
    ds_read_b128 a[0:3], v11 offset:0
    ds_read_b128 a[4:7], v11 offset:1024
    ds_read_b128 a[8:11], v11 offset:2048
    ds_read_b128 a[12:15], v11 offset:3072
    ds_read_b128 a[16:19], v11 offset:4096
    ds_read_b128 a[20:23], v11 offset:5120
    ds_read_b128 a[24:27], v11 offset:6144
    ds_read_b128 a[28:31], v11 offset:7168
    ds_read_b128 a[32:35], v11 offset:8192
    ds_read_b128 a[36:39], v11 offset:9216
    ds_read_b128 a[40:43], v11 offset:10240
    ds_read_b128 a[44:47], v11 offset:11264
    ds_read_b128 a[48:51], v11 offset:12288
    ds_read_b128 a[52:55], v11 offset:13312
    ds_read_b128 a[56:59], v11 offset:14336
    ds_read_b128 a[60:63], v11 offset:15360
    ds_read_b128 a[64:67], v11 offset:16384
    ds_read_b128 a[68:71], v11 offset:17408
    ds_read_b128 a[72:75], v11 offset:18432
    ds_read_b128 a[76:79], v11 offset:19456
    ds_read_b128 a[80:83], v11 offset:20480
    ds_read_b128 a[84:87], v11 offset:21504
    ds_read_b128 a[88:91], v11 offset:22528
    ds_read_b128 a[92:95], v11 offset:23552
    ds_read_b128 a[96:99], v11 offset:24576
    ds_read_b128 a[100:103], v11 offset:25600
    ds_read_b128 a[104:107], v11 offset:26624
    ds_read_b128 a[108:111], v11 offset:27648
    ds_read_b128 v[64:67], v11 offset:28672
    ds_read_b128 v[68:71], v11 offset:29696
    ds_read_b128 v[72:75], v11 offset:30720
    ds_read_b128 v[76:79], v11 offset:31744
    ds_read_b128 v[80:83], v11 offset:32768
    ds_read_b128 v[84:87], v11 offset:33792
    ds_read_b128 v[88:91], v11 offset:34816
    ds_read_b128 v[92:95], v11 offset:35840
    ds_read_b128 v[96:99], v11 offset:36864
    ds_read_b128 v[100:103], v11 offset:37888
    ds_read_b128 v[104:107], v11 offset:38912
    ds_read_b128 v[108:111], v11 offset:39936
    s_waitcnt lgkmcnt(15)
    v_mfma_f32_32x32x16_bf16 v[176:191], a[112:115], a[0:3], 0
    v_mfma_f32_32x32x16_bf16 v[192:207], a[116:119], a[4:7], 0
    v_mfma_f32_32x32x16_bf16 v[176:191], a[120:123], a[8:11], v[176:191]
    v_mfma_f32_32x32x16_bf16 v[192:207], a[124:127], a[12:15], v[192:207]
    s_waitcnt lgkmcnt(15)
    v_mfma_f32_32x32x16_bf16 v[176:191], a[128:131], a[16:19], v[176:191]
    v_mfma_f32_32x32x16_bf16 v[192:207], a[132:135], a[20:23], v[192:207]
    v_mfma_f32_32x32x16_bf16 v[176:191], a[136:139], a[24:27], v[176:191]
    v_mfma_f32_32x32x16_bf16 v[192:207], a[140:143], a[28:31], v[192:207]
    s_waitcnt lgkmcnt(15)
    v_mfma_f32_32x32x16_bf16 v[176:191], a[144:147], a[32:35], v[176:191]
    v_mfma_f32_32x32x16_bf16 v[192:207], a[148:151], a[36:39], v[192:207]
    v_mfma_f32_32x32x16_bf16 v[176:191], a[152:155], a[40:43], v[176:191]
    v_mfma_f32_32x32x16_bf16 v[192:207], a[156:159], a[44:47], v[192:207]
    s_waitcnt lgkmcnt(15)
    v_mfma_f32_32x32x16_bf16 v[176:191], a[160:163], a[48:51], v[176:191]
    v_mfma_f32_32x32x16_bf16 v[192:207], a[164:167], a[52:55], v[192:207]
    v_mfma_f32_32x32x16_bf16 v[176:191], a[168:171], a[56:59], v[176:191]
    v_mfma_f32_32x32x16_bf16 v[192:207], a[172:175], a[60:63], v[192:207]
    s_waitcnt lgkmcnt(15)
    v_mfma_f32_32x32x16_bf16 v[176:191], a[176:179], a[64:67], v[176:191]
    v_mfma_f32_32x32x16_bf16 v[192:207], a[180:183], a[68:71], v[192:207]
    v_mfma_f32_32x32x16_bf16 v[176:191], a[184:187], a[72:75], v[176:191]
    v_mfma_f32_32x32x16_bf16 v[192:207], a[188:191], a[76:79], v[192:207]
    s_waitcnt lgkmcnt(15)
    v_mfma_f32_32x32x16_bf16 v[176:191], a[192:195], a[80:83], v[176:191]
    v_mfma_f32_32x32x16_bf16 v[192:207], a[196:199], a[84:87], v[192:207]
    v_mfma_f32_32x32x16_bf16 v[176:191], a[200:203], a[88:91], v[176:191]
    v_mfma_f32_32x32x16_bf16 v[192:207], a[204:207], a[92:95], v[192:207]
    s_waitcnt lgkmcnt(12)
    v_mfma_f32_32x32x16_bf16 v[176:191], a[208:211], a[96:99], v[176:191]
    v_mfma_f32_32x32x16_bf16 v[192:207], a[212:215], a[100:103], v[192:207]
    v_mfma_f32_32x32x16_bf16 v[176:191], a[216:219], a[104:107], v[176:191]
    v_mfma_f32_32x32x16_bf16 v[192:207], a[220:223], a[108:111], v[192:207]
    s_waitcnt lgkmcnt(8)
    v_mfma_f32_32x32x16_bf16 v[176:191], a[224:227], v[64:67], v[176:191]
    v_mfma_f32_32x32x16_bf16 v[192:207], a[228:231], v[68:71], v[192:207]
    v_mfma_f32_32x32x16_bf16 v[176:191], a[232:235], v[72:75], v[176:191]
    v_mfma_f32_32x32x16_bf16 v[192:207], a[236:239], v[76:79], v[192:207]
    s_waitcnt vmcnt(0) lgkmcnt(0)
bf4_uc:
    v_max_u32 v12, v212, v213
    v_max3_u32 v12, v12, v214, v215
    v_max3_u32 v12, v12, v216, v217
    v_max3_u32 v12, v12, v218, v219
    v_max3_u32 v12, v12, v220, v221
    v_max3_u32 v12, v12, v222, v223
    v_max3_u32 v12, v12, v224, v225
    v_max3_u32 v12, v12, v226, v227
    v_max3_u32 v12, v12, v228, v229
    v_max3_u32 v12, v12, v230, v231
    v_max3_u32 v12, v12, v232, v233
    v_max3_u32 v12, v12, v234, v235
    v_max3_u32 v12, v12, v236, v237
    v_max3_u32 v12, v12, v238, v239
    v_max3_u32 v12, v12, v240, v241
    v_max3_u32 v12, v12, v242, v243
    v_cmp_eq_u32 vcc, -1, v12
    s_cbranch_vccz bf4_uok
    s_add_u32 s74, s74, 1
    s_cmp_gt_u32 s74, 3000000
    s_cbranch_scc1 wk_done
    s_mov_b32 s39, 0
    buffer_load_dwordx2 v[212:213], v209, s[28:31], s39 offen sc1
    s_mov_b32 s39, 7168
    buffer_load_dwordx2 v[214:215], v209, s[28:31], s39 offen sc1
    s_mov_b32 s39, 14336
    buffer_load_dwordx2 v[216:217], v209, s[28:31], s39 offen sc1
    s_mov_b32 s39, 21504
    buffer_load_dwordx2 v[218:219], v209, s[28:31], s39 offen sc1
    s_mov_b32 s39, 28672
    buffer_load_dwordx2 v[220:221], v209, s[28:31], s39 offen sc1
    s_mov_b32 s39, 35840
    buffer_load_dwordx2 v[222:223], v209, s[28:31], s39 offen sc1
    s_mov_b32 s39, 43008
    buffer_load_dwordx2 v[224:225], v209, s[28:31], s39 offen sc1
    s_mov_b32 s39, 50176
    buffer_load_dwordx2 v[226:227], v209, s[28:31], s39 offen sc1
    s_mov_b32 s39, 57344
    buffer_load_dwordx2 v[228:229], v209, s[28:31], s39 offen sc1
    s_mov_b32 s39, 64512
    buffer_load_dwordx2 v[230:231], v209, s[28:31], s39 offen sc1
    s_mov_b32 s39, 71680
    buffer_load_dwordx2 v[232:233], v209, s[28:31], s39 offen sc1
    s_mov_b32 s39, 78848
    buffer_load_dwordx2 v[234:235], v209, s[28:31], s39 offen sc1
    s_mov_b32 s39, 86016
    buffer_load_dwordx2 v[236:237], v209, s[28:31], s39 offen sc1
    s_mov_b32 s39, 93184
    buffer_load_dwordx2 v[238:239], v209, s[28:31], s39 offen sc1
    s_mov_b32 s39, 100352
    buffer_load_dwordx2 v[240:241], v209, s[28:31], s39 offen sc1
    s_mov_b32 s39, 107520
    buffer_load_dwordx2 v[242:243], v209, s[28:31], s39 offen sc1
    s_waitcnt vmcnt(0)
    s_branch bf4_uc
bf4_uok:
    v_mfma_f32_32x32x16_bf16 v[176:191], v[212:215], v[80:83], v[176:191]
    v_mfma_f32_32x32x16_bf16 v[192:207], v[216:219], v[84:87], v[192:207]
    v_mfma_f32_32x32x16_bf16 v[176:191], v[220:223], v[88:91], v[176:191]
    v_mfma_f32_32x32x16_bf16 v[192:207], v[224:227], v[92:95], v[192:207]
    v_mfma_f32_32x32x16_bf16 v[176:191], v[228:231], v[96:99], v[176:191]
    v_mfma_f32_32x32x16_bf16 v[192:207], v[232:235], v[100:103], v[192:207]
    v_mfma_f32_32x32x16_bf16 v[176:191], v[236:239], v[104:107], v[176:191]
    v_mfma_f32_32x32x16_bf16 v[192:207], v[240:243], v[108:111], v[192:207]
    s_nop 15
    s_nop 1
    v_pk_add_f32 v[176:177], v[176:177], v[192:193]
    v_pk_add_f32 v[178:179], v[178:179], v[194:195]
    v_pk_add_f32 v[180:181], v[180:181], v[196:197]
    v_pk_add_f32 v[182:183], v[182:183], v[198:199]
    v_pk_add_f32 v[184:185], v[184:185], v[200:201]
    v_pk_add_f32 v[186:187], v[186:187], v[202:203]
    v_pk_add_f32 v[188:189], v[188:189], v[204:205]
    v_pk_add_f32 v[190:191], v[190:191], v[206:207]
    v_cvt_pk_bf16_f32 v16, v176, v177
    v_cvt_pk_bf16_f32 v17, v178, v179
    v_cvt_pk_bf16_f32 v18, v180, v181
    v_cvt_pk_bf16_f32 v19, v182, v183
    v_cvt_pk_bf16_f32 v20, v184, v185
    v_cvt_pk_bf16_f32 v21, v186, v187
    v_cvt_pk_bf16_f32 v22, v188, v189
    v_cvt_pk_bf16_f32 v23, v190, v191
    buffer_store_dwordx4 v[16:19], v210, s[32:35], 0 offen offset:0
    buffer_store_dwordx4 v[20:23], v210, s[32:35], 0 offen offset:32
    s_branch wk_loop
ch_entry:
    buffer_store_dwordx4 v[236:239], v234, s[72:75], 0 offen offset:0 sc1
    buffer_store_dwordx4 v[236:239], v234, s[72:75], 0 offen offset:1024 sc1
    s_waitcnt vmcnt(2)
    buffer_store_dwordx4 v[224:227], v232, s[68:71], 0 offen offset:0 sc1
    buffer_store_dwordx4 v[228:231], v232, s[68:71], 0 offen offset:1024 sc1
    buffer_store_dwordx4 v[240:243], v235, s[68:71], 0 offen offset:0 sc1
    v_mov_b32 v248, v240
    v_mov_b32 v249, v242
    v_mov_b32 v250, v241
    v_mov_b32 v251, v243
    buffer_store_dwordx4 v[244:247], v235, s[68:71], 0 offen offset:1024 sc1
    v_mov_b32 v252, v244
    v_mov_b32 v253, v246
    v_mov_b32 v254, v245
    v_mov_b32 v255, v247
    s_nop 1
    v_permlane32_swap_b32 v248, v250
    v_permlane32_swap_b32 v249, v251
    v_permlane32_swap_b32 v252, v254
    v_permlane32_swap_b32 v253, v255
    s_nop 1
    buffer_store_dwordx4 v[248:251], v235, s[68:71], s83 offen offset:0 sc1
    buffer_store_dwordx4 v[252:255], v235, s[68:71], s83 offen offset:1024 sc1
    s_lshr_b32 s2, s2, 3
    s_load_dwordx2 s[4:5], s[0:1], 104
    s_load_dwordx2 s[76:77], s[0:1], 96
    s_load_dwordx2 s[78:79], s[0:1], 40
    s_and_b32 s6, s2, 15
    v_lshrrev_b32 v1, 6, v0
    v_and_b32 v22, 63, v0
    s_nop 0
    v_readfirstlane_b32 s8, v1
    v_and_b32 v23, 15, v22
    v_lshrrev_b32 v24, 4, v22
    v_and_b32 v25, 7, v22
    v_lshlrev_b32 v3, 4, v22
    s_waitcnt lgkmcnt(0)
    s_add_u32 s20, s4, 0x5ac0000
    s_addc_u32 s21, s5, 0x0
    s_mov_b32 s22, 0x580000
    s_mov_b32 s23, 0x00020000
    s_add_u32 s24, s4, 0x2840000
    s_addc_u32 s25, s5, 0x0
    s_mov_b32 s26, 0x1c00000
    s_mov_b32 s27, 0x00020000
    s_add_u32 s28, s4, 0x53c4000
    s_addc_u32 s29, s5, 0x0
    s_mov_b32 s30, 0x70000
    s_mov_b32 s31, 0x00020000
    s_add_u32 s36, s4, 0x5240000
    s_addc_u32 s37, s5, 0x0
    s_mov_b32 s38, 0xe3800
    s_mov_b32 s39, 0x00020000
    s_add_u32 s40, s4, 0x5324000
    s_addc_u32 s41, s5, 0x0
    s_mov_b32 s42, 0xa0000
    s_mov_b32 s43, 0x00020000
    s_mov_b32 s80, s76
    s_mov_b32 s81, s77
    s_mov_b32 s82, 0x100
    s_mov_b32 s83, 0x00020000
    s_mov_b32 s84, s78
    s_mov_b32 s85, s79
    s_mov_b32 s86, 0x1c00
    s_mov_b32 s87, 0x00020000
    s_mov_b32 s52, 0
    s_add_u32 s101, s2, 1900
    s_add_u32 s72, s4, 0x543c000
    s_addc_u32 s73, s5, 0x0
    s_mov_b32 s74, 0x4000
    s_mov_b32 s75, 0x00020000
    v_mov_b32 v40, 0
    v_mov_b32 v41, 0
    v_mov_b32 v42, 0
    v_mov_b32 v43, 0
    v_lshlrev_b32 v9, 5, v0
    ds_write_b128 v9, v[40:43]
    ds_write_b128 v9, v[40:43] offset:16
    v_lshrrev_b32 v26, 3, v23
    v_mul_u32_u24 v26, 7, v26
    v_lshl_add_u32 v26, v24, 1, v26
    s_mul_i32 s12, s6, 14
    v_add_u32 v26, s12, v26
    v_mul_u32_u24 v27, 896, v25
    v_lshl_add_u32 v8, v26, 2, v27
    buffer_load_dwordx2 v[18:19], v8, s[84:87], 0 offen
    v_add_u32 v28, 0, v26
    v_lshrrev_b32 v29, 3, v28
    v_lshl_add_u32 v29, v29, 5, v27
    v_and_b32 v30, 1, v28
    v_bfe_u32 v31, v28, 1, 2
    v_lshl_add_u32 v31, v30, 2, v31
    v_lshl_add_u32 v11, v31, 2, v29
    v_bfe_u32 v31, v28, 2, 1
    v_lshl_add_u32 v31, v30, 1, v31
    v_bfe_u32 v30, v28, 1, 1
    v_lshl_add_u32 v31, v30, 2, v31
    v_lshl_add_u32 v13, v31, 2, v29
    v_add_u32 v13, 7168, v13
    v_add_u32 v28, 1, v26
    v_lshrrev_b32 v29, 3, v28
    v_lshl_add_u32 v29, v29, 5, v27
    v_and_b32 v30, 1, v28
    v_bfe_u32 v31, v28, 1, 2
    v_lshl_add_u32 v31, v30, 2, v31
    v_lshl_add_u32 v12, v31, 2, v29
    v_bfe_u32 v31, v28, 2, 1
    v_lshl_add_u32 v31, v30, 1, v31
    v_bfe_u32 v30, v28, 1, 1
    v_lshl_add_u32 v31, v30, 2, v31
    v_lshl_add_u32 v2, v31, 2, v29
    v_add_u32 v2, 7168, v2
    v_mov_b32 v28, 0x40000000
    v_cmp_eq_u32 vcc, 3, v24
    s_nop 1
    v_cndmask_b32 v12, v12, v28, vcc
    v_cndmask_b32 v2, v2, v28, vcc
    s_getreg_b32 s12, hwreg(HW_REG_XCC_ID, 0, 4)
    s_lshl_b32 s12, 1, s12
    v_mov_b32 v48, s12
    v_mov_b32 v49, 12
    v_cmp_eq_u32 vcc, 0, v0
    s_and_b64 exec, exec, vcc
    buffer_atomic_or v48, v49, s[80:83], 0 offen sc1
    s_mov_b64 exec, -1
    s_waitcnt vmcnt(0)
    s_barrier
    v_mov_b32 v36, 1
    v_mov_b32 v37, 8
    v_cmp_eq_u32 vcc, 0, v0
    s_and_b64 exec, exec, vcc
    buffer_atomic_add v36, v37, s[80:83], 0 offen sc1
    s_mov_b64 exec, -1
    v_mov_b32 v50, 124928
    s_cmp_eq_u32 s8, 0
    s_cbranch_scc0 ch_iw
    v_mov_b32 v37, 16
    s_mov_b32 s12, 0
wc_58:
    buffer_load_dword v36, v37, s[80:83], 0 offen sc1
    s_add_u32 s12, s12, 1
    s_cmp_gt_u32 s12, 3000000
    s_cbranch_scc1 ch_done
    s_waitcnt vmcnt(0)
    v_readfirstlane_b32 s13, v36
    s_nop 3
    s_cmp_ge_u32 s13, 224
    s_cbranch_scc1 wc_58_ok
    s_sleep 8
    s_branch wc_58
wc_58_ok:
ch_iw:
    s_barrier
    s_add_u32 s32, s4, 0x6660000
    s_addc_u32 s33, s5, 0x0
    s_mov_b32 s34, 0x1000
    s_mov_b32 s35, 0x00020000
    s_mov_b32 s76, s72
    s_mov_b32 s77, s73
    s_mov_b32 s78, s74
    s_mov_b32 s79, s75
    v_cmp_gt_u32 s[46:47], 56, v22
    v_mul_u32_u24 v1, 912, v25
    v_lshl_add_u32 v1, v24, 5, v1
    v_lshrrev_b32 v26, 3, v23
    v_lshl_add_u32 v1, v26, 4, v1
    v_mov_b32 v4, 0x4444
    v_mov_b32 v26, 0xeeee
    v_cmp_gt_u32 vcc, 8, v23
    s_nop 1
    v_cndmask_b32 v4, v26, v4, vcc
    v_and_b32 v26, 1, v24
    v_lshlrev_b32 v6, 3, v26
    v_lshrrev_b32 v26, 1, v24
    v_lshl_add_u32 v6, v26, 2, v6
    v_lshl_add_u32 v6, v23, 4, v6
    v_add_u32 v6, 8192, v6
    s_mul_i32 s12, s8, 1792
    v_add_u32 v15, s12, v3
    s_mul_i32 s12, s8, 1824
    v_add_u32 v14, s12, v3
    s_mov_b32 s53, 0
    s_mov_b32 s54, 0
    s_mov_b32 s55, 0
    s_mov_b32 s59, 14336
    s_cmp_ge_u32 s2, 16
    s_cbranch_scc1 ch_u
    s_add_u32 s16, s4, 0x6040000
    s_addc_u32 s17, s5, 0x0
    s_mov_b32 s18, 0x620000
    s_mov_b32 s19, 0x00020000
    s_mul_i32 s13, s6, 401408
    s_mul_i32 s12, s8, 100352
    s_add_u32 s13, s13, s12
    v_min_u32 v40, 6, v22
    s_mul_i32 s12, s6, 7
    v_add_u32 v40, s12, v40
    v_lshlrev_b32 v40, 2, v40
    v_mov_b32 v41, 0
    s_and_b32 s12, s8, 1
    s_cmp_eq_u32 s12, 1
    s_cbranch_scc1 qw_1
qw_0:
    s_add_u32 s88, s13, 0
    s_add_u32 s89, s13, 14336
    s_add_u32 s90, s13, 28672
    s_add_u32 s91, s13, 43008
    s_add_u32 s92, s13, 57344
    s_add_u32 s93, s13, 71680
    s_add_u32 s94, s13, 86016
    v_add_u32 v43, 4096, v3
    v_add_u32 v44, 8192, v3
    v_add_u32 v45, 12288, v3
    s_mov_b32 s62, 0
qw0_s0:
    buffer_load_dword v42, v40, s[32:35], 0 offen sc1
    s_add_u32 s62, s62, 1
    s_cmp_gt_u32 s62, 3000000
    s_cbranch_scc1 ch_done
    s_waitcnt vmcnt(0)
    v_sub_u32 v42, v42, v41
    v_cmp_gt_i32 vcc, 1, v42
    s_cbranch_vccz qw0_k0
    s_sleep 4
    s_branch qw0_s0
qw0_k0:
    buffer_load_dwordx4 a[0:3], v3, s[16:19], s88 offen offset:0
    buffer_load_dwordx4 a[4:7], v3, s[16:19], s88 offen offset:1024
    buffer_load_dwordx4 a[56:59], v3, s[16:19], s89 offen offset:0
    buffer_load_dwordx4 a[60:63], v3, s[16:19], s89 offen offset:1024
    buffer_load_dword v42, v40, s[32:35], 0 offen sc1
    buffer_load_dwordx4 a[120:123], v3, s[16:19], s90 offen offset:2048
    buffer_load_dwordx4 a[124:127], v3, s[16:19], s90 offen offset:3072
    buffer_load_dwordx4 a[176:179], v3, s[16:19], s91 offen offset:2048
    buffer_load_dwordx4 a[180:183], v3, s[16:19], s91 offen offset:3072
    buffer_load_dwordx4 v[104:107], v43, s[16:19], s92 offen offset:0
    buffer_load_dwordx4 v[108:111], v43, s[16:19], s92 offen offset:1024
    buffer_load_dwordx4 v[160:163], v43, s[16:19], s93 offen offset:0
    buffer_load_dwordx4 v[164:167], v43, s[16:19], s93 offen offset:1024
    buffer_load_dwordx4 v[224:227], v43, s[16:19], s94 offen offset:2048
    buffer_load_dwordx4 v[228:231], v43, s[16:19], s94 offen offset:3072
    s_waitcnt vmcnt(10)
    v_sub_u32 v42, v42, v41
    v_cmp_gt_i32 vcc, 2, v42
    s_cbranch_vccz qw0_k1
qw0_s1:
    buffer_load_dword v42, v40, s[32:35], 0 offen sc1
    s_add_u32 s62, s62, 1
    s_cmp_gt_u32 s62, 3000000
    s_cbranch_scc1 ch_done
    s_waitcnt vmcnt(0)
    v_sub_u32 v42, v42, v41
    v_cmp_gt_i32 vcc, 2, v42
    s_cbranch_vccz qw0_k1
    s_sleep 4
    s_branch qw0_s1
qw0_k1:
    buffer_load_dwordx4 a[48:51], v45, s[16:19], s88 offen offset:0
    buffer_load_dwordx4 a[52:55], v45, s[16:19], s88 offen offset:1024
    buffer_load_dwordx4 a[104:107], v45, s[16:19], s89 offen offset:0
    buffer_load_dwordx4 a[108:111], v45, s[16:19], s89 offen offset:1024
    buffer_load_dword v42, v40, s[32:35], 0 offen sc1
    buffer_load_dwordx4 a[112:115], v3, s[16:19], s90 offen offset:0
    buffer_load_dwordx4 a[116:119], v3, s[16:19], s90 offen offset:1024
    buffer_load_dwordx4 a[168:171], v3, s[16:19], s91 offen offset:0
    buffer_load_dwordx4 a[172:175], v3, s[16:19], s91 offen offset:1024
    buffer_load_dwordx4 v[96:99], v3, s[16:19], s92 offen offset:2048
    buffer_load_dwordx4 v[100:103], v3, s[16:19], s92 offen offset:3072
    buffer_load_dwordx4 v[152:155], v3, s[16:19], s93 offen offset:2048
    buffer_load_dwordx4 v[156:159], v3, s[16:19], s93 offen offset:3072
    buffer_load_dwordx4 v[216:219], v43, s[16:19], s94 offen offset:0
    buffer_load_dwordx4 v[220:223], v43, s[16:19], s94 offen offset:1024
    s_waitcnt vmcnt(10)
    v_sub_u32 v42, v42, v41
    v_cmp_gt_i32 vcc, 3, v42
    s_cbranch_vccz qw0_k2
qw0_s2:
    buffer_load_dword v42, v40, s[32:35], 0 offen sc1
    s_add_u32 s62, s62, 1
    s_cmp_gt_u32 s62, 3000000
    s_cbranch_scc1 ch_done
    s_waitcnt vmcnt(0)
    v_sub_u32 v42, v42, v41
    v_cmp_gt_i32 vcc, 3, v42
    s_cbranch_vccz qw0_k2
    s_sleep 4
    s_branch qw0_s2
qw0_k2:
    s_cmp_eq_u32 s8, 0
    s_cbranch_scc0 ai_59
    v_mov_b32 v37, 8
    s_mov_b32 s12, 0
wc_60:
    buffer_load_dwordx2 v[38:39], v37, s[80:83], 0 offen sc1
    s_add_u32 s12, s12, 1
    s_cmp_gt_u32 s12, 3000000
    s_cbranch_scc1 ch_done
    s_waitcnt vmcnt(0)
    v_readfirstlane_b32 s13, v38
    s_nop 3
    s_cmp_ge_u32 s13, 256
    s_cbranch_scc1 wc_60_ok
    s_sleep 8
    s_branch wc_60
wc_60_ok:
    ds_write_b32 v50, v39
ai_59:
    buffer_load_dwordx4 a[40:43], v44, s[16:19], s88 offen offset:2048
    buffer_load_dwordx4 a[44:47], v44, s[16:19], s88 offen offset:3072
    buffer_load_dwordx4 a[96:99], v44, s[16:19], s89 offen offset:2048
    buffer_load_dwordx4 a[100:103], v44, s[16:19], s89 offen offset:3072
    buffer_load_dword v42, v40, s[32:35], 0 offen sc1
    buffer_load_dwordx4 a[160:163], v45, s[16:19], s90 offen offset:0
    buffer_load_dwordx4 a[164:167], v45, s[16:19], s90 offen offset:1024
    buffer_load_dwordx4 a[216:219], v45, s[16:19], s91 offen offset:0
    buffer_load_dwordx4 a[220:223], v45, s[16:19], s91 offen offset:1024
    buffer_load_dwordx4 v[88:91], v3, s[16:19], s92 offen offset:0
    buffer_load_dwordx4 v[92:95], v3, s[16:19], s92 offen offset:1024
    buffer_load_dwordx4 v[144:147], v3, s[16:19], s93 offen offset:0
    buffer_load_dwordx4 v[148:151], v3, s[16:19], s93 offen offset:1024
    buffer_load_dwordx4 v[208:211], v3, s[16:19], s94 offen offset:2048
    buffer_load_dwordx4 v[212:215], v3, s[16:19], s94 offen offset:3072
    s_waitcnt vmcnt(10)
    v_sub_u32 v42, v42, v41
    v_cmp_gt_i32 vcc, 4, v42
    s_cbranch_vccz qw0_k3
qw0_s3:
    buffer_load_dword v42, v40, s[32:35], 0 offen sc1
    s_add_u32 s62, s62, 1
    s_cmp_gt_u32 s62, 3000000
    s_cbranch_scc1 ch_done
    s_waitcnt vmcnt(0)
    v_sub_u32 v42, v42, v41
    v_cmp_gt_i32 vcc, 4, v42
    s_cbranch_vccz qw0_k3
    s_sleep 4
    s_branch qw0_s3
qw0_k3:
    buffer_load_dwordx4 a[32:35], v44, s[16:19], s88 offen offset:0
    buffer_load_dwordx4 a[36:39], v44, s[16:19], s88 offen offset:1024
    buffer_load_dwordx4 a[88:91], v44, s[16:19], s89 offen offset:0
    buffer_load_dwordx4 a[92:95], v44, s[16:19], s89 offen offset:1024
    buffer_load_dword v42, v40, s[32:35], 0 offen sc1
    buffer_load_dwordx4 a[152:155], v44, s[16:19], s90 offen offset:2048
    buffer_load_dwordx4 a[156:159], v44, s[16:19], s90 offen offset:3072
    buffer_load_dwordx4 a[208:211], v44, s[16:19], s91 offen offset:2048
    buffer_load_dwordx4 a[212:215], v44, s[16:19], s91 offen offset:3072
    buffer_load_dwordx4 v[136:139], v45, s[16:19], s92 offen offset:0
    buffer_load_dwordx4 v[140:143], v45, s[16:19], s92 offen offset:1024
    buffer_load_dwordx4 v[192:195], v45, s[16:19], s93 offen offset:0
    buffer_load_dwordx4 v[196:199], v45, s[16:19], s93 offen offset:1024
    buffer_load_dwordx4 v[200:203], v3, s[16:19], s94 offen offset:0
    buffer_load_dwordx4 v[204:207], v3, s[16:19], s94 offen offset:1024
    s_waitcnt vmcnt(10)
    v_sub_u32 v42, v42, v41
    v_cmp_gt_i32 vcc, 5, v42
    s_cbranch_vccz qw0_k4
qw0_s4:
    buffer_load_dword v42, v40, s[32:35], 0 offen sc1
    s_add_u32 s62, s62, 1
    s_cmp_gt_u32 s62, 3000000
    s_cbranch_scc1 ch_done
    s_waitcnt vmcnt(0)
    v_sub_u32 v42, v42, v41
    v_cmp_gt_i32 vcc, 5, v42
    s_cbranch_vccz qw0_k4
    s_sleep 4
    s_branch qw0_s4
qw0_k4:
    buffer_load_dwordx4 a[24:27], v43, s[16:19], s88 offen offset:2048
    buffer_load_dwordx4 a[28:31], v43, s[16:19], s88 offen offset:3072
    buffer_load_dwordx4 a[80:83], v43, s[16:19], s89 offen offset:2048
    buffer_load_dwordx4 a[84:87], v43, s[16:19], s89 offen offset:3072
    buffer_load_dword v42, v40, s[32:35], 0 offen sc1
    buffer_load_dwordx4 a[144:147], v44, s[16:19], s90 offen offset:0
    buffer_load_dwordx4 a[148:151], v44, s[16:19], s90 offen offset:1024
    buffer_load_dwordx4 a[200:203], v44, s[16:19], s91 offen offset:0
    buffer_load_dwordx4 a[204:207], v44, s[16:19], s91 offen offset:1024
    buffer_load_dwordx4 v[128:131], v44, s[16:19], s92 offen offset:2048
    buffer_load_dwordx4 v[132:135], v44, s[16:19], s92 offen offset:3072
    buffer_load_dwordx4 v[184:187], v44, s[16:19], s93 offen offset:2048
    buffer_load_dwordx4 v[188:191], v44, s[16:19], s93 offen offset:3072
    buffer_load_dwordx4 v[248:251], v45, s[16:19], s94 offen offset:0
    buffer_load_dwordx4 v[252:255], v45, s[16:19], s94 offen offset:1024
    s_waitcnt vmcnt(10)
    v_sub_u32 v42, v42, v41
    v_cmp_gt_i32 vcc, 6, v42
    s_cbranch_vccz qw0_k5
qw0_s5:
    buffer_load_dword v42, v40, s[32:35], 0 offen sc1
    s_add_u32 s62, s62, 1
    s_cmp_gt_u32 s62, 3000000
    s_cbranch_scc1 ch_done
    s_waitcnt vmcnt(0)
    v_sub_u32 v42, v42, v41
    v_cmp_gt_i32 vcc, 6, v42
    s_cbranch_vccz qw0_k5
    s_sleep 4
    s_branch qw0_s5
qw0_k5:
    buffer_load_dwordx4 a[16:19], v43, s[16:19], s88 offen offset:0
    buffer_load_dwordx4 a[20:23], v43, s[16:19], s88 offen offset:1024
    buffer_load_dwordx4 a[72:75], v43, s[16:19], s89 offen offset:0
    buffer_load_dwordx4 a[76:79], v43, s[16:19], s89 offen offset:1024
    buffer_load_dword v42, v40, s[32:35], 0 offen sc1
    buffer_load_dwordx4 a[136:139], v43, s[16:19], s90 offen offset:2048
    buffer_load_dwordx4 a[140:143], v43, s[16:19], s90 offen offset:3072
    buffer_load_dwordx4 a[192:195], v43, s[16:19], s91 offen offset:2048
    buffer_load_dwordx4 a[196:199], v43, s[16:19], s91 offen offset:3072
    buffer_load_dwordx4 v[120:123], v44, s[16:19], s92 offen offset:0
    buffer_load_dwordx4 v[124:127], v44, s[16:19], s92 offen offset:1024
    buffer_load_dwordx4 v[176:179], v44, s[16:19], s93 offen offset:0
    buffer_load_dwordx4 v[180:183], v44, s[16:19], s93 offen offset:1024
    buffer_load_dwordx4 v[240:243], v44, s[16:19], s94 offen offset:2048
    buffer_load_dwordx4 v[244:247], v44, s[16:19], s94 offen offset:3072
    s_waitcnt vmcnt(10)
    v_sub_u32 v42, v42, v41
    v_cmp_gt_i32 vcc, 7, v42
    s_cbranch_vccz qw0_k6
qw0_s6:
    buffer_load_dword v42, v40, s[32:35], 0 offen sc1
    s_add_u32 s62, s62, 1
    s_cmp_gt_u32 s62, 3000000
    s_cbranch_scc1 ch_done
    s_waitcnt vmcnt(0)
    v_sub_u32 v42, v42, v41
    v_cmp_gt_i32 vcc, 7, v42
    s_cbranch_vccz qw0_k6
    s_sleep 4
    s_branch qw0_s6
qw0_k6:
    buffer_load_dwordx4 a[8:11], v3, s[16:19], s88 offen offset:2048
    buffer_load_dwordx4 a[12:15], v3, s[16:19], s88 offen offset:3072
    buffer_load_dwordx4 a[64:67], v3, s[16:19], s89 offen offset:2048
    buffer_load_dwordx4 a[68:71], v3, s[16:19], s89 offen offset:3072
    buffer_load_dwordx4 a[128:131], v43, s[16:19], s90 offen offset:0
    buffer_load_dwordx4 a[132:135], v43, s[16:19], s90 offen offset:1024
    buffer_load_dwordx4 a[184:187], v43, s[16:19], s91 offen offset:0
    buffer_load_dwordx4 a[188:191], v43, s[16:19], s91 offen offset:1024
    buffer_load_dwordx4 v[112:115], v43, s[16:19], s92 offen offset:2048
    buffer_load_dwordx4 v[116:119], v43, s[16:19], s92 offen offset:3072
    buffer_load_dwordx4 v[168:171], v43, s[16:19], s93 offen offset:2048
    buffer_load_dwordx4 v[172:175], v43, s[16:19], s93 offen offset:3072
    buffer_load_dwordx4 v[232:235], v44, s[16:19], s94 offen offset:0
    buffer_load_dwordx4 v[236:239], v44, s[16:19], s94 offen offset:1024
    s_branch qw_d
qw_1:
    s_add_u32 s88, s13, 0
    s_add_u32 s89, s13, 14336
    s_add_u32 s90, s13, 28672
    s_add_u32 s91, s13, 43008
    s_add_u32 s92, s13, 57344
    s_add_u32 s93, s13, 71680
    s_add_u32 s94, s13, 86016
    v_add_u32 v43, 4096, v3
    v_add_u32 v44, 8192, v3
    v_add_u32 v45, 12288, v3
    s_mov_b32 s62, 0
qw1_s0:
    buffer_load_dword v42, v40, s[32:35], 0 offen sc1
    s_add_u32 s62, s62, 1
    s_cmp_gt_u32 s62, 3000000
    s_cbranch_scc1 ch_done
    s_waitcnt vmcnt(0)
    v_sub_u32 v42, v42, v41
    v_cmp_gt_i32 vcc, 1, v42
    s_cbranch_vccz qw1_k0
    s_sleep 4
    s_branch qw1_s0
qw1_k0:
    buffer_load_dwordx4 a[24:27], v43, s[16:19], s88 offen offset:2048
    buffer_load_dwordx4 a[28:31], v43, s[16:19], s88 offen offset:3072
    buffer_load_dwordx4 a[88:91], v44, s[16:19], s89 offen offset:0
    buffer_load_dwordx4 a[92:95], v44, s[16:19], s89 offen offset:1024
    buffer_load_dword v42, v40, s[32:35], 0 offen sc1
    buffer_load_dwordx4 a[144:147], v44, s[16:19], s90 offen offset:0
    buffer_load_dwordx4 a[148:151], v44, s[16:19], s90 offen offset:1024
    buffer_load_dwordx4 a[208:211], v44, s[16:19], s91 offen offset:2048
    buffer_load_dwordx4 a[212:215], v44, s[16:19], s91 offen offset:3072
    buffer_load_dwordx4 v[128:131], v44, s[16:19], s92 offen offset:2048
    buffer_load_dwordx4 v[132:135], v44, s[16:19], s92 offen offset:3072
    buffer_load_dwordx4 v[192:195], v45, s[16:19], s93 offen offset:0
    buffer_load_dwordx4 v[196:199], v45, s[16:19], s93 offen offset:1024
    buffer_load_dwordx4 v[248:251], v45, s[16:19], s94 offen offset:0
    buffer_load_dwordx4 v[252:255], v45, s[16:19], s94 offen offset:1024
    s_waitcnt vmcnt(10)
    v_sub_u32 v42, v42, v41
    v_cmp_gt_i32 vcc, 2, v42
    s_cbranch_vccz qw1_k1
qw1_s1:
    buffer_load_dword v42, v40, s[32:35], 0 offen sc1
    s_add_u32 s62, s62, 1
    s_cmp_gt_u32 s62, 3000000
    s_cbranch_scc1 ch_done
    s_waitcnt vmcnt(0)
    v_sub_u32 v42, v42, v41
    v_cmp_gt_i32 vcc, 2, v42
    s_cbranch_vccz qw1_k1
    s_sleep 4
    s_branch qw1_s1
qw1_k1:
    buffer_load_dwordx4 a[16:19], v43, s[16:19], s88 offen offset:0
    buffer_load_dwordx4 a[20:23], v43, s[16:19], s88 offen offset:1024
    buffer_load_dwordx4 a[80:83], v43, s[16:19], s89 offen offset:2048
    buffer_load_dwordx4 a[84:87], v43, s[16:19], s89 offen offset:3072
    buffer_load_dword v42, v40, s[32:35], 0 offen sc1
    buffer_load_dwordx4 a[136:139], v43, s[16:19], s90 offen offset:2048
    buffer_load_dwordx4 a[140:143], v43, s[16:19], s90 offen offset:3072
    buffer_load_dwordx4 a[200:203], v44, s[16:19], s91 offen offset:0
    buffer_load_dwordx4 a[204:207], v44, s[16:19], s91 offen offset:1024
    buffer_load_dwordx4 v[120:123], v44, s[16:19], s92 offen offset:0
    buffer_load_dwordx4 v[124:127], v44, s[16:19], s92 offen offset:1024
    buffer_load_dwordx4 v[184:187], v44, s[16:19], s93 offen offset:2048
    buffer_load_dwordx4 v[188:191], v44, s[16:19], s93 offen offset:3072
    buffer_load_dwordx4 v[240:243], v44, s[16:19], s94 offen offset:2048
    buffer_load_dwordx4 v[244:247], v44, s[16:19], s94 offen offset:3072
    s_waitcnt vmcnt(10)
    v_sub_u32 v42, v42, v41
    v_cmp_gt_i32 vcc, 3, v42
    s_cbranch_vccz qw1_k2
qw1_s2:
    buffer_load_dword v42, v40, s[32:35], 0 offen sc1
    s_add_u32 s62, s62, 1
    s_cmp_gt_u32 s62, 3000000
    s_cbranch_scc1 ch_done
    s_waitcnt vmcnt(0)
    v_sub_u32 v42, v42, v41
    v_cmp_gt_i32 vcc, 3, v42
    s_cbranch_vccz qw1_k2
    s_sleep 4
    s_branch qw1_s2
qw1_k2:
    s_cmp_eq_u32 s8, 0
    s_cbranch_scc0 ai_61
    v_mov_b32 v37, 8
    s_mov_b32 s12, 0
wc_62:
    buffer_load_dwordx2 v[38:39], v37, s[80:83], 0 offen sc1
    s_add_u32 s12, s12, 1
    s_cmp_gt_u32 s12, 3000000
    s_cbranch_scc1 ch_done
    s_waitcnt vmcnt(0)
    v_readfirstlane_b32 s13, v38
    s_nop 3
    s_cmp_ge_u32 s13, 256
    s_cbranch_scc1 wc_62_ok
    s_sleep 8
    s_branch wc_62
wc_62_ok:
    ds_write_b32 v50, v39
ai_61:
    buffer_load_dwordx4 a[8:11], v3, s[16:19], s88 offen offset:2048
    buffer_load_dwordx4 a[12:15], v3, s[16:19], s88 offen offset:3072
    buffer_load_dwordx4 a[72:75], v43, s[16:19], s89 offen offset:0
    buffer_load_dwordx4 a[76:79], v43, s[16:19], s89 offen offset:1024
    buffer_load_dword v42, v40, s[32:35], 0 offen sc1
    buffer_load_dwordx4 a[128:131], v43, s[16:19], s90 offen offset:0
    buffer_load_dwordx4 a[132:135], v43, s[16:19], s90 offen offset:1024
    buffer_load_dwordx4 a[192:195], v43, s[16:19], s91 offen offset:2048
    buffer_load_dwordx4 a[196:199], v43, s[16:19], s91 offen offset:3072
    buffer_load_dwordx4 v[112:115], v43, s[16:19], s92 offen offset:2048
    buffer_load_dwordx4 v[116:119], v43, s[16:19], s92 offen offset:3072
    buffer_load_dwordx4 v[176:179], v44, s[16:19], s93 offen offset:0
    buffer_load_dwordx4 v[180:183], v44, s[16:19], s93 offen offset:1024
    buffer_load_dwordx4 v[232:235], v44, s[16:19], s94 offen offset:0
    buffer_load_dwordx4 v[236:239], v44, s[16:19], s94 offen offset:1024
    s_waitcnt vmcnt(10)
    v_sub_u32 v42, v42, v41
    v_cmp_gt_i32 vcc, 4, v42
    s_cbranch_vccz qw1_k3
qw1_s3:
    buffer_load_dword v42, v40, s[32:35], 0 offen sc1
    s_add_u32 s62, s62, 1
    s_cmp_gt_u32 s62, 3000000
    s_cbranch_scc1 ch_done
    s_waitcnt vmcnt(0)
    v_sub_u32 v42, v42, v41
    v_cmp_gt_i32 vcc, 4, v42
    s_cbranch_vccz qw1_k3
    s_sleep 4
    s_branch qw1_s3
qw1_k3:
    buffer_load_dwordx4 a[0:3], v3, s[16:19], s88 offen offset:0
    buffer_load_dwordx4 a[4:7], v3, s[16:19], s88 offen offset:1024
    buffer_load_dwordx4 a[64:67], v3, s[16:19], s89 offen offset:2048
    buffer_load_dwordx4 a[68:71], v3, s[16:19], s89 offen offset:3072
    buffer_load_dword v42, v40, s[32:35], 0 offen sc1
    buffer_load_dwordx4 a[120:123], v3, s[16:19], s90 offen offset:2048
    buffer_load_dwordx4 a[124:127], v3, s[16:19], s90 offen offset:3072
    buffer_load_dwordx4 a[184:187], v43, s[16:19], s91 offen offset:0
    buffer_load_dwordx4 a[188:191], v43, s[16:19], s91 offen offset:1024
    buffer_load_dwordx4 v[104:107], v43, s[16:19], s92 offen offset:0
    buffer_load_dwordx4 v[108:111], v43, s[16:19], s92 offen offset:1024
    buffer_load_dwordx4 v[168:171], v43, s[16:19], s93 offen offset:2048
    buffer_load_dwordx4 v[172:175], v43, s[16:19], s93 offen offset:3072
    buffer_load_dwordx4 v[224:227], v43, s[16:19], s94 offen offset:2048
    buffer_load_dwordx4 v[228:231], v43, s[16:19], s94 offen offset:3072
    s_waitcnt vmcnt(10)
    v_sub_u32 v42, v42, v41
    v_cmp_gt_i32 vcc, 5, v42
    s_cbranch_vccz qw1_k4
qw1_s4:
    buffer_load_dword v42, v40, s[32:35], 0 offen sc1
    s_add_u32 s62, s62, 1
    s_cmp_gt_u32 s62, 3000000
    s_cbranch_scc1 ch_done
    s_waitcnt vmcnt(0)
    v_sub_u32 v42, v42, v41
    v_cmp_gt_i32 vcc, 5, v42
    s_cbranch_vccz qw1_k4
    s_sleep 4
    s_branch qw1_s4
qw1_k4:
    buffer_load_dwordx4 a[48:51], v45, s[16:19], s88 offen offset:0
    buffer_load_dwordx4 a[52:55], v45, s[16:19], s88 offen offset:1024
    buffer_load_dwordx4 a[56:59], v3, s[16:19], s89 offen offset:0
    buffer_load_dwordx4 a[60:63], v3, s[16:19], s89 offen offset:1024
    buffer_load_dword v42, v40, s[32:35], 0 offen sc1
    buffer_load_dwordx4 a[112:115], v3, s[16:19], s90 offen offset:0
    buffer_load_dwordx4 a[116:119], v3, s[16:19], s90 offen offset:1024
    buffer_load_dwordx4 a[176:179], v3, s[16:19], s91 offen offset:2048
    buffer_load_dwordx4 a[180:183], v3, s[16:19], s91 offen offset:3072
    buffer_load_dwordx4 v[96:99], v3, s[16:19], s92 offen offset:2048
    buffer_load_dwordx4 v[100:103], v3, s[16:19], s92 offen offset:3072
    buffer_load_dwordx4 v[160:163], v43, s[16:19], s93 offen offset:0
    buffer_load_dwordx4 v[164:167], v43, s[16:19], s93 offen offset:1024
    buffer_load_dwordx4 v[216:219], v43, s[16:19], s94 offen offset:0
    buffer_load_dwordx4 v[220:223], v43, s[16:19], s94 offen offset:1024
    s_waitcnt vmcnt(10)
    v_sub_u32 v42, v42, v41
    v_cmp_gt_i32 vcc, 6, v42
    s_cbranch_vccz qw1_k5
qw1_s5:
    buffer_load_dword v42, v40, s[32:35], 0 offen sc1
    s_add_u32 s62, s62, 1
    s_cmp_gt_u32 s62, 3000000
    s_cbranch_scc1 ch_done
    s_waitcnt vmcnt(0)
    v_sub_u32 v42, v42, v41
    v_cmp_gt_i32 vcc, 6, v42
    s_cbranch_vccz qw1_k5
    s_sleep 4
    s_branch qw1_s5
qw1_k5:
    buffer_load_dwordx4 a[40:43], v44, s[16:19], s88 offen offset:2048
    buffer_load_dwordx4 a[44:47], v44, s[16:19], s88 offen offset:3072
    buffer_load_dwordx4 a[104:107], v45, s[16:19], s89 offen offset:0
    buffer_load_dwordx4 a[108:111], v45, s[16:19], s89 offen offset:1024
    buffer_load_dword v42, v40, s[32:35], 0 offen sc1
    buffer_load_dwordx4 a[160:163], v45, s[16:19], s90 offen offset:0
    buffer_load_dwordx4 a[164:167], v45, s[16:19], s90 offen offset:1024
    buffer_load_dwordx4 a[168:171], v3, s[16:19], s91 offen offset:0
    buffer_load_dwordx4 a[172:175], v3, s[16:19], s91 offen offset:1024
    buffer_load_dwordx4 v[88:91], v3, s[16:19], s92 offen offset:0
    buffer_load_dwordx4 v[92:95], v3, s[16:19], s92 offen offset:1024
    buffer_load_dwordx4 v[152:155], v3, s[16:19], s93 offen offset:2048
    buffer_load_dwordx4 v[156:159], v3, s[16:19], s93 offen offset:3072
    buffer_load_dwordx4 v[208:211], v3, s[16:19], s94 offen offset:2048
    buffer_load_dwordx4 v[212:215], v3, s[16:19], s94 offen offset:3072
    s_waitcnt vmcnt(10)
    v_sub_u32 v42, v42, v41
    v_cmp_gt_i32 vcc, 7, v42
    s_cbranch_vccz qw1_k6
qw1_s6:
    buffer_load_dword v42, v40, s[32:35], 0 offen sc1
    s_add_u32 s62, s62, 1
    s_cmp_gt_u32 s62, 3000000
    s_cbranch_scc1 ch_done
    s_waitcnt vmcnt(0)
    v_sub_u32 v42, v42, v41
    v_cmp_gt_i32 vcc, 7, v42
    s_cbranch_vccz qw1_k6
    s_sleep 4
    s_branch qw1_s6
qw1_k6:
    buffer_load_dwordx4 a[32:35], v44, s[16:19], s88 offen offset:0
    buffer_load_dwordx4 a[36:39], v44, s[16:19], s88 offen offset:1024
    buffer_load_dwordx4 a[96:99], v44, s[16:19], s89 offen offset:2048
    buffer_load_dwordx4 a[100:103], v44, s[16:19], s89 offen offset:3072
    buffer_load_dwordx4 a[152:155], v44, s[16:19], s90 offen offset:2048
    buffer_load_dwordx4 a[156:159], v44, s[16:19], s90 offen offset:3072
    buffer_load_dwordx4 a[216:219], v45, s[16:19], s91 offen offset:0
    buffer_load_dwordx4 a[220:223], v45, s[16:19], s91 offen offset:1024
    buffer_load_dwordx4 v[136:139], v45, s[16:19], s92 offen offset:0
    buffer_load_dwordx4 v[140:143], v45, s[16:19], s92 offen offset:1024
    buffer_load_dwordx4 v[144:147], v3, s[16:19], s93 offen offset:0
    buffer_load_dwordx4 v[148:151], v3, s[16:19], s93 offen offset:1024
    buffer_load_dwordx4 v[200:203], v3, s[16:19], s94 offen offset:0
    buffer_load_dwordx4 v[204:207], v3, s[16:19], s94 offen offset:1024
    s_branch qw_d
qw_d:
    s_waitcnt lgkmcnt(0)
    s_barrier
    ds_read_b32 v48, v50
    s_waitcnt lgkmcnt(0)
    v_readfirstlane_b32 s12, v48
    s_nop 3
    s_bcnt1_i32_b32 s12, s12
    s_cmp_eq_u32 s12, 1
    s_cselect_b32 s63, 1, 0
    v_add_u32 v15, 7168, v15
    v_and_b32 v26, 1, v24
    v_lshrrev_b32 v27, 1, v24
    v_mul_u32_u24 v2, 912, v25
    v_lshl_add_u32 v2, v26, 6, v2
    v_lshl_add_u32 v2, v27, 4, v2
    s_mul_i32 s12, s8, 224
    v_add_u32 v2, s12, v2
    v_lshl_add_u32 v28, v26, 1, v27
    v_mul_u32_u24 v28, 1360, v28
    s_lshl_b32 s12, s8, 2
    s_add_u32 s12, s12, 16384
    v_add_u32 v28, s12, v28
    v_and_b32 v29, 3, v23
    v_mul_u32_u24 v29, 272, v29
    v_add_u32 v5, v28, v29
    v_lshrrev_b32 v29, 2, v23
    v_lshl_add_u32 v5, v29, 5, v5
    v_lshl_add_u32 v7, v23, 5, v28
    v_add_u32 v7, 1088, v7
    v_lshlrev_b32 v29, 2, v22
    v_add_u32 v29, 22528, v29
    v_cmp_gt_u32 vcc, 8, v23
    s_nop 1
    v_cndmask_b32 v7, v29, v7, vcc
    v_lshrrev_b32 v28, 3, v22
    v_lshrrev_b32 v29, 4, v22
    v_mul_u32_u24 v8, 1360, v29
    v_lshl_add_u32 v8, v25, 5, v8
    v_and_b32 v29, 1, v28
    v_lshl_add_u32 v8, v29, 4, v8
    v_add_u32 v8, 16384, v8
    v_lshrrev_b32 v29, 1, v25
    v_lshlrev_b32 v9, 7, v29
    v_lshl_add_u32 v9, v28, 4, v9
    v_and_b32 v30, 1, v25
    v_lshl_add_u32 v9, v30, 3, v9
    s_lshl_b32 s12, s6, 9
    v_add_u32 v9, s12, v9
    v_lshlrev_b32 v10, 4, v28
    v_lshl_add_u32 v10, v29, 2, v10
    s_lshl_b32 s12, s6, 7
    s_add_u32 s12, s12, 8192
    v_add_u32 v10, s12, v10
    v_mov_b32 v29, 0x40000000
    v_cmp_eq_u32 vcc, 1, v30
    s_nop 1
    v_cndmask_b32 v10, v10, v29, vcc
    v_lshlrev_b32 v11, 7, v23
    s_lshl_b32 s12, s6, 11
    v_add_u32 v11, s12, v11
    v_min_u32 v12, 4, v22
    v_lshlrev_b32 v12, 7, v12
    s_mul_i32 s12, s6, 640
    v_add_u32 v12, s12, v12
    v_bfe_u32 v27, v23, 2, 1
    v_lshrrev_b32 v28, 3, v23
    v_and_b32 v29, 3, v23
    v_lshl_add_u32 v28, v28, 2, v29
    v_mov_b32 v29, 64
    v_cmp_eq_u32 vcc, v26, v27
    s_nop 1
    v_cndmask_b32 v28, v29, v28, vcc
    v_mov_b32 v26, 0x3f80
    v_mov_b32 v27, 0x3f800000
    v_mov_b32 v29, 0
    v_cmp_eq_u32 vcc, 0, v28
    s_nop 1
    v_cndmask_b32 v16, v29, v26, vcc
    v_cmp_eq_u32 vcc, 1, v28
    s_nop 1
    v_cndmask_b32 v16, v16, v27, vcc
    v_cmp_eq_u32 vcc, 2, v28
    s_nop 1
    v_cndmask_b32 v17, v29, v26, vcc
    v_cmp_eq_u32 vcc, 3, v28
    s_nop 1
    v_cndmask_b32 v17, v17, v27, vcc
    v_cmp_eq_u32 vcc, 4, v28
    s_nop 1
    v_cndmask_b32 v18, v29, v26, vcc
    v_cmp_eq_u32 vcc, 5, v28
    s_nop 1
    v_cndmask_b32 v18, v18, v27, vcc
    v_cmp_eq_u32 vcc, 6, v28
    s_nop 1
    v_cndmask_b32 v19, v29, v26, vcc
    v_cmp_eq_u32 vcc, 7, v28
    s_nop 1
    v_cndmask_b32 v19, v19, v27, vcc
    s_mov_b32 s60, 0x3db8aa3b
    s_lshl_b32 s56, s8, 13
    s_add_u32 s56, s56, 3670016
    s_add_u32 s57, s56, 4096
    s_mov_b32 s58, 3702784
    s_mul_i32 s12, s6, 28672
    s_sub_u32 s13, s8, 1
    s_mul_i32 s14, s13, 7168
    s_add_u32 s12, s12, s14
    s_cmp_lt_u32 s13, 2
    s_cselect_b32 s12, s12, 0x40000000
    v_lshlrev_b32 v6, 7, v22
    v_add_u32 v6, s12, v6
    v_mov_b32 v29, 0x40000000
    v_cndmask_b32_e64 v6, v29, v6, s[46:47]
    s_mov_b32 s61, 458752
    s_mul_i32 s12, s6, 448
    s_mul_i32 s14, s6, 448
    s_cmp_eq_u32 s8, 2
    s_cselect_b32 s48, 0xfffffff, 0
    s_mov_b32 s49, 0
    s_mov_b32 s12, 64
    s_cmp_eq_u32 s8, 3
    s_cbranch_scc0 ch_proq_ng
    s_lshl_b32 s12, s12, 7
    s_add_u32 s12, s12, 4096
    v_and_b32 v28, 63, v0
    v_lshlrev_b32 v28, 4, v28
    v_add_u32 v28, s12, v28
    s_mov_b32 s62, 0
    v_mov_b32 v20, 0
    v_mov_b32 v21, 0
    v_mov_b32 v22, 0
    v_mov_b32 v23, 0
    v_mov_b32 v24, 0
    v_mov_b32 v25, 0
    v_mov_b32 v26, 0
    v_mov_b32 v27, 0
fw_63:
    s_mov_b32 exec_lo, 0xffffffff
    s_mov_b32 exec_hi, 0xffffff
    buffer_load_dwordx4 v[20:23], v28, s[76:79], 0 offen sc1
    s_mov_b64 exec, -1
    s_add_u32 s62, s62, 1
    s_cmp_gt_u32 s62, 3000000
    s_cbranch_scc1 ch_done
    s_waitcnt vmcnt(0)
    v_max3_u32 v20, v20, v21, v22
    v_max3_u32 v24, v24, v25, v26
    v_max3_u32 v20, v20, v23, v27
    v_max_u32 v20, v20, v24
    v_cmp_eq_u32 vcc, -1, v20
    s_cbranch_vccz fw_63_ok
    s_sleep 1
    s_branch fw_63
fw_63_ok:
ch_proq_ng:
    buffer_load_dwordx4 a[224:227], v3, s[20:23], s56 offen offset:0 sc1
    s_sleep 1
    buffer_load_dwordx4 a[228:231], v3, s[20:23], s56 offen offset:1024 sc1
    s_sleep 1
    buffer_load_dwordx4 a[232:235], v3, s[20:23], s56 offen offset:2048 sc1
    s_sleep 1
    buffer_load_dwordx4 a[236:239], v3, s[20:23], s56 offen offset:3072 sc1
    s_sleep 1
    buffer_load_dwordx4 a[240:243], v3, s[20:23], s57 offen offset:0 sc1
    s_sleep 1
    buffer_load_dwordx4 a[244:247], v3, s[20:23], s57 offen offset:1024 sc1
    s_sleep 1
    buffer_load_dwordx4 a[248:251], v3, s[20:23], s57 offen offset:2048 sc1
    s_sleep 1
    buffer_load_dwordx4 a[252:255], v3, s[20:23], s57 offen offset:3072 sc1
    s_add_u32 s56, s56, 32768
    s_add_u32 s57, s57, 32768
    buffer_load_dword v13, v11, s[20:23], s58 offen sc1
    s_add_u32 s58, s58, 32768
    s_waitcnt vmcnt(0)
    s_cmp_eq_u32 s8, 0
    s_cbranch_scc0 ch_q1
ch_q0:
    v_mov_b32 v48, 0
    v_mov_b32 v49, 0
    v_mov_b32 v50, 0
    v_mov_b32 v51, 0
    v_mov_b32 v52, 0
    v_mov_b32 v53, 0
    v_mov_b32 v54, 0
    v_mov_b32 v55, 0
    v_mov_b32 v56, 0
    v_mov_b32 v57, 0
    v_mov_b32 v58, 0
    v_mov_b32 v59, 0
    v_mov_b32 v60, 0
    v_mov_b32 v61, 0
    v_mov_b32 v62, 0
    v_mov_b32 v63, 0
    v_mov_b32 v72, 0
    v_mov_b32 v73, 0
    v_mov_b32 v74, 0
    v_mov_b32 v75, 0
    v_mov_b32 v76, 0
    v_mov_b32 v77, 0
    v_mov_b32 v78, 0
    v_mov_b32 v79, 0
    v_mov_b32 v80, 0
    v_mov_b32 v81, 0
    v_mov_b32 v82, 0
    v_mov_b32 v83, 0
    s_mov_b32 s62, 0
    s_sleep 4
    s_mov_b64 exec, s[46:47]
ch_q0_pm:
    buffer_load_dwordx4 v[20:23], v15, s[36:39], s53 offen offset:0 sc1
    buffer_load_dwordx4 v[24:27], v15, s[36:39], s53 offen offset:896 sc1
    s_add_u32 s62, s62, 1
    s_cmp_gt_u32 s62, 200000
    s_cbranch_scc1 ch_done
    s_waitcnt vmcnt(0)
    v_max3_u32 v36, v20, v21, v22
    v_max3_u32 v37, v23, v24, v25
    v_max3_u32 v36, v36, v26, v27
    v_max_u32 v36, v36, v37
    v_cmp_eq_u32 vcc, -1, v36
    s_cbranch_vccnz ch_q0_pm
    ds_write_b128 v14, v[20:23] offset:0
    ds_write_b128 v14, v[24:27] offset:912
    s_mov_b64 exec, -1
    s_waitcnt lgkmcnt(0)
    s_barrier
    ds_read_b128 v[20:23], v1 offset:0
    ds_read_b128 v[24:27], v1 offset:128
    ds_read_b128 v[28:31], v1 offset:256
    ds_read_b128 v[32:35], v1 offset:384
    ds_read_b128 v[36:39], v1 offset:512
    ds_read_b128 v[40:43], v1 offset:640
    ds_read_b128 v[44:47], v1 offset:768
    s_waitcnt lgkmcnt(6)
    v_smfmac_f32_16x16x64_bf16 v[80:83], v[20:23], v[200:207], v4
    v_smfmac_f32_16x16x64_bf16 v[48:51], v[20:23], a[0:7], v4
    v_smfmac_f32_16x16x64_bf16 v[52:55], v[20:23], a[56:63], v4
    s_waitcnt lgkmcnt(5)
    v_smfmac_f32_16x16x64_bf16 v[80:83], v[24:27], v[208:215], v4
    v_smfmac_f32_16x16x64_bf16 v[48:51], v[24:27], a[8:15], v4
    v_smfmac_f32_16x16x64_bf16 v[52:55], v[24:27], a[64:71], v4
    s_waitcnt lgkmcnt(4)
    v_smfmac_f32_16x16x64_bf16 v[80:83], v[28:31], v[216:223], v4
    v_smfmac_f32_16x16x64_bf16 v[48:51], v[28:31], a[16:23], v4
    v_smfmac_f32_16x16x64_bf16 v[52:55], v[28:31], a[72:79], v4
    s_waitcnt lgkmcnt(3)
    v_smfmac_f32_16x16x64_bf16 v[80:83], v[32:35], v[224:231], v4
    v_smfmac_f32_16x16x64_bf16 v[48:51], v[32:35], a[24:31], v4
    v_smfmac_f32_16x16x64_bf16 v[52:55], v[32:35], a[80:87], v4
    s_waitcnt lgkmcnt(2)
    v_smfmac_f32_16x16x64_bf16 v[80:83], v[36:39], v[232:239], v4
    v_smfmac_f32_16x16x64_bf16 v[48:51], v[36:39], a[32:39], v4
    v_smfmac_f32_16x16x64_bf16 v[52:55], v[36:39], a[88:95], v4
    s_waitcnt lgkmcnt(1)
    v_smfmac_f32_16x16x64_bf16 v[80:83], v[40:43], v[240:247], v4
    v_smfmac_f32_16x16x64_bf16 v[48:51], v[40:43], a[40:47], v4
    v_smfmac_f32_16x16x64_bf16 v[52:55], v[40:43], a[96:103], v4
    s_waitcnt lgkmcnt(0)
    v_smfmac_f32_16x16x64_bf16 v[80:83], v[44:47], v[248:255], v4
    v_smfmac_f32_16x16x64_bf16 v[48:51], v[44:47], a[48:55], v4
    v_smfmac_f32_16x16x64_bf16 v[52:55], v[44:47], a[104:111], v4
    v_smfmac_f32_16x16x64_bf16 v[56:59], v[20:23], a[112:119], v4
    v_cvt_pk_bf16_f32 v80, v80, v81
    v_smfmac_f32_16x16x64_bf16 v[60:63], v[20:23], a[168:175], v4
    v_cvt_pk_bf16_f32 v81, v82, v83
    v_smfmac_f32_16x16x64_bf16 v[56:59], v[24:27], a[120:127], v4
    v_cvt_pk_bf16_f32 v48, v48, v49
    v_smfmac_f32_16x16x64_bf16 v[60:63], v[24:27], a[176:183], v4
    v_mfma_f32_16x16x16_bf16 v[84:87], v[80:81], v[16:17], 0
    v_cvt_pk_bf16_f32 v49, v50, v51
    v_cvt_pk_bf16_f32 v50, v52, v53
    v_smfmac_f32_16x16x64_bf16 v[56:59], v[28:31], a[128:135], v4
    v_cvt_pk_bf16_f32 v51, v54, v55
    v_smfmac_f32_16x16x64_bf16 v[60:63], v[28:31], a[184:191], v4
    v_smfmac_f32_16x16x64_bf16 v[56:59], v[32:35], a[136:143], v4
    v_mfma_f32_16x16x32_bf16 v[52:55], v[48:51], v[16:19], 0
    v_cvt_pk_bf16_f32 v70, v84, v85
    v_cvt_pk_bf16_f32 v71, v86, v87
    v_smfmac_f32_16x16x64_bf16 v[60:63], v[32:35], a[192:199], v4
    ds_read2_b32 v[80:81], v2 offset0:0 offset1:8
    v_smfmac_f32_16x16x64_bf16 v[56:59], v[36:39], a[144:151], v4
    ds_read2_b32 v[82:83], v2 offset0:2 offset1:10
    v_mov_b32 v48, 0
    v_smfmac_f32_16x16x64_bf16 v[60:63], v[36:39], a[200:207], v4
    v_cvt_pk_bf16_f32 v64, v52, v53
    v_smfmac_f32_16x16x64_bf16 v[56:59], v[40:43], a[152:159], v4
    v_cvt_pk_bf16_f32 v65, v54, v55
    v_smfmac_f32_16x16x64_bf16 v[60:63], v[40:43], a[208:215], v4
    ds_read2_b32 v[84:85], v2 offset0:1 offset1:9
    v_smfmac_f32_16x16x64_bf16 v[56:59], v[44:47], a[160:167], v4
    ds_read2_b32 v[86:87], v2 offset0:3 offset1:11
    v_mov_b32 v49, 0
    v_smfmac_f32_16x16x64_bf16 v[60:63], v[44:47], a[216:223], v4
    v_mov_b32 v50, 0
    v_smfmac_f32_16x16x64_bf16 v[72:75], v[20:23], v[88:95], v4
    v_mov_b32 v51, 0
    v_smfmac_f32_16x16x64_bf16 v[72:75], v[24:27], v[96:103], v4
    v_mov_b32 v52, 0
    v_smfmac_f32_16x16x64_bf16 v[72:75], v[28:31], v[104:111], v4
    v_cvt_pk_bf16_f32 v56, v56, v57
    v_smfmac_f32_16x16x64_bf16 v[72:75], v[32:35], v[112:119], v4
    v_cvt_pk_bf16_f32 v57, v58, v59
    v_smfmac_f32_16x16x64_bf16 v[72:75], v[36:39], v[120:127], v4
    v_cvt_pk_bf16_f32 v58, v60, v61
    v_smfmac_f32_16x16x64_bf16 v[72:75], v[40:43], v[128:135], v4
    v_cvt_pk_bf16_f32 v59, v62, v63
    v_smfmac_f32_16x16x64_bf16 v[72:75], v[44:47], v[136:143], v4
    v_mfma_f32_16x16x32_bf16 v[60:63], v[56:59], v[16:19], 0
    v_mov_b32 v53, 0
    v_mov_b32 v54, 0
    v_smfmac_f32_16x16x64_bf16 v[76:79], v[20:23], v[144:151], v4
    v_mov_b32 v55, 0
    v_smfmac_f32_16x16x64_bf16 v[76:79], v[24:27], v[152:159], v4
    v_mov_b32 v56, 0
    v_smfmac_f32_16x16x64_bf16 v[76:79], v[28:31], v[160:167], v4
    v_cvt_pk_bf16_f32 v66, v60, v61
    v_smfmac_f32_16x16x64_bf16 v[76:79], v[32:35], v[168:175], v4
    v_cvt_pk_bf16_f32 v67, v62, v63
    v_cvt_pk_bf16_f32 v72, v72, v73
    s_waitcnt lgkmcnt(0)
    v_smfmac_f32_16x16x64_bf16 v[76:79], v[36:39], v[176:183], v4
    v_smfmac_f32_16x16x64_bf16 v[48:51], v[64:67], v[80:87], v4
    v_cvt_pk_bf16_f32 v73, v74, v75
    v_smfmac_f32_16x16x64_bf16 v[76:79], v[40:43], v[184:191], v4
    v_mov_b32 v57, 0
    ds_read2_b32 v[80:81], v2 offset0:32 offset1:40
    ds_read2_b32 v[82:83], v2 offset0:34 offset1:42
    v_smfmac_f32_16x16x64_bf16 v[76:79], v[44:47], v[192:199], v4
    ds_read2_b32 v[84:85], v2 offset0:33 offset1:41
    ds_read2_b32 v[86:87], v2 offset0:35 offset1:43
    v_mov_b32 v58, 0
    v_mov_b32 v59, 0
    v_smfmac_f32_16x16x64_bf16 v[52:55], v[64:67], a[224:231], v4
    s_nop 0
    v_cvt_pk_bf16_f32 v74, v76, v77
    v_cvt_pk_bf16_f32 v75, v78, v79
    s_nop 1
    v_mfma_f32_16x16x32_bf16 v[76:79], v[72:75], v[16:19], 0
    v_smfmac_f32_16x16x64_bf16 v[56:59], v[64:67], a[232:239], v4
    s_nop 4
    v_cvt_pk_bf16_f32 v68, v76, v77
    v_cvt_pk_bf16_f32 v69, v78, v79
    s_nop 1
    v_smfmac_f32_16x16x64_bf16 v[52:55], v[68:71], a[240:247], v4
    v_smfmac_f32_16x16x64_bf16 v[56:59], v[68:71], a[248:255], v4
    s_waitcnt lgkmcnt(0)
    v_smfmac_f32_16x16x64_bf16 v[48:51], v[68:71], v[80:87], v4
    s_nop 1
    v_permlane32_swap_b32 v52, v54
    v_permlane32_swap_b32 v53, v55
    s_nop 1
    v_permlane32_swap_b32 v56, v58
    v_permlane32_swap_b32 v57, v59
    v_add_f32 v52, v52, v54
    v_add_f32 v53, v53, v55
    ds_write2_b32 v5, v52, v53 offset0:0 offset1:4
    v_add_f32 v56, v56, v58
    v_add_f32 v57, v57, v59
    v_permlane32_swap_b32 v48, v50
    v_permlane32_swap_b32 v49, v51
    ds_write2_b32 v5, v56, v57 offset0:32 offset1:36
    s_nop 0
    v_add_f32 v48, v48, v50
    v_add_f32 v49, v49, v51
    ds_write2_b32 v7, v48, v49 offset0:0 offset1:4
    s_waitcnt lgkmcnt(0)
    s_barrier
    ds_read_b128 v[48:51], v8 offset:0
    ds_read_b128 v[52:55], v8 offset:272
    ds_read_b128 v[56:59], v8 offset:544
    ds_read_b128 v[60:63], v8 offset:816
    ds_read_b128 v[64:67], v8 offset:1088
    s_cmp_eq_u32 s63, 0
    s_waitcnt lgkmcnt(4)
    v_pk_add_f32 v[48:49], v[48:49], v[50:51]
    v_add_f32 v48, v48, v49
    v_exp_f32 v72, v48
    s_waitcnt lgkmcnt(3)
    v_pk_add_f32 v[52:53], v[52:53], v[54:55]
    v_add_f32 v52, v52, v53
    v_exp_f32 v73, v52
    s_waitcnt lgkmcnt(2)
    v_pk_add_f32 v[56:57], v[56:57], v[58:59]
    v_add_f32 v56, v56, v57
    v_exp_f32 v74, v56
    s_waitcnt lgkmcnt(1)
    v_pk_add_f32 v[60:61], v[60:61], v[62:63]
    v_add_f32 v60, v60, v61
    v_exp_f32 v75, v60
    s_waitcnt lgkmcnt(0)
    v_pk_add_f32 v[64:65], v[64:65], v[66:67]
    v_add_f32 v64, v64, v65
    v_exp_f32 v76, v64
    v_add_f32 v78, v72, v73
    v_add_f32 v79, v74, v75
    v_add_f32 v78, v78, v79
    v_add_f32 v78, v78, v76
    v_mov_b32_dpp v77, v76 quad_perm:[1,0,3,2] row_mask:0xf bank_mask:0xf
    s_nop 1
    v_add_f32_dpp v78, v78, v78 quad_perm:[1,0,3,2] row_mask:0xf bank_mask:0xf
    s_nop 1
    v_add_f32_dpp v78, v78, v78 quad_perm:[2,3,0,1] row_mask:0xf bank_mask:0xf
    s_nop 1
    v_add_f32_dpp v78, v78, v78 row_half_mirror row_mask:0xf bank_mask:0xf
    v_rcp_f32 v79, v78
    v_subrev_u32 v80, 0x21800000, v78
    v_cmp_lt_u32 vcc, 0x3c000000, v80
    s_cbranch_vccnz ch_q0_fb
ch_q0_ok:
    v_pk_mul_f32 v[72:73], v[72:73], v[78:79] op_sel:[0,1] op_sel_hi:[1,1]
    v_pk_mul_f32 v[74:75], v[74:75], v[78:79] op_sel:[0,1] op_sel_hi:[1,1]
    v_pk_mul_f32 v[76:77], v[76:77], v[78:79] op_sel:[0,1] op_sel_hi:[1,1]
    v_cvt_pk_bf16_f32 v72, v72, v73
    v_cvt_pk_bf16_f32 v73, v74, v75
    v_cvt_pk_bf16_f32 v74, v76, v77
    s_cbranch_scc1 pp_64_s
    buffer_store_dwordx2 v[72:73], v9, s[40:43], s54 offen
    buffer_store_dword v74, v10, s[40:43], s54 offen
    s_branch pp_64_d
pp_64_s:
    buffer_store_dwordx2 v[72:73], v9, s[40:43], s54 offen sc1
    buffer_store_dword v74, v10, s[40:43], s54 offen sc1
pp_64_d:
    s_barrier
    buffer_load_dwordx4 a[224:227], v3, s[20:23], s56 offen offset:0 sc1
    s_sleep 1
    buffer_load_dwordx4 a[228:231], v3, s[20:23], s56 offen offset:1024 sc1
    s_sleep 1
    buffer_load_dwordx4 a[232:235], v3, s[20:23], s56 offen offset:2048 sc1
    s_sleep 1
    buffer_load_dwordx4 a[236:239], v3, s[20:23], s56 offen offset:3072 sc1
    s_sleep 1
    buffer_load_dwordx4 a[240:243], v3, s[20:23], s57 offen offset:0 sc1
    s_sleep 1
    buffer_load_dwordx4 a[244:247], v3, s[20:23], s57 offen offset:1024 sc1
    s_sleep 1
    buffer_load_dwordx4 a[248:251], v3, s[20:23], s57 offen offset:2048 sc1
    s_sleep 1
    buffer_load_dwordx4 a[252:255], v3, s[20:23], s57 offen offset:3072 sc1
    s_add_u32 s56, s56, 32768
    s_add_u32 s57, s57, 32768
    s_add_u32 s52, s52, 1
    s_add_u32 s53, s53, 14336
    s_add_u32 s54, s54, 10240
    s_cmp_lt_u32 s52, 63
    s_cbranch_scc1 ch_q0
    s_waitcnt vmcnt(0)
    s_branch ch_done
ch_q0_fb:
    v_max3_f32 v80, v48, v52, v56
    v_max3_f32 v80, v80, v60, v64
    s_nop 1
    v_max_f32_dpp v80, v80, v80 quad_perm:[1,0,3,2] row_mask:0xf bank_mask:0xf
    s_nop 1
    v_max_f32_dpp v80, v80, v80 quad_perm:[2,3,0,1] row_mask:0xf bank_mask:0xf
    s_nop 1
    v_max_f32_dpp v80, v80, v80 row_half_mirror row_mask:0xf bank_mask:0xf
    v_sub_f32 v72, v48, v80
    v_sub_f32 v73, v52, v80
    v_sub_f32 v74, v56, v80
    v_sub_f32 v75, v60, v80
    v_sub_f32 v76, v64, v80
    v_exp_f32 v72, v72
    v_exp_f32 v73, v73
    v_exp_f32 v74, v74
    v_exp_f32 v75, v75
    v_exp_f32 v76, v76
    s_nop 1
    v_add_f32 v78, v72, v73
    v_add_f32 v79, v74, v75
    v_add_f32 v78, v78, v79
    v_add_f32 v78, v78, v76
    v_mov_b32_dpp v77, v76 quad_perm:[1,0,3,2] row_mask:0xf bank_mask:0xf
    s_nop 1
    v_add_f32_dpp v78, v78, v78 quad_perm:[1,0,3,2] row_mask:0xf bank_mask:0xf
    s_nop 1
    v_add_f32_dpp v78, v78, v78 quad_perm:[2,3,0,1] row_mask:0xf bank_mask:0xf
    s_nop 1
    v_add_f32_dpp v78, v78, v78 row_half_mirror row_mask:0xf bank_mask:0xf
    v_rcp_f32 v79, v78
    s_nop 1
    s_branch ch_q0_ok
ch_q1:
    v_mov_b32 v48, 0
    v_mov_b32 v49, 0
    v_mov_b32 v50, 0
    v_mov_b32 v51, 0
    v_mov_b32 v52, 0
    v_mov_b32 v53, 0
    v_mov_b32 v54, 0
    v_mov_b32 v55, 0
    v_mov_b32 v56, 0
    v_mov_b32 v57, 0
    v_mov_b32 v58, 0
    v_mov_b32 v59, 0
    v_mov_b32 v60, 0
    v_mov_b32 v61, 0
    v_mov_b32 v62, 0
    v_mov_b32 v63, 0
    v_mov_b32 v72, 0
    v_mov_b32 v73, 0
    v_mov_b32 v74, 0
    v_mov_b32 v75, 0
    v_mov_b32 v76, 0
    v_mov_b32 v77, 0
    v_mov_b32 v78, 0
    v_mov_b32 v79, 0
    v_mov_b32 v80, 0
    v_mov_b32 v81, 0
    v_mov_b32 v82, 0
    v_mov_b32 v83, 0
    s_mov_b32 s62, 0
    s_sleep 4
    s_mov_b64 exec, s[46:47]
ch_q1_pm:
    buffer_load_dwordx4 v[20:23], v15, s[36:39], s53 offen offset:0 sc1
    buffer_load_dwordx4 v[24:27], v15, s[36:39], s53 offen offset:896 sc1
    s_add_u32 s62, s62, 1
    s_cmp_gt_u32 s62, 200000
    s_cbranch_scc1 ch_done
    s_waitcnt vmcnt(0)
    v_max3_u32 v36, v20, v21, v22
    v_max3_u32 v37, v23, v24, v25
    v_max3_u32 v36, v36, v26, v27
    v_max_u32 v36, v36, v37
    v_cmp_eq_u32 vcc, -1, v36
    s_cbranch_vccnz ch_q1_pm
    ds_write_b128 v14, v[20:23] offset:0
    ds_write_b128 v14, v[24:27] offset:912
    s_mov_b64 exec, -1
    s_waitcnt lgkmcnt(0)
    s_barrier
    ds_read_b128 v[20:23], v1 offset:0
    ds_read_b128 v[24:27], v1 offset:128
    ds_read_b128 v[28:31], v1 offset:256
    ds_read_b128 v[32:35], v1 offset:384
    ds_read_b128 v[36:39], v1 offset:512
    ds_read_b128 v[40:43], v1 offset:640
    ds_read_b128 v[44:47], v1 offset:768
    s_waitcnt lgkmcnt(6)
    v_smfmac_f32_16x16x64_bf16 v[80:83], v[20:23], v[200:207], v4
    v_smfmac_f32_16x16x64_bf16 v[48:51], v[20:23], a[0:7], v4
    s_add_u32 s12, s53, s14
    s_add_u32 s13, s55, s14
    s_mov_b32 s33, 0
    v_smfmac_f32_16x16x64_bf16 v[52:55], v[20:23], a[56:63], v4
    s_mov_b64 exec, s[48:49]
    buffer_load_dwordx4 v[84:87], v3, s[36:39], s12 offen sc1
    s_mov_b64 exec, -1
    s_waitcnt lgkmcnt(5)
    v_smfmac_f32_16x16x64_bf16 v[80:83], v[24:27], v[208:215], v4
    v_smfmac_f32_16x16x64_bf16 v[48:51], v[24:27], a[8:15], v4
    v_smfmac_f32_16x16x64_bf16 v[52:55], v[24:27], a[64:71], v4
    s_waitcnt lgkmcnt(4)
    v_smfmac_f32_16x16x64_bf16 v[80:83], v[28:31], v[216:223], v4
    v_smfmac_f32_16x16x64_bf16 v[48:51], v[28:31], a[16:23], v4
    v_smfmac_f32_16x16x64_bf16 v[52:55], v[28:31], a[72:79], v4
    s_waitcnt lgkmcnt(3)
    v_smfmac_f32_16x16x64_bf16 v[80:83], v[32:35], v[224:231], v4
    v_smfmac_f32_16x16x64_bf16 v[48:51], v[32:35], a[24:31], v4
    v_smfmac_f32_16x16x64_bf16 v[52:55], v[32:35], a[80:87], v4
    s_waitcnt lgkmcnt(2)
    v_smfmac_f32_16x16x64_bf16 v[80:83], v[36:39], v[232:239], v4
    v_smfmac_f32_16x16x64_bf16 v[48:51], v[36:39], a[32:39], v4
    v_smfmac_f32_16x16x64_bf16 v[52:55], v[36:39], a[88:95], v4
    s_waitcnt lgkmcnt(1)
    v_smfmac_f32_16x16x64_bf16 v[80:83], v[40:43], v[240:247], v4
    s_waitcnt vmcnt(0)
    v_max3_u32 v13, v84, v85, v86
    v_smfmac_f32_16x16x64_bf16 v[48:51], v[40:43], a[40:47], v4
    v_max_u32 v13, v13, v87
    v_smfmac_f32_16x16x64_bf16 v[52:55], v[40:43], a[96:103], v4
    s_mov_b64 exec, s[48:49]
    v_cmp_eq_u32 vcc, -1, v13
    s_cbranch_vccnz ch_q1_n3
    buffer_store_dwordx4 v[84:87], v3, s[28:31], s13 offen sc1
    s_mov_b32 s33, 1
    s_add_u32 s55, s55, 7168
ch_q1_n3:
    s_mov_b64 exec, -1
    s_waitcnt lgkmcnt(0)
    v_smfmac_f32_16x16x64_bf16 v[80:83], v[44:47], v[248:255], v4
    buffer_load_dword v13, v6, s[24:27], s61 offen sc1
    s_add_u32 s61, s61, 458752
    v_smfmac_f32_16x16x64_bf16 v[48:51], v[44:47], a[48:55], v4
    v_smfmac_f32_16x16x64_bf16 v[52:55], v[44:47], a[104:111], v4
    v_smfmac_f32_16x16x64_bf16 v[56:59], v[20:23], a[112:119], v4
    v_cvt_pk_bf16_f32 v80, v80, v81
    v_smfmac_f32_16x16x64_bf16 v[60:63], v[20:23], a[168:175], v4
    v_cvt_pk_bf16_f32 v81, v82, v83
    v_smfmac_f32_16x16x64_bf16 v[56:59], v[24:27], a[120:127], v4
    v_cvt_pk_bf16_f32 v48, v48, v49
    v_smfmac_f32_16x16x64_bf16 v[60:63], v[24:27], a[176:183], v4
    v_mfma_f32_16x16x16_bf16 v[84:87], v[80:81], v[16:17], 0
    v_cvt_pk_bf16_f32 v49, v50, v51
    v_cvt_pk_bf16_f32 v50, v52, v53
    v_smfmac_f32_16x16x64_bf16 v[56:59], v[28:31], a[128:135], v4
    v_cvt_pk_bf16_f32 v51, v54, v55
    v_smfmac_f32_16x16x64_bf16 v[60:63], v[28:31], a[184:191], v4
    v_smfmac_f32_16x16x64_bf16 v[56:59], v[32:35], a[136:143], v4
    v_mfma_f32_16x16x32_bf16 v[52:55], v[48:51], v[16:19], 0
    v_cvt_pk_bf16_f32 v70, v84, v85
    v_cvt_pk_bf16_f32 v71, v86, v87
    v_smfmac_f32_16x16x64_bf16 v[60:63], v[32:35], a[192:199], v4
    ds_read2_b32 v[80:81], v2 offset0:0 offset1:8
    v_smfmac_f32_16x16x64_bf16 v[56:59], v[36:39], a[144:151], v4
    ds_read2_b32 v[82:83], v2 offset0:2 offset1:10
    v_mov_b32 v48, 0
    v_smfmac_f32_16x16x64_bf16 v[60:63], v[36:39], a[200:207], v4
    v_cvt_pk_bf16_f32 v64, v52, v53
    v_smfmac_f32_16x16x64_bf16 v[56:59], v[40:43], a[152:159], v4
    v_cvt_pk_bf16_f32 v65, v54, v55
    v_smfmac_f32_16x16x64_bf16 v[60:63], v[40:43], a[208:215], v4
    ds_read2_b32 v[84:85], v2 offset0:1 offset1:9
    v_smfmac_f32_16x16x64_bf16 v[56:59], v[44:47], a[160:167], v4
    ds_read2_b32 v[86:87], v2 offset0:3 offset1:11
    v_mov_b32 v49, 0
    v_smfmac_f32_16x16x64_bf16 v[60:63], v[44:47], a[216:223], v4
    v_mov_b32 v50, 0
    v_smfmac_f32_16x16x64_bf16 v[72:75], v[20:23], v[88:95], v4
    v_mov_b32 v51, 0
    v_smfmac_f32_16x16x64_bf16 v[72:75], v[24:27], v[96:103], v4
    v_mov_b32 v52, 0
    v_smfmac_f32_16x16x64_bf16 v[72:75], v[28:31], v[104:111], v4
    v_cvt_pk_bf16_f32 v56, v56, v57
    v_smfmac_f32_16x16x64_bf16 v[72:75], v[32:35], v[112:119], v4
    v_cvt_pk_bf16_f32 v57, v58, v59
    v_smfmac_f32_16x16x64_bf16 v[72:75], v[36:39], v[120:127], v4
    v_cvt_pk_bf16_f32 v58, v60, v61
    v_smfmac_f32_16x16x64_bf16 v[72:75], v[40:43], v[128:135], v4
    v_cvt_pk_bf16_f32 v59, v62, v63
    v_smfmac_f32_16x16x64_bf16 v[72:75], v[44:47], v[136:143], v4
    v_mfma_f32_16x16x32_bf16 v[60:63], v[56:59], v[16:19], 0
    v_mov_b32 v53, 0
    v_mov_b32 v54, 0
    v_smfmac_f32_16x16x64_bf16 v[76:79], v[20:23], v[144:151], v4
    v_mov_b32 v55, 0
    v_smfmac_f32_16x16x64_bf16 v[76:79], v[24:27], v[152:159], v4
    v_mov_b32 v56, 0
    v_smfmac_f32_16x16x64_bf16 v[76:79], v[28:31], v[160:167], v4
    v_cvt_pk_bf16_f32 v66, v60, v61
    v_smfmac_f32_16x16x64_bf16 v[76:79], v[32:35], v[168:175], v4
    v_cvt_pk_bf16_f32 v67, v62, v63
    v_cvt_pk_bf16_f32 v72, v72, v73
    s_waitcnt lgkmcnt(0)
    v_smfmac_f32_16x16x64_bf16 v[76:79], v[36:39], v[176:183], v4
    v_smfmac_f32_16x16x64_bf16 v[48:51], v[64:67], v[80:87], v4
    v_cvt_pk_bf16_f32 v73, v74, v75
    v_smfmac_f32_16x16x64_bf16 v[76:79], v[40:43], v[184:191], v4
    v_mov_b32 v57, 0
    ds_read2_b32 v[80:81], v2 offset0:32 offset1:40
    ds_read2_b32 v[82:83], v2 offset0:34 offset1:42
    v_smfmac_f32_16x16x64_bf16 v[76:79], v[44:47], v[192:199], v4
    ds_read2_b32 v[84:85], v2 offset0:33 offset1:41
    ds_read2_b32 v[86:87], v2 offset0:35 offset1:43
    v_mov_b32 v58, 0
    v_mov_b32 v59, 0
    v_smfmac_f32_16x16x64_bf16 v[52:55], v[64:67], a[224:231], v4
    s_nop 0
    v_cvt_pk_bf16_f32 v74, v76, v77
    v_cvt_pk_bf16_f32 v75, v78, v79
    s_nop 1
    v_mfma_f32_16x16x32_bf16 v[76:79], v[72:75], v[16:19], 0
    v_smfmac_f32_16x16x64_bf16 v[56:59], v[64:67], a[232:239], v4
    s_nop 4
    v_cvt_pk_bf16_f32 v68, v76, v77
    v_cvt_pk_bf16_f32 v69, v78, v79
    s_nop 1
    v_smfmac_f32_16x16x64_bf16 v[52:55], v[68:71], a[240:247], v4
    v_smfmac_f32_16x16x64_bf16 v[56:59], v[68:71], a[248:255], v4
    s_waitcnt lgkmcnt(0)
    v_smfmac_f32_16x16x64_bf16 v[48:51], v[68:71], v[80:87], v4
    s_nop 1
    v_permlane32_swap_b32 v52, v54
    v_permlane32_swap_b32 v53, v55
    s_nop 1
    v_permlane32_swap_b32 v56, v58
    v_permlane32_swap_b32 v57, v59
    v_add_f32 v52, v52, v54
    v_add_f32 v53, v53, v55
    ds_write2_b32 v5, v52, v53 offset0:0 offset1:4
    v_add_f32 v56, v56, v58
    v_add_f32 v57, v57, v59
    v_permlane32_swap_b32 v48, v50
    v_permlane32_swap_b32 v49, v51
    ds_write2_b32 v5, v56, v57 offset0:32 offset1:36
    s_nop 0
    v_add_f32 v48, v48, v50
    v_add_f32 v49, v49, v51
    ds_write2_b32 v7, v48, v49 offset0:0 offset1:4
    s_waitcnt lgkmcnt(0)
    s_barrier
    s_barrier
    s_cmp_eq_u32 s8, 2
    s_cbranch_scc0 ch_q1_n2
    s_cmp_eq_u32 s33, 1
    s_cbranch_scc1 ch_q1_n2
    s_add_u32 s12, s53, s14
    s_add_u32 s13, s55, s14
    s_mov_b32 s15, 0
    s_mov_b64 exec, 0xfffffff
ch_q1_m2:
    buffer_load_dwordx4 v[20:23], v3, s[36:39], s12 offen sc1
    s_add_u32 s15, s15, 1
    s_cmp_gt_u32 s15, 200000
    s_cbranch_scc1 ch_done
    s_waitcnt vmcnt(0)
    v_max3_u32 v24, v20, v21, v22
    v_max_u32 v24, v24, v23
    v_cmp_eq_u32 vcc, -1, v24
    s_cbranch_vccnz ch_q1_m2
    buffer_store_dwordx4 v[20:23], v3, s[28:31], s13 offen sc1
    s_mov_b64 exec, -1
    s_add_u32 s55, s55, 7168
ch_q1_n2:
    buffer_load_dwordx4 a[224:227], v3, s[20:23], s56 offen offset:0 sc1
    s_sleep 1
    buffer_load_dwordx4 a[228:231], v3, s[20:23], s56 offen offset:1024 sc1
    s_sleep 1
    buffer_load_dwordx4 a[232:235], v3, s[20:23], s56 offen offset:2048 sc1
    s_sleep 1
    buffer_load_dwordx4 a[236:239], v3, s[20:23], s56 offen offset:3072 sc1
    s_sleep 1
    buffer_load_dwordx4 a[240:243], v3, s[20:23], s57 offen offset:0 sc1
    s_sleep 1
    buffer_load_dwordx4 a[244:247], v3, s[20:23], s57 offen offset:1024 sc1
    s_sleep 1
    buffer_load_dwordx4 a[248:251], v3, s[20:23], s57 offen offset:2048 sc1
    s_sleep 1
    buffer_load_dwordx4 a[252:255], v3, s[20:23], s57 offen offset:3072 sc1
    s_add_u32 s56, s56, 32768
    s_add_u32 s57, s57, 32768
    s_add_u32 s12, s54, 10240
    s_cmp_eq_u32 s8, 1
    s_cbranch_scc0 ch_q1_n1
    buffer_load_dword v13, v11, s[20:23], s58 offen sc1
    s_add_u32 s58, s58, 32768
    buffer_load_dword v13, v12, s[40:43], s12 offen sc1
ch_q1_n1:
    s_add_u32 s12, s52, 2
    s_cmp_eq_u32 s12, 4
    s_cselect_b32 s12, 0, s12
    s_and_b32 s13, s12, 7
    s_cmp_eq_u32 s13, 0
    s_cbranch_scc0 ch_q1_ng
    s_cmp_lt_u32 s12, 64
    s_cbranch_scc0 ch_q1_ng
    s_cmp_eq_u32 s8, 3
    s_cbranch_scc0 ch_q1_ng
    s_lshl_b32 s12, s12, 7
    s_add_u32 s12, s12, 4096
    v_and_b32 v28, 63, v0
    v_lshlrev_b32 v28, 4, v28
    v_add_u32 v28, s12, v28
    s_mov_b32 s62, 0
    v_mov_b32 v20, 0
    v_mov_b32 v21, 0
    v_mov_b32 v22, 0
    v_mov_b32 v23, 0
    v_mov_b32 v24, 0
    v_mov_b32 v25, 0
    v_mov_b32 v26, 0
    v_mov_b32 v27, 0
fw_65:
    s_mov_b32 exec_lo, 0xffffffff
    s_mov_b32 exec_hi, 0xffffff
    buffer_load_dwordx4 v[20:23], v28, s[76:79], 0 offen sc1
    s_mov_b64 exec, -1
    s_add_u32 s62, s62, 1
    s_cmp_gt_u32 s62, 3000000
    s_cbranch_scc1 ch_done
    s_waitcnt vmcnt(0)
    v_max3_u32 v20, v20, v21, v22
    v_max3_u32 v24, v24, v25, v26
    v_max3_u32 v20, v20, v23, v27
    v_max_u32 v20, v20, v24
    v_cmp_eq_u32 vcc, -1, v20
    s_cbranch_vccz fw_65_ok
    s_sleep 1
    s_branch fw_65
fw_65_ok:
ch_q1_ng:
    s_add_u32 s52, s52, 1
    s_add_u32 s53, s53, 14336
    s_add_u32 s54, s54, 10240
    s_cmp_lt_u32 s52, 63
    s_cbranch_scc1 ch_q1
    s_waitcnt vmcnt(0)
    s_branch ch_done
ch_u:
    s_mov_b32 s16, s4
    s_mov_b32 s17, s5
    s_mov_b32 s18, 0xc40000
    s_mov_b32 s19, 0x00020000
    s_lshr_b32 s14, s8, 1
    s_and_b32 s15, s8, 1
    s_lshl_b32 s13, s6, 1
    s_add_u32 s13, s13, s14
    s_mul_i32 s13, s13, 401408
    s_mul_i32 s12, s15, 100352
    s_add_u32 s13, s13, s12
    s_add_u32 s13, s13, 200704
    s_lshl_b32 s12, s6, 1
    s_add_u32 s12, s12, s14
    s_mul_i32 s12, s12, 14
    s_lshr_b32 s9, s12, 6
    s_add_u32 s12, s12, 13
    s_lshr_b32 s10, s12, 6
    s_sub_u32 s11, s10, s9
    v_and_b32 v41, 1, v22
    v_mul_u32_u24 v41, s11, v41
    v_bfe_u32 v40, v22, 1, 4
    v_mul_u32_u24 v40, 7, v40
    s_add_u32 s12, s10, 112
    v_add_u32 v40, s12, v40
    v_sub_u32 v40, v40, v41
    v_lshlrev_b32 v40, 2, v40
    s_cmp_eq_u32 s10, 1
    s_cbranch_scc1 uw_1
    s_cmp_eq_u32 s10, 2
    s_cbranch_scc1 uw_2
    s_cmp_eq_u32 s10, 3
    s_cbranch_scc1 uw_3
    s_cmp_eq_u32 s10, 4
    s_cbranch_scc1 uw_4
    s_cmp_eq_u32 s10, 5
    s_cbranch_scc1 uw_5
    s_cmp_eq_u32 s10, 6
    s_cbranch_scc1 uw_6
uw_0:
    s_add_u32 s88, s13, 0
    s_add_u32 s89, s13, 14336
    s_add_u32 s90, s13, 28672
    s_add_u32 s91, s13, 43008
    s_add_u32 s92, s13, 57344
    s_add_u32 s93, s13, 71680
    s_add_u32 s94, s13, 86016
    v_add_u32 v43, 4096, v3
    v_add_u32 v44, 8192, v3
    v_add_u32 v45, 12288, v3
    s_mov_b32 s62, 0
uw0_s0:
    buffer_load_dword v42, v40, s[32:35], 0 offen sc1
    s_add_u32 s62, s62, 1
    s_cmp_gt_u32 s62, 3000000
    s_cbranch_scc1 ch_done
    s_waitcnt vmcnt(0)
    v_sub_u32 v42, v42, v41
    v_cmp_gt_i32 vcc, 1, v42
    s_cbranch_vccz uw0_k0
    s_sleep 4
    s_branch uw0_s0
uw0_k0:
    buffer_load_dwordx4 a[0:3], v3, s[16:19], s88 offen offset:0
    buffer_load_dwordx4 a[28:31], v43, s[16:19], s88 offen offset:3072
    buffer_load_dwordx4 a[56:59], v3, s[16:19], s89 offen offset:0
    buffer_load_dwordx4 a[84:87], v43, s[16:19], s89 offen offset:3072
    buffer_load_dword v42, v40, s[32:35], 0 offen sc1
    buffer_load_dwordx4 a[112:115], v3, s[16:19], s90 offen offset:0
    buffer_load_dwordx4 a[140:143], v43, s[16:19], s90 offen offset:3072
    buffer_load_dwordx4 a[168:171], v3, s[16:19], s91 offen offset:0
    buffer_load_dwordx4 a[196:199], v43, s[16:19], s91 offen offset:3072
    buffer_load_dwordx4 v[88:91], v3, s[16:19], s92 offen offset:0
    buffer_load_dwordx4 v[116:119], v43, s[16:19], s92 offen offset:3072
    buffer_load_dwordx4 v[144:147], v3, s[16:19], s93 offen offset:0
    buffer_load_dwordx4 v[172:175], v43, s[16:19], s93 offen offset:3072
    buffer_load_dwordx4 v[200:203], v3, s[16:19], s94 offen offset:0
    buffer_load_dwordx4 v[228:231], v43, s[16:19], s94 offen offset:3072
    s_waitcnt vmcnt(10)
    v_sub_u32 v42, v42, v41
    v_cmp_gt_i32 vcc, 2, v42
    s_cbranch_vccz uw0_k1
uw0_s1:
    buffer_load_dword v42, v40, s[32:35], 0 offen sc1
    s_add_u32 s62, s62, 1
    s_cmp_gt_u32 s62, 3000000
    s_cbranch_scc1 ch_done
    s_waitcnt vmcnt(0)
    v_sub_u32 v42, v42, v41
    v_cmp_gt_i32 vcc, 2, v42
    s_cbranch_vccz uw0_k1
    s_sleep 4
    s_branch uw0_s1
uw0_k1:
    buffer_load_dwordx4 a[4:7], v3, s[16:19], s88 offen offset:1024
    buffer_load_dwordx4 a[32:35], v44, s[16:19], s88 offen offset:0
    buffer_load_dwordx4 a[60:63], v3, s[16:19], s89 offen offset:1024
    buffer_load_dwordx4 a[88:91], v44, s[16:19], s89 offen offset:0
    buffer_load_dword v42, v40, s[32:35], 0 offen sc1
    buffer_load_dwordx4 a[116:119], v3, s[16:19], s90 offen offset:1024
    buffer_load_dwordx4 a[144:147], v44, s[16:19], s90 offen offset:0
    buffer_load_dwordx4 a[172:175], v3, s[16:19], s91 offen offset:1024
    buffer_load_dwordx4 a[200:203], v44, s[16:19], s91 offen offset:0
    buffer_load_dwordx4 v[92:95], v3, s[16:19], s92 offen offset:1024
    buffer_load_dwordx4 v[120:123], v44, s[16:19], s92 offen offset:0
    buffer_load_dwordx4 v[148:151], v3, s[16:19], s93 offen offset:1024
    buffer_load_dwordx4 v[176:179], v44, s[16:19], s93 offen offset:0
    buffer_load_dwordx4 v[204:207], v3, s[16:19], s94 offen offset:1024
    buffer_load_dwordx4 v[232:235], v44, s[16:19], s94 offen offset:0
    s_waitcnt vmcnt(10)
    v_sub_u32 v42, v42, v41
    v_cmp_gt_i32 vcc, 3, v42
    s_cbranch_vccz uw0_k2
uw0_s2:
    buffer_load_dword v42, v40, s[32:35], 0 offen sc1
    s_add_u32 s62, s62, 1
    s_cmp_gt_u32 s62, 3000000
    s_cbranch_scc1 ch_done
    s_waitcnt vmcnt(0)
    v_sub_u32 v42, v42, v41
    v_cmp_gt_i32 vcc, 3, v42
    s_cbranch_vccz uw0_k2
    s_sleep 4
    s_branch uw0_s2
uw0_k2:
    s_cmp_eq_u32 s8, 0
    s_cbranch_scc0 ai_66
    v_mov_b32 v37, 8
    s_mov_b32 s12, 0
wc_67:
    buffer_load_dwordx2 v[38:39], v37, s[80:83], 0 offen sc1
    s_add_u32 s12, s12, 1
    s_cmp_gt_u32 s12, 3000000
    s_cbranch_scc1 ch_done
    s_waitcnt vmcnt(0)
    v_readfirstlane_b32 s13, v38
    s_nop 3
    s_cmp_ge_u32 s13, 256
    s_cbranch_scc1 wc_67_ok
    s_sleep 8
    s_branch wc_67
wc_67_ok:
    ds_write_b32 v50, v39
    v_readfirstlane_b32 s12, v39
    s_nop 3
    s_bcnt1_i32_b32 s12, s12
    s_cmp_eq_u32 s12, 1
    s_cselect_b32 s63, 1, 0
    v_min_u32 v18, 0xfffffffe, v18
    v_min_u32 v19, 0xfffffffe, v19
    s_cmp_eq_u32 s63, 0
    s_cbranch_scc1 mp_68_s
    buffer_store_dword v18, v13, s[36:39], 0 offen
    buffer_store_dword v19, v2, s[36:39], 0 offen
    buffer_store_dword v18, v11, s[36:39], 0 offen
    buffer_store_dword v19, v12, s[36:39], 0 offen
    s_branch mp_68_d
mp_68_s:
    buffer_store_dword v18, v13, s[36:39], 0 offen sc1
    buffer_store_dword v19, v2, s[36:39], 0 offen sc1
    buffer_store_dword v18, v11, s[36:39], 0 offen sc1
    buffer_store_dword v19, v12, s[36:39], 0 offen sc1
mp_68_d:
ai_66:
    buffer_load_dwordx4 a[8:11], v3, s[16:19], s88 offen offset:2048
    buffer_load_dwordx4 a[36:39], v44, s[16:19], s88 offen offset:1024
    buffer_load_dwordx4 a[64:67], v3, s[16:19], s89 offen offset:2048
    buffer_load_dwordx4 a[92:95], v44, s[16:19], s89 offen offset:1024
    buffer_load_dword v42, v40, s[32:35], 0 offen sc1
    buffer_load_dwordx4 a[120:123], v3, s[16:19], s90 offen offset:2048
    buffer_load_dwordx4 a[148:151], v44, s[16:19], s90 offen offset:1024
    buffer_load_dwordx4 a[176:179], v3, s[16:19], s91 offen offset:2048
    buffer_load_dwordx4 a[204:207], v44, s[16:19], s91 offen offset:1024
    buffer_load_dwordx4 v[96:99], v3, s[16:19], s92 offen offset:2048
    buffer_load_dwordx4 v[124:127], v44, s[16:19], s92 offen offset:1024
    buffer_load_dwordx4 v[152:155], v3, s[16:19], s93 offen offset:2048
    buffer_load_dwordx4 v[180:183], v44, s[16:19], s93 offen offset:1024
    buffer_load_dwordx4 v[208:211], v3, s[16:19], s94 offen offset:2048
    buffer_load_dwordx4 v[236:239], v44, s[16:19], s94 offen offset:1024
    s_waitcnt vmcnt(10)
    v_sub_u32 v42, v42, v41
    v_cmp_gt_i32 vcc, 4, v42
    s_cbranch_vccz uw0_k3
uw0_s3:
    buffer_load_dword v42, v40, s[32:35], 0 offen sc1
    s_add_u32 s62, s62, 1
    s_cmp_gt_u32 s62, 3000000
    s_cbranch_scc1 ch_done
    s_waitcnt vmcnt(0)
    v_sub_u32 v42, v42, v41
    v_cmp_gt_i32 vcc, 4, v42
    s_cbranch_vccz uw0_k3
    s_sleep 4
    s_branch uw0_s3
uw0_k3:
    buffer_load_dwordx4 a[12:15], v3, s[16:19], s88 offen offset:3072
    buffer_load_dwordx4 a[40:43], v44, s[16:19], s88 offen offset:2048
    buffer_load_dwordx4 a[68:71], v3, s[16:19], s89 offen offset:3072
    buffer_load_dwordx4 a[96:99], v44, s[16:19], s89 offen offset:2048
    buffer_load_dword v42, v40, s[32:35], 0 offen sc1
    buffer_load_dwordx4 a[124:127], v3, s[16:19], s90 offen offset:3072
    buffer_load_dwordx4 a[152:155], v44, s[16:19], s90 offen offset:2048
    buffer_load_dwordx4 a[180:183], v3, s[16:19], s91 offen offset:3072
    buffer_load_dwordx4 a[208:211], v44, s[16:19], s91 offen offset:2048
    buffer_load_dwordx4 v[100:103], v3, s[16:19], s92 offen offset:3072
    buffer_load_dwordx4 v[128:131], v44, s[16:19], s92 offen offset:2048
    buffer_load_dwordx4 v[156:159], v3, s[16:19], s93 offen offset:3072
    buffer_load_dwordx4 v[184:187], v44, s[16:19], s93 offen offset:2048
    buffer_load_dwordx4 v[212:215], v3, s[16:19], s94 offen offset:3072
    buffer_load_dwordx4 v[240:243], v44, s[16:19], s94 offen offset:2048
    s_waitcnt vmcnt(10)
    v_sub_u32 v42, v42, v41
    v_cmp_gt_i32 vcc, 5, v42
    s_cbranch_vccz uw0_k4
uw0_s4:
    buffer_load_dword v42, v40, s[32:35], 0 offen sc1
    s_add_u32 s62, s62, 1
    s_cmp_gt_u32 s62, 3000000
    s_cbranch_scc1 ch_done
    s_waitcnt vmcnt(0)
    v_sub_u32 v42, v42, v41
    v_cmp_gt_i32 vcc, 5, v42
    s_cbranch_vccz uw0_k4
    s_sleep 4
    s_branch uw0_s4
uw0_k4:
    buffer_load_dwordx4 a[16:19], v43, s[16:19], s88 offen offset:0
    buffer_load_dwordx4 a[44:47], v44, s[16:19], s88 offen offset:3072
    buffer_load_dwordx4 a[72:75], v43, s[16:19], s89 offen offset:0
    buffer_load_dwordx4 a[100:103], v44, s[16:19], s89 offen offset:3072
    buffer_load_dword v42, v40, s[32:35], 0 offen sc1
    buffer_load_dwordx4 a[128:131], v43, s[16:19], s90 offen offset:0
    buffer_load_dwordx4 a[156:159], v44, s[16:19], s90 offen offset:3072
    buffer_load_dwordx4 a[184:187], v43, s[16:19], s91 offen offset:0
    buffer_load_dwordx4 a[212:215], v44, s[16:19], s91 offen offset:3072
    buffer_load_dwordx4 v[104:107], v43, s[16:19], s92 offen offset:0
    buffer_load_dwordx4 v[132:135], v44, s[16:19], s92 offen offset:3072
    buffer_load_dwordx4 v[160:163], v43, s[16:19], s93 offen offset:0
    buffer_load_dwordx4 v[188:191], v44, s[16:19], s93 offen offset:3072
    buffer_load_dwordx4 v[216:219], v43, s[16:19], s94 offen offset:0
    buffer_load_dwordx4 v[244:247], v44, s[16:19], s94 offen offset:3072
    s_waitcnt vmcnt(10)
    v_sub_u32 v42, v42, v41
    v_cmp_gt_i32 vcc, 6, v42
    s_cbranch_vccz uw0_k5
uw0_s5:
    buffer_load_dword v42, v40, s[32:35], 0 offen sc1
    s_add_u32 s62, s62, 1
    s_cmp_gt_u32 s62, 3000000
    s_cbranch_scc1 ch_done
    s_waitcnt vmcnt(0)
    v_sub_u32 v42, v42, v41
    v_cmp_gt_i32 vcc, 6, v42
    s_cbranch_vccz uw0_k5
    s_sleep 4
    s_branch uw0_s5
uw0_k5:
    buffer_load_dwordx4 a[20:23], v43, s[16:19], s88 offen offset:1024
    buffer_load_dwordx4 a[48:51], v45, s[16:19], s88 offen offset:0
    buffer_load_dwordx4 a[76:79], v43, s[16:19], s89 offen offset:1024
    buffer_load_dwordx4 a[104:107], v45, s[16:19], s89 offen offset:0
    buffer_load_dword v42, v40, s[32:35], 0 offen sc1
    buffer_load_dwordx4 a[132:135], v43, s[16:19], s90 offen offset:1024
    buffer_load_dwordx4 a[160:163], v45, s[16:19], s90 offen offset:0
    buffer_load_dwordx4 a[188:191], v43, s[16:19], s91 offen offset:1024
    buffer_load_dwordx4 a[216:219], v45, s[16:19], s91 offen offset:0
    buffer_load_dwordx4 v[108:111], v43, s[16:19], s92 offen offset:1024
    buffer_load_dwordx4 v[136:139], v45, s[16:19], s92 offen offset:0
    buffer_load_dwordx4 v[164:167], v43, s[16:19], s93 offen offset:1024
    buffer_load_dwordx4 v[192:195], v45, s[16:19], s93 offen offset:0
    buffer_load_dwordx4 v[220:223], v43, s[16:19], s94 offen offset:1024
    buffer_load_dwordx4 v[248:251], v45, s[16:19], s94 offen offset:0
    s_waitcnt vmcnt(10)
    v_sub_u32 v42, v42, v41
    v_cmp_gt_i32 vcc, 7, v42
    s_cbranch_vccz uw0_k6
uw0_s6:
    buffer_load_dword v42, v40, s[32:35], 0 offen sc1
    s_add_u32 s62, s62, 1
    s_cmp_gt_u32 s62, 3000000
    s_cbranch_scc1 ch_done
    s_waitcnt vmcnt(0)
    v_sub_u32 v42, v42, v41
    v_cmp_gt_i32 vcc, 7, v42
    s_cbranch_vccz uw0_k6
    s_sleep 4
    s_branch uw0_s6
uw0_k6:
    buffer_load_dwordx4 a[24:27], v43, s[16:19], s88 offen offset:2048
    buffer_load_dwordx4 a[52:55], v45, s[16:19], s88 offen offset:1024
    buffer_load_dwordx4 a[80:83], v43, s[16:19], s89 offen offset:2048
    buffer_load_dwordx4 a[108:111], v45, s[16:19], s89 offen offset:1024
    buffer_load_dwordx4 a[136:139], v43, s[16:19], s90 offen offset:2048
    buffer_load_dwordx4 a[164:167], v45, s[16:19], s90 offen offset:1024
    buffer_load_dwordx4 a[192:195], v43, s[16:19], s91 offen offset:2048
    buffer_load_dwordx4 a[220:223], v45, s[16:19], s91 offen offset:1024
    buffer_load_dwordx4 v[112:115], v43, s[16:19], s92 offen offset:2048
    buffer_load_dwordx4 v[140:143], v45, s[16:19], s92 offen offset:1024
    buffer_load_dwordx4 v[168:171], v43, s[16:19], s93 offen offset:2048
    buffer_load_dwordx4 v[196:199], v45, s[16:19], s93 offen offset:1024
    buffer_load_dwordx4 v[224:227], v43, s[16:19], s94 offen offset:2048
    buffer_load_dwordx4 v[252:255], v45, s[16:19], s94 offen offset:1024
    s_branch uw_d
uw_1:
    s_add_u32 s88, s13, 0
    s_add_u32 s89, s13, 14336
    s_add_u32 s90, s13, 28672
    s_add_u32 s91, s13, 43008
    s_add_u32 s92, s13, 57344
    s_add_u32 s93, s13, 71680
    s_add_u32 s94, s13, 86016
    v_add_u32 v43, 4096, v3
    v_add_u32 v44, 8192, v3
    v_add_u32 v45, 12288, v3
    s_mov_b32 s62, 0
uw1_s0:
    buffer_load_dword v42, v40, s[32:35], 0 offen sc1
    s_add_u32 s62, s62, 1
    s_cmp_gt_u32 s62, 3000000
    s_cbranch_scc1 ch_done
    s_waitcnt vmcnt(0)
    v_sub_u32 v42, v42, v41
    v_cmp_gt_i32 vcc, 1, v42
    s_cbranch_vccz uw1_k0
    s_sleep 4
    s_branch uw1_s0
uw1_k0:
    buffer_load_dwordx4 a[4:7], v3, s[16:19], s88 offen offset:1024
    buffer_load_dwordx4 a[32:35], v44, s[16:19], s88 offen offset:0
    buffer_load_dwordx4 a[60:63], v3, s[16:19], s89 offen offset:1024
    buffer_load_dwordx4 a[88:91], v44, s[16:19], s89 offen offset:0
    buffer_load_dword v42, v40, s[32:35], 0 offen sc1
    buffer_load_dwordx4 a[116:119], v3, s[16:19], s90 offen offset:1024
    buffer_load_dwordx4 a[144:147], v44, s[16:19], s90 offen offset:0
    buffer_load_dwordx4 a[172:175], v3, s[16:19], s91 offen offset:1024
    buffer_load_dwordx4 a[200:203], v44, s[16:19], s91 offen offset:0
    buffer_load_dwordx4 v[92:95], v3, s[16:19], s92 offen offset:1024
    buffer_load_dwordx4 v[120:123], v44, s[16:19], s92 offen offset:0
    buffer_load_dwordx4 v[148:151], v3, s[16:19], s93 offen offset:1024
    buffer_load_dwordx4 v[176:179], v44, s[16:19], s93 offen offset:0
    buffer_load_dwordx4 v[204:207], v3, s[16:19], s94 offen offset:1024
    buffer_load_dwordx4 v[232:235], v44, s[16:19], s94 offen offset:0
    s_waitcnt vmcnt(10)
    v_sub_u32 v42, v42, v41
    v_cmp_gt_i32 vcc, 2, v42
    s_cbranch_vccz uw1_k1
uw1_s1:
    buffer_load_dword v42, v40, s[32:35], 0 offen sc1
    s_add_u32 s62, s62, 1
    s_cmp_gt_u32 s62, 3000000
    s_cbranch_scc1 ch_done
    s_waitcnt vmcnt(0)
    v_sub_u32 v42, v42, v41
    v_cmp_gt_i32 vcc, 2, v42
    s_cbranch_vccz uw1_k1
    s_sleep 4
    s_branch uw1_s1
uw1_k1:
    buffer_load_dwordx4 a[8:11], v3, s[16:19], s88 offen offset:2048
    buffer_load_dwordx4 a[36:39], v44, s[16:19], s88 offen offset:1024
    buffer_load_dwordx4 a[64:67], v3, s[16:19], s89 offen offset:2048
    buffer_load_dwordx4 a[92:95], v44, s[16:19], s89 offen offset:1024
    buffer_load_dword v42, v40, s[32:35], 0 offen sc1
    buffer_load_dwordx4 a[120:123], v3, s[16:19], s90 offen offset:2048
    buffer_load_dwordx4 a[148:151], v44, s[16:19], s90 offen offset:1024
    buffer_load_dwordx4 a[176:179], v3, s[16:19], s91 offen offset:2048
    buffer_load_dwordx4 a[204:207], v44, s[16:19], s91 offen offset:1024
    buffer_load_dwordx4 v[96:99], v3, s[16:19], s92 offen offset:2048
    buffer_load_dwordx4 v[124:127], v44, s[16:19], s92 offen offset:1024
    buffer_load_dwordx4 v[152:155], v3, s[16:19], s93 offen offset:2048
    buffer_load_dwordx4 v[180:183], v44, s[16:19], s93 offen offset:1024
    buffer_load_dwordx4 v[208:211], v3, s[16:19], s94 offen offset:2048
    buffer_load_dwordx4 v[236:239], v44, s[16:19], s94 offen offset:1024
    s_waitcnt vmcnt(10)
    v_sub_u32 v42, v42, v41
    v_cmp_gt_i32 vcc, 3, v42
    s_cbranch_vccz uw1_k2
uw1_s2:
    buffer_load_dword v42, v40, s[32:35], 0 offen sc1
    s_add_u32 s62, s62, 1
    s_cmp_gt_u32 s62, 3000000
    s_cbranch_scc1 ch_done
    s_waitcnt vmcnt(0)
    v_sub_u32 v42, v42, v41
    v_cmp_gt_i32 vcc, 3, v42
    s_cbranch_vccz uw1_k2
    s_sleep 4
    s_branch uw1_s2
uw1_k2:
    s_cmp_eq_u32 s8, 0
    s_cbranch_scc0 ai_69
    v_mov_b32 v37, 8
    s_mov_b32 s12, 0
wc_70:
    buffer_load_dwordx2 v[38:39], v37, s[80:83], 0 offen sc1
    s_add_u32 s12, s12, 1
    s_cmp_gt_u32 s12, 3000000
    s_cbranch_scc1 ch_done
    s_waitcnt vmcnt(0)
    v_readfirstlane_b32 s13, v38
    s_nop 3
    s_cmp_ge_u32 s13, 256
    s_cbranch_scc1 wc_70_ok
    s_sleep 8
    s_branch wc_70
wc_70_ok:
    ds_write_b32 v50, v39
    v_readfirstlane_b32 s12, v39
    s_nop 3
    s_bcnt1_i32_b32 s12, s12
    s_cmp_eq_u32 s12, 1
    s_cselect_b32 s63, 1, 0
    v_min_u32 v18, 0xfffffffe, v18
    v_min_u32 v19, 0xfffffffe, v19
    s_cmp_eq_u32 s63, 0
    s_cbranch_scc1 mp_71_s
    buffer_store_dword v18, v13, s[36:39], 0 offen
    buffer_store_dword v19, v2, s[36:39], 0 offen
    buffer_store_dword v18, v11, s[36:39], 0 offen
    buffer_store_dword v19, v12, s[36:39], 0 offen
    s_branch mp_71_d
mp_71_s:
    buffer_store_dword v18, v13, s[36:39], 0 offen sc1
    buffer_store_dword v19, v2, s[36:39], 0 offen sc1
    buffer_store_dword v18, v11, s[36:39], 0 offen sc1
    buffer_store_dword v19, v12, s[36:39], 0 offen sc1
mp_71_d:
ai_69:
    buffer_load_dwordx4 a[12:15], v3, s[16:19], s88 offen offset:3072
    buffer_load_dwordx4 a[40:43], v44, s[16:19], s88 offen offset:2048
    buffer_load_dwordx4 a[68:71], v3, s[16:19], s89 offen offset:3072
    buffer_load_dwordx4 a[96:99], v44, s[16:19], s89 offen offset:2048
    buffer_load_dword v42, v40, s[32:35], 0 offen sc1
    buffer_load_dwordx4 a[124:127], v3, s[16:19], s90 offen offset:3072
    buffer_load_dwordx4 a[152:155], v44, s[16:19], s90 offen offset:2048
    buffer_load_dwordx4 a[180:183], v3, s[16:19], s91 offen offset:3072
    buffer_load_dwordx4 a[208:211], v44, s[16:19], s91 offen offset:2048
    buffer_load_dwordx4 v[100:103], v3, s[16:19], s92 offen offset:3072
    buffer_load_dwordx4 v[128:131], v44, s[16:19], s92 offen offset:2048
    buffer_load_dwordx4 v[156:159], v3, s[16:19], s93 offen offset:3072
    buffer_load_dwordx4 v[184:187], v44, s[16:19], s93 offen offset:2048
    buffer_load_dwordx4 v[212:215], v3, s[16:19], s94 offen offset:3072
    buffer_load_dwordx4 v[240:243], v44, s[16:19], s94 offen offset:2048
    s_waitcnt vmcnt(10)
    v_sub_u32 v42, v42, v41
    v_cmp_gt_i32 vcc, 4, v42
    s_cbranch_vccz uw1_k3
uw1_s3:
    buffer_load_dword v42, v40, s[32:35], 0 offen sc1
    s_add_u32 s62, s62, 1
    s_cmp_gt_u32 s62, 3000000
    s_cbranch_scc1 ch_done
    s_waitcnt vmcnt(0)
    v_sub_u32 v42, v42, v41
    v_cmp_gt_i32 vcc, 4, v42
    s_cbranch_vccz uw1_k3
    s_sleep 4
    s_branch uw1_s3
uw1_k3:
    buffer_load_dwordx4 a[16:19], v43, s[16:19], s88 offen offset:0
    buffer_load_dwordx4 a[44:47], v44, s[16:19], s88 offen offset:3072
    buffer_load_dwordx4 a[72:75], v43, s[16:19], s89 offen offset:0
    buffer_load_dwordx4 a[100:103], v44, s[16:19], s89 offen offset:3072
    buffer_load_dword v42, v40, s[32:35], 0 offen sc1
    buffer_load_dwordx4 a[128:131], v43, s[16:19], s90 offen offset:0
    buffer_load_dwordx4 a[156:159], v44, s[16:19], s90 offen offset:3072
    buffer_load_dwordx4 a[184:187], v43, s[16:19], s91 offen offset:0
    buffer_load_dwordx4 a[212:215], v44, s[16:19], s91 offen offset:3072
    buffer_load_dwordx4 v[104:107], v43, s[16:19], s92 offen offset:0
    buffer_load_dwordx4 v[132:135], v44, s[16:19], s92 offen offset:3072
    buffer_load_dwordx4 v[160:163], v43, s[16:19], s93 offen offset:0
    buffer_load_dwordx4 v[188:191], v44, s[16:19], s93 offen offset:3072
    buffer_load_dwordx4 v[216:219], v43, s[16:19], s94 offen offset:0
    buffer_load_dwordx4 v[244:247], v44, s[16:19], s94 offen offset:3072
    s_waitcnt vmcnt(10)
    v_sub_u32 v42, v42, v41
    v_cmp_gt_i32 vcc, 5, v42
    s_cbranch_vccz uw1_k4
uw1_s4:
    buffer_load_dword v42, v40, s[32:35], 0 offen sc1
    s_add_u32 s62, s62, 1
    s_cmp_gt_u32 s62, 3000000
    s_cbranch_scc1 ch_done
    s_waitcnt vmcnt(0)
    v_sub_u32 v42, v42, v41
    v_cmp_gt_i32 vcc, 5, v42
    s_cbranch_vccz uw1_k4
    s_sleep 4
    s_branch uw1_s4
uw1_k4:
    buffer_load_dwordx4 a[20:23], v43, s[16:19], s88 offen offset:1024
    buffer_load_dwordx4 a[48:51], v45, s[16:19], s88 offen offset:0
    buffer_load_dwordx4 a[76:79], v43, s[16:19], s89 offen offset:1024
    buffer_load_dwordx4 a[104:107], v45, s[16:19], s89 offen offset:0
    buffer_load_dword v42, v40, s[32:35], 0 offen sc1
    buffer_load_dwordx4 a[132:135], v43, s[16:19], s90 offen offset:1024
    buffer_load_dwordx4 a[160:163], v45, s[16:19], s90 offen offset:0
    buffer_load_dwordx4 a[188:191], v43, s[16:19], s91 offen offset:1024
    buffer_load_dwordx4 a[216:219], v45, s[16:19], s91 offen offset:0
    buffer_load_dwordx4 v[108:111], v43, s[16:19], s92 offen offset:1024
    buffer_load_dwordx4 v[136:139], v45, s[16:19], s92 offen offset:0
    buffer_load_dwordx4 v[164:167], v43, s[16:19], s93 offen offset:1024
    buffer_load_dwordx4 v[192:195], v45, s[16:19], s93 offen offset:0
    buffer_load_dwordx4 v[220:223], v43, s[16:19], s94 offen offset:1024
    buffer_load_dwordx4 v[248:251], v45, s[16:19], s94 offen offset:0
    s_waitcnt vmcnt(10)
    v_sub_u32 v42, v42, v41
    v_cmp_gt_i32 vcc, 6, v42
    s_cbranch_vccz uw1_k5
uw1_s5:
    buffer_load_dword v42, v40, s[32:35], 0 offen sc1
    s_add_u32 s62, s62, 1
    s_cmp_gt_u32 s62, 3000000
    s_cbranch_scc1 ch_done
    s_waitcnt vmcnt(0)
    v_sub_u32 v42, v42, v41
    v_cmp_gt_i32 vcc, 6, v42
    s_cbranch_vccz uw1_k5
    s_sleep 4
    s_branch uw1_s5
uw1_k5:
    buffer_load_dwordx4 a[24:27], v43, s[16:19], s88 offen offset:2048
    buffer_load_dwordx4 a[52:55], v45, s[16:19], s88 offen offset:1024
    buffer_load_dwordx4 a[80:83], v43, s[16:19], s89 offen offset:2048
    buffer_load_dwordx4 a[108:111], v45, s[16:19], s89 offen offset:1024
    buffer_load_dword v42, v40, s[32:35], 0 offen sc1
    buffer_load_dwordx4 a[136:139], v43, s[16:19], s90 offen offset:2048
    buffer_load_dwordx4 a[164:167], v45, s[16:19], s90 offen offset:1024
    buffer_load_dwordx4 a[192:195], v43, s[16:19], s91 offen offset:2048
    buffer_load_dwordx4 a[220:223], v45, s[16:19], s91 offen offset:1024
    buffer_load_dwordx4 v[112:115], v43, s[16:19], s92 offen offset:2048
    buffer_load_dwordx4 v[140:143], v45, s[16:19], s92 offen offset:1024
    buffer_load_dwordx4 v[168:171], v43, s[16:19], s93 offen offset:2048
    buffer_load_dwordx4 v[196:199], v45, s[16:19], s93 offen offset:1024
    buffer_load_dwordx4 v[224:227], v43, s[16:19], s94 offen offset:2048
    buffer_load_dwordx4 v[252:255], v45, s[16:19], s94 offen offset:1024
    s_waitcnt vmcnt(10)
    v_sub_u32 v42, v42, v41
    v_cmp_gt_i32 vcc, 7, v42
    s_cbranch_vccz uw1_k6
uw1_s6:
    buffer_load_dword v42, v40, s[32:35], 0 offen sc1
    s_add_u32 s62, s62, 1
    s_cmp_gt_u32 s62, 3000000
    s_cbranch_scc1 ch_done
    s_waitcnt vmcnt(0)
    v_sub_u32 v42, v42, v41
    v_cmp_gt_i32 vcc, 7, v42
    s_cbranch_vccz uw1_k6
    s_sleep 4
    s_branch uw1_s6
uw1_k6:
    buffer_load_dwordx4 a[0:3], v3, s[16:19], s88 offen offset:0
    buffer_load_dwordx4 a[28:31], v43, s[16:19], s88 offen offset:3072
    buffer_load_dwordx4 a[56:59], v3, s[16:19], s89 offen offset:0
    buffer_load_dwordx4 a[84:87], v43, s[16:19], s89 offen offset:3072
    buffer_load_dwordx4 a[112:115], v3, s[16:19], s90 offen offset:0
    buffer_load_dwordx4 a[140:143], v43, s[16:19], s90 offen offset:3072
    buffer_load_dwordx4 a[168:171], v3, s[16:19], s91 offen offset:0
    buffer_load_dwordx4 a[196:199], v43, s[16:19], s91 offen offset:3072
    buffer_load_dwordx4 v[88:91], v3, s[16:19], s92 offen offset:0
    buffer_load_dwordx4 v[116:119], v43, s[16:19], s92 offen offset:3072
    buffer_load_dwordx4 v[144:147], v3, s[16:19], s93 offen offset:0
    buffer_load_dwordx4 v[172:175], v43, s[16:19], s93 offen offset:3072
    buffer_load_dwordx4 v[200:203], v3, s[16:19], s94 offen offset:0
    buffer_load_dwordx4 v[228:231], v43, s[16:19], s94 offen offset:3072
    s_branch uw_d
uw_2:
    s_add_u32 s88, s13, 0
    s_add_u32 s89, s13, 14336
    s_add_u32 s90, s13, 28672
    s_add_u32 s91, s13, 43008
    s_add_u32 s92, s13, 57344
    s_add_u32 s93, s13, 71680
    s_add_u32 s94, s13, 86016
    v_add_u32 v43, 4096, v3
    v_add_u32 v44, 8192, v3
    v_add_u32 v45, 12288, v3
    s_mov_b32 s62, 0
uw2_s0:
    buffer_load_dword v42, v40, s[32:35], 0 offen sc1
    s_add_u32 s62, s62, 1
    s_cmp_gt_u32 s62, 3000000
    s_cbranch_scc1 ch_done
    s_waitcnt vmcnt(0)
    v_sub_u32 v42, v42, v41
    v_cmp_gt_i32 vcc, 1, v42
    s_cbranch_vccz uw2_k0
    s_sleep 4
    s_branch uw2_s0
uw2_k0:
    buffer_load_dwordx4 a[8:11], v3, s[16:19], s88 offen offset:2048
    buffer_load_dwordx4 a[36:39], v44, s[16:19], s88 offen offset:1024
    buffer_load_dwordx4 a[64:67], v3, s[16:19], s89 offen offset:2048
    buffer_load_dwordx4 a[92:95], v44, s[16:19], s89 offen offset:1024
    buffer_load_dword v42, v40, s[32:35], 0 offen sc1
    buffer_load_dwordx4 a[120:123], v3, s[16:19], s90 offen offset:2048
    buffer_load_dwordx4 a[148:151], v44, s[16:19], s90 offen offset:1024
    buffer_load_dwordx4 a[176:179], v3, s[16:19], s91 offen offset:2048
    buffer_load_dwordx4 a[204:207], v44, s[16:19], s91 offen offset:1024
    buffer_load_dwordx4 v[96:99], v3, s[16:19], s92 offen offset:2048
    buffer_load_dwordx4 v[124:127], v44, s[16:19], s92 offen offset:1024
    buffer_load_dwordx4 v[152:155], v3, s[16:19], s93 offen offset:2048
    buffer_load_dwordx4 v[180:183], v44, s[16:19], s93 offen offset:1024
    buffer_load_dwordx4 v[208:211], v3, s[16:19], s94 offen offset:2048
    buffer_load_dwordx4 v[236:239], v44, s[16:19], s94 offen offset:1024
    s_waitcnt vmcnt(10)
    v_sub_u32 v42, v42, v41
    v_cmp_gt_i32 vcc, 2, v42
    s_cbranch_vccz uw2_k1
uw2_s1:
    buffer_load_dword v42, v40, s[32:35], 0 offen sc1
    s_add_u32 s62, s62, 1
    s_cmp_gt_u32 s62, 3000000
    s_cbranch_scc1 ch_done
    s_waitcnt vmcnt(0)
    v_sub_u32 v42, v42, v41
    v_cmp_gt_i32 vcc, 2, v42
    s_cbranch_vccz uw2_k1
    s_sleep 4
    s_branch uw2_s1
uw2_k1:
    buffer_load_dwordx4 a[12:15], v3, s[16:19], s88 offen offset:3072
    buffer_load_dwordx4 a[40:43], v44, s[16:19], s88 offen offset:2048
    buffer_load_dwordx4 a[68:71], v3, s[16:19], s89 offen offset:3072
    buffer_load_dwordx4 a[96:99], v44, s[16:19], s89 offen offset:2048
    buffer_load_dword v42, v40, s[32:35], 0 offen sc1
    buffer_load_dwordx4 a[124:127], v3, s[16:19], s90 offen offset:3072
    buffer_load_dwordx4 a[152:155], v44, s[16:19], s90 offen offset:2048
    buffer_load_dwordx4 a[180:183], v3, s[16:19], s91 offen offset:3072
    buffer_load_dwordx4 a[208:211], v44, s[16:19], s91 offen offset:2048
    buffer_load_dwordx4 v[100:103], v3, s[16:19], s92 offen offset:3072
    buffer_load_dwordx4 v[128:131], v44, s[16:19], s92 offen offset:2048
    buffer_load_dwordx4 v[156:159], v3, s[16:19], s93 offen offset:3072
    buffer_load_dwordx4 v[184:187], v44, s[16:19], s93 offen offset:2048
    buffer_load_dwordx4 v[212:215], v3, s[16:19], s94 offen offset:3072
    buffer_load_dwordx4 v[240:243], v44, s[16:19], s94 offen offset:2048
    s_waitcnt vmcnt(10)
    v_sub_u32 v42, v42, v41
    v_cmp_gt_i32 vcc, 3, v42
    s_cbranch_vccz uw2_k2
uw2_s2:
    buffer_load_dword v42, v40, s[32:35], 0 offen sc1
    s_add_u32 s62, s62, 1
    s_cmp_gt_u32 s62, 3000000
    s_cbranch_scc1 ch_done
    s_waitcnt vmcnt(0)
    v_sub_u32 v42, v42, v41
    v_cmp_gt_i32 vcc, 3, v42
    s_cbranch_vccz uw2_k2
    s_sleep 4
    s_branch uw2_s2
uw2_k2:
    s_cmp_eq_u32 s8, 0
    s_cbranch_scc0 ai_72
    v_mov_b32 v37, 8
    s_mov_b32 s12, 0
wc_73:
    buffer_load_dwordx2 v[38:39], v37, s[80:83], 0 offen sc1
    s_add_u32 s12, s12, 1
    s_cmp_gt_u32 s12, 3000000
    s_cbranch_scc1 ch_done
    s_waitcnt vmcnt(0)
    v_readfirstlane_b32 s13, v38
    s_nop 3
    s_cmp_ge_u32 s13, 256
    s_cbranch_scc1 wc_73_ok
    s_sleep 8
    s_branch wc_73
wc_73_ok:
    ds_write_b32 v50, v39
    v_readfirstlane_b32 s12, v39
    s_nop 3
    s_bcnt1_i32_b32 s12, s12
    s_cmp_eq_u32 s12, 1
    s_cselect_b32 s63, 1, 0
    v_min_u32 v18, 0xfffffffe, v18
    v_min_u32 v19, 0xfffffffe, v19
    s_cmp_eq_u32 s63, 0
    s_cbranch_scc1 mp_74_s
    buffer_store_dword v18, v13, s[36:39], 0 offen
    buffer_store_dword v19, v2, s[36:39], 0 offen
    buffer_store_dword v18, v11, s[36:39], 0 offen
    buffer_store_dword v19, v12, s[36:39], 0 offen
    s_branch mp_74_d
mp_74_s:
    buffer_store_dword v18, v13, s[36:39], 0 offen sc1
    buffer_store_dword v19, v2, s[36:39], 0 offen sc1
    buffer_store_dword v18, v11, s[36:39], 0 offen sc1
    buffer_store_dword v19, v12, s[36:39], 0 offen sc1
mp_74_d:
ai_72:
    buffer_load_dwordx4 a[16:19], v43, s[16:19], s88 offen offset:0
    buffer_load_dwordx4 a[44:47], v44, s[16:19], s88 offen offset:3072
    buffer_load_dwordx4 a[72:75], v43, s[16:19], s89 offen offset:0
    buffer_load_dwordx4 a[100:103], v44, s[16:19], s89 offen offset:3072
    buffer_load_dword v42, v40, s[32:35], 0 offen sc1
    buffer_load_dwordx4 a[128:131], v43, s[16:19], s90 offen offset:0
    buffer_load_dwordx4 a[156:159], v44, s[16:19], s90 offen offset:3072
    buffer_load_dwordx4 a[184:187], v43, s[16:19], s91 offen offset:0
    buffer_load_dwordx4 a[212:215], v44, s[16:19], s91 offen offset:3072
    buffer_load_dwordx4 v[104:107], v43, s[16:19], s92 offen offset:0
    buffer_load_dwordx4 v[132:135], v44, s[16:19], s92 offen offset:3072
    buffer_load_dwordx4 v[160:163], v43, s[16:19], s93 offen offset:0
    buffer_load_dwordx4 v[188:191], v44, s[16:19], s93 offen offset:3072
    buffer_load_dwordx4 v[216:219], v43, s[16:19], s94 offen offset:0
    buffer_load_dwordx4 v[244:247], v44, s[16:19], s94 offen offset:3072
    s_waitcnt vmcnt(10)
    v_sub_u32 v42, v42, v41
    v_cmp_gt_i32 vcc, 4, v42
    s_cbranch_vccz uw2_k3
uw2_s3:
    buffer_load_dword v42, v40, s[32:35], 0 offen sc1
    s_add_u32 s62, s62, 1
    s_cmp_gt_u32 s62, 3000000
    s_cbranch_scc1 ch_done
    s_waitcnt vmcnt(0)
    v_sub_u32 v42, v42, v41
    v_cmp_gt_i32 vcc, 4, v42
    s_cbranch_vccz uw2_k3
    s_sleep 4
    s_branch uw2_s3
uw2_k3:
    buffer_load_dwordx4 a[20:23], v43, s[16:19], s88 offen offset:1024
    buffer_load_dwordx4 a[48:51], v45, s[16:19], s88 offen offset:0
    buffer_load_dwordx4 a[76:79], v43, s[16:19], s89 offen offset:1024
    buffer_load_dwordx4 a[104:107], v45, s[16:19], s89 offen offset:0
    buffer_load_dword v42, v40, s[32:35], 0 offen sc1
    buffer_load_dwordx4 a[132:135], v43, s[16:19], s90 offen offset:1024
    buffer_load_dwordx4 a[160:163], v45, s[16:19], s90 offen offset:0
    buffer_load_dwordx4 a[188:191], v43, s[16:19], s91 offen offset:1024
    buffer_load_dwordx4 a[216:219], v45, s[16:19], s91 offen offset:0
    buffer_load_dwordx4 v[108:111], v43, s[16:19], s92 offen offset:1024
    buffer_load_dwordx4 v[136:139], v45, s[16:19], s92 offen offset:0
    buffer_load_dwordx4 v[164:167], v43, s[16:19], s93 offen offset:1024
    buffer_load_dwordx4 v[192:195], v45, s[16:19], s93 offen offset:0
    buffer_load_dwordx4 v[220:223], v43, s[16:19], s94 offen offset:1024
    buffer_load_dwordx4 v[248:251], v45, s[16:19], s94 offen offset:0
    s_waitcnt vmcnt(10)
    v_sub_u32 v42, v42, v41
    v_cmp_gt_i32 vcc, 5, v42
    s_cbranch_vccz uw2_k4
uw2_s4:
    buffer_load_dword v42, v40, s[32:35], 0 offen sc1
    s_add_u32 s62, s62, 1
    s_cmp_gt_u32 s62, 3000000
    s_cbranch_scc1 ch_done
    s_waitcnt vmcnt(0)
    v_sub_u32 v42, v42, v41
    v_cmp_gt_i32 vcc, 5, v42
    s_cbranch_vccz uw2_k4
    s_sleep 4
    s_branch uw2_s4
uw2_k4:
    buffer_load_dwordx4 a[24:27], v43, s[16:19], s88 offen offset:2048
    buffer_load_dwordx4 a[52:55], v45, s[16:19], s88 offen offset:1024
    buffer_load_dwordx4 a[80:83], v43, s[16:19], s89 offen offset:2048
    buffer_load_dwordx4 a[108:111], v45, s[16:19], s89 offen offset:1024
    buffer_load_dword v42, v40, s[32:35], 0 offen sc1
    buffer_load_dwordx4 a[136:139], v43, s[16:19], s90 offen offset:2048
    buffer_load_dwordx4 a[164:167], v45, s[16:19], s90 offen offset:1024
    buffer_load_dwordx4 a[192:195], v43, s[16:19], s91 offen offset:2048
    buffer_load_dwordx4 a[220:223], v45, s[16:19], s91 offen offset:1024
    buffer_load_dwordx4 v[112:115], v43, s[16:19], s92 offen offset:2048
    buffer_load_dwordx4 v[140:143], v45, s[16:19], s92 offen offset:1024
    buffer_load_dwordx4 v[168:171], v43, s[16:19], s93 offen offset:2048
    buffer_load_dwordx4 v[196:199], v45, s[16:19], s93 offen offset:1024
    buffer_load_dwordx4 v[224:227], v43, s[16:19], s94 offen offset:2048
    buffer_load_dwordx4 v[252:255], v45, s[16:19], s94 offen offset:1024
    s_waitcnt vmcnt(10)
    v_sub_u32 v42, v42, v41
    v_cmp_gt_i32 vcc, 6, v42
    s_cbranch_vccz uw2_k5
uw2_s5:
    buffer_load_dword v42, v40, s[32:35], 0 offen sc1
    s_add_u32 s62, s62, 1
    s_cmp_gt_u32 s62, 3000000
    s_cbranch_scc1 ch_done
    s_waitcnt vmcnt(0)
    v_sub_u32 v42, v42, v41
    v_cmp_gt_i32 vcc, 6, v42
    s_cbranch_vccz uw2_k5
    s_sleep 4
    s_branch uw2_s5
uw2_k5:
    buffer_load_dwordx4 a[0:3], v3, s[16:19], s88 offen offset:0
    buffer_load_dwordx4 a[28:31], v43, s[16:19], s88 offen offset:3072
    buffer_load_dwordx4 a[56:59], v3, s[16:19], s89 offen offset:0
    buffer_load_dwordx4 a[84:87], v43, s[16:19], s89 offen offset:3072
    buffer_load_dword v42, v40, s[32:35], 0 offen sc1
    buffer_load_dwordx4 a[112:115], v3, s[16:19], s90 offen offset:0
    buffer_load_dwordx4 a[140:143], v43, s[16:19], s90 offen offset:3072
    buffer_load_dwordx4 a[168:171], v3, s[16:19], s91 offen offset:0
    buffer_load_dwordx4 a[196:199], v43, s[16:19], s91 offen offset:3072
    buffer_load_dwordx4 v[88:91], v3, s[16:19], s92 offen offset:0
    buffer_load_dwordx4 v[116:119], v43, s[16:19], s92 offen offset:3072
    buffer_load_dwordx4 v[144:147], v3, s[16:19], s93 offen offset:0
    buffer_load_dwordx4 v[172:175], v43, s[16:19], s93 offen offset:3072
    buffer_load_dwordx4 v[200:203], v3, s[16:19], s94 offen offset:0
    buffer_load_dwordx4 v[228:231], v43, s[16:19], s94 offen offset:3072
    s_waitcnt vmcnt(10)
    v_sub_u32 v42, v42, v41
    v_cmp_gt_i32 vcc, 7, v42
    s_cbranch_vccz uw2_k6
uw2_s6:
    buffer_load_dword v42, v40, s[32:35], 0 offen sc1
    s_add_u32 s62, s62, 1
    s_cmp_gt_u32 s62, 3000000
    s_cbranch_scc1 ch_done
    s_waitcnt vmcnt(0)
    v_sub_u32 v42, v42, v41
    v_cmp_gt_i32 vcc, 7, v42
    s_cbranch_vccz uw2_k6
    s_sleep 4
    s_branch uw2_s6
uw2_k6:
    buffer_load_dwordx4 a[4:7], v3, s[16:19], s88 offen offset:1024
    buffer_load_dwordx4 a[32:35], v44, s[16:19], s88 offen offset:0
    buffer_load_dwordx4 a[60:63], v3, s[16:19], s89 offen offset:1024
    buffer_load_dwordx4 a[88:91], v44, s[16:19], s89 offen offset:0
    buffer_load_dwordx4 a[116:119], v3, s[16:19], s90 offen offset:1024
    buffer_load_dwordx4 a[144:147], v44, s[16:19], s90 offen offset:0
    buffer_load_dwordx4 a[172:175], v3, s[16:19], s91 offen offset:1024
    buffer_load_dwordx4 a[200:203], v44, s[16:19], s91 offen offset:0
    buffer_load_dwordx4 v[92:95], v3, s[16:19], s92 offen offset:1024
    buffer_load_dwordx4 v[120:123], v44, s[16:19], s92 offen offset:0
    buffer_load_dwordx4 v[148:151], v3, s[16:19], s93 offen offset:1024
    buffer_load_dwordx4 v[176:179], v44, s[16:19], s93 offen offset:0
    buffer_load_dwordx4 v[204:207], v3, s[16:19], s94 offen offset:1024
    buffer_load_dwordx4 v[232:235], v44, s[16:19], s94 offen offset:0
    s_branch uw_d
uw_3:
    s_add_u32 s88, s13, 0
    s_add_u32 s89, s13, 14336
    s_add_u32 s90, s13, 28672
    s_add_u32 s91, s13, 43008
    s_add_u32 s92, s13, 57344
    s_add_u32 s93, s13, 71680
    s_add_u32 s94, s13, 86016
    v_add_u32 v43, 4096, v3
    v_add_u32 v44, 8192, v3
    v_add_u32 v45, 12288, v3
    s_mov_b32 s62, 0
uw3_s0:
    buffer_load_dword v42, v40, s[32:35], 0 offen sc1
    s_add_u32 s62, s62, 1
    s_cmp_gt_u32 s62, 3000000
    s_cbranch_scc1 ch_done
    s_waitcnt vmcnt(0)
    v_sub_u32 v42, v42, v41
    v_cmp_gt_i32 vcc, 1, v42
    s_cbranch_vccz uw3_k0
    s_sleep 4
    s_branch uw3_s0
uw3_k0:
    buffer_load_dwordx4 a[12:15], v3, s[16:19], s88 offen offset:3072
    buffer_load_dwordx4 a[40:43], v44, s[16:19], s88 offen offset:2048
    buffer_load_dwordx4 a[68:71], v3, s[16:19], s89 offen offset:3072
    buffer_load_dwordx4 a[96:99], v44, s[16:19], s89 offen offset:2048
    buffer_load_dword v42, v40, s[32:35], 0 offen sc1
    buffer_load_dwordx4 a[124:127], v3, s[16:19], s90 offen offset:3072
    buffer_load_dwordx4 a[152:155], v44, s[16:19], s90 offen offset:2048
    buffer_load_dwordx4 a[180:183], v3, s[16:19], s91 offen offset:3072
    buffer_load_dwordx4 a[208:211], v44, s[16:19], s91 offen offset:2048
    buffer_load_dwordx4 v[100:103], v3, s[16:19], s92 offen offset:3072
    buffer_load_dwordx4 v[128:131], v44, s[16:19], s92 offen offset:2048
    buffer_load_dwordx4 v[156:159], v3, s[16:19], s93 offen offset:3072
    buffer_load_dwordx4 v[184:187], v44, s[16:19], s93 offen offset:2048
    buffer_load_dwordx4 v[212:215], v3, s[16:19], s94 offen offset:3072
    buffer_load_dwordx4 v[240:243], v44, s[16:19], s94 offen offset:2048
    s_waitcnt vmcnt(10)
    v_sub_u32 v42, v42, v41
    v_cmp_gt_i32 vcc, 2, v42
    s_cbranch_vccz uw3_k1
uw3_s1:
    buffer_load_dword v42, v40, s[32:35], 0 offen sc1
    s_add_u32 s62, s62, 1
    s_cmp_gt_u32 s62, 3000000
    s_cbranch_scc1 ch_done
    s_waitcnt vmcnt(0)
    v_sub_u32 v42, v42, v41
    v_cmp_gt_i32 vcc, 2, v42
    s_cbranch_vccz uw3_k1
    s_sleep 4
    s_branch uw3_s1
uw3_k1:
    buffer_load_dwordx4 a[16:19], v43, s[16:19], s88 offen offset:0
    buffer_load_dwordx4 a[44:47], v44, s[16:19], s88 offen offset:3072
    buffer_load_dwordx4 a[72:75], v43, s[16:19], s89 offen offset:0
    buffer_load_dwordx4 a[100:103], v44, s[16:19], s89 offen offset:3072
    buffer_load_dword v42, v40, s[32:35], 0 offen sc1
    buffer_load_dwordx4 a[128:131], v43, s[16:19], s90 offen offset:0
    buffer_load_dwordx4 a[156:159], v44, s[16:19], s90 offen offset:3072
    buffer_load_dwordx4 a[184:187], v43, s[16:19], s91 offen offset:0
    buffer_load_dwordx4 a[212:215], v44, s[16:19], s91 offen offset:3072
    buffer_load_dwordx4 v[104:107], v43, s[16:19], s92 offen offset:0
    buffer_load_dwordx4 v[132:135], v44, s[16:19], s92 offen offset:3072
    buffer_load_dwordx4 v[160:163], v43, s[16:19], s93 offen offset:0
    buffer_load_dwordx4 v[188:191], v44, s[16:19], s93 offen offset:3072
    buffer_load_dwordx4 v[216:219], v43, s[16:19], s94 offen offset:0
    buffer_load_dwordx4 v[244:247], v44, s[16:19], s94 offen offset:3072
    s_waitcnt vmcnt(10)
    v_sub_u32 v42, v42, v41
    v_cmp_gt_i32 vcc, 3, v42
    s_cbranch_vccz uw3_k2
uw3_s2:
    buffer_load_dword v42, v40, s[32:35], 0 offen sc1
    s_add_u32 s62, s62, 1
    s_cmp_gt_u32 s62, 3000000
    s_cbranch_scc1 ch_done
    s_waitcnt vmcnt(0)
    v_sub_u32 v42, v42, v41
    v_cmp_gt_i32 vcc, 3, v42
    s_cbranch_vccz uw3_k2
    s_sleep 4
    s_branch uw3_s2
uw3_k2:
    s_cmp_eq_u32 s8, 0
    s_cbranch_scc0 ai_75
    v_mov_b32 v37, 8
    s_mov_b32 s12, 0
wc_76:
    buffer_load_dwordx2 v[38:39], v37, s[80:83], 0 offen sc1
    s_add_u32 s12, s12, 1
    s_cmp_gt_u32 s12, 3000000
    s_cbranch_scc1 ch_done
    s_waitcnt vmcnt(0)
    v_readfirstlane_b32 s13, v38
    s_nop 3
    s_cmp_ge_u32 s13, 256
    s_cbranch_scc1 wc_76_ok
    s_sleep 8
    s_branch wc_76
wc_76_ok:
    ds_write_b32 v50, v39
    v_readfirstlane_b32 s12, v39
    s_nop 3
    s_bcnt1_i32_b32 s12, s12
    s_cmp_eq_u32 s12, 1
    s_cselect_b32 s63, 1, 0
    v_min_u32 v18, 0xfffffffe, v18
    v_min_u32 v19, 0xfffffffe, v19
    s_cmp_eq_u32 s63, 0
    s_cbranch_scc1 mp_77_s
    buffer_store_dword v18, v13, s[36:39], 0 offen
    buffer_store_dword v19, v2, s[36:39], 0 offen
    buffer_store_dword v18, v11, s[36:39], 0 offen
    buffer_store_dword v19, v12, s[36:39], 0 offen
    s_branch mp_77_d
mp_77_s:
    buffer_store_dword v18, v13, s[36:39], 0 offen sc1
    buffer_store_dword v19, v2, s[36:39], 0 offen sc1
    buffer_store_dword v18, v11, s[36:39], 0 offen sc1
    buffer_store_dword v19, v12, s[36:39], 0 offen sc1
mp_77_d:
ai_75:
    buffer_load_dwordx4 a[20:23], v43, s[16:19], s88 offen offset:1024
    buffer_load_dwordx4 a[48:51], v45, s[16:19], s88 offen offset:0
    buffer_load_dwordx4 a[76:79], v43, s[16:19], s89 offen offset:1024
    buffer_load_dwordx4 a[104:107], v45, s[16:19], s89 offen offset:0
    buffer_load_dword v42, v40, s[32:35], 0 offen sc1
    buffer_load_dwordx4 a[132:135], v43, s[16:19], s90 offen offset:1024
    buffer_load_dwordx4 a[160:163], v45, s[16:19], s90 offen offset:0
    buffer_load_dwordx4 a[188:191], v43, s[16:19], s91 offen offset:1024
    buffer_load_dwordx4 a[216:219], v45, s[16:19], s91 offen offset:0
    buffer_load_dwordx4 v[108:111], v43, s[16:19], s92 offen offset:1024
    buffer_load_dwordx4 v[136:139], v45, s[16:19], s92 offen offset:0
    buffer_load_dwordx4 v[164:167], v43, s[16:19], s93 offen offset:1024
    buffer_load_dwordx4 v[192:195], v45, s[16:19], s93 offen offset:0
    buffer_load_dwordx4 v[220:223], v43, s[16:19], s94 offen offset:1024
    buffer_load_dwordx4 v[248:251], v45, s[16:19], s94 offen offset:0
    s_waitcnt vmcnt(10)
    v_sub_u32 v42, v42, v41
    v_cmp_gt_i32 vcc, 4, v42
    s_cbranch_vccz uw3_k3
uw3_s3:
    buffer_load_dword v42, v40, s[32:35], 0 offen sc1
    s_add_u32 s62, s62, 1
    s_cmp_gt_u32 s62, 3000000
    s_cbranch_scc1 ch_done
    s_waitcnt vmcnt(0)
    v_sub_u32 v42, v42, v41
    v_cmp_gt_i32 vcc, 4, v42
    s_cbranch_vccz uw3_k3
    s_sleep 4
    s_branch uw3_s3
uw3_k3:
    buffer_load_dwordx4 a[24:27], v43, s[16:19], s88 offen offset:2048
    buffer_load_dwordx4 a[52:55], v45, s[16:19], s88 offen offset:1024
    buffer_load_dwordx4 a[80:83], v43, s[16:19], s89 offen offset:2048
    buffer_load_dwordx4 a[108:111], v45, s[16:19], s89 offen offset:1024
    buffer_load_dword v42, v40, s[32:35], 0 offen sc1
    buffer_load_dwordx4 a[136:139], v43, s[16:19], s90 offen offset:2048
    buffer_load_dwordx4 a[164:167], v45, s[16:19], s90 offen offset:1024
    buffer_load_dwordx4 a[192:195], v43, s[16:19], s91 offen offset:2048
    buffer_load_dwordx4 a[220:223], v45, s[16:19], s91 offen offset:1024
    buffer_load_dwordx4 v[112:115], v43, s[16:19], s92 offen offset:2048
    buffer_load_dwordx4 v[140:143], v45, s[16:19], s92 offen offset:1024
    buffer_load_dwordx4 v[168:171], v43, s[16:19], s93 offen offset:2048
    buffer_load_dwordx4 v[196:199], v45, s[16:19], s93 offen offset:1024
    buffer_load_dwordx4 v[224:227], v43, s[16:19], s94 offen offset:2048
    buffer_load_dwordx4 v[252:255], v45, s[16:19], s94 offen offset:1024
    s_waitcnt vmcnt(10)
    v_sub_u32 v42, v42, v41
    v_cmp_gt_i32 vcc, 5, v42
    s_cbranch_vccz uw3_k4
uw3_s4:
    buffer_load_dword v42, v40, s[32:35], 0 offen sc1
    s_add_u32 s62, s62, 1
    s_cmp_gt_u32 s62, 3000000
    s_cbranch_scc1 ch_done
    s_waitcnt vmcnt(0)
    v_sub_u32 v42, v42, v41
    v_cmp_gt_i32 vcc, 5, v42
    s_cbranch_vccz uw3_k4
    s_sleep 4
    s_branch uw3_s4
uw3_k4:
    buffer_load_dwordx4 a[0:3], v3, s[16:19], s88 offen offset:0
    buffer_load_dwordx4 a[28:31], v43, s[16:19], s88 offen offset:3072
    buffer_load_dwordx4 a[56:59], v3, s[16:19], s89 offen offset:0
    buffer_load_dwordx4 a[84:87], v43, s[16:19], s89 offen offset:3072
    buffer_load_dword v42, v40, s[32:35], 0 offen sc1
    buffer_load_dwordx4 a[112:115], v3, s[16:19], s90 offen offset:0
    buffer_load_dwordx4 a[140:143], v43, s[16:19], s90 offen offset:3072
    buffer_load_dwordx4 a[168:171], v3, s[16:19], s91 offen offset:0
    buffer_load_dwordx4 a[196:199], v43, s[16:19], s91 offen offset:3072
    buffer_load_dwordx4 v[88:91], v3, s[16:19], s92 offen offset:0
    buffer_load_dwordx4 v[116:119], v43, s[16:19], s92 offen offset:3072
    buffer_load_dwordx4 v[144:147], v3, s[16:19], s93 offen offset:0
    buffer_load_dwordx4 v[172:175], v43, s[16:19], s93 offen offset:3072
    buffer_load_dwordx4 v[200:203], v3, s[16:19], s94 offen offset:0
    buffer_load_dwordx4 v[228:231], v43, s[16:19], s94 offen offset:3072
    s_waitcnt vmcnt(10)
    v_sub_u32 v42, v42, v41
    v_cmp_gt_i32 vcc, 6, v42
    s_cbranch_vccz uw3_k5
uw3_s5:
    buffer_load_dword v42, v40, s[32:35], 0 offen sc1
    s_add_u32 s62, s62, 1
    s_cmp_gt_u32 s62, 3000000
    s_cbranch_scc1 ch_done
    s_waitcnt vmcnt(0)
    v_sub_u32 v42, v42, v41
    v_cmp_gt_i32 vcc, 6, v42
    s_cbranch_vccz uw3_k5
    s_sleep 4
    s_branch uw3_s5
uw3_k5:
    buffer_load_dwordx4 a[4:7], v3, s[16:19], s88 offen offset:1024
    buffer_load_dwordx4 a[32:35], v44, s[16:19], s88 offen offset:0
    buffer_load_dwordx4 a[60:63], v3, s[16:19], s89 offen offset:1024
    buffer_load_dwordx4 a[88:91], v44, s[16:19], s89 offen offset:0
    buffer_load_dword v42, v40, s[32:35], 0 offen sc1
    buffer_load_dwordx4 a[116:119], v3, s[16:19], s90 offen offset:1024
    buffer_load_dwordx4 a[144:147], v44, s[16:19], s90 offen offset:0
    buffer_load_dwordx4 a[172:175], v3, s[16:19], s91 offen offset:1024
    buffer_load_dwordx4 a[200:203], v44, s[16:19], s91 offen offset:0
    buffer_load_dwordx4 v[92:95], v3, s[16:19], s92 offen offset:1024
    buffer_load_dwordx4 v[120:123], v44, s[16:19], s92 offen offset:0
    buffer_load_dwordx4 v[148:151], v3, s[16:19], s93 offen offset:1024
    buffer_load_dwordx4 v[176:179], v44, s[16:19], s93 offen offset:0
    buffer_load_dwordx4 v[204:207], v3, s[16:19], s94 offen offset:1024
    buffer_load_dwordx4 v[232:235], v44, s[16:19], s94 offen offset:0
    s_waitcnt vmcnt(10)
    v_sub_u32 v42, v42, v41
    v_cmp_gt_i32 vcc, 7, v42
    s_cbranch_vccz uw3_k6
uw3_s6:
    buffer_load_dword v42, v40, s[32:35], 0 offen sc1
    s_add_u32 s62, s62, 1
    s_cmp_gt_u32 s62, 3000000
    s_cbranch_scc1 ch_done
    s_waitcnt vmcnt(0)
    v_sub_u32 v42, v42, v41
    v_cmp_gt_i32 vcc, 7, v42
    s_cbranch_vccz uw3_k6
    s_sleep 4
    s_branch uw3_s6
uw3_k6:
    buffer_load_dwordx4 a[8:11], v3, s[16:19], s88 offen offset:2048
    buffer_load_dwordx4 a[36:39], v44, s[16:19], s88 offen offset:1024
    buffer_load_dwordx4 a[64:67], v3, s[16:19], s89 offen offset:2048
    buffer_load_dwordx4 a[92:95], v44, s[16:19], s89 offen offset:1024
    buffer_load_dwordx4 a[120:123], v3, s[16:19], s90 offen offset:2048
    buffer_load_dwordx4 a[148:151], v44, s[16:19], s90 offen offset:1024
    buffer_load_dwordx4 a[176:179], v3, s[16:19], s91 offen offset:2048
    buffer_load_dwordx4 a[204:207], v44, s[16:19], s91 offen offset:1024
    buffer_load_dwordx4 v[96:99], v3, s[16:19], s92 offen offset:2048
    buffer_load_dwordx4 v[124:127], v44, s[16:19], s92 offen offset:1024
    buffer_load_dwordx4 v[152:155], v3, s[16:19], s93 offen offset:2048
    buffer_load_dwordx4 v[180:183], v44, s[16:19], s93 offen offset:1024
    buffer_load_dwordx4 v[208:211], v3, s[16:19], s94 offen offset:2048
    buffer_load_dwordx4 v[236:239], v44, s[16:19], s94 offen offset:1024
    s_branch uw_d
uw_4:
    s_add_u32 s88, s13, 0
    s_add_u32 s89, s13, 14336
    s_add_u32 s90, s13, 28672
    s_add_u32 s91, s13, 43008
    s_add_u32 s92, s13, 57344
    s_add_u32 s93, s13, 71680
    s_add_u32 s94, s13, 86016
    v_add_u32 v43, 4096, v3
    v_add_u32 v44, 8192, v3
    v_add_u32 v45, 12288, v3
    s_mov_b32 s62, 0
uw4_s0:
    buffer_load_dword v42, v40, s[32:35], 0 offen sc1
    s_add_u32 s62, s62, 1
    s_cmp_gt_u32 s62, 3000000
    s_cbranch_scc1 ch_done
    s_waitcnt vmcnt(0)
    v_sub_u32 v42, v42, v41
    v_cmp_gt_i32 vcc, 1, v42
    s_cbranch_vccz uw4_k0
    s_sleep 4
    s_branch uw4_s0
uw4_k0:
    buffer_load_dwordx4 a[16:19], v43, s[16:19], s88 offen offset:0
    buffer_load_dwordx4 a[44:47], v44, s[16:19], s88 offen offset:3072
    buffer_load_dwordx4 a[72:75], v43, s[16:19], s89 offen offset:0
    buffer_load_dwordx4 a[100:103], v44, s[16:19], s89 offen offset:3072
    buffer_load_dword v42, v40, s[32:35], 0 offen sc1
    buffer_load_dwordx4 a[128:131], v43, s[16:19], s90 offen offset:0
    buffer_load_dwordx4 a[156:159], v44, s[16:19], s90 offen offset:3072
    buffer_load_dwordx4 a[184:187], v43, s[16:19], s91 offen offset:0
    buffer_load_dwordx4 a[212:215], v44, s[16:19], s91 offen offset:3072
    buffer_load_dwordx4 v[104:107], v43, s[16:19], s92 offen offset:0
    buffer_load_dwordx4 v[132:135], v44, s[16:19], s92 offen offset:3072
    buffer_load_dwordx4 v[160:163], v43, s[16:19], s93 offen offset:0
    buffer_load_dwordx4 v[188:191], v44, s[16:19], s93 offen offset:3072
    buffer_load_dwordx4 v[216:219], v43, s[16:19], s94 offen offset:0
    buffer_load_dwordx4 v[244:247], v44, s[16:19], s94 offen offset:3072
    s_waitcnt vmcnt(10)
    v_sub_u32 v42, v42, v41
    v_cmp_gt_i32 vcc, 2, v42
    s_cbranch_vccz uw4_k1
uw4_s1:
    buffer_load_dword v42, v40, s[32:35], 0 offen sc1
    s_add_u32 s62, s62, 1
    s_cmp_gt_u32 s62, 3000000
    s_cbranch_scc1 ch_done
    s_waitcnt vmcnt(0)
    v_sub_u32 v42, v42, v41
    v_cmp_gt_i32 vcc, 2, v42
    s_cbranch_vccz uw4_k1
    s_sleep 4
    s_branch uw4_s1
uw4_k1:
    buffer_load_dwordx4 a[20:23], v43, s[16:19], s88 offen offset:1024
    buffer_load_dwordx4 a[48:51], v45, s[16:19], s88 offen offset:0
    buffer_load_dwordx4 a[76:79], v43, s[16:19], s89 offen offset:1024
    buffer_load_dwordx4 a[104:107], v45, s[16:19], s89 offen offset:0
    buffer_load_dword v42, v40, s[32:35], 0 offen sc1
    buffer_load_dwordx4 a[132:135], v43, s[16:19], s90 offen offset:1024
    buffer_load_dwordx4 a[160:163], v45, s[16:19], s90 offen offset:0
    buffer_load_dwordx4 a[188:191], v43, s[16:19], s91 offen offset:1024
    buffer_load_dwordx4 a[216:219], v45, s[16:19], s91 offen offset:0
    buffer_load_dwordx4 v[108:111], v43, s[16:19], s92 offen offset:1024
    buffer_load_dwordx4 v[136:139], v45, s[16:19], s92 offen offset:0
    buffer_load_dwordx4 v[164:167], v43, s[16:19], s93 offen offset:1024
    buffer_load_dwordx4 v[192:195], v45, s[16:19], s93 offen offset:0
    buffer_load_dwordx4 v[220:223], v43, s[16:19], s94 offen offset:1024
    buffer_load_dwordx4 v[248:251], v45, s[16:19], s94 offen offset:0
    s_waitcnt vmcnt(10)
    v_sub_u32 v42, v42, v41
    v_cmp_gt_i32 vcc, 3, v42
    s_cbranch_vccz uw4_k2
uw4_s2:
    buffer_load_dword v42, v40, s[32:35], 0 offen sc1
    s_add_u32 s62, s62, 1
    s_cmp_gt_u32 s62, 3000000
    s_cbranch_scc1 ch_done
    s_waitcnt vmcnt(0)
    v_sub_u32 v42, v42, v41
    v_cmp_gt_i32 vcc, 3, v42
    s_cbranch_vccz uw4_k2
    s_sleep 4
    s_branch uw4_s2
uw4_k2:
    s_cmp_eq_u32 s8, 0
    s_cbranch_scc0 ai_78
    v_mov_b32 v37, 8
    s_mov_b32 s12, 0
wc_79:
    buffer_load_dwordx2 v[38:39], v37, s[80:83], 0 offen sc1
    s_add_u32 s12, s12, 1
    s_cmp_gt_u32 s12, 3000000
    s_cbranch_scc1 ch_done
    s_waitcnt vmcnt(0)
    v_readfirstlane_b32 s13, v38
    s_nop 3
    s_cmp_ge_u32 s13, 256
    s_cbranch_scc1 wc_79_ok
    s_sleep 8
    s_branch wc_79
wc_79_ok:
    ds_write_b32 v50, v39
    v_readfirstlane_b32 s12, v39
    s_nop 3
    s_bcnt1_i32_b32 s12, s12
    s_cmp_eq_u32 s12, 1
    s_cselect_b32 s63, 1, 0
    v_min_u32 v18, 0xfffffffe, v18
    v_min_u32 v19, 0xfffffffe, v19
    s_cmp_eq_u32 s63, 0
    s_cbranch_scc1 mp_80_s
    buffer_store_dword v18, v13, s[36:39], 0 offen
    buffer_store_dword v19, v2, s[36:39], 0 offen
    buffer_store_dword v18, v11, s[36:39], 0 offen
    buffer_store_dword v19, v12, s[36:39], 0 offen
    s_branch mp_80_d
mp_80_s:
    buffer_store_dword v18, v13, s[36:39], 0 offen sc1
    buffer_store_dword v19, v2, s[36:39], 0 offen sc1
    buffer_store_dword v18, v11, s[36:39], 0 offen sc1
    buffer_store_dword v19, v12, s[36:39], 0 offen sc1
mp_80_d:
ai_78:
    buffer_load_dwordx4 a[24:27], v43, s[16:19], s88 offen offset:2048
    buffer_load_dwordx4 a[52:55], v45, s[16:19], s88 offen offset:1024
    buffer_load_dwordx4 a[80:83], v43, s[16:19], s89 offen offset:2048
    buffer_load_dwordx4 a[108:111], v45, s[16:19], s89 offen offset:1024
    buffer_load_dword v42, v40, s[32:35], 0 offen sc1
    buffer_load_dwordx4 a[136:139], v43, s[16:19], s90 offen offset:2048
    buffer_load_dwordx4 a[164:167], v45, s[16:19], s90 offen offset:1024
    buffer_load_dwordx4 a[192:195], v43, s[16:19], s91 offen offset:2048
    buffer_load_dwordx4 a[220:223], v45, s[16:19], s91 offen offset:1024
    buffer_load_dwordx4 v[112:115], v43, s[16:19], s92 offen offset:2048
    buffer_load_dwordx4 v[140:143], v45, s[16:19], s92 offen offset:1024
    buffer_load_dwordx4 v[168:171], v43, s[16:19], s93 offen offset:2048
    buffer_load_dwordx4 v[196:199], v45, s[16:19], s93 offen offset:1024
    buffer_load_dwordx4 v[224:227], v43, s[16:19], s94 offen offset:2048
    buffer_load_dwordx4 v[252:255], v45, s[16:19], s94 offen offset:1024
    s_waitcnt vmcnt(10)
    v_sub_u32 v42, v42, v41
    v_cmp_gt_i32 vcc, 4, v42
    s_cbranch_vccz uw4_k3
uw4_s3:
    buffer_load_dword v42, v40, s[32:35], 0 offen sc1
    s_add_u32 s62, s62, 1
    s_cmp_gt_u32 s62, 3000000
    s_cbranch_scc1 ch_done
    s_waitcnt vmcnt(0)
    v_sub_u32 v42, v42, v41
    v_cmp_gt_i32 vcc, 4, v42
    s_cbranch_vccz uw4_k3
    s_sleep 4
    s_branch uw4_s3
uw4_k3:
    buffer_load_dwordx4 a[0:3], v3, s[16:19], s88 offen offset:0
    buffer_load_dwordx4 a[28:31], v43, s[16:19], s88 offen offset:3072
    buffer_load_dwordx4 a[56:59], v3, s[16:19], s89 offen offset:0
    buffer_load_dwordx4 a[84:87], v43, s[16:19], s89 offen offset:3072
    buffer_load_dword v42, v40, s[32:35], 0 offen sc1
    buffer_load_dwordx4 a[112:115], v3, s[16:19], s90 offen offset:0
    buffer_load_dwordx4 a[140:143], v43, s[16:19], s90 offen offset:3072
    buffer_load_dwordx4 a[168:171], v3, s[16:19], s91 offen offset:0
    buffer_load_dwordx4 a[196:199], v43, s[16:19], s91 offen offset:3072
    buffer_load_dwordx4 v[88:91], v3, s[16:19], s92 offen offset:0
    buffer_load_dwordx4 v[116:119], v43, s[16:19], s92 offen offset:3072
    buffer_load_dwordx4 v[144:147], v3, s[16:19], s93 offen offset:0
    buffer_load_dwordx4 v[172:175], v43, s[16:19], s93 offen offset:3072
    buffer_load_dwordx4 v[200:203], v3, s[16:19], s94 offen offset:0
    buffer_load_dwordx4 v[228:231], v43, s[16:19], s94 offen offset:3072
    s_waitcnt vmcnt(10)
    v_sub_u32 v42, v42, v41
    v_cmp_gt_i32 vcc, 5, v42
    s_cbranch_vccz uw4_k4
uw4_s4:
    buffer_load_dword v42, v40, s[32:35], 0 offen sc1
    s_add_u32 s62, s62, 1
    s_cmp_gt_u32 s62, 3000000
    s_cbranch_scc1 ch_done
    s_waitcnt vmcnt(0)
    v_sub_u32 v42, v42, v41
    v_cmp_gt_i32 vcc, 5, v42
    s_cbranch_vccz uw4_k4
    s_sleep 4
    s_branch uw4_s4
uw4_k4:
    buffer_load_dwordx4 a[4:7], v3, s[16:19], s88 offen offset:1024
    buffer_load_dwordx4 a[32:35], v44, s[16:19], s88 offen offset:0
    buffer_load_dwordx4 a[60:63], v3, s[16:19], s89 offen offset:1024
    buffer_load_dwordx4 a[88:91], v44, s[16:19], s89 offen offset:0
    buffer_load_dword v42, v40, s[32:35], 0 offen sc1
    buffer_load_dwordx4 a[116:119], v3, s[16:19], s90 offen offset:1024
    buffer_load_dwordx4 a[144:147], v44, s[16:19], s90 offen offset:0
    buffer_load_dwordx4 a[172:175], v3, s[16:19], s91 offen offset:1024
    buffer_load_dwordx4 a[200:203], v44, s[16:19], s91 offen offset:0
    buffer_load_dwordx4 v[92:95], v3, s[16:19], s92 offen offset:1024
    buffer_load_dwordx4 v[120:123], v44, s[16:19], s92 offen offset:0
    buffer_load_dwordx4 v[148:151], v3, s[16:19], s93 offen offset:1024
    buffer_load_dwordx4 v[176:179], v44, s[16:19], s93 offen offset:0
    buffer_load_dwordx4 v[204:207], v3, s[16:19], s94 offen offset:1024
    buffer_load_dwordx4 v[232:235], v44, s[16:19], s94 offen offset:0
    s_waitcnt vmcnt(10)
    v_sub_u32 v42, v42, v41
    v_cmp_gt_i32 vcc, 6, v42
    s_cbranch_vccz uw4_k5
uw4_s5:
    buffer_load_dword v42, v40, s[32:35], 0 offen sc1
    s_add_u32 s62, s62, 1
    s_cmp_gt_u32 s62, 3000000
    s_cbranch_scc1 ch_done
    s_waitcnt vmcnt(0)
    v_sub_u32 v42, v42, v41
    v_cmp_gt_i32 vcc, 6, v42
    s_cbranch_vccz uw4_k5
    s_sleep 4
    s_branch uw4_s5
uw4_k5:
    buffer_load_dwordx4 a[8:11], v3, s[16:19], s88 offen offset:2048
    buffer_load_dwordx4 a[36:39], v44, s[16:19], s88 offen offset:1024
    buffer_load_dwordx4 a[64:67], v3, s[16:19], s89 offen offset:2048
    buffer_load_dwordx4 a[92:95], v44, s[16:19], s89 offen offset:1024
    buffer_load_dword v42, v40, s[32:35], 0 offen sc1
    buffer_load_dwordx4 a[120:123], v3, s[16:19], s90 offen offset:2048
    buffer_load_dwordx4 a[148:151], v44, s[16:19], s90 offen offset:1024
    buffer_load_dwordx4 a[176:179], v3, s[16:19], s91 offen offset:2048
    buffer_load_dwordx4 a[204:207], v44, s[16:19], s91 offen offset:1024
    buffer_load_dwordx4 v[96:99], v3, s[16:19], s92 offen offset:2048
    buffer_load_dwordx4 v[124:127], v44, s[16:19], s92 offen offset:1024
    buffer_load_dwordx4 v[152:155], v3, s[16:19], s93 offen offset:2048
    buffer_load_dwordx4 v[180:183], v44, s[16:19], s93 offen offset:1024
    buffer_load_dwordx4 v[208:211], v3, s[16:19], s94 offen offset:2048
    buffer_load_dwordx4 v[236:239], v44, s[16:19], s94 offen offset:1024
    s_waitcnt vmcnt(10)
    v_sub_u32 v42, v42, v41
    v_cmp_gt_i32 vcc, 7, v42
    s_cbranch_vccz uw4_k6
uw4_s6:
    buffer_load_dword v42, v40, s[32:35], 0 offen sc1
    s_add_u32 s62, s62, 1
    s_cmp_gt_u32 s62, 3000000
    s_cbranch_scc1 ch_done
    s_waitcnt vmcnt(0)
    v_sub_u32 v42, v42, v41
    v_cmp_gt_i32 vcc, 7, v42
    s_cbranch_vccz uw4_k6
    s_sleep 4
    s_branch uw4_s6
uw4_k6:
    buffer_load_dwordx4 a[12:15], v3, s[16:19], s88 offen offset:3072
    buffer_load_dwordx4 a[40:43], v44, s[16:19], s88 offen offset:2048
    buffer_load_dwordx4 a[68:71], v3, s[16:19], s89 offen offset:3072
    buffer_load_dwordx4 a[96:99], v44, s[16:19], s89 offen offset:2048
    buffer_load_dwordx4 a[124:127], v3, s[16:19], s90 offen offset:3072
    buffer_load_dwordx4 a[152:155], v44, s[16:19], s90 offen offset:2048
    buffer_load_dwordx4 a[180:183], v3, s[16:19], s91 offen offset:3072
    buffer_load_dwordx4 a[208:211], v44, s[16:19], s91 offen offset:2048
    buffer_load_dwordx4 v[100:103], v3, s[16:19], s92 offen offset:3072
    buffer_load_dwordx4 v[128:131], v44, s[16:19], s92 offen offset:2048
    buffer_load_dwordx4 v[156:159], v3, s[16:19], s93 offen offset:3072
    buffer_load_dwordx4 v[184:187], v44, s[16:19], s93 offen offset:2048
    buffer_load_dwordx4 v[212:215], v3, s[16:19], s94 offen offset:3072
    buffer_load_dwordx4 v[240:243], v44, s[16:19], s94 offen offset:2048
    s_branch uw_d
uw_5:
    s_add_u32 s88, s13, 0
    s_add_u32 s89, s13, 14336
    s_add_u32 s90, s13, 28672
    s_add_u32 s91, s13, 43008
    s_add_u32 s92, s13, 57344
    s_add_u32 s93, s13, 71680
    s_add_u32 s94, s13, 86016
    v_add_u32 v43, 4096, v3
    v_add_u32 v44, 8192, v3
    v_add_u32 v45, 12288, v3
    s_mov_b32 s62, 0
uw5_s0:
    buffer_load_dword v42, v40, s[32:35], 0 offen sc1
    s_add_u32 s62, s62, 1
    s_cmp_gt_u32 s62, 3000000
    s_cbranch_scc1 ch_done
    s_waitcnt vmcnt(0)
    v_sub_u32 v42, v42, v41
    v_cmp_gt_i32 vcc, 1, v42
    s_cbranch_vccz uw5_k0
    s_sleep 4
    s_branch uw5_s0
uw5_k0:
    buffer_load_dwordx4 a[20:23], v43, s[16:19], s88 offen offset:1024
    buffer_load_dwordx4 a[48:51], v45, s[16:19], s88 offen offset:0
    buffer_load_dwordx4 a[76:79], v43, s[16:19], s89 offen offset:1024
    buffer_load_dwordx4 a[104:107], v45, s[16:19], s89 offen offset:0
    buffer_load_dword v42, v40, s[32:35], 0 offen sc1
    buffer_load_dwordx4 a[132:135], v43, s[16:19], s90 offen offset:1024
    buffer_load_dwordx4 a[160:163], v45, s[16:19], s90 offen offset:0
    buffer_load_dwordx4 a[188:191], v43, s[16:19], s91 offen offset:1024
    buffer_load_dwordx4 a[216:219], v45, s[16:19], s91 offen offset:0
    buffer_load_dwordx4 v[108:111], v43, s[16:19], s92 offen offset:1024
    buffer_load_dwordx4 v[136:139], v45, s[16:19], s92 offen offset:0
    buffer_load_dwordx4 v[164:167], v43, s[16:19], s93 offen offset:1024
    buffer_load_dwordx4 v[192:195], v45, s[16:19], s93 offen offset:0
    buffer_load_dwordx4 v[220:223], v43, s[16:19], s94 offen offset:1024
    buffer_load_dwordx4 v[248:251], v45, s[16:19], s94 offen offset:0
    s_waitcnt vmcnt(10)
    v_sub_u32 v42, v42, v41
    v_cmp_gt_i32 vcc, 2, v42
    s_cbranch_vccz uw5_k1
uw5_s1:
    buffer_load_dword v42, v40, s[32:35], 0 offen sc1
    s_add_u32 s62, s62, 1
    s_cmp_gt_u32 s62, 3000000
    s_cbranch_scc1 ch_done
    s_waitcnt vmcnt(0)
    v_sub_u32 v42, v42, v41
    v_cmp_gt_i32 vcc, 2, v42
    s_cbranch_vccz uw5_k1
    s_sleep 4
    s_branch uw5_s1
uw5_k1:
    buffer_load_dwordx4 a[24:27], v43, s[16:19], s88 offen offset:2048
    buffer_load_dwordx4 a[52:55], v45, s[16:19], s88 offen offset:1024
    buffer_load_dwordx4 a[80:83], v43, s[16:19], s89 offen offset:2048
    buffer_load_dwordx4 a[108:111], v45, s[16:19], s89 offen offset:1024
    buffer_load_dword v42, v40, s[32:35], 0 offen sc1
    buffer_load_dwordx4 a[136:139], v43, s[16:19], s90 offen offset:2048
    buffer_load_dwordx4 a[164:167], v45, s[16:19], s90 offen offset:1024
    buffer_load_dwordx4 a[192:195], v43, s[16:19], s91 offen offset:2048
    buffer_load_dwordx4 a[220:223], v45, s[16:19], s91 offen offset:1024
    buffer_load_dwordx4 v[112:115], v43, s[16:19], s92 offen offset:2048
    buffer_load_dwordx4 v[140:143], v45, s[16:19], s92 offen offset:1024
    buffer_load_dwordx4 v[168:171], v43, s[16:19], s93 offen offset:2048
    buffer_load_dwordx4 v[196:199], v45, s[16:19], s93 offen offset:1024
    buffer_load_dwordx4 v[224:227], v43, s[16:19], s94 offen offset:2048
    buffer_load_dwordx4 v[252:255], v45, s[16:19], s94 offen offset:1024
    s_waitcnt vmcnt(10)
    v_sub_u32 v42, v42, v41
    v_cmp_gt_i32 vcc, 3, v42
    s_cbranch_vccz uw5_k2
uw5_s2:
    buffer_load_dword v42, v40, s[32:35], 0 offen sc1
    s_add_u32 s62, s62, 1
    s_cmp_gt_u32 s62, 3000000
    s_cbranch_scc1 ch_done
    s_waitcnt vmcnt(0)
    v_sub_u32 v42, v42, v41
    v_cmp_gt_i32 vcc, 3, v42
    s_cbranch_vccz uw5_k2
    s_sleep 4
    s_branch uw5_s2
uw5_k2:
    s_cmp_eq_u32 s8, 0
    s_cbranch_scc0 ai_81
    v_mov_b32 v37, 8
    s_mov_b32 s12, 0
wc_82:
    buffer_load_dwordx2 v[38:39], v37, s[80:83], 0 offen sc1
    s_add_u32 s12, s12, 1
    s_cmp_gt_u32 s12, 3000000
    s_cbranch_scc1 ch_done
    s_waitcnt vmcnt(0)
    v_readfirstlane_b32 s13, v38
    s_nop 3
    s_cmp_ge_u32 s13, 256
    s_cbranch_scc1 wc_82_ok
    s_sleep 8
    s_branch wc_82
wc_82_ok:
    ds_write_b32 v50, v39
    v_readfirstlane_b32 s12, v39
    s_nop 3
    s_bcnt1_i32_b32 s12, s12
    s_cmp_eq_u32 s12, 1
    s_cselect_b32 s63, 1, 0
    v_min_u32 v18, 0xfffffffe, v18
    v_min_u32 v19, 0xfffffffe, v19
    s_cmp_eq_u32 s63, 0
    s_cbranch_scc1 mp_83_s
    buffer_store_dword v18, v13, s[36:39], 0 offen
    buffer_store_dword v19, v2, s[36:39], 0 offen
    buffer_store_dword v18, v11, s[36:39], 0 offen
    buffer_store_dword v19, v12, s[36:39], 0 offen
    s_branch mp_83_d
mp_83_s:
    buffer_store_dword v18, v13, s[36:39], 0 offen sc1
    buffer_store_dword v19, v2, s[36:39], 0 offen sc1
    buffer_store_dword v18, v11, s[36:39], 0 offen sc1
    buffer_store_dword v19, v12, s[36:39], 0 offen sc1
mp_83_d:
ai_81:
    buffer_load_dwordx4 a[0:3], v3, s[16:19], s88 offen offset:0
    buffer_load_dwordx4 a[28:31], v43, s[16:19], s88 offen offset:3072
    buffer_load_dwordx4 a[56:59], v3, s[16:19], s89 offen offset:0
    buffer_load_dwordx4 a[84:87], v43, s[16:19], s89 offen offset:3072
    buffer_load_dword v42, v40, s[32:35], 0 offen sc1
    buffer_load_dwordx4 a[112:115], v3, s[16:19], s90 offen offset:0
    buffer_load_dwordx4 a[140:143], v43, s[16:19], s90 offen offset:3072
    buffer_load_dwordx4 a[168:171], v3, s[16:19], s91 offen offset:0
    buffer_load_dwordx4 a[196:199], v43, s[16:19], s91 offen offset:3072
    buffer_load_dwordx4 v[88:91], v3, s[16:19], s92 offen offset:0
    buffer_load_dwordx4 v[116:119], v43, s[16:19], s92 offen offset:3072
    buffer_load_dwordx4 v[144:147], v3, s[16:19], s93 offen offset:0
    buffer_load_dwordx4 v[172:175], v43, s[16:19], s93 offen offset:3072
    buffer_load_dwordx4 v[200:203], v3, s[16:19], s94 offen offset:0
    buffer_load_dwordx4 v[228:231], v43, s[16:19], s94 offen offset:3072
    s_waitcnt vmcnt(10)
    v_sub_u32 v42, v42, v41
    v_cmp_gt_i32 vcc, 4, v42
    s_cbranch_vccz uw5_k3
uw5_s3:
    buffer_load_dword v42, v40, s[32:35], 0 offen sc1
    s_add_u32 s62, s62, 1
    s_cmp_gt_u32 s62, 3000000
    s_cbranch_scc1 ch_done
    s_waitcnt vmcnt(0)
    v_sub_u32 v42, v42, v41
    v_cmp_gt_i32 vcc, 4, v42
    s_cbranch_vccz uw5_k3
    s_sleep 4
    s_branch uw5_s3
uw5_k3:
    buffer_load_dwordx4 a[4:7], v3, s[16:19], s88 offen offset:1024
    buffer_load_dwordx4 a[32:35], v44, s[16:19], s88 offen offset:0
    buffer_load_dwordx4 a[60:63], v3, s[16:19], s89 offen offset:1024
    buffer_load_dwordx4 a[88:91], v44, s[16:19], s89 offen offset:0
    buffer_load_dword v42, v40, s[32:35], 0 offen sc1
    buffer_load_dwordx4 a[116:119], v3, s[16:19], s90 offen offset:1024
    buffer_load_dwordx4 a[144:147], v44, s[16:19], s90 offen offset:0
    buffer_load_dwordx4 a[172:175], v3, s[16:19], s91 offen offset:1024
    buffer_load_dwordx4 a[200:203], v44, s[16:19], s91 offen offset:0
    buffer_load_dwordx4 v[92:95], v3, s[16:19], s92 offen offset:1024
    buffer_load_dwordx4 v[120:123], v44, s[16:19], s92 offen offset:0
    buffer_load_dwordx4 v[148:151], v3, s[16:19], s93 offen offset:1024
    buffer_load_dwordx4 v[176:179], v44, s[16:19], s93 offen offset:0
    buffer_load_dwordx4 v[204:207], v3, s[16:19], s94 offen offset:1024
    buffer_load_dwordx4 v[232:235], v44, s[16:19], s94 offen offset:0
    s_waitcnt vmcnt(10)
    v_sub_u32 v42, v42, v41
    v_cmp_gt_i32 vcc, 5, v42
    s_cbranch_vccz uw5_k4
uw5_s4:
    buffer_load_dword v42, v40, s[32:35], 0 offen sc1
    s_add_u32 s62, s62, 1
    s_cmp_gt_u32 s62, 3000000
    s_cbranch_scc1 ch_done
    s_waitcnt vmcnt(0)
    v_sub_u32 v42, v42, v41
    v_cmp_gt_i32 vcc, 5, v42
    s_cbranch_vccz uw5_k4
    s_sleep 4
    s_branch uw5_s4
uw5_k4:
    buffer_load_dwordx4 a[8:11], v3, s[16:19], s88 offen offset:2048
    buffer_load_dwordx4 a[36:39], v44, s[16:19], s88 offen offset:1024
    buffer_load_dwordx4 a[64:67], v3, s[16:19], s89 offen offset:2048
    buffer_load_dwordx4 a[92:95], v44, s[16:19], s89 offen offset:1024
    buffer_load_dword v42, v40, s[32:35], 0 offen sc1
    buffer_load_dwordx4 a[120:123], v3, s[16:19], s90 offen offset:2048
    buffer_load_dwordx4 a[148:151], v44, s[16:19], s90 offen offset:1024
    buffer_load_dwordx4 a[176:179], v3, s[16:19], s91 offen offset:2048
    buffer_load_dwordx4 a[204:207], v44, s[16:19], s91 offen offset:1024
    buffer_load_dwordx4 v[96:99], v3, s[16:19], s92 offen offset:2048
    buffer_load_dwordx4 v[124:127], v44, s[16:19], s92 offen offset:1024
    buffer_load_dwordx4 v[152:155], v3, s[16:19], s93 offen offset:2048
    buffer_load_dwordx4 v[180:183], v44, s[16:19], s93 offen offset:1024
    buffer_load_dwordx4 v[208:211], v3, s[16:19], s94 offen offset:2048
    buffer_load_dwordx4 v[236:239], v44, s[16:19], s94 offen offset:1024
    s_waitcnt vmcnt(10)
    v_sub_u32 v42, v42, v41
    v_cmp_gt_i32 vcc, 6, v42
    s_cbranch_vccz uw5_k5
uw5_s5:
    buffer_load_dword v42, v40, s[32:35], 0 offen sc1
    s_add_u32 s62, s62, 1
    s_cmp_gt_u32 s62, 3000000
    s_cbranch_scc1 ch_done
    s_waitcnt vmcnt(0)
    v_sub_u32 v42, v42, v41
    v_cmp_gt_i32 vcc, 6, v42
    s_cbranch_vccz uw5_k5
    s_sleep 4
    s_branch uw5_s5
uw5_k5:
    buffer_load_dwordx4 a[12:15], v3, s[16:19], s88 offen offset:3072
    buffer_load_dwordx4 a[40:43], v44, s[16:19], s88 offen offset:2048
    buffer_load_dwordx4 a[68:71], v3, s[16:19], s89 offen offset:3072
    buffer_load_dwordx4 a[96:99], v44, s[16:19], s89 offen offset:2048
    buffer_load_dword v42, v40, s[32:35], 0 offen sc1
    buffer_load_dwordx4 a[124:127], v3, s[16:19], s90 offen offset:3072
    buffer_load_dwordx4 a[152:155], v44, s[16:19], s90 offen offset:2048
    buffer_load_dwordx4 a[180:183], v3, s[16:19], s91 offen offset:3072
    buffer_load_dwordx4 a[208:211], v44, s[16:19], s91 offen offset:2048
    buffer_load_dwordx4 v[100:103], v3, s[16:19], s92 offen offset:3072
    buffer_load_dwordx4 v[128:131], v44, s[16:19], s92 offen offset:2048
    buffer_load_dwordx4 v[156:159], v3, s[16:19], s93 offen offset:3072
    buffer_load_dwordx4 v[184:187], v44, s[16:19], s93 offen offset:2048
    buffer_load_dwordx4 v[212:215], v3, s[16:19], s94 offen offset:3072
    buffer_load_dwordx4 v[240:243], v44, s[16:19], s94 offen offset:2048
    s_waitcnt vmcnt(10)
    v_sub_u32 v42, v42, v41
    v_cmp_gt_i32 vcc, 7, v42
    s_cbranch_vccz uw5_k6
uw5_s6:
    buffer_load_dword v42, v40, s[32:35], 0 offen sc1
    s_add_u32 s62, s62, 1
    s_cmp_gt_u32 s62, 3000000
    s_cbranch_scc1 ch_done
    s_waitcnt vmcnt(0)
    v_sub_u32 v42, v42, v41
    v_cmp_gt_i32 vcc, 7, v42
    s_cbranch_vccz uw5_k6
    s_sleep 4
    s_branch uw5_s6
uw5_k6:
    buffer_load_dwordx4 a[16:19], v43, s[16:19], s88 offen offset:0
    buffer_load_dwordx4 a[44:47], v44, s[16:19], s88 offen offset:3072
    buffer_load_dwordx4 a[72:75], v43, s[16:19], s89 offen offset:0
    buffer_load_dwordx4 a[100:103], v44, s[16:19], s89 offen offset:3072
    buffer_load_dwordx4 a[128:131], v43, s[16:19], s90 offen offset:0
    buffer_load_dwordx4 a[156:159], v44, s[16:19], s90 offen offset:3072
    buffer_load_dwordx4 a[184:187], v43, s[16:19], s91 offen offset:0
    buffer_load_dwordx4 a[212:215], v44, s[16:19], s91 offen offset:3072
    buffer_load_dwordx4 v[104:107], v43, s[16:19], s92 offen offset:0
    buffer_load_dwordx4 v[132:135], v44, s[16:19], s92 offen offset:3072
    buffer_load_dwordx4 v[160:163], v43, s[16:19], s93 offen offset:0
    buffer_load_dwordx4 v[188:191], v44, s[16:19], s93 offen offset:3072
    buffer_load_dwordx4 v[216:219], v43, s[16:19], s94 offen offset:0
    buffer_load_dwordx4 v[244:247], v44, s[16:19], s94 offen offset:3072
    s_branch uw_d
uw_6:
    s_add_u32 s88, s13, 0
    s_add_u32 s89, s13, 14336
    s_add_u32 s90, s13, 28672
    s_add_u32 s91, s13, 43008
    s_add_u32 s92, s13, 57344
    s_add_u32 s93, s13, 71680
    s_add_u32 s94, s13, 86016
    v_add_u32 v43, 4096, v3
    v_add_u32 v44, 8192, v3
    v_add_u32 v45, 12288, v3
    s_mov_b32 s62, 0
uw6_s0:
    buffer_load_dword v42, v40, s[32:35], 0 offen sc1
    s_add_u32 s62, s62, 1
    s_cmp_gt_u32 s62, 3000000
    s_cbranch_scc1 ch_done
    s_waitcnt vmcnt(0)
    v_sub_u32 v42, v42, v41
    v_cmp_gt_i32 vcc, 1, v42
    s_cbranch_vccz uw6_k0
    s_sleep 4
    s_branch uw6_s0
uw6_k0:
    buffer_load_dwordx4 a[24:27], v43, s[16:19], s88 offen offset:2048
    buffer_load_dwordx4 a[52:55], v45, s[16:19], s88 offen offset:1024
    buffer_load_dwordx4 a[80:83], v43, s[16:19], s89 offen offset:2048
    buffer_load_dwordx4 a[108:111], v45, s[16:19], s89 offen offset:1024
    buffer_load_dword v42, v40, s[32:35], 0 offen sc1
    buffer_load_dwordx4 a[136:139], v43, s[16:19], s90 offen offset:2048
    buffer_load_dwordx4 a[164:167], v45, s[16:19], s90 offen offset:1024
    buffer_load_dwordx4 a[192:195], v43, s[16:19], s91 offen offset:2048
    buffer_load_dwordx4 a[220:223], v45, s[16:19], s91 offen offset:1024
    buffer_load_dwordx4 v[112:115], v43, s[16:19], s92 offen offset:2048
    buffer_load_dwordx4 v[140:143], v45, s[16:19], s92 offen offset:1024
    buffer_load_dwordx4 v[168:171], v43, s[16:19], s93 offen offset:2048
    buffer_load_dwordx4 v[196:199], v45, s[16:19], s93 offen offset:1024
    buffer_load_dwordx4 v[224:227], v43, s[16:19], s94 offen offset:2048
    buffer_load_dwordx4 v[252:255], v45, s[16:19], s94 offen offset:1024
    s_waitcnt vmcnt(10)
    v_sub_u32 v42, v42, v41
    v_cmp_gt_i32 vcc, 2, v42
    s_cbranch_vccz uw6_k1
uw6_s1:
    buffer_load_dword v42, v40, s[32:35], 0 offen sc1
    s_add_u32 s62, s62, 1
    s_cmp_gt_u32 s62, 3000000
    s_cbranch_scc1 ch_done
    s_waitcnt vmcnt(0)
    v_sub_u32 v42, v42, v41
    v_cmp_gt_i32 vcc, 2, v42
    s_cbranch_vccz uw6_k1
    s_sleep 4
    s_branch uw6_s1
uw6_k1:
    buffer_load_dwordx4 a[0:3], v3, s[16:19], s88 offen offset:0
    buffer_load_dwordx4 a[28:31], v43, s[16:19], s88 offen offset:3072
    buffer_load_dwordx4 a[56:59], v3, s[16:19], s89 offen offset:0
    buffer_load_dwordx4 a[84:87], v43, s[16:19], s89 offen offset:3072
    buffer_load_dword v42, v40, s[32:35], 0 offen sc1
    buffer_load_dwordx4 a[112:115], v3, s[16:19], s90 offen offset:0
    buffer_load_dwordx4 a[140:143], v43, s[16:19], s90 offen offset:3072
    buffer_load_dwordx4 a[168:171], v3, s[16:19], s91 offen offset:0
    buffer_load_dwordx4 a[196:199], v43, s[16:19], s91 offen offset:3072
    buffer_load_dwordx4 v[88:91], v3, s[16:19], s92 offen offset:0
    buffer_load_dwordx4 v[116:119], v43, s[16:19], s92 offen offset:3072
    buffer_load_dwordx4 v[144:147], v3, s[16:19], s93 offen offset:0
    buffer_load_dwordx4 v[172:175], v43, s[16:19], s93 offen offset:3072
    buffer_load_dwordx4 v[200:203], v3, s[16:19], s94 offen offset:0
    buffer_load_dwordx4 v[228:231], v43, s[16:19], s94 offen offset:3072
    s_waitcnt vmcnt(10)
    v_sub_u32 v42, v42, v41
    v_cmp_gt_i32 vcc, 3, v42
    s_cbranch_vccz uw6_k2
uw6_s2:
    buffer_load_dword v42, v40, s[32:35], 0 offen sc1
    s_add_u32 s62, s62, 1
    s_cmp_gt_u32 s62, 3000000
    s_cbranch_scc1 ch_done
    s_waitcnt vmcnt(0)
    v_sub_u32 v42, v42, v41
    v_cmp_gt_i32 vcc, 3, v42
    s_cbranch_vccz uw6_k2
    s_sleep 4
    s_branch uw6_s2
uw6_k2:
    s_cmp_eq_u32 s8, 0
    s_cbranch_scc0 ai_84
    v_mov_b32 v37, 8
    s_mov_b32 s12, 0
wc_85:
    buffer_load_dwordx2 v[38:39], v37, s[80:83], 0 offen sc1
    s_add_u32 s12, s12, 1
    s_cmp_gt_u32 s12, 3000000
    s_cbranch_scc1 ch_done
    s_waitcnt vmcnt(0)
    v_readfirstlane_b32 s13, v38
    s_nop 3
    s_cmp_ge_u32 s13, 256
    s_cbranch_scc1 wc_85_ok
    s_sleep 8
    s_branch wc_85
wc_85_ok:
    ds_write_b32 v50, v39
    v_readfirstlane_b32 s12, v39
    s_nop 3
    s_bcnt1_i32_b32 s12, s12
    s_cmp_eq_u32 s12, 1
    s_cselect_b32 s63, 1, 0
    v_min_u32 v18, 0xfffffffe, v18
    v_min_u32 v19, 0xfffffffe, v19
    s_cmp_eq_u32 s63, 0
    s_cbranch_scc1 mp_86_s
    buffer_store_dword v18, v13, s[36:39], 0 offen
    buffer_store_dword v19, v2, s[36:39], 0 offen
    buffer_store_dword v18, v11, s[36:39], 0 offen
    buffer_store_dword v19, v12, s[36:39], 0 offen
    s_branch mp_86_d
mp_86_s:
    buffer_store_dword v18, v13, s[36:39], 0 offen sc1
    buffer_store_dword v19, v2, s[36:39], 0 offen sc1
    buffer_store_dword v18, v11, s[36:39], 0 offen sc1
    buffer_store_dword v19, v12, s[36:39], 0 offen sc1
mp_86_d:
ai_84:
    buffer_load_dwordx4 a[4:7], v3, s[16:19], s88 offen offset:1024
    buffer_load_dwordx4 a[32:35], v44, s[16:19], s88 offen offset:0
    buffer_load_dwordx4 a[60:63], v3, s[16:19], s89 offen offset:1024
    buffer_load_dwordx4 a[88:91], v44, s[16:19], s89 offen offset:0
    buffer_load_dword v42, v40, s[32:35], 0 offen sc1
    buffer_load_dwordx4 a[116:119], v3, s[16:19], s90 offen offset:1024
    buffer_load_dwordx4 a[144:147], v44, s[16:19], s90 offen offset:0
    buffer_load_dwordx4 a[172:175], v3, s[16:19], s91 offen offset:1024
    buffer_load_dwordx4 a[200:203], v44, s[16:19], s91 offen offset:0
    buffer_load_dwordx4 v[92:95], v3, s[16:19], s92 offen offset:1024
    buffer_load_dwordx4 v[120:123], v44, s[16:19], s92 offen offset:0
    buffer_load_dwordx4 v[148:151], v3, s[16:19], s93 offen offset:1024
    buffer_load_dwordx4 v[176:179], v44, s[16:19], s93 offen offset:0
    buffer_load_dwordx4 v[204:207], v3, s[16:19], s94 offen offset:1024
    buffer_load_dwordx4 v[232:235], v44, s[16:19], s94 offen offset:0
    s_waitcnt vmcnt(10)
    v_sub_u32 v42, v42, v41
    v_cmp_gt_i32 vcc, 4, v42
    s_cbranch_vccz uw6_k3
uw6_s3:
    buffer_load_dword v42, v40, s[32:35], 0 offen sc1
    s_add_u32 s62, s62, 1
    s_cmp_gt_u32 s62, 3000000
    s_cbranch_scc1 ch_done
    s_waitcnt vmcnt(0)
    v_sub_u32 v42, v42, v41
    v_cmp_gt_i32 vcc, 4, v42
    s_cbranch_vccz uw6_k3
    s_sleep 4
    s_branch uw6_s3
uw6_k3:
    buffer_load_dwordx4 a[8:11], v3, s[16:19], s88 offen offset:2048
    buffer_load_dwordx4 a[36:39], v44, s[16:19], s88 offen offset:1024
    buffer_load_dwordx4 a[64:67], v3, s[16:19], s89 offen offset:2048
    buffer_load_dwordx4 a[92:95], v44, s[16:19], s89 offen offset:1024
    buffer_load_dword v42, v40, s[32:35], 0 offen sc1
    buffer_load_dwordx4 a[120:123], v3, s[16:19], s90 offen offset:2048
    buffer_load_dwordx4 a[148:151], v44, s[16:19], s90 offen offset:1024
    buffer_load_dwordx4 a[176:179], v3, s[16:19], s91 offen offset:2048
    buffer_load_dwordx4 a[204:207], v44, s[16:19], s91 offen offset:1024
    buffer_load_dwordx4 v[96:99], v3, s[16:19], s92 offen offset:2048
    buffer_load_dwordx4 v[124:127], v44, s[16:19], s92 offen offset:1024
    buffer_load_dwordx4 v[152:155], v3, s[16:19], s93 offen offset:2048
    buffer_load_dwordx4 v[180:183], v44, s[16:19], s93 offen offset:1024
    buffer_load_dwordx4 v[208:211], v3, s[16:19], s94 offen offset:2048
    buffer_load_dwordx4 v[236:239], v44, s[16:19], s94 offen offset:1024
    s_waitcnt vmcnt(10)
    v_sub_u32 v42, v42, v41
    v_cmp_gt_i32 vcc, 5, v42
    s_cbranch_vccz uw6_k4
uw6_s4:
    buffer_load_dword v42, v40, s[32:35], 0 offen sc1
    s_add_u32 s62, s62, 1
    s_cmp_gt_u32 s62, 3000000
    s_cbranch_scc1 ch_done
    s_waitcnt vmcnt(0)
    v_sub_u32 v42, v42, v41
    v_cmp_gt_i32 vcc, 5, v42
    s_cbranch_vccz uw6_k4
    s_sleep 4
    s_branch uw6_s4
uw6_k4:
    buffer_load_dwordx4 a[12:15], v3, s[16:19], s88 offen offset:3072
    buffer_load_dwordx4 a[40:43], v44, s[16:19], s88 offen offset:2048
    buffer_load_dwordx4 a[68:71], v3, s[16:19], s89 offen offset:3072
    buffer_load_dwordx4 a[96:99], v44, s[16:19], s89 offen offset:2048
    buffer_load_dword v42, v40, s[32:35], 0 offen sc1
    buffer_load_dwordx4 a[124:127], v3, s[16:19], s90 offen offset:3072
    buffer_load_dwordx4 a[152:155], v44, s[16:19], s90 offen offset:2048
    buffer_load_dwordx4 a[180:183], v3, s[16:19], s91 offen offset:3072
    buffer_load_dwordx4 a[208:211], v44, s[16:19], s91 offen offset:2048
    buffer_load_dwordx4 v[100:103], v3, s[16:19], s92 offen offset:3072
    buffer_load_dwordx4 v[128:131], v44, s[16:19], s92 offen offset:2048
    buffer_load_dwordx4 v[156:159], v3, s[16:19], s93 offen offset:3072
    buffer_load_dwordx4 v[184:187], v44, s[16:19], s93 offen offset:2048
    buffer_load_dwordx4 v[212:215], v3, s[16:19], s94 offen offset:3072
    buffer_load_dwordx4 v[240:243], v44, s[16:19], s94 offen offset:2048
    s_waitcnt vmcnt(10)
    v_sub_u32 v42, v42, v41
    v_cmp_gt_i32 vcc, 6, v42
    s_cbranch_vccz uw6_k5
uw6_s5:
    buffer_load_dword v42, v40, s[32:35], 0 offen sc1
    s_add_u32 s62, s62, 1
    s_cmp_gt_u32 s62, 3000000
    s_cbranch_scc1 ch_done
    s_waitcnt vmcnt(0)
    v_sub_u32 v42, v42, v41
    v_cmp_gt_i32 vcc, 6, v42
    s_cbranch_vccz uw6_k5
    s_sleep 4
    s_branch uw6_s5
uw6_k5:
    buffer_load_dwordx4 a[16:19], v43, s[16:19], s88 offen offset:0
    buffer_load_dwordx4 a[44:47], v44, s[16:19], s88 offen offset:3072
    buffer_load_dwordx4 a[72:75], v43, s[16:19], s89 offen offset:0
    buffer_load_dwordx4 a[100:103], v44, s[16:19], s89 offen offset:3072
    buffer_load_dword v42, v40, s[32:35], 0 offen sc1
    buffer_load_dwordx4 a[128:131], v43, s[16:19], s90 offen offset:0
    buffer_load_dwordx4 a[156:159], v44, s[16:19], s90 offen offset:3072
    buffer_load_dwordx4 a[184:187], v43, s[16:19], s91 offen offset:0
    buffer_load_dwordx4 a[212:215], v44, s[16:19], s91 offen offset:3072
    buffer_load_dwordx4 v[104:107], v43, s[16:19], s92 offen offset:0
    buffer_load_dwordx4 v[132:135], v44, s[16:19], s92 offen offset:3072
    buffer_load_dwordx4 v[160:163], v43, s[16:19], s93 offen offset:0
    buffer_load_dwordx4 v[188:191], v44, s[16:19], s93 offen offset:3072
    buffer_load_dwordx4 v[216:219], v43, s[16:19], s94 offen offset:0
    buffer_load_dwordx4 v[244:247], v44, s[16:19], s94 offen offset:3072
    s_waitcnt vmcnt(10)
    v_sub_u32 v42, v42, v41
    v_cmp_gt_i32 vcc, 7, v42
    s_cbranch_vccz uw6_k6
uw6_s6:
    buffer_load_dword v42, v40, s[32:35], 0 offen sc1
    s_add_u32 s62, s62, 1
    s_cmp_gt_u32 s62, 3000000
    s_cbranch_scc1 ch_done
    s_waitcnt vmcnt(0)
    v_sub_u32 v42, v42, v41
    v_cmp_gt_i32 vcc, 7, v42
    s_cbranch_vccz uw6_k6
    s_sleep 4
    s_branch uw6_s6
uw6_k6:
    buffer_load_dwordx4 a[20:23], v43, s[16:19], s88 offen offset:1024
    buffer_load_dwordx4 a[48:51], v45, s[16:19], s88 offen offset:0
    buffer_load_dwordx4 a[76:79], v43, s[16:19], s89 offen offset:1024
    buffer_load_dwordx4 a[104:107], v45, s[16:19], s89 offen offset:0
    buffer_load_dwordx4 a[132:135], v43, s[16:19], s90 offen offset:1024
    buffer_load_dwordx4 a[160:163], v45, s[16:19], s90 offen offset:0
    buffer_load_dwordx4 a[188:191], v43, s[16:19], s91 offen offset:1024
    buffer_load_dwordx4 a[216:219], v45, s[16:19], s91 offen offset:0
    buffer_load_dwordx4 v[108:111], v43, s[16:19], s92 offen offset:1024
    buffer_load_dwordx4 v[136:139], v45, s[16:19], s92 offen offset:0
    buffer_load_dwordx4 v[164:167], v43, s[16:19], s93 offen offset:1024
    buffer_load_dwordx4 v[192:195], v45, s[16:19], s93 offen offset:0
    buffer_load_dwordx4 v[220:223], v43, s[16:19], s94 offen offset:1024
    buffer_load_dwordx4 v[248:251], v45, s[16:19], s94 offen offset:0
    s_branch uw_d
uw_d:
    s_waitcnt lgkmcnt(0)
    s_barrier
    ds_read_b32 v48, v50
    s_waitcnt lgkmcnt(0)
    v_readfirstlane_b32 s12, v48
    s_nop 3
    s_bcnt1_i32_b32 s12, s12
    s_cmp_eq_u32 s12, 1
    s_cselect_b32 s63, 1, 0
    s_mul_i32 s12, s8, 1792
    v_add_u32 v6, s12, v6
    s_mul_i32 s12, s6, 28
    v_add_u32 v8, s12, v23
    v_lshlrev_b32 v8, 4, v8
    v_mul_u32_u24 v26, 7168, v24
    v_add_u32 v8, v8, v26
    v_mul_u32_u24 v9, 224, v24
    v_lshl_add_u32 v9, v23, 4, v9
    s_mul_i32 s12, s8, 896
    s_add_u32 s12, s12, 8192
    v_add_u32 v9, s12, v9
    v_lshrrev_b32 v26, 3, v23
    v_lshlrev_b32 v7, 9, v26
    v_lshl_add_u32 v7, v24, 7, v7
    v_lshl_add_u32 v7, v25, 4, v7
    s_lshl_b32 s12, s8, 11
    v_add_u32 v7, s12, v7
    v_lshlrev_b32 v10, 7, v24
    v_lshl_add_u32 v10, v25, 4, v10
    s_lshl_b32 s12, s8, 9
    s_add_u32 s12, s12, 8192
    v_add_u32 v10, s12, v10
    v_min_u32 v5, 6, v22
    v_lshlrev_b32 v5, 7, v5
    s_mul_i32 s12, s6, 896
    v_add_u32 v5, s12, v5
    s_lshl_b32 s12, s8, 10
    s_add_u32 s12, s12, 15360
    v_add_u32 v16, s12, v3
    s_mul_i32 s80, s8, 114688
    s_add_u32 s81, s80, 28672
    s_add_u32 s82, s80, 57344
    s_add_u32 s83, s80, 86016
    s_waitcnt vmcnt(0)
    s_mov_b32 s12, 64
    s_cmp_eq_u32 s8, 3
    s_cbranch_scc0 ch_pro_ng
    s_lshl_b32 s12, s12, 7
    s_add_u32 s12, s12, 4096
    v_and_b32 v28, 63, v0
    v_lshlrev_b32 v28, 4, v28
    v_add_u32 v28, s12, v28
    s_mov_b32 s62, 0
    v_mov_b32 v20, 0
    v_mov_b32 v21, 0
    v_mov_b32 v22, 0
    v_mov_b32 v23, 0
    v_mov_b32 v24, 0
    v_mov_b32 v25, 0
    v_mov_b32 v26, 0
    v_mov_b32 v27, 0
fw_87:
    s_mov_b32 exec_lo, 0xffffffff
    s_mov_b32 exec_hi, 0xffffff
    buffer_load_dwordx4 v[20:23], v28, s[76:79], 0 offen sc1
    s_mov_b64 exec, -1
    s_add_u32 s62, s62, 1
    s_cmp_gt_u32 s62, 3000000
    s_cbranch_scc1 ch_done
    s_waitcnt vmcnt(0)
    v_max3_u32 v20, v20, v21, v22
    v_max3_u32 v24, v24, v25, v26
    v_max3_u32 v20, v20, v23, v27
    v_max_u32 v20, v20, v24
    v_cmp_eq_u32 vcc, -1, v20
    s_cbranch_vccz fw_87_ok
    s_sleep 1
    s_branch fw_87
fw_87_ok:
ch_pro_ng:
    s_cmp_eq_u32 s8, 0
    s_cbranch_scc0 ch_u1
ch_u0:
    v_mov_b32 v48, 0
    v_mov_b32 v49, 0
    v_mov_b32 v50, 0
    v_mov_b32 v51, 0
    v_mov_b32 v52, 0
    v_mov_b32 v53, 0
    v_mov_b32 v54, 0
    v_mov_b32 v55, 0
    v_mov_b32 v56, 0
    v_mov_b32 v57, 0
    v_mov_b32 v58, 0
    v_mov_b32 v59, 0
    v_mov_b32 v60, 0
    v_mov_b32 v61, 0
    v_mov_b32 v62, 0
    v_mov_b32 v63, 0
    v_mov_b32 v64, 0
    v_mov_b32 v65, 0
    v_mov_b32 v66, 0
    v_mov_b32 v67, 0
    v_mov_b32 v68, 0
    v_mov_b32 v69, 0
    v_mov_b32 v70, 0
    v_mov_b32 v71, 0
    v_mov_b32 v72, 0
    v_mov_b32 v73, 0
    v_mov_b32 v74, 0
    v_mov_b32 v75, 0
    s_add_u32 s12, s53, 28672
    s_mov_b32 s62, 0
    s_mov_b64 exec, s[46:47]
ch_u0_pm:
    buffer_load_dwordx4 v[20:23], v15, s[36:39], s53 offen offset:0 sc1
    buffer_load_dwordx4 v[24:27], v15, s[36:39], s53 offen offset:896 sc1
    s_add_u32 s62, s62, 1
    s_cmp_gt_u32 s62, 200000
    s_cbranch_scc1 ch_done
    s_waitcnt vmcnt(0)
    v_max3_u32 v36, v20, v21, v22
    v_max3_u32 v37, v23, v24, v25
    v_max3_u32 v36, v36, v26, v27
    v_max_u32 v36, v36, v37
    v_cmp_eq_u32 vcc, -1, v36
    s_cbranch_vccnz ch_u0_pm
    ds_write_b128 v14, v[20:23] offset:0
    ds_write_b128 v14, v[24:27] offset:912
    s_mov_b64 exec, -1
    s_waitcnt lgkmcnt(0)
    s_barrier
    ds_read_b128 v[20:23], v1 offset:0
    ds_read_b128 v[24:27], v1 offset:128
    ds_read_b128 v[28:31], v1 offset:256
    ds_read_b128 v[32:35], v1 offset:384
    ds_read_b128 v[36:39], v1 offset:512
    ds_read_b128 v[40:43], v1 offset:640
    ds_read_b128 v[44:47], v1 offset:768
    buffer_load_dwordx4 a[224:227], v8, s[24:27], s80 offen offset:0 sc1
    buffer_load_dwordx4 a[228:231], v8, s[24:27], s80 offen offset:224 sc1
    s_waitcnt lgkmcnt(6)
    v_smfmac_f32_16x16x64_bf16 v[48:51], v[20:23], a[0:7], v4
    buffer_load_dwordx4 a[232:235], v8, s[24:27], s81 offen offset:0 sc1
    v_smfmac_f32_16x16x64_bf16 v[52:55], v[20:23], a[56:63], v4
    buffer_load_dwordx4 a[236:239], v8, s[24:27], s81 offen offset:224 sc1
    v_smfmac_f32_16x16x64_bf16 v[56:59], v[20:23], a[112:119], v4
    buffer_load_dwordx4 a[240:243], v8, s[24:27], s82 offen offset:0 sc1
    v_smfmac_f32_16x16x64_bf16 v[60:63], v[20:23], a[168:175], v4
    buffer_load_dwordx4 a[244:247], v8, s[24:27], s82 offen offset:224 sc1
    v_smfmac_f32_16x16x64_bf16 v[64:67], v[20:23], v[88:95], v4
    buffer_load_dwordx4 a[248:251], v8, s[24:27], s83 offen offset:0 sc1
    v_smfmac_f32_16x16x64_bf16 v[68:71], v[20:23], v[144:151], v4
    buffer_load_dwordx4 a[252:255], v8, s[24:27], s83 offen offset:224 sc1
    v_smfmac_f32_16x16x64_bf16 v[72:75], v[20:23], v[200:207], v4
    buffer_load_dword v17, v5, s[36:39], s12 offen sc1
    s_waitcnt lgkmcnt(5)
    v_smfmac_f32_16x16x64_bf16 v[48:51], v[24:27], a[8:15], v4
    v_smfmac_f32_16x16x64_bf16 v[52:55], v[24:27], a[64:71], v4
    v_smfmac_f32_16x16x64_bf16 v[56:59], v[24:27], a[120:127], v4
    v_smfmac_f32_16x16x64_bf16 v[60:63], v[24:27], a[176:183], v4
    v_smfmac_f32_16x16x64_bf16 v[64:67], v[24:27], v[96:103], v4
    v_smfmac_f32_16x16x64_bf16 v[68:71], v[24:27], v[152:159], v4
    v_smfmac_f32_16x16x64_bf16 v[72:75], v[24:27], v[208:215], v4
    s_waitcnt lgkmcnt(4)
    v_smfmac_f32_16x16x64_bf16 v[48:51], v[28:31], a[16:23], v4
    v_smfmac_f32_16x16x64_bf16 v[52:55], v[28:31], a[72:79], v4
    v_smfmac_f32_16x16x64_bf16 v[56:59], v[28:31], a[128:135], v4
    v_smfmac_f32_16x16x64_bf16 v[60:63], v[28:31], a[184:191], v4
    v_smfmac_f32_16x16x64_bf16 v[64:67], v[28:31], v[104:111], v4
    v_smfmac_f32_16x16x64_bf16 v[68:71], v[28:31], v[160:167], v4
    v_smfmac_f32_16x16x64_bf16 v[72:75], v[28:31], v[216:223], v4
    s_waitcnt lgkmcnt(3)
    v_smfmac_f32_16x16x64_bf16 v[48:51], v[32:35], a[24:31], v4
    v_smfmac_f32_16x16x64_bf16 v[52:55], v[32:35], a[80:87], v4
    v_smfmac_f32_16x16x64_bf16 v[56:59], v[32:35], a[136:143], v4
    v_smfmac_f32_16x16x64_bf16 v[60:63], v[32:35], a[192:199], v4
    v_smfmac_f32_16x16x64_bf16 v[64:67], v[32:35], v[112:119], v4
    v_smfmac_f32_16x16x64_bf16 v[68:71], v[32:35], v[168:175], v4
    v_smfmac_f32_16x16x64_bf16 v[72:75], v[32:35], v[224:231], v4
    s_waitcnt lgkmcnt(2)
    v_smfmac_f32_16x16x64_bf16 v[48:51], v[36:39], a[32:39], v4
    v_smfmac_f32_16x16x64_bf16 v[52:55], v[36:39], a[88:95], v4
    v_smfmac_f32_16x16x64_bf16 v[56:59], v[36:39], a[144:151], v4
    v_smfmac_f32_16x16x64_bf16 v[60:63], v[36:39], a[200:207], v4
    v_smfmac_f32_16x16x64_bf16 v[64:67], v[36:39], v[120:127], v4
    v_smfmac_f32_16x16x64_bf16 v[68:71], v[36:39], v[176:183], v4
    v_smfmac_f32_16x16x64_bf16 v[72:75], v[36:39], v[232:239], v4
    s_waitcnt lgkmcnt(1)
    v_smfmac_f32_16x16x64_bf16 v[48:51], v[40:43], a[40:47], v4
    v_smfmac_f32_16x16x64_bf16 v[52:55], v[40:43], a[96:103], v4
    v_smfmac_f32_16x16x64_bf16 v[56:59], v[40:43], a[152:159], v4
    v_smfmac_f32_16x16x64_bf16 v[60:63], v[40:43], a[208:215], v4
    v_smfmac_f32_16x16x64_bf16 v[64:67], v[40:43], v[128:135], v4
    v_smfmac_f32_16x16x64_bf16 v[68:71], v[40:43], v[184:191], v4
    v_smfmac_f32_16x16x64_bf16 v[72:75], v[40:43], v[240:247], v4
    s_waitcnt lgkmcnt(0)
    v_smfmac_f32_16x16x64_bf16 v[48:51], v[44:47], a[48:55], v4
    v_smfmac_f32_16x16x64_bf16 v[52:55], v[44:47], a[104:111], v4
    v_smfmac_f32_16x16x64_bf16 v[56:59], v[44:47], a[160:167], v4
    v_smfmac_f32_16x16x64_bf16 v[60:63], v[44:47], a[216:223], v4
    v_smfmac_f32_16x16x64_bf16 v[64:67], v[44:47], v[136:143], v4
    v_smfmac_f32_16x16x64_bf16 v[68:71], v[44:47], v[192:199], v4
    v_smfmac_f32_16x16x64_bf16 v[72:75], v[44:47], v[248:255], v4
    s_nop 3
    v_permlane32_swap_b32 v48, v50
    v_permlane32_swap_b32 v49, v51
    s_nop 0
    v_add_f32 v48, v48, v50
    v_add_f32 v49, v49, v51
    v_cvt_pk_bf16_f32 v48, v48, v49
    ds_write_b32 v6, v48 offset:0
    v_permlane32_swap_b32 v52, v54
    v_permlane32_swap_b32 v53, v55
    s_nop 0
    v_add_f32 v52, v52, v54
    v_add_f32 v53, v53, v55
    v_cvt_pk_bf16_f32 v52, v52, v53
    ds_write_b32 v6, v52 offset:256
    v_permlane32_swap_b32 v56, v58
    v_permlane32_swap_b32 v57, v59
    s_nop 0
    v_add_f32 v56, v56, v58
    v_add_f32 v57, v57, v59
    v_cvt_pk_bf16_f32 v56, v56, v57
    ds_write_b32 v6, v56 offset:512
    v_permlane32_swap_b32 v60, v62
    v_permlane32_swap_b32 v61, v63
    s_nop 0
    v_add_f32 v60, v60, v62
    v_add_f32 v61, v61, v63
    v_cvt_pk_bf16_f32 v60, v60, v61
    ds_write_b32 v6, v60 offset:768
    v_permlane32_swap_b32 v64, v66
    v_permlane32_swap_b32 v65, v67
    s_nop 0
    v_add_f32 v64, v64, v66
    v_add_f32 v65, v65, v67
    v_cvt_pk_bf16_f32 v64, v64, v65
    ds_write_b32 v6, v64 offset:1024
    v_permlane32_swap_b32 v68, v70
    v_permlane32_swap_b32 v69, v71
    s_nop 0
    v_add_f32 v68, v68, v70
    v_add_f32 v69, v69, v71
    v_cvt_pk_bf16_f32 v68, v68, v69
    ds_write_b32 v6, v68 offset:1280
    v_permlane32_swap_b32 v72, v74
    v_permlane32_swap_b32 v73, v75
    s_nop 0
    v_add_f32 v72, v72, v74
    v_add_f32 v73, v73, v75
    v_cvt_pk_bf16_f32 v72, v72, v73
    ds_write_b32 v6, v72 offset:1536
    s_add_u32 s80, s80, 458752
    s_add_u32 s81, s81, 458752
    s_add_u32 s82, s82, 458752
    s_add_u32 s83, s83, 458752
    s_waitcnt lgkmcnt(0)
    s_barrier
    ds_read_b128 v[64:67], v9 offset:0
    ds_read_b128 v[68:71], v9 offset:3584
    s_sleep 4
    s_waitcnt lgkmcnt(0)
    buffer_load_dwordx4 v[76:79], v7, s[40:43], s54 offen sc1
    buffer_load_dwordx4 v[80:83], v7, s[40:43], s54 offen offset:1024 sc1
    buffer_load_dwordx4 v[84:87], v10, s[40:43], s54 offen sc1
    s_sleep 2
ch_u0_pp:
    buffer_load_dwordx4 v[32:35], v7, s[40:43], s54 offen sc1
    buffer_load_dwordx4 v[36:39], v7, s[40:43], s54 offen offset:1024 sc1
    buffer_load_dwordx4 v[40:43], v10, s[40:43], s54 offen sc1
    s_add_u32 s62, s62, 256
    s_cmp_gt_u32 s62, 51200000
    s_cbranch_scc1 ch_done
    s_waitcnt vmcnt(3)
    v_mfma_f32_16x16x32_bf16 v[56:59], a[232:235], v[76:79], 0
    v_max3_u32 v44, v76, v78, v80
    v_max3_u32 v45, v82, v84, v85
    v_mfma_f32_16x16x32_bf16 v[60:63], a[236:239], v[76:79], 0
    v_max3_u32 v44, v44, v86, v87
    v_max_u32 v44, v44, v45
    v_mfma_f32_16x16x32_bf16 v[48:51], a[224:227], v[76:79], 0
    v_cmp_eq_u32 vcc, -1, v44
    s_cbranch_vccnz ch_u0_pq
    v_mfma_f32_16x16x32_bf16 v[52:55], a[228:231], v[76:79], 0
    v_mfma_f32_16x16x32_bf16 v[56:59], a[248:251], v[80:83], v[56:59]
    v_mfma_f32_16x16x32_bf16 v[60:63], a[252:255], v[80:83], v[60:63]
    v_mfma_f32_16x16x32_bf16 v[48:51], a[240:243], v[80:83], v[48:51]
    v_mfma_f32_16x16x32_bf16 v[52:55], a[244:247], v[80:83], v[52:55]
    s_nop 1
    v_mfma_f32_16x16x32_bf16 v[48:51], v[64:67], v[84:87], v[48:51]
    v_mfma_f32_16x16x32_bf16 v[52:55], v[68:71], v[84:87], v[52:55]
    s_branch ch_u0_pd
ch_u0_pq:
    buffer_load_dwordx4 v[76:79], v7, s[40:43], s54 offen sc1
    buffer_load_dwordx4 v[80:83], v7, s[40:43], s54 offen offset:1024 sc1
    buffer_load_dwordx4 v[84:87], v10, s[40:43], s54 offen sc1
    s_waitcnt vmcnt(3)
    v_mfma_f32_16x16x32_bf16 v[56:59], a[232:235], v[32:35], 0
    v_max3_u32 v44, v32, v34, v36
    v_max3_u32 v45, v38, v40, v41
    v_mfma_f32_16x16x32_bf16 v[60:63], a[236:239], v[32:35], 0
    v_max3_u32 v44, v44, v42, v43
    v_max_u32 v44, v44, v45
    v_mfma_f32_16x16x32_bf16 v[48:51], a[224:227], v[32:35], 0
    v_cmp_eq_u32 vcc, -1, v44
    s_cbranch_vccnz ch_u0_pp
    v_mfma_f32_16x16x32_bf16 v[52:55], a[228:231], v[32:35], 0
    v_mfma_f32_16x16x32_bf16 v[56:59], a[248:251], v[36:39], v[56:59]
    v_mfma_f32_16x16x32_bf16 v[60:63], a[252:255], v[36:39], v[60:63]
    v_mfma_f32_16x16x32_bf16 v[48:51], a[240:243], v[36:39], v[48:51]
    v_mfma_f32_16x16x32_bf16 v[52:55], a[244:247], v[36:39], v[52:55]
    s_nop 1
    v_mfma_f32_16x16x32_bf16 v[48:51], v[64:67], v[40:43], v[48:51]
    v_mfma_f32_16x16x32_bf16 v[52:55], v[68:71], v[40:43], v[52:55]
ch_u0_pd:
    s_nop 4
    v_add_f32_dpp v72, v56, v48 row_ror:8 row_mask:0xf bank_mask:0x3
    v_add_f32_dpp v73, v57, v49 row_ror:8 row_mask:0xf bank_mask:0x3
    v_add_f32_dpp v74, v58, v50 row_ror:8 row_mask:0xf bank_mask:0x3
    v_add_f32_dpp v75, v59, v51 row_ror:8 row_mask:0xf bank_mask:0x3
    v_add_f32_dpp v72, v52, v60 row_ror:8 row_mask:0xf bank_mask:0xc
    v_add_f32_dpp v73, v53, v61 row_ror:8 row_mask:0xf bank_mask:0xc
    v_add_f32_dpp v74, v54, v62 row_ror:8 row_mask:0xf bank_mask:0xc
    v_add_f32_dpp v75, v55, v63 row_ror:8 row_mask:0xf bank_mask:0xc
    s_barrier
    ds_read_b128 v[48:51], v3 offset:16384
    ds_read_b128 v[52:55], v3 offset:17408
    ds_read_b128 v[56:59], v3 offset:18432
    s_cmp_eq_u32 s63, 0
    s_waitcnt lgkmcnt(1)
    v_pk_add_f32 v[72:73], v[72:73], v[48:49]
    v_pk_add_f32 v[74:75], v[74:75], v[50:51]
    s_waitcnt lgkmcnt(0)
    v_pk_add_f32 v[52:53], v[52:53], v[56:57]
    v_pk_add_f32 v[54:55], v[54:55], v[58:59]
    v_pk_add_f32 v[72:73], v[72:73], v[52:53]
    v_pk_add_f32 v[74:75], v[74:75], v[54:55]
    v_cvt_pk_bf16_f32 v18, v72, v73
    v_cvt_pk_bf16_f32 v19, v74, v75
    s_cbranch_scc1 mp_88_s
    buffer_store_dword v18, v13, s[36:39], s59 offen
    buffer_store_dword v19, v2, s[36:39], s59 offen
    buffer_store_dword v18, v11, s[36:39], s59 offen
    buffer_store_dword v19, v12, s[36:39], s59 offen
    s_branch mp_88_d
mp_88_s:
    buffer_store_dword v18, v13, s[36:39], s59 offen sc1
    buffer_store_dword v19, v2, s[36:39], s59 offen sc1
    buffer_store_dword v18, v11, s[36:39], s59 offen sc1
    buffer_store_dword v19, v12, s[36:39], s59 offen sc1
mp_88_d:
    s_add_u32 s59, s59, 14336
    s_add_u32 s52, s52, 1
    s_add_u32 s53, s53, 14336
    s_add_u32 s54, s54, 10240
    s_cmp_lt_u32 s52, 63
    s_cbranch_scc1 ch_u0
    s_mov_b32 s55, 451584
    buffer_store_dword v18, v11, s[28:31], s55 offen sc1
    buffer_store_dword v19, v12, s[28:31], s55 offen sc1
    s_add_u32 s55, s55, 7168
    s_waitcnt vmcnt(0)
    s_branch ch_done
ch_u1:
    v_mov_b32 v48, 0
    v_mov_b32 v49, 0
    v_mov_b32 v50, 0
    v_mov_b32 v51, 0
    v_mov_b32 v52, 0
    v_mov_b32 v53, 0
    v_mov_b32 v54, 0
    v_mov_b32 v55, 0
    v_mov_b32 v56, 0
    v_mov_b32 v57, 0
    v_mov_b32 v58, 0
    v_mov_b32 v59, 0
    v_mov_b32 v60, 0
    v_mov_b32 v61, 0
    v_mov_b32 v62, 0
    v_mov_b32 v63, 0
    v_mov_b32 v64, 0
    v_mov_b32 v65, 0
    v_mov_b32 v66, 0
    v_mov_b32 v67, 0
    v_mov_b32 v68, 0
    v_mov_b32 v69, 0
    v_mov_b32 v70, 0
    v_mov_b32 v71, 0
    v_mov_b32 v72, 0
    v_mov_b32 v73, 0
    v_mov_b32 v74, 0
    v_mov_b32 v75, 0
    s_add_u32 s12, s53, 28672
    s_mov_b32 s62, 0
    s_mov_b64 exec, s[46:47]
ch_u1_pm:
    buffer_load_dwordx4 v[20:23], v15, s[36:39], s53 offen offset:0 sc1
    buffer_load_dwordx4 v[24:27], v15, s[36:39], s53 offen offset:896 sc1
    s_add_u32 s62, s62, 1
    s_cmp_gt_u32 s62, 200000
    s_cbranch_scc1 ch_done
    s_waitcnt vmcnt(0)
    v_max3_u32 v36, v20, v21, v22
    v_max3_u32 v37, v23, v24, v25
    v_max3_u32 v36, v36, v26, v27
    v_max_u32 v36, v36, v37
    v_cmp_eq_u32 vcc, -1, v36
    s_cbranch_vccnz ch_u1_pm
    ds_write_b128 v14, v[20:23] offset:0
    ds_write_b128 v14, v[24:27] offset:912
    s_mov_b64 exec, -1
    s_waitcnt lgkmcnt(0)
    s_barrier
    ds_read_b128 v[20:23], v1 offset:0
    ds_read_b128 v[24:27], v1 offset:128
    ds_read_b128 v[28:31], v1 offset:256
    ds_read_b128 v[32:35], v1 offset:384
    ds_read_b128 v[36:39], v1 offset:512
    ds_read_b128 v[40:43], v1 offset:640
    ds_read_b128 v[44:47], v1 offset:768
    buffer_load_dwordx4 a[224:227], v8, s[24:27], s80 offen offset:0 sc1
    buffer_load_dwordx4 a[228:231], v8, s[24:27], s80 offen offset:224 sc1
    s_waitcnt lgkmcnt(6)
    v_smfmac_f32_16x16x64_bf16 v[48:51], v[20:23], a[0:7], v4
    buffer_load_dwordx4 a[232:235], v8, s[24:27], s81 offen offset:0 sc1
    v_smfmac_f32_16x16x64_bf16 v[52:55], v[20:23], a[56:63], v4
    buffer_load_dwordx4 a[236:239], v8, s[24:27], s81 offen offset:224 sc1
    v_smfmac_f32_16x16x64_bf16 v[56:59], v[20:23], a[112:119], v4
    buffer_load_dwordx4 a[240:243], v8, s[24:27], s82 offen offset:0 sc1
    v_smfmac_f32_16x16x64_bf16 v[60:63], v[20:23], a[168:175], v4
    buffer_load_dwordx4 a[244:247], v8, s[24:27], s82 offen offset:224 sc1
    v_smfmac_f32_16x16x64_bf16 v[64:67], v[20:23], v[88:95], v4
    buffer_load_dwordx4 a[248:251], v8, s[24:27], s83 offen offset:0 sc1
    v_smfmac_f32_16x16x64_bf16 v[68:71], v[20:23], v[144:151], v4
    buffer_load_dwordx4 a[252:255], v8, s[24:27], s83 offen offset:224 sc1
    v_smfmac_f32_16x16x64_bf16 v[72:75], v[20:23], v[200:207], v4
    s_waitcnt lgkmcnt(5)
    v_smfmac_f32_16x16x64_bf16 v[48:51], v[24:27], a[8:15], v4
    v_smfmac_f32_16x16x64_bf16 v[52:55], v[24:27], a[64:71], v4
    v_smfmac_f32_16x16x64_bf16 v[56:59], v[24:27], a[120:127], v4
    v_smfmac_f32_16x16x64_bf16 v[60:63], v[24:27], a[176:183], v4
    v_smfmac_f32_16x16x64_bf16 v[64:67], v[24:27], v[96:103], v4
    v_smfmac_f32_16x16x64_bf16 v[68:71], v[24:27], v[152:159], v4
    v_smfmac_f32_16x16x64_bf16 v[72:75], v[24:27], v[208:215], v4
    s_waitcnt lgkmcnt(4)
    v_smfmac_f32_16x16x64_bf16 v[48:51], v[28:31], a[16:23], v4
    v_smfmac_f32_16x16x64_bf16 v[52:55], v[28:31], a[72:79], v4
    v_smfmac_f32_16x16x64_bf16 v[56:59], v[28:31], a[128:135], v4
    v_smfmac_f32_16x16x64_bf16 v[60:63], v[28:31], a[184:191], v4
    v_smfmac_f32_16x16x64_bf16 v[64:67], v[28:31], v[104:111], v4
    v_smfmac_f32_16x16x64_bf16 v[68:71], v[28:31], v[160:167], v4
    v_smfmac_f32_16x16x64_bf16 v[72:75], v[28:31], v[216:223], v4
    s_waitcnt lgkmcnt(3)
    v_smfmac_f32_16x16x64_bf16 v[48:51], v[32:35], a[24:31], v4
    v_smfmac_f32_16x16x64_bf16 v[52:55], v[32:35], a[80:87], v4
    v_smfmac_f32_16x16x64_bf16 v[56:59], v[32:35], a[136:143], v4
    v_smfmac_f32_16x16x64_bf16 v[60:63], v[32:35], a[192:199], v4
    v_smfmac_f32_16x16x64_bf16 v[64:67], v[32:35], v[112:119], v4
    v_smfmac_f32_16x16x64_bf16 v[68:71], v[32:35], v[168:175], v4
    v_smfmac_f32_16x16x64_bf16 v[72:75], v[32:35], v[224:231], v4
    s_waitcnt lgkmcnt(2)
    v_smfmac_f32_16x16x64_bf16 v[48:51], v[36:39], a[32:39], v4
    v_smfmac_f32_16x16x64_bf16 v[52:55], v[36:39], a[88:95], v4
    v_smfmac_f32_16x16x64_bf16 v[56:59], v[36:39], a[144:151], v4
    v_smfmac_f32_16x16x64_bf16 v[60:63], v[36:39], a[200:207], v4
    v_smfmac_f32_16x16x64_bf16 v[64:67], v[36:39], v[120:127], v4
    v_smfmac_f32_16x16x64_bf16 v[68:71], v[36:39], v[176:183], v4
    v_smfmac_f32_16x16x64_bf16 v[72:75], v[36:39], v[232:239], v4
    s_waitcnt lgkmcnt(1)
    v_smfmac_f32_16x16x64_bf16 v[48:51], v[40:43], a[40:47], v4
    v_smfmac_f32_16x16x64_bf16 v[52:55], v[40:43], a[96:103], v4
    v_smfmac_f32_16x16x64_bf16 v[56:59], v[40:43], a[152:159], v4
    v_smfmac_f32_16x16x64_bf16 v[60:63], v[40:43], a[208:215], v4
    v_smfmac_f32_16x16x64_bf16 v[64:67], v[40:43], v[128:135], v4
    v_smfmac_f32_16x16x64_bf16 v[68:71], v[40:43], v[184:191], v4
    v_smfmac_f32_16x16x64_bf16 v[72:75], v[40:43], v[240:247], v4
    s_waitcnt lgkmcnt(0)
    v_smfmac_f32_16x16x64_bf16 v[48:51], v[44:47], a[48:55], v4
    v_smfmac_f32_16x16x64_bf16 v[52:55], v[44:47], a[104:111], v4
    v_smfmac_f32_16x16x64_bf16 v[56:59], v[44:47], a[160:167], v4
    v_smfmac_f32_16x16x64_bf16 v[60:63], v[44:47], a[216:223], v4
    v_smfmac_f32_16x16x64_bf16 v[64:67], v[44:47], v[136:143], v4
    v_smfmac_f32_16x16x64_bf16 v[68:71], v[44:47], v[192:199], v4
    v_smfmac_f32_16x16x64_bf16 v[72:75], v[44:47], v[248:255], v4
    s_nop 3
    v_permlane32_swap_b32 v48, v50
    v_permlane32_swap_b32 v49, v51
    s_nop 0
    v_add_f32 v48, v48, v50
    v_add_f32 v49, v49, v51
    v_cvt_pk_bf16_f32 v48, v48, v49
    ds_write_b32 v6, v48 offset:0
    v_permlane32_swap_b32 v52, v54
    v_permlane32_swap_b32 v53, v55
    s_nop 0
    v_add_f32 v52, v52, v54
    v_add_f32 v53, v53, v55
    v_cvt_pk_bf16_f32 v52, v52, v53
    ds_write_b32 v6, v52 offset:256
    v_permlane32_swap_b32 v56, v58
    v_permlane32_swap_b32 v57, v59
    s_nop 0
    v_add_f32 v56, v56, v58
    v_add_f32 v57, v57, v59
    v_cvt_pk_bf16_f32 v56, v56, v57
    ds_write_b32 v6, v56 offset:512
    v_permlane32_swap_b32 v60, v62
    v_permlane32_swap_b32 v61, v63
    s_nop 0
    v_add_f32 v60, v60, v62
    v_add_f32 v61, v61, v63
    v_cvt_pk_bf16_f32 v60, v60, v61
    ds_write_b32 v6, v60 offset:768
    v_permlane32_swap_b32 v64, v66
    v_permlane32_swap_b32 v65, v67
    s_nop 0
    v_add_f32 v64, v64, v66
    v_add_f32 v65, v65, v67
    v_cvt_pk_bf16_f32 v64, v64, v65
    ds_write_b32 v6, v64 offset:1024
    v_permlane32_swap_b32 v68, v70
    v_permlane32_swap_b32 v69, v71
    s_nop 0
    v_add_f32 v68, v68, v70
    v_add_f32 v69, v69, v71
    v_cvt_pk_bf16_f32 v68, v68, v69
    ds_write_b32 v6, v68 offset:1280
    v_permlane32_swap_b32 v72, v74
    v_permlane32_swap_b32 v73, v75
    s_nop 0
    v_add_f32 v72, v72, v74
    v_add_f32 v73, v73, v75
    v_cvt_pk_bf16_f32 v72, v72, v73
    ds_write_b32 v6, v72 offset:1536
    s_add_u32 s80, s80, 458752
    s_add_u32 s81, s81, 458752
    s_add_u32 s82, s82, 458752
    s_add_u32 s83, s83, 458752
    s_waitcnt lgkmcnt(0)
    s_barrier
    ds_read_b128 v[64:67], v9 offset:0
    ds_read_b128 v[68:71], v9 offset:3584
    s_sleep 4
    s_waitcnt lgkmcnt(0)
    buffer_load_dwordx4 v[76:79], v7, s[40:43], s54 offen sc1
    buffer_load_dwordx4 v[80:83], v7, s[40:43], s54 offen offset:1024 sc1
    buffer_load_dwordx4 v[84:87], v10, s[40:43], s54 offen sc1
    s_sleep 2
ch_u1_pp:
    buffer_load_dwordx4 v[32:35], v7, s[40:43], s54 offen sc1
    buffer_load_dwordx4 v[36:39], v7, s[40:43], s54 offen offset:1024 sc1
    buffer_load_dwordx4 v[40:43], v10, s[40:43], s54 offen sc1
    s_add_u32 s62, s62, 256
    s_cmp_gt_u32 s62, 51200000
    s_cbranch_scc1 ch_done
    s_waitcnt vmcnt(3)
    v_mfma_f32_16x16x32_bf16 v[56:59], a[232:235], v[76:79], 0
    v_max3_u32 v44, v76, v78, v80
    v_max3_u32 v45, v82, v84, v85
    v_mfma_f32_16x16x32_bf16 v[60:63], a[236:239], v[76:79], 0
    v_max3_u32 v44, v44, v86, v87
    v_max_u32 v44, v44, v45
    v_mfma_f32_16x16x32_bf16 v[48:51], a[224:227], v[76:79], 0
    v_cmp_eq_u32 vcc, -1, v44
    s_cbranch_vccnz ch_u1_pq
    v_mfma_f32_16x16x32_bf16 v[52:55], a[228:231], v[76:79], 0
    v_mfma_f32_16x16x32_bf16 v[56:59], a[248:251], v[80:83], v[56:59]
    v_mfma_f32_16x16x32_bf16 v[60:63], a[252:255], v[80:83], v[60:63]
    v_mfma_f32_16x16x32_bf16 v[48:51], a[240:243], v[80:83], v[48:51]
    v_mfma_f32_16x16x32_bf16 v[52:55], a[244:247], v[80:83], v[52:55]
    s_nop 1
    v_mfma_f32_16x16x32_bf16 v[48:51], v[64:67], v[84:87], v[48:51]
    v_mfma_f32_16x16x32_bf16 v[52:55], v[68:71], v[84:87], v[52:55]
    s_branch ch_u1_pd
ch_u1_pq:
    buffer_load_dwordx4 v[76:79], v7, s[40:43], s54 offen sc1
    buffer_load_dwordx4 v[80:83], v7, s[40:43], s54 offen offset:1024 sc1
    buffer_load_dwordx4 v[84:87], v10, s[40:43], s54 offen sc1
    s_waitcnt vmcnt(3)
    v_mfma_f32_16x16x32_bf16 v[56:59], a[232:235], v[32:35], 0
    v_max3_u32 v44, v32, v34, v36
    v_max3_u32 v45, v38, v40, v41
    v_mfma_f32_16x16x32_bf16 v[60:63], a[236:239], v[32:35], 0
    v_max3_u32 v44, v44, v42, v43
    v_max_u32 v44, v44, v45
    v_mfma_f32_16x16x32_bf16 v[48:51], a[224:227], v[32:35], 0
    v_cmp_eq_u32 vcc, -1, v44
    s_cbranch_vccnz ch_u1_pp
    v_mfma_f32_16x16x32_bf16 v[52:55], a[228:231], v[32:35], 0
    v_mfma_f32_16x16x32_bf16 v[56:59], a[248:251], v[36:39], v[56:59]
    v_mfma_f32_16x16x32_bf16 v[60:63], a[252:255], v[36:39], v[60:63]
    v_mfma_f32_16x16x32_bf16 v[48:51], a[240:243], v[36:39], v[48:51]
    v_mfma_f32_16x16x32_bf16 v[52:55], a[244:247], v[36:39], v[52:55]
    s_nop 1
    v_mfma_f32_16x16x32_bf16 v[48:51], v[64:67], v[40:43], v[48:51]
    v_mfma_f32_16x16x32_bf16 v[52:55], v[68:71], v[40:43], v[52:55]
ch_u1_pd:
    s_nop 4
    v_add_f32_dpp v72, v56, v48 row_ror:8 row_mask:0xf bank_mask:0x3
    v_add_f32_dpp v73, v57, v49 row_ror:8 row_mask:0xf bank_mask:0x3
    v_add_f32_dpp v74, v58, v50 row_ror:8 row_mask:0xf bank_mask:0x3
    v_add_f32_dpp v75, v59, v51 row_ror:8 row_mask:0xf bank_mask:0x3
    v_add_f32_dpp v72, v52, v60 row_ror:8 row_mask:0xf bank_mask:0xc
    v_add_f32_dpp v73, v53, v61 row_ror:8 row_mask:0xf bank_mask:0xc
    v_add_f32_dpp v74, v54, v62 row_ror:8 row_mask:0xf bank_mask:0xc
    v_add_f32_dpp v75, v55, v63 row_ror:8 row_mask:0xf bank_mask:0xc
    ds_write_b128 v16, v[72:75]
    s_waitcnt lgkmcnt(0)
    s_barrier
    s_add_u32 s12, s52, 1
    s_cmp_eq_u32 s12, 4
    s_cselect_b32 s12, 0, s12
    s_and_b32 s13, s12, 7
    s_cmp_eq_u32 s13, 0
    s_cbranch_scc0 ch_u1_ng
    s_cmp_lt_u32 s12, 64
    s_cbranch_scc0 ch_u1_ng
    s_cmp_eq_u32 s8, 3
    s_cbranch_scc0 ch_u1_ng
    s_lshl_b32 s12, s12, 7
    s_add_u32 s12, s12, 4096
    v_and_b32 v28, 63, v0
    v_lshlrev_b32 v28, 4, v28
    v_add_u32 v28, s12, v28
    s_mov_b32 s62, 0
    v_mov_b32 v20, 0
    v_mov_b32 v21, 0
    v_mov_b32 v22, 0
    v_mov_b32 v23, 0
    v_mov_b32 v24, 0
    v_mov_b32 v25, 0
    v_mov_b32 v26, 0
    v_mov_b32 v27, 0
fw_89:
    s_mov_b32 exec_lo, 0xffffffff
    s_mov_b32 exec_hi, 0xffffff
    buffer_load_dwordx4 v[20:23], v28, s[76:79], 0 offen sc1
    s_mov_b64 exec, -1
    s_add_u32 s62, s62, 1
    s_cmp_gt_u32 s62, 3000000
    s_cbranch_scc1 ch_done
    s_waitcnt vmcnt(0)
    v_max3_u32 v20, v20, v21, v22
    v_max3_u32 v24, v24, v25, v26
    v_max3_u32 v20, v20, v23, v27
    v_max_u32 v20, v20, v24
    v_cmp_eq_u32 vcc, -1, v20
    s_cbranch_vccz fw_89_ok
    s_sleep 1
    s_branch fw_89
fw_89_ok:
ch_u1_ng:
    s_add_u32 s52, s52, 1
    s_add_u32 s53, s53, 14336
    s_add_u32 s54, s54, 10240
    s_cmp_lt_u32 s52, 63
    s_cbranch_scc1 ch_u1
    s_waitcnt vmcnt(0)
    s_branch ch_done
ch_done:
    s_mov_b64 exec, -1
    s_endpgm
    s_endpgm
.section .rodata,"a"
.p2align 6
.amdhsa_kernel mega_kernel
  .amdhsa_next_free_vgpr 512
  .amdhsa_next_free_sgpr 102
  .amdhsa_accum_offset 256
  .amdhsa_group_segment_fixed_size 0
  .amdhsa_kernarg_size 112
  .amdhsa_user_sgpr_count 2
  .amdhsa_user_sgpr_kernarg_segment_ptr 1
  .amdhsa_system_sgpr_workgroup_id_x 1
.end_amdhsa_kernel
```
